```python
import torch

def _softmax(x, axis=-1):
    return torch.softmax(x, dim=axis)

def _gelu(x):
    return torch.nn.functional.gelu(x, approximate='tanh')

def _silu(x):
    return torch.nn.functional.silu(x)

def _sigmoid(x):
    return torch.sigmoid(x)

def _layernorm(x, axis=-1, eps=1e-05):
    m = x.mean(dim=axis, keepdim=True)
    v = x.var(dim=axis, keepdim=True, unbiased=False)
    return (x - m) / torch.sqrt(v + eps)

def _scatter_add(tgt, idx, src, axis=0):
    return tgt.clone().index_add_(axis, idx, src)

def _segment_sum(src, seg, n):
    out = torch.zeros((n,) + src.shape[1:], dtype=src.dtype)
    return out.index_add_(0, seg, src)

def _pad(x, pw):
    flat = tuple((v for pair in reversed(pw) for v in pair))
    return torch.nn.functional.pad(x, flat)
kernel_name = 'interleave_layers__memory_aug_recurrent_mem_tr__sliding_local_dilated__prompt'

def setup_inputs():

    _w = lambda a: (lambda t: t.to(torch.bfloat16) if t.is_floating_point() else t)(torch.as_tensor(a))

    def _A_setup():
        B, S, Dm = (1, 2048, 640)
        H, Dh = (32, 192)
        M, seg = (8, 32)
        seg = min(seg, S)
        S = S // seg * seg
        return {'x': _w((lambda *s: torch.randn(*s, dtype=torch.bfloat16) * 0.05)(B, S, Dm)), 'mem0': _w((lambda *s: torch.randn(*s, dtype=torch.bfloat16) * 0.8)(B, M, Dm)), 'Wq': _w((lambda *s: torch.randn(*s, dtype=torch.bfloat16) * 1.6)(Dm, H, Dh) * Dm ** (-0.5)), 'Wk': _w((lambda *s: torch.randn(*s, dtype=torch.bfloat16) * 1.6)(Dm, H, Dh) * Dm ** (-0.5)), 'Wv': _w((lambda *s: torch.randn(*s, dtype=torch.bfloat16) * 0.8)(Dm, H, Dh) * Dm ** (-0.5)), 'Wo': _w((lambda *s: torch.randn(*s, dtype=torch.bfloat16) * 0.8)(H, Dh, Dm) * (H * Dh) ** (-0.5)), 'seg_len': seg}
    _A_in = _A_setup()

    def _B_setup():
        B, S, D = (1, 2048, 640)
        return {'x': _w((lambda *s: torch.randn(*s, dtype=torch.bfloat16) * 0.05)(B, S, D)), 'wqkv': _w((lambda *s: torch.randn(*s, dtype=torch.bfloat16) * 0.05)(D, 3 * D)), 'wo': _w((lambda *s: torch.randn(*s, dtype=torch.bfloat16) * 0.05)(D, D))}
    _B_in = _B_setup()
    return {'A_x': _A_in['x'], 'A_mem0': _A_in['mem0'], 'A_Wq': _A_in['Wq'], 'A_Wk': _A_in['Wk'], 'A_Wv': _A_in['Wv'], 'A_Wo': _A_in['Wo'], 'A_seg_len': _A_in['seg_len'], 'B_x': _B_in['x'], 'B_wqkv': _B_in['wqkv'], 'B_wo': _B_in['wo']}

def reference(A_x, A_mem0, A_Wq, A_Wk, A_Wv, A_Wo, A_seg_len, B_x, B_wqkv, B_wo):

    def _A_ref(x, mem0, Wq, Wk, Wv, Wo, seg_len):
        B, S, Dm = x.shape
        H, Dh = (Wq.shape[1], Wq.shape[2])
        M = mem0.shape[1]
        scale = Dh ** (-0.5)
        n_seg = S // seg_len
        L = M + seg_len
        idx = torch.arange(L)
        mask = (idx[:, None] < M) | (idx[:, None] >= idx[None, :])
        mem = mem0
        outs = []
        for s in range(n_seg):
            xs = x[:, s * seg_len:(s + 1) * seg_len, :].clone()
            h = torch.concatenate([mem, xs], axis=1)
            q = torch.einsum('btd,dhe->bhte', h, Wq)
            k = torch.einsum('btd,dhe->bhte', h, Wk)
            v = torch.einsum('btd,dhe->bhte', h, Wv)
            scores = torch.einsum('bhqe,bhke->bhqk', q, k) * scale
            scores = torch.where(mask[None, None], scores, -1000000000.0)
            p = _softmax(scores, axis=-1)
            o = torch.einsum('bhqk,bhke->bhqe', p, v)
            o = torch.einsum('bhte,hed->btd', o, Wo)
            mem = o[:, :M, :].clone()
            outs.append(o[:, M:, :])
        return torch.concatenate(outs, axis=1)

    def _B_ref(x, wqkv, wo):
        B, S, D = x.shape
        H = 32
        Dh = D // H
        W, dil = (8, 2)
        qkv = (lambda x, *d: x.permute(*d))((x @ wqkv).reshape(B, S, 3, H, Dh), 2, 0, 3, 1, 4)
        q, k, v = (qkv[0], qkv[1], qkv[2])
        scale = Dh ** (-0.5)
        pos = torch.arange(S)
        off = torch.arange(W) * dil
        idx = pos[:, None] - off[None, :]
        mask = idx >= 0
        idx_c = torch.where(mask, idx, 0).reshape(-1)
        kg = k[:, :, idx_c, :].reshape(B, H, S, W, Dh)
        vg = v[:, :, idx_c, :].reshape(B, H, S, W, Dh)
        logits = torch.einsum('bhsd,bhswd->bhsw', q, kg) * scale
        logits = torch.where(mask[None, None, :, :], logits, -1000000000.0)
        attn = _softmax(logits, axis=-1)
        o = torch.einsum('bhsw,bhswd->bhsd', attn, vg)
        return (lambda x, *d: x.permute(*d))(o, 0, 2, 1, 3).reshape(B, S, D) @ wo
    x = A_x
    x = x + _A_ref(_layernorm(x, axis=-1), A_mem0, A_Wq, A_Wk, A_Wv, A_Wo, A_seg_len)
    x = x + _B_ref(_layernorm(x, axis=-1), B_wqkv, B_wo)
    x = x + _A_ref(_layernorm(x, axis=-1), A_mem0, A_Wq, A_Wk, A_Wv, A_Wo, A_seg_len)
    x = x + _B_ref(_layernorm(x, axis=-1), B_wqkv, B_wo)
    return x
```

```asm
; @launch grid=(256,1,1) block=(256,1,1) lds=163840
.amdgcn_target "amdgcn-amd-amdhsa--gfx950"
.text
.globl interleave_layers__memory_aug_recurrent_mem_tr__sliding_local_dilated__prompt_kernel
.p2align 8
.type interleave_layers__memory_aug_recurrent_mem_tr__sliding_local_dilated__prompt_kernel,@function
interleave_layers__memory_aug_recurrent_mem_tr__sliding_local_dilated__prompt_kernel:
    s_cmp_ge_u32 s2, 256
    s_cbranch_scc1 L_end
    s_load_dwordx16 s[32:47], s[0:1], 0
    s_load_dwordx8 s[48:55], s[0:1], 64
    s_load_dwordx2 s[56:57], s[0:1], 96
    s_getreg_b32 s58, hwreg(HW_REG_XCC_ID)
    s_and_b32 s58, s58, 7
    v_lshrrev_b32 v1, 6, v0
    s_nop 0
    v_readfirstlane_b32 s60, v1
    s_mov_b32 s61, 0x100000
    s_waitcnt lgkmcnt(0)
    s_mov_b32 s4, s56
    s_mov_b32 s5, s57
    s_mov_b32 s6, 268435456
    s_mov_b32 s7, 0x20000
    s_mov_b32 s8, s54
    s_mov_b32 s9, s55
    s_mov_b32 s10, 256
    s_mov_b32 s11, 0x20000
    s_mov_b32 s12, s32
    s_mov_b32 s13, s33
    s_mov_b32 s14, 2621440
    s_mov_b32 s15, 0x20000
    s_cmp_lg_u32 s60, 0
    s_cbranch_scc1 L_notick
    s_mov_b64 exec, 1
    v_mov_b32 v2, 1
    s_lshl_b32 s64, s58, 5
    v_mov_b32 v3, s64
    buffer_atomic_add v2, v3, s[8:11], 0 offen sc0
    s_mov_b64 exec, -1
L_notick:
    v_lshrrev_b32 v4, 5, v0
    s_lshl_b32 s64, s2, 3
    v_add_u32 v4, s64, v4
    v_mul_u32_u24 v4, 1280, v4
    v_and_b32 v5, 31, v0
    v_lshl_add_u32 v6, v5, 3, v4
    v_lshl_add_u32 v5, v5, 4, v4
    buffer_load_dwordx4 v[8:11], v5, s[12:15], 0 offen
    buffer_load_dwordx4 v[12:15], v5, s[12:15], 0 offen offset:512
    buffer_load_dwordx2 v[16:17], v6, s[12:15], 0 offen offset:1024
    s_cmp_lg_u32 s60, 0
    s_cbranch_scc1 L_notick2
    v_mov_b32 v3, 0
    s_mov_b64 exec, 1
    s_waitcnt vmcnt(3)
    ds_write_b32 v3, v2
    s_mov_b64 exec, -1
L_notick2:
    s_waitcnt lgkmcnt(0)
    s_barrier
    v_mov_b32 v3, 0
    s_waitcnt vmcnt(3)
    ds_read_b32 v2, v3
    s_waitcnt lgkmcnt(0)
    v_readfirstlane_b32 s59, v2
    s_waitcnt lgkmcnt(0)
    s_barrier
    s_waitcnt vmcnt(2)
    v_lshlrev_b32 v20, 16, v8
    v_and_b32 v21, 0xffff0000, v8
    v_lshlrev_b32 v22, 16, v9
    v_and_b32 v23, 0xffff0000, v9
    v_lshlrev_b32 v24, 16, v10
    v_and_b32 v25, 0xffff0000, v10
    v_lshlrev_b32 v26, 16, v11
    v_and_b32 v27, 0xffff0000, v11
    s_waitcnt vmcnt(1)
    v_lshlrev_b32 v28, 16, v12
    v_and_b32 v29, 0xffff0000, v12
    v_lshlrev_b32 v30, 16, v13
    v_and_b32 v31, 0xffff0000, v13
    v_lshlrev_b32 v32, 16, v14
    v_and_b32 v33, 0xffff0000, v14
    v_lshlrev_b32 v34, 16, v15
    v_and_b32 v35, 0xffff0000, v15
    s_waitcnt vmcnt(0)
    v_lshlrev_b32 v36, 16, v16
    v_and_b32 v37, 0xffff0000, v16
    v_lshlrev_b32 v38, 16, v17
    v_and_b32 v39, 0xffff0000, v17
    v_add_f32 v40, v20, v21
    v_add_f32 v41, v22, v23
    v_add_f32 v40, v40, v24
    v_add_f32 v41, v41, v25
    v_add_f32 v40, v40, v26
    v_add_f32 v41, v41, v27
    v_add_f32 v40, v40, v28
    v_add_f32 v41, v41, v29
    v_add_f32 v40, v40, v30
    v_add_f32 v41, v41, v31
    v_add_f32 v40, v40, v32
    v_add_f32 v41, v41, v33
    v_add_f32 v40, v40, v34
    v_add_f32 v41, v41, v35
    v_add_f32 v40, v40, v36
    v_add_f32 v41, v41, v37
    v_add_f32 v40, v40, v38
    v_add_f32 v41, v41, v39
    v_add_f32 v40, v40, v41
    s_nop 1
    v_add_f32_dpp v40, v40, v40 quad_perm:[1,0,3,2] row_mask:0xf bank_mask:0xf
    s_nop 1
    v_add_f32_dpp v40, v40, v40 quad_perm:[2,3,0,1] row_mask:0xf bank_mask:0xf
    s_nop 1
    v_add_f32_dpp v40, v40, v40 row_half_mirror row_mask:0xf bank_mask:0xf
    s_nop 1
    v_add_f32_dpp v40, v40, v40 row_mirror row_mask:0xf bank_mask:0xf
    v_mov_b32 v41, v40
    s_nop 1
    v_permlane16_swap_b32 v40, v41
    v_add_f32 v40, v40, v41
    v_mul_f32 v40, 0x3acccccd, v40
    v_sub_f32 v20, v20, v40
    v_sub_f32 v21, v21, v40
    v_sub_f32 v22, v22, v40
    v_sub_f32 v23, v23, v40
    v_sub_f32 v24, v24, v40
    v_sub_f32 v25, v25, v40
    v_sub_f32 v26, v26, v40
    v_sub_f32 v27, v27, v40
    v_sub_f32 v28, v28, v40
    v_sub_f32 v29, v29, v40
    v_sub_f32 v30, v30, v40
    v_sub_f32 v31, v31, v40
    v_sub_f32 v32, v32, v40
    v_sub_f32 v33, v33, v40
    v_sub_f32 v34, v34, v40
    v_sub_f32 v35, v35, v40
    v_sub_f32 v36, v36, v40
    v_sub_f32 v37, v37, v40
    v_sub_f32 v38, v38, v40
    v_sub_f32 v39, v39, v40
    v_mul_f32 v40, v20, v20
    v_mul_f32 v41, v21, v21
    v_fmac_f32 v40, v22, v22
    v_fmac_f32 v41, v23, v23
    v_fmac_f32 v40, v24, v24
    v_fmac_f32 v41, v25, v25
    v_fmac_f32 v40, v26, v26
    v_fmac_f32 v41, v27, v27
    v_fmac_f32 v40, v28, v28
    v_fmac_f32 v41, v29, v29
    v_fmac_f32 v40, v30, v30
    v_fmac_f32 v41, v31, v31
    v_fmac_f32 v40, v32, v32
    v_fmac_f32 v41, v33, v33
    v_fmac_f32 v40, v34, v34
    v_fmac_f32 v41, v35, v35
    v_fmac_f32 v40, v36, v36
    v_fmac_f32 v41, v37, v37
    v_fmac_f32 v40, v38, v38
    v_fmac_f32 v41, v39, v39
    v_add_f32 v40, v40, v41
    s_nop 1
    v_add_f32_dpp v40, v40, v40 quad_perm:[1,0,3,2] row_mask:0xf bank_mask:0xf
    s_nop 1
    v_add_f32_dpp v40, v40, v40 quad_perm:[2,3,0,1] row_mask:0xf bank_mask:0xf
    s_nop 1
    v_add_f32_dpp v40, v40, v40 row_half_mirror row_mask:0xf bank_mask:0xf
    s_nop 1
    v_add_f32_dpp v40, v40, v40 row_mirror row_mask:0xf bank_mask:0xf
    v_mov_b32 v41, v40
    s_nop 1
    v_permlane16_swap_b32 v40, v41
    v_add_f32 v40, v40, v41
    v_mov_b32 v41, 0x3727c5ac
    v_fmac_f32 v41, 0x3acccccd, v40
    v_rsq_f32 v40, v41
    s_nop 0
    v_mul_f32 v20, v20, v40
    v_mul_f32 v21, v21, v40
    v_mul_f32 v22, v22, v40
    v_mul_f32 v23, v23, v40
    v_mul_f32 v24, v24, v40
    v_mul_f32 v25, v25, v40
    v_mul_f32 v26, v26, v40
    v_mul_f32 v27, v27, v40
    v_mul_f32 v28, v28, v40
    v_mul_f32 v29, v29, v40
    v_mul_f32 v30, v30, v40
    v_mul_f32 v31, v31, v40
    v_mul_f32 v32, v32, v40
    v_mul_f32 v33, v33, v40
    v_mul_f32 v34, v34, v40
    v_mul_f32 v35, v35, v40
    v_mul_f32 v36, v36, v40
    v_mul_f32 v37, v37, v40
    v_mul_f32 v38, v38, v40
    v_mul_f32 v39, v39, v40
    v_cvt_pk_bf16_f32 v8, v20, v21
    v_cvt_pk_bf16_f32 v9, v22, v23
    v_cvt_pk_bf16_f32 v10, v24, v25
    v_cvt_pk_bf16_f32 v11, v26, v27
    v_cvt_pk_bf16_f32 v12, v28, v29
    v_cvt_pk_bf16_f32 v13, v30, v31
    v_cvt_pk_bf16_f32 v14, v32, v33
    v_cvt_pk_bf16_f32 v15, v34, v35
    v_cvt_pk_bf16_f32 v16, v36, v37
    v_cvt_pk_bf16_f32 v17, v38, v39
    s_mov_b32 s64, 16777216
    buffer_store_dwordx4 v[8:11], v5, s[4:7], s64 offen sc1
    buffer_store_dwordx4 v[12:15], v5, s[4:7], s64 offen offset:512 sc1
    buffer_store_dwordx2 v[16:17], v6, s[4:7], s64 offen offset:1024 sc1
    s_lshr_b32 s68, s58, 2
    s_and_b32 s69, s58, 3
    s_lshl_b32 s63, s58, 5
    s_add_u32 s63, s63, s59
    s_lshl_b32 s63, s63, 5
    s_add_u32 s63, s63, s60
    s_lshl_b32 s63, s63, 2
    s_add_u32 s63, s63, 8388608
    s_mov_b32 s62, 0
    s_cmp_lt_u32 s59, 24
    s_cbranch_scc1 L_roleC
    s_cmp_lt_u32 s59, 28
    s_cbranch_scc1 L_roleT
    s_cmp_lt_u32 s59, 30
    s_cbranch_scc1 L_roleB
    s_cmp_lt_u32 s59, 32
    s_cbranch_scc1 L_roleR
    s_mov_b32 s67, 2
L_fail:
    s_mov_b64 exec, 1
    s_lshl_b32 s67, s67, 8
    s_add_u32 s67, s67, s59
    s_lshl_b32 s67, s67, 8
    s_add_u32 s67, s67, s58
    s_lshl_b32 s67, s67, 8
    s_add_u32 s67, s67, s62
    s_waitcnt vmcnt(0)
    v_mov_b32 v2, s67
    v_mov_b32 v3, 24
    buffer_store_dword v2, v3, s[8:11], 0 offen
L_end:
    s_endpgm
L_roleC:
    s_mov_b32 s12, s36
    s_mov_b32 s13, s37
    s_mov_b32 s14, 7864320
    s_mov_b32 s15, 0x20000
    s_mov_b32 s16, s38
    s_mov_b32 s17, s39
    s_mov_b32 s18, 7864320
    s_mov_b32 s19, 0x20000
    s_mov_b32 s20, s40
    s_mov_b32 s21, s41
    s_mov_b32 s22, 7864320
    s_mov_b32 s23, 0x20000
    s_mov_b32 s24, s42
    s_mov_b32 s25, s43
    s_mov_b32 s26, 7864320
    s_mov_b32 s27, 0x20000
    s_mov_b32 s28, s34
    s_mov_b32 s29, s35
    s_mov_b32 s30, 10240
    s_mov_b32 s31, 0x20000
    v_and_b32 v1, 63, v0
    s_mul_i32 s64, s69, 3072
    s_lshl_b32 s65, s59, 7
    s_add_u32 s64, s64, s65
    s_mul_i32 s65, s60, 98304
    s_add_u32 s64, s64, s65
    v_lshrrev_b32 v180, 3, v1
    v_mul_u32_u24 v180, 12288, v180
    v_and_b32 v181, 7, v1
    v_lshl_add_u32 v180, v181, 4, v180
    v_add_u32 v180, s64, v180
    s_lshl_b32 s78, s60, 10
    s_mov_b32 s65, 0
    s_add_u32 m0, s78, 0
Lstg_1:
    s_nop 0
    buffer_load_dwordx4 v180, s[12:15], s65 offen lds
    s_add_u32 m0, m0, 4096
    s_add_u32 s65, s65, 393216
    s_cmp_lt_u32 s65, 7864320
    s_cbranch_scc1 Lstg_1
    s_mov_b32 s65, 0
    s_add_u32 m0, s78, 81920
Lstg_2:
    s_nop 0
    buffer_load_dwordx4 v180, s[16:19], s65 offen lds
    s_add_u32 m0, m0, 4096
    s_add_u32 s65, s65, 393216
    s_cmp_lt_u32 s65, 7864320
    s_cbranch_scc1 Lstg_2
    v_and_b32 v204, 7, v1
    v_bfe_u32 v205, v1, 3, 1
    v_lshrrev_b32 v206, 4, v1
    v_and_b32 v207, 15, v1
    v_lshlrev_b32 v88, 4, v0
    v_lshlrev_b32 v89, 3, v0
    v_add_u32 v89, 8192, v89
    v_lshlrev_b32 v90, 4, v1
    v_lshlrev_b32 v92, 3, v1
    v_lshlrev_b32 v91, 2, v1
    v_lshrrev_b32 v208, 3, v0
    v_mul_u32_u24 v84, 1280, v208
    v_and_b32 v208, 7, v208
    v_xor_b32 v208, v208, v204
    v_lshl_add_u32 v84, v208, 4, v84
    v_mul_u32_u24 v85, 10240, v205
    v_lshl_add_u32 v85, v204, 7, v85
    v_xor_b32 v208, v206, v204
    v_lshl_add_u32 v85, v208, 4, v85
    v_xor_b32 v86, 64, v85
    v_lshlrev_b32 v87, 7, v206
    v_lshl_add_u32 v87, v204, 4, v87
    v_lshl_add_u32 v102, v205, 3, v87
    s_lshl_b32 s64, s60, 13
    s_add_u32 s64, s64, 61440
    v_add_u32 v93, s64, v90
    v_lshl_add_u32 v94, v205, 10, v90
    v_add_u32 v94, 62464, v94
    v_lshrrev_b32 v208, 1, v206
    v_lshl_add_u32 v208, v208, 1, v205
    v_lshl_add_u32 v95, v208, 2, v90
    v_add_u32 v95, 61440, v95
    s_and_b32 s64, s60, 1
    s_lshl_b32 s64, s64, 3
    s_lshr_b32 s65, s60, 1
    v_lshl_add_u32 v209, v206, 4, v204
    v_add_u32 v209, s64, v209
    v_add_u32 v96, 1, v205
    v_mul_u32_u24 v96, s65, v96
    v_lshlrev_b32 v96, 10, v96
    v_lshl_add_u32 v96, v209, 4, v96
    v_add_u32 v96, 66560, v96
    s_lshl_b32 s66, s65, 10
    s_add_u32 s66, s66, 64512
    v_lshlrev_b32 v97, 4, v209
    v_lshl_add_u32 v97, v208, 2, v97
    v_add_u32 v97, s66, v97
    s_mul_i32 s66, s65, 1536
    s_add_u32 s66, s66, 12288
    v_lshlrev_b32 v99, 4, v209
    v_lshlrev_b32 v98, 3, v209
    v_add_u32 v98, 1024, v98
    v_cmp_eq_u32 vcc, 0, v205
    s_nop 1
    v_cndmask_b32 v98, v98, v99, vcc
    v_add_u32 v98, s66, v98
    v_lshl_add_u32 v99, v208, 1, v99
    v_add_u32 v99, 8, v99
    v_add_u32 v99, s66, v99
    v_mov_b32 v209, 0xffff
    v_mov_b32 v105, 0xffff0000
    v_cndmask_b32 v209, v105, v209, vcc
    s_lshl_b32 s66, s60, 8
    v_lshlrev_b32 v100, 5, v204
    v_lshl_add_u32 v100, v206, 3, v100
    v_add_u32 v100, s66, v100
    v_mov_b32 v106, 0x80000000
    v_cndmask_b32 v100, v106, v100, vcc
    v_cmp_gt_u32 vcc, 2, v206
    s_nop 1
    v_cndmask_b32 v105, 0, v209, vcc
    v_xor_b32 v106, v105, v209
    v_lshrrev_b32 v208, 1, v206
    v_lshl_add_u32 v208, v205, 1, v208
    v_lshlrev_b32 v101, 8, v208
    v_lshl_add_u32 v101, v204, 5, v101
    v_and_b32 v208, 1, v206
    v_lshl_add_u32 v101, v208, 4, v101
    s_mul_i32 s66, s60, 6144
    s_add_u32 s66, s66, 153600
    v_add_u32 v101, s66, v101
    v_lshrrev_b32 v209, 5, v1
    v_mul_u32_u24 v103, 24576, v209
    v_and_b32 v209, 31, v1
    v_lshl_add_u32 v103, v209, 4, v103
    s_lshl_b32 s66, s60, 9
    v_add_u32 v103, s66, v103
    s_cmp_ge_u32 s59, 12
    s_cselect_b32 s66, 24576, 0
    s_lshl_b32 s75, s59, 11
    s_add_u32 s75, s75, s66
    s_mul_i32 s66, s69, 98304
    s_add_u32 s75, s75, s66
    s_mul_i32 s66, s68, 25165824
    s_add_u32 s75, s75, s66
    s_add_u32 s75, s75, 41943040
    v_and_b32 v104, 3, v1
    v_lshlrev_b32 v104, 12, v104
    v_add_u32 v104, 8392576, v104
    v_lshlrev_b32 v208, 2, v206
    v_lshl_add_u32 v208, v205, 4, v208
    s_lshl_b32 s66, s60, 3
    v_add_u32 v209, s66, v204
    v_cmp_gt_u32 s[84:85], v208, v209
    v_add_u32 v208, 1, v208
    v_cmp_gt_u32 s[86:87], v208, v209
    v_add_u32 v208, 1, v208
    v_cmp_gt_u32 s[88:89], v208, v209
    v_add_u32 v208, 1, v208
    v_cmp_gt_u32 s[90:91], v208, v209
    v_add_u32 v208, 1, v208
    v_mov_b32 v172, -1
    v_mov_b32 v176, 0x3f803f80
    v_mov_b32 v173, -1
    v_mov_b32 v177, 0x3f803f80
    v_mov_b32 v174, -1
    v_mov_b32 v178, 0x3f803f80
    v_mov_b32 v175, -1
    v_mov_b32 v179, 0x3f803f80
    s_mov_b32 s70, 0x3dd53b95
    s_mov_b32 s71, 0xd04e79ff
    s_mul_i32 s73, s60, 10240
    s_mul_i32 s74, s68, 2621440
    s_add_u32 s74, s74, 16777216
    s_mul_i32 s64, s59, 43
    s_lshr_b32 s64, s64, 7
    s_mul_i32 s64, s64, 3
    s_add_u32 s65, s64, 3
    s_add_u32 s76, s59, 1
    s_cmp_eq_u32 s76, s65
    s_cselect_b32 s76, s64, s76
    s_add_u32 s77, s76, 1
    s_cmp_eq_u32 s77, s65
    s_cselect_b32 s77, s64, s77
    s_cmp_lt_u32 s59, 20
    s_cselect_b32 s82, s60, 0
    s_lshl_b32 s72, s58, 20
Lrinit_3:
    s_lshl_b32 s64, s59, 2
    s_add_u32 s64, s64, s60
    s_mul_i32 s64, s64, 1280
    s_add_u32 s64, s64, s72
    s_add_u32 s64, s64, 30720
    buffer_store_dwordx4 v[172:175], v90, s[4:7], s64 offen
    buffer_store_dword v172, v91, s[4:7], s64 offen offset:1024
    s_lshl_b32 s65, s59, 10
    s_add_u32 s65, s65, s72
    s_add_u32 s65, s65, 153600
    buffer_store_dwordx2 v[172:173], v100, s[4:7], s65 offen
    s_cmp_lg_u32 s60, 0
    s_cbranch_scc1 Lrs_4
    s_mul_i32 s64, s59, 1280
    s_add_u32 s64, s64, s72
    buffer_store_dwordx4 v[172:175], v90, s[4:7], s64 offen
    buffer_store_dword v172, v91, s[4:7], s64 offen offset:1024
Lrs_4:
    s_cmp_lg_u32 s82, 3
    s_cbranch_scc1 Lrs_5
    s_lshl_b32 s64, s59, 9
    s_add_u32 s64, s64, s72
    s_add_u32 s64, s64, 178176
    s_lshl_b32 s65, s59, 10
    s_add_u32 s65, s65, s72
    s_add_u32 s65, s65, 188416
    buffer_store_dwordx2 v[172:173], v102, s[4:7], s64 offen
    buffer_store_dwordx4 v[172:175], v90, s[4:7], s65 offen sc1
Lrs_5:
    s_add_u32 s72, s72, 262144
    s_and_b32 s64, s72, 786432
    s_cbranch_scc1 Lrinit_3
    v_mov_b32 v2, 0
    v_mov_b32 v3, s63
    buffer_store_dword v2, v3, s[4:7], 0 offen sc1
    s_waitcnt vmcnt(0)
    s_barrier
    s_cmp_lg_u32 s60, 0
    s_cbranch_scc1 Larr_6
    s_mov_b64 exec, 1
    v_mov_b32 v2, 1
    v_mov_b32 v3, 20
    buffer_atomic_add v2, v3, s[8:11], 0 offen
    s_mov_b64 exec, -1
Larr_6:
    v_lshrrev_b32 v181, 4, v1
    v_lshlrev_b32 v181, 3, v181
    v_bfe_u32 v182, v1, 2, 2
    v_add_u32 v185, v181, v182
    v_lshlrev_b32 v181, 7, v185
    v_and_b32 v184, 3, v1
    v_lshl_add_u32 v181, v184, 3, v181
    s_lshl_b32 s64, s60, 5
    v_add_u32 v181, s64, v181
    v_add_u32 v182, 40960, v181
    ds_read_b64_tr_b16 a[0:1], v181 offset:0
    ds_read_b64_tr_b16 a[2:3], v181 offset:512
    ds_read_b64_tr_b16 a[4:5], v181 offset:4096
    ds_read_b64_tr_b16 a[6:7], v181 offset:4608
    ds_read_b64_tr_b16 a[8:9], v181 offset:8192
    ds_read_b64_tr_b16 a[10:11], v181 offset:8704
    ds_read_b64_tr_b16 a[12:13], v181 offset:12288
    ds_read_b64_tr_b16 a[14:15], v181 offset:12800
    ds_read_b64_tr_b16 a[16:17], v181 offset:16384
    ds_read_b64_tr_b16 a[18:19], v181 offset:16896
    ds_read_b64_tr_b16 a[20:21], v181 offset:20480
    ds_read_b64_tr_b16 a[22:23], v181 offset:20992
    ds_read_b64_tr_b16 a[24:25], v181 offset:24576
    ds_read_b64_tr_b16 a[26:27], v181 offset:25088
    ds_read_b64_tr_b16 a[28:29], v181 offset:28672
    ds_read_b64_tr_b16 a[30:31], v181 offset:29184
    ds_read_b64_tr_b16 a[32:33], v181 offset:32768
    ds_read_b64_tr_b16 a[34:35], v181 offset:33280
    ds_read_b64_tr_b16 a[36:37], v181 offset:36864
    ds_read_b64_tr_b16 a[38:39], v181 offset:37376
    ds_read_b64_tr_b16 a[40:41], v182 offset:0
    ds_read_b64_tr_b16 a[42:43], v182 offset:512
    ds_read_b64_tr_b16 a[44:45], v182 offset:4096
    ds_read_b64_tr_b16 a[46:47], v182 offset:4608
    ds_read_b64_tr_b16 a[48:49], v182 offset:8192
    ds_read_b64_tr_b16 a[50:51], v182 offset:8704
    ds_read_b64_tr_b16 a[52:53], v182 offset:12288
    ds_read_b64_tr_b16 a[54:55], v182 offset:12800
    ds_read_b64_tr_b16 a[56:57], v182 offset:16384
    ds_read_b64_tr_b16 a[58:59], v182 offset:16896
    ds_read_b64_tr_b16 a[60:61], v182 offset:20480
    ds_read_b64_tr_b16 a[62:63], v182 offset:20992
    ds_read_b64_tr_b16 a[64:65], v182 offset:24576
    ds_read_b64_tr_b16 a[66:67], v182 offset:25088
    ds_read_b64_tr_b16 a[68:69], v182 offset:28672
    ds_read_b64_tr_b16 a[70:71], v182 offset:29184
    ds_read_b64_tr_b16 a[72:73], v182 offset:32768
    ds_read_b64_tr_b16 a[74:75], v182 offset:33280
    ds_read_b64_tr_b16 a[76:77], v182 offset:36864
    ds_read_b64_tr_b16 a[78:79], v182 offset:37376
    s_waitcnt lgkmcnt(0)
    s_barrier
    s_mov_b32 s65, 0
    s_add_u32 m0, s78, 0
Lstg_7:
    s_nop 0
    buffer_load_dwordx4 v180, s[20:23], s65 offen lds
    s_add_u32 m0, m0, 4096
    s_add_u32 s65, s65, 393216
    s_cmp_lt_u32 s65, 7864320
    s_cbranch_scc1 Lstg_7
    v_add_u32 v181, 81920, v181
    v_add_u32 v182, 81920, v182
    ds_read_b64_tr_b16 a[80:81], v181 offset:0
    ds_read_b64_tr_b16 a[82:83], v181 offset:512
    ds_read_b64_tr_b16 a[84:85], v181 offset:4096
    ds_read_b64_tr_b16 a[86:87], v181 offset:4608
    ds_read_b64_tr_b16 a[88:89], v181 offset:8192
    ds_read_b64_tr_b16 a[90:91], v181 offset:8704
    ds_read_b64_tr_b16 a[92:93], v181 offset:12288
    ds_read_b64_tr_b16 a[94:95], v181 offset:12800
    ds_read_b64_tr_b16 a[96:97], v181 offset:16384
    ds_read_b64_tr_b16 a[98:99], v181 offset:16896
    ds_read_b64_tr_b16 a[100:101], v181 offset:20480
    ds_read_b64_tr_b16 a[102:103], v181 offset:20992
    ds_read_b64_tr_b16 a[104:105], v181 offset:24576
    ds_read_b64_tr_b16 a[106:107], v181 offset:25088
    ds_read_b64_tr_b16 a[108:109], v181 offset:28672
    ds_read_b64_tr_b16 a[110:111], v181 offset:29184
    ds_read_b64_tr_b16 a[112:113], v181 offset:32768
    ds_read_b64_tr_b16 a[114:115], v181 offset:33280
    ds_read_b64_tr_b16 a[116:117], v181 offset:36864
    ds_read_b64_tr_b16 a[118:119], v181 offset:37376
    ds_read_b64_tr_b16 a[120:121], v182 offset:0
    ds_read_b64_tr_b16 a[122:123], v182 offset:512
    ds_read_b64_tr_b16 a[124:125], v182 offset:4096
    ds_read_b64_tr_b16 a[126:127], v182 offset:4608
    ds_read_b64_tr_b16 a[128:129], v182 offset:8192
    ds_read_b64_tr_b16 a[130:131], v182 offset:8704
    ds_read_b64_tr_b16 a[132:133], v182 offset:12288
    ds_read_b64_tr_b16 a[134:135], v182 offset:12800
    ds_read_b64_tr_b16 a[136:137], v182 offset:16384
    ds_read_b64_tr_b16 a[138:139], v182 offset:16896
    ds_read_b64_tr_b16 a[140:141], v182 offset:20480
    ds_read_b64_tr_b16 a[142:143], v182 offset:20992
    ds_read_b64_tr_b16 a[144:145], v182 offset:24576
    ds_read_b64_tr_b16 a[146:147], v182 offset:25088
    ds_read_b64_tr_b16 a[148:149], v182 offset:28672
    ds_read_b64_tr_b16 a[150:151], v182 offset:29184
    ds_read_b64_tr_b16 a[152:153], v182 offset:32768
    ds_read_b64_tr_b16 a[154:155], v182 offset:33280
    ds_read_b64_tr_b16 a[156:157], v182 offset:36864
    ds_read_b64_tr_b16 a[158:159], v182 offset:37376
    s_waitcnt lgkmcnt(0)
    s_barrier
    s_cmp_ge_u32 s59, 20
    s_cbranch_scc1 Lnowo_8
    s_lshl_b32 s64, s69, 2
    s_add_u32 s64, s64, s60
    s_mul_i32 s64, s64, 491520
    s_lshl_b32 s65, s59, 6
    s_add_u32 s64, s64, s65
    v_lshrrev_b32 v183, 2, v1
    v_mul_u32_u24 v183, 1280, v183
    v_lshl_add_u32 v183, v184, 4, v183
    v_add_u32 v183, s64, v183
    s_mul_i32 s79, s60, 20480
    s_add_u32 s79, s79, 81920
    v_lshlrev_b32 v185, 6, v185
    v_lshl_add_u32 v185, v184, 4, v185
    v_add_u32 v185, s79, v185
    s_mov_b32 s65, 0
    s_mov_b32 m0, s79
Lstgo_9:
    s_nop 0
    buffer_load_dwordx4 v183, s[24:27], s65 offen lds
    s_add_u32 m0, m0, 1024
    s_add_u32 s65, s65, 20480
    s_cmp_lt_u32 s65, 409600
    s_cbranch_scc1 Lstgo_9
    s_waitcnt vmcnt(0)
    ds_read_b64_tr_b16 a[240:241], v185 offset:0
    ds_read_b64_tr_b16 a[242:243], v185 offset:256
    ds_read_b64_tr_b16 a[244:245], v185 offset:8
    ds_read_b64_tr_b16 a[246:247], v185 offset:264
    ds_read_b64_tr_b16 a[248:249], v185 offset:2048
    ds_read_b64_tr_b16 a[250:251], v185 offset:2304
    ds_read_b64_tr_b16 a[252:253], v185 offset:2056
    ds_read_b64_tr_b16 a[254:255], v185 offset:2312
    ds_read_b64_tr_b16 v[4:5], v185 offset:4096
    ds_read_b64_tr_b16 v[6:7], v185 offset:4352
    ds_read_b64_tr_b16 v[8:9], v185 offset:4104
    ds_read_b64_tr_b16 v[10:11], v185 offset:4360
    ds_read_b64_tr_b16 v[12:13], v185 offset:6144
    ds_read_b64_tr_b16 v[14:15], v185 offset:6400
    ds_read_b64_tr_b16 v[16:17], v185 offset:6152
    ds_read_b64_tr_b16 v[18:19], v185 offset:6408
    ds_read_b64_tr_b16 v[20:21], v185 offset:8192
    ds_read_b64_tr_b16 v[22:23], v185 offset:8448
    ds_read_b64_tr_b16 v[24:25], v185 offset:8200
    ds_read_b64_tr_b16 v[26:27], v185 offset:8456
    ds_read_b64_tr_b16 v[28:29], v185 offset:10240
    ds_read_b64_tr_b16 v[30:31], v185 offset:10496
    ds_read_b64_tr_b16 v[32:33], v185 offset:10248
    ds_read_b64_tr_b16 v[34:35], v185 offset:10504
    ds_read_b64_tr_b16 v[36:37], v185 offset:12288
    ds_read_b64_tr_b16 v[38:39], v185 offset:12544
    ds_read_b64_tr_b16 v[40:41], v185 offset:12296
    ds_read_b64_tr_b16 v[42:43], v185 offset:12552
    ds_read_b64_tr_b16 v[44:45], v185 offset:14336
    ds_read_b64_tr_b16 v[46:47], v185 offset:14592
    ds_read_b64_tr_b16 v[48:49], v185 offset:14344
    ds_read_b64_tr_b16 v[50:51], v185 offset:14600
    ds_read_b64_tr_b16 v[52:53], v185 offset:16384
    ds_read_b64_tr_b16 v[54:55], v185 offset:16640
    ds_read_b64_tr_b16 v[56:57], v185 offset:16392
    ds_read_b64_tr_b16 v[58:59], v185 offset:16648
    ds_read_b64_tr_b16 v[60:61], v185 offset:18432
    ds_read_b64_tr_b16 v[62:63], v185 offset:18688
    ds_read_b64_tr_b16 v[64:65], v185 offset:18440
    ds_read_b64_tr_b16 v[66:67], v185 offset:18696
    s_waitcnt lgkmcnt(0)
    s_mov_b32 s65, 409600
    s_mov_b32 m0, s79
Lstgo_10:
    s_nop 0
    buffer_load_dwordx4 v183, s[24:27], s65 offen lds
    s_add_u32 m0, m0, 1024
    s_add_u32 s65, s65, 20480
    s_cmp_lt_u32 s65, 491520
    s_cbranch_scc1 Lstgo_10
    s_waitcnt vmcnt(0)
    ds_read_b64_tr_b16 v[68:69], v185 offset:0
    ds_read_b64_tr_b16 v[70:71], v185 offset:256
    ds_read_b64_tr_b16 v[72:73], v185 offset:8
    ds_read_b64_tr_b16 v[74:75], v185 offset:264
    ds_read_b64_tr_b16 v[76:77], v185 offset:2048
    ds_read_b64_tr_b16 v[78:79], v185 offset:2304
    ds_read_b64_tr_b16 v[80:81], v185 offset:2056
    ds_read_b64_tr_b16 v[82:83], v185 offset:2312
Lnowo_8:
    s_waitcnt vmcnt(0)
    s_waitcnt lgkmcnt(0)
    s_barrier
    v_subrev_u32 v181, 81920, v181
    v_subrev_u32 v182, 81920, v182
    ds_read_b64_tr_b16 a[160:161], v181 offset:0
    ds_read_b64_tr_b16 a[162:163], v181 offset:512
    ds_read_b64_tr_b16 a[164:165], v181 offset:4096
    ds_read_b64_tr_b16 a[166:167], v181 offset:4608
    ds_read_b64_tr_b16 a[168:169], v181 offset:8192
    ds_read_b64_tr_b16 a[170:171], v181 offset:8704
    ds_read_b64_tr_b16 a[172:173], v181 offset:12288
    ds_read_b64_tr_b16 a[174:175], v181 offset:12800
    ds_read_b64_tr_b16 a[176:177], v181 offset:16384
    ds_read_b64_tr_b16 a[178:179], v181 offset:16896
    ds_read_b64_tr_b16 a[180:181], v181 offset:20480
    ds_read_b64_tr_b16 a[182:183], v181 offset:20992
    ds_read_b64_tr_b16 a[184:185], v181 offset:24576
    ds_read_b64_tr_b16 a[186:187], v181 offset:25088
    ds_read_b64_tr_b16 a[188:189], v181 offset:28672
    ds_read_b64_tr_b16 a[190:191], v181 offset:29184
    ds_read_b64_tr_b16 a[192:193], v181 offset:32768
    ds_read_b64_tr_b16 a[194:195], v181 offset:33280
    ds_read_b64_tr_b16 a[196:197], v181 offset:36864
    ds_read_b64_tr_b16 a[198:199], v181 offset:37376
    ds_read_b64_tr_b16 a[200:201], v182 offset:0
    ds_read_b64_tr_b16 a[202:203], v182 offset:512
    ds_read_b64_tr_b16 a[204:205], v182 offset:4096
    ds_read_b64_tr_b16 a[206:207], v182 offset:4608
    ds_read_b64_tr_b16 a[208:209], v182 offset:8192
    ds_read_b64_tr_b16 a[210:211], v182 offset:8704
    ds_read_b64_tr_b16 a[212:213], v182 offset:12288
    ds_read_b64_tr_b16 a[214:215], v182 offset:12800
    ds_read_b64_tr_b16 a[216:217], v182 offset:16384
    ds_read_b64_tr_b16 a[218:219], v182 offset:16896
    ds_read_b64_tr_b16 a[220:221], v182 offset:20480
    ds_read_b64_tr_b16 a[222:223], v182 offset:20992
    ds_read_b64_tr_b16 a[224:225], v182 offset:24576
    ds_read_b64_tr_b16 a[226:227], v182 offset:25088
    ds_read_b64_tr_b16 a[228:229], v182 offset:28672
    ds_read_b64_tr_b16 a[230:231], v182 offset:29184
    ds_read_b64_tr_b16 a[232:233], v182 offset:32768
    ds_read_b64_tr_b16 a[234:235], v182 offset:33280
    ds_read_b64_tr_b16 a[236:237], v182 offset:36864
    ds_read_b64_tr_b16 a[238:239], v182 offset:37376
    v_mov_b32 v3, 20
    buffer_load_dword v2, v3, s[8:11], 0 offen sc1
Lgchk_11:
    s_waitcnt vmcnt(0)
    v_cmp_gt_u32 vcc, 256, v2
    s_cbranch_vccnz Lgrty_12
    s_waitcnt lgkmcnt(0)
    s_barrier
    v_mov_b32 v180, 0
    v_mov_b32 v181, 0
    v_mov_b32 v182, 0
    v_mov_b32 v183, 0
    ds_write_b128 v88, v[180:183] offset:12288
    buffer_load_dwordx4 v[224:227], v104, s[4:7], 0 offen sc1
    s_cmp_eq_u32 s68, 0
    s_cbranch_scc1 Lnofl_13
    s_add_u32 s64, s62, 1
    s_min_u32 s64, s64, 64
Lfchk_14:
    s_waitcnt vmcnt(0)
    v_min3_u32 v223, v224, v225, v226
    v_min_u32 v223, v223, v227
    v_cmp_gt_u32 vcc, s64, v223
    s_cbranch_vccnz Lfrty_15
Lnofl_13:
    s_add_u32 m0, s73, 20480
    s_nop 0
    buffer_load_dwordx4 v84, s[4:7], s74 offen offset:0 sc1 lds
    s_add_u32 m0, s73, 21376
    s_nop 0
    buffer_load_dwordx4 v84, s[4:7], s74 offen offset:128 sc1 lds
    s_add_u32 m0, s73, 22272
    s_nop 0
    buffer_load_dwordx4 v84, s[4:7], s74 offen offset:256 sc1 lds
    s_add_u32 m0, s73, 23168
    s_nop 0
    buffer_load_dwordx4 v84, s[4:7], s74 offen offset:384 sc1 lds
    s_add_u32 m0, s73, 24064
    s_nop 0
    buffer_load_dwordx4 v84, s[4:7], s74 offen offset:512 sc1 lds
    s_add_u32 m0, s73, 24960
    s_nop 0
    buffer_load_dwordx4 v84, s[4:7], s74 offen offset:640 sc1 lds
    s_add_u32 m0, s73, 25856
    s_nop 0
    buffer_load_dwordx4 v84, s[4:7], s74 offen offset:768 sc1 lds
    s_add_u32 m0, s73, 26752
    s_nop 0
    buffer_load_dwordx4 v84, s[4:7], s74 offen offset:896 sc1 lds
    s_add_u32 m0, s73, 27648
    s_nop 0
    buffer_load_dwordx4 v84, s[4:7], s74 offen offset:1024 sc1 lds
    s_add_u32 m0, s73, 28544
    s_nop 0
    buffer_load_dwordx4 v84, s[4:7], s74 offen offset:1152 sc1 lds
    v_and_b32 v185, 7, v0
    v_mul_u32_u24 v185, 1280, v185
    v_lshrrev_b32 v186, 3, v0
    v_lshl_add_u32 v185, v186, 4, v185
    buffer_load_dwordx4 v[188:191], v185, s[28:31], 0 offen offset:0
    buffer_load_dwordx4 v[192:195], v185, s[28:31], 0 offen offset:512
    buffer_load_dwordx4 v[196:199], v185, s[28:31], 0 offen offset:1024
    s_waitcnt vmcnt(2)
    ds_write_b128 v88, v[188:191] offset:0
    s_waitcnt vmcnt(1)
    ds_write_b128 v88, v[192:195] offset:4096
    s_waitcnt vmcnt(0)
    ds_write_b128 v88, v[196:199] offset:8192
    s_add_u32 s74, s74, 40960
    buffer_load_dwordx4 v[224:227], v104, s[4:7], 0 offen sc1
    s_waitcnt lgkmcnt(0)
    s_barrier
    ds_read_b128 v[108:111], v85 offset:20480
    ds_read_b128 v[112:115], v85 offset:40960
    ds_read_b128 v[116:119], v86 offset:20480
    ds_read_b128 v[120:123], v86 offset:40960
    s_waitcnt lgkmcnt(3)
    v_mfma_f32_16x16x32_bf16 v[132:135], a[0:3], v[108:111], 0
    ds_read_b128 v[124:127], v85 offset:21504
    v_mfma_f32_16x16x32_bf16 v[140:143], a[80:83], v[108:111], 0
    ds_read_b128 v[128:131], v85 offset:41984
    v_mfma_f32_16x16x32_bf16 v[148:151], v[108:111], a[160:163], 0
    s_waitcnt lgkmcnt(4)
    v_mfma_f32_16x16x32_bf16 v[136:139], a[0:3], v[112:115], 0
    v_mfma_f32_16x16x32_bf16 v[144:147], a[80:83], v[112:115], 0
    v_mfma_f32_16x16x32_bf16 v[152:155], v[112:115], a[160:163], 0
    s_waitcnt lgkmcnt(3)
    v_mfma_f32_16x16x32_bf16 v[132:135], a[4:7], v[116:119], v[132:135]
    ds_read_b128 v[108:111], v86 offset:21504
    v_mfma_f32_16x16x32_bf16 v[140:143], a[84:87], v[116:119], v[140:143]
    ds_read_b128 v[112:115], v86 offset:41984
    v_mfma_f32_16x16x32_bf16 v[148:151], v[116:119], a[164:167], v[148:151]
    s_waitcnt lgkmcnt(4)
    v_mfma_f32_16x16x32_bf16 v[136:139], a[4:7], v[120:123], v[136:139]
    v_mfma_f32_16x16x32_bf16 v[144:147], a[84:87], v[120:123], v[144:147]
    v_mfma_f32_16x16x32_bf16 v[152:155], v[120:123], a[164:167], v[152:155]
    s_waitcnt lgkmcnt(3)
    v_mfma_f32_16x16x32_bf16 v[132:135], a[8:11], v[124:127], v[132:135]
    ds_read_b128 v[116:119], v85 offset:22528
    v_mfma_f32_16x16x32_bf16 v[140:143], a[88:91], v[124:127], v[140:143]
    ds_read_b128 v[120:123], v85 offset:43008
    v_mfma_f32_16x16x32_bf16 v[148:151], v[124:127], a[168:171], v[148:151]
    s_waitcnt lgkmcnt(4)
    v_mfma_f32_16x16x32_bf16 v[136:139], a[8:11], v[128:131], v[136:139]
    v_mfma_f32_16x16x32_bf16 v[144:147], a[88:91], v[128:131], v[144:147]
    v_mfma_f32_16x16x32_bf16 v[152:155], v[128:131], a[168:171], v[152:155]
    s_waitcnt lgkmcnt(3)
    v_mfma_f32_16x16x32_bf16 v[132:135], a[12:15], v[108:111], v[132:135]
    ds_read_b128 v[124:127], v86 offset:22528
    v_mfma_f32_16x16x32_bf16 v[140:143], a[92:95], v[108:111], v[140:143]
    ds_read_b128 v[128:131], v86 offset:43008
    v_mfma_f32_16x16x32_bf16 v[148:151], v[108:111], a[172:175], v[148:151]
    s_waitcnt lgkmcnt(4)
    v_mfma_f32_16x16x32_bf16 v[136:139], a[12:15], v[112:115], v[136:139]
    v_mfma_f32_16x16x32_bf16 v[144:147], a[92:95], v[112:115], v[144:147]
    v_mfma_f32_16x16x32_bf16 v[152:155], v[112:115], a[172:175], v[152:155]
    s_waitcnt lgkmcnt(3)
    v_mfma_f32_16x16x32_bf16 v[132:135], a[16:19], v[116:119], v[132:135]
    ds_read_b128 v[108:111], v85 offset:23552
    v_mfma_f32_16x16x32_bf16 v[140:143], a[96:99], v[116:119], v[140:143]
    ds_read_b128 v[112:115], v85 offset:44032
    v_mfma_f32_16x16x32_bf16 v[148:151], v[116:119], a[176:179], v[148:151]
    s_waitcnt lgkmcnt(4)
    v_mfma_f32_16x16x32_bf16 v[136:139], a[16:19], v[120:123], v[136:139]
    v_mfma_f32_16x16x32_bf16 v[144:147], a[96:99], v[120:123], v[144:147]
    v_mfma_f32_16x16x32_bf16 v[152:155], v[120:123], a[176:179], v[152:155]
    s_waitcnt lgkmcnt(3)
    v_mfma_f32_16x16x32_bf16 v[132:135], a[20:23], v[124:127], v[132:135]
    ds_read_b128 v[116:119], v86 offset:23552
    v_mfma_f32_16x16x32_bf16 v[140:143], a[100:103], v[124:127], v[140:143]
    ds_read_b128 v[120:123], v86 offset:44032
    v_mfma_f32_16x16x32_bf16 v[148:151], v[124:127], a[180:183], v[148:151]
    s_waitcnt lgkmcnt(4)
    v_mfma_f32_16x16x32_bf16 v[136:139], a[20:23], v[128:131], v[136:139]
    v_mfma_f32_16x16x32_bf16 v[144:147], a[100:103], v[128:131], v[144:147]
    v_mfma_f32_16x16x32_bf16 v[152:155], v[128:131], a[180:183], v[152:155]
    s_waitcnt lgkmcnt(3)
    v_mfma_f32_16x16x32_bf16 v[132:135], a[24:27], v[108:111], v[132:135]
    ds_read_b128 v[124:127], v85 offset:24576
    v_mfma_f32_16x16x32_bf16 v[140:143], a[104:107], v[108:111], v[140:143]
    ds_read_b128 v[128:131], v85 offset:45056
    v_mfma_f32_16x16x32_bf16 v[148:151], v[108:111], a[184:187], v[148:151]
    s_waitcnt lgkmcnt(4)
    v_mfma_f32_16x16x32_bf16 v[136:139], a[24:27], v[112:115], v[136:139]
    v_mfma_f32_16x16x32_bf16 v[144:147], a[104:107], v[112:115], v[144:147]
    v_mfma_f32_16x16x32_bf16 v[152:155], v[112:115], a[184:187], v[152:155]
    s_waitcnt lgkmcnt(3)
    v_mfma_f32_16x16x32_bf16 v[132:135], a[28:31], v[116:119], v[132:135]
    ds_read_b128 v[108:111], v86 offset:24576
    v_mfma_f32_16x16x32_bf16 v[140:143], a[108:111], v[116:119], v[140:143]
    ds_read_b128 v[112:115], v86 offset:45056
    v_mfma_f32_16x16x32_bf16 v[148:151], v[116:119], a[188:191], v[148:151]
    s_waitcnt lgkmcnt(4)
    v_mfma_f32_16x16x32_bf16 v[136:139], a[28:31], v[120:123], v[136:139]
    v_mfma_f32_16x16x32_bf16 v[144:147], a[108:111], v[120:123], v[144:147]
    v_mfma_f32_16x16x32_bf16 v[152:155], v[120:123], a[188:191], v[152:155]
    s_waitcnt lgkmcnt(3)
    v_mfma_f32_16x16x32_bf16 v[132:135], a[32:35], v[124:127], v[132:135]
    ds_read_b128 v[116:119], v85 offset:25600
    v_mfma_f32_16x16x32_bf16 v[140:143], a[112:115], v[124:127], v[140:143]
    ds_read_b128 v[120:123], v85 offset:46080
    v_mfma_f32_16x16x32_bf16 v[148:151], v[124:127], a[192:195], v[148:151]
    s_waitcnt lgkmcnt(4)
    v_mfma_f32_16x16x32_bf16 v[136:139], a[32:35], v[128:131], v[136:139]
    v_mfma_f32_16x16x32_bf16 v[144:147], a[112:115], v[128:131], v[144:147]
    v_mfma_f32_16x16x32_bf16 v[152:155], v[128:131], a[192:195], v[152:155]
    s_waitcnt lgkmcnt(3)
    v_mfma_f32_16x16x32_bf16 v[132:135], a[36:39], v[108:111], v[132:135]
    ds_read_b128 v[124:127], v86 offset:25600
    v_mfma_f32_16x16x32_bf16 v[140:143], a[116:119], v[108:111], v[140:143]
    ds_read_b128 v[128:131], v86 offset:46080
    v_mfma_f32_16x16x32_bf16 v[148:151], v[108:111], a[196:199], v[148:151]
    s_waitcnt lgkmcnt(4)
    v_mfma_f32_16x16x32_bf16 v[136:139], a[36:39], v[112:115], v[136:139]
    v_mfma_f32_16x16x32_bf16 v[144:147], a[116:119], v[112:115], v[144:147]
    v_mfma_f32_16x16x32_bf16 v[152:155], v[112:115], a[196:199], v[152:155]
    s_waitcnt lgkmcnt(3)
    v_mfma_f32_16x16x32_bf16 v[132:135], a[40:43], v[116:119], v[132:135]
    ds_read_b128 v[108:111], v85 offset:26624
    v_mfma_f32_16x16x32_bf16 v[140:143], a[120:123], v[116:119], v[140:143]
    ds_read_b128 v[112:115], v85 offset:47104
    v_mfma_f32_16x16x32_bf16 v[148:151], v[116:119], a[200:203], v[148:151]
    s_waitcnt lgkmcnt(4)
    v_mfma_f32_16x16x32_bf16 v[136:139], a[40:43], v[120:123], v[136:139]
    v_mfma_f32_16x16x32_bf16 v[144:147], a[120:123], v[120:123], v[144:147]
    v_mfma_f32_16x16x32_bf16 v[152:155], v[120:123], a[200:203], v[152:155]
    s_waitcnt lgkmcnt(3)
    v_mfma_f32_16x16x32_bf16 v[132:135], a[44:47], v[124:127], v[132:135]
    ds_read_b128 v[116:119], v86 offset:26624
    v_mfma_f32_16x16x32_bf16 v[140:143], a[124:127], v[124:127], v[140:143]
    ds_read_b128 v[120:123], v86 offset:47104
    v_mfma_f32_16x16x32_bf16 v[148:151], v[124:127], a[204:207], v[148:151]
    s_waitcnt lgkmcnt(4)
    v_mfma_f32_16x16x32_bf16 v[136:139], a[44:47], v[128:131], v[136:139]
    v_mfma_f32_16x16x32_bf16 v[144:147], a[124:127], v[128:131], v[144:147]
    v_mfma_f32_16x16x32_bf16 v[152:155], v[128:131], a[204:207], v[152:155]
    s_waitcnt lgkmcnt(3)
    v_mfma_f32_16x16x32_bf16 v[132:135], a[48:51], v[108:111], v[132:135]
    ds_read_b128 v[124:127], v85 offset:27648
    v_mfma_f32_16x16x32_bf16 v[140:143], a[128:131], v[108:111], v[140:143]
    ds_read_b128 v[128:131], v85 offset:48128
    v_mfma_f32_16x16x32_bf16 v[148:151], v[108:111], a[208:211], v[148:151]
    s_waitcnt lgkmcnt(4)
    v_mfma_f32_16x16x32_bf16 v[136:139], a[48:51], v[112:115], v[136:139]
    v_mfma_f32_16x16x32_bf16 v[144:147], a[128:131], v[112:115], v[144:147]
    v_mfma_f32_16x16x32_bf16 v[152:155], v[112:115], a[208:211], v[152:155]
    s_waitcnt lgkmcnt(3)
    v_mfma_f32_16x16x32_bf16 v[132:135], a[52:55], v[116:119], v[132:135]
    ds_read_b128 v[108:111], v86 offset:27648
    v_mfma_f32_16x16x32_bf16 v[140:143], a[132:135], v[116:119], v[140:143]
    ds_read_b128 v[112:115], v86 offset:48128
    v_mfma_f32_16x16x32_bf16 v[148:151], v[116:119], a[212:215], v[148:151]
    s_waitcnt lgkmcnt(4)
    v_mfma_f32_16x16x32_bf16 v[136:139], a[52:55], v[120:123], v[136:139]
    v_mfma_f32_16x16x32_bf16 v[144:147], a[132:135], v[120:123], v[144:147]
    v_mfma_f32_16x16x32_bf16 v[152:155], v[120:123], a[212:215], v[152:155]
    s_waitcnt lgkmcnt(3)
    v_mfma_f32_16x16x32_bf16 v[132:135], a[56:59], v[124:127], v[132:135]
    ds_read_b128 v[116:119], v85 offset:28672
    v_mfma_f32_16x16x32_bf16 v[140:143], a[136:139], v[124:127], v[140:143]
    ds_read_b128 v[120:123], v85 offset:49152
    v_mfma_f32_16x16x32_bf16 v[148:151], v[124:127], a[216:219], v[148:151]
    s_waitcnt lgkmcnt(4)
    v_mfma_f32_16x16x32_bf16 v[136:139], a[56:59], v[128:131], v[136:139]
    v_mfma_f32_16x16x32_bf16 v[144:147], a[136:139], v[128:131], v[144:147]
    v_mfma_f32_16x16x32_bf16 v[152:155], v[128:131], a[216:219], v[152:155]
    s_waitcnt lgkmcnt(3)
    v_mfma_f32_16x16x32_bf16 v[132:135], a[60:63], v[108:111], v[132:135]
    ds_read_b128 v[124:127], v86 offset:28672
    v_mfma_f32_16x16x32_bf16 v[140:143], a[140:143], v[108:111], v[140:143]
    ds_read_b128 v[128:131], v86 offset:49152
    v_mfma_f32_16x16x32_bf16 v[148:151], v[108:111], a[220:223], v[148:151]
    s_waitcnt lgkmcnt(4)
    v_mfma_f32_16x16x32_bf16 v[136:139], a[60:63], v[112:115], v[136:139]
    v_mfma_f32_16x16x32_bf16 v[144:147], a[140:143], v[112:115], v[144:147]
    v_mfma_f32_16x16x32_bf16 v[152:155], v[112:115], a[220:223], v[152:155]
    s_waitcnt lgkmcnt(3)
    v_mfma_f32_16x16x32_bf16 v[132:135], a[64:67], v[116:119], v[132:135]
    ds_read_b128 v[108:111], v85 offset:29696
    v_mfma_f32_16x16x32_bf16 v[140:143], a[144:147], v[116:119], v[140:143]
    ds_read_b128 v[112:115], v85 offset:50176
    v_mfma_f32_16x16x32_bf16 v[148:151], v[116:119], a[224:227], v[148:151]
    s_waitcnt lgkmcnt(4)
    v_mfma_f32_16x16x32_bf16 v[136:139], a[64:67], v[120:123], v[136:139]
    v_mfma_f32_16x16x32_bf16 v[144:147], a[144:147], v[120:123], v[144:147]
    v_mfma_f32_16x16x32_bf16 v[152:155], v[120:123], a[224:227], v[152:155]
    s_waitcnt lgkmcnt(3)
    v_mfma_f32_16x16x32_bf16 v[132:135], a[68:71], v[124:127], v[132:135]
    ds_read_b128 v[116:119], v86 offset:29696
    v_mfma_f32_16x16x32_bf16 v[140:143], a[148:151], v[124:127], v[140:143]
    ds_read_b128 v[120:123], v86 offset:50176
    v_mfma_f32_16x16x32_bf16 v[148:151], v[124:127], a[228:231], v[148:151]
    s_waitcnt lgkmcnt(4)
    v_mfma_f32_16x16x32_bf16 v[136:139], a[68:71], v[128:131], v[136:139]
    v_mfma_f32_16x16x32_bf16 v[144:147], a[148:151], v[128:131], v[144:147]
    v_mfma_f32_16x16x32_bf16 v[152:155], v[128:131], a[228:231], v[152:155]
    s_waitcnt lgkmcnt(3)
    v_mfma_f32_16x16x32_bf16 v[132:135], a[72:75], v[108:111], v[132:135]
    v_mfma_f32_16x16x32_bf16 v[140:143], a[152:155], v[108:111], v[140:143]
    v_mfma_f32_16x16x32_bf16 v[148:151], v[108:111], a[232:235], v[148:151]
    s_waitcnt lgkmcnt(2)
    v_mfma_f32_16x16x32_bf16 v[136:139], a[72:75], v[112:115], v[136:139]
    v_mfma_f32_16x16x32_bf16 v[144:147], a[152:155], v[112:115], v[144:147]
    v_mfma_f32_16x16x32_bf16 v[152:155], v[112:115], a[232:235], v[152:155]
    s_waitcnt lgkmcnt(1)
    v_mfma_f32_16x16x32_bf16 v[132:135], a[76:79], v[116:119], v[132:135]
    v_mfma_f32_16x16x32_bf16 v[140:143], a[156:159], v[116:119], v[140:143]
    v_mfma_f32_16x16x32_bf16 v[148:151], v[116:119], a[236:239], v[148:151]
    s_waitcnt lgkmcnt(0)
    v_mfma_f32_16x16x32_bf16 v[136:139], a[76:79], v[120:123], v[136:139]
    v_mfma_f32_16x16x32_bf16 v[144:147], a[156:159], v[120:123], v[144:147]
    v_mfma_f32_16x16x32_bf16 v[152:155], v[120:123], a[236:239], v[152:155]
    s_nop 1
    v_cvt_pk_bf16_f32 v156, v132, v133
    v_cvt_pk_bf16_f32 v157, v134, v135
    v_cvt_pk_bf16_f32 v160, v140, v141
    v_cvt_pk_bf16_f32 v161, v142, v143
    v_cvt_pk_bf16_f32 v164, v148, v149
    v_cvt_pk_bf16_f32 v165, v150, v151
    v_cvt_pk_bf16_f32 v158, v136, v137
    v_cvt_pk_bf16_f32 v159, v138, v139
    v_cvt_pk_bf16_f32 v162, v144, v145
    v_cvt_pk_bf16_f32 v163, v146, v147
    v_cvt_pk_bf16_f32 v168, v152, v153
    v_cvt_pk_bf16_f32 v169, v154, v155
    v_mfma_f32_16x16x16_bf16 v[132:135], v[160:161], v[156:157], 0
    v_mfma_f32_16x16x16_bf16 v[136:139], v[160:161], v[158:159], 0
    v_mfma_f32_16x16x16_bf16 v[140:143], v[162:163], v[158:159], 0
    s_nop 5
    ds_write_b128 v93, v[132:135] offset:5120
    ds_write_b128 v93, v[136:139] offset:6144
    ds_write_b128 v93, v[140:143] offset:7168
    s_lshl_b32 s72, s58, 20
L_Cstep:
    s_waitcnt lgkmcnt(0)
    s_barrier
    ds_read_b128 v[108:111], v87 offset:0
    ds_read_b128 v[112:115], v87 offset:512
    ds_read_b128 v[116:119], v87 offset:1024
    ds_read_b128 v[120:123], v87 offset:1536
    ds_read_b128 v[124:127], v87 offset:2048
    s_cmp_eq_u32 s68, 0
    s_cbranch_scc1 Lnofl_16
    s_add_u32 s64, s62, 2
    s_min_u32 s64, s64, 64
Lfchk_17:
    s_waitcnt vmcnt(0)
    v_min3_u32 v223, v224, v225, v226
    v_min_u32 v223, v223, v227
    v_cmp_gt_u32 vcc, s64, v223
    s_cbranch_vccnz Lfrty_18
Lnofl_16:
    s_waitcnt lgkmcnt(4)
    v_mfma_f32_16x16x32_bf16 v[192:195], a[0:3], v[108:111], 0
    ds_read_b128 v[128:131], v87 offset:2560
    v_mfma_f32_16x16x32_bf16 v[196:199], a[80:83], v[108:111], 0
    s_add_u32 m0, s73, 20480
    s_nop 0
    buffer_load_dwordx4 v84, s[4:7], s74 offen offset:0 sc1 lds
    s_waitcnt lgkmcnt(4)
    v_mfma_f32_16x16x32_bf16 v[192:195], a[4:7], v[112:115], v[192:195]
    ds_read_b128 v[108:111], v87 offset:3072
    v_mfma_f32_16x16x32_bf16 v[196:199], a[84:87], v[112:115], v[196:199]
    s_mul_i32 s78, s59, 1280
    s_add_u32 s78, s78, s72
    s_waitcnt lgkmcnt(4)
    v_mfma_f32_16x16x32_bf16 v[192:195], a[8:11], v[116:119], v[192:195]
    ds_read_b128 v[112:115], v87 offset:3584
    v_mfma_f32_16x16x32_bf16 v[196:199], a[88:91], v[116:119], v[196:199]
    s_add_u32 m0, s73, 21376
    s_nop 0
    buffer_load_dwordx4 v84, s[4:7], s74 offen offset:128 sc1 lds
    s_waitcnt lgkmcnt(4)
    v_mfma_f32_16x16x32_bf16 v[192:195], a[12:15], v[120:123], v[192:195]
    ds_read_b128 v[116:119], v87 offset:4096
    v_mfma_f32_16x16x32_bf16 v[196:199], a[92:95], v[120:123], v[196:199]
    s_mul_i32 s79, s76, 1280
    s_add_u32 s79, s79, s72
    s_waitcnt lgkmcnt(4)
    v_mfma_f32_16x16x32_bf16 v[192:195], a[16:19], v[124:127], v[192:195]
    ds_read_b128 v[120:123], v87 offset:4608
    v_mfma_f32_16x16x32_bf16 v[196:199], a[96:99], v[124:127], v[196:199]
    s_add_u32 m0, s73, 22272
    s_nop 0
    buffer_load_dwordx4 v84, s[4:7], s74 offen offset:256 sc1 lds
    s_waitcnt lgkmcnt(4)
    v_mfma_f32_16x16x32_bf16 v[192:195], a[20:23], v[128:131], v[192:195]
    ds_read_b128 v[124:127], v87 offset:5120
    v_mfma_f32_16x16x32_bf16 v[196:199], a[100:103], v[128:131], v[196:199]
    s_mul_i32 s80, s77, 1280
    s_add_u32 s80, s80, s72
    s_waitcnt lgkmcnt(4)
    v_mfma_f32_16x16x32_bf16 v[192:195], a[24:27], v[108:111], v[192:195]
    ds_read_b128 v[128:131], v87 offset:5632
    v_mfma_f32_16x16x32_bf16 v[196:199], a[104:107], v[108:111], v[196:199]
    s_add_u32 m0, s73, 23168
    s_nop 0
    buffer_load_dwordx4 v84, s[4:7], s74 offen offset:384 sc1 lds
    s_waitcnt lgkmcnt(4)
    v_mfma_f32_16x16x32_bf16 v[192:195], a[28:31], v[112:115], v[192:195]
    ds_read_b128 v[108:111], v87 offset:6144
    v_mfma_f32_16x16x32_bf16 v[196:199], a[108:111], v[112:115], v[196:199]
    s_lshl_b32 s81, s59, 2
    s_add_u32 s81, s81, s60
    s_waitcnt lgkmcnt(4)
    v_mfma_f32_16x16x32_bf16 v[192:195], a[32:35], v[116:119], v[192:195]
    ds_read_b128 v[112:115], v87 offset:6656
    v_mfma_f32_16x16x32_bf16 v[196:199], a[112:115], v[116:119], v[196:199]
    s_add_u32 m0, s73, 24064
    s_nop 0
    buffer_load_dwordx4 v84, s[4:7], s74 offen offset:512 sc1 lds
    s_waitcnt lgkmcnt(4)
    v_mfma_f32_16x16x32_bf16 v[192:195], a[36:39], v[120:123], v[192:195]
    ds_read_b128 v[116:119], v87 offset:7168
    v_mfma_f32_16x16x32_bf16 v[196:199], a[116:119], v[120:123], v[196:199]
    s_mul_i32 s81, s81, 1280
    s_add_u32 s81, s81, s72
    s_waitcnt lgkmcnt(4)
    v_mfma_f32_16x16x32_bf16 v[192:195], a[40:43], v[124:127], v[192:195]
    ds_read_b128 v[120:123], v87 offset:7680
    v_mfma_f32_16x16x32_bf16 v[196:199], a[120:123], v[124:127], v[196:199]
    s_add_u32 m0, s73, 24960
    s_nop 0
    buffer_load_dwordx4 v84, s[4:7], s74 offen offset:640 sc1 lds
    s_waitcnt lgkmcnt(4)
    v_mfma_f32_16x16x32_bf16 v[192:195], a[44:47], v[128:131], v[192:195]
    ds_read_b128 v[124:127], v87 offset:8192
    v_mfma_f32_16x16x32_bf16 v[196:199], a[124:127], v[128:131], v[196:199]
    s_add_u32 s81, s81, 30720
    s_waitcnt lgkmcnt(4)
    v_mfma_f32_16x16x32_bf16 v[192:195], a[48:51], v[108:111], v[192:195]
    ds_read_b128 v[128:131], v87 offset:8704
    v_mfma_f32_16x16x32_bf16 v[196:199], a[128:131], v[108:111], v[196:199]
    s_add_u32 m0, s73, 25856
    s_nop 0
    buffer_load_dwordx4 v84, s[4:7], s74 offen offset:768 sc1 lds
    s_waitcnt lgkmcnt(4)
    v_mfma_f32_16x16x32_bf16 v[192:195], a[52:55], v[112:115], v[192:195]
    ds_read_b128 v[108:111], v87 offset:9216
    v_mfma_f32_16x16x32_bf16 v[196:199], a[132:135], v[112:115], v[196:199]
    s_waitcnt lgkmcnt(4)
    v_mfma_f32_16x16x32_bf16 v[192:195], a[56:59], v[116:119], v[192:195]
    ds_read_b128 v[112:115], v87 offset:9728
    v_mfma_f32_16x16x32_bf16 v[196:199], a[136:139], v[116:119], v[196:199]
    s_add_u32 m0, s73, 26752
    s_nop 0
    buffer_load_dwordx4 v84, s[4:7], s74 offen offset:896 sc1 lds
    s_waitcnt lgkmcnt(4)
    v_mfma_f32_16x16x32_bf16 v[192:195], a[60:63], v[120:123], v[192:195]
    v_mfma_f32_16x16x32_bf16 v[196:199], a[140:143], v[120:123], v[196:199]
    s_waitcnt lgkmcnt(3)
    v_mfma_f32_16x16x32_bf16 v[192:195], a[64:67], v[124:127], v[192:195]
    v_mfma_f32_16x16x32_bf16 v[196:199], a[144:147], v[124:127], v[196:199]
    s_add_u32 m0, s73, 27648
    s_nop 0
    buffer_load_dwordx4 v84, s[4:7], s74 offen offset:1024 sc1 lds
    s_waitcnt lgkmcnt(2)
    v_mfma_f32_16x16x32_bf16 v[192:195], a[68:71], v[128:131], v[192:195]
    v_mfma_f32_16x16x32_bf16 v[196:199], a[148:151], v[128:131], v[196:199]
    s_waitcnt lgkmcnt(1)
    v_mfma_f32_16x16x32_bf16 v[192:195], a[72:75], v[108:111], v[192:195]
    v_mfma_f32_16x16x32_bf16 v[196:199], a[152:155], v[108:111], v[196:199]
    s_add_u32 m0, s73, 28544
    s_nop 0
    buffer_load_dwordx4 v84, s[4:7], s74 offen offset:1152 sc1 lds
    s_waitcnt lgkmcnt(0)
    v_mfma_f32_16x16x32_bf16 v[192:195], a[76:79], v[112:115], v[192:195]
    v_mfma_f32_16x16x32_bf16 v[196:199], a[156:159], v[112:115], v[196:199]
    s_add_u32 s74, s74, 40960
    s_nop 5
    v_cvt_pk_bf16_f32 v200, v192, v193
    v_cvt_pk_bf16_f32 v201, v194, v195
    v_cvt_pk_bf16_f32 v202, v196, v197
    v_cvt_pk_bf16_f32 v203, v198, v199
    v_mfma_f32_16x16x16_bf16 v[208:211], v[160:161], v[200:201], 0
    v_mfma_f32_16x16x16_bf16 v[212:215], v[162:163], v[200:201], 0
    v_mfma_f32_16x16x16_bf16 v[204:207], v[202:203], v[200:201], 0
    v_mfma_f32_16x16x16_bf16 v[216:219], v[202:203], v[156:157], 0
    v_mfma_f32_16x16x16_bf16 v[220:223], v[202:203], v[158:159], 0
    s_nop 3
    ds_write_b128 v93, v[208:211] offset:1024
    ds_write_b128 v93, v[212:215] offset:2048
    ds_write_b128 v93, v[204:207] offset:0
    ds_write_b128 v93, v[216:219] offset:3072
    ds_write_b128 v93, v[220:223] offset:4096
    s_waitcnt lgkmcnt(0)
    s_barrier
    ds_read_b128 v[180:183], v94 offset:0
    ds_read_b32 v196, v95 offset:0
    ds_read_b128 v[184:187], v94 offset:8192
    ds_read_b32 v197, v95 offset:8192
    ds_read_b128 v[188:191], v94 offset:16384
    ds_read_b32 v198, v95 offset:16384
    ds_read_b128 v[192:195], v94 offset:24576
    ds_read_b32 v199, v95 offset:24576
    ds_read_b128 v[108:111], v87 offset:0
    ds_read_b128 v[112:115], v87 offset:512
    ds_read_b128 v[116:119], v87 offset:1024
    ds_read_b128 v[120:123], v87 offset:1536
    ds_read_b128 v[124:127], v87 offset:2048
    s_waitcnt lgkmcnt(10)
    v_add_f32 v180, v180, v184
    v_add_f32 v181, v181, v185
    v_add_f32 v182, v182, v186
    v_add_f32 v183, v183, v187
    s_waitcnt lgkmcnt(9)
    v_add_f32 v196, v196, v197
    s_waitcnt lgkmcnt(6)
    v_add_f32 v188, v188, v192
    v_add_f32 v228, v180, v188
    v_add_f32 v189, v189, v193
    v_add_f32 v229, v181, v189
    v_add_f32 v190, v190, v194
    v_add_f32 v230, v182, v190
    v_add_f32 v191, v191, v195
    v_add_f32 v231, v183, v191
    s_waitcnt lgkmcnt(5)
    v_add_f32 v198, v198, v199
    v_add_f32 v232, v196, v198
    s_cmp_lg_u32 s60, 0
    s_cbranch_scc1 Lpubm_19
    buffer_store_dwordx4 v[228:231], v90, s[4:7], s78 offen
    buffer_store_dword v232, v91, s[4:7], s78 offen offset:1024
Lpubm_19:
    ds_read_b128 v[204:207], v96 offset:0
    ds_read_b32 v220, v97 offset:0
    ds_read_b128 v[208:211], v96 offset:8192
    ds_read_b32 v221, v97 offset:8192
    ds_read_b128 v[212:215], v96 offset:16384
    ds_read_b32 v222, v97 offset:16384
    ds_read_b128 v[216:219], v96 offset:24576
    ds_read_b32 v223, v97 offset:24576
    s_waitcnt vmcnt(10) lgkmcnt(12)
    v_mfma_f32_16x16x32_bf16 v[224:227], v[108:111], a[160:163], 0
    ds_read_b128 v[128:131], v87 offset:2560
    s_waitcnt lgkmcnt(12)
    v_mfma_f32_16x16x32_bf16 v[224:227], v[112:115], a[164:167], v[224:227]
    ds_read_b128 v[108:111], v87 offset:3072
    s_waitcnt lgkmcnt(12)
    v_mfma_f32_16x16x32_bf16 v[224:227], v[116:119], a[168:171], v[224:227]
    ds_read_b128 v[112:115], v87 offset:3584
    s_waitcnt lgkmcnt(12)
    v_mfma_f32_16x16x32_bf16 v[224:227], v[120:123], a[172:175], v[224:227]
    ds_read_b128 v[116:119], v87 offset:4096
    s_waitcnt lgkmcnt(12)
    v_mfma_f32_16x16x32_bf16 v[224:227], v[124:127], a[176:179], v[224:227]
    s_waitcnt lgkmcnt(9)
    v_add_f32 v204, v204, v208
    ds_read_b128 v[120:123], v87 offset:4608
    v_add_f32 v205, v205, v209
    s_waitcnt lgkmcnt(4)
    v_mfma_f32_16x16x32_bf16 v[224:227], v[128:131], a[180:183], v[224:227]
    v_add_f32 v206, v206, v210
    ds_read_b128 v[124:127], v87 offset:5120
    v_add_f32 v207, v207, v211
    s_waitcnt lgkmcnt(4)
    v_mfma_f32_16x16x32_bf16 v[224:227], v[108:111], a[184:187], v[224:227]
    v_add_f32 v220, v220, v221
    ds_read_b128 v[128:131], v87 offset:5632
    v_add_f32 v212, v212, v216
    s_waitcnt lgkmcnt(4)
    v_mfma_f32_16x16x32_bf16 v[224:227], v[112:115], a[188:191], v[224:227]
    v_add_f32 v234, v204, v212
    ds_read_b128 v[108:111], v87 offset:6144
    v_add_f32 v213, v213, v217
    s_waitcnt lgkmcnt(4)
    v_mfma_f32_16x16x32_bf16 v[224:227], v[116:119], a[192:195], v[224:227]
    v_add_f32 v235, v205, v213
    ds_read_b128 v[112:115], v87 offset:6656
    v_add_f32 v214, v214, v218
    s_waitcnt lgkmcnt(4)
    v_mfma_f32_16x16x32_bf16 v[224:227], v[120:123], a[196:199], v[224:227]
    v_add_f32 v236, v206, v214
    ds_read_b128 v[116:119], v87 offset:7168
    v_add_f32 v215, v215, v219
    s_waitcnt lgkmcnt(4)
    v_mfma_f32_16x16x32_bf16 v[224:227], v[124:127], a[200:203], v[224:227]
    v_add_f32 v237, v207, v215
    ds_read_b128 v[120:123], v87 offset:7680
    v_add_f32 v222, v222, v223
    s_waitcnt lgkmcnt(4)
    v_mfma_f32_16x16x32_bf16 v[224:227], v[128:131], a[204:207], v[224:227]
    v_add_f32 v238, v220, v222
    ds_read_b128 v[124:127], v87 offset:8192
    buffer_load_dwordx4 v[180:183], v90, s[4:7], s79 offen sc1
    buffer_load_dword v184, v91, s[4:7], s79 offen offset:1024 sc1
    buffer_load_dwordx4 v[186:189], v90, s[4:7], s80 offen sc1
    buffer_load_dword v190, v91, s[4:7], s80 offen offset:1024 sc1
    s_waitcnt lgkmcnt(4)
    v_mfma_f32_16x16x32_bf16 v[224:227], v[108:111], a[208:211], v[224:227]
    buffer_store_dwordx4 v[234:237], v90, s[4:7], s81 offen
    buffer_store_dword v238, v91, s[4:7], s81 offen offset:1024
    ds_read_b128 v[128:131], v87 offset:8704
    s_waitcnt lgkmcnt(4)
    v_mfma_f32_16x16x32_bf16 v[224:227], v[112:115], a[212:215], v[224:227]
    ds_read_b128 v[108:111], v87 offset:9216
    s_waitcnt lgkmcnt(4)
    v_mfma_f32_16x16x32_bf16 v[224:227], v[116:119], a[216:219], v[224:227]
    ds_read_b128 v[112:115], v87 offset:9728
    s_waitcnt lgkmcnt(4)
    v_mfma_f32_16x16x32_bf16 v[224:227], v[120:123], a[220:223], v[224:227]
    s_waitcnt lgkmcnt(3)
    v_mfma_f32_16x16x32_bf16 v[224:227], v[124:127], a[224:227], v[224:227]
    s_waitcnt lgkmcnt(2)
    v_mfma_f32_16x16x32_bf16 v[224:227], v[128:131], a[228:231], v[224:227]
    s_waitcnt lgkmcnt(1)
    v_mfma_f32_16x16x32_bf16 v[224:227], v[108:111], a[232:235], v[224:227]
    s_waitcnt lgkmcnt(0)
    v_mfma_f32_16x16x32_bf16 v[224:227], v[112:115], a[236:239], v[224:227]
    s_lshl_b32 s78, s76, 2
    s_add_u32 s78, s78, s60
    s_mul_i32 s78, s78, 1280
    s_add_u32 s78, s78, s72
    s_add_u32 s78, s78, 30720
    s_lshl_b32 s81, s77, 2
    s_add_u32 s81, s81, s60
    s_mul_i32 s81, s81, 1280
    s_add_u32 s81, s81, s72
    s_add_u32 s81, s81, 30720
    v_cvt_pk_bf16_f32 v166, v224, v225
    v_cvt_pk_bf16_f32 v167, v226, v227
    v_cvt_pk_bf16_f32 v170, v224, v225
    v_cvt_pk_bf16_f32 v171, v226, v227
Lchk_20:
    s_waitcnt vmcnt(5)
    v_max3_u32 v192, v180, v181, v182
    s_waitcnt vmcnt(4)
    v_max3_u32 v192, v192, v183, v184
    s_waitcnt vmcnt(3)
    v_max3_u32 v192, v192, v186, v187
    v_max3_u32 v192, v192, v188, v189
    s_waitcnt vmcnt(2)
    v_max_u32 v192, v192, v190
    v_cmp_eq_u32 vcc, -1, v192
    s_cbranch_vccnz Lrty_21
    buffer_load_dwordx4 v[216:219], v90, s[4:7], s78 offen sc1
    buffer_load_dword v220, v91, s[4:7], s78 offen offset:1024 sc1
    buffer_load_dwordx4 v[222:225], v90, s[4:7], s81 offen sc1
    buffer_load_dword v226, v91, s[4:7], s81 offen offset:1024 sc1
    s_lshl_b32 s79, s59, 10
    s_add_u32 s79, s79, s72
    s_add_u32 s79, s79, 153600
    v_add_f32 v180, v180, v186
    v_add_f32 v181, v181, v187
    v_add_f32 v182, v182, v188
    v_add_f32 v183, v183, v189
    v_add_f32 v184, v184, v190
    v_add_f32 v228, v228, v180
    v_add_f32 v229, v229, v181
    v_add_f32 v230, v230, v182
    v_add_f32 v231, v231, v183
    v_add_f32 v232, v232, v184
    v_max3_f32 v192, v228, v229, v230
    v_max3_f32 v192, v192, v231, v232
    s_nop 1
    v_max_f32_dpp v192, v192, v192 row_ror:8 row_mask:0xf bank_mask:0xf
    v_mov_b32 v193, v192
    s_nop 1
    v_permlane16_swap_b32 v192, v193
    v_max_f32 v192, v192, v193
    v_mov_b32 v193, v192
    s_nop 1
    v_permlane32_swap_b32 v192, v193
    v_max_f32 v192, v192, v193
    v_mul_f32 v192, s70, v192
    v_fma_f32 v228, v228, s70, -v192
    v_fma_f32 v229, v229, s70, -v192
    v_fma_f32 v230, v230, s70, -v192
    v_fma_f32 v231, v231, s70, -v192
    v_fma_f32 v232, v232, s70, -v192
    v_exp_f32 v228, v228
    v_exp_f32 v229, v229
    v_exp_f32 v230, v230
    v_exp_f32 v231, v231
    v_exp_f32 v232, v232
    s_nop 0
    v_cvt_pk_bf16_f32 v199, v232, v232
    v_cvt_pk_bf16_f32 v196, v228, v229
    v_cvt_pk_bf16_f32 v197, v230, v231
    v_and_b32 v198, v105, v199
    v_and_b32 v199, v106, v199
    s_nop 1
    v_mfma_f32_16x16x32_bf16 v[212:215], v[176:179], v[196:199], 0
    v_mfma_f32_16x16x32_bf16 v[204:207], v[164:167], v[196:199], 0
    v_mfma_f32_16x16x32_bf16 v[208:211], v[168:171], v[196:199], 0
    s_add_u32 s80, s72, 4096
    s_nop 4
    v_add_f32_dpp v212, v212, v212 row_ror:8 row_mask:0xf bank_mask:0xf
    v_rcp_f32 v212, v212
    v_add_f32_dpp v204, v208, v204 row_ror:8 row_mask:0xf bank_mask:0xf
    v_add_f32_dpp v205, v209, v205 row_ror:8 row_mask:0xf bank_mask:0xf
    v_add_f32_dpp v206, v210, v206 row_ror:8 row_mask:0xf bank_mask:0xf
    v_add_f32_dpp v207, v211, v207 row_ror:8 row_mask:0xf bank_mask:0xf
    v_mul_f32 v204, v204, v212
    v_mul_f32 v205, v205, v212
    v_mul_f32 v206, v206, v212
    v_mul_f32 v207, v207, v212
    v_cvt_pk_bf16_f32 v204, v204, v205
    v_cvt_pk_bf16_f32 v205, v206, v207
    v_min_u32 v204, -2, v204
    v_min_u32 v205, -2, v205
    buffer_store_dwordx2 v[204:205], v100, s[4:7], s79 offen
Lchk_22:
    s_waitcnt vmcnt(4)
    v_max3_u32 v192, v216, v217, v218
    s_waitcnt vmcnt(3)
    v_max3_u32 v192, v192, v219, v220
    s_waitcnt vmcnt(2)
    v_max3_u32 v192, v192, v222, v223
    v_max3_u32 v192, v192, v224, v225
    s_waitcnt vmcnt(1)
    v_max_u32 v192, v192, v226
    v_cmp_eq_u32 vcc, -1, v192
    s_cbranch_vccnz Lrty_23
    v_add_f32 v216, v216, v222
    v_add_f32 v217, v217, v223
    v_add_f32 v218, v218, v224
    v_add_f32 v219, v219, v225
    v_add_f32 v220, v220, v226
    v_add_f32 v234, v234, v216
    v_add_f32 v235, v235, v217
    v_add_f32 v236, v236, v218
    v_add_f32 v237, v237, v219
    v_add_f32 v238, v238, v220
    v_mov_b32 v192, s71
    v_cndmask_b32 v234, v234, v192, s[84:85]
    v_cndmask_b32 v235, v235, v192, s[86:87]
    v_cndmask_b32 v236, v236, v192, s[88:89]
    v_cndmask_b32 v237, v237, v192, s[90:91]
    v_max3_f32 v192, v234, v235, v236
    v_max3_f32 v192, v192, v237, v238
    s_nop 1
    v_max_f32_dpp v192, v192, v192 row_ror:8 row_mask:0xf bank_mask:0xf
    v_mov_b32 v193, v192
    s_nop 1
    v_permlane16_swap_b32 v192, v193
    v_max_f32 v192, v192, v193
    v_mov_b32 v193, v192
    s_nop 1
    v_permlane32_swap_b32 v192, v193
    v_max_f32 v192, v192, v193
    v_mul_f32 v192, s70, v192
    v_fma_f32 v234, v234, s70, -v192
    v_fma_f32 v235, v235, s70, -v192
    v_fma_f32 v236, v236, s70, -v192
    v_fma_f32 v237, v237, s70, -v192
    v_fma_f32 v238, v238, s70, -v192
    v_exp_f32 v234, v234
    v_exp_f32 v235, v235
    v_exp_f32 v236, v236
    v_exp_f32 v237, v237
    v_exp_f32 v238, v238
    v_cvt_pk_bf16_f32 v196, v234, v235
    v_cvt_pk_bf16_f32 v197, v236, v237
    v_cvt_pk_bf16_f32 v198, v238, v238
    ds_write_b64 v98, v[196:197]
    ds_write_b16 v99, v198
    buffer_load_dwordx4 v[108:111], v101, s[4:7], s72 offen offset:0 sc1
    buffer_load_dwordx4 v[112:115], v101, s[4:7], s72 offen offset:1024 sc1
    buffer_load_dwordx4 v[116:119], v101, s[4:7], s72 offen offset:2048 sc1
    buffer_load_dwordx4 v[120:123], v101, s[4:7], s72 offen offset:3072 sc1
    buffer_load_dwordx4 v[124:127], v101, s[4:7], s80 offen offset:0 sc1
    buffer_load_dwordx4 v[128:131], v101, s[4:7], s80 offen offset:1024 sc1
    s_waitcnt lgkmcnt(0)
    s_barrier
    ds_read_b128 v[180:183], v90 offset:12288
    ds_read_b128 v[184:187], v90 offset:13824
    ds_read_b64 v[188:189], v92 offset:14848
    s_waitcnt lgkmcnt(2)
    v_mfma_f32_16x16x32_bf16 v[212:215], v[176:179], v[180:183], 0
    v_mfma_f32_16x16x32_bf16 v[204:207], v[164:167], v[180:183], 0
    s_waitcnt lgkmcnt(1)
    v_mfma_f32_16x16x32_bf16 v[216:219], v[176:179], v[184:187], 0
    v_mfma_f32_16x16x32_bf16 v[208:211], v[164:167], v[184:187], 0
    s_waitcnt lgkmcnt(0)
    s_nop 3
    v_mfma_f32_16x16x16_bf16 v[216:219], v[176:177], v[188:189], v[216:219]
    v_mfma_f32_16x16x16_bf16 v[208:211], v[168:169], v[188:189], v[208:211]
    v_rcp_f32 v212, v212
    s_nop 0
    v_mul_f32 v204, v204, v212
    v_mul_f32 v205, v205, v212
    v_mul_f32 v206, v206, v212
    v_mul_f32 v207, v207, v212
    s_nop 0
    v_rcp_f32 v216, v216
    v_cvt_pk_bf16_f32 v240, v204, v205
    v_cvt_pk_bf16_f32 v241, v206, v207
    v_mul_f32 v208, v208, v216
    v_mul_f32 v209, v209, v216
    v_mul_f32 v210, v210, v216
    v_mul_f32 v211, v211, v216
    v_cvt_pk_bf16_f32 v242, v208, v209
    v_cvt_pk_bf16_f32 v243, v210, v211
    s_nop 0
    v_permlane32_swap_b32 v240, v242
    v_permlane32_swap_b32 v241, v243
    s_cmp_eq_u32 s62, 63
    s_cbranch_scc1 L_Clast
    s_cmp_ge_u32 s59, 20
    s_cbranch_scc1 L_CnoWo0
Lchk_24:
    s_waitcnt vmcnt(5)
    v_max3_u32 v200, v108, v109, v110
    s_waitcnt vmcnt(4)
    v_max3_u32 v200, v200, v111, v112
    v_max3_u32 v200, v200, v113, v114
    s_waitcnt vmcnt(3)
    v_max3_u32 v200, v200, v115, v116
    v_max3_u32 v200, v200, v117, v118
    s_waitcnt vmcnt(2)
    v_max3_u32 v200, v200, v119, v120
    v_max3_u32 v200, v200, v121, v122
    s_waitcnt vmcnt(1)
    v_max3_u32 v200, v200, v123, v124
    v_max3_u32 v200, v200, v125, v126
    s_waitcnt vmcnt(0)
    v_max3_u32 v200, v200, v127, v128
    v_max3_u32 v200, v200, v129, v130
    v_max_u32 v200, v200, v131
    v_cmp_eq_u32 vcc, -1, v200
    s_cbranch_vccnz Lrty_25
    v_mfma_f32_16x16x32_bf16 v[180:183], a[240:243], v[108:111], 0
    v_mfma_f32_16x16x32_bf16 v[184:187], a[244:247], v[108:111], 0
    v_mfma_f32_16x16x32_bf16 v[188:191], a[248:251], v[108:111], 0
    v_mfma_f32_16x16x32_bf16 v[192:195], a[252:255], v[108:111], 0
    v_mfma_f32_16x16x32_bf16 v[180:183], v[4:7], v[112:115], v[180:183]
    v_mfma_f32_16x16x32_bf16 v[184:187], v[8:11], v[112:115], v[184:187]
    v_mfma_f32_16x16x32_bf16 v[188:191], v[12:15], v[112:115], v[188:191]
    v_mfma_f32_16x16x32_bf16 v[192:195], v[16:19], v[112:115], v[192:195]
    v_mfma_f32_16x16x32_bf16 v[180:183], v[20:23], v[116:119], v[180:183]
    v_mfma_f32_16x16x32_bf16 v[184:187], v[24:27], v[116:119], v[184:187]
    v_mfma_f32_16x16x32_bf16 v[188:191], v[28:31], v[116:119], v[188:191]
    v_mfma_f32_16x16x32_bf16 v[192:195], v[32:35], v[116:119], v[192:195]
    v_mfma_f32_16x16x32_bf16 v[180:183], v[36:39], v[120:123], v[180:183]
    v_mfma_f32_16x16x32_bf16 v[184:187], v[40:43], v[120:123], v[184:187]
    v_mfma_f32_16x16x32_bf16 v[188:191], v[44:47], v[120:123], v[188:191]
    v_mfma_f32_16x16x32_bf16 v[192:195], v[48:51], v[120:123], v[192:195]
    v_mfma_f32_16x16x32_bf16 v[180:183], v[52:55], v[124:127], v[180:183]
    v_mfma_f32_16x16x32_bf16 v[184:187], v[56:59], v[124:127], v[184:187]
    v_mfma_f32_16x16x32_bf16 v[188:191], v[60:63], v[124:127], v[188:191]
    v_mfma_f32_16x16x32_bf16 v[192:195], v[64:67], v[124:127], v[192:195]
    v_mfma_f32_16x16x32_bf16 v[180:183], v[68:71], v[128:131], v[180:183]
    v_mfma_f32_16x16x32_bf16 v[184:187], v[72:75], v[128:131], v[184:187]
    v_mfma_f32_16x16x32_bf16 v[188:191], v[76:79], v[128:131], v[188:191]
    v_mfma_f32_16x16x32_bf16 v[192:195], v[80:83], v[128:131], v[192:195]
    s_lshl_b32 s78, s59, 10
    s_add_u32 s78, s78, s72
    s_add_u32 s78, s78, 188416
    s_nop 3
    v_add_f32_dpp v196, v188, v180 row_ror:8 row_mask:0xf bank_mask:0x3
    v_add_f32_dpp v197, v189, v181 row_ror:8 row_mask:0xf bank_mask:0x3
    v_add_f32_dpp v198, v190, v182 row_ror:8 row_mask:0xf bank_mask:0x3
    v_add_f32_dpp v199, v191, v183 row_ror:8 row_mask:0xf bank_mask:0x3
    v_add_f32_dpp v196, v184, v192 row_ror:8 row_mask:0xf bank_mask:0xc
    v_add_f32_dpp v197, v185, v193 row_ror:8 row_mask:0xf bank_mask:0xc
    v_add_f32_dpp v198, v186, v194 row_ror:8 row_mask:0xf bank_mask:0xc
    v_add_f32_dpp v199, v187, v195 row_ror:8 row_mask:0xf bank_mask:0xc
    ds_write_b128 v88, v[196:199] offset:16384
    s_waitcnt lgkmcnt(0)
    s_barrier
    s_cmp_lg_u32 s82, 3
    s_cbranch_scc1 L_CnoWo
    ds_read_b128 v[204:207], v90 offset:16384
    ds_read_b128 v[208:211], v90 offset:17408
    ds_read_b128 v[212:215], v90 offset:18432
    ds_read_b128 v[216:219], v90 offset:19456
    s_waitcnt lgkmcnt(2)
    v_add_f32 v204, v204, v208
    v_add_f32 v205, v205, v209
    v_add_f32 v206, v206, v210
    v_add_f32 v207, v207, v211
    s_waitcnt lgkmcnt(0)
    v_add_f32 v212, v212, v216
    v_add_f32 v244, v204, v212
    v_add_f32 v213, v213, v217
    v_add_f32 v245, v205, v213
    v_add_f32 v214, v214, v218
    v_add_f32 v246, v206, v214
    v_add_f32 v215, v215, v219
    v_add_f32 v247, v207, v215
    buffer_store_dwordx4 v[244:247], v90, s[4:7], s78 offen sc1
L_CnoWo:
    ds_read_b128 v[108:111], v85 offset:20480
    ds_read_b128 v[112:115], v85 offset:40960
    ds_read_b128 v[116:119], v86 offset:20480
    ds_read_b128 v[120:123], v86 offset:40960
    buffer_store_dwordx4 v[240:243], v103, s[4:7], s75 offen sc1
    s_add_u32 s75, s75, 393216
    s_xor_b32 s79, s72, 524288
    s_lshl_b32 s64, s59, 2
    s_add_u32 s64, s64, s60
    s_mul_i32 s64, s64, 1280
    s_add_u32 s64, s64, s79
    s_add_u32 s64, s64, 30720
    buffer_store_dwordx4 v[172:175], v90, s[4:7], s64 offen
    buffer_store_dword v172, v91, s[4:7], s64 offen offset:1024
    s_lshl_b32 s65, s59, 10
    s_add_u32 s65, s65, s79
    s_add_u32 s65, s65, 153600
    buffer_store_dwordx2 v[172:173], v100, s[4:7], s65 offen
    s_cmp_lg_u32 s60, 0
    s_cbranch_scc1 Lrs_26
    s_mul_i32 s64, s59, 1280
    s_add_u32 s64, s64, s79
    buffer_store_dwordx4 v[172:175], v90, s[4:7], s64 offen
    buffer_store_dword v172, v91, s[4:7], s64 offen offset:1024
Lrs_26:
    s_cmp_lg_u32 s82, 3
    s_cbranch_scc1 Lrs_27
    s_lshl_b32 s64, s59, 9
    s_add_u32 s64, s64, s79
    s_add_u32 s64, s64, 178176
    s_lshl_b32 s65, s59, 10
    s_add_u32 s65, s65, s79
    s_add_u32 s65, s65, 188416
    buffer_store_dwordx2 v[172:173], v102, s[4:7], s64 offen
    buffer_store_dwordx4 v[172:175], v90, s[4:7], s65 offen sc1
Lrs_27:
    s_waitcnt lgkmcnt(3)
    v_mfma_f32_16x16x32_bf16 v[132:135], a[0:3], v[108:111], 0
    ds_read_b128 v[124:127], v85 offset:21504
    v_mfma_f32_16x16x32_bf16 v[140:143], a[80:83], v[108:111], 0
    ds_read_b128 v[128:131], v85 offset:41984
    v_mfma_f32_16x16x32_bf16 v[148:151], v[108:111], a[160:163], 0
    s_waitcnt lgkmcnt(4)
    v_mfma_f32_16x16x32_bf16 v[136:139], a[0:3], v[112:115], 0
    v_mfma_f32_16x16x32_bf16 v[144:147], a[80:83], v[112:115], 0
    v_mfma_f32_16x16x32_bf16 v[152:155], v[112:115], a[160:163], 0
    s_waitcnt lgkmcnt(3)
    v_mfma_f32_16x16x32_bf16 v[132:135], a[4:7], v[116:119], v[132:135]
    ds_read_b128 v[108:111], v86 offset:21504
    v_mfma_f32_16x16x32_bf16 v[140:143], a[84:87], v[116:119], v[140:143]
    ds_read_b128 v[112:115], v86 offset:41984
    v_mfma_f32_16x16x32_bf16 v[148:151], v[116:119], a[164:167], v[148:151]
    s_waitcnt lgkmcnt(4)
    v_mfma_f32_16x16x32_bf16 v[136:139], a[4:7], v[120:123], v[136:139]
    v_mfma_f32_16x16x32_bf16 v[144:147], a[84:87], v[120:123], v[144:147]
    v_mfma_f32_16x16x32_bf16 v[152:155], v[120:123], a[164:167], v[152:155]
    s_cmp_lg_u32 s82, 3
    s_cbranch_scc1 Lx3i_28
    s_xor_b32 s79, s78, 1048576
    s_xor_b32 s80, s78, 2097152
    s_xor_b32 s81, s78, 3145728
    buffer_load_dwordx4 v[204:207], v90, s[4:7], s79 offen sc1
    buffer_load_dwordx4 v[208:211], v90, s[4:7], s80 offen sc1
    buffer_load_dwordx4 v[212:215], v90, s[4:7], s81 offen sc1
Lx3i_28:
    s_waitcnt lgkmcnt(3)
    v_mfma_f32_16x16x32_bf16 v[132:135], a[8:11], v[124:127], v[132:135]
    ds_read_b128 v[116:119], v85 offset:22528
    v_mfma_f32_16x16x32_bf16 v[140:143], a[88:91], v[124:127], v[140:143]
    ds_read_b128 v[120:123], v85 offset:43008
    v_mfma_f32_16x16x32_bf16 v[148:151], v[124:127], a[168:171], v[148:151]
    s_waitcnt lgkmcnt(4)
    v_mfma_f32_16x16x32_bf16 v[136:139], a[8:11], v[128:131], v[136:139]
    v_mfma_f32_16x16x32_bf16 v[144:147], a[88:91], v[128:131], v[144:147]
    v_mfma_f32_16x16x32_bf16 v[152:155], v[128:131], a[168:171], v[152:155]
    s_waitcnt lgkmcnt(3)
    v_mfma_f32_16x16x32_bf16 v[132:135], a[12:15], v[108:111], v[132:135]
    ds_read_b128 v[124:127], v86 offset:22528
    v_mfma_f32_16x16x32_bf16 v[140:143], a[92:95], v[108:111], v[140:143]
    ds_read_b128 v[128:131], v86 offset:43008
    v_mfma_f32_16x16x32_bf16 v[148:151], v[108:111], a[172:175], v[148:151]
    s_waitcnt lgkmcnt(4)
    v_mfma_f32_16x16x32_bf16 v[136:139], a[12:15], v[112:115], v[136:139]
    v_mfma_f32_16x16x32_bf16 v[144:147], a[92:95], v[112:115], v[144:147]
    v_mfma_f32_16x16x32_bf16 v[152:155], v[112:115], a[172:175], v[152:155]
    s_waitcnt lgkmcnt(3)
    v_mfma_f32_16x16x32_bf16 v[132:135], a[16:19], v[116:119], v[132:135]
    ds_read_b128 v[108:111], v85 offset:23552
    v_mfma_f32_16x16x32_bf16 v[140:143], a[96:99], v[116:119], v[140:143]
    ds_read_b128 v[112:115], v85 offset:44032
    v_mfma_f32_16x16x32_bf16 v[148:151], v[116:119], a[176:179], v[148:151]
    s_waitcnt lgkmcnt(4)
    v_mfma_f32_16x16x32_bf16 v[136:139], a[16:19], v[120:123], v[136:139]
    v_mfma_f32_16x16x32_bf16 v[144:147], a[96:99], v[120:123], v[144:147]
    v_mfma_f32_16x16x32_bf16 v[152:155], v[120:123], a[176:179], v[152:155]
    s_waitcnt lgkmcnt(3)
    v_mfma_f32_16x16x32_bf16 v[132:135], a[20:23], v[124:127], v[132:135]
    ds_read_b128 v[116:119], v86 offset:23552
    v_mfma_f32_16x16x32_bf16 v[140:143], a[100:103], v[124:127], v[140:143]
    ds_read_b128 v[120:123], v86 offset:44032
    v_mfma_f32_16x16x32_bf16 v[148:151], v[124:127], a[180:183], v[148:151]
    s_waitcnt lgkmcnt(4)
    v_mfma_f32_16x16x32_bf16 v[136:139], a[20:23], v[128:131], v[136:139]
    v_mfma_f32_16x16x32_bf16 v[144:147], a[100:103], v[128:131], v[144:147]
    v_mfma_f32_16x16x32_bf16 v[152:155], v[128:131], a[180:183], v[152:155]
    s_waitcnt lgkmcnt(3)
    v_mfma_f32_16x16x32_bf16 v[132:135], a[24:27], v[108:111], v[132:135]
    ds_read_b128 v[124:127], v85 offset:24576
    v_mfma_f32_16x16x32_bf16 v[140:143], a[104:107], v[108:111], v[140:143]
    ds_read_b128 v[128:131], v85 offset:45056
    v_mfma_f32_16x16x32_bf16 v[148:151], v[108:111], a[184:187], v[148:151]
    s_waitcnt lgkmcnt(4)
    v_mfma_f32_16x16x32_bf16 v[136:139], a[24:27], v[112:115], v[136:139]
    v_mfma_f32_16x16x32_bf16 v[144:147], a[104:107], v[112:115], v[144:147]
    v_mfma_f32_16x16x32_bf16 v[152:155], v[112:115], a[184:187], v[152:155]
    s_waitcnt lgkmcnt(3)
    v_mfma_f32_16x16x32_bf16 v[132:135], a[28:31], v[116:119], v[132:135]
    ds_read_b128 v[108:111], v86 offset:24576
    v_mfma_f32_16x16x32_bf16 v[140:143], a[108:111], v[116:119], v[140:143]
    ds_read_b128 v[112:115], v86 offset:45056
    v_mfma_f32_16x16x32_bf16 v[148:151], v[116:119], a[188:191], v[148:151]
    s_waitcnt lgkmcnt(4)
    v_mfma_f32_16x16x32_bf16 v[136:139], a[28:31], v[120:123], v[136:139]
    v_mfma_f32_16x16x32_bf16 v[144:147], a[108:111], v[120:123], v[144:147]
    v_mfma_f32_16x16x32_bf16 v[152:155], v[120:123], a[188:191], v[152:155]
    s_cmp_eq_u32 s82, 3
    s_cbranch_scc1 Lflg_29
    s_waitcnt vmcnt(0)
    s_add_u32 s64, s62, 1
    v_mov_b32 v180, s64
    s_mov_b64 exec, 1
    buffer_store_dword v180, off, s[4:7], s63 sc1
    s_mov_b64 exec, -1
Lflg_29:
    s_waitcnt lgkmcnt(3)
    v_mfma_f32_16x16x32_bf16 v[132:135], a[32:35], v[124:127], v[132:135]
    ds_read_b128 v[116:119], v85 offset:25600
    v_mfma_f32_16x16x32_bf16 v[140:143], a[112:115], v[124:127], v[140:143]
    ds_read_b128 v[120:123], v85 offset:46080
    v_mfma_f32_16x16x32_bf16 v[148:151], v[124:127], a[192:195], v[148:151]
    s_waitcnt lgkmcnt(4)
    v_mfma_f32_16x16x32_bf16 v[136:139], a[32:35], v[128:131], v[136:139]
    v_mfma_f32_16x16x32_bf16 v[144:147], a[112:115], v[128:131], v[144:147]
    v_mfma_f32_16x16x32_bf16 v[152:155], v[128:131], a[192:195], v[152:155]
    s_waitcnt lgkmcnt(3)
    v_mfma_f32_16x16x32_bf16 v[132:135], a[36:39], v[108:111], v[132:135]
    ds_read_b128 v[124:127], v86 offset:25600
    v_mfma_f32_16x16x32_bf16 v[140:143], a[116:119], v[108:111], v[140:143]
    ds_read_b128 v[128:131], v86 offset:46080
    v_mfma_f32_16x16x32_bf16 v[148:151], v[108:111], a[196:199], v[148:151]
    s_waitcnt lgkmcnt(4)
    v_mfma_f32_16x16x32_bf16 v[136:139], a[36:39], v[112:115], v[136:139]
    v_mfma_f32_16x16x32_bf16 v[144:147], a[116:119], v[112:115], v[144:147]
    v_mfma_f32_16x16x32_bf16 v[152:155], v[112:115], a[196:199], v[152:155]
    s_waitcnt lgkmcnt(3)
    v_mfma_f32_16x16x32_bf16 v[132:135], a[40:43], v[116:119], v[132:135]
    ds_read_b128 v[108:111], v85 offset:26624
    v_mfma_f32_16x16x32_bf16 v[140:143], a[120:123], v[116:119], v[140:143]
    ds_read_b128 v[112:115], v85 offset:47104
    v_mfma_f32_16x16x32_bf16 v[148:151], v[116:119], a[200:203], v[148:151]
    s_waitcnt lgkmcnt(4)
    v_mfma_f32_16x16x32_bf16 v[136:139], a[40:43], v[120:123], v[136:139]
    v_mfma_f32_16x16x32_bf16 v[144:147], a[120:123], v[120:123], v[144:147]
    v_mfma_f32_16x16x32_bf16 v[152:155], v[120:123], a[200:203], v[152:155]
    s_cmp_lg_u32 s82, 3
    s_cbranch_scc1 Lx3c_30
    s_lshl_b32 s78, s59, 9
    s_add_u32 s78, s78, s72
    s_add_u32 s78, s78, 178176
Lchk_31:
    s_waitcnt vmcnt(2)
    v_max3_u32 v216, v204, v205, v206
    s_waitcnt vmcnt(1)
    v_max3_u32 v216, v216, v207, v208
    v_max3_u32 v216, v216, v209, v210
    s_waitcnt vmcnt(0)
    v_max3_u32 v216, v216, v211, v212
    v_max3_u32 v216, v216, v213, v214
    v_max_u32 v216, v216, v215
    v_cmp_eq_u32 vcc, -1, v216
    s_cbranch_vccnz Lrty_32
    v_add_f32 v204, v204, v244
    v_add_f32 v208, v208, v212
    v_add_f32 v205, v205, v245
    v_add_f32 v209, v209, v213
    v_add_f32 v206, v206, v246
    v_add_f32 v210, v210, v214
    v_add_f32 v207, v207, v247
    v_add_f32 v211, v211, v215
    v_add_f32 v204, v204, v208
    v_add_f32 v205, v205, v209
    v_add_f32 v206, v206, v210
    v_add_f32 v207, v207, v211
    v_cvt_pk_bf16_f32 v204, v204, v205
    v_cvt_pk_bf16_f32 v205, v206, v207
    v_min_u32 v204, -2, v204
    v_min_u32 v205, -2, v205
    buffer_store_dwordx2 v[204:205], v102, s[4:7], s78 offen
    s_add_u32 s64, s62, 1
    v_mov_b32 v180, s64
    s_mov_b64 exec, 1
    buffer_store_dword v180, off, s[4:7], s63 sc1
    s_mov_b64 exec, -1
Lx3c_30:
    s_waitcnt lgkmcnt(3)
    v_mfma_f32_16x16x32_bf16 v[132:135], a[44:47], v[124:127], v[132:135]
    ds_read_b128 v[116:119], v86 offset:26624
    v_mfma_f32_16x16x32_bf16 v[140:143], a[124:127], v[124:127], v[140:143]
    ds_read_b128 v[120:123], v86 offset:47104
    v_mfma_f32_16x16x32_bf16 v[148:151], v[124:127], a[204:207], v[148:151]
    s_waitcnt lgkmcnt(4)
    v_mfma_f32_16x16x32_bf16 v[136:139], a[44:47], v[128:131], v[136:139]
    v_mfma_f32_16x16x32_bf16 v[144:147], a[124:127], v[128:131], v[144:147]
    v_mfma_f32_16x16x32_bf16 v[152:155], v[128:131], a[204:207], v[152:155]
    s_waitcnt lgkmcnt(3)
    v_mfma_f32_16x16x32_bf16 v[132:135], a[48:51], v[108:111], v[132:135]
    ds_read_b128 v[124:127], v85 offset:27648
    v_mfma_f32_16x16x32_bf16 v[140:143], a[128:131], v[108:111], v[140:143]
    ds_read_b128 v[128:131], v85 offset:48128
    v_mfma_f32_16x16x32_bf16 v[148:151], v[108:111], a[208:211], v[148:151]
    s_waitcnt lgkmcnt(4)
    v_mfma_f32_16x16x32_bf16 v[136:139], a[48:51], v[112:115], v[136:139]
    v_mfma_f32_16x16x32_bf16 v[144:147], a[128:131], v[112:115], v[144:147]
    v_mfma_f32_16x16x32_bf16 v[152:155], v[112:115], a[208:211], v[152:155]
    s_waitcnt lgkmcnt(3)
    v_mfma_f32_16x16x32_bf16 v[132:135], a[52:55], v[116:119], v[132:135]
    ds_read_b128 v[108:111], v86 offset:27648
    v_mfma_f32_16x16x32_bf16 v[140:143], a[132:135], v[116:119], v[140:143]
    ds_read_b128 v[112:115], v86 offset:48128
    v_mfma_f32_16x16x32_bf16 v[148:151], v[116:119], a[212:215], v[148:151]
    s_waitcnt lgkmcnt(4)
    v_mfma_f32_16x16x32_bf16 v[136:139], a[52:55], v[120:123], v[136:139]
    v_mfma_f32_16x16x32_bf16 v[144:147], a[132:135], v[120:123], v[144:147]
    v_mfma_f32_16x16x32_bf16 v[152:155], v[120:123], a[212:215], v[152:155]
    s_waitcnt lgkmcnt(3)
    v_mfma_f32_16x16x32_bf16 v[132:135], a[56:59], v[124:127], v[132:135]
    ds_read_b128 v[116:119], v85 offset:28672
    v_mfma_f32_16x16x32_bf16 v[140:143], a[136:139], v[124:127], v[140:143]
    ds_read_b128 v[120:123], v85 offset:49152
    v_mfma_f32_16x16x32_bf16 v[148:151], v[124:127], a[216:219], v[148:151]
    s_waitcnt lgkmcnt(4)
    v_mfma_f32_16x16x32_bf16 v[136:139], a[56:59], v[128:131], v[136:139]
    v_mfma_f32_16x16x32_bf16 v[144:147], a[136:139], v[128:131], v[144:147]
    v_mfma_f32_16x16x32_bf16 v[152:155], v[128:131], a[216:219], v[152:155]
    s_waitcnt lgkmcnt(3)
    v_mfma_f32_16x16x32_bf16 v[132:135], a[60:63], v[108:111], v[132:135]
    ds_read_b128 v[124:127], v86 offset:28672
    v_mfma_f32_16x16x32_bf16 v[140:143], a[140:143], v[108:111], v[140:143]
    ds_read_b128 v[128:131], v86 offset:49152
    v_mfma_f32_16x16x32_bf16 v[148:151], v[108:111], a[220:223], v[148:151]
    s_waitcnt lgkmcnt(4)
    v_mfma_f32_16x16x32_bf16 v[136:139], a[60:63], v[112:115], v[136:139]
    v_mfma_f32_16x16x32_bf16 v[144:147], a[140:143], v[112:115], v[144:147]
    v_mfma_f32_16x16x32_bf16 v[152:155], v[112:115], a[220:223], v[152:155]
    s_add_u32 s78, s72, 178176
    s_add_u32 s79, s72, 182272
    buffer_load_dwordx4 v[224:227], v104, s[4:7], 0 offen sc1
    buffer_load_dwordx4 v[180:183], v88, s[4:7], s78 offen sc1
    buffer_load_dwordx4 v[184:187], v88, s[4:7], s79 offen sc1
    buffer_load_dwordx2 v[188:189], v89, s[4:7], s78 offen sc1
    s_waitcnt lgkmcnt(3)
    v_mfma_f32_16x16x32_bf16 v[132:135], a[64:67], v[116:119], v[132:135]
    ds_read_b128 v[108:111], v85 offset:29696
    v_mfma_f32_16x16x32_bf16 v[140:143], a[144:147], v[116:119], v[140:143]
    ds_read_b128 v[112:115], v85 offset:50176
    v_mfma_f32_16x16x32_bf16 v[148:151], v[116:119], a[224:227], v[148:151]
    s_waitcnt lgkmcnt(4)
    v_mfma_f32_16x16x32_bf16 v[136:139], a[64:67], v[120:123], v[136:139]
    v_mfma_f32_16x16x32_bf16 v[144:147], a[144:147], v[120:123], v[144:147]
    v_mfma_f32_16x16x32_bf16 v[152:155], v[120:123], a[224:227], v[152:155]
    s_waitcnt lgkmcnt(3)
    v_mfma_f32_16x16x32_bf16 v[132:135], a[68:71], v[124:127], v[132:135]
    ds_read_b128 v[116:119], v86 offset:29696
    v_mfma_f32_16x16x32_bf16 v[140:143], a[148:151], v[124:127], v[140:143]
    ds_read_b128 v[120:123], v86 offset:50176
    v_mfma_f32_16x16x32_bf16 v[148:151], v[124:127], a[228:231], v[148:151]
    s_waitcnt lgkmcnt(4)
    v_mfma_f32_16x16x32_bf16 v[136:139], a[68:71], v[128:131], v[136:139]
    v_mfma_f32_16x16x32_bf16 v[144:147], a[148:151], v[128:131], v[144:147]
    v_mfma_f32_16x16x32_bf16 v[152:155], v[128:131], a[228:231], v[152:155]
    s_waitcnt lgkmcnt(3)
    v_mfma_f32_16x16x32_bf16 v[132:135], a[72:75], v[108:111], v[132:135]
    v_mfma_f32_16x16x32_bf16 v[140:143], a[152:155], v[108:111], v[140:143]
    v_mfma_f32_16x16x32_bf16 v[148:151], v[108:111], a[232:235], v[148:151]
    s_waitcnt lgkmcnt(2)
    v_mfma_f32_16x16x32_bf16 v[136:139], a[72:75], v[112:115], v[136:139]
    v_mfma_f32_16x16x32_bf16 v[144:147], a[152:155], v[112:115], v[144:147]
    v_mfma_f32_16x16x32_bf16 v[152:155], v[112:115], a[232:235], v[152:155]
    s_waitcnt lgkmcnt(1)
    v_mfma_f32_16x16x32_bf16 v[132:135], a[76:79], v[116:119], v[132:135]
    v_mfma_f32_16x16x32_bf16 v[140:143], a[156:159], v[116:119], v[140:143]
    v_mfma_f32_16x16x32_bf16 v[148:151], v[116:119], a[236:239], v[148:151]
    s_waitcnt lgkmcnt(0)
    v_mfma_f32_16x16x32_bf16 v[136:139], a[76:79], v[120:123], v[136:139]
    v_mfma_f32_16x16x32_bf16 v[144:147], a[156:159], v[120:123], v[144:147]
    v_mfma_f32_16x16x32_bf16 v[152:155], v[120:123], a[236:239], v[152:155]
    s_nop 1
    v_cvt_pk_bf16_f32 v156, v132, v133
    v_cvt_pk_bf16_f32 v157, v134, v135
    v_cvt_pk_bf16_f32 v160, v140, v141
    v_cvt_pk_bf16_f32 v161, v142, v143
    v_cvt_pk_bf16_f32 v164, v148, v149
    v_cvt_pk_bf16_f32 v165, v150, v151
    v_cvt_pk_bf16_f32 v158, v136, v137
    v_cvt_pk_bf16_f32 v159, v138, v139
    v_cvt_pk_bf16_f32 v162, v144, v145
    v_cvt_pk_bf16_f32 v163, v146, v147
    v_cvt_pk_bf16_f32 v168, v152, v153
    v_cvt_pk_bf16_f32 v169, v154, v155
    v_mfma_f32_16x16x16_bf16 v[132:135], v[160:161], v[156:157], 0
    v_mfma_f32_16x16x16_bf16 v[136:139], v[160:161], v[158:159], 0
    v_mfma_f32_16x16x16_bf16 v[140:143], v[162:163], v[158:159], 0
    s_nop 5
    ds_write_b128 v93, v[132:135] offset:5120
    ds_write_b128 v93, v[136:139] offset:6144
    ds_write_b128 v93, v[140:143] offset:7168
Lchk_33:
    s_waitcnt vmcnt(2)
    v_max3_u32 v192, v180, v181, v182
    s_waitcnt vmcnt(1)
    v_max3_u32 v192, v192, v183, v184
    v_max3_u32 v192, v192, v185, v186
    s_waitcnt vmcnt(0)
    v_max3_u32 v192, v192, v187, v188
    v_max_u32 v192, v192, v189
    v_cmp_eq_u32 vcc, -1, v192
    s_cbranch_vccnz Lrty_34
    ds_write_b128 v88, v[180:183] offset:0
    ds_write_b128 v88, v[184:187] offset:4096
    ds_write_b64 v89, v[188:189] offset:0
    s_add_u32 s62, s62, 1
    s_add_u32 s64, s72, 262144
    s_and_b32 s64, s64, 786432
    s_andn2_b32 s72, s72, 786432
    s_or_b32 s72, s72, s64
    s_branch L_Cstep
Lgrty_12:
    s_sleep 4
    buffer_load_dword v2, v3, s[8:11], 0 offen sc1
    s_sub_u32 s61, s61, 1
    s_mov_b32 s67, 1
    s_cbranch_scc1 L_fail
    s_branch Lgchk_11
Lfrty_15:
    s_sleep 1
    buffer_load_dwordx4 v[224:227], v104, s[4:7], 0 offen sc1
    s_sub_u32 s61, s61, 1
    s_mov_b32 s67, 10
    s_cbranch_scc1 L_fail
    s_waitcnt vmcnt(0)
    s_branch Lfchk_14
Lfrty_18:
    s_sleep 1
    buffer_load_dwordx4 v[224:227], v104, s[4:7], 0 offen sc1
    s_sub_u32 s61, s61, 1
    s_mov_b32 s67, 10
    s_cbranch_scc1 L_fail
    s_waitcnt vmcnt(0)
    s_branch Lfchk_17
Lrty_21:
    buffer_load_dwordx4 v[180:183], v90, s[4:7], s79 offen sc1
    buffer_load_dword v184, v91, s[4:7], s79 offen offset:1024 sc1
    buffer_load_dwordx4 v[186:189], v90, s[4:7], s80 offen sc1
    buffer_load_dword v190, v91, s[4:7], s80 offen offset:1024 sc1
    s_sub_u32 s61, s61, 1
    s_mov_b32 s67, 11
    s_cbranch_scc1 L_fail
    s_waitcnt vmcnt(0)
    s_branch Lchk_20
Lrty_23:
    buffer_load_dwordx4 v[216:219], v90, s[4:7], s78 offen sc1
    buffer_load_dword v220, v91, s[4:7], s78 offen offset:1024 sc1
    buffer_load_dwordx4 v[222:225], v90, s[4:7], s81 offen sc1
    buffer_load_dword v226, v91, s[4:7], s81 offen offset:1024 sc1
    s_sub_u32 s61, s61, 1
    s_mov_b32 s67, 12
    s_cbranch_scc1 L_fail
    s_waitcnt vmcnt(0)
    s_branch Lchk_22
L_Clast:
    buffer_store_dwordx4 v[240:243], v103, s[4:7], s75 offen sc1
    s_waitcnt vmcnt(0)
    s_add_u32 s64, s62, 1
    v_mov_b32 v180, s64
    s_mov_b64 exec, 1
    buffer_store_dword v180, off, s[4:7], s63 sc1
    s_mov_b64 exec, -1
    s_endpgm
L_CnoWo0:
    s_waitcnt vmcnt(0)
    s_branch L_CnoWo
Lrty_25:
    buffer_load_dwordx4 v[108:111], v101, s[4:7], s72 offen offset:0 sc1
    buffer_load_dwordx4 v[112:115], v101, s[4:7], s72 offen offset:1024 sc1
    buffer_load_dwordx4 v[116:119], v101, s[4:7], s72 offen offset:2048 sc1
    buffer_load_dwordx4 v[120:123], v101, s[4:7], s72 offen offset:3072 sc1
    buffer_load_dwordx4 v[124:127], v101, s[4:7], s80 offen offset:0 sc1
    buffer_load_dwordx4 v[128:131], v101, s[4:7], s80 offen offset:1024 sc1
    s_sub_u32 s61, s61, 1
    s_mov_b32 s67, 13
    s_cbranch_scc1 L_fail
    s_waitcnt vmcnt(0)
    s_branch Lchk_24
Lrty_32:
    buffer_load_dwordx4 v[204:207], v90, s[4:7], s79 offen sc1
    buffer_load_dwordx4 v[208:211], v90, s[4:7], s80 offen sc1
    buffer_load_dwordx4 v[212:215], v90, s[4:7], s81 offen sc1
    s_sub_u32 s61, s61, 1
    s_mov_b32 s67, 14
    s_cbranch_scc1 L_fail
    s_waitcnt vmcnt(0)
    s_branch Lchk_31
Lrty_34:
    buffer_load_dwordx4 v[180:183], v88, s[4:7], s78 offen sc1
    buffer_load_dwordx4 v[184:187], v88, s[4:7], s79 offen sc1
    buffer_load_dwordx2 v[188:189], v89, s[4:7], s78 offen sc1
    s_sub_u32 s61, s61, 1
    s_mov_b32 s67, 15
    s_cbranch_scc1 L_fail
    s_waitcnt vmcnt(0)
    s_branch Lchk_33
L_roleT:
    s_mov_b32 s24, s42
    s_mov_b32 s25, s43
    s_mov_b32 s26, 7864320
    s_mov_b32 s27, 0x20000
    v_mov_b32 v2, 0
    v_mov_b32 v3, s63
    buffer_store_dword v2, v3, s[4:7], 0 offen sc1
    s_waitcnt vmcnt(0)
    s_barrier
    s_cmp_lg_u32 s60, 0
    s_cbranch_scc1 Larr_35
    s_mov_b64 exec, 1
    v_mov_b32 v2, 1
    v_mov_b32 v3, 20
    buffer_atomic_add v2, v3, s[8:11], 0 offen
    s_mov_b64 exec, -1
Larr_35:
    v_and_b32 v1, 63, v0
    s_and_b32 s74, s59, 1
    s_bfe_u32 s75, s59, 0x10001
    s_lshl_b32 s64, s69, 1
    s_add_u32 s75, s75, s64
    s_mul_i32 s64, s75, 983040
    s_mul_i32 s65, s60, 10240
    s_add_u32 s64, s64, s65
    s_lshl_b32 s65, s74, 8
    s_add_u32 s65, s65, s64
    v_lshrrev_b32 v164, 4, v1
    v_mul_u32_u24 v164, 1280, v164
    v_and_b32 v166, 15, v1
    v_lshl_add_u32 v164, v166, 4, v164
    v_add_u32 v164, s65, v164
    s_lshl_b32 s65, s74, 7
    s_add_u32 s65, s65, s64
    s_add_u32 s65, s65, 1024
    v_lshrrev_b32 v165, 3, v1
    v_mul_u32_u24 v165, 1280, v165
    v_and_b32 v166, 7, v1
    v_lshl_add_u32 v165, v166, 4, v165
    v_add_u32 v165, s65, v165
    v_lshrrev_b32 v166, 5, v1
    v_lshlrev_b32 v166, 4, v166
    v_bfe_u32 v167, v1, 2, 3
    v_add_u32 v166, v166, v167
    v_and_b32 v167, 3, v1
    v_lshlrev_b32 v168, 7, v166
    v_lshl_add_u32 v168, v167, 3, v168
    s_lshl_b32 s64, s60, 5
    v_add_u32 v168, s64, v168
    v_lshlrev_b32 v166, 1, v168
    v_add_u32 v167, 40960, v166
    v_add_u32 v169, 40960, v168
    v_lshlrev_b32 v240, 4, v0
    v_lshlrev_b32 v241, 4, v1
    s_lshl_b32 s64, s60, 14
    s_add_u32 s64, s64, 98304
    v_add_u32 v242, s64, v241
    s_lshl_b32 s70, s60, 11
    s_lshl_b32 s71, s60, 10
    s_mov_b32 s64, 0
    s_add_u32 m0, s70, 0
    s_nop 0
    buffer_load_dwordx4 v164, s[24:27], s64 offen lds
    s_mov_b32 s64, 5120
    s_add_u32 m0, s70, 1024
    s_nop 0
    buffer_load_dwordx4 v164, s[24:27], s64 offen lds
    s_mov_b32 s64, 512
    s_add_u32 m0, s70, 8192
    s_nop 0
    buffer_load_dwordx4 v164, s[24:27], s64 offen lds
    s_mov_b32 s64, 5632
    s_add_u32 m0, s70, 9216
    s_nop 0
    buffer_load_dwordx4 v164, s[24:27], s64 offen lds
    s_mov_b32 s64, 0
    s_add_u32 m0, s71, 16384
    s_nop 0
    buffer_load_dwordx4 v165, s[24:27], s64 offen lds
    s_mov_b32 s64, 40960
    s_add_u32 m0, s70, 20480
    s_nop 0
    buffer_load_dwordx4 v164, s[24:27], s64 offen lds
    s_mov_b32 s64, 46080
    s_add_u32 m0, s70, 21504
    s_nop 0
    buffer_load_dwordx4 v164, s[24:27], s64 offen lds
    s_mov_b32 s64, 41472
    s_add_u32 m0, s70, 28672
    s_nop 0
    buffer_load_dwordx4 v164, s[24:27], s64 offen lds
    s_mov_b32 s64, 46592
    s_add_u32 m0, s70, 29696
    s_nop 0
    buffer_load_dwordx4 v164, s[24:27], s64 offen lds
    s_mov_b32 s64, 40960
    s_add_u32 m0, s71, 36864
    s_nop 0
    buffer_load_dwordx4 v165, s[24:27], s64 offen lds
    s_mov_b32 s64, 81920
    s_add_u32 m0, s70, 40960
    s_nop 0
    buffer_load_dwordx4 v164, s[24:27], s64 offen lds
    s_mov_b32 s64, 87040
    s_add_u32 m0, s70, 41984
    s_nop 0
    buffer_load_dwordx4 v164, s[24:27], s64 offen lds
    s_mov_b32 s64, 82432
    s_add_u32 m0, s70, 49152
    s_nop 0
    buffer_load_dwordx4 v164, s[24:27], s64 offen lds
    s_mov_b32 s64, 87552
    s_add_u32 m0, s70, 50176
    s_nop 0
    buffer_load_dwordx4 v164, s[24:27], s64 offen lds
    s_mov_b32 s64, 81920
    s_add_u32 m0, s71, 57344
    s_nop 0
    buffer_load_dwordx4 v165, s[24:27], s64 offen lds
    s_waitcnt vmcnt(10)
    s_waitcnt lgkmcnt(0)
    s_barrier
    s_mov_b32 s64, 122880
    s_add_u32 m0, s70, 61440
    s_nop 0
    buffer_load_dwordx4 v164, s[24:27], s64 offen lds
    s_mov_b32 s64, 128000
    s_add_u32 m0, s70, 62464
    s_nop 0
    buffer_load_dwordx4 v164, s[24:27], s64 offen lds
    s_mov_b32 s64, 123392
    s_add_u32 m0, s70, 69632
    s_nop 0
    buffer_load_dwordx4 v164, s[24:27], s64 offen lds
    s_mov_b32 s64, 128512
    s_add_u32 m0, s70, 70656
    s_nop 0
    buffer_load_dwordx4 v164, s[24:27], s64 offen lds
    s_mov_b32 s64, 122880
    s_add_u32 m0, s71, 77824
    s_nop 0
    buffer_load_dwordx4 v165, s[24:27], s64 offen lds
    ds_read_b64_tr_b16 a[0:1], v166 offset:0
    ds_read_b64_tr_b16 a[2:3], v166 offset:2048
    ds_read_b64_tr_b16 a[4:5], v166 offset:8
    ds_read_b64_tr_b16 a[6:7], v166 offset:2056
    ds_read_b64_tr_b16 a[8:9], v166 offset:8192
    ds_read_b64_tr_b16 a[10:11], v166 offset:10240
    ds_read_b64_tr_b16 a[12:13], v166 offset:8200
    ds_read_b64_tr_b16 a[14:15], v166 offset:10248
    ds_read_b64_tr_b16 v[220:221], v168 offset:16384
    ds_read_b64_tr_b16 v[222:223], v168 offset:17408
    s_waitcnt lgkmcnt(0)
    ds_write_b128 v242, v[220:223] offset:0
    s_waitcnt vmcnt(10)
    s_waitcnt lgkmcnt(0)
    s_barrier
    s_mov_b32 s64, 163840
    s_add_u32 m0, s70, 0
    s_nop 0
    buffer_load_dwordx4 v164, s[24:27], s64 offen lds
    s_mov_b32 s64, 168960
    s_add_u32 m0, s70, 1024
    s_nop 0
    buffer_load_dwordx4 v164, s[24:27], s64 offen lds
    s_mov_b32 s64, 164352
    s_add_u32 m0, s70, 8192
    s_nop 0
    buffer_load_dwordx4 v164, s[24:27], s64 offen lds
    s_mov_b32 s64, 169472
    s_add_u32 m0, s70, 9216
    s_nop 0
    buffer_load_dwordx4 v164, s[24:27], s64 offen lds
    s_mov_b32 s64, 163840
    s_add_u32 m0, s71, 16384
    s_nop 0
    buffer_load_dwordx4 v165, s[24:27], s64 offen lds
    ds_read_b64_tr_b16 a[16:17], v166 offset:20480
    ds_read_b64_tr_b16 a[18:19], v166 offset:22528
    ds_read_b64_tr_b16 a[20:21], v166 offset:20488
    ds_read_b64_tr_b16 a[22:23], v166 offset:22536
    ds_read_b64_tr_b16 a[24:25], v166 offset:28672
    ds_read_b64_tr_b16 a[26:27], v166 offset:30720
    ds_read_b64_tr_b16 a[28:29], v166 offset:28680
    ds_read_b64_tr_b16 a[30:31], v166 offset:30728
    ds_read_b64_tr_b16 v[224:225], v168 offset:36864
    ds_read_b64_tr_b16 v[226:227], v168 offset:37888
    s_waitcnt lgkmcnt(0)
    ds_write_b128 v242, v[224:227] offset:1024
    s_waitcnt vmcnt(10)
    s_waitcnt lgkmcnt(0)
    s_barrier
    s_mov_b32 s64, 204800
    s_add_u32 m0, s70, 20480
    s_nop 0
    buffer_load_dwordx4 v164, s[24:27], s64 offen lds
    s_mov_b32 s64, 209920
    s_add_u32 m0, s70, 21504
    s_nop 0
    buffer_load_dwordx4 v164, s[24:27], s64 offen lds
    s_mov_b32 s64, 205312
    s_add_u32 m0, s70, 28672
    s_nop 0
    buffer_load_dwordx4 v164, s[24:27], s64 offen lds
    s_mov_b32 s64, 210432
    s_add_u32 m0, s70, 29696
    s_nop 0
    buffer_load_dwordx4 v164, s[24:27], s64 offen lds
    s_mov_b32 s64, 204800
    s_add_u32 m0, s71, 36864
    s_nop 0
    buffer_load_dwordx4 v165, s[24:27], s64 offen lds
    ds_read_b64_tr_b16 a[32:33], v167 offset:0
    ds_read_b64_tr_b16 a[34:35], v167 offset:2048
    ds_read_b64_tr_b16 a[36:37], v167 offset:8
    ds_read_b64_tr_b16 a[38:39], v167 offset:2056
    ds_read_b64_tr_b16 a[40:41], v167 offset:8192
    ds_read_b64_tr_b16 a[42:43], v167 offset:10240
    ds_read_b64_tr_b16 a[44:45], v167 offset:8200
    ds_read_b64_tr_b16 a[46:47], v167 offset:10248
    ds_read_b64_tr_b16 v[220:221], v169 offset:16384
    ds_read_b64_tr_b16 v[222:223], v169 offset:17408
    s_waitcnt lgkmcnt(0)
    ds_write_b128 v242, v[220:223] offset:2048
    s_waitcnt vmcnt(10)
    s_waitcnt lgkmcnt(0)
    s_barrier
    s_mov_b32 s64, 245760
    s_add_u32 m0, s70, 40960
    s_nop 0
    buffer_load_dwordx4 v164, s[24:27], s64 offen lds
    s_mov_b32 s64, 250880
    s_add_u32 m0, s70, 41984
    s_nop 0
    buffer_load_dwordx4 v164, s[24:27], s64 offen lds
    s_mov_b32 s64, 246272
    s_add_u32 m0, s70, 49152
    s_nop 0
    buffer_load_dwordx4 v164, s[24:27], s64 offen lds
    s_mov_b32 s64, 251392
    s_add_u32 m0, s70, 50176
    s_nop 0
    buffer_load_dwordx4 v164, s[24:27], s64 offen lds
    s_mov_b32 s64, 245760
    s_add_u32 m0, s71, 57344
    s_nop 0
    buffer_load_dwordx4 v165, s[24:27], s64 offen lds
    ds_read_b64_tr_b16 a[48:49], v167 offset:20480
    ds_read_b64_tr_b16 a[50:51], v167 offset:22528
    ds_read_b64_tr_b16 a[52:53], v167 offset:20488
    ds_read_b64_tr_b16 a[54:55], v167 offset:22536
    ds_read_b64_tr_b16 a[56:57], v167 offset:28672
    ds_read_b64_tr_b16 a[58:59], v167 offset:30720
    ds_read_b64_tr_b16 a[60:61], v167 offset:28680
    ds_read_b64_tr_b16 a[62:63], v167 offset:30728
    ds_read_b64_tr_b16 v[224:225], v169 offset:36864
    ds_read_b64_tr_b16 v[226:227], v169 offset:37888
    s_waitcnt lgkmcnt(0)
    ds_write_b128 v242, v[224:227] offset:3072
    s_waitcnt vmcnt(10)
    s_waitcnt lgkmcnt(0)
    s_barrier
    s_mov_b32 s64, 286720
    s_add_u32 m0, s70, 61440
    s_nop 0
    buffer_load_dwordx4 v164, s[24:27], s64 offen lds
    s_mov_b32 s64, 291840
    s_add_u32 m0, s70, 62464
    s_nop 0
    buffer_load_dwordx4 v164, s[24:27], s64 offen lds
    s_mov_b32 s64, 287232
    s_add_u32 m0, s70, 69632
    s_nop 0
    buffer_load_dwordx4 v164, s[24:27], s64 offen lds
    s_mov_b32 s64, 292352
    s_add_u32 m0, s70, 70656
    s_nop 0
    buffer_load_dwordx4 v164, s[24:27], s64 offen lds
    s_mov_b32 s64, 286720
    s_add_u32 m0, s71, 77824
    s_nop 0
    buffer_load_dwordx4 v165, s[24:27], s64 offen lds
    ds_read_b64_tr_b16 a[64:65], v166 offset:0
    ds_read_b64_tr_b16 a[66:67], v166 offset:2048
    ds_read_b64_tr_b16 a[68:69], v166 offset:8
    ds_read_b64_tr_b16 a[70:71], v166 offset:2056
    ds_read_b64_tr_b16 a[72:73], v166 offset:8192
    ds_read_b64_tr_b16 a[74:75], v166 offset:10240
    ds_read_b64_tr_b16 a[76:77], v166 offset:8200
    ds_read_b64_tr_b16 a[78:79], v166 offset:10248
    ds_read_b64_tr_b16 v[220:221], v168 offset:16384
    ds_read_b64_tr_b16 v[222:223], v168 offset:17408
    s_waitcnt lgkmcnt(0)
    ds_write_b128 v242, v[220:223] offset:4096
    s_waitcnt vmcnt(10)
    s_waitcnt lgkmcnt(0)
    s_barrier
    s_mov_b32 s64, 327680
    s_add_u32 m0, s70, 0
    s_nop 0
    buffer_load_dwordx4 v164, s[24:27], s64 offen lds
    s_mov_b32 s64, 332800
    s_add_u32 m0, s70, 1024
    s_nop 0
    buffer_load_dwordx4 v164, s[24:27], s64 offen lds
    s_mov_b32 s64, 328192
    s_add_u32 m0, s70, 8192
    s_nop 0
    buffer_load_dwordx4 v164, s[24:27], s64 offen lds
    s_mov_b32 s64, 333312
    s_add_u32 m0, s70, 9216
    s_nop 0
    buffer_load_dwordx4 v164, s[24:27], s64 offen lds
    s_mov_b32 s64, 327680
    s_add_u32 m0, s71, 16384
    s_nop 0
    buffer_load_dwordx4 v165, s[24:27], s64 offen lds
    ds_read_b64_tr_b16 a[80:81], v166 offset:20480
    ds_read_b64_tr_b16 a[82:83], v166 offset:22528
    ds_read_b64_tr_b16 a[84:85], v166 offset:20488
    ds_read_b64_tr_b16 a[86:87], v166 offset:22536
    ds_read_b64_tr_b16 a[88:89], v166 offset:28672
    ds_read_b64_tr_b16 a[90:91], v166 offset:30720
    ds_read_b64_tr_b16 a[92:93], v166 offset:28680
    ds_read_b64_tr_b16 a[94:95], v166 offset:30728
    ds_read_b64_tr_b16 v[224:225], v168 offset:36864
    ds_read_b64_tr_b16 v[226:227], v168 offset:37888
    s_waitcnt lgkmcnt(0)
    ds_write_b128 v242, v[224:227] offset:5120
    s_waitcnt vmcnt(10)
    s_waitcnt lgkmcnt(0)
    s_barrier
    s_mov_b32 s64, 368640
    s_add_u32 m0, s70, 20480
    s_nop 0
    buffer_load_dwordx4 v164, s[24:27], s64 offen lds
    s_mov_b32 s64, 373760
    s_add_u32 m0, s70, 21504
    s_nop 0
    buffer_load_dwordx4 v164, s[24:27], s64 offen lds
    s_mov_b32 s64, 369152
    s_add_u32 m0, s70, 28672
    s_nop 0
    buffer_load_dwordx4 v164, s[24:27], s64 offen lds
    s_mov_b32 s64, 374272
    s_add_u32 m0, s70, 29696
    s_nop 0
    buffer_load_dwordx4 v164, s[24:27], s64 offen lds
    s_mov_b32 s64, 368640
    s_add_u32 m0, s71, 36864
    s_nop 0
    buffer_load_dwordx4 v165, s[24:27], s64 offen lds
    ds_read_b64_tr_b16 a[96:97], v167 offset:0
    ds_read_b64_tr_b16 a[98:99], v167 offset:2048
    ds_read_b64_tr_b16 a[100:101], v167 offset:8
    ds_read_b64_tr_b16 a[102:103], v167 offset:2056
    ds_read_b64_tr_b16 a[104:105], v167 offset:8192
    ds_read_b64_tr_b16 a[106:107], v167 offset:10240
    ds_read_b64_tr_b16 a[108:109], v167 offset:8200
    ds_read_b64_tr_b16 a[110:111], v167 offset:10248
    ds_read_b64_tr_b16 v[220:221], v169 offset:16384
    ds_read_b64_tr_b16 v[222:223], v169 offset:17408
    s_waitcnt lgkmcnt(0)
    ds_write_b128 v242, v[220:223] offset:6144
    s_waitcnt vmcnt(10)
    s_waitcnt lgkmcnt(0)
    s_barrier
    s_mov_b32 s64, 409600
    s_add_u32 m0, s70, 40960
    s_nop 0
    buffer_load_dwordx4 v164, s[24:27], s64 offen lds
    s_mov_b32 s64, 414720
    s_add_u32 m0, s70, 41984
    s_nop 0
    buffer_load_dwordx4 v164, s[24:27], s64 offen lds
    s_mov_b32 s64, 410112
    s_add_u32 m0, s70, 49152
    s_nop 0
    buffer_load_dwordx4 v164, s[24:27], s64 offen lds
    s_mov_b32 s64, 415232
    s_add_u32 m0, s70, 50176
    s_nop 0
    buffer_load_dwordx4 v164, s[24:27], s64 offen lds
    s_mov_b32 s64, 409600
    s_add_u32 m0, s71, 57344
    s_nop 0
    buffer_load_dwordx4 v165, s[24:27], s64 offen lds
    ds_read_b64_tr_b16 a[112:113], v167 offset:20480
    ds_read_b64_tr_b16 a[114:115], v167 offset:22528
    ds_read_b64_tr_b16 a[116:117], v167 offset:20488
    ds_read_b64_tr_b16 a[118:119], v167 offset:22536
    ds_read_b64_tr_b16 a[120:121], v167 offset:28672
    ds_read_b64_tr_b16 a[122:123], v167 offset:30720
    ds_read_b64_tr_b16 a[124:125], v167 offset:28680
    ds_read_b64_tr_b16 a[126:127], v167 offset:30728
    ds_read_b64_tr_b16 v[224:225], v169 offset:36864
    ds_read_b64_tr_b16 v[226:227], v169 offset:37888
    s_waitcnt lgkmcnt(0)
    ds_write_b128 v242, v[224:227] offset:7168
    s_waitcnt vmcnt(10)
    s_waitcnt lgkmcnt(0)
    s_barrier
    s_mov_b32 s64, 450560
    s_add_u32 m0, s70, 61440
    s_nop 0
    buffer_load_dwordx4 v164, s[24:27], s64 offen lds
    s_mov_b32 s64, 455680
    s_add_u32 m0, s70, 62464
    s_nop 0
    buffer_load_dwordx4 v164, s[24:27], s64 offen lds
    s_mov_b32 s64, 451072
    s_add_u32 m0, s70, 69632
    s_nop 0
    buffer_load_dwordx4 v164, s[24:27], s64 offen lds
    s_mov_b32 s64, 456192
    s_add_u32 m0, s70, 70656
    s_nop 0
    buffer_load_dwordx4 v164, s[24:27], s64 offen lds
    s_mov_b32 s64, 450560
    s_add_u32 m0, s71, 77824
    s_nop 0
    buffer_load_dwordx4 v165, s[24:27], s64 offen lds
    ds_read_b64_tr_b16 a[128:129], v166 offset:0
    ds_read_b64_tr_b16 a[130:131], v166 offset:2048
    ds_read_b64_tr_b16 a[132:133], v166 offset:8
    ds_read_b64_tr_b16 a[134:135], v166 offset:2056
    ds_read_b64_tr_b16 a[136:137], v166 offset:8192
    ds_read_b64_tr_b16 a[138:139], v166 offset:10240
    ds_read_b64_tr_b16 a[140:141], v166 offset:8200
    ds_read_b64_tr_b16 a[142:143], v166 offset:10248
    ds_read_b64_tr_b16 v[220:221], v168 offset:16384
    ds_read_b64_tr_b16 v[222:223], v168 offset:17408
    s_waitcnt lgkmcnt(0)
    ds_write_b128 v242, v[220:223] offset:8192
    s_waitcnt vmcnt(10)
    s_waitcnt lgkmcnt(0)
    s_barrier
    s_mov_b32 s64, 491520
    s_add_u32 m0, s70, 0
    s_nop 0
    buffer_load_dwordx4 v164, s[24:27], s64 offen lds
    s_mov_b32 s64, 496640
    s_add_u32 m0, s70, 1024
    s_nop 0
    buffer_load_dwordx4 v164, s[24:27], s64 offen lds
    s_mov_b32 s64, 492032
    s_add_u32 m0, s70, 8192
    s_nop 0
    buffer_load_dwordx4 v164, s[24:27], s64 offen lds
    s_mov_b32 s64, 497152
    s_add_u32 m0, s70, 9216
    s_nop 0
    buffer_load_dwordx4 v164, s[24:27], s64 offen lds
    s_mov_b32 s64, 491520
    s_add_u32 m0, s71, 16384
    s_nop 0
    buffer_load_dwordx4 v165, s[24:27], s64 offen lds
    ds_read_b64_tr_b16 a[144:145], v166 offset:20480
    ds_read_b64_tr_b16 a[146:147], v166 offset:22528
    ds_read_b64_tr_b16 a[148:149], v166 offset:20488
    ds_read_b64_tr_b16 a[150:151], v166 offset:22536
    ds_read_b64_tr_b16 a[152:153], v166 offset:28672
    ds_read_b64_tr_b16 a[154:155], v166 offset:30720
    ds_read_b64_tr_b16 a[156:157], v166 offset:28680
    ds_read_b64_tr_b16 a[158:159], v166 offset:30728
    ds_read_b64_tr_b16 v[224:225], v168 offset:36864
    ds_read_b64_tr_b16 v[226:227], v168 offset:37888
    s_waitcnt lgkmcnt(0)
    ds_write_b128 v242, v[224:227] offset:9216
    s_waitcnt vmcnt(10)
    s_waitcnt lgkmcnt(0)
    s_barrier
    s_mov_b32 s64, 532480
    s_add_u32 m0, s70, 20480
    s_nop 0
    buffer_load_dwordx4 v164, s[24:27], s64 offen lds
    s_mov_b32 s64, 537600
    s_add_u32 m0, s70, 21504
    s_nop 0
    buffer_load_dwordx4 v164, s[24:27], s64 offen lds
    s_mov_b32 s64, 532992
    s_add_u32 m0, s70, 28672
    s_nop 0
    buffer_load_dwordx4 v164, s[24:27], s64 offen lds
    s_mov_b32 s64, 538112
    s_add_u32 m0, s70, 29696
    s_nop 0
    buffer_load_dwordx4 v164, s[24:27], s64 offen lds
    s_mov_b32 s64, 532480
    s_add_u32 m0, s71, 36864
    s_nop 0
    buffer_load_dwordx4 v165, s[24:27], s64 offen lds
    ds_read_b64_tr_b16 a[160:161], v167 offset:0
    ds_read_b64_tr_b16 a[162:163], v167 offset:2048
    ds_read_b64_tr_b16 a[164:165], v167 offset:8
    ds_read_b64_tr_b16 a[166:167], v167 offset:2056
    ds_read_b64_tr_b16 a[168:169], v167 offset:8192
    ds_read_b64_tr_b16 a[170:171], v167 offset:10240
    ds_read_b64_tr_b16 a[172:173], v167 offset:8200
    ds_read_b64_tr_b16 a[174:175], v167 offset:10248
    ds_read_b64_tr_b16 v[220:221], v169 offset:16384
    ds_read_b64_tr_b16 v[222:223], v169 offset:17408
    s_waitcnt lgkmcnt(0)
    ds_write_b128 v242, v[220:223] offset:10240
    s_waitcnt vmcnt(10)
    s_waitcnt lgkmcnt(0)
    s_barrier
    s_mov_b32 s64, 573440
    s_add_u32 m0, s70, 40960
    s_nop 0
    buffer_load_dwordx4 v164, s[24:27], s64 offen lds
    s_mov_b32 s64, 578560
    s_add_u32 m0, s70, 41984
    s_nop 0
    buffer_load_dwordx4 v164, s[24:27], s64 offen lds
    s_mov_b32 s64, 573952
    s_add_u32 m0, s70, 49152
    s_nop 0
    buffer_load_dwordx4 v164, s[24:27], s64 offen lds
    s_mov_b32 s64, 579072
    s_add_u32 m0, s70, 50176
    s_nop 0
    buffer_load_dwordx4 v164, s[24:27], s64 offen lds
    s_mov_b32 s64, 573440
    s_add_u32 m0, s71, 57344
    s_nop 0
    buffer_load_dwordx4 v165, s[24:27], s64 offen lds
    ds_read_b64_tr_b16 a[176:177], v167 offset:20480
    ds_read_b64_tr_b16 a[178:179], v167 offset:22528
    ds_read_b64_tr_b16 a[180:181], v167 offset:20488
    ds_read_b64_tr_b16 a[182:183], v167 offset:22536
    ds_read_b64_tr_b16 a[184:185], v167 offset:28672
    ds_read_b64_tr_b16 a[186:187], v167 offset:30720
    ds_read_b64_tr_b16 a[188:189], v167 offset:28680
    ds_read_b64_tr_b16 a[190:191], v167 offset:30728
    ds_read_b64_tr_b16 v[224:225], v169 offset:36864
    ds_read_b64_tr_b16 v[226:227], v169 offset:37888
    s_waitcnt lgkmcnt(0)
    ds_write_b128 v242, v[224:227] offset:11264
    s_waitcnt vmcnt(10)
    s_waitcnt lgkmcnt(0)
    s_barrier
    s_mov_b32 s64, 614400
    s_add_u32 m0, s70, 61440
    s_nop 0
    buffer_load_dwordx4 v164, s[24:27], s64 offen lds
    s_mov_b32 s64, 619520
    s_add_u32 m0, s70, 62464
    s_nop 0
    buffer_load_dwordx4 v164, s[24:27], s64 offen lds
    s_mov_b32 s64, 614912
    s_add_u32 m0, s70, 69632
    s_nop 0
    buffer_load_dwordx4 v164, s[24:27], s64 offen lds
    s_mov_b32 s64, 620032
    s_add_u32 m0, s70, 70656
    s_nop 0
    buffer_load_dwordx4 v164, s[24:27], s64 offen lds
    s_mov_b32 s64, 614400
    s_add_u32 m0, s71, 77824
    s_nop 0
    buffer_load_dwordx4 v165, s[24:27], s64 offen lds
    ds_read_b64_tr_b16 a[192:193], v166 offset:0
    ds_read_b64_tr_b16 a[194:195], v166 offset:2048
    ds_read_b64_tr_b16 a[196:197], v166 offset:8
    ds_read_b64_tr_b16 a[198:199], v166 offset:2056
    ds_read_b64_tr_b16 a[200:201], v166 offset:8192
    ds_read_b64_tr_b16 a[202:203], v166 offset:10240
    ds_read_b64_tr_b16 a[204:205], v166 offset:8200
    ds_read_b64_tr_b16 a[206:207], v166 offset:10248
    ds_read_b64_tr_b16 v[220:221], v168 offset:16384
    ds_read_b64_tr_b16 v[222:223], v168 offset:17408
    s_waitcnt lgkmcnt(0)
    ds_write_b128 v242, v[220:223] offset:12288
    s_waitcnt vmcnt(10)
    s_waitcnt lgkmcnt(0)
    s_barrier
    s_mov_b32 s64, 655360
    s_add_u32 m0, s70, 0
    s_nop 0
    buffer_load_dwordx4 v164, s[24:27], s64 offen lds
    s_mov_b32 s64, 660480
    s_add_u32 m0, s70, 1024
    s_nop 0
    buffer_load_dwordx4 v164, s[24:27], s64 offen lds
    s_mov_b32 s64, 655872
    s_add_u32 m0, s70, 8192
    s_nop 0
    buffer_load_dwordx4 v164, s[24:27], s64 offen lds
    s_mov_b32 s64, 660992
    s_add_u32 m0, s70, 9216
    s_nop 0
    buffer_load_dwordx4 v164, s[24:27], s64 offen lds
    s_mov_b32 s64, 655360
    s_add_u32 m0, s71, 16384
    s_nop 0
    buffer_load_dwordx4 v165, s[24:27], s64 offen lds
    ds_read_b64_tr_b16 a[208:209], v166 offset:20480
    ds_read_b64_tr_b16 a[210:211], v166 offset:22528
    ds_read_b64_tr_b16 a[212:213], v166 offset:20488
    ds_read_b64_tr_b16 a[214:215], v166 offset:22536
    ds_read_b64_tr_b16 a[216:217], v166 offset:28672
    ds_read_b64_tr_b16 a[218:219], v166 offset:30720
    ds_read_b64_tr_b16 a[220:221], v166 offset:28680
    ds_read_b64_tr_b16 a[222:223], v166 offset:30728
    ds_read_b64_tr_b16 v[224:225], v168 offset:36864
    ds_read_b64_tr_b16 v[226:227], v168 offset:37888
    s_waitcnt lgkmcnt(0)
    ds_write_b128 v242, v[224:227] offset:13312
    s_waitcnt vmcnt(10)
    s_waitcnt lgkmcnt(0)
    s_barrier
    s_mov_b32 s64, 696320
    s_add_u32 m0, s70, 20480
    s_nop 0
    buffer_load_dwordx4 v164, s[24:27], s64 offen lds
    s_mov_b32 s64, 701440
    s_add_u32 m0, s70, 21504
    s_nop 0
    buffer_load_dwordx4 v164, s[24:27], s64 offen lds
    s_mov_b32 s64, 696832
    s_add_u32 m0, s70, 28672
    s_nop 0
    buffer_load_dwordx4 v164, s[24:27], s64 offen lds
    s_mov_b32 s64, 701952
    s_add_u32 m0, s70, 29696
    s_nop 0
    buffer_load_dwordx4 v164, s[24:27], s64 offen lds
    s_mov_b32 s64, 696320
    s_add_u32 m0, s71, 36864
    s_nop 0
    buffer_load_dwordx4 v165, s[24:27], s64 offen lds
    ds_read_b64_tr_b16 a[224:225], v167 offset:0
    ds_read_b64_tr_b16 a[226:227], v167 offset:2048
    ds_read_b64_tr_b16 a[228:229], v167 offset:8
    ds_read_b64_tr_b16 a[230:231], v167 offset:2056
    ds_read_b64_tr_b16 a[232:233], v167 offset:8192
    ds_read_b64_tr_b16 a[234:235], v167 offset:10240
    ds_read_b64_tr_b16 a[236:237], v167 offset:8200
    ds_read_b64_tr_b16 a[238:239], v167 offset:10248
    ds_read_b64_tr_b16 v[220:221], v169 offset:16384
    ds_read_b64_tr_b16 v[222:223], v169 offset:17408
    s_waitcnt lgkmcnt(0)
    ds_write_b128 v242, v[220:223] offset:14336
    s_waitcnt vmcnt(10)
    s_waitcnt lgkmcnt(0)
    s_barrier
    s_mov_b32 s64, 737280
    s_add_u32 m0, s70, 40960
    s_nop 0
    buffer_load_dwordx4 v164, s[24:27], s64 offen lds
    s_mov_b32 s64, 742400
    s_add_u32 m0, s70, 41984
    s_nop 0
    buffer_load_dwordx4 v164, s[24:27], s64 offen lds
    s_mov_b32 s64, 737792
    s_add_u32 m0, s70, 49152
    s_nop 0
    buffer_load_dwordx4 v164, s[24:27], s64 offen lds
    s_mov_b32 s64, 742912
    s_add_u32 m0, s70, 50176
    s_nop 0
    buffer_load_dwordx4 v164, s[24:27], s64 offen lds
    s_mov_b32 s64, 737280
    s_add_u32 m0, s71, 57344
    s_nop 0
    buffer_load_dwordx4 v165, s[24:27], s64 offen lds
    ds_read_b64_tr_b16 a[240:241], v167 offset:20480
    ds_read_b64_tr_b16 a[242:243], v167 offset:22528
    ds_read_b64_tr_b16 a[244:245], v167 offset:20488
    ds_read_b64_tr_b16 a[246:247], v167 offset:22536
    ds_read_b64_tr_b16 a[248:249], v167 offset:28672
    ds_read_b64_tr_b16 a[250:251], v167 offset:30720
    ds_read_b64_tr_b16 a[252:253], v167 offset:28680
    ds_read_b64_tr_b16 a[254:255], v167 offset:30728
    ds_read_b64_tr_b16 v[224:225], v169 offset:36864
    ds_read_b64_tr_b16 v[226:227], v169 offset:37888
    s_waitcnt lgkmcnt(0)
    ds_write_b128 v242, v[224:227] offset:15360
    s_waitcnt vmcnt(10)
    s_waitcnt lgkmcnt(0)
    s_barrier
    s_mov_b32 s64, 778240
    s_add_u32 m0, s70, 61440
    s_nop 0
    buffer_load_dwordx4 v164, s[24:27], s64 offen lds
    s_mov_b32 s64, 783360
    s_add_u32 m0, s70, 62464
    s_nop 0
    buffer_load_dwordx4 v164, s[24:27], s64 offen lds
    s_mov_b32 s64, 778752
    s_add_u32 m0, s70, 69632
    s_nop 0
    buffer_load_dwordx4 v164, s[24:27], s64 offen lds
    s_mov_b32 s64, 783872
    s_add_u32 m0, s70, 70656
    s_nop 0
    buffer_load_dwordx4 v164, s[24:27], s64 offen lds
    s_mov_b32 s64, 778240
    s_add_u32 m0, s71, 77824
    s_nop 0
    buffer_load_dwordx4 v165, s[24:27], s64 offen lds
    ds_read_b64_tr_b16 v[4:5], v166 offset:0
    ds_read_b64_tr_b16 v[6:7], v166 offset:2048
    ds_read_b64_tr_b16 v[8:9], v166 offset:8
    ds_read_b64_tr_b16 v[10:11], v166 offset:2056
    ds_read_b64_tr_b16 v[12:13], v166 offset:8192
    ds_read_b64_tr_b16 v[14:15], v166 offset:10240
    ds_read_b64_tr_b16 v[16:17], v166 offset:8200
    ds_read_b64_tr_b16 v[18:19], v166 offset:10248
    ds_read_b64_tr_b16 v[132:133], v168 offset:16384
    ds_read_b64_tr_b16 v[134:135], v168 offset:17408
    s_waitcnt vmcnt(10)
    s_waitcnt lgkmcnt(0)
    s_barrier
    s_mov_b32 s64, 819200
    s_add_u32 m0, s70, 0
    s_nop 0
    buffer_load_dwordx4 v164, s[24:27], s64 offen lds
    s_mov_b32 s64, 824320
    s_add_u32 m0, s70, 1024
    s_nop 0
    buffer_load_dwordx4 v164, s[24:27], s64 offen lds
    s_mov_b32 s64, 819712
    s_add_u32 m0, s70, 8192
    s_nop 0
    buffer_load_dwordx4 v164, s[24:27], s64 offen lds
    s_mov_b32 s64, 824832
    s_add_u32 m0, s70, 9216
    s_nop 0
    buffer_load_dwordx4 v164, s[24:27], s64 offen lds
    s_mov_b32 s64, 819200
    s_add_u32 m0, s71, 16384
    s_nop 0
    buffer_load_dwordx4 v165, s[24:27], s64 offen lds
    ds_read_b64_tr_b16 v[20:21], v166 offset:20480
    ds_read_b64_tr_b16 v[22:23], v166 offset:22528
    ds_read_b64_tr_b16 v[24:25], v166 offset:20488
    ds_read_b64_tr_b16 v[26:27], v166 offset:22536
    ds_read_b64_tr_b16 v[28:29], v166 offset:28672
    ds_read_b64_tr_b16 v[30:31], v166 offset:30720
    ds_read_b64_tr_b16 v[32:33], v166 offset:28680
    ds_read_b64_tr_b16 v[34:35], v166 offset:30728
    ds_read_b64_tr_b16 v[136:137], v168 offset:36864
    ds_read_b64_tr_b16 v[138:139], v168 offset:37888
    s_waitcnt vmcnt(10)
    s_waitcnt lgkmcnt(0)
    s_barrier
    s_mov_b32 s64, 860160
    s_add_u32 m0, s70, 20480
    s_nop 0
    buffer_load_dwordx4 v164, s[24:27], s64 offen lds
    s_mov_b32 s64, 865280
    s_add_u32 m0, s70, 21504
    s_nop 0
    buffer_load_dwordx4 v164, s[24:27], s64 offen lds
    s_mov_b32 s64, 860672
    s_add_u32 m0, s70, 28672
    s_nop 0
    buffer_load_dwordx4 v164, s[24:27], s64 offen lds
    s_mov_b32 s64, 865792
    s_add_u32 m0, s70, 29696
    s_nop 0
    buffer_load_dwordx4 v164, s[24:27], s64 offen lds
    s_mov_b32 s64, 860160
    s_add_u32 m0, s71, 36864
    s_nop 0
    buffer_load_dwordx4 v165, s[24:27], s64 offen lds
    ds_read_b64_tr_b16 v[36:37], v167 offset:0
    ds_read_b64_tr_b16 v[38:39], v167 offset:2048
    ds_read_b64_tr_b16 v[40:41], v167 offset:8
    ds_read_b64_tr_b16 v[42:43], v167 offset:2056
    ds_read_b64_tr_b16 v[44:45], v167 offset:8192
    ds_read_b64_tr_b16 v[46:47], v167 offset:10240
    ds_read_b64_tr_b16 v[48:49], v167 offset:8200
    ds_read_b64_tr_b16 v[50:51], v167 offset:10248
    ds_read_b64_tr_b16 v[140:141], v169 offset:16384
    ds_read_b64_tr_b16 v[142:143], v169 offset:17408
    s_waitcnt vmcnt(10)
    s_waitcnt lgkmcnt(0)
    s_barrier
    s_mov_b32 s64, 901120
    s_add_u32 m0, s70, 40960
    s_nop 0
    buffer_load_dwordx4 v164, s[24:27], s64 offen lds
    s_mov_b32 s64, 906240
    s_add_u32 m0, s70, 41984
    s_nop 0
    buffer_load_dwordx4 v164, s[24:27], s64 offen lds
    s_mov_b32 s64, 901632
    s_add_u32 m0, s70, 49152
    s_nop 0
    buffer_load_dwordx4 v164, s[24:27], s64 offen lds
    s_mov_b32 s64, 906752
    s_add_u32 m0, s70, 50176
    s_nop 0
    buffer_load_dwordx4 v164, s[24:27], s64 offen lds
    s_mov_b32 s64, 901120
    s_add_u32 m0, s71, 57344
    s_nop 0
    buffer_load_dwordx4 v165, s[24:27], s64 offen lds
    ds_read_b64_tr_b16 v[52:53], v167 offset:20480
    ds_read_b64_tr_b16 v[54:55], v167 offset:22528
    ds_read_b64_tr_b16 v[56:57], v167 offset:20488
    ds_read_b64_tr_b16 v[58:59], v167 offset:22536
    ds_read_b64_tr_b16 v[60:61], v167 offset:28672
    ds_read_b64_tr_b16 v[62:63], v167 offset:30720
    ds_read_b64_tr_b16 v[64:65], v167 offset:28680
    ds_read_b64_tr_b16 v[66:67], v167 offset:30728
    ds_read_b64_tr_b16 v[144:145], v169 offset:36864
    ds_read_b64_tr_b16 v[146:147], v169 offset:37888
    s_waitcnt vmcnt(10)
    s_waitcnt lgkmcnt(0)
    s_barrier
    s_mov_b32 s64, 942080
    s_add_u32 m0, s70, 61440
    s_nop 0
    buffer_load_dwordx4 v164, s[24:27], s64 offen lds
    s_mov_b32 s64, 947200
    s_add_u32 m0, s70, 62464
    s_nop 0
    buffer_load_dwordx4 v164, s[24:27], s64 offen lds
    s_mov_b32 s64, 942592
    s_add_u32 m0, s70, 69632
    s_nop 0
    buffer_load_dwordx4 v164, s[24:27], s64 offen lds
    s_mov_b32 s64, 947712
    s_add_u32 m0, s70, 70656
    s_nop 0
    buffer_load_dwordx4 v164, s[24:27], s64 offen lds
    s_mov_b32 s64, 942080
    s_add_u32 m0, s71, 77824
    s_nop 0
    buffer_load_dwordx4 v165, s[24:27], s64 offen lds
    ds_read_b64_tr_b16 v[68:69], v166 offset:0
    ds_read_b64_tr_b16 v[70:71], v166 offset:2048
    ds_read_b64_tr_b16 v[72:73], v166 offset:8
    ds_read_b64_tr_b16 v[74:75], v166 offset:2056
    ds_read_b64_tr_b16 v[76:77], v166 offset:8192
    ds_read_b64_tr_b16 v[78:79], v166 offset:10240
    ds_read_b64_tr_b16 v[80:81], v166 offset:8200
    ds_read_b64_tr_b16 v[82:83], v166 offset:10248
    ds_read_b64_tr_b16 v[148:149], v168 offset:16384
    ds_read_b64_tr_b16 v[150:151], v168 offset:17408
    s_waitcnt vmcnt(10)
    s_waitcnt lgkmcnt(0)
    s_barrier
    ds_read_b64_tr_b16 v[84:85], v166 offset:20480
    ds_read_b64_tr_b16 v[86:87], v166 offset:22528
    ds_read_b64_tr_b16 v[88:89], v166 offset:20488
    ds_read_b64_tr_b16 v[90:91], v166 offset:22536
    ds_read_b64_tr_b16 v[92:93], v166 offset:28672
    ds_read_b64_tr_b16 v[94:95], v166 offset:30720
    ds_read_b64_tr_b16 v[96:97], v166 offset:28680
    ds_read_b64_tr_b16 v[98:99], v166 offset:30728
    ds_read_b64_tr_b16 v[152:153], v168 offset:36864
    ds_read_b64_tr_b16 v[154:155], v168 offset:37888
    s_waitcnt vmcnt(5)
    s_waitcnt lgkmcnt(0)
    s_barrier
    ds_read_b64_tr_b16 v[100:101], v167 offset:0
    ds_read_b64_tr_b16 v[102:103], v167 offset:2048
    ds_read_b64_tr_b16 v[104:105], v167 offset:8
    ds_read_b64_tr_b16 v[106:107], v167 offset:2056
    ds_read_b64_tr_b16 v[108:109], v167 offset:8192
    ds_read_b64_tr_b16 v[110:111], v167 offset:10240
    ds_read_b64_tr_b16 v[112:113], v167 offset:8200
    ds_read_b64_tr_b16 v[114:115], v167 offset:10248
    ds_read_b64_tr_b16 v[156:157], v169 offset:16384
    ds_read_b64_tr_b16 v[158:159], v169 offset:17408
    s_waitcnt vmcnt(0)
    s_waitcnt lgkmcnt(0)
    s_barrier
    ds_read_b64_tr_b16 v[116:117], v167 offset:20480
    ds_read_b64_tr_b16 v[118:119], v167 offset:22528
    ds_read_b64_tr_b16 v[120:121], v167 offset:20488
    ds_read_b64_tr_b16 v[122:123], v167 offset:22536
    ds_read_b64_tr_b16 v[124:125], v167 offset:28672
    ds_read_b64_tr_b16 v[126:127], v167 offset:30720
    ds_read_b64_tr_b16 v[128:129], v167 offset:28680
    ds_read_b64_tr_b16 v[130:131], v167 offset:30728
    ds_read_b64_tr_b16 v[160:161], v169 offset:36864
    ds_read_b64_tr_b16 v[162:163], v169 offset:37888
    v_and_b32 v164, 15, v1
    v_lshrrev_b32 v165, 4, v1
    v_lshlrev_b32 v244, 5, v164
    v_lshl_add_u32 v244, v165, 3, v244
    v_lshlrev_b32 v243, 1, v244
    s_lshl_b32 s64, s74, 2
    s_add_u32 s64, s64, s60
    s_mul_i32 s64, s64, 5120
    v_add_u32 v243, s64, v243
    s_add_u32 s64, s64, 4096
    v_add_u32 v244, s64, v244
    v_min_u32 v245, 11, v1
    s_and_b32 s64, s75, 1
    s_mul_i32 s64, s64, 12
    s_lshl_b32 s65, s58, 5
    s_add_u32 s64, s64, s65
    v_add_u32 v245, s64, v245
    v_lshlrev_b32 v245, 7, v245
    v_add_u32 v245, 8388608, v245
    s_lshl_b32 s64, s68, 9
    s_add_u32 s64, s64, s75
    s_mul_i32 s70, s64, 49152
    s_add_u32 s70, s70, 41943040
    s_mul_i32 s71, s64, 40960
    s_add_u32 s71, s71, 92274688
    s_lshl_b32 s72, s60, 10
    s_mov_b32 s73, 0
    v_mov_b32 v3, 20
    buffer_load_dword v2, v3, s[8:11], 0 offen sc1
Lgchk_36:
    s_waitcnt vmcnt(0)
    v_cmp_gt_u32 vcc, 256, v2
    s_cbranch_vccnz Lgrty_37
    s_waitcnt lgkmcnt(0)
    s_barrier
L_Tseg:
    s_cmp_lg_u32 s73, 0
    s_cbranch_scc1 L_Thave
    s_add_u32 s65, s62, 1
    buffer_load_dwordx4 v[246:249], v245, s[4:7], 0 offen sc1
Lfchk_38:
    s_waitcnt vmcnt(0)
    v_min3_u32 v228, v246, v247, v248
    v_min_u32 v228, v228, v249
    v_cmp_gt_u32 vcc, s65, v228
    s_cbranch_vccnz Lfrty_39
    s_add_u32 m0, s72, 0
    s_add_u32 s64, s70, 0
    buffer_load_dwordx4 v240, s[4:7], s64 offen sc1 lds
    s_add_u32 m0, s72, 24576
    s_add_u32 s64, s70, 24576
    buffer_load_dwordx4 v240, s[4:7], s64 offen sc1 lds
    s_add_u32 m0, s72, 4096
    s_add_u32 s64, s70, 4096
    buffer_load_dwordx4 v240, s[4:7], s64 offen sc1 lds
    s_add_u32 m0, s72, 28672
    s_add_u32 s64, s70, 28672
    buffer_load_dwordx4 v240, s[4:7], s64 offen sc1 lds
    s_add_u32 m0, s72, 8192
    s_add_u32 s64, s70, 8192
    buffer_load_dwordx4 v240, s[4:7], s64 offen sc1 lds
    s_add_u32 m0, s72, 32768
    s_add_u32 s64, s70, 32768
    buffer_load_dwordx4 v240, s[4:7], s64 offen sc1 lds
    s_add_u32 m0, s72, 12288
    s_add_u32 s64, s70, 12288
    buffer_load_dwordx4 v240, s[4:7], s64 offen sc1 lds
    s_add_u32 m0, s72, 36864
    s_add_u32 s64, s70, 36864
    buffer_load_dwordx4 v240, s[4:7], s64 offen sc1 lds
    s_add_u32 m0, s72, 16384
    s_add_u32 s64, s70, 16384
    buffer_load_dwordx4 v240, s[4:7], s64 offen sc1 lds
    s_add_u32 m0, s72, 40960
    s_add_u32 s64, s70, 40960
    buffer_load_dwordx4 v240, s[4:7], s64 offen sc1 lds
    s_add_u32 m0, s72, 20480
    s_add_u32 s64, s70, 20480
    buffer_load_dwordx4 v240, s[4:7], s64 offen sc1 lds
    s_add_u32 m0, s72, 45056
    s_add_u32 s64, s70, 45056
    buffer_load_dwordx4 v240, s[4:7], s64 offen sc1 lds
    s_add_u32 s70, s70, 393216
    s_xor_b32 s72, s72, 49152
L_Thave:
    s_waitcnt vmcnt(10)
    s_barrier
    ds_read_b128 v[204:207], v241 offset:0
    ds_read_b128 v[208:211], v241 offset:24576
    ds_read_b128 v[220:223], v242 offset:0
    s_waitcnt lgkmcnt(2)
    v_mfma_f32_16x16x32_bf16 v[164:167], a[0:3], v[204:207], 0
    ds_read_b128 v[212:215], v241 offset:1024
    v_mfma_f32_16x16x32_bf16 v[168:171], a[4:7], v[204:207], 0
    ds_read_b128 v[216:219], v241 offset:25600
    v_mfma_f32_16x16x32_bf16 v[172:175], a[8:11], v[204:207], 0
    ds_read_b128 v[224:227], v242 offset:1024
    v_mfma_f32_16x16x32_bf16 v[176:179], a[12:15], v[204:207], 0
    s_waitcnt lgkmcnt(3)
    v_mfma_f32_16x16x32_bf16 v[180:183], v[220:223], v[204:207], 0
    v_mfma_f32_16x16x32_bf16 v[184:187], a[0:3], v[208:211], 0
    v_mfma_f32_16x16x32_bf16 v[188:191], a[4:7], v[208:211], 0
    v_mfma_f32_16x16x32_bf16 v[192:195], a[8:11], v[208:211], 0
    v_mfma_f32_16x16x32_bf16 v[196:199], a[12:15], v[208:211], 0
    v_mfma_f32_16x16x32_bf16 v[200:203], v[220:223], v[208:211], 0
    s_waitcnt lgkmcnt(2)
    v_mfma_f32_16x16x32_bf16 v[164:167], a[16:19], v[212:215], v[164:167]
    ds_read_b128 v[204:207], v241 offset:2048
    v_mfma_f32_16x16x32_bf16 v[168:171], a[20:23], v[212:215], v[168:171]
    ds_read_b128 v[208:211], v241 offset:26624
    v_mfma_f32_16x16x32_bf16 v[172:175], a[24:27], v[212:215], v[172:175]
    ds_read_b128 v[220:223], v242 offset:2048
    v_mfma_f32_16x16x32_bf16 v[176:179], a[28:31], v[212:215], v[176:179]
    s_waitcnt lgkmcnt(3)
    v_mfma_f32_16x16x32_bf16 v[180:183], v[224:227], v[212:215], v[180:183]
    v_mfma_f32_16x16x32_bf16 v[184:187], a[16:19], v[216:219], v[184:187]
    v_mfma_f32_16x16x32_bf16 v[188:191], a[20:23], v[216:219], v[188:191]
    v_mfma_f32_16x16x32_bf16 v[192:195], a[24:27], v[216:219], v[192:195]
    v_mfma_f32_16x16x32_bf16 v[196:199], a[28:31], v[216:219], v[196:199]
    v_mfma_f32_16x16x32_bf16 v[200:203], v[224:227], v[216:219], v[200:203]
    s_waitcnt lgkmcnt(2)
    v_mfma_f32_16x16x32_bf16 v[164:167], a[32:35], v[204:207], v[164:167]
    ds_read_b128 v[212:215], v241 offset:3072
    v_mfma_f32_16x16x32_bf16 v[168:171], a[36:39], v[204:207], v[168:171]
    ds_read_b128 v[216:219], v241 offset:27648
    v_mfma_f32_16x16x32_bf16 v[172:175], a[40:43], v[204:207], v[172:175]
    ds_read_b128 v[224:227], v242 offset:3072
    v_mfma_f32_16x16x32_bf16 v[176:179], a[44:47], v[204:207], v[176:179]
    s_waitcnt lgkmcnt(3)
    v_mfma_f32_16x16x32_bf16 v[180:183], v[220:223], v[204:207], v[180:183]
    v_mfma_f32_16x16x32_bf16 v[184:187], a[32:35], v[208:211], v[184:187]
    v_mfma_f32_16x16x32_bf16 v[188:191], a[36:39], v[208:211], v[188:191]
    v_mfma_f32_16x16x32_bf16 v[192:195], a[40:43], v[208:211], v[192:195]
    v_mfma_f32_16x16x32_bf16 v[196:199], a[44:47], v[208:211], v[196:199]
    v_mfma_f32_16x16x32_bf16 v[200:203], v[220:223], v[208:211], v[200:203]
    s_waitcnt vmcnt(0)
    s_barrier
    s_waitcnt lgkmcnt(2)
    v_mfma_f32_16x16x32_bf16 v[164:167], a[48:51], v[212:215], v[164:167]
    ds_read_b128 v[204:207], v241 offset:4096
    v_mfma_f32_16x16x32_bf16 v[168:171], a[52:55], v[212:215], v[168:171]
    ds_read_b128 v[208:211], v241 offset:28672
    v_mfma_f32_16x16x32_bf16 v[172:175], a[56:59], v[212:215], v[172:175]
    ds_read_b128 v[220:223], v242 offset:4096
    v_mfma_f32_16x16x32_bf16 v[176:179], a[60:63], v[212:215], v[176:179]
    s_waitcnt lgkmcnt(3)
    v_mfma_f32_16x16x32_bf16 v[180:183], v[224:227], v[212:215], v[180:183]
    v_mfma_f32_16x16x32_bf16 v[184:187], a[48:51], v[216:219], v[184:187]
    v_mfma_f32_16x16x32_bf16 v[188:191], a[52:55], v[216:219], v[188:191]
    v_mfma_f32_16x16x32_bf16 v[192:195], a[56:59], v[216:219], v[192:195]
    v_mfma_f32_16x16x32_bf16 v[196:199], a[60:63], v[216:219], v[196:199]
    v_mfma_f32_16x16x32_bf16 v[200:203], v[224:227], v[216:219], v[200:203]
    s_waitcnt lgkmcnt(2)
    v_mfma_f32_16x16x32_bf16 v[164:167], a[64:67], v[204:207], v[164:167]
    ds_read_b128 v[212:215], v241 offset:5120
    v_mfma_f32_16x16x32_bf16 v[168:171], a[68:71], v[204:207], v[168:171]
    ds_read_b128 v[216:219], v241 offset:29696
    v_mfma_f32_16x16x32_bf16 v[172:175], a[72:75], v[204:207], v[172:175]
    ds_read_b128 v[224:227], v242 offset:5120
    v_mfma_f32_16x16x32_bf16 v[176:179], a[76:79], v[204:207], v[176:179]
    s_waitcnt lgkmcnt(3)
    v_mfma_f32_16x16x32_bf16 v[180:183], v[220:223], v[204:207], v[180:183]
    v_mfma_f32_16x16x32_bf16 v[184:187], a[64:67], v[208:211], v[184:187]
    v_mfma_f32_16x16x32_bf16 v[188:191], a[68:71], v[208:211], v[188:191]
    v_mfma_f32_16x16x32_bf16 v[192:195], a[72:75], v[208:211], v[192:195]
    v_mfma_f32_16x16x32_bf16 v[196:199], a[76:79], v[208:211], v[196:199]
    v_mfma_f32_16x16x32_bf16 v[200:203], v[220:223], v[208:211], v[200:203]
    s_waitcnt lgkmcnt(2)
    v_mfma_f32_16x16x32_bf16 v[164:167], a[80:83], v[212:215], v[164:167]
    ds_read_b128 v[204:207], v241 offset:6144
    v_mfma_f32_16x16x32_bf16 v[168:171], a[84:87], v[212:215], v[168:171]
    ds_read_b128 v[208:211], v241 offset:30720
    v_mfma_f32_16x16x32_bf16 v[172:175], a[88:91], v[212:215], v[172:175]
    ds_read_b128 v[220:223], v242 offset:6144
    v_mfma_f32_16x16x32_bf16 v[176:179], a[92:95], v[212:215], v[176:179]
    s_waitcnt lgkmcnt(3)
    v_mfma_f32_16x16x32_bf16 v[180:183], v[224:227], v[212:215], v[180:183]
    v_mfma_f32_16x16x32_bf16 v[184:187], a[80:83], v[216:219], v[184:187]
    v_mfma_f32_16x16x32_bf16 v[188:191], a[84:87], v[216:219], v[188:191]
    v_mfma_f32_16x16x32_bf16 v[192:195], a[88:91], v[216:219], v[192:195]
    v_mfma_f32_16x16x32_bf16 v[196:199], a[92:95], v[216:219], v[196:199]
    v_mfma_f32_16x16x32_bf16 v[200:203], v[224:227], v[216:219], v[200:203]
    s_waitcnt lgkmcnt(2)
    v_mfma_f32_16x16x32_bf16 v[164:167], a[96:99], v[204:207], v[164:167]
    ds_read_b128 v[212:215], v241 offset:7168
    v_mfma_f32_16x16x32_bf16 v[168:171], a[100:103], v[204:207], v[168:171]
    ds_read_b128 v[216:219], v241 offset:31744
    v_mfma_f32_16x16x32_bf16 v[172:175], a[104:107], v[204:207], v[172:175]
    ds_read_b128 v[224:227], v242 offset:7168
    v_mfma_f32_16x16x32_bf16 v[176:179], a[108:111], v[204:207], v[176:179]
    s_waitcnt lgkmcnt(3)
    v_mfma_f32_16x16x32_bf16 v[180:183], v[220:223], v[204:207], v[180:183]
    v_mfma_f32_16x16x32_bf16 v[184:187], a[96:99], v[208:211], v[184:187]
    v_mfma_f32_16x16x32_bf16 v[188:191], a[100:103], v[208:211], v[188:191]
    v_mfma_f32_16x16x32_bf16 v[192:195], a[104:107], v[208:211], v[192:195]
    v_mfma_f32_16x16x32_bf16 v[196:199], a[108:111], v[208:211], v[196:199]
    v_mfma_f32_16x16x32_bf16 v[200:203], v[220:223], v[208:211], v[200:203]
    s_waitcnt lgkmcnt(2)
    v_mfma_f32_16x16x32_bf16 v[164:167], a[112:115], v[212:215], v[164:167]
    ds_read_b128 v[204:207], v241 offset:8192
    v_mfma_f32_16x16x32_bf16 v[168:171], a[116:119], v[212:215], v[168:171]
    ds_read_b128 v[208:211], v241 offset:32768
    v_mfma_f32_16x16x32_bf16 v[172:175], a[120:123], v[212:215], v[172:175]
    ds_read_b128 v[220:223], v242 offset:8192
    v_mfma_f32_16x16x32_bf16 v[176:179], a[124:127], v[212:215], v[176:179]
    s_waitcnt lgkmcnt(3)
    v_mfma_f32_16x16x32_bf16 v[180:183], v[224:227], v[212:215], v[180:183]
    v_mfma_f32_16x16x32_bf16 v[184:187], a[112:115], v[216:219], v[184:187]
    v_mfma_f32_16x16x32_bf16 v[188:191], a[116:119], v[216:219], v[188:191]
    v_mfma_f32_16x16x32_bf16 v[192:195], a[120:123], v[216:219], v[192:195]
    v_mfma_f32_16x16x32_bf16 v[196:199], a[124:127], v[216:219], v[196:199]
    v_mfma_f32_16x16x32_bf16 v[200:203], v[224:227], v[216:219], v[200:203]
    s_waitcnt lgkmcnt(2)
    v_mfma_f32_16x16x32_bf16 v[164:167], a[128:131], v[204:207], v[164:167]
    ds_read_b128 v[212:215], v241 offset:9216
    v_mfma_f32_16x16x32_bf16 v[168:171], a[132:135], v[204:207], v[168:171]
    ds_read_b128 v[216:219], v241 offset:33792
    v_mfma_f32_16x16x32_bf16 v[172:175], a[136:139], v[204:207], v[172:175]
    ds_read_b128 v[224:227], v242 offset:9216
    v_mfma_f32_16x16x32_bf16 v[176:179], a[140:143], v[204:207], v[176:179]
    s_waitcnt lgkmcnt(3)
    v_mfma_f32_16x16x32_bf16 v[180:183], v[220:223], v[204:207], v[180:183]
    v_mfma_f32_16x16x32_bf16 v[184:187], a[128:131], v[208:211], v[184:187]
    v_mfma_f32_16x16x32_bf16 v[188:191], a[132:135], v[208:211], v[188:191]
    v_mfma_f32_16x16x32_bf16 v[192:195], a[136:139], v[208:211], v[192:195]
    v_mfma_f32_16x16x32_bf16 v[196:199], a[140:143], v[208:211], v[196:199]
    v_mfma_f32_16x16x32_bf16 v[200:203], v[220:223], v[208:211], v[200:203]
    s_waitcnt lgkmcnt(2)
    v_mfma_f32_16x16x32_bf16 v[164:167], a[144:147], v[212:215], v[164:167]
    ds_read_b128 v[204:207], v241 offset:10240
    v_mfma_f32_16x16x32_bf16 v[168:171], a[148:151], v[212:215], v[168:171]
    ds_read_b128 v[208:211], v241 offset:34816
    v_mfma_f32_16x16x32_bf16 v[172:175], a[152:155], v[212:215], v[172:175]
    ds_read_b128 v[220:223], v242 offset:10240
    v_mfma_f32_16x16x32_bf16 v[176:179], a[156:159], v[212:215], v[176:179]
    s_waitcnt lgkmcnt(3)
    v_mfma_f32_16x16x32_bf16 v[180:183], v[224:227], v[212:215], v[180:183]
    v_mfma_f32_16x16x32_bf16 v[184:187], a[144:147], v[216:219], v[184:187]
    v_mfma_f32_16x16x32_bf16 v[188:191], a[148:151], v[216:219], v[188:191]
    v_mfma_f32_16x16x32_bf16 v[192:195], a[152:155], v[216:219], v[192:195]
    v_mfma_f32_16x16x32_bf16 v[196:199], a[156:159], v[216:219], v[196:199]
    v_mfma_f32_16x16x32_bf16 v[200:203], v[224:227], v[216:219], v[200:203]
    s_waitcnt lgkmcnt(2)
    v_mfma_f32_16x16x32_bf16 v[164:167], a[160:163], v[204:207], v[164:167]
    ds_read_b128 v[212:215], v241 offset:11264
    v_mfma_f32_16x16x32_bf16 v[168:171], a[164:167], v[204:207], v[168:171]
    ds_read_b128 v[216:219], v241 offset:35840
    v_mfma_f32_16x16x32_bf16 v[172:175], a[168:171], v[204:207], v[172:175]
    ds_read_b128 v[224:227], v242 offset:11264
    v_mfma_f32_16x16x32_bf16 v[176:179], a[172:175], v[204:207], v[176:179]
    s_waitcnt lgkmcnt(3)
    v_mfma_f32_16x16x32_bf16 v[180:183], v[220:223], v[204:207], v[180:183]
    v_mfma_f32_16x16x32_bf16 v[184:187], a[160:163], v[208:211], v[184:187]
    v_mfma_f32_16x16x32_bf16 v[188:191], a[164:167], v[208:211], v[188:191]
    v_mfma_f32_16x16x32_bf16 v[192:195], a[168:171], v[208:211], v[192:195]
    v_mfma_f32_16x16x32_bf16 v[196:199], a[172:175], v[208:211], v[196:199]
    v_mfma_f32_16x16x32_bf16 v[200:203], v[220:223], v[208:211], v[200:203]
    s_waitcnt lgkmcnt(2)
    v_mfma_f32_16x16x32_bf16 v[164:167], a[176:179], v[212:215], v[164:167]
    ds_read_b128 v[204:207], v241 offset:12288
    v_mfma_f32_16x16x32_bf16 v[168:171], a[180:183], v[212:215], v[168:171]
    ds_read_b128 v[208:211], v241 offset:36864
    v_mfma_f32_16x16x32_bf16 v[172:175], a[184:187], v[212:215], v[172:175]
    ds_read_b128 v[220:223], v242 offset:12288
    v_mfma_f32_16x16x32_bf16 v[176:179], a[188:191], v[212:215], v[176:179]
    s_waitcnt lgkmcnt(3)
    v_mfma_f32_16x16x32_bf16 v[180:183], v[224:227], v[212:215], v[180:183]
    v_mfma_f32_16x16x32_bf16 v[184:187], a[176:179], v[216:219], v[184:187]
    v_mfma_f32_16x16x32_bf16 v[188:191], a[180:183], v[216:219], v[188:191]
    v_mfma_f32_16x16x32_bf16 v[192:195], a[184:187], v[216:219], v[192:195]
    v_mfma_f32_16x16x32_bf16 v[196:199], a[188:191], v[216:219], v[196:199]
    v_mfma_f32_16x16x32_bf16 v[200:203], v[224:227], v[216:219], v[200:203]
    s_waitcnt lgkmcnt(2)
    v_mfma_f32_16x16x32_bf16 v[164:167], a[192:195], v[204:207], v[164:167]
    ds_read_b128 v[212:215], v241 offset:13312
    v_mfma_f32_16x16x32_bf16 v[168:171], a[196:199], v[204:207], v[168:171]
    ds_read_b128 v[216:219], v241 offset:37888
    v_mfma_f32_16x16x32_bf16 v[172:175], a[200:203], v[204:207], v[172:175]
    ds_read_b128 v[224:227], v242 offset:13312
    v_mfma_f32_16x16x32_bf16 v[176:179], a[204:207], v[204:207], v[176:179]
    s_waitcnt lgkmcnt(3)
    v_mfma_f32_16x16x32_bf16 v[180:183], v[220:223], v[204:207], v[180:183]
    v_mfma_f32_16x16x32_bf16 v[184:187], a[192:195], v[208:211], v[184:187]
    v_mfma_f32_16x16x32_bf16 v[188:191], a[196:199], v[208:211], v[188:191]
    v_mfma_f32_16x16x32_bf16 v[192:195], a[200:203], v[208:211], v[192:195]
    v_mfma_f32_16x16x32_bf16 v[196:199], a[204:207], v[208:211], v[196:199]
    v_mfma_f32_16x16x32_bf16 v[200:203], v[220:223], v[208:211], v[200:203]
    s_waitcnt lgkmcnt(2)
    v_mfma_f32_16x16x32_bf16 v[164:167], a[208:211], v[212:215], v[164:167]
    ds_read_b128 v[204:207], v241 offset:14336
    v_mfma_f32_16x16x32_bf16 v[168:171], a[212:215], v[212:215], v[168:171]
    ds_read_b128 v[208:211], v241 offset:38912
    v_mfma_f32_16x16x32_bf16 v[172:175], a[216:219], v[212:215], v[172:175]
    ds_read_b128 v[220:223], v242 offset:14336
    v_mfma_f32_16x16x32_bf16 v[176:179], a[220:223], v[212:215], v[176:179]
    s_waitcnt lgkmcnt(3)
    v_mfma_f32_16x16x32_bf16 v[180:183], v[224:227], v[212:215], v[180:183]
    v_mfma_f32_16x16x32_bf16 v[184:187], a[208:211], v[216:219], v[184:187]
    v_mfma_f32_16x16x32_bf16 v[188:191], a[212:215], v[216:219], v[188:191]
    v_mfma_f32_16x16x32_bf16 v[192:195], a[216:219], v[216:219], v[192:195]
    v_mfma_f32_16x16x32_bf16 v[196:199], a[220:223], v[216:219], v[196:199]
    v_mfma_f32_16x16x32_bf16 v[200:203], v[224:227], v[216:219], v[200:203]
    buffer_load_dwordx4 v[246:249], v245, s[4:7], 0 offen sc1
    s_waitcnt lgkmcnt(2)
    v_mfma_f32_16x16x32_bf16 v[164:167], a[224:227], v[204:207], v[164:167]
    ds_read_b128 v[212:215], v241 offset:15360
    v_mfma_f32_16x16x32_bf16 v[168:171], a[228:231], v[204:207], v[168:171]
    ds_read_b128 v[216:219], v241 offset:39936
    v_mfma_f32_16x16x32_bf16 v[172:175], a[232:235], v[204:207], v[172:175]
    ds_read_b128 v[224:227], v242 offset:15360
    v_mfma_f32_16x16x32_bf16 v[176:179], a[236:239], v[204:207], v[176:179]
    s_waitcnt lgkmcnt(3)
    v_mfma_f32_16x16x32_bf16 v[180:183], v[220:223], v[204:207], v[180:183]
    v_mfma_f32_16x16x32_bf16 v[184:187], a[224:227], v[208:211], v[184:187]
    v_mfma_f32_16x16x32_bf16 v[188:191], a[228:231], v[208:211], v[188:191]
    v_mfma_f32_16x16x32_bf16 v[192:195], a[232:235], v[208:211], v[192:195]
    v_mfma_f32_16x16x32_bf16 v[196:199], a[236:239], v[208:211], v[196:199]
    v_mfma_f32_16x16x32_bf16 v[200:203], v[220:223], v[208:211], v[200:203]
    s_waitcnt lgkmcnt(2)
    v_mfma_f32_16x16x32_bf16 v[164:167], a[240:243], v[212:215], v[164:167]
    ds_read_b128 v[204:207], v241 offset:16384
    v_mfma_f32_16x16x32_bf16 v[168:171], a[244:247], v[212:215], v[168:171]
    ds_read_b128 v[208:211], v241 offset:40960
    v_mfma_f32_16x16x32_bf16 v[172:175], a[248:251], v[212:215], v[172:175]
    v_mfma_f32_16x16x32_bf16 v[176:179], a[252:255], v[212:215], v[176:179]
    s_waitcnt lgkmcnt(2)
    v_mfma_f32_16x16x32_bf16 v[180:183], v[224:227], v[212:215], v[180:183]
    v_mfma_f32_16x16x32_bf16 v[184:187], a[240:243], v[216:219], v[184:187]
    v_mfma_f32_16x16x32_bf16 v[188:191], a[244:247], v[216:219], v[188:191]
    v_mfma_f32_16x16x32_bf16 v[192:195], a[248:251], v[216:219], v[192:195]
    v_mfma_f32_16x16x32_bf16 v[196:199], a[252:255], v[216:219], v[196:199]
    v_mfma_f32_16x16x32_bf16 v[200:203], v[224:227], v[216:219], v[200:203]
    s_waitcnt lgkmcnt(1)
    v_mfma_f32_16x16x32_bf16 v[164:167], v[4:7], v[204:207], v[164:167]
    ds_read_b128 v[212:215], v241 offset:17408
    v_mfma_f32_16x16x32_bf16 v[168:171], v[8:11], v[204:207], v[168:171]
    ds_read_b128 v[216:219], v241 offset:41984
    v_mfma_f32_16x16x32_bf16 v[172:175], v[12:15], v[204:207], v[172:175]
    v_mfma_f32_16x16x32_bf16 v[176:179], v[16:19], v[204:207], v[176:179]
    v_mfma_f32_16x16x32_bf16 v[180:183], v[132:135], v[204:207], v[180:183]
    s_waitcnt lgkmcnt(2)
    v_mfma_f32_16x16x32_bf16 v[184:187], v[4:7], v[208:211], v[184:187]
    v_mfma_f32_16x16x32_bf16 v[188:191], v[8:11], v[208:211], v[188:191]
    v_mfma_f32_16x16x32_bf16 v[192:195], v[12:15], v[208:211], v[192:195]
    v_mfma_f32_16x16x32_bf16 v[196:199], v[16:19], v[208:211], v[196:199]
    v_mfma_f32_16x16x32_bf16 v[200:203], v[132:135], v[208:211], v[200:203]
    s_waitcnt lgkmcnt(1)
    v_mfma_f32_16x16x32_bf16 v[164:167], v[20:23], v[212:215], v[164:167]
    ds_read_b128 v[204:207], v241 offset:18432
    v_mfma_f32_16x16x32_bf16 v[168:171], v[24:27], v[212:215], v[168:171]
    ds_read_b128 v[208:211], v241 offset:43008
    v_mfma_f32_16x16x32_bf16 v[172:175], v[28:31], v[212:215], v[172:175]
    v_mfma_f32_16x16x32_bf16 v[176:179], v[32:35], v[212:215], v[176:179]
    v_mfma_f32_16x16x32_bf16 v[180:183], v[136:139], v[212:215], v[180:183]
    s_waitcnt lgkmcnt(2)
    v_mfma_f32_16x16x32_bf16 v[184:187], v[20:23], v[216:219], v[184:187]
    v_mfma_f32_16x16x32_bf16 v[188:191], v[24:27], v[216:219], v[188:191]
    v_mfma_f32_16x16x32_bf16 v[192:195], v[28:31], v[216:219], v[192:195]
    v_mfma_f32_16x16x32_bf16 v[196:199], v[32:35], v[216:219], v[196:199]
    v_mfma_f32_16x16x32_bf16 v[200:203], v[136:139], v[216:219], v[200:203]
    s_waitcnt lgkmcnt(1)
    v_mfma_f32_16x16x32_bf16 v[164:167], v[36:39], v[204:207], v[164:167]
    ds_read_b128 v[212:215], v241 offset:19456
    v_mfma_f32_16x16x32_bf16 v[168:171], v[40:43], v[204:207], v[168:171]
    ds_read_b128 v[216:219], v241 offset:44032
    v_mfma_f32_16x16x32_bf16 v[172:175], v[44:47], v[204:207], v[172:175]
    v_mfma_f32_16x16x32_bf16 v[176:179], v[48:51], v[204:207], v[176:179]
    v_mfma_f32_16x16x32_bf16 v[180:183], v[140:143], v[204:207], v[180:183]
    s_waitcnt lgkmcnt(2)
    v_mfma_f32_16x16x32_bf16 v[184:187], v[36:39], v[208:211], v[184:187]
    v_mfma_f32_16x16x32_bf16 v[188:191], v[40:43], v[208:211], v[188:191]
    v_mfma_f32_16x16x32_bf16 v[192:195], v[44:47], v[208:211], v[192:195]
    v_mfma_f32_16x16x32_bf16 v[196:199], v[48:51], v[208:211], v[196:199]
    v_mfma_f32_16x16x32_bf16 v[200:203], v[140:143], v[208:211], v[200:203]
    s_mov_b32 s73, 0
    s_add_u32 s65, s62, 2
Lfchk_40:
    s_waitcnt vmcnt(0)
    v_min3_u32 v228, v246, v247, v248
    v_min_u32 v228, v228, v249
    v_cmp_gt_u32 vcc, s65, v228
    s_cbranch_vccnz L_Tnopre
    s_mov_b32 s73, 1
    s_add_u32 m0, s72, 0
    s_add_u32 s64, s70, 0
    buffer_load_dwordx4 v240, s[4:7], s64 offen sc1 lds
    s_add_u32 m0, s72, 24576
    s_add_u32 s64, s70, 24576
    buffer_load_dwordx4 v240, s[4:7], s64 offen sc1 lds
    s_add_u32 m0, s72, 4096
    s_add_u32 s64, s70, 4096
    buffer_load_dwordx4 v240, s[4:7], s64 offen sc1 lds
    s_add_u32 m0, s72, 28672
    s_add_u32 s64, s70, 28672
    buffer_load_dwordx4 v240, s[4:7], s64 offen sc1 lds
    s_add_u32 m0, s72, 8192
    s_add_u32 s64, s70, 8192
    buffer_load_dwordx4 v240, s[4:7], s64 offen sc1 lds
    s_add_u32 m0, s72, 32768
    s_add_u32 s64, s70, 32768
    buffer_load_dwordx4 v240, s[4:7], s64 offen sc1 lds
    s_add_u32 m0, s72, 12288
    s_add_u32 s64, s70, 12288
    buffer_load_dwordx4 v240, s[4:7], s64 offen sc1 lds
    s_add_u32 m0, s72, 36864
    s_add_u32 s64, s70, 36864
    buffer_load_dwordx4 v240, s[4:7], s64 offen sc1 lds
    s_add_u32 m0, s72, 16384
    s_add_u32 s64, s70, 16384
    buffer_load_dwordx4 v240, s[4:7], s64 offen sc1 lds
    s_add_u32 m0, s72, 40960
    s_add_u32 s64, s70, 40960
    buffer_load_dwordx4 v240, s[4:7], s64 offen sc1 lds
    s_add_u32 m0, s72, 20480
    s_add_u32 s64, s70, 20480
    buffer_load_dwordx4 v240, s[4:7], s64 offen sc1 lds
    s_add_u32 m0, s72, 45056
    s_add_u32 s64, s70, 45056
    buffer_load_dwordx4 v240, s[4:7], s64 offen sc1 lds
    s_add_u32 s70, s70, 393216
    s_xor_b32 s72, s72, 49152
L_Tnopre:
    s_waitcnt lgkmcnt(1)
    v_mfma_f32_16x16x32_bf16 v[164:167], v[52:55], v[212:215], v[164:167]
    ds_read_b128 v[204:207], v241 offset:20480
    v_mfma_f32_16x16x32_bf16 v[168:171], v[56:59], v[212:215], v[168:171]
    ds_read_b128 v[208:211], v241 offset:45056
    v_mfma_f32_16x16x32_bf16 v[172:175], v[60:63], v[212:215], v[172:175]
    v_mfma_f32_16x16x32_bf16 v[176:179], v[64:67], v[212:215], v[176:179]
    v_mfma_f32_16x16x32_bf16 v[180:183], v[144:147], v[212:215], v[180:183]
    s_waitcnt lgkmcnt(2)
    v_mfma_f32_16x16x32_bf16 v[184:187], v[52:55], v[216:219], v[184:187]
    v_mfma_f32_16x16x32_bf16 v[188:191], v[56:59], v[216:219], v[188:191]
    v_mfma_f32_16x16x32_bf16 v[192:195], v[60:63], v[216:219], v[192:195]
    v_mfma_f32_16x16x32_bf16 v[196:199], v[64:67], v[216:219], v[196:199]
    v_mfma_f32_16x16x32_bf16 v[200:203], v[144:147], v[216:219], v[200:203]
    s_waitcnt lgkmcnt(1)
    v_mfma_f32_16x16x32_bf16 v[164:167], v[68:71], v[204:207], v[164:167]
    ds_read_b128 v[212:215], v241 offset:21504
    v_mfma_f32_16x16x32_bf16 v[168:171], v[72:75], v[204:207], v[168:171]
    ds_read_b128 v[216:219], v241 offset:46080
    v_mfma_f32_16x16x32_bf16 v[172:175], v[76:79], v[204:207], v[172:175]
    v_mfma_f32_16x16x32_bf16 v[176:179], v[80:83], v[204:207], v[176:179]
    v_mfma_f32_16x16x32_bf16 v[180:183], v[148:151], v[204:207], v[180:183]
    s_waitcnt lgkmcnt(2)
    v_mfma_f32_16x16x32_bf16 v[184:187], v[68:71], v[208:211], v[184:187]
    v_mfma_f32_16x16x32_bf16 v[188:191], v[72:75], v[208:211], v[188:191]
    v_mfma_f32_16x16x32_bf16 v[192:195], v[76:79], v[208:211], v[192:195]
    v_mfma_f32_16x16x32_bf16 v[196:199], v[80:83], v[208:211], v[196:199]
    v_mfma_f32_16x16x32_bf16 v[200:203], v[148:151], v[208:211], v[200:203]
    s_waitcnt lgkmcnt(1)
    v_mfma_f32_16x16x32_bf16 v[164:167], v[84:87], v[212:215], v[164:167]
    ds_read_b128 v[204:207], v241 offset:22528
    v_mfma_f32_16x16x32_bf16 v[168:171], v[88:91], v[212:215], v[168:171]
    ds_read_b128 v[208:211], v241 offset:47104
    v_mfma_f32_16x16x32_bf16 v[172:175], v[92:95], v[212:215], v[172:175]
    v_mfma_f32_16x16x32_bf16 v[176:179], v[96:99], v[212:215], v[176:179]
    v_mfma_f32_16x16x32_bf16 v[180:183], v[152:155], v[212:215], v[180:183]
    s_waitcnt lgkmcnt(2)
    v_mfma_f32_16x16x32_bf16 v[184:187], v[84:87], v[216:219], v[184:187]
    v_mfma_f32_16x16x32_bf16 v[188:191], v[88:91], v[216:219], v[188:191]
    v_mfma_f32_16x16x32_bf16 v[192:195], v[92:95], v[216:219], v[192:195]
    v_mfma_f32_16x16x32_bf16 v[196:199], v[96:99], v[216:219], v[196:199]
    v_mfma_f32_16x16x32_bf16 v[200:203], v[152:155], v[216:219], v[200:203]
    s_waitcnt lgkmcnt(1)
    v_mfma_f32_16x16x32_bf16 v[164:167], v[100:103], v[204:207], v[164:167]
    ds_read_b128 v[212:215], v241 offset:23552
    v_mfma_f32_16x16x32_bf16 v[168:171], v[104:107], v[204:207], v[168:171]
    ds_read_b128 v[216:219], v241 offset:48128
    v_mfma_f32_16x16x32_bf16 v[172:175], v[108:111], v[204:207], v[172:175]
    v_mfma_f32_16x16x32_bf16 v[176:179], v[112:115], v[204:207], v[176:179]
    v_mfma_f32_16x16x32_bf16 v[180:183], v[156:159], v[204:207], v[180:183]
    s_waitcnt lgkmcnt(2)
    v_mfma_f32_16x16x32_bf16 v[184:187], v[100:103], v[208:211], v[184:187]
    v_mfma_f32_16x16x32_bf16 v[188:191], v[104:107], v[208:211], v[188:191]
    v_mfma_f32_16x16x32_bf16 v[192:195], v[108:111], v[208:211], v[192:195]
    v_mfma_f32_16x16x32_bf16 v[196:199], v[112:115], v[208:211], v[196:199]
    v_mfma_f32_16x16x32_bf16 v[200:203], v[156:159], v[208:211], v[200:203]
    s_waitcnt lgkmcnt(1)
    v_mfma_f32_16x16x32_bf16 v[164:167], v[116:119], v[212:215], v[164:167]
    v_mfma_f32_16x16x32_bf16 v[168:171], v[120:123], v[212:215], v[168:171]
    v_mfma_f32_16x16x32_bf16 v[172:175], v[124:127], v[212:215], v[172:175]
    v_mfma_f32_16x16x32_bf16 v[176:179], v[128:131], v[212:215], v[176:179]
    v_mfma_f32_16x16x32_bf16 v[180:183], v[160:163], v[212:215], v[180:183]
    s_waitcnt lgkmcnt(0)
    v_mfma_f32_16x16x32_bf16 v[184:187], v[116:119], v[216:219], v[184:187]
    v_mfma_f32_16x16x32_bf16 v[188:191], v[120:123], v[216:219], v[188:191]
    v_mfma_f32_16x16x32_bf16 v[192:195], v[124:127], v[216:219], v[192:195]
    v_mfma_f32_16x16x32_bf16 v[196:199], v[128:131], v[216:219], v[196:199]
    v_mfma_f32_16x16x32_bf16 v[200:203], v[160:163], v[216:219], v[200:203]
    v_xor_b32 v241, 49152, v241
    v_cvt_pk_bf16_f32 v164, v164, v165
    v_cvt_pk_bf16_f32 v165, v166, v167
    v_cvt_pk_bf16_f32 v166, v168, v169
    v_cvt_pk_bf16_f32 v167, v170, v171
    v_cvt_pk_bf16_f32 v168, v172, v173
    v_cvt_pk_bf16_f32 v169, v174, v175
    v_cvt_pk_bf16_f32 v170, v176, v177
    v_cvt_pk_bf16_f32 v171, v178, v179
    v_cvt_pk_bf16_f32 v172, v180, v181
    v_cvt_pk_bf16_f32 v173, v182, v183
    buffer_store_dwordx4 v[164:167], v243, s[4:7], s71 offen offset:0 sc1
    buffer_store_dwordx4 v[168:171], v243, s[4:7], s71 offen offset:2048 sc1
    buffer_store_dwordx2 v[172:173], v244, s[4:7], s71 offen offset:0 sc1
    v_cvt_pk_bf16_f32 v184, v184, v185
    v_cvt_pk_bf16_f32 v185, v186, v187
    v_cvt_pk_bf16_f32 v186, v188, v189
    v_cvt_pk_bf16_f32 v187, v190, v191
    v_cvt_pk_bf16_f32 v188, v192, v193
    v_cvt_pk_bf16_f32 v189, v194, v195
    v_cvt_pk_bf16_f32 v190, v196, v197
    v_cvt_pk_bf16_f32 v191, v198, v199
    v_cvt_pk_bf16_f32 v192, v200, v201
    v_cvt_pk_bf16_f32 v193, v202, v203
    buffer_store_dwordx4 v[184:187], v243, s[4:7], s71 offen offset:1024 sc1
    buffer_store_dwordx4 v[188:191], v243, s[4:7], s71 offen offset:3072 sc1
    buffer_store_dwordx2 v[192:193], v244, s[4:7], s71 offen offset:512 sc1
    s_add_u32 s71, s71, 327680
    s_waitcnt vmcnt(0)
    s_add_u32 s64, s62, 1
    v_mov_b32 v228, s64
    s_mov_b64 exec, 1
    buffer_store_dword v228, off, s[4:7], s63 sc1
    s_mov_b64 exec, -1
    s_add_u32 s62, s62, 1
    s_cmp_lt_u32 s62, 64
    s_cbranch_scc1 L_Tseg
    s_endpgm
Lgrty_37:
    s_sleep 4
    buffer_load_dword v2, v3, s[8:11], 0 offen sc1
    s_sub_u32 s61, s61, 1
    s_mov_b32 s67, 1
    s_cbranch_scc1 L_fail
    s_branch Lgchk_36
Lfrty_39:
    s_sleep 1
    buffer_load_dwordx4 v[246:249], v245, s[4:7], 0 offen sc1
    s_sub_u32 s61, s61, 1
    s_mov_b32 s67, 20
    s_cbranch_scc1 L_fail
    s_waitcnt vmcnt(0)
    s_branch Lfchk_38
L_roleB:
    s_mov_b32 s20, s48
    s_mov_b32 s21, s49
    s_mov_b32 s22, 2457600
    s_mov_b32 s23, 0x20000
    s_mov_b32 s24, s50
    s_mov_b32 s25, s51
    s_mov_b32 s26, 819200
    s_mov_b32 s27, 0x20000
    v_mov_b32 v2, 0
    v_mov_b32 v3, s63
    buffer_store_dword v2, v3, s[4:7], 0 offen sc1
    s_waitcnt vmcnt(0)
    s_barrier
    s_cmp_lg_u32 s60, 0
    s_cbranch_scc1 Larr_42
    s_mov_b64 exec, 1
    v_mov_b32 v2, 1
    v_mov_b32 v3, 20
    buffer_atomic_add v2, v3, s[8:11], 0 offen
    s_mov_b64 exec, -1
Larr_42:
    v_and_b32 v1, 63, v0
    s_lshl_b32 s74, s69, 1
    s_and_b32 s64, s59, 1
    s_add_u32 s74, s74, s64
    v_lshrrev_b32 v176, 4, v1
    v_bfe_u32 v177, v1, 2, 2
    v_and_b32 v178, 3, v1
    v_lshlrev_b32 v245, 4, v1
    v_and_b32 v169, 31, v1
    v_mul_u32_u24 v170, 26, v169
    v_lshrrev_b32 v170, 8, v170
    v_mul_u32_u24 v168, 1120, v170
    v_lshl_add_u32 v168, v169, 4, v168
    v_lshrrev_b32 v170, 5, v0
    v_mul_u32_u24 v170, 3840, v170
    s_mul_i32 s64, s74, 160
    v_add3_u32 v168, v168, v170, s64
    v_mov_b32 v170, 0x80000000
    v_cmp_gt_u32 vcc, 30, v169
    s_nop 1
    v_cndmask_b32 v168, v170, v168, vcc
    v_lshl_add_u32 v169, v176, 3, v177
    v_lshlrev_b32 v169, 9, v169
    s_mul_i32 s64, s60, 40
    v_mul_u32_u24 v171, 160, v178
    s_add_u32 s65, s64, 32
    v_mov_b32 v172, s65
    v_cmp_gt_u32 vcc, 3, v178
    s_nop 1
    v_cndmask_b32 v172, 0, v172, vcc
    v_add3_u32 v171, v171, v172, v169
    v_lshl_add_u32 v169, v178, 3, v169
    v_add_u32 v169, s64, v169
    v_add_u32 v170, 65536, v169
    v_add_u32 v172, 65536, v171
    v_lshl_add_u32 v173, v178, 2, v177
    v_lshl_add_u32 v173, v176, 4, v173
    v_lshlrev_b32 v173, 2, v173
    s_lshl_b32 s70, s60, 10
    s_mov_b32 s64, 0
    s_add_u32 m0, s70, 0
    s_nop 0
    buffer_load_dwordx4 v168, s[20:23], s64 offen lds
    s_mov_b32 s64, 30720
    s_add_u32 m0, s70, 4096
    s_nop 0
    buffer_load_dwordx4 v168, s[20:23], s64 offen lds
    s_mov_b32 s64, 61440
    s_add_u32 m0, s70, 8192
    s_nop 0
    buffer_load_dwordx4 v168, s[20:23], s64 offen lds
    s_mov_b32 s64, 92160
    s_add_u32 m0, s70, 12288
    s_nop 0
    buffer_load_dwordx4 v168, s[20:23], s64 offen lds
    s_mov_b32 s64, 122880
    s_add_u32 m0, s70, 16384
    s_nop 0
    buffer_load_dwordx4 v168, s[20:23], s64 offen lds
    s_mov_b32 s64, 153600
    s_add_u32 m0, s70, 20480
    s_nop 0
    buffer_load_dwordx4 v168, s[20:23], s64 offen lds
    s_mov_b32 s64, 184320
    s_add_u32 m0, s70, 24576
    s_nop 0
    buffer_load_dwordx4 v168, s[20:23], s64 offen lds
    s_mov_b32 s64, 215040
    s_add_u32 m0, s70, 28672
    s_nop 0
    buffer_load_dwordx4 v168, s[20:23], s64 offen lds
    s_mov_b32 s64, 245760
    s_add_u32 m0, s70, 32768
    s_nop 0
    buffer_load_dwordx4 v168, s[20:23], s64 offen lds
    s_mov_b32 s64, 276480
    s_add_u32 m0, s70, 36864
    s_nop 0
    buffer_load_dwordx4 v168, s[20:23], s64 offen lds
    s_mov_b32 s64, 307200
    s_add_u32 m0, s70, 40960
    s_nop 0
    buffer_load_dwordx4 v168, s[20:23], s64 offen lds
    s_mov_b32 s64, 337920
    s_add_u32 m0, s70, 45056
    s_nop 0
    buffer_load_dwordx4 v168, s[20:23], s64 offen lds
    s_mov_b32 s64, 368640
    s_add_u32 m0, s70, 49152
    s_nop 0
    buffer_load_dwordx4 v168, s[20:23], s64 offen lds
    s_mov_b32 s64, 399360
    s_add_u32 m0, s70, 53248
    s_nop 0
    buffer_load_dwordx4 v168, s[20:23], s64 offen lds
    s_mov_b32 s64, 430080
    s_add_u32 m0, s70, 57344
    s_nop 0
    buffer_load_dwordx4 v168, s[20:23], s64 offen lds
    s_mov_b32 s64, 460800
    s_add_u32 m0, s70, 61440
    s_nop 0
    buffer_load_dwordx4 v168, s[20:23], s64 offen lds
    s_mov_b32 s64, 491520
    s_add_u32 m0, s70, 65536
    s_nop 0
    buffer_load_dwordx4 v168, s[20:23], s64 offen lds
    s_mov_b32 s64, 522240
    s_add_u32 m0, s70, 69632
    s_nop 0
    buffer_load_dwordx4 v168, s[20:23], s64 offen lds
    s_mov_b32 s64, 552960
    s_add_u32 m0, s70, 73728
    s_nop 0
    buffer_load_dwordx4 v168, s[20:23], s64 offen lds
    s_mov_b32 s64, 583680
    s_add_u32 m0, s70, 77824
    s_nop 0
    buffer_load_dwordx4 v168, s[20:23], s64 offen lds
    s_mov_b32 s64, 614400
    s_add_u32 m0, s70, 81920
    s_nop 0
    buffer_load_dwordx4 v168, s[20:23], s64 offen lds
    s_mov_b32 s64, 645120
    s_add_u32 m0, s70, 86016
    s_nop 0
    buffer_load_dwordx4 v168, s[20:23], s64 offen lds
    s_mov_b32 s64, 675840
    s_add_u32 m0, s70, 90112
    s_nop 0
    buffer_load_dwordx4 v168, s[20:23], s64 offen lds
    s_mov_b32 s64, 706560
    s_add_u32 m0, s70, 94208
    s_nop 0
    buffer_load_dwordx4 v168, s[20:23], s64 offen lds
    s_mov_b32 s64, 737280
    s_add_u32 m0, s70, 98304
    s_nop 0
    buffer_load_dwordx4 v168, s[20:23], s64 offen lds
    s_mov_b32 s64, 768000
    s_add_u32 m0, s70, 102400
    s_nop 0
    buffer_load_dwordx4 v168, s[20:23], s64 offen lds
    s_mov_b32 s64, 798720
    s_add_u32 m0, s70, 106496
    s_nop 0
    buffer_load_dwordx4 v168, s[20:23], s64 offen lds
    s_mov_b32 s64, 829440
    s_add_u32 m0, s70, 110592
    s_nop 0
    buffer_load_dwordx4 v168, s[20:23], s64 offen lds
    s_waitcnt vmcnt(24)
    s_waitcnt lgkmcnt(0)
    s_barrier
    s_mov_b32 s64, 860160
    s_add_u32 m0, s70, 114688
    s_nop 0
    buffer_load_dwordx4 v168, s[20:23], s64 offen lds
    s_mov_b32 s64, 890880
    s_add_u32 m0, s70, 118784
    s_nop 0
    buffer_load_dwordx4 v168, s[20:23], s64 offen lds
    s_mov_b32 s64, 921600
    s_add_u32 m0, s70, 122880
    s_nop 0
    buffer_load_dwordx4 v168, s[20:23], s64 offen lds
    s_mov_b32 s64, 952320
    s_add_u32 m0, s70, 126976
    s_nop 0
    buffer_load_dwordx4 v168, s[20:23], s64 offen lds
    ds_read_b64_tr_b16 v[200:201], v171 offset:0
    ds_read_b64_tr_b16 v[202:203], v171 offset:2048
    ds_read_b64_tr_b16 a[0:1], v169 offset:0
    ds_read_b64_tr_b16 a[2:3], v169 offset:2048
    ds_read_b64_tr_b16 a[80:81], v169 offset:160
    ds_read_b64_tr_b16 a[82:83], v169 offset:2208
    ds_read_b64_tr_b16 a[160:161], v169 offset:320
    ds_read_b64_tr_b16 a[162:163], v169 offset:2368
    s_waitcnt lgkmcnt(7)
    ds_bpermute_b32 v4, v173, v200
    ds_bpermute_b32 v5, v173, v201
    s_waitcnt lgkmcnt(8)
    ds_bpermute_b32 v6, v173, v202
    ds_bpermute_b32 v7, v173, v203
    s_waitcnt vmcnt(24)
    s_waitcnt lgkmcnt(0)
    s_barrier
    s_mov_b32 s64, 983040
    s_add_u32 m0, s70, 0
    s_nop 0
    buffer_load_dwordx4 v168, s[20:23], s64 offen lds
    s_mov_b32 s64, 1013760
    s_add_u32 m0, s70, 4096
    s_nop 0
    buffer_load_dwordx4 v168, s[20:23], s64 offen lds
    s_mov_b32 s64, 1044480
    s_add_u32 m0, s70, 8192
    s_nop 0
    buffer_load_dwordx4 v168, s[20:23], s64 offen lds
    s_mov_b32 s64, 1075200
    s_add_u32 m0, s70, 12288
    s_nop 0
    buffer_load_dwordx4 v168, s[20:23], s64 offen lds
    ds_read_b64_tr_b16 v[200:201], v171 offset:16384
    ds_read_b64_tr_b16 v[202:203], v171 offset:18432
    ds_read_b64_tr_b16 a[4:5], v169 offset:16384
    ds_read_b64_tr_b16 a[6:7], v169 offset:18432
    ds_read_b64_tr_b16 a[84:85], v169 offset:16544
    ds_read_b64_tr_b16 a[86:87], v169 offset:18592
    ds_read_b64_tr_b16 a[164:165], v169 offset:16704
    ds_read_b64_tr_b16 a[166:167], v169 offset:18752
    s_waitcnt lgkmcnt(7)
    ds_bpermute_b32 v8, v173, v200
    ds_bpermute_b32 v9, v173, v201
    s_waitcnt lgkmcnt(8)
    ds_bpermute_b32 v10, v173, v202
    ds_bpermute_b32 v11, v173, v203
    s_waitcnt vmcnt(24)
    s_waitcnt lgkmcnt(0)
    s_barrier
    s_mov_b32 s64, 1105920
    s_add_u32 m0, s70, 16384
    s_nop 0
    buffer_load_dwordx4 v168, s[20:23], s64 offen lds
    s_mov_b32 s64, 1136640
    s_add_u32 m0, s70, 20480
    s_nop 0
    buffer_load_dwordx4 v168, s[20:23], s64 offen lds
    s_mov_b32 s64, 1167360
    s_add_u32 m0, s70, 24576
    s_nop 0
    buffer_load_dwordx4 v168, s[20:23], s64 offen lds
    s_mov_b32 s64, 1198080
    s_add_u32 m0, s70, 28672
    s_nop 0
    buffer_load_dwordx4 v168, s[20:23], s64 offen lds
    ds_read_b64_tr_b16 v[200:201], v171 offset:32768
    ds_read_b64_tr_b16 v[202:203], v171 offset:34816
    ds_read_b64_tr_b16 a[8:9], v169 offset:32768
    ds_read_b64_tr_b16 a[10:11], v169 offset:34816
    ds_read_b64_tr_b16 a[88:89], v169 offset:32928
    ds_read_b64_tr_b16 a[90:91], v169 offset:34976
    ds_read_b64_tr_b16 a[168:169], v169 offset:33088
    ds_read_b64_tr_b16 a[170:171], v169 offset:35136
    s_waitcnt lgkmcnt(7)
    ds_bpermute_b32 v12, v173, v200
    ds_bpermute_b32 v13, v173, v201
    s_waitcnt lgkmcnt(8)
    ds_bpermute_b32 v14, v173, v202
    ds_bpermute_b32 v15, v173, v203
    s_waitcnt vmcnt(24)
    s_waitcnt lgkmcnt(0)
    s_barrier
    s_mov_b32 s64, 1228800
    s_add_u32 m0, s70, 32768
    s_nop 0
    buffer_load_dwordx4 v168, s[20:23], s64 offen lds
    s_mov_b32 s64, 1259520
    s_add_u32 m0, s70, 36864
    s_nop 0
    buffer_load_dwordx4 v168, s[20:23], s64 offen lds
    s_mov_b32 s64, 1290240
    s_add_u32 m0, s70, 40960
    s_nop 0
    buffer_load_dwordx4 v168, s[20:23], s64 offen lds
    s_mov_b32 s64, 1320960
    s_add_u32 m0, s70, 45056
    s_nop 0
    buffer_load_dwordx4 v168, s[20:23], s64 offen lds
    ds_read_b64_tr_b16 v[200:201], v171 offset:49152
    ds_read_b64_tr_b16 v[202:203], v171 offset:51200
    ds_read_b64_tr_b16 a[12:13], v169 offset:49152
    ds_read_b64_tr_b16 a[14:15], v169 offset:51200
    ds_read_b64_tr_b16 a[92:93], v169 offset:49312
    ds_read_b64_tr_b16 a[94:95], v169 offset:51360
    ds_read_b64_tr_b16 a[172:173], v169 offset:49472
    ds_read_b64_tr_b16 a[174:175], v169 offset:51520
    s_waitcnt lgkmcnt(7)
    ds_bpermute_b32 v16, v173, v200
    ds_bpermute_b32 v17, v173, v201
    s_waitcnt lgkmcnt(8)
    ds_bpermute_b32 v18, v173, v202
    ds_bpermute_b32 v19, v173, v203
    s_waitcnt vmcnt(24)
    s_waitcnt lgkmcnt(0)
    s_barrier
    s_mov_b32 s64, 1351680
    s_add_u32 m0, s70, 49152
    s_nop 0
    buffer_load_dwordx4 v168, s[20:23], s64 offen lds
    s_mov_b32 s64, 1382400
    s_add_u32 m0, s70, 53248
    s_nop 0
    buffer_load_dwordx4 v168, s[20:23], s64 offen lds
    s_mov_b32 s64, 1413120
    s_add_u32 m0, s70, 57344
    s_nop 0
    buffer_load_dwordx4 v168, s[20:23], s64 offen lds
    s_mov_b32 s64, 1443840
    s_add_u32 m0, s70, 61440
    s_nop 0
    buffer_load_dwordx4 v168, s[20:23], s64 offen lds
    ds_read_b64_tr_b16 v[200:201], v172 offset:0
    ds_read_b64_tr_b16 v[202:203], v172 offset:2048
    ds_read_b64_tr_b16 a[16:17], v170 offset:0
    ds_read_b64_tr_b16 a[18:19], v170 offset:2048
    ds_read_b64_tr_b16 a[96:97], v170 offset:160
    ds_read_b64_tr_b16 a[98:99], v170 offset:2208
    ds_read_b64_tr_b16 a[176:177], v170 offset:320
    ds_read_b64_tr_b16 a[178:179], v170 offset:2368
    s_waitcnt lgkmcnt(7)
    ds_bpermute_b32 v20, v173, v200
    ds_bpermute_b32 v21, v173, v201
    s_waitcnt lgkmcnt(8)
    ds_bpermute_b32 v22, v173, v202
    ds_bpermute_b32 v23, v173, v203
    s_waitcnt vmcnt(24)
    s_waitcnt lgkmcnt(0)
    s_barrier
    s_mov_b32 s64, 1474560
    s_add_u32 m0, s70, 65536
    s_nop 0
    buffer_load_dwordx4 v168, s[20:23], s64 offen lds
    s_mov_b32 s64, 1505280
    s_add_u32 m0, s70, 69632
    s_nop 0
    buffer_load_dwordx4 v168, s[20:23], s64 offen lds
    s_mov_b32 s64, 1536000
    s_add_u32 m0, s70, 73728
    s_nop 0
    buffer_load_dwordx4 v168, s[20:23], s64 offen lds
    s_mov_b32 s64, 1566720
    s_add_u32 m0, s70, 77824
    s_nop 0
    buffer_load_dwordx4 v168, s[20:23], s64 offen lds
    ds_read_b64_tr_b16 v[200:201], v172 offset:16384
    ds_read_b64_tr_b16 v[202:203], v172 offset:18432
    ds_read_b64_tr_b16 a[20:21], v170 offset:16384
    ds_read_b64_tr_b16 a[22:23], v170 offset:18432
    ds_read_b64_tr_b16 a[100:101], v170 offset:16544
    ds_read_b64_tr_b16 a[102:103], v170 offset:18592
    ds_read_b64_tr_b16 a[180:181], v170 offset:16704
    ds_read_b64_tr_b16 a[182:183], v170 offset:18752
    s_waitcnt lgkmcnt(7)
    ds_bpermute_b32 v24, v173, v200
    ds_bpermute_b32 v25, v173, v201
    s_waitcnt lgkmcnt(8)
    ds_bpermute_b32 v26, v173, v202
    ds_bpermute_b32 v27, v173, v203
    s_waitcnt vmcnt(24)
    s_waitcnt lgkmcnt(0)
    s_barrier
    s_mov_b32 s64, 1597440
    s_add_u32 m0, s70, 81920
    s_nop 0
    buffer_load_dwordx4 v168, s[20:23], s64 offen lds
    s_mov_b32 s64, 1628160
    s_add_u32 m0, s70, 86016
    s_nop 0
    buffer_load_dwordx4 v168, s[20:23], s64 offen lds
    s_mov_b32 s64, 1658880
    s_add_u32 m0, s70, 90112
    s_nop 0
    buffer_load_dwordx4 v168, s[20:23], s64 offen lds
    s_mov_b32 s64, 1689600
    s_add_u32 m0, s70, 94208
    s_nop 0
    buffer_load_dwordx4 v168, s[20:23], s64 offen lds
    ds_read_b64_tr_b16 v[200:201], v172 offset:32768
    ds_read_b64_tr_b16 v[202:203], v172 offset:34816
    ds_read_b64_tr_b16 a[24:25], v170 offset:32768
    ds_read_b64_tr_b16 a[26:27], v170 offset:34816
    ds_read_b64_tr_b16 a[104:105], v170 offset:32928
    ds_read_b64_tr_b16 a[106:107], v170 offset:34976
    ds_read_b64_tr_b16 a[184:185], v170 offset:33088
    ds_read_b64_tr_b16 a[186:187], v170 offset:35136
    s_waitcnt lgkmcnt(7)
    ds_bpermute_b32 v28, v173, v200
    ds_bpermute_b32 v29, v173, v201
    s_waitcnt lgkmcnt(8)
    ds_bpermute_b32 v30, v173, v202
    ds_bpermute_b32 v31, v173, v203
    s_waitcnt vmcnt(24)
    s_waitcnt lgkmcnt(0)
    s_barrier
    s_mov_b32 s64, 1720320
    s_add_u32 m0, s70, 98304
    s_nop 0
    buffer_load_dwordx4 v168, s[20:23], s64 offen lds
    s_mov_b32 s64, 1751040
    s_add_u32 m0, s70, 102400
    s_nop 0
    buffer_load_dwordx4 v168, s[20:23], s64 offen lds
    s_mov_b32 s64, 1781760
    s_add_u32 m0, s70, 106496
    s_nop 0
    buffer_load_dwordx4 v168, s[20:23], s64 offen lds
    s_mov_b32 s64, 1812480
    s_add_u32 m0, s70, 110592
    s_nop 0
    buffer_load_dwordx4 v168, s[20:23], s64 offen lds
    ds_read_b64_tr_b16 v[200:201], v172 offset:49152
    ds_read_b64_tr_b16 v[202:203], v172 offset:51200
    ds_read_b64_tr_b16 a[28:29], v170 offset:49152
    ds_read_b64_tr_b16 a[30:31], v170 offset:51200
    ds_read_b64_tr_b16 a[108:109], v170 offset:49312
    ds_read_b64_tr_b16 a[110:111], v170 offset:51360
    ds_read_b64_tr_b16 a[188:189], v170 offset:49472
    ds_read_b64_tr_b16 a[190:191], v170 offset:51520
    s_waitcnt lgkmcnt(7)
    ds_bpermute_b32 v32, v173, v200
    ds_bpermute_b32 v33, v173, v201
    s_waitcnt lgkmcnt(8)
    ds_bpermute_b32 v34, v173, v202
    ds_bpermute_b32 v35, v173, v203
    s_waitcnt vmcnt(24)
    s_waitcnt lgkmcnt(0)
    s_barrier
    s_mov_b32 s64, 1843200
    s_add_u32 m0, s70, 114688
    s_nop 0
    buffer_load_dwordx4 v168, s[20:23], s64 offen lds
    s_mov_b32 s64, 1873920
    s_add_u32 m0, s70, 118784
    s_nop 0
    buffer_load_dwordx4 v168, s[20:23], s64 offen lds
    s_mov_b32 s64, 1904640
    s_add_u32 m0, s70, 122880
    s_nop 0
    buffer_load_dwordx4 v168, s[20:23], s64 offen lds
    s_mov_b32 s64, 1935360
    s_add_u32 m0, s70, 126976
    s_nop 0
    buffer_load_dwordx4 v168, s[20:23], s64 offen lds
    ds_read_b64_tr_b16 v[200:201], v171 offset:0
    ds_read_b64_tr_b16 v[202:203], v171 offset:2048
    ds_read_b64_tr_b16 a[32:33], v169 offset:0
    ds_read_b64_tr_b16 a[34:35], v169 offset:2048
    ds_read_b64_tr_b16 a[112:113], v169 offset:160
    ds_read_b64_tr_b16 a[114:115], v169 offset:2208
    ds_read_b64_tr_b16 a[192:193], v169 offset:320
    ds_read_b64_tr_b16 a[194:195], v169 offset:2368
    s_waitcnt lgkmcnt(7)
    ds_bpermute_b32 v36, v173, v200
    ds_bpermute_b32 v37, v173, v201
    s_waitcnt lgkmcnt(8)
    ds_bpermute_b32 v38, v173, v202
    ds_bpermute_b32 v39, v173, v203
    s_waitcnt vmcnt(24)
    s_waitcnt lgkmcnt(0)
    s_barrier
    s_mov_b32 s64, 1966080
    s_add_u32 m0, s70, 0
    s_nop 0
    buffer_load_dwordx4 v168, s[20:23], s64 offen lds
    s_mov_b32 s64, 1996800
    s_add_u32 m0, s70, 4096
    s_nop 0
    buffer_load_dwordx4 v168, s[20:23], s64 offen lds
    s_mov_b32 s64, 2027520
    s_add_u32 m0, s70, 8192
    s_nop 0
    buffer_load_dwordx4 v168, s[20:23], s64 offen lds
    s_mov_b32 s64, 2058240
    s_add_u32 m0, s70, 12288
    s_nop 0
    buffer_load_dwordx4 v168, s[20:23], s64 offen lds
    ds_read_b64_tr_b16 v[200:201], v171 offset:16384
    ds_read_b64_tr_b16 v[202:203], v171 offset:18432
    ds_read_b64_tr_b16 a[36:37], v169 offset:16384
    ds_read_b64_tr_b16 a[38:39], v169 offset:18432
    ds_read_b64_tr_b16 a[116:117], v169 offset:16544
    ds_read_b64_tr_b16 a[118:119], v169 offset:18592
    ds_read_b64_tr_b16 a[196:197], v169 offset:16704
    ds_read_b64_tr_b16 a[198:199], v169 offset:18752
    s_waitcnt lgkmcnt(7)
    ds_bpermute_b32 v40, v173, v200
    ds_bpermute_b32 v41, v173, v201
    s_waitcnt lgkmcnt(8)
    ds_bpermute_b32 v42, v173, v202
    ds_bpermute_b32 v43, v173, v203
    s_waitcnt vmcnt(24)
    s_waitcnt lgkmcnt(0)
    s_barrier
    s_mov_b32 s64, 2088960
    s_add_u32 m0, s70, 16384
    s_nop 0
    buffer_load_dwordx4 v168, s[20:23], s64 offen lds
    s_mov_b32 s64, 2119680
    s_add_u32 m0, s70, 20480
    s_nop 0
    buffer_load_dwordx4 v168, s[20:23], s64 offen lds
    s_mov_b32 s64, 2150400
    s_add_u32 m0, s70, 24576
    s_nop 0
    buffer_load_dwordx4 v168, s[20:23], s64 offen lds
    s_mov_b32 s64, 2181120
    s_add_u32 m0, s70, 28672
    s_nop 0
    buffer_load_dwordx4 v168, s[20:23], s64 offen lds
    ds_read_b64_tr_b16 v[200:201], v171 offset:32768
    ds_read_b64_tr_b16 v[202:203], v171 offset:34816
    ds_read_b64_tr_b16 a[40:41], v169 offset:32768
    ds_read_b64_tr_b16 a[42:43], v169 offset:34816
    ds_read_b64_tr_b16 a[120:121], v169 offset:32928
    ds_read_b64_tr_b16 a[122:123], v169 offset:34976
    ds_read_b64_tr_b16 a[200:201], v169 offset:33088
    ds_read_b64_tr_b16 a[202:203], v169 offset:35136
    s_waitcnt lgkmcnt(7)
    ds_bpermute_b32 v44, v173, v200
    ds_bpermute_b32 v45, v173, v201
    s_waitcnt lgkmcnt(8)
    ds_bpermute_b32 v46, v173, v202
    ds_bpermute_b32 v47, v173, v203
    s_waitcnt vmcnt(24)
    s_waitcnt lgkmcnt(0)
    s_barrier
    s_mov_b32 s64, 2211840
    s_add_u32 m0, s70, 32768
    s_nop 0
    buffer_load_dwordx4 v168, s[20:23], s64 offen lds
    s_mov_b32 s64, 2242560
    s_add_u32 m0, s70, 36864
    s_nop 0
    buffer_load_dwordx4 v168, s[20:23], s64 offen lds
    s_mov_b32 s64, 2273280
    s_add_u32 m0, s70, 40960
    s_nop 0
    buffer_load_dwordx4 v168, s[20:23], s64 offen lds
    s_mov_b32 s64, 2304000
    s_add_u32 m0, s70, 45056
    s_nop 0
    buffer_load_dwordx4 v168, s[20:23], s64 offen lds
    ds_read_b64_tr_b16 v[200:201], v171 offset:49152
    ds_read_b64_tr_b16 v[202:203], v171 offset:51200
    ds_read_b64_tr_b16 a[44:45], v169 offset:49152
    ds_read_b64_tr_b16 a[46:47], v169 offset:51200
    ds_read_b64_tr_b16 a[124:125], v169 offset:49312
    ds_read_b64_tr_b16 a[126:127], v169 offset:51360
    ds_read_b64_tr_b16 a[204:205], v169 offset:49472
    ds_read_b64_tr_b16 a[206:207], v169 offset:51520
    s_waitcnt lgkmcnt(7)
    ds_bpermute_b32 v48, v173, v200
    ds_bpermute_b32 v49, v173, v201
    s_waitcnt lgkmcnt(8)
    ds_bpermute_b32 v50, v173, v202
    ds_bpermute_b32 v51, v173, v203
    s_waitcnt vmcnt(24)
    s_waitcnt lgkmcnt(0)
    s_barrier
    s_mov_b32 s64, 2334720
    s_add_u32 m0, s70, 49152
    s_nop 0
    buffer_load_dwordx4 v168, s[20:23], s64 offen lds
    s_mov_b32 s64, 2365440
    s_add_u32 m0, s70, 53248
    s_nop 0
    buffer_load_dwordx4 v168, s[20:23], s64 offen lds
    s_mov_b32 s64, 2396160
    s_add_u32 m0, s70, 57344
    s_nop 0
    buffer_load_dwordx4 v168, s[20:23], s64 offen lds
    s_mov_b32 s64, 2426880
    s_add_u32 m0, s70, 61440
    s_nop 0
    buffer_load_dwordx4 v168, s[20:23], s64 offen lds
    ds_read_b64_tr_b16 v[200:201], v172 offset:0
    ds_read_b64_tr_b16 v[202:203], v172 offset:2048
    ds_read_b64_tr_b16 a[48:49], v170 offset:0
    ds_read_b64_tr_b16 a[50:51], v170 offset:2048
    ds_read_b64_tr_b16 a[128:129], v170 offset:160
    ds_read_b64_tr_b16 a[130:131], v170 offset:2208
    ds_read_b64_tr_b16 a[208:209], v170 offset:320
    ds_read_b64_tr_b16 a[210:211], v170 offset:2368
    s_waitcnt lgkmcnt(7)
    ds_bpermute_b32 v52, v173, v200
    ds_bpermute_b32 v53, v173, v201
    s_waitcnt lgkmcnt(8)
    ds_bpermute_b32 v54, v173, v202
    ds_bpermute_b32 v55, v173, v203
    s_waitcnt vmcnt(24)
    s_waitcnt lgkmcnt(0)
    s_barrier
    ds_read_b64_tr_b16 v[200:201], v172 offset:16384
    ds_read_b64_tr_b16 v[202:203], v172 offset:18432
    ds_read_b64_tr_b16 a[52:53], v170 offset:16384
    ds_read_b64_tr_b16 a[54:55], v170 offset:18432
    ds_read_b64_tr_b16 a[132:133], v170 offset:16544
    ds_read_b64_tr_b16 a[134:135], v170 offset:18592
    ds_read_b64_tr_b16 a[212:213], v170 offset:16704
    ds_read_b64_tr_b16 a[214:215], v170 offset:18752
    s_waitcnt lgkmcnt(7)
    ds_bpermute_b32 v56, v173, v200
    ds_bpermute_b32 v57, v173, v201
    s_waitcnt lgkmcnt(8)
    ds_bpermute_b32 v58, v173, v202
    ds_bpermute_b32 v59, v173, v203
    s_waitcnt vmcnt(20)
    s_waitcnt lgkmcnt(0)
    s_barrier
    ds_read_b64_tr_b16 v[200:201], v172 offset:32768
    ds_read_b64_tr_b16 v[202:203], v172 offset:34816
    ds_read_b64_tr_b16 a[56:57], v170 offset:32768
    ds_read_b64_tr_b16 a[58:59], v170 offset:34816
    ds_read_b64_tr_b16 a[136:137], v170 offset:32928
    ds_read_b64_tr_b16 a[138:139], v170 offset:34976
    ds_read_b64_tr_b16 a[216:217], v170 offset:33088
    ds_read_b64_tr_b16 a[218:219], v170 offset:35136
    s_waitcnt lgkmcnt(7)
    ds_bpermute_b32 v60, v173, v200
    ds_bpermute_b32 v61, v173, v201
    s_waitcnt lgkmcnt(8)
    ds_bpermute_b32 v62, v173, v202
    ds_bpermute_b32 v63, v173, v203
    s_waitcnt vmcnt(16)
    s_waitcnt lgkmcnt(0)
    s_barrier
    ds_read_b64_tr_b16 v[200:201], v172 offset:49152
    ds_read_b64_tr_b16 v[202:203], v172 offset:51200
    ds_read_b64_tr_b16 a[60:61], v170 offset:49152
    ds_read_b64_tr_b16 a[62:63], v170 offset:51200
    ds_read_b64_tr_b16 a[140:141], v170 offset:49312
    ds_read_b64_tr_b16 a[142:143], v170 offset:51360
    ds_read_b64_tr_b16 a[220:221], v170 offset:49472
    ds_read_b64_tr_b16 a[222:223], v170 offset:51520
    s_waitcnt lgkmcnt(7)
    ds_bpermute_b32 v64, v173, v200
    ds_bpermute_b32 v65, v173, v201
    s_waitcnt lgkmcnt(8)
    ds_bpermute_b32 v66, v173, v202
    ds_bpermute_b32 v67, v173, v203
    s_waitcnt vmcnt(12)
    s_waitcnt lgkmcnt(0)
    s_barrier
    ds_read_b64_tr_b16 v[200:201], v171 offset:0
    ds_read_b64_tr_b16 v[202:203], v171 offset:2048
    ds_read_b64_tr_b16 a[64:65], v169 offset:0
    ds_read_b64_tr_b16 a[66:67], v169 offset:2048
    ds_read_b64_tr_b16 a[144:145], v169 offset:160
    ds_read_b64_tr_b16 a[146:147], v169 offset:2208
    ds_read_b64_tr_b16 a[224:225], v169 offset:320
    ds_read_b64_tr_b16 a[226:227], v169 offset:2368
    s_waitcnt lgkmcnt(7)
    ds_bpermute_b32 v68, v173, v200
    ds_bpermute_b32 v69, v173, v201
    s_waitcnt lgkmcnt(8)
    ds_bpermute_b32 v70, v173, v202
    ds_bpermute_b32 v71, v173, v203
    s_waitcnt vmcnt(8)
    s_waitcnt lgkmcnt(0)
    s_barrier
    ds_read_b64_tr_b16 v[200:201], v171 offset:16384
    ds_read_b64_tr_b16 v[202:203], v171 offset:18432
    ds_read_b64_tr_b16 a[68:69], v169 offset:16384
    ds_read_b64_tr_b16 a[70:71], v169 offset:18432
    ds_read_b64_tr_b16 a[148:149], v169 offset:16544
    ds_read_b64_tr_b16 a[150:151], v169 offset:18592
    ds_read_b64_tr_b16 a[228:229], v169 offset:16704
    ds_read_b64_tr_b16 a[230:231], v169 offset:18752
    s_waitcnt lgkmcnt(7)
    ds_bpermute_b32 v72, v173, v200
    ds_bpermute_b32 v73, v173, v201
    s_waitcnt lgkmcnt(8)
    ds_bpermute_b32 v74, v173, v202
    ds_bpermute_b32 v75, v173, v203
    s_waitcnt vmcnt(4)
    s_waitcnt lgkmcnt(0)
    s_barrier
    ds_read_b64_tr_b16 v[200:201], v171 offset:32768
    ds_read_b64_tr_b16 v[202:203], v171 offset:34816
    ds_read_b64_tr_b16 a[72:73], v169 offset:32768
    ds_read_b64_tr_b16 a[74:75], v169 offset:34816
    ds_read_b64_tr_b16 a[152:153], v169 offset:32928
    ds_read_b64_tr_b16 a[154:155], v169 offset:34976
    ds_read_b64_tr_b16 a[232:233], v169 offset:33088
    ds_read_b64_tr_b16 a[234:235], v169 offset:35136
    s_waitcnt lgkmcnt(7)
    ds_bpermute_b32 v76, v173, v200
    ds_bpermute_b32 v77, v173, v201
    s_waitcnt lgkmcnt(8)
    ds_bpermute_b32 v78, v173, v202
    ds_bpermute_b32 v79, v173, v203
    s_waitcnt vmcnt(0)
    s_waitcnt lgkmcnt(0)
    s_barrier
    ds_read_b64_tr_b16 v[200:201], v171 offset:49152
    ds_read_b64_tr_b16 v[202:203], v171 offset:51200
    ds_read_b64_tr_b16 a[76:77], v169 offset:49152
    ds_read_b64_tr_b16 a[78:79], v169 offset:51200
    ds_read_b64_tr_b16 a[156:157], v169 offset:49312
    ds_read_b64_tr_b16 a[158:159], v169 offset:51360
    ds_read_b64_tr_b16 a[236:237], v169 offset:49472
    ds_read_b64_tr_b16 a[238:239], v169 offset:51520
    s_waitcnt lgkmcnt(7)
    ds_bpermute_b32 v80, v173, v200
    ds_bpermute_b32 v81, v173, v201
    s_waitcnt lgkmcnt(8)
    ds_bpermute_b32 v82, v173, v202
    ds_bpermute_b32 v83, v173, v203
    s_waitcnt lgkmcnt(0)
    s_barrier
    v_lshlrev_b32 v168, 4, v0
    s_mul_i32 s64, s74, 102400
    s_add_u32 s65, s64, 102400
    s_mov_b32 m0, s70
Lstgb_43:
    s_nop 0
    buffer_load_dwordx4 v168, s[24:27], s64 offen lds
    s_add_u32 m0, m0, 4096
    s_add_u32 s64, s64, 4096
    s_cmp_lt_u32 s64, s65
    s_cbranch_scc1 Lstgb_43
    v_lshl_add_u32 v169, v176, 2, v177
    v_mul_u32_u24 v169, 1280, v169
    v_mul_u32_u24 v171, 20, v177
    v_add3_u32 v171, v171, v176, 16
    v_mul_u32_u24 v171, 1280, v171
    s_lshl_b32 s64, s60, 6
    v_lshl_add_u32 v173, v178, 3, s64
    v_add_u32 v170, v169, v173
    v_add_u32 v172, v171, v173
    v_lshl_add_u32 v169, v173, 1, v169
    v_lshl_add_u32 v171, v173, 1, v171
    v_add_u32 v174, 51200, v169
    v_add_u32 v175, 51200, v170
    s_waitcnt vmcnt(0)
    s_barrier
    ds_read_b64_tr_b16 v[84:85], v169 offset:0
    ds_read_b64_tr_b16 v[86:87], v169 offset:25600
    ds_read_b64_tr_b16 v[88:89], v174 offset:0
    ds_read_b64_tr_b16 v[90:91], v174 offset:25600
    ds_read_b64_tr_b16 a[240:241], v171 offset:0
    ds_read_b64_tr_b16 v[92:93], v169 offset:8
    ds_read_b64_tr_b16 v[94:95], v169 offset:25608
    ds_read_b64_tr_b16 v[96:97], v174 offset:8
    ds_read_b64_tr_b16 v[98:99], v174 offset:25608
    ds_read_b64_tr_b16 a[242:243], v171 offset:8
    ds_read_b64_tr_b16 v[100:101], v169 offset:512
    ds_read_b64_tr_b16 v[102:103], v169 offset:26112
    ds_read_b64_tr_b16 v[104:105], v174 offset:512
    ds_read_b64_tr_b16 v[106:107], v174 offset:26112
    ds_read_b64_tr_b16 a[244:245], v171 offset:512
    ds_read_b64_tr_b16 v[108:109], v169 offset:520
    ds_read_b64_tr_b16 v[110:111], v169 offset:26120
    ds_read_b64_tr_b16 v[112:113], v174 offset:520
    ds_read_b64_tr_b16 v[114:115], v174 offset:26120
    ds_read_b64_tr_b16 a[246:247], v171 offset:520
    ds_read_b64_tr_b16 v[116:117], v170 offset:1024
    ds_read_b64_tr_b16 v[118:119], v170 offset:26624
    ds_read_b64_tr_b16 v[120:121], v175 offset:1024
    ds_read_b64_tr_b16 v[122:123], v175 offset:26624
    ds_read_b64_tr_b16 a[248:249], v172 offset:1024
    ds_read_b64_tr_b16 v[124:125], v169 offset:64
    ds_read_b64_tr_b16 v[126:127], v169 offset:25664
    ds_read_b64_tr_b16 v[128:129], v174 offset:64
    ds_read_b64_tr_b16 v[130:131], v174 offset:25664
    ds_read_b64_tr_b16 a[250:251], v171 offset:64
    ds_read_b64_tr_b16 v[132:133], v169 offset:72
    ds_read_b64_tr_b16 v[134:135], v169 offset:25672
    ds_read_b64_tr_b16 v[136:137], v174 offset:72
    ds_read_b64_tr_b16 v[138:139], v174 offset:25672
    ds_read_b64_tr_b16 a[252:253], v171 offset:72
    ds_read_b64_tr_b16 v[140:141], v169 offset:576
    ds_read_b64_tr_b16 v[142:143], v169 offset:26176
    ds_read_b64_tr_b16 v[144:145], v174 offset:576
    ds_read_b64_tr_b16 v[146:147], v174 offset:26176
    ds_read_b64_tr_b16 a[254:255], v171 offset:576
    ds_read_b64_tr_b16 v[148:149], v169 offset:584
    ds_read_b64_tr_b16 v[150:151], v169 offset:26184
    ds_read_b64_tr_b16 v[152:153], v174 offset:584
    ds_read_b64_tr_b16 v[154:155], v174 offset:26184
    ds_read_b64_tr_b16 v[164:165], v171 offset:584
    ds_read_b64_tr_b16 v[156:157], v170 offset:1056
    ds_read_b64_tr_b16 v[158:159], v170 offset:26656
    ds_read_b64_tr_b16 v[160:161], v175 offset:1056
    ds_read_b64_tr_b16 v[162:163], v175 offset:26656
    ds_read_b64_tr_b16 v[166:167], v172 offset:1056
    s_waitcnt lgkmcnt(0)
    s_barrier
    v_and_b32 v179, 7, v1
    v_bfe_u32 v180, v1, 3, 1
    v_lshrrev_b32 v181, 3, v0
    v_mul_u32_u24 v242, 1280, v181
    v_and_b32 v181, 7, v181
    v_xor_b32 v181, v181, v179
    v_lshl_add_u32 v242, v181, 4, v242
    v_mul_u32_u24 v243, 10240, v180
    v_lshl_add_u32 v243, v179, 7, v243
    v_xor_b32 v181, v176, v179
    v_lshl_add_u32 v243, v181, 4, v243
    v_xor_b32 v244, 64, v243
    v_and_b32 v168, 15, v1
    v_lshlrev_b32 v181, 2, v176
    v_cmp_eq_u32 vcc, v168, v181
    s_nop 1
    v_cndmask_b32 v240, 0, 1.0, vcc
    v_mov_b32 v182, 0x3f803f80
    v_cmp_eq_u32 vcc, 1, v178
    s_nop 1
    v_cndmask_b32 v241, 0, v182, vcc
    v_sub_u32 v181, v168, v181
    v_mov_b32 v182, 0xff800000
    v_add_u32 v169, 16, v181
    v_and_b32 v169, 0xfffffff1, v169
    v_cmp_eq_u32 vcc, 0, v169
    s_nop 1
    v_cndmask_b32 v200, v182, 0, vcc
    v_add_u32 v169, 15, v181
    v_and_b32 v169, 0xfffffff1, v169
    v_cmp_eq_u32 vcc, 0, v169
    s_nop 1
    v_cndmask_b32 v201, v182, 0, vcc
    v_add_u32 v169, 14, v181
    v_and_b32 v169, 0xfffffff1, v169
    v_cmp_eq_u32 vcc, 0, v169
    s_nop 1
    v_cndmask_b32 v202, v182, 0, vcc
    v_add_u32 v169, 13, v181
    v_and_b32 v169, 0xfffffff1, v169
    v_cmp_eq_u32 vcc, 0, v169
    s_nop 1
    v_cndmask_b32 v203, v182, 0, vcc
    v_add_u32 v169, 0, v181
    v_and_b32 v169, 0xfffffff1, v169
    v_cmp_eq_u32 vcc, 0, v169
    s_nop 1
    v_cndmask_b32 v204, v182, 0, vcc
    v_add_u32 v169, -1, v181
    v_and_b32 v169, 0xfffffff1, v169
    v_cmp_eq_u32 vcc, 0, v169
    s_nop 1
    v_cndmask_b32 v205, v182, 0, vcc
    v_add_u32 v169, -2, v181
    v_and_b32 v169, 0xfffffff1, v169
    v_cmp_eq_u32 vcc, 0, v169
    s_nop 1
    v_cndmask_b32 v206, v182, 0, vcc
    v_add_u32 v169, -3, v181
    v_and_b32 v169, 0xfffffff1, v169
    v_cmp_eq_u32 vcc, 0, v169
    s_nop 1
    v_cndmask_b32 v207, v182, 0, vcc
    v_mov_b32 v208, v182
    v_mov_b32 v224, 0
    v_mov_b32 v209, v182
    v_mov_b32 v225, 0
    v_mov_b32 v210, v182
    v_mov_b32 v226, 0
    v_mov_b32 v211, v182
    v_mov_b32 v227, 0
    ds_write_b128 v245, v[200:203] offset:5120
    ds_write_b128 v245, v[204:207] offset:6144
    ds_write_b128 v245, v[208:211] offset:7168
    v_mov_b32 v228, 0
    v_mov_b32 v229, 0
    v_mov_b32 v234, 0
    v_mov_b32 v235, 0
    v_add_u32 v246, 2048, v245
    s_lshr_b32 s64, s60, 1
    s_lshl_b32 s64, s64, 10
    s_and_b32 s65, s60, 1
    s_lshl_b32 s65, s65, 3
    s_add_u32 s64, s64, s65
    v_add_u32 v247, s64, v245
    s_lshl_b32 s64, s60, 1
    v_lshl_add_u32 v248, v1, 3, s64
    v_lshlrev_b32 v250, 5, v168
    v_lshl_add_u32 v250, v176, 3, v250
    v_lshlrev_b32 v249, 1, v250
    s_mul_i32 s64, s60, 10240
    v_add_u32 v249, s64, v249
    s_add_u32 s64, s64, 4096
    v_add_u32 v250, s64, v250
    s_lshl_b32 s64, s68, 14
    s_add_u32 s64, s64, 8392448
    v_lshl_add_u32 v251, v178, 12, s64
    s_mul_i32 s70, s68, 2621440
    s_add_u32 s70, s70, 23068672
    s_lshl_b32 s64, s68, 9
    s_add_u32 s64, s64, s74
    s_mul_i32 s71, s64, 40960
    s_add_u32 s71, s71, 134217728
    s_mul_i32 s72, s60, 10240
    s_mov_b32 s76, 40960
    s_mov_b32 s77, 40960
    s_mov_b32 s75, 0x3ea52b5c
    s_mov_b32 s73, 0
    v_mov_b32 v3, 20
    buffer_load_dword v2, v3, s[8:11], 0 offen sc1
Lgchk_44:
    s_waitcnt vmcnt(0)
    v_cmp_gt_u32 vcc, 256, v2
    s_cbranch_vccnz Lgrty_45
L_Bseg:
    s_cmp_lg_u32 s73, 0
    s_cbranch_scc1 L_Bhave
    s_add_u32 s65, s62, 1
    buffer_load_dwordx4 v[252:255], v251, s[4:7], 0 offen sc1
Lfchk_46:
    s_waitcnt vmcnt(0)
    v_min3_u32 v2, v252, v253, v254
    v_min_u32 v2, v2, v255
    v_cmp_gt_u32 vcc, s65, v2
    s_cbranch_vccnz Lfrty_47
    s_add_u32 m0, s72, 8192
    s_nop 0
    buffer_load_dwordx4 v242, s[4:7], s70 offen offset:0 sc1 lds
    s_add_u32 m0, s72, 9088
    s_nop 0
    buffer_load_dwordx4 v242, s[4:7], s70 offen offset:128 sc1 lds
    s_add_u32 m0, s72, 9984
    s_nop 0
    buffer_load_dwordx4 v242, s[4:7], s70 offen offset:256 sc1 lds
    s_add_u32 m0, s72, 10880
    s_nop 0
    buffer_load_dwordx4 v242, s[4:7], s70 offen offset:384 sc1 lds
    s_add_u32 m0, s72, 11776
    s_nop 0
    buffer_load_dwordx4 v242, s[4:7], s70 offen offset:512 sc1 lds
    s_add_u32 m0, s72, 12672
    s_nop 0
    buffer_load_dwordx4 v242, s[4:7], s70 offen offset:640 sc1 lds
    s_add_u32 m0, s72, 13568
    s_nop 0
    buffer_load_dwordx4 v242, s[4:7], s70 offen offset:768 sc1 lds
    s_add_u32 m0, s72, 14464
    s_nop 0
    buffer_load_dwordx4 v242, s[4:7], s70 offen offset:896 sc1 lds
    s_add_u32 m0, s72, 15360
    s_nop 0
    buffer_load_dwordx4 v242, s[4:7], s70 offen offset:1024 sc1 lds
    s_add_u32 m0, s72, 16256
    s_nop 0
    buffer_load_dwordx4 v242, s[4:7], s70 offen offset:1152 sc1 lds
    s_add_u32 s70, s70, 40960
    s_add_u32 s72, s72, s77
    s_sub_u32 s77, 0, s77
L_Bhave:
    s_waitcnt vmcnt(7) lgkmcnt(0)
    s_barrier
    ds_read_b128 v[200:203], v243 offset:8192
    ds_read_b128 v[204:207], v243 offset:28672
    ds_read_b128 v[208:211], v244 offset:8192
    ds_read_b128 v[212:215], v244 offset:28672
    s_waitcnt lgkmcnt(3)
    v_mfma_f32_16x16x32_bf16 v[168:171], a[0:3], v[200:203], 0
    ds_read_b128 v[216:219], v243 offset:9216
    v_mfma_f32_16x16x32_bf16 v[172:175], a[80:83], v[200:203], 0
    ds_read_b128 v[220:223], v243 offset:29696
    v_mfma_f32_16x16x32_bf16 v[176:179], v[200:203], a[160:163], 0
    v_mfma_f32_16x16x32_bf16 v[180:183], v[4:7], v[200:203], 0
    s_waitcnt lgkmcnt(4)
    v_mfma_f32_16x16x32_bf16 v[184:187], a[0:3], v[204:207], 0
    v_mfma_f32_16x16x32_bf16 v[188:191], a[80:83], v[204:207], 0
    v_mfma_f32_16x16x32_bf16 v[192:195], v[204:207], a[160:163], 0
    v_mfma_f32_16x16x32_bf16 v[196:199], v[4:7], v[204:207], 0
    s_waitcnt lgkmcnt(3)
    v_mfma_f32_16x16x32_bf16 v[168:171], a[4:7], v[208:211], v[168:171]
    ds_read_b128 v[200:203], v244 offset:9216
    v_mfma_f32_16x16x32_bf16 v[172:175], a[84:87], v[208:211], v[172:175]
    ds_read_b128 v[204:207], v244 offset:29696
    v_mfma_f32_16x16x32_bf16 v[176:179], v[208:211], a[164:167], v[176:179]
    v_mfma_f32_16x16x32_bf16 v[180:183], v[8:11], v[208:211], v[180:183]
    s_waitcnt lgkmcnt(4)
    v_mfma_f32_16x16x32_bf16 v[184:187], a[4:7], v[212:215], v[184:187]
    v_mfma_f32_16x16x32_bf16 v[188:191], a[84:87], v[212:215], v[188:191]
    v_mfma_f32_16x16x32_bf16 v[192:195], v[212:215], a[164:167], v[192:195]
    v_mfma_f32_16x16x32_bf16 v[196:199], v[8:11], v[212:215], v[196:199]
    s_waitcnt lgkmcnt(3)
    v_mfma_f32_16x16x32_bf16 v[168:171], a[8:11], v[216:219], v[168:171]
    ds_read_b128 v[208:211], v243 offset:10240
    v_mfma_f32_16x16x32_bf16 v[172:175], a[88:91], v[216:219], v[172:175]
    ds_read_b128 v[212:215], v243 offset:30720
    v_mfma_f32_16x16x32_bf16 v[176:179], v[216:219], a[168:171], v[176:179]
    v_mfma_f32_16x16x32_bf16 v[180:183], v[12:15], v[216:219], v[180:183]
    s_waitcnt lgkmcnt(4)
    v_mfma_f32_16x16x32_bf16 v[184:187], a[8:11], v[220:223], v[184:187]
    v_mfma_f32_16x16x32_bf16 v[188:191], a[88:91], v[220:223], v[188:191]
    v_mfma_f32_16x16x32_bf16 v[192:195], v[220:223], a[168:171], v[192:195]
    v_mfma_f32_16x16x32_bf16 v[196:199], v[12:15], v[220:223], v[196:199]
    s_waitcnt lgkmcnt(3)
    v_mfma_f32_16x16x32_bf16 v[168:171], a[12:15], v[200:203], v[168:171]
    ds_read_b128 v[216:219], v244 offset:10240
    v_mfma_f32_16x16x32_bf16 v[172:175], a[92:95], v[200:203], v[172:175]
    ds_read_b128 v[220:223], v244 offset:30720
    v_mfma_f32_16x16x32_bf16 v[176:179], v[200:203], a[172:175], v[176:179]
    v_mfma_f32_16x16x32_bf16 v[180:183], v[16:19], v[200:203], v[180:183]
    s_waitcnt lgkmcnt(4)
    v_mfma_f32_16x16x32_bf16 v[184:187], a[12:15], v[204:207], v[184:187]
    v_mfma_f32_16x16x32_bf16 v[188:191], a[92:95], v[204:207], v[188:191]
    v_mfma_f32_16x16x32_bf16 v[192:195], v[204:207], a[172:175], v[192:195]
    v_mfma_f32_16x16x32_bf16 v[196:199], v[16:19], v[204:207], v[196:199]
    s_waitcnt vmcnt(0)
    s_barrier
    s_waitcnt lgkmcnt(3)
    v_mfma_f32_16x16x32_bf16 v[168:171], a[16:19], v[208:211], v[168:171]
    ds_read_b128 v[200:203], v243 offset:11264
    v_mfma_f32_16x16x32_bf16 v[172:175], a[96:99], v[208:211], v[172:175]
    ds_read_b128 v[204:207], v243 offset:31744
    v_mfma_f32_16x16x32_bf16 v[176:179], v[208:211], a[176:179], v[176:179]
    v_mfma_f32_16x16x32_bf16 v[180:183], v[20:23], v[208:211], v[180:183]
    s_waitcnt lgkmcnt(4)
    v_mfma_f32_16x16x32_bf16 v[184:187], a[16:19], v[212:215], v[184:187]
    v_mfma_f32_16x16x32_bf16 v[188:191], a[96:99], v[212:215], v[188:191]
    v_mfma_f32_16x16x32_bf16 v[192:195], v[212:215], a[176:179], v[192:195]
    v_mfma_f32_16x16x32_bf16 v[196:199], v[20:23], v[212:215], v[196:199]
    s_waitcnt lgkmcnt(3)
    v_mfma_f32_16x16x32_bf16 v[168:171], a[20:23], v[216:219], v[168:171]
    ds_read_b128 v[208:211], v244 offset:11264
    v_mfma_f32_16x16x32_bf16 v[172:175], a[100:103], v[216:219], v[172:175]
    ds_read_b128 v[212:215], v244 offset:31744
    v_mfma_f32_16x16x32_bf16 v[176:179], v[216:219], a[180:183], v[176:179]
    v_mfma_f32_16x16x32_bf16 v[180:183], v[24:27], v[216:219], v[180:183]
    s_waitcnt lgkmcnt(4)
    v_mfma_f32_16x16x32_bf16 v[184:187], a[20:23], v[220:223], v[184:187]
    v_mfma_f32_16x16x32_bf16 v[188:191], a[100:103], v[220:223], v[188:191]
    v_mfma_f32_16x16x32_bf16 v[192:195], v[220:223], a[180:183], v[192:195]
    v_mfma_f32_16x16x32_bf16 v[196:199], v[24:27], v[220:223], v[196:199]
    s_waitcnt lgkmcnt(3)
    v_mfma_f32_16x16x32_bf16 v[168:171], a[24:27], v[200:203], v[168:171]
    ds_read_b128 v[216:219], v243 offset:12288
    v_mfma_f32_16x16x32_bf16 v[172:175], a[104:107], v[200:203], v[172:175]
    ds_read_b128 v[220:223], v243 offset:32768
    v_mfma_f32_16x16x32_bf16 v[176:179], v[200:203], a[184:187], v[176:179]
    v_mfma_f32_16x16x32_bf16 v[180:183], v[28:31], v[200:203], v[180:183]
    s_waitcnt lgkmcnt(4)
    v_mfma_f32_16x16x32_bf16 v[184:187], a[24:27], v[204:207], v[184:187]
    v_mfma_f32_16x16x32_bf16 v[188:191], a[104:107], v[204:207], v[188:191]
    v_mfma_f32_16x16x32_bf16 v[192:195], v[204:207], a[184:187], v[192:195]
    v_mfma_f32_16x16x32_bf16 v[196:199], v[28:31], v[204:207], v[196:199]
    s_waitcnt lgkmcnt(3)
    v_mfma_f32_16x16x32_bf16 v[168:171], a[28:31], v[208:211], v[168:171]
    ds_read_b128 v[200:203], v244 offset:12288
    v_mfma_f32_16x16x32_bf16 v[172:175], a[108:111], v[208:211], v[172:175]
    ds_read_b128 v[204:207], v244 offset:32768
    v_mfma_f32_16x16x32_bf16 v[176:179], v[208:211], a[188:191], v[176:179]
    v_mfma_f32_16x16x32_bf16 v[180:183], v[32:35], v[208:211], v[180:183]
    s_waitcnt lgkmcnt(4)
    v_mfma_f32_16x16x32_bf16 v[184:187], a[28:31], v[212:215], v[184:187]
    v_mfma_f32_16x16x32_bf16 v[188:191], a[108:111], v[212:215], v[188:191]
    v_mfma_f32_16x16x32_bf16 v[192:195], v[212:215], a[188:191], v[192:195]
    v_mfma_f32_16x16x32_bf16 v[196:199], v[32:35], v[212:215], v[196:199]
    s_waitcnt lgkmcnt(3)
    v_mfma_f32_16x16x32_bf16 v[168:171], a[32:35], v[216:219], v[168:171]
    ds_read_b128 v[208:211], v243 offset:13312
    v_mfma_f32_16x16x32_bf16 v[172:175], a[112:115], v[216:219], v[172:175]
    ds_read_b128 v[212:215], v243 offset:33792
    v_mfma_f32_16x16x32_bf16 v[176:179], v[216:219], a[192:195], v[176:179]
    v_mfma_f32_16x16x32_bf16 v[180:183], v[36:39], v[216:219], v[180:183]
    s_waitcnt lgkmcnt(4)
    v_mfma_f32_16x16x32_bf16 v[184:187], a[32:35], v[220:223], v[184:187]
    v_mfma_f32_16x16x32_bf16 v[188:191], a[112:115], v[220:223], v[188:191]
    v_mfma_f32_16x16x32_bf16 v[192:195], v[220:223], a[192:195], v[192:195]
    v_mfma_f32_16x16x32_bf16 v[196:199], v[36:39], v[220:223], v[196:199]
    s_waitcnt lgkmcnt(3)
    v_mfma_f32_16x16x32_bf16 v[168:171], a[36:39], v[200:203], v[168:171]
    ds_read_b128 v[216:219], v244 offset:13312
    v_mfma_f32_16x16x32_bf16 v[172:175], a[116:119], v[200:203], v[172:175]
    ds_read_b128 v[220:223], v244 offset:33792
    v_mfma_f32_16x16x32_bf16 v[176:179], v[200:203], a[196:199], v[176:179]
    v_mfma_f32_16x16x32_bf16 v[180:183], v[40:43], v[200:203], v[180:183]
    s_waitcnt lgkmcnt(4)
    v_mfma_f32_16x16x32_bf16 v[184:187], a[36:39], v[204:207], v[184:187]
    v_mfma_f32_16x16x32_bf16 v[188:191], a[116:119], v[204:207], v[188:191]
    v_mfma_f32_16x16x32_bf16 v[192:195], v[204:207], a[196:199], v[192:195]
    v_mfma_f32_16x16x32_bf16 v[196:199], v[40:43], v[204:207], v[196:199]
    s_waitcnt lgkmcnt(3)
    v_mfma_f32_16x16x32_bf16 v[168:171], a[40:43], v[208:211], v[168:171]
    ds_read_b128 v[200:203], v243 offset:14336
    v_mfma_f32_16x16x32_bf16 v[172:175], a[120:123], v[208:211], v[172:175]
    ds_read_b128 v[204:207], v243 offset:34816
    v_mfma_f32_16x16x32_bf16 v[176:179], v[208:211], a[200:203], v[176:179]
    v_mfma_f32_16x16x32_bf16 v[180:183], v[44:47], v[208:211], v[180:183]
    s_waitcnt lgkmcnt(4)
    v_mfma_f32_16x16x32_bf16 v[184:187], a[40:43], v[212:215], v[184:187]
    v_mfma_f32_16x16x32_bf16 v[188:191], a[120:123], v[212:215], v[188:191]
    v_mfma_f32_16x16x32_bf16 v[192:195], v[212:215], a[200:203], v[192:195]
    v_mfma_f32_16x16x32_bf16 v[196:199], v[44:47], v[212:215], v[196:199]
    s_waitcnt lgkmcnt(3)
    v_mfma_f32_16x16x32_bf16 v[168:171], a[44:47], v[216:219], v[168:171]
    ds_read_b128 v[208:211], v244 offset:14336
    v_mfma_f32_16x16x32_bf16 v[172:175], a[124:127], v[216:219], v[172:175]
    ds_read_b128 v[212:215], v244 offset:34816
    v_mfma_f32_16x16x32_bf16 v[176:179], v[216:219], a[204:207], v[176:179]
    v_mfma_f32_16x16x32_bf16 v[180:183], v[48:51], v[216:219], v[180:183]
    s_waitcnt lgkmcnt(4)
    v_mfma_f32_16x16x32_bf16 v[184:187], a[44:47], v[220:223], v[184:187]
    v_mfma_f32_16x16x32_bf16 v[188:191], a[124:127], v[220:223], v[188:191]
    v_mfma_f32_16x16x32_bf16 v[192:195], v[220:223], a[204:207], v[192:195]
    v_mfma_f32_16x16x32_bf16 v[196:199], v[48:51], v[220:223], v[196:199]
    s_waitcnt lgkmcnt(3)
    v_mfma_f32_16x16x32_bf16 v[168:171], a[48:51], v[200:203], v[168:171]
    ds_read_b128 v[216:219], v243 offset:15360
    v_mfma_f32_16x16x32_bf16 v[172:175], a[128:131], v[200:203], v[172:175]
    ds_read_b128 v[220:223], v243 offset:35840
    v_mfma_f32_16x16x32_bf16 v[176:179], v[200:203], a[208:211], v[176:179]
    v_mfma_f32_16x16x32_bf16 v[180:183], v[52:55], v[200:203], v[180:183]
    s_waitcnt lgkmcnt(4)
    v_mfma_f32_16x16x32_bf16 v[184:187], a[48:51], v[204:207], v[184:187]
    v_mfma_f32_16x16x32_bf16 v[188:191], a[128:131], v[204:207], v[188:191]
    v_mfma_f32_16x16x32_bf16 v[192:195], v[204:207], a[208:211], v[192:195]
    v_mfma_f32_16x16x32_bf16 v[196:199], v[52:55], v[204:207], v[196:199]
    s_waitcnt lgkmcnt(3)
    v_mfma_f32_16x16x32_bf16 v[168:171], a[52:55], v[208:211], v[168:171]
    ds_read_b128 v[200:203], v244 offset:15360
    v_mfma_f32_16x16x32_bf16 v[172:175], a[132:135], v[208:211], v[172:175]
    ds_read_b128 v[204:207], v244 offset:35840
    v_mfma_f32_16x16x32_bf16 v[176:179], v[208:211], a[212:215], v[176:179]
    v_mfma_f32_16x16x32_bf16 v[180:183], v[56:59], v[208:211], v[180:183]
    s_waitcnt lgkmcnt(4)
    v_mfma_f32_16x16x32_bf16 v[184:187], a[52:55], v[212:215], v[184:187]
    v_mfma_f32_16x16x32_bf16 v[188:191], a[132:135], v[212:215], v[188:191]
    v_mfma_f32_16x16x32_bf16 v[192:195], v[212:215], a[212:215], v[192:195]
    v_mfma_f32_16x16x32_bf16 v[196:199], v[56:59], v[212:215], v[196:199]
    s_waitcnt lgkmcnt(3)
    v_mfma_f32_16x16x32_bf16 v[168:171], a[56:59], v[216:219], v[168:171]
    ds_read_b128 v[208:211], v243 offset:16384
    v_mfma_f32_16x16x32_bf16 v[172:175], a[136:139], v[216:219], v[172:175]
    ds_read_b128 v[212:215], v243 offset:36864
    v_mfma_f32_16x16x32_bf16 v[176:179], v[216:219], a[216:219], v[176:179]
    v_mfma_f32_16x16x32_bf16 v[180:183], v[60:63], v[216:219], v[180:183]
    s_waitcnt lgkmcnt(4)
    v_mfma_f32_16x16x32_bf16 v[184:187], a[56:59], v[220:223], v[184:187]
    v_mfma_f32_16x16x32_bf16 v[188:191], a[136:139], v[220:223], v[188:191]
    v_mfma_f32_16x16x32_bf16 v[192:195], v[220:223], a[216:219], v[192:195]
    v_mfma_f32_16x16x32_bf16 v[196:199], v[60:63], v[220:223], v[196:199]
    s_waitcnt lgkmcnt(3)
    v_mfma_f32_16x16x32_bf16 v[168:171], a[60:63], v[200:203], v[168:171]
    ds_read_b128 v[216:219], v244 offset:16384
    v_mfma_f32_16x16x32_bf16 v[172:175], a[140:143], v[200:203], v[172:175]
    ds_read_b128 v[220:223], v244 offset:36864
    v_mfma_f32_16x16x32_bf16 v[176:179], v[200:203], a[220:223], v[176:179]
    v_mfma_f32_16x16x32_bf16 v[180:183], v[64:67], v[200:203], v[180:183]
    s_waitcnt lgkmcnt(4)
    v_mfma_f32_16x16x32_bf16 v[184:187], a[60:63], v[204:207], v[184:187]
    v_mfma_f32_16x16x32_bf16 v[188:191], a[140:143], v[204:207], v[188:191]
    v_mfma_f32_16x16x32_bf16 v[192:195], v[204:207], a[220:223], v[192:195]
    v_mfma_f32_16x16x32_bf16 v[196:199], v[64:67], v[204:207], v[196:199]
    s_waitcnt lgkmcnt(3)
    v_mfma_f32_16x16x32_bf16 v[168:171], a[64:67], v[208:211], v[168:171]
    ds_read_b128 v[200:203], v243 offset:17408
    v_mfma_f32_16x16x32_bf16 v[172:175], a[144:147], v[208:211], v[172:175]
    ds_read_b128 v[204:207], v243 offset:37888
    v_mfma_f32_16x16x32_bf16 v[176:179], v[208:211], a[224:227], v[176:179]
    v_mfma_f32_16x16x32_bf16 v[180:183], v[68:71], v[208:211], v[180:183]
    s_waitcnt lgkmcnt(4)
    v_mfma_f32_16x16x32_bf16 v[184:187], a[64:67], v[212:215], v[184:187]
    v_mfma_f32_16x16x32_bf16 v[188:191], a[144:147], v[212:215], v[188:191]
    v_mfma_f32_16x16x32_bf16 v[192:195], v[212:215], a[224:227], v[192:195]
    v_mfma_f32_16x16x32_bf16 v[196:199], v[68:71], v[212:215], v[196:199]
    s_waitcnt lgkmcnt(3)
    v_mfma_f32_16x16x32_bf16 v[168:171], a[68:71], v[216:219], v[168:171]
    ds_read_b128 v[208:211], v244 offset:17408
    v_mfma_f32_16x16x32_bf16 v[172:175], a[148:151], v[216:219], v[172:175]
    ds_read_b128 v[212:215], v244 offset:37888
    v_mfma_f32_16x16x32_bf16 v[176:179], v[216:219], a[228:231], v[176:179]
    v_mfma_f32_16x16x32_bf16 v[180:183], v[72:75], v[216:219], v[180:183]
    s_waitcnt lgkmcnt(4)
    v_mfma_f32_16x16x32_bf16 v[184:187], a[68:71], v[220:223], v[184:187]
    v_mfma_f32_16x16x32_bf16 v[188:191], a[148:151], v[220:223], v[188:191]
    v_mfma_f32_16x16x32_bf16 v[192:195], v[220:223], a[228:231], v[192:195]
    v_mfma_f32_16x16x32_bf16 v[196:199], v[72:75], v[220:223], v[196:199]
    s_waitcnt lgkmcnt(3)
    v_mfma_f32_16x16x32_bf16 v[168:171], a[72:75], v[200:203], v[168:171]
    v_mfma_f32_16x16x32_bf16 v[172:175], a[152:155], v[200:203], v[172:175]
    v_mfma_f32_16x16x32_bf16 v[176:179], v[200:203], a[232:235], v[176:179]
    v_mfma_f32_16x16x32_bf16 v[180:183], v[76:79], v[200:203], v[180:183]
    s_waitcnt lgkmcnt(2)
    v_mfma_f32_16x16x32_bf16 v[184:187], a[72:75], v[204:207], v[184:187]
    v_mfma_f32_16x16x32_bf16 v[188:191], a[152:155], v[204:207], v[188:191]
    v_mfma_f32_16x16x32_bf16 v[192:195], v[204:207], a[232:235], v[192:195]
    v_mfma_f32_16x16x32_bf16 v[196:199], v[76:79], v[204:207], v[196:199]
    s_waitcnt lgkmcnt(1)
    v_mfma_f32_16x16x32_bf16 v[168:171], a[76:79], v[208:211], v[168:171]
    v_mfma_f32_16x16x32_bf16 v[172:175], a[156:159], v[208:211], v[172:175]
    v_mfma_f32_16x16x32_bf16 v[176:179], v[208:211], a[236:239], v[176:179]
    v_mfma_f32_16x16x32_bf16 v[180:183], v[80:83], v[208:211], v[180:183]
    s_waitcnt lgkmcnt(0)
    v_mfma_f32_16x16x32_bf16 v[184:187], a[76:79], v[212:215], v[184:187]
    v_mfma_f32_16x16x32_bf16 v[188:191], a[156:159], v[212:215], v[188:191]
    v_mfma_f32_16x16x32_bf16 v[192:195], v[212:215], a[236:239], v[192:195]
    v_mfma_f32_16x16x32_bf16 v[196:199], v[80:83], v[212:215], v[196:199]
    buffer_load_dwordx4 v[252:255], v251, s[4:7], 0 offen sc1
    v_add_u32 v243, s76, v243
    v_add_u32 v244, s76, v244
    s_sub_u32 s76, 0, s76
    v_mfma_f32_16x16x4_f32 v[216:219], v182, v240, 0
    v_cvt_pk_bf16_f32 v200, v168, v169
    v_cvt_pk_bf16_f32 v201, v170, v171
    v_cvt_pk_bf16_f32 v202, v180, 0
    v_mov_b32 v203, 0
    v_cvt_pk_bf16_f32 v208, v172, v173
    v_cvt_pk_bf16_f32 v209, v174, v175
    v_cvt_pk_bf16_f32 v210, v181, 0
    v_mov_b32 v211, 0
    v_cvt_pk_bf16_f32 v230, v176, v177
    v_cvt_pk_bf16_f32 v231, v178, v179
    ds_read_b128 v[168:171], v246 offset:5120
    ds_read_b128 v[172:175], v245 offset:6144
    v_mfma_f32_16x16x4_f32 v[220:223], v198, v240, 0
    v_cvt_pk_bf16_f32 v204, v184, v185
    v_cvt_pk_bf16_f32 v205, v186, v187
    v_cvt_pk_bf16_f32 v206, v196, 0
    v_mov_b32 v207, 0
    v_cvt_pk_bf16_f32 v212, v188, v189
    v_cvt_pk_bf16_f32 v213, v190, v191
    v_cvt_pk_bf16_f32 v214, v197, 0
    v_mov_b32 v215, 0
    v_cvt_pk_bf16_f32 v232, v192, v193
    v_cvt_pk_bf16_f32 v233, v194, v195
    ds_read_b128 v[184:187], v245 offset:5120
    ds_read_b128 v[188:191], v245 offset:6144
    v_cvt_pk_bf16_f32 v236, v216, v217
    v_cvt_pk_bf16_f32 v237, v218, v219
    v_or_b32 v236, v241, v236
    v_or_b32 v237, v241, v237
    v_cvt_pk_bf16_f32 v238, v220, v221
    v_cvt_pk_bf16_f32 v239, v222, v223
    v_or_b32 v238, v241, v238
    v_or_b32 v239, v241, v239
    s_waitcnt lgkmcnt(3)
    v_mfma_f32_16x16x32_bf16 v[168:171], v[224:227], v[200:203], v[168:171]
    s_waitcnt lgkmcnt(2)
    v_mfma_f32_16x16x32_bf16 v[172:175], v[208:211], v[200:203], v[172:175]
    s_waitcnt lgkmcnt(1)
    v_mfma_f32_16x16x32_bf16 v[184:187], v[208:211], v[204:207], v[184:187]
    s_waitcnt lgkmcnt(0)
    v_mfma_f32_16x16x32_bf16 v[188:191], v[212:215], v[204:207], v[188:191]
    v_mov_b32 v246, v245
    v_mov_b32 v224, v212
    v_mov_b32 v225, v213
    v_mov_b32 v226, v214
    v_max3_f32 v216, v168, v169, v170
    s_nop 0
    v_max3_f32 v218, v184, v185, v186
    v_max3_f32 v217, v171, v172, v173
    v_max3_f32 v219, v187, v188, v189
    v_max3_f32 v216, v216, v174, v175
    v_max3_f32 v218, v218, v190, v191
    v_max_f32 v216, v216, v217
    v_max_f32 v218, v218, v219
    v_mov_b32 v217, v216
    v_mov_b32 v219, v218
    s_nop 0
    v_permlane16_swap_b32 v216, v217
    v_permlane16_swap_b32 v218, v219
    v_max_f32 v216, v216, v217
    v_max_f32 v218, v218, v219
    v_mov_b32 v217, v216
    v_mov_b32 v219, v218
    s_nop 0
    v_permlane32_swap_b32 v216, v217
    v_permlane32_swap_b32 v218, v219
    v_max_f32 v216, v216, v217
    v_max_f32 v218, v218, v219
    v_mul_f32 v216, s75, v216
    v_mul_f32 v218, s75, v218
    v_fma_f32 v168, v168, s75, -v216
    v_fma_f32 v184, v184, s75, -v218
    v_fma_f32 v169, v169, s75, -v216
    v_fma_f32 v185, v185, s75, -v218
    v_fma_f32 v170, v170, s75, -v216
    v_fma_f32 v186, v186, s75, -v218
    v_fma_f32 v171, v171, s75, -v216
    v_fma_f32 v187, v187, s75, -v218
    v_fma_f32 v172, v172, s75, -v216
    v_fma_f32 v188, v188, s75, -v218
    v_fma_f32 v173, v173, s75, -v216
    v_fma_f32 v189, v189, s75, -v218
    v_fma_f32 v174, v174, s75, -v216
    v_fma_f32 v190, v190, s75, -v218
    v_fma_f32 v175, v175, s75, -v216
    v_fma_f32 v191, v191, s75, -v218
    v_exp_f32 v168, v168
    v_exp_f32 v184, v184
    v_exp_f32 v169, v169
    v_exp_f32 v185, v185
    v_exp_f32 v170, v170
    v_exp_f32 v186, v186
    v_exp_f32 v171, v171
    v_exp_f32 v187, v187
    v_exp_f32 v172, v172
    v_exp_f32 v188, v188
    v_exp_f32 v173, v173
    v_exp_f32 v189, v189
    v_exp_f32 v174, v174
    v_exp_f32 v190, v190
    v_exp_f32 v175, v175
    v_exp_f32 v191, v191
    v_cvt_pk_bf16_f32 v168, v168, v169
    v_cvt_pk_bf16_f32 v184, v184, v185
    v_cvt_pk_bf16_f32 v169, v170, v171
    v_cvt_pk_bf16_f32 v185, v186, v187
    v_cvt_pk_bf16_f32 v170, v172, v173
    v_cvt_pk_bf16_f32 v186, v188, v189
    v_cvt_pk_bf16_f32 v171, v174, v175
    v_cvt_pk_bf16_f32 v187, v190, v191
    s_nop 0
    v_mfma_f32_16x16x32_bf16 v[180:183], v[234:237], v[168:171], 0
    v_mfma_f32_16x16x32_bf16 v[196:199], v[236:239], v[184:187], 0
    v_mfma_f32_16x16x32_bf16 v[176:179], v[228:231], v[168:171], 0
    v_mfma_f32_16x16x32_bf16 v[192:195], v[230:233], v[184:187], 0
    v_mov_b32 v228, v232
    v_mov_b32 v229, v233
    v_mov_b32 v234, v238
    v_mov_b32 v235, v239
    s_mov_b32 s73, 0
    s_add_u32 s65, s62, 2
    v_rcp_f32 v181, v181
    v_rcp_f32 v197, v197
    v_mul_f32 v176, v176, v181
    v_mul_f32 v192, v192, v197
    v_mul_f32 v177, v177, v181
    v_mul_f32 v193, v193, v197
    v_mul_f32 v178, v178, v181
    v_mul_f32 v194, v194, v197
    v_mul_f32 v179, v179, v181
    v_mul_f32 v195, v195, v197
    v_mul_f32 v180, v180, v181
    v_mul_f32 v196, v196, v197
    v_cvt_pk_bf16_f32 v168, v176, v177
    v_cvt_pk_bf16_f32 v184, v192, v193
    v_cvt_pk_bf16_f32 v169, v178, v179
    v_cvt_pk_bf16_f32 v185, v194, v195
    v_cvt_pk_bf16_f32 v170, v180, v180
    v_cvt_pk_bf16_f32 v186, v196, v196
    ds_write_b64 v247, v[168:169] offset:0
    ds_write_b64 v247, v[184:185] offset:2048
    ds_write_b16 v248, v170 offset:4096
    ds_write_b16 v248, v186 offset:4608
    v_lshrrev_b32 v3, 1, v245
    s_waitcnt lgkmcnt(0)
    s_barrier
    ds_read_b64 v[208:209], v3 offset:4096
    ds_read_b128 v[200:203], v245 offset:0
    ds_read_b128 v[204:207], v245 offset:1024
    ds_read_b64 v[218:219], v3 offset:4608
    ds_read_b128 v[210:213], v245 offset:2048
    ds_read_b128 v[214:217], v245 offset:3072
Lfchk_48:
    s_waitcnt vmcnt(0)
    v_min3_u32 v2, v252, v253, v254
    v_min_u32 v2, v2, v255
    v_cmp_gt_u32 vcc, s65, v2
    s_cbranch_vccnz L_Bnopre
    s_mov_b32 s73, 1
    s_add_u32 m0, s72, 8192
    s_nop 0
    buffer_load_dwordx4 v242, s[4:7], s70 offen offset:0 sc1 lds
    s_add_u32 m0, s72, 9088
    s_nop 0
    buffer_load_dwordx4 v242, s[4:7], s70 offen offset:128 sc1 lds
    s_add_u32 m0, s72, 9984
    s_nop 0
    buffer_load_dwordx4 v242, s[4:7], s70 offen offset:256 sc1 lds
    s_add_u32 m0, s72, 10880
    s_nop 0
    buffer_load_dwordx4 v242, s[4:7], s70 offen offset:384 sc1 lds
    s_add_u32 m0, s72, 11776
    s_nop 0
    buffer_load_dwordx4 v242, s[4:7], s70 offen offset:512 sc1 lds
    s_add_u32 m0, s72, 12672
    s_nop 0
    buffer_load_dwordx4 v242, s[4:7], s70 offen offset:640 sc1 lds
    s_add_u32 m0, s72, 13568
    s_nop 0
    buffer_load_dwordx4 v242, s[4:7], s70 offen offset:768 sc1 lds
    s_add_u32 m0, s72, 14464
    s_nop 0
    buffer_load_dwordx4 v242, s[4:7], s70 offen offset:896 sc1 lds
    s_add_u32 m0, s72, 15360
    s_nop 0
    buffer_load_dwordx4 v242, s[4:7], s70 offen offset:1024 sc1 lds
    s_add_u32 m0, s72, 16256
    s_nop 0
    buffer_load_dwordx4 v242, s[4:7], s70 offen offset:1152 sc1 lds
    s_add_u32 s70, s70, 40960
    s_add_u32 s72, s72, s77
    s_sub_u32 s77, 0, s77
L_Bnopre:
    s_add_u32 s65, s71, 5120
    s_waitcnt lgkmcnt(5)
    v_mfma_f32_16x16x16_bf16 v[168:171], a[240:241], v[208:209], 0
    v_mfma_f32_16x16x16_bf16 v[172:175], a[242:243], v[208:209], 0
    v_mfma_f32_16x16x16_bf16 v[176:179], a[244:245], v[208:209], 0
    v_mfma_f32_16x16x16_bf16 v[180:183], a[246:247], v[208:209], 0
    v_mfma_f32_16x16x16_bf16 v[220:223], a[248:249], v[208:209], 0
    s_waitcnt lgkmcnt(4)
    s_nop 0
    v_mfma_f32_16x16x32_bf16 v[168:171], v[84:87], v[200:203], v[168:171]
    v_mfma_f32_16x16x32_bf16 v[172:175], v[92:95], v[200:203], v[172:175]
    v_mfma_f32_16x16x32_bf16 v[176:179], v[100:103], v[200:203], v[176:179]
    v_mfma_f32_16x16x32_bf16 v[180:183], v[108:111], v[200:203], v[180:183]
    v_mfma_f32_16x16x32_bf16 v[220:223], v[116:119], v[200:203], v[220:223]
    s_waitcnt lgkmcnt(3)
    v_mfma_f32_16x16x32_bf16 v[168:171], v[88:91], v[204:207], v[168:171]
    v_mfma_f32_16x16x32_bf16 v[172:175], v[96:99], v[204:207], v[172:175]
    v_mfma_f32_16x16x32_bf16 v[176:179], v[104:107], v[204:207], v[176:179]
    v_mfma_f32_16x16x32_bf16 v[180:183], v[112:115], v[204:207], v[180:183]
    v_mfma_f32_16x16x32_bf16 v[220:223], v[120:123], v[204:207], v[220:223]
    v_mfma_f32_16x16x16_bf16 v[184:187], a[250:251], v[208:209], 0
    v_mfma_f32_16x16x16_bf16 v[188:191], a[252:253], v[208:209], 0
    s_nop 1
    v_cvt_pk_bf16_f32 v168, v168, v169
    v_mfma_f32_16x16x16_bf16 v[192:195], a[254:255], v[208:209], 0
    v_cvt_pk_bf16_f32 v169, v170, v171
    v_mfma_f32_16x16x16_bf16 v[196:199], v[164:165], v[208:209], 0
    v_cvt_pk_bf16_f32 v170, v172, v173
    v_mfma_f32_16x16x16_bf16 v[252:255], v[166:167], v[208:209], 0
    v_cvt_pk_bf16_f32 v171, v174, v175
    v_mfma_f32_16x16x32_bf16 v[184:187], v[124:127], v[200:203], v[184:187]
    buffer_store_dwordx4 v[168:171], v249, s[4:7], s71 offen offset:0 sc1
    v_mfma_f32_16x16x32_bf16 v[188:191], v[132:135], v[200:203], v[188:191]
    v_cvt_pk_bf16_f32 v176, v176, v177
    v_mfma_f32_16x16x32_bf16 v[192:195], v[140:143], v[200:203], v[192:195]
    v_cvt_pk_bf16_f32 v177, v178, v179
    v_mfma_f32_16x16x32_bf16 v[196:199], v[148:151], v[200:203], v[196:199]
    v_cvt_pk_bf16_f32 v178, v180, v181
    v_mfma_f32_16x16x32_bf16 v[252:255], v[156:159], v[200:203], v[252:255]
    v_cvt_pk_bf16_f32 v179, v182, v183
    v_mfma_f32_16x16x32_bf16 v[184:187], v[128:131], v[204:207], v[184:187]
    buffer_store_dwordx4 v[176:179], v249, s[4:7], s71 offen offset:2048 sc1
    v_mfma_f32_16x16x32_bf16 v[188:191], v[136:139], v[204:207], v[188:191]
    v_cvt_pk_bf16_f32 v220, v220, v221
    v_mfma_f32_16x16x32_bf16 v[192:195], v[144:147], v[204:207], v[192:195]
    v_cvt_pk_bf16_f32 v221, v222, v223
    v_mfma_f32_16x16x32_bf16 v[196:199], v[152:155], v[204:207], v[196:199]
    buffer_store_dwordx2 v[220:221], v250, s[4:7], s71 offen offset:0 sc1
    v_mfma_f32_16x16x32_bf16 v[252:255], v[160:163], v[204:207], v[252:255]
    s_waitcnt lgkmcnt(2)
    v_mfma_f32_16x16x16_bf16 v[168:171], a[240:241], v[218:219], 0
    v_mfma_f32_16x16x16_bf16 v[172:175], a[242:243], v[218:219], 0
    v_cvt_pk_bf16_f32 v184, v184, v185
    v_mfma_f32_16x16x16_bf16 v[176:179], a[244:245], v[218:219], 0
    v_cvt_pk_bf16_f32 v185, v186, v187
    v_mfma_f32_16x16x16_bf16 v[180:183], a[246:247], v[218:219], 0
    v_cvt_pk_bf16_f32 v186, v188, v189
    v_mfma_f32_16x16x16_bf16 v[220:223], a[248:249], v[218:219], 0
    v_cvt_pk_bf16_f32 v187, v190, v191
    s_waitcnt lgkmcnt(1)
    v_mfma_f32_16x16x32_bf16 v[168:171], v[84:87], v[210:213], v[168:171]
    buffer_store_dwordx4 v[184:187], v249, s[4:7], s65 offen offset:0 sc1
    v_mfma_f32_16x16x32_bf16 v[172:175], v[92:95], v[210:213], v[172:175]
    v_cvt_pk_bf16_f32 v192, v192, v193
    v_mfma_f32_16x16x32_bf16 v[176:179], v[100:103], v[210:213], v[176:179]
    v_cvt_pk_bf16_f32 v193, v194, v195
    v_mfma_f32_16x16x32_bf16 v[180:183], v[108:111], v[210:213], v[180:183]
    v_cvt_pk_bf16_f32 v194, v196, v197
    v_mfma_f32_16x16x32_bf16 v[220:223], v[116:119], v[210:213], v[220:223]
    v_cvt_pk_bf16_f32 v195, v198, v199
    s_waitcnt lgkmcnt(0)
    v_mfma_f32_16x16x32_bf16 v[168:171], v[88:91], v[214:217], v[168:171]
    buffer_store_dwordx4 v[192:195], v249, s[4:7], s65 offen offset:2048 sc1
    v_mfma_f32_16x16x32_bf16 v[172:175], v[96:99], v[214:217], v[172:175]
    v_cvt_pk_bf16_f32 v252, v252, v253
    v_mfma_f32_16x16x32_bf16 v[176:179], v[104:107], v[214:217], v[176:179]
    v_cvt_pk_bf16_f32 v253, v254, v255
    v_mfma_f32_16x16x32_bf16 v[180:183], v[112:115], v[214:217], v[180:183]
    buffer_store_dwordx2 v[252:253], v250, s[4:7], s65 offen offset:0 sc1
    v_mfma_f32_16x16x32_bf16 v[220:223], v[120:123], v[214:217], v[220:223]
    v_mfma_f32_16x16x16_bf16 v[184:187], a[250:251], v[218:219], 0
    v_mfma_f32_16x16x16_bf16 v[188:191], a[252:253], v[218:219], 0
    v_cvt_pk_bf16_f32 v168, v168, v169
    v_mfma_f32_16x16x16_bf16 v[192:195], a[254:255], v[218:219], 0
    v_cvt_pk_bf16_f32 v169, v170, v171
    v_mfma_f32_16x16x16_bf16 v[196:199], v[164:165], v[218:219], 0
    v_cvt_pk_bf16_f32 v170, v172, v173
    v_mfma_f32_16x16x16_bf16 v[252:255], v[166:167], v[218:219], 0
    v_cvt_pk_bf16_f32 v171, v174, v175
    v_mfma_f32_16x16x32_bf16 v[184:187], v[124:127], v[210:213], v[184:187]
    buffer_store_dwordx4 v[168:171], v249, s[4:7], s71 offen offset:1024 sc1
    v_mfma_f32_16x16x32_bf16 v[188:191], v[132:135], v[210:213], v[188:191]
    v_cvt_pk_bf16_f32 v176, v176, v177
    v_mfma_f32_16x16x32_bf16 v[192:195], v[140:143], v[210:213], v[192:195]
    v_cvt_pk_bf16_f32 v177, v178, v179
    v_mfma_f32_16x16x32_bf16 v[196:199], v[148:151], v[210:213], v[196:199]
    v_cvt_pk_bf16_f32 v178, v180, v181
    v_mfma_f32_16x16x32_bf16 v[252:255], v[156:159], v[210:213], v[252:255]
    v_cvt_pk_bf16_f32 v179, v182, v183
    v_mfma_f32_16x16x32_bf16 v[184:187], v[128:131], v[214:217], v[184:187]
    buffer_store_dwordx4 v[176:179], v249, s[4:7], s71 offen offset:3072 sc1
    v_mfma_f32_16x16x32_bf16 v[188:191], v[136:139], v[214:217], v[188:191]
    v_cvt_pk_bf16_f32 v220, v220, v221
    v_mfma_f32_16x16x32_bf16 v[192:195], v[144:147], v[214:217], v[192:195]
    v_cvt_pk_bf16_f32 v221, v222, v223
    v_mfma_f32_16x16x32_bf16 v[196:199], v[152:155], v[214:217], v[196:199]
    buffer_store_dwordx2 v[220:221], v250, s[4:7], s71 offen offset:512 sc1
    v_mfma_f32_16x16x32_bf16 v[252:255], v[160:163], v[214:217], v[252:255]
    v_cvt_pk_bf16_f32 v184, v184, v185
    v_cvt_pk_bf16_f32 v185, v186, v187
    v_cvt_pk_bf16_f32 v186, v188, v189
    v_cvt_pk_bf16_f32 v187, v190, v191
    buffer_store_dwordx4 v[184:187], v249, s[4:7], s65 offen offset:1024 sc1
    v_cvt_pk_bf16_f32 v192, v192, v193
    v_cvt_pk_bf16_f32 v193, v194, v195
    v_cvt_pk_bf16_f32 v194, v196, v197
    v_cvt_pk_bf16_f32 v195, v198, v199
    buffer_store_dwordx4 v[192:195], v249, s[4:7], s65 offen offset:3072 sc1
    v_cvt_pk_bf16_f32 v252, v252, v253
    v_cvt_pk_bf16_f32 v253, v254, v255
    buffer_store_dwordx2 v[252:253], v250, s[4:7], s65 offen offset:512 sc1
    s_add_u32 s71, s71, 327680
    s_waitcnt vmcnt(0)
    s_add_u32 s64, s62, 1
    v_mov_b32 v2, s64
    s_mov_b64 exec, 1
    buffer_store_dword v2, off, s[4:7], s63 sc1
    s_mov_b64 exec, -1
    s_add_u32 s62, s62, 1
    s_cmp_lt_u32 s62, 64
    s_cbranch_scc1 L_Bseg
    s_endpgm
Lgrty_45:
    s_sleep 4
    buffer_load_dword v2, v3, s[8:11], 0 offen sc1
    s_sub_u32 s61, s61, 1
    s_mov_b32 s67, 1
    s_cbranch_scc1 L_fail
    s_branch Lgchk_44
Lfrty_47:
    s_sleep 1
    buffer_load_dwordx4 v[252:255], v251, s[4:7], 0 offen sc1
    s_sub_u32 s61, s61, 1
    s_mov_b32 s67, 30
    s_cbranch_scc1 L_fail
    s_waitcnt vmcnt(0)
    s_branch Lfchk_46
L_roleR:
    v_mov_b32 v2, 0
    v_mov_b32 v3, s63
    buffer_store_dword v2, v3, s[4:7], 0 offen sc1
    s_waitcnt vmcnt(0)
    s_barrier
    s_cmp_lg_u32 s60, 0
    s_cbranch_scc1 Larr_50
    s_mov_b64 exec, 1
    v_mov_b32 v2, 1
    v_mov_b32 v3, 20
    buffer_atomic_add v2, v3, s[8:11], 0 offen
    s_mov_b64 exec, -1
Larr_50:
    s_and_b32 s64, s59, 1
    s_lshl_b32 s74, s68, 1
    s_add_u32 s74, s74, s64
    s_cmp_eq_u32 s74, 0
    s_cselect_b32 s16, s32, s56
    s_cselect_b32 s17, s33, s57
    s_cselect_b32 s18, 2621440, s6
    s_mov_b32 s19, 0x20000
    s_cmp_eq_u32 s74, 3
    s_cselect_b32 s20, s52, s56
    s_cselect_b32 s21, s53, s57
    s_cselect_b32 s22, 2621440, s6
    s_mov_b32 s23, 0x20000
    s_mov_b32 s71, 0
    s_mov_b32 s72, 29360128
    s_mov_b32 s73, 23068672
    s_cmp_eq_u32 s74, 1
    s_cselect_b32 s71, 29360128, s71
    s_cselect_b32 s72, 35651584, s72
    s_cselect_b32 s73, 19398656, s73
    s_cmp_eq_u32 s74, 2
    s_cselect_b32 s71, 35651584, s71
    s_cselect_b32 s72, 31981568, s72
    s_cselect_b32 s73, 25690112, s73
    s_cmp_eq_u32 s74, 3
    s_cselect_b32 s71, 31981568, s71
    s_cselect_b32 s72, 0, s72
    s_cselect_b32 s73, 0, s73
    s_mov_b32 s70, 134217728
    s_cmp_eq_u32 s64, 0
    s_cselect_b32 s70, 92274688, s70
    s_cselect_b32 s65, 24, 28
    s_cselect_b32 s66, 3, 1
    s_mul_i32 s64, s68, 20971520
    s_add_u32 s70, s70, s64
    v_lshrrev_b32 v96, 5, v0
    s_lshl_b32 s64, s69, 3
    v_add_u32 v96, s64, v96
    v_and_b32 v97, 31, v0
    v_mul_u32_u24 v98, 1280, v96
    v_lshl_add_u32 v122, v97, 4, v98
    v_lshl_add_u32 v123, v97, 3, v98
    v_lshrrev_b32 v98, 2, v97
    v_mul_u32_u24 v98, 5120, v98
    v_and_b32 v99, 3, v97
    v_lshlrev_b32 v99, 3, v99
    v_lshl_add_u32 v99, v96, 5, v99
    v_lshl_add_u32 v120, v99, 1, v98
    v_add_u32 v121, v99, v98
    v_add_u32 v121, 4096, v121
    v_and_b32 v98, s66, v0
    v_add_u32 v98, s65, v98
    v_bfe_u32 v99, v0, 2, 2
    v_lshl_add_u32 v98, v99, 5, v98
    s_lshl_b32 s64, s68, 14
    s_add_u32 s64, s64, 8388608
    v_lshl_add_u32 v124, v98, 7, s64
    s_mov_b32 s75, 0x3f80
    s_mov_b32 s76, 0x3f800000
    v_mov_b32 v3, 20
    buffer_load_dword v2, v3, s[8:11], 0 offen sc1
Lgchk_51:
    s_waitcnt vmcnt(0)
    v_cmp_gt_u32 vcc, 256, v2
    s_cbranch_vccnz Lgrty_52
L_Rseg:
    s_add_u32 s65, s62, 1
    buffer_load_dwordx4 v[126:129], v124, s[4:7], 0 offen sc1
Lfchk_53:
    s_waitcnt vmcnt(0)
    v_min3_u32 v116, v126, v127, v128
    v_min_u32 v116, v116, v129
    v_cmp_gt_u32 vcc, s65, v116
    s_cbranch_vccnz Lfrty_54
    buffer_load_dwordx4 v[84:87], v122, s[16:19], s71 offen sc1
    buffer_load_dwordx4 v[88:91], v122, s[16:19], s71 offen offset:512 sc1
    buffer_load_dwordx2 v[92:93], v123, s[16:19], s71 offen offset:1024 sc1
    buffer_load_dwordx4 v[4:7], v120, s[4:7], s70 offen sc1
    buffer_load_dwordx4 v[8:11], v120, s[4:7], s70 offen offset:2048 sc1
    buffer_load_dwordx2 v[12:13], v121, s[4:7], s70 offen sc1
    s_add_u32 s70, s70, 40960
    buffer_load_dwordx4 v[14:17], v120, s[4:7], s70 offen sc1
    buffer_load_dwordx4 v[18:21], v120, s[4:7], s70 offen offset:2048 sc1
    buffer_load_dwordx2 v[22:23], v121, s[4:7], s70 offen sc1
    s_add_u32 s70, s70, 40960
    buffer_load_dwordx4 v[24:27], v120, s[4:7], s70 offen sc1
    buffer_load_dwordx4 v[28:31], v120, s[4:7], s70 offen offset:2048 sc1
    buffer_load_dwordx2 v[32:33], v121, s[4:7], s70 offen sc1
    s_add_u32 s70, s70, 40960
    buffer_load_dwordx4 v[34:37], v120, s[4:7], s70 offen sc1
    buffer_load_dwordx4 v[38:41], v120, s[4:7], s70 offen offset:2048 sc1
    buffer_load_dwordx2 v[42:43], v121, s[4:7], s70 offen sc1
    s_add_u32 s70, s70, 40960
    buffer_load_dwordx4 v[44:47], v120, s[4:7], s70 offen sc1
    buffer_load_dwordx4 v[48:51], v120, s[4:7], s70 offen offset:2048 sc1
    buffer_load_dwordx2 v[52:53], v121, s[4:7], s70 offen sc1
    s_add_u32 s70, s70, 40960
    buffer_load_dwordx4 v[54:57], v120, s[4:7], s70 offen sc1
    buffer_load_dwordx4 v[58:61], v120, s[4:7], s70 offen offset:2048 sc1
    buffer_load_dwordx2 v[62:63], v121, s[4:7], s70 offen sc1
    s_add_u32 s70, s70, 40960
    buffer_load_dwordx4 v[64:67], v120, s[4:7], s70 offen sc1
    buffer_load_dwordx4 v[68:71], v120, s[4:7], s70 offen offset:2048 sc1
    buffer_load_dwordx2 v[72:73], v121, s[4:7], s70 offen sc1
    s_add_u32 s70, s70, 40960
    buffer_load_dwordx4 v[74:77], v120, s[4:7], s70 offen sc1
    buffer_load_dwordx4 v[78:81], v120, s[4:7], s70 offen offset:2048 sc1
    buffer_load_dwordx2 v[82:83], v121, s[4:7], s70 offen sc1
    s_add_u32 s70, s70, 40960
    s_add_u32 s71, s71, 40960
    s_waitcnt vmcnt(26)
    v_lshlrev_b32 v96, 16, v84
    v_and_b32 v97, 0xffff0000, v84
    v_lshlrev_b32 v98, 16, v85
    v_and_b32 v99, 0xffff0000, v85
    v_lshlrev_b32 v100, 16, v86
    v_and_b32 v101, 0xffff0000, v86
    v_lshlrev_b32 v102, 16, v87
    v_and_b32 v103, 0xffff0000, v87
    s_waitcnt vmcnt(25)
    v_lshlrev_b32 v104, 16, v88
    v_and_b32 v105, 0xffff0000, v88
    v_lshlrev_b32 v106, 16, v89
    v_and_b32 v107, 0xffff0000, v89
    v_lshlrev_b32 v108, 16, v90
    v_and_b32 v109, 0xffff0000, v90
    v_lshlrev_b32 v110, 16, v91
    v_and_b32 v111, 0xffff0000, v91
    s_waitcnt vmcnt(24)
    v_lshlrev_b32 v112, 16, v92
    v_and_b32 v113, 0xffff0000, v92
    v_lshlrev_b32 v114, 16, v93
    v_and_b32 v115, 0xffff0000, v93
    s_waitcnt vmcnt(23)
    v_dot2_f32_bf16 v96, v4, s75, v96
    v_dot2_f32_bf16 v97, v4, s76, v97
    v_dot2_f32_bf16 v98, v5, s75, v98
    v_dot2_f32_bf16 v99, v5, s76, v99
    v_dot2_f32_bf16 v100, v6, s75, v100
    v_dot2_f32_bf16 v101, v6, s76, v101
    v_dot2_f32_bf16 v102, v7, s75, v102
    v_dot2_f32_bf16 v103, v7, s76, v103
    s_waitcnt vmcnt(22)
    v_dot2_f32_bf16 v104, v8, s75, v104
    v_dot2_f32_bf16 v105, v8, s76, v105
    v_dot2_f32_bf16 v106, v9, s75, v106
    v_dot2_f32_bf16 v107, v9, s76, v107
    v_dot2_f32_bf16 v108, v10, s75, v108
    v_dot2_f32_bf16 v109, v10, s76, v109
    v_dot2_f32_bf16 v110, v11, s75, v110
    v_dot2_f32_bf16 v111, v11, s76, v111
    s_waitcnt vmcnt(21)
    v_dot2_f32_bf16 v112, v12, s75, v112
    v_dot2_f32_bf16 v113, v12, s76, v113
    v_dot2_f32_bf16 v114, v13, s75, v114
    v_dot2_f32_bf16 v115, v13, s76, v115
    s_waitcnt vmcnt(20)
    v_dot2_f32_bf16 v96, v14, s75, v96
    v_dot2_f32_bf16 v97, v14, s76, v97
    v_dot2_f32_bf16 v98, v15, s75, v98
    v_dot2_f32_bf16 v99, v15, s76, v99
    v_dot2_f32_bf16 v100, v16, s75, v100
    v_dot2_f32_bf16 v101, v16, s76, v101
    v_dot2_f32_bf16 v102, v17, s75, v102
    v_dot2_f32_bf16 v103, v17, s76, v103
    s_waitcnt vmcnt(19)
    v_dot2_f32_bf16 v104, v18, s75, v104
    v_dot2_f32_bf16 v105, v18, s76, v105
    v_dot2_f32_bf16 v106, v19, s75, v106
    v_dot2_f32_bf16 v107, v19, s76, v107
    v_dot2_f32_bf16 v108, v20, s75, v108
    v_dot2_f32_bf16 v109, v20, s76, v109
    v_dot2_f32_bf16 v110, v21, s75, v110
    v_dot2_f32_bf16 v111, v21, s76, v111
    s_waitcnt vmcnt(18)
    v_dot2_f32_bf16 v112, v22, s75, v112
    v_dot2_f32_bf16 v113, v22, s76, v113
    v_dot2_f32_bf16 v114, v23, s75, v114
    v_dot2_f32_bf16 v115, v23, s76, v115
    s_waitcnt vmcnt(17)
    v_dot2_f32_bf16 v96, v24, s75, v96
    v_dot2_f32_bf16 v97, v24, s76, v97
    v_dot2_f32_bf16 v98, v25, s75, v98
    v_dot2_f32_bf16 v99, v25, s76, v99
    v_dot2_f32_bf16 v100, v26, s75, v100
    v_dot2_f32_bf16 v101, v26, s76, v101
    v_dot2_f32_bf16 v102, v27, s75, v102
    v_dot2_f32_bf16 v103, v27, s76, v103
    s_waitcnt vmcnt(16)
    v_dot2_f32_bf16 v104, v28, s75, v104
    v_dot2_f32_bf16 v105, v28, s76, v105
    v_dot2_f32_bf16 v106, v29, s75, v106
    v_dot2_f32_bf16 v107, v29, s76, v107
    v_dot2_f32_bf16 v108, v30, s75, v108
    v_dot2_f32_bf16 v109, v30, s76, v109
    v_dot2_f32_bf16 v110, v31, s75, v110
    v_dot2_f32_bf16 v111, v31, s76, v111
    s_waitcnt vmcnt(15)
    v_dot2_f32_bf16 v112, v32, s75, v112
    v_dot2_f32_bf16 v113, v32, s76, v113
    v_dot2_f32_bf16 v114, v33, s75, v114
    v_dot2_f32_bf16 v115, v33, s76, v115
    s_waitcnt vmcnt(14)
    v_dot2_f32_bf16 v96, v34, s75, v96
    v_dot2_f32_bf16 v97, v34, s76, v97
    v_dot2_f32_bf16 v98, v35, s75, v98
    v_dot2_f32_bf16 v99, v35, s76, v99
    v_dot2_f32_bf16 v100, v36, s75, v100
    v_dot2_f32_bf16 v101, v36, s76, v101
    v_dot2_f32_bf16 v102, v37, s75, v102
    v_dot2_f32_bf16 v103, v37, s76, v103
    s_waitcnt vmcnt(13)
    v_dot2_f32_bf16 v104, v38, s75, v104
    v_dot2_f32_bf16 v105, v38, s76, v105
    v_dot2_f32_bf16 v106, v39, s75, v106
    v_dot2_f32_bf16 v107, v39, s76, v107
    v_dot2_f32_bf16 v108, v40, s75, v108
    v_dot2_f32_bf16 v109, v40, s76, v109
    v_dot2_f32_bf16 v110, v41, s75, v110
    v_dot2_f32_bf16 v111, v41, s76, v111
    s_waitcnt vmcnt(12)
    v_dot2_f32_bf16 v112, v42, s75, v112
    v_dot2_f32_bf16 v113, v42, s76, v113
    v_dot2_f32_bf16 v114, v43, s75, v114
    v_dot2_f32_bf16 v115, v43, s76, v115
    s_waitcnt vmcnt(11)
    v_dot2_f32_bf16 v96, v44, s75, v96
    v_dot2_f32_bf16 v97, v44, s76, v97
    v_dot2_f32_bf16 v98, v45, s75, v98
    v_dot2_f32_bf16 v99, v45, s76, v99
    v_dot2_f32_bf16 v100, v46, s75, v100
    v_dot2_f32_bf16 v101, v46, s76, v101
    v_dot2_f32_bf16 v102, v47, s75, v102
    v_dot2_f32_bf16 v103, v47, s76, v103
    s_waitcnt vmcnt(10)
    v_dot2_f32_bf16 v104, v48, s75, v104
    v_dot2_f32_bf16 v105, v48, s76, v105
    v_dot2_f32_bf16 v106, v49, s75, v106
    v_dot2_f32_bf16 v107, v49, s76, v107
    v_dot2_f32_bf16 v108, v50, s75, v108
    v_dot2_f32_bf16 v109, v50, s76, v109
    v_dot2_f32_bf16 v110, v51, s75, v110
    v_dot2_f32_bf16 v111, v51, s76, v111
    s_waitcnt vmcnt(9)
    v_dot2_f32_bf16 v112, v52, s75, v112
    v_dot2_f32_bf16 v113, v52, s76, v113
    v_dot2_f32_bf16 v114, v53, s75, v114
    v_dot2_f32_bf16 v115, v53, s76, v115
    s_waitcnt vmcnt(8)
    v_dot2_f32_bf16 v96, v54, s75, v96
    v_dot2_f32_bf16 v97, v54, s76, v97
    v_dot2_f32_bf16 v98, v55, s75, v98
    v_dot2_f32_bf16 v99, v55, s76, v99
    v_dot2_f32_bf16 v100, v56, s75, v100
    v_dot2_f32_bf16 v101, v56, s76, v101
    v_dot2_f32_bf16 v102, v57, s75, v102
    v_dot2_f32_bf16 v103, v57, s76, v103
    s_waitcnt vmcnt(7)
    v_dot2_f32_bf16 v104, v58, s75, v104
    v_dot2_f32_bf16 v105, v58, s76, v105
    v_dot2_f32_bf16 v106, v59, s75, v106
    v_dot2_f32_bf16 v107, v59, s76, v107
    v_dot2_f32_bf16 v108, v60, s75, v108
    v_dot2_f32_bf16 v109, v60, s76, v109
    v_dot2_f32_bf16 v110, v61, s75, v110
    v_dot2_f32_bf16 v111, v61, s76, v111
    s_waitcnt vmcnt(6)
    v_dot2_f32_bf16 v112, v62, s75, v112
    v_dot2_f32_bf16 v113, v62, s76, v113
    v_dot2_f32_bf16 v114, v63, s75, v114
    v_dot2_f32_bf16 v115, v63, s76, v115
    s_waitcnt vmcnt(5)
    v_dot2_f32_bf16 v96, v64, s75, v96
    v_dot2_f32_bf16 v97, v64, s76, v97
    v_dot2_f32_bf16 v98, v65, s75, v98
    v_dot2_f32_bf16 v99, v65, s76, v99
    v_dot2_f32_bf16 v100, v66, s75, v100
    v_dot2_f32_bf16 v101, v66, s76, v101
    v_dot2_f32_bf16 v102, v67, s75, v102
    v_dot2_f32_bf16 v103, v67, s76, v103
    s_waitcnt vmcnt(4)
    v_dot2_f32_bf16 v104, v68, s75, v104
    v_dot2_f32_bf16 v105, v68, s76, v105
    v_dot2_f32_bf16 v106, v69, s75, v106
    v_dot2_f32_bf16 v107, v69, s76, v107
    v_dot2_f32_bf16 v108, v70, s75, v108
    v_dot2_f32_bf16 v109, v70, s76, v109
    v_dot2_f32_bf16 v110, v71, s75, v110
    v_dot2_f32_bf16 v111, v71, s76, v111
    s_waitcnt vmcnt(3)
    v_dot2_f32_bf16 v112, v72, s75, v112
    v_dot2_f32_bf16 v113, v72, s76, v113
    v_dot2_f32_bf16 v114, v73, s75, v114
    v_dot2_f32_bf16 v115, v73, s76, v115
    s_waitcnt vmcnt(2)
    v_dot2_f32_bf16 v96, v74, s75, v96
    v_dot2_f32_bf16 v97, v74, s76, v97
    v_dot2_f32_bf16 v98, v75, s75, v98
    v_dot2_f32_bf16 v99, v75, s76, v99
    v_dot2_f32_bf16 v100, v76, s75, v100
    v_dot2_f32_bf16 v101, v76, s76, v101
    v_dot2_f32_bf16 v102, v77, s75, v102
    v_dot2_f32_bf16 v103, v77, s76, v103
    s_waitcnt vmcnt(1)
    v_dot2_f32_bf16 v104, v78, s75, v104
    v_dot2_f32_bf16 v105, v78, s76, v105
    v_dot2_f32_bf16 v106, v79, s75, v106
    v_dot2_f32_bf16 v107, v79, s76, v107
    v_dot2_f32_bf16 v108, v80, s75, v108
    v_dot2_f32_bf16 v109, v80, s76, v109
    v_dot2_f32_bf16 v110, v81, s75, v110
    v_dot2_f32_bf16 v111, v81, s76, v111
    s_waitcnt vmcnt(0)
    v_dot2_f32_bf16 v112, v82, s75, v112
    v_dot2_f32_bf16 v113, v82, s76, v113
    v_dot2_f32_bf16 v114, v83, s75, v114
    v_dot2_f32_bf16 v115, v83, s76, v115
    v_cvt_pk_bf16_f32 v84, v96, v97
    v_cvt_pk_bf16_f32 v85, v98, v99
    v_cvt_pk_bf16_f32 v86, v100, v101
    v_cvt_pk_bf16_f32 v87, v102, v103
    v_cvt_pk_bf16_f32 v88, v104, v105
    v_cvt_pk_bf16_f32 v89, v106, v107
    v_cvt_pk_bf16_f32 v90, v108, v109
    v_cvt_pk_bf16_f32 v91, v110, v111
    v_cvt_pk_bf16_f32 v92, v112, v113
    v_cvt_pk_bf16_f32 v93, v114, v115
    buffer_store_dwordx4 v[84:87], v122, s[20:23], s72 offen sc1
    buffer_store_dwordx4 v[88:91], v122, s[20:23], s72 offen offset:512 sc1
    buffer_store_dwordx2 v[92:93], v123, s[20:23], s72 offen offset:1024 sc1
    s_add_u32 s72, s72, 40960
    s_cmp_eq_u32 s74, 3
    s_cbranch_scc1 L_Rnext
    v_lshlrev_b32 v96, 16, v84
    v_and_b32 v97, 0xffff0000, v84
    v_lshlrev_b32 v98, 16, v85
    v_and_b32 v99, 0xffff0000, v85
    v_lshlrev_b32 v100, 16, v86
    v_and_b32 v101, 0xffff0000, v86
    v_lshlrev_b32 v102, 16, v87
    v_and_b32 v103, 0xffff0000, v87
    v_lshlrev_b32 v104, 16, v88
    v_and_b32 v105, 0xffff0000, v88
    v_lshlrev_b32 v106, 16, v89
    v_and_b32 v107, 0xffff0000, v89
    v_lshlrev_b32 v108, 16, v90
    v_and_b32 v109, 0xffff0000, v90
    v_lshlrev_b32 v110, 16, v91
    v_and_b32 v111, 0xffff0000, v91
    v_lshlrev_b32 v112, 16, v92
    v_and_b32 v113, 0xffff0000, v92
    v_lshlrev_b32 v114, 16, v93
    v_and_b32 v115, 0xffff0000, v93
    v_add_f32 v116, v96, v97
    v_add_f32 v117, v98, v99
    v_add_f32 v116, v116, v100
    v_add_f32 v117, v117, v101
    v_add_f32 v116, v116, v102
    v_add_f32 v117, v117, v103
    v_add_f32 v116, v116, v104
    v_add_f32 v117, v117, v105
    v_add_f32 v116, v116, v106
    v_add_f32 v117, v117, v107
    v_add_f32 v116, v116, v108
    v_add_f32 v117, v117, v109
    v_add_f32 v116, v116, v110
    v_add_f32 v117, v117, v111
    v_add_f32 v116, v116, v112
    v_add_f32 v117, v117, v113
    v_add_f32 v116, v116, v114
    v_add_f32 v117, v117, v115
    v_add_f32 v116, v116, v117
    s_nop 1
    v_add_f32_dpp v116, v116, v116 quad_perm:[1,0,3,2] row_mask:0xf bank_mask:0xf
    s_nop 1
    v_add_f32_dpp v116, v116, v116 quad_perm:[2,3,0,1] row_mask:0xf bank_mask:0xf
    s_nop 1
    v_add_f32_dpp v116, v116, v116 row_half_mirror row_mask:0xf bank_mask:0xf
    s_nop 1
    v_add_f32_dpp v116, v116, v116 row_mirror row_mask:0xf bank_mask:0xf
    v_mov_b32 v117, v116
    s_nop 1
    v_permlane16_swap_b32 v116, v117
    v_add_f32 v116, v116, v117
    v_mul_f32 v116, 0x3acccccd, v116
    v_sub_f32 v96, v96, v116
    v_sub_f32 v97, v97, v116
    v_sub_f32 v98, v98, v116
    v_sub_f32 v99, v99, v116
    v_sub_f32 v100, v100, v116
    v_sub_f32 v101, v101, v116
    v_sub_f32 v102, v102, v116
    v_sub_f32 v103, v103, v116
    v_sub_f32 v104, v104, v116
    v_sub_f32 v105, v105, v116
    v_sub_f32 v106, v106, v116
    v_sub_f32 v107, v107, v116
    v_sub_f32 v108, v108, v116
    v_sub_f32 v109, v109, v116
    v_sub_f32 v110, v110, v116
    v_sub_f32 v111, v111, v116
    v_sub_f32 v112, v112, v116
    v_sub_f32 v113, v113, v116
    v_sub_f32 v114, v114, v116
    v_sub_f32 v115, v115, v116
    v_mul_f32 v116, v96, v96
    v_mul_f32 v117, v97, v97
    v_fmac_f32 v116, v98, v98
    v_fmac_f32 v117, v99, v99
    v_fmac_f32 v116, v100, v100
    v_fmac_f32 v117, v101, v101
    v_fmac_f32 v116, v102, v102
    v_fmac_f32 v117, v103, v103
    v_fmac_f32 v116, v104, v104
    v_fmac_f32 v117, v105, v105
    v_fmac_f32 v116, v106, v106
    v_fmac_f32 v117, v107, v107
    v_fmac_f32 v116, v108, v108
    v_fmac_f32 v117, v109, v109
    v_fmac_f32 v116, v110, v110
    v_fmac_f32 v117, v111, v111
    v_fmac_f32 v116, v112, v112
    v_fmac_f32 v117, v113, v113
    v_fmac_f32 v116, v114, v114
    v_fmac_f32 v117, v115, v115
    v_add_f32 v116, v116, v117
    s_nop 1
    v_add_f32_dpp v116, v116, v116 quad_perm:[1,0,3,2] row_mask:0xf bank_mask:0xf
    s_nop 1
    v_add_f32_dpp v116, v116, v116 quad_perm:[2,3,0,1] row_mask:0xf bank_mask:0xf
    s_nop 1
    v_add_f32_dpp v116, v116, v116 row_half_mirror row_mask:0xf bank_mask:0xf
    s_nop 1
    v_add_f32_dpp v116, v116, v116 row_mirror row_mask:0xf bank_mask:0xf
    v_mov_b32 v117, v116
    s_nop 1
    v_permlane16_swap_b32 v116, v117
    v_add_f32 v116, v116, v117
    v_mov_b32 v117, 0x3727c5ac
    v_fmac_f32 v117, 0x3acccccd, v116
    v_rsq_f32 v116, v117
    s_nop 0
    v_mul_f32 v96, v96, v116
    v_mul_f32 v97, v97, v116
    v_mul_f32 v98, v98, v116
    v_mul_f32 v99, v99, v116
    v_mul_f32 v100, v100, v116
    v_mul_f32 v101, v101, v116
    v_mul_f32 v102, v102, v116
    v_mul_f32 v103, v103, v116
    v_mul_f32 v104, v104, v116
    v_mul_f32 v105, v105, v116
    v_mul_f32 v106, v106, v116
    v_mul_f32 v107, v107, v116
    v_mul_f32 v108, v108, v116
    v_mul_f32 v109, v109, v116
    v_mul_f32 v110, v110, v116
    v_mul_f32 v111, v111, v116
    v_mul_f32 v112, v112, v116
    v_mul_f32 v113, v113, v116
    v_mul_f32 v114, v114, v116
    v_mul_f32 v115, v115, v116
    v_cvt_pk_bf16_f32 v84, v96, v97
    v_cvt_pk_bf16_f32 v85, v98, v99
    v_cvt_pk_bf16_f32 v86, v100, v101
    v_cvt_pk_bf16_f32 v87, v102, v103
    v_cvt_pk_bf16_f32 v88, v104, v105
    v_cvt_pk_bf16_f32 v89, v106, v107
    v_cvt_pk_bf16_f32 v90, v108, v109
    v_cvt_pk_bf16_f32 v91, v110, v111
    v_cvt_pk_bf16_f32 v92, v112, v113
    v_cvt_pk_bf16_f32 v93, v114, v115
    buffer_store_dwordx4 v[84:87], v122, s[4:7], s73 offen sc1
    buffer_store_dwordx4 v[88:91], v122, s[4:7], s73 offen offset:512 sc1
    buffer_store_dwordx2 v[92:93], v123, s[4:7], s73 offen offset:1024 sc1
    s_add_u32 s73, s73, 40960
    s_waitcnt vmcnt(0)
    s_add_u32 s64, s62, 1
    v_mov_b32 v116, s64
    s_mov_b64 exec, 1
    buffer_store_dword v116, off, s[4:7], s63 sc1
    s_mov_b64 exec, -1
L_Rnext:
    s_add_u32 s62, s62, 1
    s_cmp_lt_u32 s62, 64
    s_cbranch_scc1 L_Rseg
    s_endpgm
Lgrty_52:
    s_sleep 4
    buffer_load_dword v2, v3, s[8:11], 0 offen sc1
    s_sub_u32 s61, s61, 1
    s_mov_b32 s67, 1
    s_cbranch_scc1 L_fail
    s_branch Lgchk_51
Lfrty_54:
    s_sleep 1
    buffer_load_dwordx4 v[126:129], v124, s[4:7], 0 offen sc1
    s_sub_u32 s61, s61, 1
    s_mov_b32 s67, 40
    s_cbranch_scc1 L_fail
    s_waitcnt vmcnt(0)
    s_branch Lfchk_53
.section .rodata,"a"
.p2align 6
.amdhsa_kernel interleave_layers__memory_aug_recurrent_mem_tr__sliding_local_dilated__prompt_kernel
  .amdhsa_next_free_vgpr 512
  .amdhsa_next_free_sgpr 102
  .amdhsa_accum_offset 256
  .amdhsa_group_segment_fixed_size 0
  .amdhsa_kernarg_size 104
  .amdhsa_user_sgpr_count 2
  .amdhsa_user_sgpr_kernarg_segment_ptr 1
  .amdhsa_system_sgpr_workgroup_id_x 1
  .amdhsa_float_denorm_mode_32 3
.end_amdhsa_kernel
```

```asm
; @launch grid=(256,1,1) block=(256,1,1) lds=163840
.amdgcn_target "amdgcn-amd-amdhsa--gfx950"
.text
.globl interleave_layers__memory_aug_recurrent_mem_tr__sliding_local_dilated__prompt_kernel
.p2align 8
.type interleave_layers__memory_aug_recurrent_mem_tr__sliding_local_dilated__prompt_kernel,@function
interleave_layers__memory_aug_recurrent_mem_tr__sliding_local_dilated__prompt_kernel:
    s_cmp_ge_u32 s2, 256
    s_cbranch_scc1 L_end
    s_load_dwordx16 s[32:47], s[0:1], 0
    s_load_dwordx8 s[48:55], s[0:1], 64
    s_load_dwordx2 s[56:57], s[0:1], 96
    s_getreg_b32 s58, hwreg(HW_REG_XCC_ID)
    s_and_b32 s58, s58, 7
    v_lshrrev_b32 v1, 6, v0
    s_nop 0
    v_readfirstlane_b32 s60, v1
    s_mov_b32 s61, 0x100000
    s_waitcnt lgkmcnt(0)
    s_mov_b32 s4, s56
    s_mov_b32 s5, s57
    s_mov_b32 s6, 268435456
    s_mov_b32 s7, 0x20000
    s_mov_b32 s8, s54
    s_mov_b32 s9, s55
    s_mov_b32 s10, 256
    s_mov_b32 s11, 0x20000
    s_mov_b32 s12, s32
    s_mov_b32 s13, s33
    s_mov_b32 s14, 2621440
    s_mov_b32 s15, 0x20000
    s_cmp_lg_u32 s60, 0
    s_cbranch_scc1 L_notick
    s_mov_b64 exec, 1
    v_mov_b32 v2, 1
    s_lshl_b32 s64, s58, 5
    v_mov_b32 v3, s64
    buffer_atomic_add v2, v3, s[8:11], 0 offen sc0
    s_mov_b64 exec, -1
L_notick:
    v_lshrrev_b32 v4, 5, v0
    s_lshl_b32 s64, s2, 3
    v_add_u32 v4, s64, v4
    v_mul_u32_u24 v4, 1280, v4
    v_and_b32 v5, 31, v0
    v_lshl_add_u32 v6, v5, 3, v4
    v_lshl_add_u32 v5, v5, 4, v4
    buffer_load_dwordx4 v[8:11], v5, s[12:15], 0 offen
    buffer_load_dwordx4 v[12:15], v5, s[12:15], 0 offen offset:512
    buffer_load_dwordx2 v[16:17], v6, s[12:15], 0 offen offset:1024
    s_cmp_lg_u32 s60, 0
    s_cbranch_scc1 L_notick2
    v_mov_b32 v3, 0
    s_mov_b64 exec, 1
    s_waitcnt vmcnt(3)
    ds_write_b32 v3, v2
    s_mov_b64 exec, -1
L_notick2:
    s_waitcnt lgkmcnt(0)
    s_barrier
    v_mov_b32 v3, 0
    s_waitcnt vmcnt(3)
    ds_read_b32 v2, v3
    s_waitcnt lgkmcnt(0)
    v_readfirstlane_b32 s59, v2
    s_waitcnt lgkmcnt(0)
    s_barrier
    s_waitcnt vmcnt(2)
    v_lshlrev_b32 v20, 16, v8
    v_and_b32 v21, 0xffff0000, v8
    v_lshlrev_b32 v22, 16, v9
    v_and_b32 v23, 0xffff0000, v9
    v_lshlrev_b32 v24, 16, v10
    v_and_b32 v25, 0xffff0000, v10
    v_lshlrev_b32 v26, 16, v11
    v_and_b32 v27, 0xffff0000, v11
    s_waitcnt vmcnt(1)
    v_lshlrev_b32 v28, 16, v12
    v_and_b32 v29, 0xffff0000, v12
    v_lshlrev_b32 v30, 16, v13
    v_and_b32 v31, 0xffff0000, v13
    v_lshlrev_b32 v32, 16, v14
    v_and_b32 v33, 0xffff0000, v14
    v_lshlrev_b32 v34, 16, v15
    v_and_b32 v35, 0xffff0000, v15
    s_waitcnt vmcnt(0)
    v_lshlrev_b32 v36, 16, v16
    v_and_b32 v37, 0xffff0000, v16
    v_lshlrev_b32 v38, 16, v17
    v_and_b32 v39, 0xffff0000, v17
    v_add_f32 v40, v20, v21
    v_add_f32 v41, v22, v23
    v_add_f32 v40, v40, v24
    v_add_f32 v41, v41, v25
    v_add_f32 v40, v40, v26
    v_add_f32 v41, v41, v27
    v_add_f32 v40, v40, v28
    v_add_f32 v41, v41, v29
    v_add_f32 v40, v40, v30
    v_add_f32 v41, v41, v31
    v_add_f32 v40, v40, v32
    v_add_f32 v41, v41, v33
    v_add_f32 v40, v40, v34
    v_add_f32 v41, v41, v35
    v_add_f32 v40, v40, v36
    v_add_f32 v41, v41, v37
    v_add_f32 v40, v40, v38
    v_add_f32 v41, v41, v39
    v_add_f32 v40, v40, v41
    s_nop 1
    v_add_f32_dpp v40, v40, v40 quad_perm:[1,0,3,2] row_mask:0xf bank_mask:0xf
    s_nop 1
    v_add_f32_dpp v40, v40, v40 quad_perm:[2,3,0,1] row_mask:0xf bank_mask:0xf
    s_nop 1
    v_add_f32_dpp v40, v40, v40 row_half_mirror row_mask:0xf bank_mask:0xf
    s_nop 1
    v_add_f32_dpp v40, v40, v40 row_mirror row_mask:0xf bank_mask:0xf
    v_mov_b32 v41, v40
    s_nop 1
    v_permlane16_swap_b32 v40, v41
    v_add_f32 v40, v40, v41
    v_mul_f32 v40, 0x3acccccd, v40
    v_sub_f32 v20, v20, v40
    v_sub_f32 v21, v21, v40
    v_sub_f32 v22, v22, v40
    v_sub_f32 v23, v23, v40
    v_sub_f32 v24, v24, v40
    v_sub_f32 v25, v25, v40
    v_sub_f32 v26, v26, v40
    v_sub_f32 v27, v27, v40
    v_sub_f32 v28, v28, v40
    v_sub_f32 v29, v29, v40
    v_sub_f32 v30, v30, v40
    v_sub_f32 v31, v31, v40
    v_sub_f32 v32, v32, v40
    v_sub_f32 v33, v33, v40
    v_sub_f32 v34, v34, v40
    v_sub_f32 v35, v35, v40
    v_sub_f32 v36, v36, v40
    v_sub_f32 v37, v37, v40
    v_sub_f32 v38, v38, v40
    v_sub_f32 v39, v39, v40
    v_mul_f32 v40, v20, v20
    v_mul_f32 v41, v21, v21
    v_fmac_f32 v40, v22, v22
    v_fmac_f32 v41, v23, v23
    v_fmac_f32 v40, v24, v24
    v_fmac_f32 v41, v25, v25
    v_fmac_f32 v40, v26, v26
    v_fmac_f32 v41, v27, v27
    v_fmac_f32 v40, v28, v28
    v_fmac_f32 v41, v29, v29
    v_fmac_f32 v40, v30, v30
    v_fmac_f32 v41, v31, v31
    v_fmac_f32 v40, v32, v32
    v_fmac_f32 v41, v33, v33
    v_fmac_f32 v40, v34, v34
    v_fmac_f32 v41, v35, v35
    v_fmac_f32 v40, v36, v36
    v_fmac_f32 v41, v37, v37
    v_fmac_f32 v40, v38, v38
    v_fmac_f32 v41, v39, v39
    v_add_f32 v40, v40, v41
    s_nop 1
    v_add_f32_dpp v40, v40, v40 quad_perm:[1,0,3,2] row_mask:0xf bank_mask:0xf
    s_nop 1
    v_add_f32_dpp v40, v40, v40 quad_perm:[2,3,0,1] row_mask:0xf bank_mask:0xf
    s_nop 1
    v_add_f32_dpp v40, v40, v40 row_half_mirror row_mask:0xf bank_mask:0xf
    s_nop 1
    v_add_f32_dpp v40, v40, v40 row_mirror row_mask:0xf bank_mask:0xf
    v_mov_b32 v41, v40
    s_nop 1
    v_permlane16_swap_b32 v40, v41
    v_add_f32 v40, v40, v41
    v_mov_b32 v41, 0x3727c5ac
    v_fmac_f32 v41, 0x3acccccd, v40
    v_rsq_f32 v40, v41
    s_nop 0
    v_mul_f32 v20, v20, v40
    v_mul_f32 v21, v21, v40
    v_mul_f32 v22, v22, v40
    v_mul_f32 v23, v23, v40
    v_mul_f32 v24, v24, v40
    v_mul_f32 v25, v25, v40
    v_mul_f32 v26, v26, v40
    v_mul_f32 v27, v27, v40
    v_mul_f32 v28, v28, v40
    v_mul_f32 v29, v29, v40
    v_mul_f32 v30, v30, v40
    v_mul_f32 v31, v31, v40
    v_mul_f32 v32, v32, v40
    v_mul_f32 v33, v33, v40
    v_mul_f32 v34, v34, v40
    v_mul_f32 v35, v35, v40
    v_mul_f32 v36, v36, v40
    v_mul_f32 v37, v37, v40
    v_mul_f32 v38, v38, v40
    v_mul_f32 v39, v39, v40
    v_cvt_pk_bf16_f32 v8, v20, v21
    v_cvt_pk_bf16_f32 v9, v22, v23
    v_cvt_pk_bf16_f32 v10, v24, v25
    v_cvt_pk_bf16_f32 v11, v26, v27
    v_cvt_pk_bf16_f32 v12, v28, v29
    v_cvt_pk_bf16_f32 v13, v30, v31
    v_cvt_pk_bf16_f32 v14, v32, v33
    v_cvt_pk_bf16_f32 v15, v34, v35
    v_cvt_pk_bf16_f32 v16, v36, v37
    v_cvt_pk_bf16_f32 v17, v38, v39
    s_mov_b32 s64, 16777216
    buffer_store_dwordx4 v[8:11], v5, s[4:7], s64 offen sc1
    buffer_store_dwordx4 v[12:15], v5, s[4:7], s64 offen offset:512 sc1
    buffer_store_dwordx2 v[16:17], v6, s[4:7], s64 offen offset:1024 sc1
    s_lshr_b32 s68, s58, 2
    s_and_b32 s69, s58, 3
    s_lshl_b32 s63, s58, 5
    s_add_u32 s63, s63, s59
    s_lshl_b32 s63, s63, 2
    s_add_u32 s63, s63, s60
    s_lshl_b32 s63, s63, 7
    s_add_u32 s63, s63, 8388608
    s_add_u32 s3, s63, 131072
    s_mov_b32 s62, 0
    s_cmp_lt_u32 s59, 24
    s_cbranch_scc1 L_roleC
    s_cmp_lt_u32 s59, 28
    s_cbranch_scc1 L_roleT
    s_cmp_lt_u32 s59, 30
    s_cbranch_scc1 L_roleB
    s_cmp_lt_u32 s59, 32
    s_cbranch_scc1 L_roleR
    s_mov_b32 s67, 2
L_fail:
    s_mov_b64 exec, 1
    s_lshl_b32 s67, s67, 8
    s_add_u32 s67, s67, s59
    s_lshl_b32 s67, s67, 8
    s_add_u32 s67, s67, s58
    s_lshl_b32 s67, s67, 8
    s_add_u32 s67, s67, s62
    s_waitcnt vmcnt(0)
    v_mov_b32 v2, s67
    v_mov_b32 v3, 24
    buffer_store_dword v2, v3, s[8:11], 0 offen
L_end:
    s_endpgm
L_roleC:
    s_mov_b32 s12, s36
    s_mov_b32 s13, s37
    s_mov_b32 s14, 7864320
    s_mov_b32 s15, 0x20000
    s_mov_b32 s16, s38
    s_mov_b32 s17, s39
    s_mov_b32 s18, 7864320
    s_mov_b32 s19, 0x20000
    s_mov_b32 s20, s40
    s_mov_b32 s21, s41
    s_mov_b32 s22, 7864320
    s_mov_b32 s23, 0x20000
    s_mov_b32 s24, s42
    s_mov_b32 s25, s43
    s_mov_b32 s26, 7864320
    s_mov_b32 s27, 0x20000
    s_mov_b32 s28, s34
    s_mov_b32 s29, s35
    s_mov_b32 s30, 10240
    s_mov_b32 s31, 0x20000
    v_and_b32 v1, 63, v0
    s_mul_i32 s64, s69, 3072
    s_lshl_b32 s65, s59, 7
    s_add_u32 s64, s64, s65
    s_mul_i32 s65, s60, 98304
    s_add_u32 s64, s64, s65
    v_lshrrev_b32 v192, 3, v1
    v_mul_u32_u24 v192, 12288, v192
    v_and_b32 v193, 7, v1
    v_lshl_add_u32 v192, v193, 4, v192
    v_add_u32 v192, s64, v192
    s_lshl_b32 s82, s60, 10
    s_mov_b32 s65, 0
    s_add_u32 m0, s82, 0
Lstg_1:
    s_nop 0
    buffer_load_dwordx4 v192, s[12:15], s65 offen lds
    s_add_u32 m0, m0, 4096
    s_add_u32 s65, s65, 393216
    s_cmp_lt_u32 s65, 7864320
    s_cbranch_scc1 Lstg_1
    s_mov_b32 s65, 0
    s_add_u32 m0, s82, 81920
Lstg_2:
    s_nop 0
    buffer_load_dwordx4 v192, s[16:19], s65 offen lds
    s_add_u32 m0, m0, 4096
    s_add_u32 s65, s65, 393216
    s_cmp_lt_u32 s65, 7864320
    s_cbranch_scc1 Lstg_2
    v_and_b32 v84, 7, v1
    v_bfe_u32 v85, v1, 3, 1
    v_lshrrev_b32 v86, 4, v1
    v_and_b32 v87, 15, v1
    v_lshlrev_b32 v235, 4, v0
    v_lshlrev_b32 v236, 3, v0
    v_add_u32 v236, 8192, v236
    v_lshlrev_b32 v237, 4, v1
    v_lshlrev_b32 v241, 3, v1
    v_lshlrev_b32 v238, 2, v1
    s_add_u32 s64, s60, 1
    s_mul_i32 s64, s64, 1280
    v_add_u32 v239, s64, v237
    v_add_u32 v240, s64, v238
    v_cmp_eq_u32 s[96:97], 1, v85
    v_cmp_lt_u32 s[98:99], 1, v86
    v_mov_b32 v88, 0x4444
    v_mov_b32 v89, 0xeeee
    v_cndmask_b32 v225, v88, v89, s[96:97]
    v_mov_b32 v88, 0xffff
    v_mov_b32 v89, 0xffff0000
    v_cndmask_b32 v231, v88, v89, s[96:97]
    v_lshrrev_b32 v88, 3, v0
    v_mul_u32_u24 v232, 1280, v88
    v_and_b32 v88, 7, v88
    v_xor_b32 v88, v88, v84
    v_lshl_add_u32 v232, v88, 4, v232
    v_mul_u32_u24 v233, 10240, v85
    v_lshl_add_u32 v233, v84, 7, v233
    v_xor_b32 v88, v86, v84
    v_lshl_add_u32 v233, v88, 4, v233
    v_add_u32 v233, 32768, v233
    v_xor_b32 v234, 64, v233
    v_lshrrev_b32 v88, 5, v1
    v_and_b32 v89, 1, v86
    v_lshlrev_b32 v90, 4, v87
    v_lshl_add_u32 v90, v89, 3, v90
    v_lshl_add_u32 v242, v88, 10, v90
    s_lshl_b32 s64, s60, 8
    v_add_u32 v242, s64, v242
    v_lshl_add_u32 v244, v88, 8, v90
    s_lshl_b32 s64, s60, 9
    v_add_u32 v244, s64, v244
    v_mul_u32_u24 v253, 24576, v88
    v_and_b32 v90, 31, v1
    v_lshl_add_u32 v253, v90, 4, v253
    v_add_u32 v253, s64, v253
    v_lshlrev_b32 v250, 9, v89
    v_lshl_add_u32 v250, v88, 6, v250
    v_bfe_u32 v90, v1, 1, 1
    v_lshl_add_u32 v250, v90, 5, v250
    v_bfe_u32 v90, v1, 2, 2
    v_lshl_add_u32 v250, v90, 3, v250
    v_and_b32 v89, 1, v1
    v_lshl_add_u32 v250, v89, 2, v250
    s_lshl_b32 s64, s60, 10
    s_add_u32 s64, s64, 18432
    v_add_u32 v250, s64, v250
    v_lshl_add_u32 v243, v86, 3, v90
    v_lshlrev_b32 v243, 4, v243
    v_lshl_add_u32 v243, v89, 3, v243
    v_bfe_u32 v88, v1, 1, 2
    v_lshlrev_b32 v251, 7, v88
    v_lshrrev_b32 v88, 3, v1
    v_lshl_add_u32 v251, v88, 4, v251
    v_lshl_add_u32 v251, v89, 3, v251
    s_lshl_b32 s64, s59, 9
    s_add_u32 s64, s64, 178176
    v_add_u32 v251, s64, v251
    s_lshl_b32 s66, s59, 10
    s_and_b32 s64, s66, 0x6000
    s_add_u32 s64, s64, s66
    s_lshl_b32 s65, s68, 20
    s_add_u32 s64, s64, s65
    s_add_u32 s64, s64, 14680064
    v_add_u32 v252, s64, v237
    s_and_b32 s64, s60, 1
    s_lshl_b32 s64, s64, 3
    s_lshr_b32 s65, s60, 1
    v_lshl_add_u32 v89, v86, 4, v84
    v_add_u32 v89, s64, v89
    s_lshl_b32 s64, s65, 11
    v_lshl_add_u32 v245, v89, 4, s64
    s_mul_i32 s64, s65, 1536
    v_lshlrev_b32 v247, 4, v89
    v_lshlrev_b32 v246, 3, v89
    v_add_u32 v246, 1024, v246
    v_cndmask_b32 v246, v247, v246, s[96:97]
    v_add_u32 v246, s64, v246
    v_lshl_add_u32 v247, v85, 1, v247
    v_add_u32 v247, s64, v247
    s_lshl_b32 s64, s60, 8
    s_add_u32 s64, s64, s66
    s_add_u32 s64, s64, 153600
    v_lshlrev_b32 v88, 5, v84
    v_lshl_add_u32 v248, v86, 3, v88
    v_add_u32 v248, s64, v248
    v_mov_b32 v89, 0x80000000
    v_cndmask_b32 v248, v248, v89, s[96:97]
    v_lshl_add_u32 v249, v86, 8, v88
    v_lshl_add_u32 v249, v85, 4, v249
    s_mul_i32 s64, s60, 6144
    s_add_u32 s64, s64, 153600
    v_add_u32 v249, s64, v249
    s_lshl_b32 s64, s59, 2
    s_add_u32 s64, s64, s60
    s_sub_u32 s64, s64, 80
    s_mul_i32 s64, s64, 2560
    v_add_u32 v89, s64, v237
    s_cmp_lt_u32 s59, 20
    s_cselect_b64 vcc, -1, 0
    v_cndmask_b32 v249, v89, v249, vcc
    s_cmp_ge_u32 s59, 12
    s_cselect_b32 s66, 24576, 0
    s_lshl_b32 s75, s59, 11
    s_add_u32 s75, s75, s66
    s_mul_i32 s66, s69, 98304
    s_add_u32 s75, s75, s66
    s_mul_i32 s66, s68, 25165824
    s_add_u32 s75, s75, s66
    s_add_u32 s75, s75, 41943040
    v_lshlrev_b32 v88, 2, v86
    v_lshl_add_u32 v88, v85, 4, v88
    s_lshl_b32 s66, s60, 3
    v_add_u32 v89, s66, v84
    v_cmp_gt_u32 s[88:89], v88, v89
    v_add_u32 v88, 1, v88
    v_cmp_gt_u32 s[90:91], v88, v89
    v_add_u32 v88, 1, v88
    v_cmp_gt_u32 s[92:93], v88, v89
    v_add_u32 v88, 1, v88
    v_cmp_gt_u32 s[94:95], v88, v89
    v_add_u32 v88, 1, v88
    v_bfe_u32 v88, v0, 4, 2
    v_lshlrev_b32 v88, 5, v88
    v_add_u32 v88, 31, v88
    v_and_b32 v254, 3, v0
    v_lshl_add_u32 v254, v88, 2, v254
    v_lshlrev_b32 v254, 7, v254
    v_add_u32 v254, 8388608, v254
    v_lshrrev_b32 v88, 2, v1
    v_and_b32 v88, 12, v88
    v_and_b32 v89, 3, v1
    v_add_u32 v88, v88, v89
    s_lshl_b32 s64, s58, 14
    s_add_u32 s64, s64, 8531968
    v_lshl_add_u32 v88, v88, 7, s64
    v_bfe_u32 v89, v1, 2, 1
    v_and_b32 v89, s68, v89
    v_cmp_eq_u32 vcc, 1, v89
    s_nop 1
    v_cndmask_b32 v254, v88, v254, vcc
    v_mov_b32 v88, -10
    v_cndmask_b32 v255, v88, 0, vcc
    v_mov_b32 v180, -1
    v_mov_b32 v184, 0x3f803f80
    v_mov_b32 v181, -1
    v_mov_b32 v185, 0x3f803f80
    v_mov_b32 v182, -1
    v_mov_b32 v186, 0x3f803f80
    v_mov_b32 v183, -1
    v_mov_b32 v187, 0x3f803f80
    v_mov_b32 v175, 0
    v_mov_b32 v179, 0
    v_mov_b32 v191, 0
    s_mov_b32 s70, 0x3dd53b95
    s_mov_b32 s71, 0xd04e79ff
    s_mul_i32 s73, s60, 10240
    s_add_u32 s73, s73, 32768
    s_mul_i32 s74, s68, 2621440
    s_add_u32 s74, s74, 16777216
    s_mul_i32 s64, s59, 43
    s_lshr_b32 s64, s64, 7
    s_mul_i32 s64, s64, 3
    s_add_u32 s65, s64, 3
    s_add_u32 s77, s59, 1
    s_cmp_eq_u32 s77, s65
    s_cselect_b32 s77, s64, s77
    s_add_u32 s78, s77, 1
    s_cmp_eq_u32 s78, s65
    s_cselect_b32 s78, s64, s78
    s_mul_i32 s76, s59, 6400
    s_mul_i32 s77, s77, 6400
    s_mul_i32 s78, s78, 6400
    s_lshl_b32 s72, s58, 20
Lrinit_3:
    s_add_u32 s79, s72, s76
    buffer_store_dwordx4 v[180:183], v239, s[4:7], s79 offen
    buffer_store_dword v180, v240, s[4:7], s79 offen offset:1024
    buffer_store_dwordx2 v[180:181], v248, s[4:7], s72 offen
    s_cmp_eq_u32 s60, 0
    s_cbranch_scc0 Lw_4
    buffer_store_dwordx4 v[180:183], v237, s[4:7], s79 offen
    buffer_store_dword v180, v238, s[4:7], s79 offen offset:1024
Lw_4:
    s_cmp_lt_u32 s59, 20
    s_cselect_b32 s64, s60, 0
    s_cmp_eq_u32 s64, 1
    s_cbranch_scc0 Lw_5
    buffer_store_dwordx2 v[180:181], v251, s[4:7], s72 offen
    s_lshr_b32 s64, s72, 2
    s_and_b32 s64, s64, 0xf0000
    buffer_store_dwordx4 v[180:183], v252, s[4:7], s64 offen sc1
Lw_5:
    v_xor_b32 v252, 0x2000, v252
    s_cmp_lt_u32 s59, 20
    s_cselect_b32 s64, s60, 0
    s_cmp_eq_u32 s64, 1
    s_cbranch_scc0 Lw_7
    buffer_store_dwordx2 v[180:181], v251, s[4:7], s72 offen
    s_lshr_b32 s64, s72, 2
    s_and_b32 s64, s64, 0xf0000
    buffer_store_dwordx4 v[180:183], v252, s[4:7], s64 offen sc1
Lw_7:
    v_xor_b32 v252, 0x2000, v252
    s_add_u32 s72, s72, 262144
    s_and_b32 s64, s72, 786432
    s_cbranch_scc1 Lrinit_3
    v_mov_b32 v2, 0
    s_mov_b64 exec, 1
    buffer_store_dword v2, off, s[4:7], s63 sc1
    buffer_store_dword v2, off, s[4:7], s3
    s_mov_b64 exec, -1
    s_waitcnt vmcnt(0)
    s_barrier
    s_cmp_lg_u32 s60, 0
    s_cbranch_scc1 Larr_8
    s_mov_b64 exec, 1
    v_mov_b32 v2, 1
    v_mov_b32 v3, 20
    buffer_atomic_add v2, v3, s[8:11], 0 offen
    s_mov_b64 exec, -1
Larr_8:
    v_lshrrev_b32 v193, 4, v1
    v_lshlrev_b32 v193, 3, v193
    v_bfe_u32 v194, v1, 2, 2
    v_add_u32 v197, v193, v194
    v_lshlrev_b32 v193, 7, v197
    v_and_b32 v196, 3, v1
    v_lshl_add_u32 v193, v196, 3, v193
    s_lshl_b32 s64, s60, 5
    v_add_u32 v193, s64, v193
    v_add_u32 v194, 40960, v193
    ds_read_b64_tr_b16 a[0:1], v193 offset:0
    ds_read_b64_tr_b16 a[2:3], v193 offset:512
    ds_read_b64_tr_b16 a[4:5], v193 offset:4096
    ds_read_b64_tr_b16 a[6:7], v193 offset:4608
    ds_read_b64_tr_b16 a[8:9], v193 offset:8192
    ds_read_b64_tr_b16 a[10:11], v193 offset:8704
    ds_read_b64_tr_b16 a[12:13], v193 offset:12288
    ds_read_b64_tr_b16 a[14:15], v193 offset:12800
    ds_read_b64_tr_b16 a[16:17], v193 offset:16384
    ds_read_b64_tr_b16 a[18:19], v193 offset:16896
    ds_read_b64_tr_b16 a[20:21], v193 offset:20480
    ds_read_b64_tr_b16 a[22:23], v193 offset:20992
    ds_read_b64_tr_b16 a[24:25], v193 offset:24576
    ds_read_b64_tr_b16 a[26:27], v193 offset:25088
    ds_read_b64_tr_b16 a[28:29], v193 offset:28672
    ds_read_b64_tr_b16 a[30:31], v193 offset:29184
    ds_read_b64_tr_b16 a[32:33], v193 offset:32768
    ds_read_b64_tr_b16 a[34:35], v193 offset:33280
    ds_read_b64_tr_b16 a[36:37], v193 offset:36864
    ds_read_b64_tr_b16 a[38:39], v193 offset:37376
    ds_read_b64_tr_b16 a[40:41], v194 offset:0
    ds_read_b64_tr_b16 a[42:43], v194 offset:512
    ds_read_b64_tr_b16 a[44:45], v194 offset:4096
    ds_read_b64_tr_b16 a[46:47], v194 offset:4608
    ds_read_b64_tr_b16 a[48:49], v194 offset:8192
    ds_read_b64_tr_b16 a[50:51], v194 offset:8704
    ds_read_b64_tr_b16 a[52:53], v194 offset:12288
    ds_read_b64_tr_b16 a[54:55], v194 offset:12800
    ds_read_b64_tr_b16 a[56:57], v194 offset:16384
    ds_read_b64_tr_b16 a[58:59], v194 offset:16896
    ds_read_b64_tr_b16 a[60:61], v194 offset:20480
    ds_read_b64_tr_b16 a[62:63], v194 offset:20992
    ds_read_b64_tr_b16 a[64:65], v194 offset:24576
    ds_read_b64_tr_b16 a[66:67], v194 offset:25088
    ds_read_b64_tr_b16 a[68:69], v194 offset:28672
    ds_read_b64_tr_b16 a[70:71], v194 offset:29184
    ds_read_b64_tr_b16 a[72:73], v194 offset:32768
    ds_read_b64_tr_b16 a[74:75], v194 offset:33280
    ds_read_b64_tr_b16 a[76:77], v194 offset:36864
    ds_read_b64_tr_b16 a[78:79], v194 offset:37376
    s_waitcnt lgkmcnt(0)
    s_barrier
    s_mov_b32 s65, 0
    s_add_u32 m0, s82, 0
Lstg_9:
    s_nop 0
    buffer_load_dwordx4 v192, s[20:23], s65 offen lds
    s_add_u32 m0, m0, 4096
    s_add_u32 s65, s65, 393216
    s_cmp_lt_u32 s65, 7864320
    s_cbranch_scc1 Lstg_9
    v_add_u32 v193, 81920, v193
    v_add_u32 v194, 81920, v194
    ds_read_b64_tr_b16 a[80:81], v193 offset:0
    ds_read_b64_tr_b16 a[82:83], v193 offset:512
    ds_read_b64_tr_b16 a[84:85], v193 offset:4096
    ds_read_b64_tr_b16 a[86:87], v193 offset:4608
    ds_read_b64_tr_b16 a[88:89], v193 offset:8192
    ds_read_b64_tr_b16 a[90:91], v193 offset:8704
    ds_read_b64_tr_b16 a[92:93], v193 offset:12288
    ds_read_b64_tr_b16 a[94:95], v193 offset:12800
    ds_read_b64_tr_b16 a[96:97], v193 offset:16384
    ds_read_b64_tr_b16 a[98:99], v193 offset:16896
    ds_read_b64_tr_b16 a[100:101], v193 offset:20480
    ds_read_b64_tr_b16 a[102:103], v193 offset:20992
    ds_read_b64_tr_b16 a[104:105], v193 offset:24576
    ds_read_b64_tr_b16 a[106:107], v193 offset:25088
    ds_read_b64_tr_b16 a[108:109], v193 offset:28672
    ds_read_b64_tr_b16 a[110:111], v193 offset:29184
    ds_read_b64_tr_b16 a[112:113], v193 offset:32768
    ds_read_b64_tr_b16 a[114:115], v193 offset:33280
    ds_read_b64_tr_b16 a[116:117], v193 offset:36864
    ds_read_b64_tr_b16 a[118:119], v193 offset:37376
    ds_read_b64_tr_b16 a[120:121], v194 offset:0
    ds_read_b64_tr_b16 a[122:123], v194 offset:512
    ds_read_b64_tr_b16 a[124:125], v194 offset:4096
    ds_read_b64_tr_b16 a[126:127], v194 offset:4608
    ds_read_b64_tr_b16 a[128:129], v194 offset:8192
    ds_read_b64_tr_b16 a[130:131], v194 offset:8704
    ds_read_b64_tr_b16 a[132:133], v194 offset:12288
    ds_read_b64_tr_b16 a[134:135], v194 offset:12800
    ds_read_b64_tr_b16 a[136:137], v194 offset:16384
    ds_read_b64_tr_b16 a[138:139], v194 offset:16896
    ds_read_b64_tr_b16 a[140:141], v194 offset:20480
    ds_read_b64_tr_b16 a[142:143], v194 offset:20992
    ds_read_b64_tr_b16 a[144:145], v194 offset:24576
    ds_read_b64_tr_b16 a[146:147], v194 offset:25088
    ds_read_b64_tr_b16 a[148:149], v194 offset:28672
    ds_read_b64_tr_b16 a[150:151], v194 offset:29184
    ds_read_b64_tr_b16 a[152:153], v194 offset:32768
    ds_read_b64_tr_b16 a[154:155], v194 offset:33280
    ds_read_b64_tr_b16 a[156:157], v194 offset:36864
    ds_read_b64_tr_b16 a[158:159], v194 offset:37376
    s_waitcnt lgkmcnt(0)
    s_barrier
    s_cmp_ge_u32 s59, 20
    s_cbranch_scc1 Lnowo_10
    s_lshl_b32 s64, s69, 2
    s_add_u32 s64, s64, s60
    s_mul_i32 s64, s64, 491520
    s_lshl_b32 s65, s59, 6
    s_add_u32 s64, s64, s65
    v_lshrrev_b32 v195, 2, v1
    v_mul_u32_u24 v195, 1280, v195
    v_lshl_add_u32 v195, v196, 4, v195
    v_add_u32 v195, s64, v195
    s_mul_i32 s83, s60, 20480
    s_add_u32 s83, s83, 81920
    v_lshrrev_b32 v197, 5, v1
    v_lshlrev_b32 v197, 4, v197
    v_lshl_add_u32 v197, v85, 3, v197
    v_and_b32 v88, 1, v86
    v_lshl_add_u32 v197, v88, 2, v197
    v_bfe_u32 v88, v1, 2, 1
    v_add_u32 v197, v197, v88
    v_lshlrev_b32 v197, 6, v197
    v_lshl_add_u32 v197, v196, 3, v197
    v_add_u32 v197, s83, v197
    s_mov_b32 s65, 0
    s_mov_b32 m0, s83
Lstgo_11:
    s_nop 0
    buffer_load_dwordx4 v195, s[24:27], s65 offen lds
    s_add_u32 m0, m0, 1024
    s_add_u32 s65, s65, 20480
    s_cmp_lt_u32 s65, 409600
    s_cbranch_scc1 Lstgo_11
    s_waitcnt vmcnt(0)
    ds_read_b64_tr_b16 a[240:241], v197 offset:0
    ds_read_b64_tr_b16 a[242:243], v197 offset:128
    ds_read_b64_tr_b16 a[244:245], v197 offset:2048
    ds_read_b64_tr_b16 a[246:247], v197 offset:2176
    ds_read_b64_tr_b16 a[248:249], v197 offset:32
    ds_read_b64_tr_b16 a[250:251], v197 offset:160
    ds_read_b64_tr_b16 a[252:253], v197 offset:2080
    ds_read_b64_tr_b16 a[254:255], v197 offset:2208
    ds_read_b64_tr_b16 v[4:5], v197 offset:4096
    ds_read_b64_tr_b16 v[6:7], v197 offset:4224
    ds_read_b64_tr_b16 v[8:9], v197 offset:6144
    ds_read_b64_tr_b16 v[10:11], v197 offset:6272
    ds_read_b64_tr_b16 v[12:13], v197 offset:4128
    ds_read_b64_tr_b16 v[14:15], v197 offset:4256
    ds_read_b64_tr_b16 v[16:17], v197 offset:6176
    ds_read_b64_tr_b16 v[18:19], v197 offset:6304
    ds_read_b64_tr_b16 v[20:21], v197 offset:8192
    ds_read_b64_tr_b16 v[22:23], v197 offset:8320
    ds_read_b64_tr_b16 v[24:25], v197 offset:10240
    ds_read_b64_tr_b16 v[26:27], v197 offset:10368
    ds_read_b64_tr_b16 v[28:29], v197 offset:8224
    ds_read_b64_tr_b16 v[30:31], v197 offset:8352
    ds_read_b64_tr_b16 v[32:33], v197 offset:10272
    ds_read_b64_tr_b16 v[34:35], v197 offset:10400
    ds_read_b64_tr_b16 v[36:37], v197 offset:12288
    ds_read_b64_tr_b16 v[38:39], v197 offset:12416
    ds_read_b64_tr_b16 v[40:41], v197 offset:14336
    ds_read_b64_tr_b16 v[42:43], v197 offset:14464
    ds_read_b64_tr_b16 v[44:45], v197 offset:12320
    ds_read_b64_tr_b16 v[46:47], v197 offset:12448
    ds_read_b64_tr_b16 v[48:49], v197 offset:14368
    ds_read_b64_tr_b16 v[50:51], v197 offset:14496
    ds_read_b64_tr_b16 v[52:53], v197 offset:16384
    ds_read_b64_tr_b16 v[54:55], v197 offset:16512
    ds_read_b64_tr_b16 v[56:57], v197 offset:18432
    ds_read_b64_tr_b16 v[58:59], v197 offset:18560
    ds_read_b64_tr_b16 v[60:61], v197 offset:16416
    ds_read_b64_tr_b16 v[62:63], v197 offset:16544
    ds_read_b64_tr_b16 v[64:65], v197 offset:18464
    ds_read_b64_tr_b16 v[66:67], v197 offset:18592
    s_waitcnt lgkmcnt(0)
    s_mov_b32 s65, 409600
    s_mov_b32 m0, s83
Lstgo_12:
    s_nop 0
    buffer_load_dwordx4 v195, s[24:27], s65 offen lds
    s_add_u32 m0, m0, 1024
    s_add_u32 s65, s65, 20480
    s_cmp_lt_u32 s65, 491520
    s_cbranch_scc1 Lstgo_12
    s_waitcnt vmcnt(0)
    ds_read_b64_tr_b16 v[68:69], v197 offset:0
    ds_read_b64_tr_b16 v[70:71], v197 offset:128
    ds_read_b64_tr_b16 v[72:73], v197 offset:2048
    ds_read_b64_tr_b16 v[74:75], v197 offset:2176
    ds_read_b64_tr_b16 v[76:77], v197 offset:32
    ds_read_b64_tr_b16 v[78:79], v197 offset:160
    ds_read_b64_tr_b16 v[80:81], v197 offset:2080
    ds_read_b64_tr_b16 v[82:83], v197 offset:2208
Lnowo_10:
    s_waitcnt vmcnt(0)
    s_waitcnt lgkmcnt(0)
    s_barrier
    v_subrev_u32 v193, 81920, v193
    v_subrev_u32 v194, 81920, v194
    ds_read_b64_tr_b16 a[160:161], v193 offset:0
    ds_read_b64_tr_b16 a[162:163], v193 offset:512
    ds_read_b64_tr_b16 a[164:165], v193 offset:4096
    ds_read_b64_tr_b16 a[166:167], v193 offset:4608
    ds_read_b64_tr_b16 a[168:169], v193 offset:8192
    ds_read_b64_tr_b16 a[170:171], v193 offset:8704
    ds_read_b64_tr_b16 a[172:173], v193 offset:12288
    ds_read_b64_tr_b16 a[174:175], v193 offset:12800
    ds_read_b64_tr_b16 a[176:177], v193 offset:16384
    ds_read_b64_tr_b16 a[178:179], v193 offset:16896
    ds_read_b64_tr_b16 a[180:181], v193 offset:20480
    ds_read_b64_tr_b16 a[182:183], v193 offset:20992
    ds_read_b64_tr_b16 a[184:185], v193 offset:24576
    ds_read_b64_tr_b16 a[186:187], v193 offset:25088
    ds_read_b64_tr_b16 a[188:189], v193 offset:28672
    ds_read_b64_tr_b16 a[190:191], v193 offset:29184
    ds_read_b64_tr_b16 a[192:193], v193 offset:32768
    ds_read_b64_tr_b16 a[194:195], v193 offset:33280
    ds_read_b64_tr_b16 a[196:197], v193 offset:36864
    ds_read_b64_tr_b16 a[198:199], v193 offset:37376
    ds_read_b64_tr_b16 a[200:201], v194 offset:0
    ds_read_b64_tr_b16 a[202:203], v194 offset:512
    ds_read_b64_tr_b16 a[204:205], v194 offset:4096
    ds_read_b64_tr_b16 a[206:207], v194 offset:4608
    ds_read_b64_tr_b16 a[208:209], v194 offset:8192
    ds_read_b64_tr_b16 a[210:211], v194 offset:8704
    ds_read_b64_tr_b16 a[212:213], v194 offset:12288
    ds_read_b64_tr_b16 a[214:215], v194 offset:12800
    ds_read_b64_tr_b16 a[216:217], v194 offset:16384
    ds_read_b64_tr_b16 a[218:219], v194 offset:16896
    ds_read_b64_tr_b16 a[220:221], v194 offset:20480
    ds_read_b64_tr_b16 a[222:223], v194 offset:20992
    ds_read_b64_tr_b16 a[224:225], v194 offset:24576
    ds_read_b64_tr_b16 a[226:227], v194 offset:25088
    ds_read_b64_tr_b16 a[228:229], v194 offset:28672
    ds_read_b64_tr_b16 a[230:231], v194 offset:29184
    ds_read_b64_tr_b16 a[232:233], v194 offset:32768
    ds_read_b64_tr_b16 a[234:235], v194 offset:33280
    ds_read_b64_tr_b16 a[236:237], v194 offset:36864
    ds_read_b64_tr_b16 a[238:239], v194 offset:37376
    s_cmp_eq_u32 s60, 0
    s_cselect_b64 exec, 1, 0
    v_mov_b32 v2, 1
    s_cbranch_execz Lld_13
    buffer_atomic_add v2, off, s[8:11], 0 offset:28
Lld_13:
    s_mov_b64 exec, -1
    v_mov_b32 v3, 20
    buffer_load_dword v2, v3, s[8:11], 0 offen sc1
Lgchk_14:
    s_waitcnt vmcnt(0)
    v_cmp_gt_u32 vcc, 256, v2
    s_cbranch_vccnz Lgrty_15
    s_waitcnt lgkmcnt(0)
    s_barrier
    v_mov_b64 v[192:193], 0
    v_mov_b64 v[194:195], 0
    ds_write_b128 v235, v[192:195] offset:14336
    v_mul_u32_u24 v197, 1280, v84
    v_lshrrev_b32 v198, 4, v0
    v_lshl_add_u32 v197, v198, 5, v197
    v_lshl_add_u32 v197, v85, 2, v197
    buffer_load_dword v200, v197, s[28:31], 0 offen offset:0
    buffer_load_dword v201, v197, s[28:31], 0 offen offset:8
    buffer_load_dword v202, v197, s[28:31], 0 offen offset:16
    buffer_load_dword v203, v197, s[28:31], 0 offen offset:24
    buffer_load_dword v204, v197, s[28:31], 0 offen offset:512
    buffer_load_dword v205, v197, s[28:31], 0 offen offset:520
    buffer_load_dword v206, v197, s[28:31], 0 offen offset:528
    buffer_load_dword v207, v197, s[28:31], 0 offen offset:536
    buffer_load_dword v208, v197, s[28:31], 0 offen offset:1024
    buffer_load_dword v209, v197, s[28:31], 0 offen offset:1032
    buffer_load_dword v210, v197, s[28:31], 0 offen offset:1040
    buffer_load_dword v211, v197, s[28:31], 0 offen offset:1048
    s_waitcnt vmcnt(8)
    ds_write_b128 v235, v[200:203] offset:0
    s_waitcnt vmcnt(4)
    ds_write_b128 v235, v[204:207] offset:4096
    s_waitcnt vmcnt(0)
    ds_write_b128 v235, v[208:211] offset:8192
    s_cmp_eq_u32 s60, 2
    s_cbranch_scc0 Lnofl_16
    s_add_u32 s64, s62, 1
    v_add_u32 v3, s64, v255
    v_min_i32 v3, 64, v3
    buffer_load_dword v2, v254, s[4:7], 0 offen sc1
Lfchk_17:
    s_waitcnt vmcnt(0)
    v_cmp_gt_i32 vcc, v3, v2
    s_cbranch_vccnz Lfrty_18
Lnofl_16:
    s_waitcnt lgkmcnt(0)
    s_barrier
    s_add_u32 m0, s73, 0
    s_nop 0
    buffer_load_dwordx4 v232, s[4:7], s74 offen offset:0 sc1 lds
    s_add_u32 m0, s73, 896
    s_nop 0
    buffer_load_dwordx4 v232, s[4:7], s74 offen offset:128 sc1 lds
    s_add_u32 m0, s73, 1792
    s_nop 0
    buffer_load_dwordx4 v232, s[4:7], s74 offen offset:256 sc1 lds
    s_add_u32 m0, s73, 2688
    s_nop 0
    buffer_load_dwordx4 v232, s[4:7], s74 offen offset:384 sc1 lds
    s_add_u32 m0, s73, 3584
    s_nop 0
    buffer_load_dwordx4 v232, s[4:7], s74 offen offset:512 sc1 lds
    s_add_u32 m0, s73, 4480
    s_nop 0
    buffer_load_dwordx4 v232, s[4:7], s74 offen offset:640 sc1 lds
    s_add_u32 m0, s73, 5376
    s_nop 0
    buffer_load_dwordx4 v232, s[4:7], s74 offen offset:768 sc1 lds
    s_add_u32 m0, s73, 6272
    s_nop 0
    buffer_load_dwordx4 v232, s[4:7], s74 offen offset:896 sc1 lds
    s_add_u32 m0, s73, 7168
    s_nop 0
    buffer_load_dwordx4 v232, s[4:7], s74 offen offset:1024 sc1 lds
    s_add_u32 m0, s73, 8064
    s_nop 0
    buffer_load_dwordx4 v232, s[4:7], s74 offen offset:1152 sc1 lds
    s_add_u32 s74, s74, 40960
    s_xor_b32 s73, s73, 65536
    s_waitcnt vmcnt(0)
    s_cmp_eq_u32 s60, 2
    s_cbranch_scc0 Lnofl_19
    s_add_u32 s64, s62, 2
    v_add_u32 v3, s64, v255
    v_min_i32 v3, 64, v3
    buffer_load_dword v2, v254, s[4:7], 0 offen sc1
Lfchk_20:
    s_waitcnt vmcnt(0)
    v_cmp_gt_i32 vcc, v3, v2
    s_cbranch_vccnz Lfrty_21
Lnofl_19:
    s_barrier
    s_add_u32 m0, s73, 0
    s_nop 0
    buffer_load_dwordx4 v232, s[4:7], s74 offen offset:0 sc1 lds
    s_add_u32 m0, s73, 896
    s_nop 0
    buffer_load_dwordx4 v232, s[4:7], s74 offen offset:128 sc1 lds
    s_add_u32 m0, s73, 1792
    s_nop 0
    buffer_load_dwordx4 v232, s[4:7], s74 offen offset:256 sc1 lds
    s_add_u32 m0, s73, 2688
    s_nop 0
    buffer_load_dwordx4 v232, s[4:7], s74 offen offset:384 sc1 lds
    s_add_u32 m0, s73, 3584
    s_nop 0
    buffer_load_dwordx4 v232, s[4:7], s74 offen offset:512 sc1 lds
    s_add_u32 m0, s73, 4480
    s_nop 0
    buffer_load_dwordx4 v232, s[4:7], s74 offen offset:640 sc1 lds
    s_add_u32 m0, s73, 5376
    s_nop 0
    buffer_load_dwordx4 v232, s[4:7], s74 offen offset:768 sc1 lds
    s_add_u32 m0, s73, 6272
    s_nop 0
    buffer_load_dwordx4 v232, s[4:7], s74 offen offset:896 sc1 lds
    s_add_u32 m0, s73, 7168
    s_nop 0
    buffer_load_dwordx4 v232, s[4:7], s74 offen offset:1024 sc1 lds
    s_add_u32 m0, s73, 8064
    s_nop 0
    buffer_load_dwordx4 v232, s[4:7], s74 offen offset:1152 sc1 lds
    s_add_u32 s74, s74, 40960
    s_xor_b32 s73, s73, 65536
    ds_read_b128 v[124:127], v233 offset:0
    ds_read_b128 v[128:131], v233 offset:20480
    ds_read_b128 v[132:135], v234 offset:0
    ds_read_b128 v[136:139], v234 offset:20480
    ds_read_b128 v[140:143], v233 offset:1024
    s_waitcnt lgkmcnt(4)
    v_mfma_f32_16x16x32_bf16 v[148:151], a[0:3], v[124:127], 0
    ds_read_b128 v[144:147], v233 offset:21504
    v_mfma_f32_16x16x32_bf16 v[156:159], a[80:83], v[124:127], 0
    v_mov_b64 v[192:193], 0
    v_mfma_f32_16x16x32_bf16 v[164:167], v[124:127], a[160:163], 0
    v_mov_b64 v[194:195], 0
    s_waitcnt lgkmcnt(4)
    v_mfma_f32_16x16x32_bf16 v[152:155], a[0:3], v[128:131], 0
    ds_read_b128 v[124:127], v234 offset:1024
    v_mfma_f32_16x16x32_bf16 v[160:163], a[80:83], v[128:131], 0
    v_mov_b64 v[196:197], 0
    v_mfma_f32_16x16x32_bf16 v[168:171], v[128:131], a[160:163], 0
    v_mov_b64 v[198:199], 0
    s_waitcnt lgkmcnt(4)
    v_mfma_f32_16x16x32_bf16 v[148:151], a[4:7], v[132:135], v[148:151]
    ds_read_b128 v[128:131], v234 offset:21504
    v_mfma_f32_16x16x32_bf16 v[156:159], a[84:87], v[132:135], v[156:159]
    v_mov_b64 v[200:201], 0
    v_mfma_f32_16x16x32_bf16 v[164:167], v[132:135], a[164:167], v[164:167]
    v_mov_b64 v[202:203], 0
    s_waitcnt lgkmcnt(4)
    v_mfma_f32_16x16x32_bf16 v[152:155], a[4:7], v[136:139], v[152:155]
    ds_read_b128 v[132:135], v233 offset:2048
    v_mfma_f32_16x16x32_bf16 v[160:163], a[84:87], v[136:139], v[160:163]
    v_mfma_f32_16x16x32_bf16 v[168:171], v[136:139], a[164:167], v[168:171]
    s_waitcnt lgkmcnt(4)
    v_mfma_f32_16x16x32_bf16 v[148:151], a[8:11], v[140:143], v[148:151]
    ds_read_b128 v[136:139], v233 offset:22528
    v_mfma_f32_16x16x32_bf16 v[156:159], a[88:91], v[140:143], v[156:159]
    v_mfma_f32_16x16x32_bf16 v[164:167], v[140:143], a[168:171], v[164:167]
    s_waitcnt lgkmcnt(4)
    v_mfma_f32_16x16x32_bf16 v[152:155], a[8:11], v[144:147], v[152:155]
    ds_read_b128 v[140:143], v234 offset:2048
    v_mfma_f32_16x16x32_bf16 v[160:163], a[88:91], v[144:147], v[160:163]
    v_mfma_f32_16x16x32_bf16 v[168:171], v[144:147], a[168:171], v[168:171]
    s_waitcnt lgkmcnt(4)
    v_mfma_f32_16x16x32_bf16 v[148:151], a[12:15], v[124:127], v[148:151]
    ds_read_b128 v[144:147], v234 offset:22528
    v_mfma_f32_16x16x32_bf16 v[156:159], a[92:95], v[124:127], v[156:159]
    v_mfma_f32_16x16x32_bf16 v[164:167], v[124:127], a[172:175], v[164:167]
    s_waitcnt lgkmcnt(4)
    v_mfma_f32_16x16x32_bf16 v[152:155], a[12:15], v[128:131], v[152:155]
    ds_read_b128 v[124:127], v233 offset:3072
    v_mfma_f32_16x16x32_bf16 v[160:163], a[92:95], v[128:131], v[160:163]
    v_mfma_f32_16x16x32_bf16 v[168:171], v[128:131], a[172:175], v[168:171]
    s_waitcnt lgkmcnt(4)
    v_mfma_f32_16x16x32_bf16 v[148:151], a[16:19], v[132:135], v[148:151]
    ds_read_b128 v[128:131], v233 offset:23552
    v_mfma_f32_16x16x32_bf16 v[156:159], a[96:99], v[132:135], v[156:159]
    v_mfma_f32_16x16x32_bf16 v[164:167], v[132:135], a[176:179], v[164:167]
    s_waitcnt lgkmcnt(4)
    v_mfma_f32_16x16x32_bf16 v[152:155], a[16:19], v[136:139], v[152:155]
    ds_read_b128 v[132:135], v234 offset:3072
    v_mfma_f32_16x16x32_bf16 v[160:163], a[96:99], v[136:139], v[160:163]
    v_mfma_f32_16x16x32_bf16 v[168:171], v[136:139], a[176:179], v[168:171]
    s_waitcnt lgkmcnt(4)
    v_mfma_f32_16x16x32_bf16 v[148:151], a[20:23], v[140:143], v[148:151]
    ds_read_b128 v[136:139], v234 offset:23552
    v_mfma_f32_16x16x32_bf16 v[156:159], a[100:103], v[140:143], v[156:159]
    v_mfma_f32_16x16x32_bf16 v[164:167], v[140:143], a[180:183], v[164:167]
    s_waitcnt lgkmcnt(4)
    v_mfma_f32_16x16x32_bf16 v[152:155], a[20:23], v[144:147], v[152:155]
    ds_read_b128 v[140:143], v233 offset:4096
    v_mfma_f32_16x16x32_bf16 v[160:163], a[100:103], v[144:147], v[160:163]
    v_mfma_f32_16x16x32_bf16 v[168:171], v[144:147], a[180:183], v[168:171]
    s_waitcnt lgkmcnt(4)
    v_mfma_f32_16x16x32_bf16 v[148:151], a[24:27], v[124:127], v[148:151]
    ds_read_b128 v[144:147], v233 offset:24576
    v_mfma_f32_16x16x32_bf16 v[156:159], a[104:107], v[124:127], v[156:159]
    v_mfma_f32_16x16x32_bf16 v[164:167], v[124:127], a[184:187], v[164:167]
    s_waitcnt lgkmcnt(4)
    v_mfma_f32_16x16x32_bf16 v[152:155], a[24:27], v[128:131], v[152:155]
    ds_read_b128 v[124:127], v234 offset:4096
    v_mfma_f32_16x16x32_bf16 v[160:163], a[104:107], v[128:131], v[160:163]
    v_mfma_f32_16x16x32_bf16 v[168:171], v[128:131], a[184:187], v[168:171]
    s_waitcnt lgkmcnt(4)
    v_mfma_f32_16x16x32_bf16 v[148:151], a[28:31], v[132:135], v[148:151]
    ds_read_b128 v[128:131], v234 offset:24576
    v_mfma_f32_16x16x32_bf16 v[156:159], a[108:111], v[132:135], v[156:159]
    v_mfma_f32_16x16x32_bf16 v[164:167], v[132:135], a[188:191], v[164:167]
    s_waitcnt lgkmcnt(4)
    v_mfma_f32_16x16x32_bf16 v[152:155], a[28:31], v[136:139], v[152:155]
    ds_read_b128 v[132:135], v233 offset:5120
    v_mfma_f32_16x16x32_bf16 v[160:163], a[108:111], v[136:139], v[160:163]
    v_mfma_f32_16x16x32_bf16 v[168:171], v[136:139], a[188:191], v[168:171]
    s_waitcnt lgkmcnt(4)
    v_mfma_f32_16x16x32_bf16 v[148:151], a[32:35], v[140:143], v[148:151]
    ds_read_b128 v[136:139], v233 offset:25600
    v_mfma_f32_16x16x32_bf16 v[156:159], a[112:115], v[140:143], v[156:159]
    v_mfma_f32_16x16x32_bf16 v[164:167], v[140:143], a[192:195], v[164:167]
    s_waitcnt lgkmcnt(4)
    v_mfma_f32_16x16x32_bf16 v[152:155], a[32:35], v[144:147], v[152:155]
    ds_read_b128 v[140:143], v234 offset:5120
    v_mfma_f32_16x16x32_bf16 v[160:163], a[112:115], v[144:147], v[160:163]
    v_mfma_f32_16x16x32_bf16 v[168:171], v[144:147], a[192:195], v[168:171]
    s_waitcnt lgkmcnt(4)
    v_mfma_f32_16x16x32_bf16 v[148:151], a[36:39], v[124:127], v[148:151]
    ds_read_b128 v[144:147], v234 offset:25600
    v_mfma_f32_16x16x32_bf16 v[156:159], a[116:119], v[124:127], v[156:159]
    v_mfma_f32_16x16x32_bf16 v[164:167], v[124:127], a[196:199], v[164:167]
    s_waitcnt lgkmcnt(4)
    v_mfma_f32_16x16x32_bf16 v[152:155], a[36:39], v[128:131], v[152:155]
    ds_read_b128 v[124:127], v233 offset:6144
    v_mfma_f32_16x16x32_bf16 v[160:163], a[116:119], v[128:131], v[160:163]
    v_mfma_f32_16x16x32_bf16 v[168:171], v[128:131], a[196:199], v[168:171]
    s_waitcnt lgkmcnt(4)
    v_mfma_f32_16x16x32_bf16 v[148:151], a[40:43], v[132:135], v[148:151]
    ds_read_b128 v[128:131], v233 offset:26624
    v_mfma_f32_16x16x32_bf16 v[156:159], a[120:123], v[132:135], v[156:159]
    v_mfma_f32_16x16x32_bf16 v[164:167], v[132:135], a[200:203], v[164:167]
    s_waitcnt lgkmcnt(4)
    v_mfma_f32_16x16x32_bf16 v[152:155], a[40:43], v[136:139], v[152:155]
    ds_read_b128 v[132:135], v234 offset:6144
    v_mfma_f32_16x16x32_bf16 v[160:163], a[120:123], v[136:139], v[160:163]
    v_mfma_f32_16x16x32_bf16 v[168:171], v[136:139], a[200:203], v[168:171]
    s_waitcnt lgkmcnt(4)
    v_mfma_f32_16x16x32_bf16 v[148:151], a[44:47], v[140:143], v[148:151]
    ds_read_b128 v[136:139], v234 offset:26624
    v_mfma_f32_16x16x32_bf16 v[156:159], a[124:127], v[140:143], v[156:159]
    v_mfma_f32_16x16x32_bf16 v[164:167], v[140:143], a[204:207], v[164:167]
    s_waitcnt lgkmcnt(4)
    v_mfma_f32_16x16x32_bf16 v[152:155], a[44:47], v[144:147], v[152:155]
    ds_read_b128 v[140:143], v233 offset:7168
    v_mfma_f32_16x16x32_bf16 v[160:163], a[124:127], v[144:147], v[160:163]
    v_mfma_f32_16x16x32_bf16 v[168:171], v[144:147], a[204:207], v[168:171]
    s_waitcnt lgkmcnt(4)
    v_mfma_f32_16x16x32_bf16 v[148:151], a[48:51], v[124:127], v[148:151]
    ds_read_b128 v[144:147], v233 offset:27648
    v_mfma_f32_16x16x32_bf16 v[156:159], a[128:131], v[124:127], v[156:159]
    v_mfma_f32_16x16x32_bf16 v[164:167], v[124:127], a[208:211], v[164:167]
    s_waitcnt lgkmcnt(4)
    v_mfma_f32_16x16x32_bf16 v[152:155], a[48:51], v[128:131], v[152:155]
    ds_read_b128 v[124:127], v234 offset:7168
    v_mfma_f32_16x16x32_bf16 v[160:163], a[128:131], v[128:131], v[160:163]
    v_mfma_f32_16x16x32_bf16 v[168:171], v[128:131], a[208:211], v[168:171]
    s_waitcnt lgkmcnt(4)
    v_mfma_f32_16x16x32_bf16 v[148:151], a[52:55], v[132:135], v[148:151]
    ds_read_b128 v[128:131], v234 offset:27648
    v_mfma_f32_16x16x32_bf16 v[156:159], a[132:135], v[132:135], v[156:159]
    v_mfma_f32_16x16x32_bf16 v[164:167], v[132:135], a[212:215], v[164:167]
    s_waitcnt lgkmcnt(4)
    v_mfma_f32_16x16x32_bf16 v[152:155], a[52:55], v[136:139], v[152:155]
    ds_read_b128 v[132:135], v233 offset:8192
    v_mfma_f32_16x16x32_bf16 v[160:163], a[132:135], v[136:139], v[160:163]
    v_mfma_f32_16x16x32_bf16 v[168:171], v[136:139], a[212:215], v[168:171]
    s_waitcnt lgkmcnt(4)
    v_mfma_f32_16x16x32_bf16 v[148:151], a[56:59], v[140:143], v[148:151]
    ds_read_b128 v[136:139], v233 offset:28672
    v_mfma_f32_16x16x32_bf16 v[156:159], a[136:139], v[140:143], v[156:159]
    v_mfma_f32_16x16x32_bf16 v[164:167], v[140:143], a[216:219], v[164:167]
    s_waitcnt lgkmcnt(4)
    v_mfma_f32_16x16x32_bf16 v[152:155], a[56:59], v[144:147], v[152:155]
    ds_read_b128 v[140:143], v234 offset:8192
    v_mfma_f32_16x16x32_bf16 v[160:163], a[136:139], v[144:147], v[160:163]
    v_mfma_f32_16x16x32_bf16 v[168:171], v[144:147], a[216:219], v[168:171]
    s_waitcnt lgkmcnt(4)
    v_mfma_f32_16x16x32_bf16 v[148:151], a[60:63], v[124:127], v[148:151]
    ds_read_b128 v[144:147], v234 offset:28672
    v_mfma_f32_16x16x32_bf16 v[156:159], a[140:143], v[124:127], v[156:159]
    v_mfma_f32_16x16x32_bf16 v[164:167], v[124:127], a[220:223], v[164:167]
    s_waitcnt lgkmcnt(4)
    v_mfma_f32_16x16x32_bf16 v[152:155], a[60:63], v[128:131], v[152:155]
    ds_read_b128 v[124:127], v233 offset:9216
    v_mfma_f32_16x16x32_bf16 v[160:163], a[140:143], v[128:131], v[160:163]
    v_mfma_f32_16x16x32_bf16 v[168:171], v[128:131], a[220:223], v[168:171]
    s_waitcnt lgkmcnt(4)
    v_mfma_f32_16x16x32_bf16 v[148:151], a[64:67], v[132:135], v[148:151]
    ds_read_b128 v[128:131], v233 offset:29696
    v_mfma_f32_16x16x32_bf16 v[156:159], a[144:147], v[132:135], v[156:159]
    v_mfma_f32_16x16x32_bf16 v[164:167], v[132:135], a[224:227], v[164:167]
    s_waitcnt lgkmcnt(4)
    v_mfma_f32_16x16x32_bf16 v[152:155], a[64:67], v[136:139], v[152:155]
    ds_read_b128 v[132:135], v234 offset:9216
    v_mfma_f32_16x16x32_bf16 v[160:163], a[144:147], v[136:139], v[160:163]
    v_mfma_f32_16x16x32_bf16 v[168:171], v[136:139], a[224:227], v[168:171]
    s_waitcnt lgkmcnt(4)
    v_mfma_f32_16x16x32_bf16 v[148:151], a[68:71], v[140:143], v[148:151]
    ds_read_b128 v[136:139], v234 offset:29696
    v_mfma_f32_16x16x32_bf16 v[156:159], a[148:151], v[140:143], v[156:159]
    v_mfma_f32_16x16x32_bf16 v[164:167], v[140:143], a[228:231], v[164:167]
    s_waitcnt lgkmcnt(4)
    v_mfma_f32_16x16x32_bf16 v[152:155], a[68:71], v[144:147], v[152:155]
    v_mfma_f32_16x16x32_bf16 v[160:163], a[148:151], v[144:147], v[160:163]
    v_mfma_f32_16x16x32_bf16 v[168:171], v[144:147], a[228:231], v[168:171]
    s_waitcnt lgkmcnt(3)
    v_mfma_f32_16x16x32_bf16 v[148:151], a[72:75], v[124:127], v[148:151]
    v_mfma_f32_16x16x32_bf16 v[156:159], a[152:155], v[124:127], v[156:159]
    v_mfma_f32_16x16x32_bf16 v[164:167], v[124:127], a[232:235], v[164:167]
    s_waitcnt lgkmcnt(2)
    v_mfma_f32_16x16x32_bf16 v[152:155], a[72:75], v[128:131], v[152:155]
    v_mfma_f32_16x16x32_bf16 v[160:163], a[152:155], v[128:131], v[160:163]
    v_mfma_f32_16x16x32_bf16 v[168:171], v[128:131], a[232:235], v[168:171]
    s_waitcnt lgkmcnt(1)
    v_mfma_f32_16x16x32_bf16 v[148:151], a[76:79], v[132:135], v[148:151]
    v_mfma_f32_16x16x32_bf16 v[156:159], a[156:159], v[132:135], v[156:159]
    v_mfma_f32_16x16x32_bf16 v[164:167], v[132:135], a[236:239], v[164:167]
    s_waitcnt lgkmcnt(0)
    v_mfma_f32_16x16x32_bf16 v[152:155], a[76:79], v[136:139], v[152:155]
    v_mfma_f32_16x16x32_bf16 v[160:163], a[156:159], v[136:139], v[160:163]
    v_mfma_f32_16x16x32_bf16 v[168:171], v[136:139], a[236:239], v[168:171]
    v_xor_b32 v233, 0x10000, v233
    v_xor_b32 v234, 0x10000, v234
    v_cvt_pk_bf16_f32 v148, v148, v149
    v_cvt_pk_bf16_f32 v149, v150, v151
    ds_write_b64 v244, v[148:149] offset:22528
    v_cvt_pk_bf16_f32 v156, v156, v157
    v_cvt_pk_bf16_f32 v157, v158, v159
    ds_write_b64 v244, v[156:157] offset:26624
    v_cvt_pk_bf16_f32 v172, v164, v165
    v_cvt_pk_bf16_f32 v173, v166, v167
    v_cvt_pk_bf16_f32 v152, v152, v153
    v_cvt_pk_bf16_f32 v153, v154, v155
    ds_write_b64 v244, v[152:153] offset:24576
    v_cvt_pk_bf16_f32 v160, v160, v161
    v_cvt_pk_bf16_f32 v161, v162, v163
    ds_write_b64 v244, v[160:161] offset:28672
    v_cvt_pk_bf16_f32 v176, v168, v169
    v_cvt_pk_bf16_f32 v177, v170, v171
    s_lshl_b32 s72, s58, 20
    s_waitcnt vmcnt(0)
    s_cmp_eq_u32 s60, 2
    s_cbranch_scc0 Lnofl_22
    s_add_u32 s64, s62, 3
    v_add_u32 v3, s64, v255
    v_min_i32 v3, 64, v3
    buffer_load_dword v2, v254, s[4:7], 0 offen sc1
Lfchk_23:
    s_waitcnt vmcnt(0)
    v_cmp_gt_i32 vcc, v3, v2
    s_cbranch_vccnz Lfrty_24
Lnofl_22:
L_Cstep:
    s_waitcnt lgkmcnt(0)
    s_barrier
    ds_read_b128 v[84:87], v237 offset:0
    ds_read_b128 v[88:91], v237 offset:1024
    ds_read_b128 v[92:95], v237 offset:2048
    ds_read_b128 v[96:99], v237 offset:3072
    ds_read_b128 v[100:103], v237 offset:4096
    ds_read_b128 v[104:107], v237 offset:5120
    ds_read_b128 v[108:111], v237 offset:6144
    ds_read_b128 v[112:115], v237 offset:7168
    ds_read_b128 v[116:119], v237 offset:8192
    ds_read_b128 v[120:123], v237 offset:9216
    s_add_u32 m0, s73, 0
    s_add_u32 s79, s72, s76
    s_add_u32 s80, s72, s77
    s_add_u32 s81, s72, s78
    buffer_load_dwordx4 v232, s[4:7], s74 offen offset:0 sc1 lds
    s_add_u32 m0, s73, 896
    s_nop 0
    buffer_load_dwordx4 v232, s[4:7], s74 offen offset:128 sc1 lds
    s_add_u32 m0, s73, 1792
    s_waitcnt lgkmcnt(9)
    v_smfmac_f32_16x16x64_bf16 v[192:195], v[84:87], a[0:7], v225
    v_smfmac_f32_16x16x64_bf16 v[196:199], v[84:87], a[80:87], v225
    s_waitcnt lgkmcnt(8)
    v_smfmac_f32_16x16x64_bf16 v[192:195], v[88:91], a[8:15], v225
    buffer_load_dwordx4 v232, s[4:7], s74 offen offset:256 sc1 lds
    s_add_u32 m0, s73, 2688
    v_smfmac_f32_16x16x64_bf16 v[196:199], v[88:91], a[88:95], v225
    s_waitcnt lgkmcnt(7)
    v_smfmac_f32_16x16x64_bf16 v[192:195], v[92:95], a[16:23], v225
    v_smfmac_f32_16x16x64_bf16 v[196:199], v[92:95], a[96:103], v225
    s_waitcnt lgkmcnt(6)
    v_smfmac_f32_16x16x64_bf16 v[192:195], v[96:99], a[24:31], v225
    buffer_load_dwordx4 v232, s[4:7], s74 offen offset:384 sc1 lds
    s_add_u32 m0, s73, 3584
    v_smfmac_f32_16x16x64_bf16 v[196:199], v[96:99], a[104:111], v225
    s_waitcnt lgkmcnt(5)
    v_smfmac_f32_16x16x64_bf16 v[192:195], v[100:103], a[32:39], v225
    v_smfmac_f32_16x16x64_bf16 v[196:199], v[100:103], a[112:119], v225
    s_waitcnt lgkmcnt(4)
    v_smfmac_f32_16x16x64_bf16 v[192:195], v[104:107], a[40:47], v225
    v_smfmac_f32_16x16x64_bf16 v[196:199], v[104:107], a[120:127], v225
    s_waitcnt lgkmcnt(3)
    v_smfmac_f32_16x16x64_bf16 v[192:195], v[108:111], a[48:55], v225
    v_smfmac_f32_16x16x64_bf16 v[196:199], v[108:111], a[128:135], v225
    s_waitcnt lgkmcnt(2)
    v_smfmac_f32_16x16x64_bf16 v[192:195], v[112:115], a[56:63], v225
    v_smfmac_f32_16x16x64_bf16 v[196:199], v[112:115], a[136:143], v225
    s_waitcnt lgkmcnt(1)
    v_smfmac_f32_16x16x64_bf16 v[192:195], v[116:119], a[64:71], v225
    v_smfmac_f32_16x16x64_bf16 v[196:199], v[116:119], a[144:151], v225
    s_waitcnt lgkmcnt(0)
    v_smfmac_f32_16x16x64_bf16 v[192:195], v[120:123], a[72:79], v225
    v_smfmac_f32_16x16x64_bf16 v[196:199], v[120:123], a[152:159], v225
    v_smfmac_f32_16x16x64_bf16 v[200:203], v[84:87], a[160:167], v225
    ds_read_b128 v[148:151], v237 offset:26624
    ds_read_b128 v[152:155], v237 offset:27648
    ds_read_b128 v[156:159], v237 offset:28672
    ds_read_b128 v[160:163], v237 offset:29696
    ds_read_b128 v[164:167], v245 offset:22528
    ds_read_b128 v[168:171], v245 offset:23552
    v_smfmac_f32_16x16x64_bf16 v[200:203], v[88:91], a[168:175], v225
    v_permlane32_swap_b32 v192, v196
    v_permlane32_swap_b32 v193, v197
    v_permlane32_swap_b32 v194, v198
    v_permlane32_swap_b32 v195, v199
    v_pk_add_f32 v[192:193], v[192:193], v[196:197]
    v_pk_add_f32 v[194:195], v[194:195], v[198:199]
    v_cvt_pk_bf16_f32 v192, v192, v193
    v_cvt_pk_bf16_f32 v193, v194, v195
    ds_write_b64 v242, v[192:193] offset:12288
    v_smfmac_f32_16x16x64_bf16 v[200:203], v[92:95], a[176:183], v225
    v_smfmac_f32_16x16x64_bf16 v[200:203], v[96:99], a[184:191], v225
    v_smfmac_f32_16x16x64_bf16 v[200:203], v[100:103], a[192:199], v225
    v_smfmac_f32_16x16x64_bf16 v[200:203], v[104:107], a[200:207], v225
    v_smfmac_f32_16x16x64_bf16 v[200:203], v[108:111], a[208:215], v225
    s_waitcnt lgkmcnt(0)
    s_barrier
    ds_read_b64_tr_b16 v[124:125], v243 offset:12288
    ds_read_b64_tr_b16 v[126:127], v243 offset:12352
    ds_read_b64_tr_b16 v[132:133], v243 offset:13312
    ds_read_b64_tr_b16 v[134:135], v243 offset:13376
    ds_read_b64_tr_b16 v[128:129], v243 offset:12800
    ds_read_b64_tr_b16 v[130:131], v243 offset:12864
    ds_read_b64_tr_b16 v[136:137], v243 offset:13824
    ds_read_b64_tr_b16 v[138:139], v243 offset:13888
    v_smfmac_f32_16x16x64_bf16 v[200:203], v[112:115], a[216:223], v225
    s_add_u32 s85, s74, 40960
    v_smfmac_f32_16x16x64_bf16 v[200:203], v[116:119], a[224:231], v225
    s_cmp_lt_u32 s59, 20
    s_cselect_b32 s85, s72, s85
    s_cselect_b32 s86, 4096, 0
    s_add_u32 s86, s86, s85
    v_smfmac_f32_16x16x64_bf16 v[200:203], v[120:123], a[232:239], v225
    v_mfma_f32_16x16x32_bf16 v[140:143], v[148:151], v[164:167], 0
    v_mfma_f32_16x16x32_bf16 v[144:147], v[156:159], v[164:167], 0
    v_mfma_f32_16x16x32_bf16 v[140:143], v[152:155], v[168:171], v[140:143]
    v_mfma_f32_16x16x32_bf16 v[144:147], v[160:163], v[168:171], v[144:147]
    s_waitcnt lgkmcnt(6)
    v_mfma_f32_16x16x32_bf16 v[204:207], v[148:151], v[124:127], 0
    v_mfma_f32_16x16x32_bf16 v[208:211], v[156:159], v[124:127], 0
    s_waitcnt lgkmcnt(4)
    v_mfma_f32_16x16x32_bf16 v[212:215], v[132:135], v[124:127], 0
    s_waitcnt lgkmcnt(2)
    v_mfma_f32_16x16x32_bf16 v[204:207], v[152:155], v[128:131], v[204:207]
    v_mfma_f32_16x16x32_bf16 v[208:211], v[160:163], v[128:131], v[208:211]
    s_waitcnt lgkmcnt(0)
    v_mfma_f32_16x16x32_bf16 v[212:215], v[136:139], v[128:131], v[212:215]
    v_mfma_f32_16x16x32_bf16 v[216:219], v[132:135], v[164:167], 0
    v_mfma_f32_16x16x32_bf16 v[216:219], v[136:139], v[168:171], v[216:219]
    v_cndmask_b32 v226, v140, v144, s[96:97]
    v_cndmask_b32 v227, v141, v145, s[96:97]
    v_cndmask_b32 v228, v142, v146, s[96:97]
    v_cndmask_b32 v229, v143, v147, s[96:97]
    v_cndmask_b32 v220, v204, v208, s[96:97]
    v_cndmask_b32 v221, v205, v209, s[96:97]
    v_cndmask_b32 v222, v206, v210, s[96:97]
    v_cndmask_b32 v223, v207, v211, s[96:97]
    v_cndmask_b32 v212, v212, v213, s[96:97]
    v_cndmask_b32 v214, v214, v215, s[96:97]
    v_cndmask_b32 v224, v212, v214, s[98:99]
    s_cmp_eq_u32 s60, 0
    s_cbranch_scc0 Lw_25
    buffer_store_dwordx4 v[220:223], v237, s[4:7], s79 offen
    buffer_store_dword v224, v238, s[4:7], s79 offen offset:1024
Lw_25:
    ds_read_b128 v[124:127], v233 offset:0
    ds_read_b128 v[128:131], v233 offset:20480
    ds_read_b128 v[132:135], v234 offset:0
    ds_read_b128 v[136:139], v234 offset:20480
    ds_read_b128 v[140:143], v233 offset:1024
    v_cndmask_b32 v216, v216, v217, s[96:97]
    v_cndmask_b32 v218, v218, v219, s[96:97]
    v_cndmask_b32 v230, v216, v218, s[98:99]
    buffer_store_dwordx4 v[226:229], v239, s[4:7], s79 offen
    buffer_store_dword v230, v240, s[4:7], s79 offen offset:1024
    v_permlane32_swap_b32 v200, v202
    v_permlane32_swap_b32 v201, v203
    v_pk_add_f32 v[200:201], v[200:201], v[202:203]
    v_cvt_pk_bf16_f32 v174, v200, v201
    v_cvt_pk_bf16_f32 v178, v200, v201
    s_waitcnt lgkmcnt(4)
    v_mfma_f32_16x16x32_bf16 v[148:151], a[0:3], v[124:127], 0
    ds_read_b128 v[144:147], v233 offset:21504
    v_mfma_f32_16x16x32_bf16 v[156:159], a[80:83], v[124:127], 0
    v_mfma_f32_16x16x32_bf16 v[164:167], v[124:127], a[160:163], 0
    s_waitcnt lgkmcnt(4)
    v_mfma_f32_16x16x32_bf16 v[152:155], a[0:3], v[128:131], 0
    ds_read_b128 v[124:127], v234 offset:1024
    v_mfma_f32_16x16x32_bf16 v[160:163], a[80:83], v[128:131], 0
    v_mfma_f32_16x16x32_bf16 v[168:171], v[128:131], a[160:163], 0
    s_waitcnt lgkmcnt(4)
    v_mfma_f32_16x16x32_bf16 v[148:151], a[4:7], v[132:135], v[148:151]
    ds_read_b128 v[128:131], v234 offset:21504
    v_mfma_f32_16x16x32_bf16 v[156:159], a[84:87], v[132:135], v[156:159]
    buffer_load_dwordx4 v[204:207], v237, s[4:7], s80 offen sc1
    v_mfma_f32_16x16x32_bf16 v[164:167], v[132:135], a[164:167], v[164:167]
    buffer_load_dwordx4 v[208:211], v237, s[4:7], s81 offen sc1
    s_waitcnt lgkmcnt(4)
    v_mfma_f32_16x16x32_bf16 v[152:155], a[4:7], v[136:139], v[152:155]
    ds_read_b128 v[132:135], v233 offset:2048
    v_mfma_f32_16x16x32_bf16 v[160:163], a[84:87], v[136:139], v[160:163]
    buffer_load_dword v212, v238, s[4:7], s80 offen offset:1024 sc1
    v_mfma_f32_16x16x32_bf16 v[168:171], v[136:139], a[164:167], v[168:171]
    buffer_load_dword v213, v238, s[4:7], s81 offen offset:1024 sc1
    s_waitcnt lgkmcnt(4)
    v_mfma_f32_16x16x32_bf16 v[148:151], a[8:11], v[140:143], v[148:151]
    ds_read_b128 v[136:139], v233 offset:22528
    v_mfma_f32_16x16x32_bf16 v[156:159], a[88:91], v[140:143], v[156:159]
    v_mfma_f32_16x16x32_bf16 v[164:167], v[140:143], a[168:171], v[164:167]
    s_waitcnt lgkmcnt(4)
    v_mfma_f32_16x16x32_bf16 v[152:155], a[8:11], v[144:147], v[152:155]
    ds_read_b128 v[140:143], v234 offset:2048
    v_mfma_f32_16x16x32_bf16 v[160:163], a[88:91], v[144:147], v[160:163]
    v_mfma_f32_16x16x32_bf16 v[168:171], v[144:147], a[168:171], v[168:171]
    s_waitcnt lgkmcnt(4)
    v_mfma_f32_16x16x32_bf16 v[148:151], a[12:15], v[124:127], v[148:151]
    ds_read_b128 v[144:147], v234 offset:22528
    v_mfma_f32_16x16x32_bf16 v[156:159], a[92:95], v[124:127], v[156:159]
    v_mfma_f32_16x16x32_bf16 v[164:167], v[124:127], a[172:175], v[164:167]
Lchk_26:
    s_waitcnt vmcnt(3)
    v_max3_u32 v214, v204, v205, v206
    s_waitcnt vmcnt(2)
    v_max3_u32 v214, v214, v207, v208
    v_max3_u32 v214, v214, v209, v210
    s_waitcnt vmcnt(1)
    v_max3_u32 v214, v214, v211, v212
    s_waitcnt vmcnt(0)
    v_max_u32 v214, v214, v213
    v_cmp_eq_u32 vcc, -1, v214
    s_cbranch_vccnz Lrty_27
    v_pk_add_f32 v[204:205], v[204:205], v[208:209]
    v_pk_add_f32 v[206:207], v[206:207], v[210:211]
    v_add_f32 v212, v212, v213
    v_pk_add_f32 v[220:221], v[220:221], v[204:205]
    v_pk_add_f32 v[222:223], v[222:223], v[206:207]
    v_add_f32 v224, v224, v212
    v_max3_f32 v214, v220, v221, v222
    v_max3_f32 v214, v214, v223, v224
    buffer_load_dwordx4 v[108:111], v239, s[4:7], s80 offen sc1
    buffer_load_dwordx4 v[112:115], v239, s[4:7], s81 offen sc1
    v_max_f32_dpp v214, v214, v214 row_ror:8 row_mask:0xf bank_mask:0xf
    v_mov_b32 v215, v214
    buffer_load_dword v116, v240, s[4:7], s80 offen offset:1024 sc1
    buffer_load_dword v117, v240, s[4:7], s81 offen offset:1024 sc1
    v_permlane16_swap_b32 v214, v215
    v_max_f32 v214, v214, v215
    v_mov_b32 v215, v214
    s_nop 1
    v_permlane32_swap_b32 v214, v215
    v_max_f32 v214, v214, v215
    v_mul_f32 v214, s70, v214
    v_fma_f32 v220, v220, s70, -v214
    v_fma_f32 v221, v221, s70, -v214
    v_fma_f32 v222, v222, s70, -v214
    v_fma_f32 v223, v223, s70, -v214
    v_fma_f32 v224, v224, s70, -v214
    v_exp_f32 v224, v224
    v_exp_f32 v220, v220
    v_exp_f32 v221, v221
    v_exp_f32 v222, v222
    v_exp_f32 v223, v223
    v_cvt_pk_bf16_f32 v190, v224, v224
    v_cvt_pk_bf16_f32 v188, v220, v221
    v_and_b32 v190, v231, v190
    v_cvt_pk_bf16_f32 v189, v222, v223
    s_nop 1
    v_mfma_f32_16x16x32_bf16 v[200:203], v[184:187], v[188:191], 0
    v_mfma_f32_16x16x32_bf16 v[192:195], v[172:175], v[188:191], 0
    v_mfma_f32_16x16x32_bf16 v[196:199], v[176:179], v[188:191], 0
    s_nop 5
    v_add_f32_dpp v200, v200, v200 row_ror:8 row_mask:0xf bank_mask:0xf
    v_rcp_f32 v200, v200
    v_add_f32_dpp v192, v196, v192 row_ror:8 row_mask:0xf bank_mask:0xf
    v_add_f32_dpp v193, v197, v193 row_ror:8 row_mask:0xf bank_mask:0xf
    v_add_f32_dpp v194, v198, v194 row_ror:8 row_mask:0xf bank_mask:0xf
    v_add_f32_dpp v195, v199, v195 row_ror:8 row_mask:0xf bank_mask:0xf
    v_pk_mul_f32 v[192:193], v[192:193], v[200:201] op_sel_hi:[1,0]
    v_pk_mul_f32 v[194:195], v[194:195], v[200:201] op_sel_hi:[1,0]
    v_cvt_pk_bf16_f32 v192, v192, v193
    v_cvt_pk_bf16_f32 v193, v194, v195
    v_min_u32 v192, -2, v192
    v_min_u32 v193, -2, v193
    buffer_store_dwordx2 v[192:193], v248, s[4:7], s72 offen
Lchk_28:
    s_waitcnt vmcnt(4)
    v_max3_u32 v214, v108, v109, v110
    s_waitcnt vmcnt(3)
    v_max3_u32 v214, v214, v111, v112
    v_max3_u32 v214, v214, v113, v114
    s_waitcnt vmcnt(2)
    v_max3_u32 v214, v214, v115, v116
    s_waitcnt vmcnt(1)
    v_max_u32 v214, v214, v117
    v_cmp_eq_u32 vcc, -1, v214
    s_cbranch_vccnz Lrty_29
    v_pk_add_f32 v[108:109], v[108:109], v[112:113]
    v_pk_add_f32 v[110:111], v[110:111], v[114:115]
    v_add_f32 v116, v116, v117
    v_pk_add_f32 v[226:227], v[226:227], v[108:109]
    v_pk_add_f32 v[228:229], v[228:229], v[110:111]
    v_add_f32 v230, v230, v116
    v_mov_b32 v214, s71
    v_cndmask_b32 v226, v226, v214, s[88:89]
    v_cndmask_b32 v227, v227, v214, s[90:91]
    v_cndmask_b32 v228, v228, v214, s[92:93]
    v_cndmask_b32 v229, v229, v214, s[94:95]
    v_max3_f32 v214, v226, v227, v228
    v_max3_f32 v214, v214, v229, v230
    v_mov_b64 v[204:205], 0
    v_mov_b64 v[206:207], 0
    v_max_f32_dpp v214, v214, v214 row_ror:8 row_mask:0xf bank_mask:0xf
    v_mov_b32 v215, v214
    v_mov_b64 v[208:209], 0
    v_mov_b64 v[210:211], 0
    v_permlane16_swap_b32 v214, v215
    v_max_f32 v214, v214, v215
    v_mov_b32 v215, v214
    s_cmp_lt_u32 s62, 63
    s_cselect_b32 s87, s59, 31
    v_permlane32_swap_b32 v214, v215
    buffer_load_dwordx4 v[84:87], v249, s[4:7], s85 offen offset:0 sc1
    v_max_f32 v214, v214, v215
    v_mul_f32 v214, s70, v214
    buffer_load_dwordx4 v[88:91], v249, s[4:7], s85 offen offset:1024 sc1
    v_fma_f32 v226, v226, s70, -v214
    v_fma_f32 v227, v227, s70, -v214
    buffer_load_dwordx4 v[92:95], v249, s[4:7], s85 offen offset:2048 sc1
    v_fma_f32 v228, v228, s70, -v214
    v_fma_f32 v229, v229, s70, -v214
    buffer_load_dwordx4 v[96:99], v249, s[4:7], s85 offen offset:3072 sc1
    v_fma_f32 v230, v230, s70, -v214
    v_exp_f32 v230, v230
    buffer_load_dwordx4 v[100:103], v249, s[4:7], s86 offen offset:0 sc1
    v_exp_f32 v226, v226
    v_exp_f32 v227, v227
    buffer_load_dwordx4 v[104:107], v249, s[4:7], s86 offen offset:1024 sc1
    v_exp_f32 v228, v228
    v_exp_f32 v229, v229
    v_cvt_pk_bf16_f32 v198, v230, v230
    v_cvt_pk_bf16_f32 v196, v226, v227
    v_cvt_pk_bf16_f32 v197, v228, v229
    ds_write_b16 v247, v198 offset:14344
    ds_write_b64 v246, v[196:197] offset:14336
    s_waitcnt lgkmcnt(6)
    v_mfma_f32_16x16x32_bf16 v[152:155], a[12:15], v[128:131], v[152:155]
    ds_read_b128 v[124:127], v233 offset:3072
    v_mfma_f32_16x16x32_bf16 v[160:163], a[92:95], v[128:131], v[160:163]
    v_mfma_f32_16x16x32_bf16 v[168:171], v[128:131], a[172:175], v[168:171]
    s_waitcnt lgkmcnt(6)
    v_mfma_f32_16x16x32_bf16 v[148:151], a[16:19], v[132:135], v[148:151]
    ds_read_b128 v[128:131], v233 offset:23552
    v_mfma_f32_16x16x32_bf16 v[156:159], a[96:99], v[132:135], v[156:159]
    v_mfma_f32_16x16x32_bf16 v[164:167], v[132:135], a[176:179], v[164:167]
    s_waitcnt lgkmcnt(6)
    v_mfma_f32_16x16x32_bf16 v[152:155], a[16:19], v[136:139], v[152:155]
    ds_read_b128 v[132:135], v234 offset:3072
    v_mfma_f32_16x16x32_bf16 v[160:163], a[96:99], v[136:139], v[160:163]
    v_mfma_f32_16x16x32_bf16 v[168:171], v[136:139], a[176:179], v[168:171]
    s_cmp_ge_u32 s87, 20
    s_cbranch_scc1 L_CnoWo0
L_CWo:
    s_waitcnt vmcnt(5)
    v_smfmac_f32_16x16x64_bf16 v[204:207], v[84:87], a[240:247], v225
    v_max3_u32 v192, v84, v85, v84
    v_smfmac_f32_16x16x64_bf16 v[208:211], v[84:87], a[248:255], v225
    v_max3_u32 v192, v86, v87, v192
    s_waitcnt vmcnt(4)
    v_smfmac_f32_16x16x64_bf16 v[204:207], v[88:91], v[4:11], v225
    v_max3_u32 v192, v88, v89, v192
    v_smfmac_f32_16x16x64_bf16 v[208:211], v[88:91], v[12:19], v225
    v_max3_u32 v192, v90, v91, v192
    s_waitcnt vmcnt(3)
    v_smfmac_f32_16x16x64_bf16 v[204:207], v[92:95], v[20:27], v225
    v_max3_u32 v192, v92, v93, v192
    v_smfmac_f32_16x16x64_bf16 v[208:211], v[92:95], v[28:35], v225
    v_max3_u32 v192, v94, v95, v192
    s_waitcnt vmcnt(2)
    v_smfmac_f32_16x16x64_bf16 v[204:207], v[96:99], v[36:43], v225
    v_max3_u32 v192, v96, v97, v192
    v_smfmac_f32_16x16x64_bf16 v[208:211], v[96:99], v[44:51], v225
    v_max3_u32 v192, v98, v99, v192
    s_waitcnt vmcnt(1)
    v_smfmac_f32_16x16x64_bf16 v[204:207], v[100:103], v[52:59], v225
    v_max3_u32 v192, v100, v101, v192
    v_smfmac_f32_16x16x64_bf16 v[208:211], v[100:103], v[60:67], v225
    v_max3_u32 v192, v102, v103, v192
    s_waitcnt vmcnt(0)
    v_smfmac_f32_16x16x64_bf16 v[204:207], v[104:107], v[68:75], v225
    v_max3_u32 v192, v104, v105, v192
    v_smfmac_f32_16x16x64_bf16 v[208:211], v[104:107], v[76:83], v225
    v_max3_u32 v192, v106, v107, v192
    v_cmp_eq_u32 vcc, -1, v192
    s_cbranch_vccnz L_CWoR
    s_xor_b32 s80, s72, 524288
    s_xor_b32 s81, s79, 524288
    s_nop 2
    v_permlane32_swap_b32 v204, v208
    v_permlane32_swap_b32 v205, v209
    v_permlane32_swap_b32 v206, v210
    v_permlane32_swap_b32 v207, v211
    v_pk_add_f32 v[204:205], v[204:205], v[208:209]
    v_pk_add_f32 v[206:207], v[206:207], v[210:211]
    ds_write2_b32 v250, v204, v205 offset0:0 offset1:32
    ds_write2_b32 v250, v206, v207 offset0:64 offset1:96
L_CnoWo:
    s_waitcnt lgkmcnt(6)
    v_mfma_f32_16x16x32_bf16 v[148:151], a[20:23], v[140:143], v[148:151]
    ds_read_b128 v[136:139], v234 offset:23552
    v_mfma_f32_16x16x32_bf16 v[156:159], a[100:103], v[140:143], v[156:159]
    v_mfma_f32_16x16x32_bf16 v[164:167], v[140:143], a[180:183], v[164:167]
    s_waitcnt lgkmcnt(6)
    v_mfma_f32_16x16x32_bf16 v[152:155], a[20:23], v[144:147], v[152:155]
    ds_read_b128 v[140:143], v233 offset:4096
    v_mfma_f32_16x16x32_bf16 v[160:163], a[100:103], v[144:147], v[160:163]
    v_mfma_f32_16x16x32_bf16 v[168:171], v[144:147], a[180:183], v[168:171]
    s_waitcnt lgkmcnt(2)
    s_barrier
    s_cmp_eq_u32 s60, 3
    s_cbranch_scc1 L_Cw3
    ds_read_b64 v[120:121], v241 offset:16896
    ds_read_b128 v[112:115], v237 offset:14336
    ds_read_b128 v[116:119], v237 offset:15872
    v_mfma_f32_16x16x32_bf16 v[148:151], a[24:27], v[124:127], v[148:151]
    ds_read_b128 v[144:147], v233 offset:24576
    v_mfma_f32_16x16x32_bf16 v[156:159], a[104:107], v[124:127], v[156:159]
    s_cmp_eq_u32 s60, 2
    s_cbranch_scc0 Lw_30
    buffer_load_dword v2, v254, s[4:7], 0 offen sc1
Lw_30:
    v_mfma_f32_16x16x32_bf16 v[164:167], v[124:127], a[184:187], v[164:167]
    buffer_store_dwordx4 v[180:183], v239, s[4:7], s81 offen
    v_mfma_f32_16x16x32_bf16 v[152:155], a[24:27], v[128:131], v[152:155]
    ds_read_b128 v[124:127], v234 offset:4096
    v_mfma_f32_16x16x32_bf16 v[160:163], a[104:107], v[128:131], v[160:163]
    buffer_store_dword v180, v240, s[4:7], s81 offen offset:1024
    v_mfma_f32_16x16x32_bf16 v[168:171], v[128:131], a[184:187], v[168:171]
    buffer_store_dwordx2 v[180:181], v248, s[4:7], s80 offen
    s_cmp_eq_u32 s60, 0
    s_cbranch_scc0 Lw_31
    buffer_store_dwordx4 v[180:183], v237, s[4:7], s81 offen
    buffer_store_dword v180, v238, s[4:7], s81 offen offset:1024
Lw_31:
    s_cmp_lt_u32 s59, 20
    s_cselect_b32 s64, s60, 0
    s_cmp_eq_u32 s64, 1
    s_cbranch_scc0 Lw_32
    buffer_store_dwordx2 v[180:181], v251, s[4:7], s80 offen
    s_lshr_b32 s64, s80, 2
    s_and_b32 s64, s64, 0xf0000
    buffer_store_dwordx4 v[180:183], v252, s[4:7], s64 offen sc1
Lw_32:
    s_waitcnt lgkmcnt(4)
    v_mfma_f32_16x16x16_bf16 v[204:207], v[184:185], v[120:121], 0
    v_mfma_f32_16x16x16_bf16 v[196:199], v[176:177], v[120:121], 0
    s_waitcnt lgkmcnt(3)
    v_mfma_f32_16x16x32_bf16 v[200:203], v[184:187], v[112:115], 0
    v_mfma_f32_16x16x32_bf16 v[192:195], v[172:175], v[112:115], 0
    v_mfma_f32_16x16x32_bf16 v[148:151], a[28:31], v[132:135], v[148:151]
    ds_read_b128 v[128:131], v234 offset:24576
    v_mfma_f32_16x16x32_bf16 v[156:159], a[108:111], v[132:135], v[156:159]
    v_mfma_f32_16x16x32_bf16 v[164:167], v[132:135], a[188:191], v[164:167]
    s_waitcnt lgkmcnt(3)
    v_mfma_f32_16x16x32_bf16 v[204:207], v[184:187], v[116:119], v[204:207]
    v_mfma_f32_16x16x32_bf16 v[196:199], v[172:175], v[116:119], v[196:199]
    v_mfma_f32_16x16x32_bf16 v[152:155], a[28:31], v[136:139], v[152:155]
    ds_read_b128 v[132:135], v233 offset:5120
    v_mfma_f32_16x16x32_bf16 v[160:163], a[108:111], v[136:139], v[160:163]
    buffer_load_dwordx4 v232, s[4:7], s74 offen offset:512 sc1 lds
    s_add_u32 m0, s73, 4480
    v_mfma_f32_16x16x32_bf16 v[168:171], v[136:139], a[188:191], v[168:171]
    v_rcp_f32 v200, v200
    v_mfma_f32_16x16x32_bf16 v[148:151], a[32:35], v[140:143], v[148:151]
    ds_read_b128 v[136:139], v233 offset:25600
    v_mfma_f32_16x16x32_bf16 v[156:159], a[112:115], v[140:143], v[156:159]
    buffer_load_dwordx4 v232, s[4:7], s74 offen offset:640 sc1 lds
    s_add_u32 m0, s73, 5376
    v_mfma_f32_16x16x32_bf16 v[164:167], v[140:143], a[192:195], v[164:167]
    v_mul_f32 v192, v192, v200
    v_mul_f32 v193, v193, v200
    s_waitcnt lgkmcnt(4)
    v_mfma_f32_16x16x32_bf16 v[152:155], a[32:35], v[144:147], v[152:155]
    ds_read_b128 v[140:143], v234 offset:5120
    v_mfma_f32_16x16x32_bf16 v[160:163], a[112:115], v[144:147], v[160:163]
    v_mul_f32 v194, v194, v200
    v_mul_f32 v195, v195, v200
    v_mfma_f32_16x16x32_bf16 v[168:171], v[144:147], a[192:195], v[168:171]
    v_cvt_pk_bf16_f32 v208, v192, v193
    v_cvt_pk_bf16_f32 v209, v194, v195
    s_waitcnt lgkmcnt(4)
    v_mfma_f32_16x16x32_bf16 v[148:151], a[36:39], v[124:127], v[148:151]
    ds_read_b128 v[144:147], v234 offset:25600
    v_mfma_f32_16x16x32_bf16 v[156:159], a[116:119], v[124:127], v[156:159]
    v_rcp_f32 v204, v204
    v_mfma_f32_16x16x32_bf16 v[164:167], v[124:127], a[196:199], v[164:167]
    v_mul_f32 v196, v196, v204
    v_mul_f32 v197, v197, v204
    s_waitcnt lgkmcnt(4)
    v_mfma_f32_16x16x32_bf16 v[152:155], a[36:39], v[128:131], v[152:155]
    ds_read_b128 v[124:127], v233 offset:6144
    v_mfma_f32_16x16x32_bf16 v[160:163], a[116:119], v[128:131], v[160:163]
    v_mul_f32 v198, v198, v204
    v_mul_f32 v199, v199, v204
    v_mfma_f32_16x16x32_bf16 v[168:171], v[128:131], a[196:199], v[168:171]
    v_cvt_pk_bf16_f32 v210, v196, v197
    v_cvt_pk_bf16_f32 v211, v198, v199
    s_nop 0
    v_permlane32_swap_b32 v208, v210
    v_permlane32_swap_b32 v209, v211
    buffer_store_dwordx4 v[208:211], v253, s[4:7], s75 offen
    s_cmp_eq_u32 s62, 63
    s_cbranch_scc1 L_Clast
    s_add_u32 s75, s75, 393216
    s_add_u32 s66, s62, 1
    s_and_b32 s66, s66, 7
    s_cselect_b32 s66, 0, 3145728
    s_sub_u32 s75, s75, s66
    s_waitcnt lgkmcnt(4)
    v_mfma_f32_16x16x32_bf16 v[148:151], a[40:43], v[132:135], v[148:151]
    ds_read_b128 v[128:131], v233 offset:26624
    v_mfma_f32_16x16x32_bf16 v[156:159], a[120:123], v[132:135], v[156:159]
    buffer_load_dwordx4 v232, s[4:7], s74 offen offset:768 sc1 lds
    s_add_u32 m0, s73, 6272
    v_mfma_f32_16x16x32_bf16 v[164:167], v[132:135], a[200:203], v[164:167]
    v_mov_b64 v[192:193], 0
    s_waitcnt lgkmcnt(4)
    v_mfma_f32_16x16x32_bf16 v[152:155], a[40:43], v[136:139], v[152:155]
    ds_read_b128 v[132:135], v234 offset:6144
    v_mfma_f32_16x16x32_bf16 v[160:163], a[120:123], v[136:139], v[160:163]
    buffer_load_dwordx4 v232, s[4:7], s74 offen offset:896 sc1 lds
    s_add_u32 m0, s73, 7168
    v_mfma_f32_16x16x32_bf16 v[168:171], v[136:139], a[200:203], v[168:171]
    v_mov_b64 v[194:195], 0
    s_waitcnt lgkmcnt(4)
    v_mfma_f32_16x16x32_bf16 v[148:151], a[44:47], v[140:143], v[148:151]
    ds_read_b128 v[136:139], v234 offset:26624
    v_mfma_f32_16x16x32_bf16 v[156:159], a[124:127], v[140:143], v[156:159]
    buffer_load_dwordx4 v232, s[4:7], s74 offen offset:1024 sc1 lds
    s_add_u32 m0, s73, 8064
    v_mfma_f32_16x16x32_bf16 v[164:167], v[140:143], a[204:207], v[164:167]
    v_mov_b64 v[196:197], 0
    s_waitcnt lgkmcnt(4)
    v_mfma_f32_16x16x32_bf16 v[152:155], a[44:47], v[144:147], v[152:155]
    ds_read_b128 v[140:143], v233 offset:7168
    v_mfma_f32_16x16x32_bf16 v[160:163], a[124:127], v[144:147], v[160:163]
    buffer_load_dwordx4 v232, s[4:7], s74 offen offset:1152 sc1 lds
    v_mfma_f32_16x16x32_bf16 v[168:171], v[144:147], a[204:207], v[168:171]
    v_mov_b64 v[198:199], 0
    s_waitcnt lgkmcnt(4)
    v_mfma_f32_16x16x32_bf16 v[148:151], a[48:51], v[124:127], v[148:151]
    ds_read_b128 v[144:147], v233 offset:27648
    v_mfma_f32_16x16x32_bf16 v[156:159], a[128:131], v[124:127], v[156:159]
    v_mov_b64 v[200:201], 0
    v_mfma_f32_16x16x32_bf16 v[164:167], v[124:127], a[208:211], v[164:167]
    v_mov_b64 v[202:203], 0
    s_waitcnt lgkmcnt(4)
    v_mfma_f32_16x16x32_bf16 v[152:155], a[48:51], v[128:131], v[152:155]
    ds_read_b128 v[124:127], v234 offset:7168
    v_mfma_f32_16x16x32_bf16 v[160:163], a[128:131], v[128:131], v[160:163]
    s_add_u32 s82, s72, 178176
    s_add_u32 s83, s72, 182272
    v_mfma_f32_16x16x32_bf16 v[168:171], v[128:131], a[208:211], v[168:171]
    s_waitcnt lgkmcnt(4)
    v_mfma_f32_16x16x32_bf16 v[148:151], a[52:55], v[132:135], v[148:151]
    ds_read_b128 v[128:131], v234 offset:27648
    v_mfma_f32_16x16x32_bf16 v[156:159], a[132:135], v[132:135], v[156:159]
    v_mfma_f32_16x16x32_bf16 v[164:167], v[132:135], a[212:215], v[164:167]
    s_waitcnt lgkmcnt(4)
    v_mfma_f32_16x16x32_bf16 v[152:155], a[52:55], v[136:139], v[152:155]
    ds_read_b128 v[132:135], v233 offset:8192
    v_mfma_f32_16x16x32_bf16 v[160:163], a[132:135], v[136:139], v[160:163]
    v_mfma_f32_16x16x32_bf16 v[168:171], v[136:139], a[212:215], v[168:171]
    s_waitcnt lgkmcnt(4)
    v_mfma_f32_16x16x32_bf16 v[148:151], a[56:59], v[140:143], v[148:151]
    ds_read_b128 v[136:139], v233 offset:28672
    v_mfma_f32_16x16x32_bf16 v[156:159], a[136:139], v[140:143], v[156:159]
    s_add_u32 s64, s62, 1
    v_mov_b32 v3, s64
    s_mov_b64 exec, 1
    s_waitcnt vmcnt(4)
    buffer_store_dword v3, off, s[4:7], s3
    s_mov_b64 exec, -1
    v_mfma_f32_16x16x32_bf16 v[164:167], v[140:143], a[216:219], v[164:167]
    s_add_u32 s74, s74, 40960
    s_xor_b32 s73, s73, 65536
    s_waitcnt lgkmcnt(4)
    v_mfma_f32_16x16x32_bf16 v[152:155], a[56:59], v[144:147], v[152:155]
    ds_read_b128 v[140:143], v234 offset:8192
    v_mfma_f32_16x16x32_bf16 v[160:163], a[136:139], v[144:147], v[160:163]
    v_mfma_f32_16x16x32_bf16 v[168:171], v[144:147], a[216:219], v[168:171]
    s_waitcnt lgkmcnt(4)
    v_mfma_f32_16x16x32_bf16 v[148:151], a[60:63], v[124:127], v[148:151]
    ds_read_b128 v[144:147], v234 offset:28672
    v_mfma_f32_16x16x32_bf16 v[156:159], a[140:143], v[124:127], v[156:159]
    v_mfma_f32_16x16x32_bf16 v[164:167], v[124:127], a[220:223], v[164:167]
    s_waitcnt lgkmcnt(4)
    v_mfma_f32_16x16x32_bf16 v[152:155], a[60:63], v[128:131], v[152:155]
    ds_read_b128 v[124:127], v233 offset:9216
    v_mfma_f32_16x16x32_bf16 v[160:163], a[140:143], v[128:131], v[160:163]
    v_mfma_f32_16x16x32_bf16 v[168:171], v[128:131], a[220:223], v[168:171]
    s_waitcnt lgkmcnt(4)
    v_mfma_f32_16x16x32_bf16 v[148:151], a[64:67], v[132:135], v[148:151]
    ds_read_b128 v[128:131], v233 offset:29696
    v_mfma_f32_16x16x32_bf16 v[156:159], a[144:147], v[132:135], v[156:159]
    v_mfma_f32_16x16x32_bf16 v[164:167], v[132:135], a[224:227], v[164:167]
    s_waitcnt lgkmcnt(4)
    v_mfma_f32_16x16x32_bf16 v[152:155], a[64:67], v[136:139], v[152:155]
    ds_read_b128 v[132:135], v234 offset:9216
    v_mfma_f32_16x16x32_bf16 v[160:163], a[144:147], v[136:139], v[160:163]
    v_mfma_f32_16x16x32_bf16 v[168:171], v[136:139], a[224:227], v[168:171]
    s_waitcnt lgkmcnt(4)
    v_mfma_f32_16x16x32_bf16 v[148:151], a[68:71], v[140:143], v[148:151]
    ds_read_b128 v[136:139], v234 offset:29696
    v_mfma_f32_16x16x32_bf16 v[156:159], a[148:151], v[140:143], v[156:159]
    v_mfma_f32_16x16x32_bf16 v[164:167], v[140:143], a[228:231], v[164:167]
    s_waitcnt lgkmcnt(4)
    v_mfma_f32_16x16x32_bf16 v[152:155], a[68:71], v[144:147], v[152:155]
    v_mfma_f32_16x16x32_bf16 v[160:163], a[148:151], v[144:147], v[160:163]
    v_mfma_f32_16x16x32_bf16 v[168:171], v[144:147], a[228:231], v[168:171]
    s_cmp_eq_u32 s60, 2
    s_cbranch_scc0 Lnofl_33
    s_add_u32 s64, s62, 4
    v_add_u32 v3, s64, v255
    v_min_i32 v3, 64, v3
Lfchk_34:
    v_cmp_gt_i32 vcc, v3, v2
    s_cbranch_vccnz Lfrty_35
Lnofl_33:
    s_branch L_Cjoin
L_Cw3:
    ds_read_b128 v[96:99], v237 offset:18432
    ds_read_b128 v[100:103], v237 offset:19456
    ds_read_b128 v[104:107], v237 offset:20480
    ds_read_b128 v[108:111], v237 offset:21504
    ds_read_b64 v[120:121], v241 offset:16896
    ds_read_b128 v[112:115], v237 offset:14336
    ds_read_b128 v[116:119], v237 offset:15872
    v_mfma_f32_16x16x32_bf16 v[148:151], a[24:27], v[124:127], v[148:151]
    ds_read_b128 v[144:147], v233 offset:24576
    v_mfma_f32_16x16x32_bf16 v[156:159], a[104:107], v[124:127], v[156:159]
    s_lshr_b32 s65, s72, 2
    s_and_b32 s65, s65, 0xf0000
    v_mfma_f32_16x16x32_bf16 v[164:167], v[124:127], a[184:187], v[164:167]
    s_xor_b32 s82, s65, 262144
    v_mfma_f32_16x16x32_bf16 v[152:155], a[24:27], v[128:131], v[152:155]
    ds_read_b128 v[124:127], v234 offset:4096
    v_mfma_f32_16x16x32_bf16 v[160:163], a[104:107], v[128:131], v[160:163]
    s_xor_b32 s83, s65, 524288
    v_mfma_f32_16x16x32_bf16 v[168:171], v[128:131], a[184:187], v[168:171]
    s_xor_b32 s84, s65, 786432
    s_waitcnt lgkmcnt(7)
    v_pk_add_f32 v[96:97], v[96:97], v[100:101]
    v_pk_add_f32 v[98:99], v[98:99], v[102:103]
    s_waitcnt lgkmcnt(5)
    v_pk_add_f32 v[104:105], v[104:105], v[108:109]
    v_pk_add_f32 v[106:107], v[106:107], v[110:111]
    v_pk_add_f32 v[96:97], v[96:97], v[104:105]
    v_pk_add_f32 v[98:99], v[98:99], v[106:107]
    s_cmp_lt_u32 s87, 20
    s_cbranch_scc0 Lw_36
    buffer_store_dwordx4 v[96:99], v252, s[4:7], s65 offen sc1
Lw_36:
    s_waitcnt lgkmcnt(4)
    v_mfma_f32_16x16x16_bf16 v[204:207], v[184:185], v[120:121], 0
    v_mfma_f32_16x16x16_bf16 v[196:199], v[176:177], v[120:121], 0
    s_waitcnt lgkmcnt(3)
    v_mfma_f32_16x16x32_bf16 v[200:203], v[184:187], v[112:115], 0
    v_mfma_f32_16x16x32_bf16 v[192:195], v[172:175], v[112:115], 0
    v_mfma_f32_16x16x32_bf16 v[148:151], a[28:31], v[132:135], v[148:151]
    ds_read_b128 v[128:131], v234 offset:24576
    v_mfma_f32_16x16x32_bf16 v[156:159], a[108:111], v[132:135], v[156:159]
    v_mfma_f32_16x16x32_bf16 v[164:167], v[132:135], a[188:191], v[164:167]
    s_waitcnt lgkmcnt(3)
    v_mfma_f32_16x16x32_bf16 v[204:207], v[184:187], v[116:119], v[204:207]
    v_mfma_f32_16x16x32_bf16 v[196:199], v[172:175], v[116:119], v[196:199]
    v_mfma_f32_16x16x32_bf16 v[152:155], a[28:31], v[136:139], v[152:155]
    ds_read_b128 v[132:135], v233 offset:5120
    v_mfma_f32_16x16x32_bf16 v[160:163], a[108:111], v[136:139], v[160:163]
    buffer_load_dwordx4 v232, s[4:7], s74 offen offset:512 sc1 lds
    s_add_u32 m0, s73, 4480
    v_mfma_f32_16x16x32_bf16 v[168:171], v[136:139], a[188:191], v[168:171]
    v_rcp_f32 v200, v200
    v_mfma_f32_16x16x32_bf16 v[148:151], a[32:35], v[140:143], v[148:151]
    ds_read_b128 v[136:139], v233 offset:25600
    v_mfma_f32_16x16x32_bf16 v[156:159], a[112:115], v[140:143], v[156:159]
    buffer_load_dwordx4 v232, s[4:7], s74 offen offset:640 sc1 lds
    s_add_u32 m0, s73, 5376
    v_mfma_f32_16x16x32_bf16 v[164:167], v[140:143], a[192:195], v[164:167]
    v_mul_f32 v192, v192, v200
    v_mul_f32 v193, v193, v200
    s_waitcnt lgkmcnt(4)
    v_mfma_f32_16x16x32_bf16 v[152:155], a[32:35], v[144:147], v[152:155]
    ds_read_b128 v[140:143], v234 offset:5120
    v_mfma_f32_16x16x32_bf16 v[160:163], a[112:115], v[144:147], v[160:163]
    v_mul_f32 v194, v194, v200
    v_mul_f32 v195, v195, v200
    v_mfma_f32_16x16x32_bf16 v[168:171], v[144:147], a[192:195], v[168:171]
    v_cvt_pk_bf16_f32 v208, v192, v193
    v_cvt_pk_bf16_f32 v209, v194, v195
    s_waitcnt lgkmcnt(4)
    v_mfma_f32_16x16x32_bf16 v[148:151], a[36:39], v[124:127], v[148:151]
    ds_read_b128 v[144:147], v234 offset:25600
    v_mfma_f32_16x16x32_bf16 v[156:159], a[116:119], v[124:127], v[156:159]
    v_rcp_f32 v204, v204
    v_mfma_f32_16x16x32_bf16 v[164:167], v[124:127], a[196:199], v[164:167]
    v_mul_f32 v196, v196, v204
    v_mul_f32 v197, v197, v204
    s_waitcnt lgkmcnt(4)
    v_mfma_f32_16x16x32_bf16 v[152:155], a[36:39], v[128:131], v[152:155]
    ds_read_b128 v[124:127], v233 offset:6144
    v_mfma_f32_16x16x32_bf16 v[160:163], a[116:119], v[128:131], v[160:163]
    v_mul_f32 v198, v198, v204
    v_mul_f32 v199, v199, v204
    v_mfma_f32_16x16x32_bf16 v[168:171], v[128:131], a[196:199], v[168:171]
    v_cvt_pk_bf16_f32 v210, v196, v197
    v_cvt_pk_bf16_f32 v211, v198, v199
    s_nop 0
    v_permlane32_swap_b32 v208, v210
    v_permlane32_swap_b32 v209, v211
    buffer_store_dwordx4 v[208:211], v253, s[4:7], s75 offen
    s_cmp_eq_u32 s62, 63
    s_cbranch_scc1 L_Clast
    s_cmp_lt_u32 s87, 20
    s_cbranch_scc0 Lw_37
    buffer_load_dwordx4 v[100:103], v252, s[4:7], s82 offen sc1
    buffer_load_dwordx4 v[104:107], v252, s[4:7], s83 offen sc1
    buffer_load_dwordx4 v[108:111], v252, s[4:7], s84 offen sc1
Lw_37:
    s_waitcnt lgkmcnt(4)
    v_mfma_f32_16x16x32_bf16 v[148:151], a[40:43], v[132:135], v[148:151]
    ds_read_b128 v[128:131], v233 offset:26624
    v_mfma_f32_16x16x32_bf16 v[156:159], a[120:123], v[132:135], v[156:159]
    buffer_load_dwordx4 v232, s[4:7], s74 offen offset:768 sc1 lds
    s_add_u32 m0, s73, 6272
    v_mfma_f32_16x16x32_bf16 v[164:167], v[132:135], a[200:203], v[164:167]
    s_add_u32 s75, s75, 393216
    s_add_u32 s66, s62, 1
    s_waitcnt lgkmcnt(4)
    v_mfma_f32_16x16x32_bf16 v[152:155], a[40:43], v[136:139], v[152:155]
    ds_read_b128 v[132:135], v234 offset:6144
    v_mfma_f32_16x16x32_bf16 v[160:163], a[120:123], v[136:139], v[160:163]
    buffer_load_dwordx4 v232, s[4:7], s74 offen offset:896 sc1 lds
    s_add_u32 m0, s73, 7168
    v_mfma_f32_16x16x32_bf16 v[168:171], v[136:139], a[200:203], v[168:171]
    s_and_b32 s66, s66, 7
    s_cselect_b32 s66, 0, 3145728
    s_sub_u32 s75, s75, s66
    s_waitcnt lgkmcnt(4)
    v_mfma_f32_16x16x32_bf16 v[148:151], a[44:47], v[140:143], v[148:151]
    ds_read_b128 v[136:139], v234 offset:26624
    v_mfma_f32_16x16x32_bf16 v[156:159], a[124:127], v[140:143], v[156:159]
    buffer_load_dwordx4 v232, s[4:7], s74 offen offset:1024 sc1 lds
    s_add_u32 m0, s73, 8064
    v_mfma_f32_16x16x32_bf16 v[164:167], v[140:143], a[204:207], v[164:167]
    buffer_store_dwordx4 v[180:183], v239, s[4:7], s81 offen
    s_waitcnt lgkmcnt(4)
    v_mfma_f32_16x16x32_bf16 v[152:155], a[44:47], v[144:147], v[152:155]
    ds_read_b128 v[140:143], v233 offset:7168
    v_mfma_f32_16x16x32_bf16 v[160:163], a[124:127], v[144:147], v[160:163]
    buffer_load_dwordx4 v232, s[4:7], s74 offen offset:1152 sc1 lds
    v_mfma_f32_16x16x32_bf16 v[168:171], v[144:147], a[204:207], v[168:171]
    buffer_store_dword v180, v240, s[4:7], s81 offen offset:1024
    s_waitcnt lgkmcnt(4)
    v_mfma_f32_16x16x32_bf16 v[148:151], a[48:51], v[124:127], v[148:151]
    ds_read_b128 v[144:147], v233 offset:27648
    v_mfma_f32_16x16x32_bf16 v[156:159], a[128:131], v[124:127], v[156:159]
    buffer_store_dwordx2 v[180:181], v248, s[4:7], s80 offen
    v_mfma_f32_16x16x32_bf16 v[164:167], v[124:127], a[208:211], v[164:167]
    v_mov_b64 v[192:193], 0
    s_waitcnt lgkmcnt(4)
    v_mfma_f32_16x16x32_bf16 v[152:155], a[48:51], v[128:131], v[152:155]
    ds_read_b128 v[124:127], v234 offset:7168
    v_mfma_f32_16x16x32_bf16 v[160:163], a[128:131], v[128:131], v[160:163]
    v_mov_b64 v[194:195], 0
    v_mfma_f32_16x16x32_bf16 v[168:171], v[128:131], a[208:211], v[168:171]
    v_mov_b64 v[196:197], 0
    s_waitcnt lgkmcnt(4)
    v_mfma_f32_16x16x32_bf16 v[148:151], a[52:55], v[132:135], v[148:151]
    ds_read_b128 v[128:131], v234 offset:27648
    v_mfma_f32_16x16x32_bf16 v[156:159], a[132:135], v[132:135], v[156:159]
    v_mov_b64 v[198:199], 0
    v_mfma_f32_16x16x32_bf16 v[164:167], v[132:135], a[212:215], v[164:167]
    v_mov_b64 v[200:201], 0
    s_waitcnt lgkmcnt(4)
    v_mfma_f32_16x16x32_bf16 v[152:155], a[52:55], v[136:139], v[152:155]
    ds_read_b128 v[132:135], v233 offset:8192
    v_mfma_f32_16x16x32_bf16 v[160:163], a[132:135], v[136:139], v[160:163]
    v_mov_b64 v[202:203], 0
    v_mfma_f32_16x16x32_bf16 v[168:171], v[136:139], a[212:215], v[168:171]
    s_cmp_lt_u32 s87, 20
    s_cbranch_scc0 Lx3c_38
Lchk_39:
    s_waitcnt vmcnt(9)
    v_max3_u32 v112, v100, v101, v102
    s_waitcnt vmcnt(8)
    v_max3_u32 v112, v112, v103, v104
    v_max3_u32 v112, v112, v105, v106
    s_waitcnt vmcnt(7)
    v_max3_u32 v112, v112, v107, v108
    v_max3_u32 v112, v112, v109, v110
    v_max_u32 v112, v112, v111
    v_cmp_eq_u32 vcc, -1, v112
    s_cbranch_vccnz Lrty_40
    v_pk_add_f32 v[96:97], v[96:97], v[100:101]
    v_pk_add_f32 v[104:105], v[104:105], v[108:109]
    v_pk_add_f32 v[98:99], v[98:99], v[102:103]
    v_pk_add_f32 v[106:107], v[106:107], v[110:111]
    v_pk_add_f32 v[96:97], v[96:97], v[104:105]
    v_pk_add_f32 v[98:99], v[98:99], v[106:107]
    v_cvt_pk_bf16_f32 v96, v96, v97
    v_cvt_pk_bf16_f32 v97, v98, v99
    v_min_u32 v96, -2, v96
    v_min_u32 v97, -2, v97
    buffer_store_dwordx2 v[96:97], v251, s[4:7], s72 offen
Lx3c_38:
    s_waitcnt lgkmcnt(4)
    v_mfma_f32_16x16x32_bf16 v[148:151], a[56:59], v[140:143], v[148:151]
    ds_read_b128 v[136:139], v233 offset:28672
    v_mfma_f32_16x16x32_bf16 v[156:159], a[136:139], v[140:143], v[156:159]
    s_add_u32 s82, s72, 178176
    s_add_u32 s83, s72, 182272
    v_mfma_f32_16x16x32_bf16 v[164:167], v[140:143], a[216:219], v[164:167]
    s_add_u32 s64, s62, 1
    v_mov_b32 v3, s64
    s_mov_b64 exec, 1
    s_waitcnt vmcnt(7)
    buffer_store_dword v3, off, s[4:7], s3
    s_mov_b64 exec, -1
    s_waitcnt lgkmcnt(4)
    v_mfma_f32_16x16x32_bf16 v[152:155], a[56:59], v[144:147], v[152:155]
    ds_read_b128 v[140:143], v234 offset:8192
    v_mfma_f32_16x16x32_bf16 v[160:163], a[136:139], v[144:147], v[160:163]
    s_add_u32 s74, s74, 40960
    s_xor_b32 s73, s73, 65536
    v_mfma_f32_16x16x32_bf16 v[168:171], v[144:147], a[216:219], v[168:171]
    s_waitcnt lgkmcnt(4)
    v_mfma_f32_16x16x32_bf16 v[148:151], a[60:63], v[124:127], v[148:151]
    ds_read_b128 v[144:147], v234 offset:28672
    v_mfma_f32_16x16x32_bf16 v[156:159], a[140:143], v[124:127], v[156:159]
    v_mfma_f32_16x16x32_bf16 v[164:167], v[124:127], a[220:223], v[164:167]
    s_waitcnt lgkmcnt(4)
    v_mfma_f32_16x16x32_bf16 v[152:155], a[60:63], v[128:131], v[152:155]
    ds_read_b128 v[124:127], v233 offset:9216
    v_mfma_f32_16x16x32_bf16 v[160:163], a[140:143], v[128:131], v[160:163]
    v_mfma_f32_16x16x32_bf16 v[168:171], v[128:131], a[220:223], v[168:171]
    s_waitcnt lgkmcnt(4)
    v_mfma_f32_16x16x32_bf16 v[148:151], a[64:67], v[132:135], v[148:151]
    ds_read_b128 v[128:131], v233 offset:29696
    v_mfma_f32_16x16x32_bf16 v[156:159], a[144:147], v[132:135], v[156:159]
    v_mfma_f32_16x16x32_bf16 v[164:167], v[132:135], a[224:227], v[164:167]
    s_waitcnt lgkmcnt(4)
    v_mfma_f32_16x16x32_bf16 v[152:155], a[64:67], v[136:139], v[152:155]
    ds_read_b128 v[132:135], v234 offset:9216
    v_mfma_f32_16x16x32_bf16 v[160:163], a[144:147], v[136:139], v[160:163]
    v_mfma_f32_16x16x32_bf16 v[168:171], v[136:139], a[224:227], v[168:171]
    s_waitcnt lgkmcnt(4)
    v_mfma_f32_16x16x32_bf16 v[148:151], a[68:71], v[140:143], v[148:151]
    ds_read_b128 v[136:139], v234 offset:29696
    v_mfma_f32_16x16x32_bf16 v[156:159], a[148:151], v[140:143], v[156:159]
    v_mfma_f32_16x16x32_bf16 v[164:167], v[140:143], a[228:231], v[164:167]
    s_waitcnt lgkmcnt(4)
    v_mfma_f32_16x16x32_bf16 v[152:155], a[68:71], v[144:147], v[152:155]
    v_mfma_f32_16x16x32_bf16 v[160:163], a[148:151], v[144:147], v[160:163]
    v_mfma_f32_16x16x32_bf16 v[168:171], v[144:147], a[228:231], v[168:171]
L_Cjoin:
    s_waitcnt lgkmcnt(3)
    v_mfma_f32_16x16x32_bf16 v[148:151], a[72:75], v[124:127], v[148:151]
    buffer_load_dwordx4 v[84:87], v235, s[4:7], s82 offen sc1
    v_mfma_f32_16x16x32_bf16 v[156:159], a[152:155], v[124:127], v[156:159]
    buffer_load_dwordx4 v[88:91], v235, s[4:7], s83 offen sc1
    v_mfma_f32_16x16x32_bf16 v[164:167], v[124:127], a[232:235], v[164:167]
    buffer_load_dwordx2 v[92:93], v236, s[4:7], s82 offen sc1
    s_waitcnt lgkmcnt(2)
    v_mfma_f32_16x16x32_bf16 v[152:155], a[72:75], v[128:131], v[152:155]
    v_mfma_f32_16x16x32_bf16 v[160:163], a[152:155], v[128:131], v[160:163]
    v_mfma_f32_16x16x32_bf16 v[168:171], v[128:131], a[232:235], v[168:171]
    s_waitcnt lgkmcnt(1)
    v_mfma_f32_16x16x32_bf16 v[148:151], a[76:79], v[132:135], v[148:151]
    v_mfma_f32_16x16x32_bf16 v[156:159], a[156:159], v[132:135], v[156:159]
    v_mfma_f32_16x16x32_bf16 v[164:167], v[132:135], a[236:239], v[164:167]
    s_waitcnt lgkmcnt(0)
    v_mfma_f32_16x16x32_bf16 v[152:155], a[76:79], v[136:139], v[152:155]
    v_mfma_f32_16x16x32_bf16 v[160:163], a[156:159], v[136:139], v[160:163]
    v_mfma_f32_16x16x32_bf16 v[168:171], v[136:139], a[236:239], v[168:171]
    v_xor_b32 v233, 0x10000, v233
    v_xor_b32 v234, 0x10000, v234
    v_cvt_pk_bf16_f32 v148, v148, v149
    v_cvt_pk_bf16_f32 v149, v150, v151
    ds_write_b64 v244, v[148:149] offset:22528
    v_cvt_pk_bf16_f32 v156, v156, v157
    v_cvt_pk_bf16_f32 v157, v158, v159
    ds_write_b64 v244, v[156:157] offset:26624
    v_cvt_pk_bf16_f32 v172, v164, v165
    v_cvt_pk_bf16_f32 v173, v166, v167
    v_cvt_pk_bf16_f32 v152, v152, v153
    v_cvt_pk_bf16_f32 v153, v154, v155
    ds_write_b64 v244, v[152:153] offset:24576
    v_cvt_pk_bf16_f32 v160, v160, v161
    v_cvt_pk_bf16_f32 v161, v162, v163
    ds_write_b64 v244, v[160:161] offset:28672
    v_cvt_pk_bf16_f32 v176, v168, v169
    v_cvt_pk_bf16_f32 v177, v170, v171
Lchk_41:
    s_waitcnt vmcnt(2)
    v_max3_u32 v96, v84, v85, v86
    s_waitcnt vmcnt(1)
    v_max3_u32 v96, v96, v87, v88
    v_max3_u32 v96, v96, v89, v90
    s_waitcnt vmcnt(0)
    v_max3_u32 v96, v96, v91, v92
    v_max_u32 v96, v96, v93
    v_cmp_eq_u32 vcc, -1, v96
    s_cbranch_vccnz Lrty_42
    ds_write_b128 v235, v[84:87] offset:0
    ds_write_b128 v235, v[88:91] offset:4096
    ds_write_b64 v236, v[92:93] offset:0
    s_add_u32 s62, s62, 1
    s_add_u32 s64, s72, 262144
    s_and_b32 s64, s64, 786432
    s_andn2_b32 s72, s72, 786432
    s_or_b32 s72, s72, s64
    s_cmp_lg_u32 s62, 4
    s_cbranch_scc1 L_Cstep
    s_lshl_b32 s64, s68, 2
L_Cpar:
    buffer_load_dword v3, off, s[8:11], s64 offset:8 sc1
    s_sub_u32 s61, s61, 1
    s_mov_b32 s67, 16
    s_cbranch_scc1 L_fail
    s_waitcnt vmcnt(0)
    v_cmp_eq_u32 vcc, 0, v3
    s_cbranch_vccnz L_Cpar
    v_bfe_u32 v3, v3, 1, 1
    v_lshl_add_u32 v252, v3, 13, v252
    s_branch L_Cstep
Lgrty_15:
    s_sleep 4
    buffer_load_dword v2, v3, s[8:11], 0 offen sc1
    s_sub_u32 s61, s61, 1
    s_mov_b32 s67, 1
    s_cbranch_scc1 L_fail
    s_branch Lgchk_14
Lfrty_18:
    s_sleep 4
    buffer_load_dword v2, v254, s[4:7], 0 offen sc1
    s_sub_u32 s61, s61, 1
    s_mov_b32 s67, 10
    s_cbranch_scc1 L_fail
    s_waitcnt vmcnt(0)
    s_branch Lfchk_17
Lfrty_21:
    s_sleep 4
    buffer_load_dword v2, v254, s[4:7], 0 offen sc1
    s_sub_u32 s61, s61, 1
    s_mov_b32 s67, 10
    s_cbranch_scc1 L_fail
    s_waitcnt vmcnt(0)
    s_branch Lfchk_20
Lfrty_24:
    s_sleep 4
    buffer_load_dword v2, v254, s[4:7], 0 offen sc1
    s_sub_u32 s61, s61, 1
    s_mov_b32 s67, 10
    s_cbranch_scc1 L_fail
    s_waitcnt vmcnt(0)
    s_branch Lfchk_23
Lrty_27:
    buffer_load_dwordx4 v[204:207], v237, s[4:7], s80 offen sc1
    buffer_load_dwordx4 v[208:211], v237, s[4:7], s81 offen sc1
    buffer_load_dword v212, v238, s[4:7], s80 offen offset:1024 sc1
    buffer_load_dword v213, v238, s[4:7], s81 offen offset:1024 sc1
    s_sub_u32 s61, s61, 1
    s_mov_b32 s67, 11
    s_cbranch_scc1 L_fail
    s_waitcnt vmcnt(0)
    s_branch Lchk_26
Lrty_29:
    buffer_load_dwordx4 v[108:111], v239, s[4:7], s80 offen sc1
    buffer_load_dwordx4 v[112:115], v239, s[4:7], s81 offen sc1
    buffer_load_dword v116, v240, s[4:7], s80 offen offset:1024 sc1
    buffer_load_dword v117, v240, s[4:7], s81 offen offset:1024 sc1
    s_sub_u32 s61, s61, 1
    s_mov_b32 s67, 12
    s_cbranch_scc1 L_fail
    s_waitcnt vmcnt(0)
    s_branch Lchk_28
L_CnoWo0:
    s_waitcnt vmcnt(0)
    s_xor_b32 s80, s72, 524288
    s_xor_b32 s81, s79, 524288
    s_branch L_CnoWo
L_CWoR:
    buffer_load_dwordx4 v[84:87], v249, s[4:7], s85 offen offset:0 sc1
    buffer_load_dwordx4 v[88:91], v249, s[4:7], s85 offen offset:1024 sc1
    buffer_load_dwordx4 v[92:95], v249, s[4:7], s85 offen offset:2048 sc1
    buffer_load_dwordx4 v[96:99], v249, s[4:7], s85 offen offset:3072 sc1
    buffer_load_dwordx4 v[100:103], v249, s[4:7], s86 offen offset:0 sc1
    buffer_load_dwordx4 v[104:107], v249, s[4:7], s86 offen offset:1024 sc1
    s_sub_u32 s61, s61, 1
    s_mov_b32 s67, 13
    s_cbranch_scc1 L_fail
    v_mov_b64 v[204:205], 0
    v_mov_b64 v[206:207], 0
    v_mov_b64 v[208:209], 0
    v_mov_b64 v[210:211], 0
    s_branch L_CWo
L_Clast:
    s_waitcnt vmcnt(0)
    s_add_u32 s64, s62, 1
    v_mov_b32 v192, s64
    s_mov_b64 exec, 1
    buffer_store_dword v192, off, s[4:7], s3
    s_mov_b64 exec, -1
    s_endpgm
Lfrty_35:
    s_sleep 4
    buffer_load_dword v2, v254, s[4:7], 0 offen sc1
    s_sub_u32 s61, s61, 1
    s_mov_b32 s67, 10
    s_cbranch_scc1 L_fail
    s_waitcnt vmcnt(0)
    s_branch Lfchk_34
Lrty_40:
    buffer_load_dwordx4 v[100:103], v252, s[4:7], s82 offen sc1
    buffer_load_dwordx4 v[104:107], v252, s[4:7], s83 offen sc1
    buffer_load_dwordx4 v[108:111], v252, s[4:7], s84 offen sc1
    s_sub_u32 s61, s61, 1
    s_mov_b32 s67, 14
    s_cbranch_scc1 L_fail
    s_waitcnt vmcnt(0)
    s_branch Lchk_39
Lrty_42:
    buffer_load_dwordx4 v[84:87], v235, s[4:7], s82 offen sc1
    buffer_load_dwordx4 v[88:91], v235, s[4:7], s83 offen sc1
    buffer_load_dwordx2 v[92:93], v236, s[4:7], s82 offen sc1
    s_sub_u32 s61, s61, 1
    s_mov_b32 s67, 15
    s_cbranch_scc1 L_fail
    s_waitcnt vmcnt(0)
    s_branch Lchk_41
L_roleT:
    s_mov_b32 s24, s42
    s_mov_b32 s25, s43
    s_mov_b32 s26, 7864320
    s_mov_b32 s27, 0x20000
    v_mov_b32 v2, 0
    s_mov_b64 exec, 1
    buffer_store_dword v2, off, s[4:7], s63 sc1
    buffer_store_dword v2, off, s[4:7], s3
    s_mov_b64 exec, -1
    s_waitcnt vmcnt(0)
    s_barrier
    s_cmp_lg_u32 s60, 0
    s_cbranch_scc1 Larr_43
    s_mov_b64 exec, 1
    v_mov_b32 v2, 1
    v_mov_b32 v3, 20
    buffer_atomic_add v2, v3, s[8:11], 0 offen
    s_mov_b64 exec, -1
Larr_43:
    v_and_b32 v1, 63, v0
    s_and_b32 s74, s59, 1
    s_bfe_u32 s75, s59, 0x10001
    s_lshl_b32 s64, s69, 1
    s_add_u32 s75, s75, s64
    s_mul_i32 s64, s75, 983040
    s_mul_i32 s65, s60, 10240
    s_add_u32 s64, s64, s65
    s_lshl_b32 s65, s74, 8
    s_add_u32 s65, s65, s64
    v_lshrrev_b32 v164, 4, v1
    v_mul_u32_u24 v164, 1280, v164
    v_and_b32 v166, 15, v1
    v_lshl_add_u32 v164, v166, 4, v164
    v_add_u32 v164, s65, v164
    s_lshl_b32 s65, s74, 7
    s_add_u32 s65, s65, s64
    s_add_u32 s65, s65, 1024
    v_lshrrev_b32 v165, 3, v1
    v_mul_u32_u24 v165, 1280, v165
    v_and_b32 v166, 7, v1
    v_lshl_add_u32 v165, v166, 4, v165
    v_add_u32 v165, s65, v165
    v_lshrrev_b32 v166, 5, v1
    v_lshlrev_b32 v166, 4, v166
    v_bfe_u32 v167, v1, 2, 3
    v_add_u32 v166, v166, v167
    v_and_b32 v167, 3, v1
    v_lshlrev_b32 v168, 7, v166
    v_lshl_add_u32 v168, v167, 3, v168
    s_lshl_b32 s64, s60, 5
    v_add_u32 v168, s64, v168
    v_lshlrev_b32 v166, 1, v168
    v_add_u32 v167, 40960, v166
    v_add_u32 v169, 40960, v168
    v_lshlrev_b32 v240, 4, v0
    v_lshlrev_b32 v241, 4, v1
    s_lshl_b32 s64, s60, 14
    s_add_u32 s64, s64, 98304
    v_add_u32 v242, s64, v241
    s_lshl_b32 s70, s60, 11
    s_lshl_b32 s71, s60, 10
    s_mov_b32 s64, 0
    s_add_u32 m0, s70, 0
    s_nop 0
    buffer_load_dwordx4 v164, s[24:27], s64 offen lds
    s_mov_b32 s64, 5120
    s_add_u32 m0, s70, 1024
    s_nop 0
    buffer_load_dwordx4 v164, s[24:27], s64 offen lds
    s_mov_b32 s64, 512
    s_add_u32 m0, s70, 8192
    s_nop 0
    buffer_load_dwordx4 v164, s[24:27], s64 offen lds
    s_mov_b32 s64, 5632
    s_add_u32 m0, s70, 9216
    s_nop 0
    buffer_load_dwordx4 v164, s[24:27], s64 offen lds
    s_mov_b32 s64, 0
    s_add_u32 m0, s71, 16384
    s_nop 0
    buffer_load_dwordx4 v165, s[24:27], s64 offen lds
    s_mov_b32 s64, 40960
    s_add_u32 m0, s70, 20480
    s_nop 0
    buffer_load_dwordx4 v164, s[24:27], s64 offen lds
    s_mov_b32 s64, 46080
    s_add_u32 m0, s70, 21504
    s_nop 0
    buffer_load_dwordx4 v164, s[24:27], s64 offen lds
    s_mov_b32 s64, 41472
    s_add_u32 m0, s70, 28672
    s_nop 0
    buffer_load_dwordx4 v164, s[24:27], s64 offen lds
    s_mov_b32 s64, 46592
    s_add_u32 m0, s70, 29696
    s_nop 0
    buffer_load_dwordx4 v164, s[24:27], s64 offen lds
    s_mov_b32 s64, 40960
    s_add_u32 m0, s71, 36864
    s_nop 0
    buffer_load_dwordx4 v165, s[24:27], s64 offen lds
    s_mov_b32 s64, 81920
    s_add_u32 m0, s70, 40960
    s_nop 0
    buffer_load_dwordx4 v164, s[24:27], s64 offen lds
    s_mov_b32 s64, 87040
    s_add_u32 m0, s70, 41984
    s_nop 0
    buffer_load_dwordx4 v164, s[24:27], s64 offen lds
    s_mov_b32 s64, 82432
    s_add_u32 m0, s70, 49152
    s_nop 0
    buffer_load_dwordx4 v164, s[24:27], s64 offen lds
    s_mov_b32 s64, 87552
    s_add_u32 m0, s70, 50176
    s_nop 0
    buffer_load_dwordx4 v164, s[24:27], s64 offen lds
    s_mov_b32 s64, 81920
    s_add_u32 m0, s71, 57344
    s_nop 0
    buffer_load_dwordx4 v165, s[24:27], s64 offen lds
    s_waitcnt vmcnt(10)
    s_waitcnt lgkmcnt(0)
    s_barrier
    s_mov_b32 s64, 122880
    s_add_u32 m0, s70, 61440
    s_nop 0
    buffer_load_dwordx4 v164, s[24:27], s64 offen lds
    s_mov_b32 s64, 128000
    s_add_u32 m0, s70, 62464
    s_nop 0
    buffer_load_dwordx4 v164, s[24:27], s64 offen lds
    s_mov_b32 s64, 123392
    s_add_u32 m0, s70, 69632
    s_nop 0
    buffer_load_dwordx4 v164, s[24:27], s64 offen lds
    s_mov_b32 s64, 128512
    s_add_u32 m0, s70, 70656
    s_nop 0
    buffer_load_dwordx4 v164, s[24:27], s64 offen lds
    s_mov_b32 s64, 122880
    s_add_u32 m0, s71, 77824
    s_nop 0
    buffer_load_dwordx4 v165, s[24:27], s64 offen lds
    ds_read_b64_tr_b16 a[0:1], v166 offset:0
    ds_read_b64_tr_b16 a[2:3], v166 offset:2048
    ds_read_b64_tr_b16 a[4:5], v166 offset:8
    ds_read_b64_tr_b16 a[6:7], v166 offset:2056
    ds_read_b64_tr_b16 a[8:9], v166 offset:8192
    ds_read_b64_tr_b16 a[10:11], v166 offset:10240
    ds_read_b64_tr_b16 a[12:13], v166 offset:8200
    ds_read_b64_tr_b16 a[14:15], v166 offset:10248
    ds_read_b64_tr_b16 v[220:221], v168 offset:16384
    ds_read_b64_tr_b16 v[222:223], v168 offset:17408
    s_waitcnt lgkmcnt(0)
    ds_write_b128 v242, v[220:223] offset:0
    s_waitcnt vmcnt(10)
    s_waitcnt lgkmcnt(0)
    s_barrier
    s_mov_b32 s64, 163840
    s_add_u32 m0, s70, 0
    s_nop 0
    buffer_load_dwordx4 v164, s[24:27], s64 offen lds
    s_mov_b32 s64, 168960
    s_add_u32 m0, s70, 1024
    s_nop 0
    buffer_load_dwordx4 v164, s[24:27], s64 offen lds
    s_mov_b32 s64, 164352
    s_add_u32 m0, s70, 8192
    s_nop 0
    buffer_load_dwordx4 v164, s[24:27], s64 offen lds
    s_mov_b32 s64, 169472
    s_add_u32 m0, s70, 9216
    s_nop 0
    buffer_load_dwordx4 v164, s[24:27], s64 offen lds
    s_mov_b32 s64, 163840
    s_add_u32 m0, s71, 16384
    s_nop 0
    buffer_load_dwordx4 v165, s[24:27], s64 offen lds
    ds_read_b64_tr_b16 a[16:17], v166 offset:20480
    ds_read_b64_tr_b16 a[18:19], v166 offset:22528
    ds_read_b64_tr_b16 a[20:21], v166 offset:20488
    ds_read_b64_tr_b16 a[22:23], v166 offset:22536
    ds_read_b64_tr_b16 a[24:25], v166 offset:28672
    ds_read_b64_tr_b16 a[26:27], v166 offset:30720
    ds_read_b64_tr_b16 a[28:29], v166 offset:28680
    ds_read_b64_tr_b16 a[30:31], v166 offset:30728
    ds_read_b64_tr_b16 v[224:225], v168 offset:36864
    ds_read_b64_tr_b16 v[226:227], v168 offset:37888
    s_waitcnt lgkmcnt(0)
    ds_write_b128 v242, v[224:227] offset:1024
    s_waitcnt vmcnt(10)
    s_waitcnt lgkmcnt(0)
    s_barrier
    s_mov_b32 s64, 204800
    s_add_u32 m0, s70, 20480
    s_nop 0
    buffer_load_dwordx4 v164, s[24:27], s64 offen lds
    s_mov_b32 s64, 209920
    s_add_u32 m0, s70, 21504
    s_nop 0
    buffer_load_dwordx4 v164, s[24:27], s64 offen lds
    s_mov_b32 s64, 205312
    s_add_u32 m0, s70, 28672
    s_nop 0
    buffer_load_dwordx4 v164, s[24:27], s64 offen lds
    s_mov_b32 s64, 210432
    s_add_u32 m0, s70, 29696
    s_nop 0
    buffer_load_dwordx4 v164, s[24:27], s64 offen lds
    s_mov_b32 s64, 204800
    s_add_u32 m0, s71, 36864
    s_nop 0
    buffer_load_dwordx4 v165, s[24:27], s64 offen lds
    ds_read_b64_tr_b16 a[32:33], v167 offset:0
    ds_read_b64_tr_b16 a[34:35], v167 offset:2048
    ds_read_b64_tr_b16 a[36:37], v167 offset:8
    ds_read_b64_tr_b16 a[38:39], v167 offset:2056
    ds_read_b64_tr_b16 a[40:41], v167 offset:8192
    ds_read_b64_tr_b16 a[42:43], v167 offset:10240
    ds_read_b64_tr_b16 a[44:45], v167 offset:8200
    ds_read_b64_tr_b16 a[46:47], v167 offset:10248
    ds_read_b64_tr_b16 v[220:221], v169 offset:16384
    ds_read_b64_tr_b16 v[222:223], v169 offset:17408
    s_waitcnt lgkmcnt(0)
    ds_write_b128 v242, v[220:223] offset:2048
    s_waitcnt vmcnt(10)
    s_waitcnt lgkmcnt(0)
    s_barrier
    s_mov_b32 s64, 245760
    s_add_u32 m0, s70, 40960
    s_nop 0
    buffer_load_dwordx4 v164, s[24:27], s64 offen lds
    s_mov_b32 s64, 250880
    s_add_u32 m0, s70, 41984
    s_nop 0
    buffer_load_dwordx4 v164, s[24:27], s64 offen lds
    s_mov_b32 s64, 246272
    s_add_u32 m0, s70, 49152
    s_nop 0
    buffer_load_dwordx4 v164, s[24:27], s64 offen lds
    s_mov_b32 s64, 251392
    s_add_u32 m0, s70, 50176
    s_nop 0
    buffer_load_dwordx4 v164, s[24:27], s64 offen lds
    s_mov_b32 s64, 245760
    s_add_u32 m0, s71, 57344
    s_nop 0
    buffer_load_dwordx4 v165, s[24:27], s64 offen lds
    ds_read_b64_tr_b16 a[48:49], v167 offset:20480
    ds_read_b64_tr_b16 a[50:51], v167 offset:22528
    ds_read_b64_tr_b16 a[52:53], v167 offset:20488
    ds_read_b64_tr_b16 a[54:55], v167 offset:22536
    ds_read_b64_tr_b16 a[56:57], v167 offset:28672
    ds_read_b64_tr_b16 a[58:59], v167 offset:30720
    ds_read_b64_tr_b16 a[60:61], v167 offset:28680
    ds_read_b64_tr_b16 a[62:63], v167 offset:30728
    ds_read_b64_tr_b16 v[224:225], v169 offset:36864
    ds_read_b64_tr_b16 v[226:227], v169 offset:37888
    s_waitcnt lgkmcnt(0)
    ds_write_b128 v242, v[224:227] offset:3072
    s_waitcnt vmcnt(10)
    s_waitcnt lgkmcnt(0)
    s_barrier
    s_mov_b32 s64, 286720
    s_add_u32 m0, s70, 61440
    s_nop 0
    buffer_load_dwordx4 v164, s[24:27], s64 offen lds
    s_mov_b32 s64, 291840
    s_add_u32 m0, s70, 62464
    s_nop 0
    buffer_load_dwordx4 v164, s[24:27], s64 offen lds
    s_mov_b32 s64, 287232
    s_add_u32 m0, s70, 69632
    s_nop 0
    buffer_load_dwordx4 v164, s[24:27], s64 offen lds
    s_mov_b32 s64, 292352
    s_add_u32 m0, s70, 70656
    s_nop 0
    buffer_load_dwordx4 v164, s[24:27], s64 offen lds
    s_mov_b32 s64, 286720
    s_add_u32 m0, s71, 77824
    s_nop 0
    buffer_load_dwordx4 v165, s[24:27], s64 offen lds
    ds_read_b64_tr_b16 a[64:65], v166 offset:0
    ds_read_b64_tr_b16 a[66:67], v166 offset:2048
    ds_read_b64_tr_b16 a[68:69], v166 offset:8
    ds_read_b64_tr_b16 a[70:71], v166 offset:2056
    ds_read_b64_tr_b16 a[72:73], v166 offset:8192
    ds_read_b64_tr_b16 a[74:75], v166 offset:10240
    ds_read_b64_tr_b16 a[76:77], v166 offset:8200
    ds_read_b64_tr_b16 a[78:79], v166 offset:10248
    ds_read_b64_tr_b16 v[220:221], v168 offset:16384
    ds_read_b64_tr_b16 v[222:223], v168 offset:17408
    s_waitcnt lgkmcnt(0)
    ds_write_b128 v242, v[220:223] offset:4096
    s_waitcnt vmcnt(10)
    s_waitcnt lgkmcnt(0)
    s_barrier
    s_mov_b32 s64, 327680
    s_add_u32 m0, s70, 0
    s_nop 0
    buffer_load_dwordx4 v164, s[24:27], s64 offen lds
    s_mov_b32 s64, 332800
    s_add_u32 m0, s70, 1024
    s_nop 0
    buffer_load_dwordx4 v164, s[24:27], s64 offen lds
    s_mov_b32 s64, 328192
    s_add_u32 m0, s70, 8192
    s_nop 0
    buffer_load_dwordx4 v164, s[24:27], s64 offen lds
    s_mov_b32 s64, 333312
    s_add_u32 m0, s70, 9216
    s_nop 0
    buffer_load_dwordx4 v164, s[24:27], s64 offen lds
    s_mov_b32 s64, 327680
    s_add_u32 m0, s71, 16384
    s_nop 0
    buffer_load_dwordx4 v165, s[24:27], s64 offen lds
    ds_read_b64_tr_b16 a[80:81], v166 offset:20480
    ds_read_b64_tr_b16 a[82:83], v166 offset:22528
    ds_read_b64_tr_b16 a[84:85], v166 offset:20488
    ds_read_b64_tr_b16 a[86:87], v166 offset:22536
    ds_read_b64_tr_b16 a[88:89], v166 offset:28672
    ds_read_b64_tr_b16 a[90:91], v166 offset:30720
    ds_read_b64_tr_b16 a[92:93], v166 offset:28680
    ds_read_b64_tr_b16 a[94:95], v166 offset:30728
    ds_read_b64_tr_b16 v[224:225], v168 offset:36864
    ds_read_b64_tr_b16 v[226:227], v168 offset:37888
    s_waitcnt lgkmcnt(0)
    ds_write_b128 v242, v[224:227] offset:5120
    s_waitcnt vmcnt(10)
    s_waitcnt lgkmcnt(0)
    s_barrier
    s_mov_b32 s64, 368640
    s_add_u32 m0, s70, 20480
    s_nop 0
    buffer_load_dwordx4 v164, s[24:27], s64 offen lds
    s_mov_b32 s64, 373760
    s_add_u32 m0, s70, 21504
    s_nop 0
    buffer_load_dwordx4 v164, s[24:27], s64 offen lds
    s_mov_b32 s64, 369152
    s_add_u32 m0, s70, 28672
    s_nop 0
    buffer_load_dwordx4 v164, s[24:27], s64 offen lds
    s_mov_b32 s64, 374272
    s_add_u32 m0, s70, 29696
    s_nop 0
    buffer_load_dwordx4 v164, s[24:27], s64 offen lds
    s_mov_b32 s64, 368640
    s_add_u32 m0, s71, 36864
    s_nop 0
    buffer_load_dwordx4 v165, s[24:27], s64 offen lds
    ds_read_b64_tr_b16 a[96:97], v167 offset:0
    ds_read_b64_tr_b16 a[98:99], v167 offset:2048
    ds_read_b64_tr_b16 a[100:101], v167 offset:8
    ds_read_b64_tr_b16 a[102:103], v167 offset:2056
    ds_read_b64_tr_b16 a[104:105], v167 offset:8192
    ds_read_b64_tr_b16 a[106:107], v167 offset:10240
    ds_read_b64_tr_b16 a[108:109], v167 offset:8200
    ds_read_b64_tr_b16 a[110:111], v167 offset:10248
    ds_read_b64_tr_b16 v[220:221], v169 offset:16384
    ds_read_b64_tr_b16 v[222:223], v169 offset:17408
    s_waitcnt lgkmcnt(0)
    ds_write_b128 v242, v[220:223] offset:6144
    s_waitcnt vmcnt(10)
    s_waitcnt lgkmcnt(0)
    s_barrier
    s_mov_b32 s64, 409600
    s_add_u32 m0, s70, 40960
    s_nop 0
    buffer_load_dwordx4 v164, s[24:27], s64 offen lds
    s_mov_b32 s64, 414720
    s_add_u32 m0, s70, 41984
    s_nop 0
    buffer_load_dwordx4 v164, s[24:27], s64 offen lds
    s_mov_b32 s64, 410112
    s_add_u32 m0, s70, 49152
    s_nop 0
    buffer_load_dwordx4 v164, s[24:27], s64 offen lds
    s_mov_b32 s64, 415232
    s_add_u32 m0, s70, 50176
    s_nop 0
    buffer_load_dwordx4 v164, s[24:27], s64 offen lds
    s_mov_b32 s64, 409600
    s_add_u32 m0, s71, 57344
    s_nop 0
    buffer_load_dwordx4 v165, s[24:27], s64 offen lds
    ds_read_b64_tr_b16 a[112:113], v167 offset:20480
    ds_read_b64_tr_b16 a[114:115], v167 offset:22528
    ds_read_b64_tr_b16 a[116:117], v167 offset:20488
    ds_read_b64_tr_b16 a[118:119], v167 offset:22536
    ds_read_b64_tr_b16 a[120:121], v167 offset:28672
    ds_read_b64_tr_b16 a[122:123], v167 offset:30720
    ds_read_b64_tr_b16 a[124:125], v167 offset:28680
    ds_read_b64_tr_b16 a[126:127], v167 offset:30728
    ds_read_b64_tr_b16 v[224:225], v169 offset:36864
    ds_read_b64_tr_b16 v[226:227], v169 offset:37888
    s_waitcnt lgkmcnt(0)
    ds_write_b128 v242, v[224:227] offset:7168
    s_waitcnt vmcnt(10)
    s_waitcnt lgkmcnt(0)
    s_barrier
    s_mov_b32 s64, 450560
    s_add_u32 m0, s70, 61440
    s_nop 0
    buffer_load_dwordx4 v164, s[24:27], s64 offen lds
    s_mov_b32 s64, 455680
    s_add_u32 m0, s70, 62464
    s_nop 0
    buffer_load_dwordx4 v164, s[24:27], s64 offen lds
    s_mov_b32 s64, 451072
    s_add_u32 m0, s70, 69632
    s_nop 0
    buffer_load_dwordx4 v164, s[24:27], s64 offen lds
    s_mov_b32 s64, 456192
    s_add_u32 m0, s70, 70656
    s_nop 0
    buffer_load_dwordx4 v164, s[24:27], s64 offen lds
    s_mov_b32 s64, 450560
    s_add_u32 m0, s71, 77824
    s_nop 0
    buffer_load_dwordx4 v165, s[24:27], s64 offen lds
    ds_read_b64_tr_b16 a[128:129], v166 offset:0
    ds_read_b64_tr_b16 a[130:131], v166 offset:2048
    ds_read_b64_tr_b16 a[132:133], v166 offset:8
    ds_read_b64_tr_b16 a[134:135], v166 offset:2056
    ds_read_b64_tr_b16 a[136:137], v166 offset:8192
    ds_read_b64_tr_b16 a[138:139], v166 offset:10240
    ds_read_b64_tr_b16 a[140:141], v166 offset:8200
    ds_read_b64_tr_b16 a[142:143], v166 offset:10248
    ds_read_b64_tr_b16 v[220:221], v168 offset:16384
    ds_read_b64_tr_b16 v[222:223], v168 offset:17408
    s_waitcnt lgkmcnt(0)
    ds_write_b128 v242, v[220:223] offset:8192
    s_waitcnt vmcnt(10)
    s_waitcnt lgkmcnt(0)
    s_barrier
    s_mov_b32 s64, 491520
    s_add_u32 m0, s70, 0
    s_nop 0
    buffer_load_dwordx4 v164, s[24:27], s64 offen lds
    s_mov_b32 s64, 496640
    s_add_u32 m0, s70, 1024
    s_nop 0
    buffer_load_dwordx4 v164, s[24:27], s64 offen lds
    s_mov_b32 s64, 492032
    s_add_u32 m0, s70, 8192
    s_nop 0
    buffer_load_dwordx4 v164, s[24:27], s64 offen lds
    s_mov_b32 s64, 497152
    s_add_u32 m0, s70, 9216
    s_nop 0
    buffer_load_dwordx4 v164, s[24:27], s64 offen lds
    s_mov_b32 s64, 491520
    s_add_u32 m0, s71, 16384
    s_nop 0
    buffer_load_dwordx4 v165, s[24:27], s64 offen lds
    ds_read_b64_tr_b16 a[144:145], v166 offset:20480
    ds_read_b64_tr_b16 a[146:147], v166 offset:22528
    ds_read_b64_tr_b16 a[148:149], v166 offset:20488
    ds_read_b64_tr_b16 a[150:151], v166 offset:22536
    ds_read_b64_tr_b16 a[152:153], v166 offset:28672
    ds_read_b64_tr_b16 a[154:155], v166 offset:30720
    ds_read_b64_tr_b16 a[156:157], v166 offset:28680
    ds_read_b64_tr_b16 a[158:159], v166 offset:30728
    ds_read_b64_tr_b16 v[224:225], v168 offset:36864
    ds_read_b64_tr_b16 v[226:227], v168 offset:37888
    s_waitcnt lgkmcnt(0)
    ds_write_b128 v242, v[224:227] offset:9216
    s_waitcnt vmcnt(10)
    s_waitcnt lgkmcnt(0)
    s_barrier
    s_mov_b32 s64, 532480
    s_add_u32 m0, s70, 20480
    s_nop 0
    buffer_load_dwordx4 v164, s[24:27], s64 offen lds
    s_mov_b32 s64, 537600
    s_add_u32 m0, s70, 21504
    s_nop 0
    buffer_load_dwordx4 v164, s[24:27], s64 offen lds
    s_mov_b32 s64, 532992
    s_add_u32 m0, s70, 28672
    s_nop 0
    buffer_load_dwordx4 v164, s[24:27], s64 offen lds
    s_mov_b32 s64, 538112
    s_add_u32 m0, s70, 29696
    s_nop 0
    buffer_load_dwordx4 v164, s[24:27], s64 offen lds
    s_mov_b32 s64, 532480
    s_add_u32 m0, s71, 36864
    s_nop 0
    buffer_load_dwordx4 v165, s[24:27], s64 offen lds
    ds_read_b64_tr_b16 a[160:161], v167 offset:0
    ds_read_b64_tr_b16 a[162:163], v167 offset:2048
    ds_read_b64_tr_b16 a[164:165], v167 offset:8
    ds_read_b64_tr_b16 a[166:167], v167 offset:2056
    ds_read_b64_tr_b16 a[168:169], v167 offset:8192
    ds_read_b64_tr_b16 a[170:171], v167 offset:10240
    ds_read_b64_tr_b16 a[172:173], v167 offset:8200
    ds_read_b64_tr_b16 a[174:175], v167 offset:10248
    ds_read_b64_tr_b16 v[220:221], v169 offset:16384
    ds_read_b64_tr_b16 v[222:223], v169 offset:17408
    s_waitcnt lgkmcnt(0)
    ds_write_b128 v242, v[220:223] offset:10240
    s_waitcnt vmcnt(10)
    s_waitcnt lgkmcnt(0)
    s_barrier
    s_mov_b32 s64, 573440
    s_add_u32 m0, s70, 40960
    s_nop 0
    buffer_load_dwordx4 v164, s[24:27], s64 offen lds
    s_mov_b32 s64, 578560
    s_add_u32 m0, s70, 41984
    s_nop 0
    buffer_load_dwordx4 v164, s[24:27], s64 offen lds
    s_mov_b32 s64, 573952
    s_add_u32 m0, s70, 49152
    s_nop 0
    buffer_load_dwordx4 v164, s[24:27], s64 offen lds
    s_mov_b32 s64, 579072
    s_add_u32 m0, s70, 50176
    s_nop 0
    buffer_load_dwordx4 v164, s[24:27], s64 offen lds
    s_mov_b32 s64, 573440
    s_add_u32 m0, s71, 57344
    s_nop 0
    buffer_load_dwordx4 v165, s[24:27], s64 offen lds
    ds_read_b64_tr_b16 a[176:177], v167 offset:20480
    ds_read_b64_tr_b16 a[178:179], v167 offset:22528
    ds_read_b64_tr_b16 a[180:181], v167 offset:20488
    ds_read_b64_tr_b16 a[182:183], v167 offset:22536
    ds_read_b64_tr_b16 a[184:185], v167 offset:28672
    ds_read_b64_tr_b16 a[186:187], v167 offset:30720
    ds_read_b64_tr_b16 a[188:189], v167 offset:28680
    ds_read_b64_tr_b16 a[190:191], v167 offset:30728
    ds_read_b64_tr_b16 v[224:225], v169 offset:36864
    ds_read_b64_tr_b16 v[226:227], v169 offset:37888
    s_waitcnt lgkmcnt(0)
    ds_write_b128 v242, v[224:227] offset:11264
    s_waitcnt vmcnt(10)
    s_waitcnt lgkmcnt(0)
    s_barrier
    s_mov_b32 s64, 614400
    s_add_u32 m0, s70, 61440
    s_nop 0
    buffer_load_dwordx4 v164, s[24:27], s64 offen lds
    s_mov_b32 s64, 619520
    s_add_u32 m0, s70, 62464
    s_nop 0
    buffer_load_dwordx4 v164, s[24:27], s64 offen lds
    s_mov_b32 s64, 614912
    s_add_u32 m0, s70, 69632
    s_nop 0
    buffer_load_dwordx4 v164, s[24:27], s64 offen lds
    s_mov_b32 s64, 620032
    s_add_u32 m0, s70, 70656
    s_nop 0
    buffer_load_dwordx4 v164, s[24:27], s64 offen lds
    s_mov_b32 s64, 614400
    s_add_u32 m0, s71, 77824
    s_nop 0
    buffer_load_dwordx4 v165, s[24:27], s64 offen lds
    ds_read_b64_tr_b16 a[192:193], v166 offset:0
    ds_read_b64_tr_b16 a[194:195], v166 offset:2048
    ds_read_b64_tr_b16 a[196:197], v166 offset:8
    ds_read_b64_tr_b16 a[198:199], v166 offset:2056
    ds_read_b64_tr_b16 a[200:201], v166 offset:8192
    ds_read_b64_tr_b16 a[202:203], v166 offset:10240
    ds_read_b64_tr_b16 a[204:205], v166 offset:8200
    ds_read_b64_tr_b16 a[206:207], v166 offset:10248
    ds_read_b64_tr_b16 v[220:221], v168 offset:16384
    ds_read_b64_tr_b16 v[222:223], v168 offset:17408
    s_waitcnt lgkmcnt(0)
    ds_write_b128 v242, v[220:223] offset:12288
    s_waitcnt vmcnt(10)
    s_waitcnt lgkmcnt(0)
    s_barrier
    s_mov_b32 s64, 655360
    s_add_u32 m0, s70, 0
    s_nop 0
    buffer_load_dwordx4 v164, s[24:27], s64 offen lds
    s_mov_b32 s64, 660480
    s_add_u32 m0, s70, 1024
    s_nop 0
    buffer_load_dwordx4 v164, s[24:27], s64 offen lds
    s_mov_b32 s64, 655872
    s_add_u32 m0, s70, 8192
    s_nop 0
    buffer_load_dwordx4 v164, s[24:27], s64 offen lds
    s_mov_b32 s64, 660992
    s_add_u32 m0, s70, 9216
    s_nop 0
    buffer_load_dwordx4 v164, s[24:27], s64 offen lds
    s_mov_b32 s64, 655360
    s_add_u32 m0, s71, 16384
    s_nop 0
    buffer_load_dwordx4 v165, s[24:27], s64 offen lds
    ds_read_b64_tr_b16 a[208:209], v166 offset:20480
    ds_read_b64_tr_b16 a[210:211], v166 offset:22528
    ds_read_b64_tr_b16 a[212:213], v166 offset:20488
    ds_read_b64_tr_b16 a[214:215], v166 offset:22536
    ds_read_b64_tr_b16 a[216:217], v166 offset:28672
    ds_read_b64_tr_b16 a[218:219], v166 offset:30720
    ds_read_b64_tr_b16 a[220:221], v166 offset:28680
    ds_read_b64_tr_b16 a[222:223], v166 offset:30728
    ds_read_b64_tr_b16 v[224:225], v168 offset:36864
    ds_read_b64_tr_b16 v[226:227], v168 offset:37888
    s_waitcnt lgkmcnt(0)
    ds_write_b128 v242, v[224:227] offset:13312
    s_waitcnt vmcnt(10)
    s_waitcnt lgkmcnt(0)
    s_barrier
    s_mov_b32 s64, 696320
    s_add_u32 m0, s70, 20480
    s_nop 0
    buffer_load_dwordx4 v164, s[24:27], s64 offen lds
    s_mov_b32 s64, 701440
    s_add_u32 m0, s70, 21504
    s_nop 0
    buffer_load_dwordx4 v164, s[24:27], s64 offen lds
    s_mov_b32 s64, 696832
    s_add_u32 m0, s70, 28672
    s_nop 0
    buffer_load_dwordx4 v164, s[24:27], s64 offen lds
    s_mov_b32 s64, 701952
    s_add_u32 m0, s70, 29696
    s_nop 0
    buffer_load_dwordx4 v164, s[24:27], s64 offen lds
    s_mov_b32 s64, 696320
    s_add_u32 m0, s71, 36864
    s_nop 0
    buffer_load_dwordx4 v165, s[24:27], s64 offen lds
    ds_read_b64_tr_b16 a[224:225], v167 offset:0
    ds_read_b64_tr_b16 a[226:227], v167 offset:2048
    ds_read_b64_tr_b16 a[228:229], v167 offset:8
    ds_read_b64_tr_b16 a[230:231], v167 offset:2056
    ds_read_b64_tr_b16 a[232:233], v167 offset:8192
    ds_read_b64_tr_b16 a[234:235], v167 offset:10240
    ds_read_b64_tr_b16 a[236:237], v167 offset:8200
    ds_read_b64_tr_b16 a[238:239], v167 offset:10248
    ds_read_b64_tr_b16 v[220:221], v169 offset:16384
    ds_read_b64_tr_b16 v[222:223], v169 offset:17408
    s_waitcnt lgkmcnt(0)
    ds_write_b128 v242, v[220:223] offset:14336
    s_waitcnt vmcnt(10)
    s_waitcnt lgkmcnt(0)
    s_barrier
    s_mov_b32 s64, 737280
    s_add_u32 m0, s70, 40960
    s_nop 0
    buffer_load_dwordx4 v164, s[24:27], s64 offen lds
    s_mov_b32 s64, 742400
    s_add_u32 m0, s70, 41984
    s_nop 0
    buffer_load_dwordx4 v164, s[24:27], s64 offen lds
    s_mov_b32 s64, 737792
    s_add_u32 m0, s70, 49152
    s_nop 0
    buffer_load_dwordx4 v164, s[24:27], s64 offen lds
    s_mov_b32 s64, 742912
    s_add_u32 m0, s70, 50176
    s_nop 0
    buffer_load_dwordx4 v164, s[24:27], s64 offen lds
    s_mov_b32 s64, 737280
    s_add_u32 m0, s71, 57344
    s_nop 0
    buffer_load_dwordx4 v165, s[24:27], s64 offen lds
    ds_read_b64_tr_b16 a[240:241], v167 offset:20480
    ds_read_b64_tr_b16 a[242:243], v167 offset:22528
    ds_read_b64_tr_b16 a[244:245], v167 offset:20488
    ds_read_b64_tr_b16 a[246:247], v167 offset:22536
    ds_read_b64_tr_b16 a[248:249], v167 offset:28672
    ds_read_b64_tr_b16 a[250:251], v167 offset:30720
    ds_read_b64_tr_b16 a[252:253], v167 offset:28680
    ds_read_b64_tr_b16 a[254:255], v167 offset:30728
    ds_read_b64_tr_b16 v[224:225], v169 offset:36864
    ds_read_b64_tr_b16 v[226:227], v169 offset:37888
    s_waitcnt lgkmcnt(0)
    ds_write_b128 v242, v[224:227] offset:15360
    s_waitcnt vmcnt(10)
    s_waitcnt lgkmcnt(0)
    s_barrier
    s_mov_b32 s64, 778240
    s_add_u32 m0, s70, 61440
    s_nop 0
    buffer_load_dwordx4 v164, s[24:27], s64 offen lds
    s_mov_b32 s64, 783360
    s_add_u32 m0, s70, 62464
    s_nop 0
    buffer_load_dwordx4 v164, s[24:27], s64 offen lds
    s_mov_b32 s64, 778752
    s_add_u32 m0, s70, 69632
    s_nop 0
    buffer_load_dwordx4 v164, s[24:27], s64 offen lds
    s_mov_b32 s64, 783872
    s_add_u32 m0, s70, 70656
    s_nop 0
    buffer_load_dwordx4 v164, s[24:27], s64 offen lds
    s_mov_b32 s64, 778240
    s_add_u32 m0, s71, 77824
    s_nop 0
    buffer_load_dwordx4 v165, s[24:27], s64 offen lds
    ds_read_b64_tr_b16 v[4:5], v166 offset:0
    ds_read_b64_tr_b16 v[6:7], v166 offset:2048
    ds_read_b64_tr_b16 v[8:9], v166 offset:8
    ds_read_b64_tr_b16 v[10:11], v166 offset:2056
    ds_read_b64_tr_b16 v[12:13], v166 offset:8192
    ds_read_b64_tr_b16 v[14:15], v166 offset:10240
    ds_read_b64_tr_b16 v[16:17], v166 offset:8200
    ds_read_b64_tr_b16 v[18:19], v166 offset:10248
    ds_read_b64_tr_b16 v[132:133], v168 offset:16384
    ds_read_b64_tr_b16 v[134:135], v168 offset:17408
    s_waitcnt vmcnt(10)
    s_waitcnt lgkmcnt(0)
    s_barrier
    s_mov_b32 s64, 819200
    s_add_u32 m0, s70, 0
    s_nop 0
    buffer_load_dwordx4 v164, s[24:27], s64 offen lds
    s_mov_b32 s64, 824320
    s_add_u32 m0, s70, 1024
    s_nop 0
    buffer_load_dwordx4 v164, s[24:27], s64 offen lds
    s_mov_b32 s64, 819712
    s_add_u32 m0, s70, 8192
    s_nop 0
    buffer_load_dwordx4 v164, s[24:27], s64 offen lds
    s_mov_b32 s64, 824832
    s_add_u32 m0, s70, 9216
    s_nop 0
    buffer_load_dwordx4 v164, s[24:27], s64 offen lds
    s_mov_b32 s64, 819200
    s_add_u32 m0, s71, 16384
    s_nop 0
    buffer_load_dwordx4 v165, s[24:27], s64 offen lds
    ds_read_b64_tr_b16 v[20:21], v166 offset:20480
    ds_read_b64_tr_b16 v[22:23], v166 offset:22528
    ds_read_b64_tr_b16 v[24:25], v166 offset:20488
    ds_read_b64_tr_b16 v[26:27], v166 offset:22536
    ds_read_b64_tr_b16 v[28:29], v166 offset:28672
    ds_read_b64_tr_b16 v[30:31], v166 offset:30720
    ds_read_b64_tr_b16 v[32:33], v166 offset:28680
    ds_read_b64_tr_b16 v[34:35], v166 offset:30728
    ds_read_b64_tr_b16 v[136:137], v168 offset:36864
    ds_read_b64_tr_b16 v[138:139], v168 offset:37888
    s_waitcnt vmcnt(10)
    s_waitcnt lgkmcnt(0)
    s_barrier
    s_mov_b32 s64, 860160
    s_add_u32 m0, s70, 20480
    s_nop 0
    buffer_load_dwordx4 v164, s[24:27], s64 offen lds
    s_mov_b32 s64, 865280
    s_add_u32 m0, s70, 21504
    s_nop 0
    buffer_load_dwordx4 v164, s[24:27], s64 offen lds
    s_mov_b32 s64, 860672
    s_add_u32 m0, s70, 28672
    s_nop 0
    buffer_load_dwordx4 v164, s[24:27], s64 offen lds
    s_mov_b32 s64, 865792
    s_add_u32 m0, s70, 29696
    s_nop 0
    buffer_load_dwordx4 v164, s[24:27], s64 offen lds
    s_mov_b32 s64, 860160
    s_add_u32 m0, s71, 36864
    s_nop 0
    buffer_load_dwordx4 v165, s[24:27], s64 offen lds
    ds_read_b64_tr_b16 v[36:37], v167 offset:0
    ds_read_b64_tr_b16 v[38:39], v167 offset:2048
    ds_read_b64_tr_b16 v[40:41], v167 offset:8
    ds_read_b64_tr_b16 v[42:43], v167 offset:2056
    ds_read_b64_tr_b16 v[44:45], v167 offset:8192
    ds_read_b64_tr_b16 v[46:47], v167 offset:10240
    ds_read_b64_tr_b16 v[48:49], v167 offset:8200
    ds_read_b64_tr_b16 v[50:51], v167 offset:10248
    ds_read_b64_tr_b16 v[140:141], v169 offset:16384
    ds_read_b64_tr_b16 v[142:143], v169 offset:17408
    s_waitcnt vmcnt(10)
    s_waitcnt lgkmcnt(0)
    s_barrier
    s_mov_b32 s64, 901120
    s_add_u32 m0, s70, 40960
    s_nop 0
    buffer_load_dwordx4 v164, s[24:27], s64 offen lds
    s_mov_b32 s64, 906240
    s_add_u32 m0, s70, 41984
    s_nop 0
    buffer_load_dwordx4 v164, s[24:27], s64 offen lds
    s_mov_b32 s64, 901632
    s_add_u32 m0, s70, 49152
    s_nop 0
    buffer_load_dwordx4 v164, s[24:27], s64 offen lds
    s_mov_b32 s64, 906752
    s_add_u32 m0, s70, 50176
    s_nop 0
    buffer_load_dwordx4 v164, s[24:27], s64 offen lds
    s_mov_b32 s64, 901120
    s_add_u32 m0, s71, 57344
    s_nop 0
    buffer_load_dwordx4 v165, s[24:27], s64 offen lds
    ds_read_b64_tr_b16 v[52:53], v167 offset:20480
    ds_read_b64_tr_b16 v[54:55], v167 offset:22528
    ds_read_b64_tr_b16 v[56:57], v167 offset:20488
    ds_read_b64_tr_b16 v[58:59], v167 offset:22536
    ds_read_b64_tr_b16 v[60:61], v167 offset:28672
    ds_read_b64_tr_b16 v[62:63], v167 offset:30720
    ds_read_b64_tr_b16 v[64:65], v167 offset:28680
    ds_read_b64_tr_b16 v[66:67], v167 offset:30728
    ds_read_b64_tr_b16 v[144:145], v169 offset:36864
    ds_read_b64_tr_b16 v[146:147], v169 offset:37888
    s_waitcnt vmcnt(10)
    s_waitcnt lgkmcnt(0)
    s_barrier
    s_mov_b32 s64, 942080
    s_add_u32 m0, s70, 61440
    s_nop 0
    buffer_load_dwordx4 v164, s[24:27], s64 offen lds
    s_mov_b32 s64, 947200
    s_add_u32 m0, s70, 62464
    s_nop 0
    buffer_load_dwordx4 v164, s[24:27], s64 offen lds
    s_mov_b32 s64, 942592
    s_add_u32 m0, s70, 69632
    s_nop 0
    buffer_load_dwordx4 v164, s[24:27], s64 offen lds
    s_mov_b32 s64, 947712
    s_add_u32 m0, s70, 70656
    s_nop 0
    buffer_load_dwordx4 v164, s[24:27], s64 offen lds
    s_mov_b32 s64, 942080
    s_add_u32 m0, s71, 77824
    s_nop 0
    buffer_load_dwordx4 v165, s[24:27], s64 offen lds
    ds_read_b64_tr_b16 v[68:69], v166 offset:0
    ds_read_b64_tr_b16 v[70:71], v166 offset:2048
    ds_read_b64_tr_b16 v[72:73], v166 offset:8
    ds_read_b64_tr_b16 v[74:75], v166 offset:2056
    ds_read_b64_tr_b16 v[76:77], v166 offset:8192
    ds_read_b64_tr_b16 v[78:79], v166 offset:10240
    ds_read_b64_tr_b16 v[80:81], v166 offset:8200
    ds_read_b64_tr_b16 v[82:83], v166 offset:10248
    ds_read_b64_tr_b16 v[148:149], v168 offset:16384
    ds_read_b64_tr_b16 v[150:151], v168 offset:17408
    s_waitcnt vmcnt(10)
    s_waitcnt lgkmcnt(0)
    s_barrier
    ds_read_b64_tr_b16 v[84:85], v166 offset:20480
    ds_read_b64_tr_b16 v[86:87], v166 offset:22528
    ds_read_b64_tr_b16 v[88:89], v166 offset:20488
    ds_read_b64_tr_b16 v[90:91], v166 offset:22536
    ds_read_b64_tr_b16 v[92:93], v166 offset:28672
    ds_read_b64_tr_b16 v[94:95], v166 offset:30720
    ds_read_b64_tr_b16 v[96:97], v166 offset:28680
    ds_read_b64_tr_b16 v[98:99], v166 offset:30728
    ds_read_b64_tr_b16 v[152:153], v168 offset:36864
    ds_read_b64_tr_b16 v[154:155], v168 offset:37888
    s_waitcnt vmcnt(5)
    s_waitcnt lgkmcnt(0)
    s_barrier
    ds_read_b64_tr_b16 v[100:101], v167 offset:0
    ds_read_b64_tr_b16 v[102:103], v167 offset:2048
    ds_read_b64_tr_b16 v[104:105], v167 offset:8
    ds_read_b64_tr_b16 v[106:107], v167 offset:2056
    ds_read_b64_tr_b16 v[108:109], v167 offset:8192
    ds_read_b64_tr_b16 v[110:111], v167 offset:10240
    ds_read_b64_tr_b16 v[112:113], v167 offset:8200
    ds_read_b64_tr_b16 v[114:115], v167 offset:10248
    ds_read_b64_tr_b16 v[156:157], v169 offset:16384
    ds_read_b64_tr_b16 v[158:159], v169 offset:17408
    s_waitcnt vmcnt(0)
    s_waitcnt lgkmcnt(0)
    s_barrier
    ds_read_b64_tr_b16 v[116:117], v167 offset:20480
    ds_read_b64_tr_b16 v[118:119], v167 offset:22528
    ds_read_b64_tr_b16 v[120:121], v167 offset:20488
    ds_read_b64_tr_b16 v[122:123], v167 offset:22536
    ds_read_b64_tr_b16 v[124:125], v167 offset:28672
    ds_read_b64_tr_b16 v[126:127], v167 offset:30720
    ds_read_b64_tr_b16 v[128:129], v167 offset:28680
    ds_read_b64_tr_b16 v[130:131], v167 offset:30728
    ds_read_b64_tr_b16 v[160:161], v169 offset:36864
    ds_read_b64_tr_b16 v[162:163], v169 offset:37888
    v_and_b32 v164, 15, v1
    v_lshrrev_b32 v165, 4, v1
    v_lshlrev_b32 v244, 5, v164
    v_lshl_add_u32 v244, v165, 3, v244
    v_lshlrev_b32 v243, 1, v244
    s_lshl_b32 s64, s74, 2
    s_add_u32 s64, s64, s60
    s_mul_i32 s64, s64, 5120
    v_add_u32 v243, s64, v243
    s_add_u32 s64, s64, 4096
    v_add_u32 v244, s64, v244
    v_min_u32 v245, 47, v1
    s_and_b32 s64, s75, 1
    s_mul_i32 s64, s64, 48
    s_lshl_b32 s65, s58, 7
    s_add_u32 s64, s64, s65
    v_add_u32 v245, s64, v245
    v_lshlrev_b32 v245, 7, v245
    v_add_u32 v245, 8519680, v245
    s_lshl_b32 s64, s68, 9
    s_add_u32 s64, s64, s75
    s_mul_i32 s70, s64, 49152
    s_add_u32 s70, s70, 41943040
    s_mul_i32 s71, s64, 40960
    s_add_u32 s71, s71, 92274688
    s_lshl_b32 s72, s60, 10
    s_mov_b32 s73, 0
    s_cmp_eq_u32 s60, 0
    s_cselect_b64 exec, 1, 0
    v_mov_b32 v2, 1
    s_cbranch_execz Lld_44
    buffer_atomic_add v2, off, s[8:11], 0 offset:28
Lld_44:
    s_mov_b64 exec, -1
    v_mov_b32 v3, 20
    buffer_load_dword v2, v3, s[8:11], 0 offen sc1
Lgchk_45:
    s_waitcnt vmcnt(0)
    v_cmp_gt_u32 vcc, 256, v2
    s_cbranch_vccnz Lgrty_46
    s_waitcnt lgkmcnt(0)
    s_barrier
L_Tseg:
    s_cmp_lg_u32 s73, 0
    s_cbranch_scc1 L_Thave
    s_add_u32 s65, s62, 1
    buffer_load_dword v246, v245, s[4:7], 0 offen sc1
    s_waitcnt vmcnt(0)
    v_mov_b32 v228, s62
    s_mov_b64 exec, 1
    buffer_store_dword v228, off, s[4:7], s63 sc1
    buffer_store_dword v228, off, s[4:7], s3
    s_mov_b64 exec, -1
Lfchk_47:
    v_cmp_gt_u32 vcc, s65, v246
    s_cbranch_vccnz Lfrty_48
    s_add_u32 m0, s72, 0
    s_add_u32 s64, s70, 0
    buffer_load_dwordx4 v240, s[4:7], s64 offen sc1 lds
    s_add_u32 m0, s72, 24576
    s_add_u32 s64, s70, 24576
    buffer_load_dwordx4 v240, s[4:7], s64 offen sc1 lds
    s_add_u32 m0, s72, 4096
    s_add_u32 s64, s70, 4096
    buffer_load_dwordx4 v240, s[4:7], s64 offen sc1 lds
    s_add_u32 m0, s72, 28672
    s_add_u32 s64, s70, 28672
    buffer_load_dwordx4 v240, s[4:7], s64 offen sc1 lds
    s_add_u32 m0, s72, 8192
    s_add_u32 s64, s70, 8192
    buffer_load_dwordx4 v240, s[4:7], s64 offen sc1 lds
    s_add_u32 m0, s72, 32768
    s_add_u32 s64, s70, 32768
    buffer_load_dwordx4 v240, s[4:7], s64 offen sc1 lds
    s_add_u32 m0, s72, 12288
    s_add_u32 s64, s70, 12288
    buffer_load_dwordx4 v240, s[4:7], s64 offen sc1 lds
    s_add_u32 m0, s72, 36864
    s_add_u32 s64, s70, 36864
    buffer_load_dwordx4 v240, s[4:7], s64 offen sc1 lds
    s_add_u32 m0, s72, 16384
    s_add_u32 s64, s70, 16384
    buffer_load_dwordx4 v240, s[4:7], s64 offen sc1 lds
    s_add_u32 m0, s72, 40960
    s_add_u32 s64, s70, 40960
    buffer_load_dwordx4 v240, s[4:7], s64 offen sc1 lds
    s_add_u32 m0, s72, 20480
    s_add_u32 s64, s70, 20480
    buffer_load_dwordx4 v240, s[4:7], s64 offen sc1 lds
    s_add_u32 m0, s72, 45056
    s_add_u32 s64, s70, 45056
    buffer_load_dwordx4 v240, s[4:7], s64 offen sc1 lds
    s_add_u32 s70, s70, 393216
    s_add_u32 s66, s62, 1
    s_and_b32 s66, s66, 7
    s_cselect_b32 s66, 0, 3145728
    s_sub_u32 s70, s70, s66
    s_xor_b32 s72, s72, 49152
    s_waitcnt vmcnt(10)
L_Thave:
    s_waitcnt vmcnt(16)
    s_barrier
    ds_read_b128 v[204:207], v241 offset:0
    ds_read_b128 v[208:211], v241 offset:24576
    ds_read_b128 v[220:223], v242 offset:0
    s_waitcnt lgkmcnt(2)
    v_mfma_f32_16x16x32_bf16 v[164:167], a[0:3], v[204:207], 0
    ds_read_b128 v[212:215], v241 offset:1024
    v_mfma_f32_16x16x32_bf16 v[168:171], a[4:7], v[204:207], 0
    ds_read_b128 v[216:219], v241 offset:25600
    v_mfma_f32_16x16x32_bf16 v[172:175], a[8:11], v[204:207], 0
    ds_read_b128 v[224:227], v242 offset:1024
    v_mfma_f32_16x16x32_bf16 v[176:179], a[12:15], v[204:207], 0
    s_waitcnt lgkmcnt(3)
    v_mfma_f32_16x16x32_bf16 v[180:183], v[220:223], v[204:207], 0
    v_mfma_f32_16x16x32_bf16 v[184:187], a[0:3], v[208:211], 0
    v_mfma_f32_16x16x32_bf16 v[188:191], a[4:7], v[208:211], 0
    v_mfma_f32_16x16x32_bf16 v[192:195], a[8:11], v[208:211], 0
    v_mfma_f32_16x16x32_bf16 v[196:199], a[12:15], v[208:211], 0
    v_mfma_f32_16x16x32_bf16 v[200:203], v[220:223], v[208:211], 0
    s_waitcnt lgkmcnt(2)
    v_mfma_f32_16x16x32_bf16 v[164:167], a[16:19], v[212:215], v[164:167]
    ds_read_b128 v[204:207], v241 offset:2048
    v_mfma_f32_16x16x32_bf16 v[168:171], a[20:23], v[212:215], v[168:171]
    ds_read_b128 v[208:211], v241 offset:26624
    v_mfma_f32_16x16x32_bf16 v[172:175], a[24:27], v[212:215], v[172:175]
    ds_read_b128 v[220:223], v242 offset:2048
    v_mfma_f32_16x16x32_bf16 v[176:179], a[28:31], v[212:215], v[176:179]
    s_waitcnt lgkmcnt(3)
    v_mfma_f32_16x16x32_bf16 v[180:183], v[224:227], v[212:215], v[180:183]
    v_mfma_f32_16x16x32_bf16 v[184:187], a[16:19], v[216:219], v[184:187]
    v_mfma_f32_16x16x32_bf16 v[188:191], a[20:23], v[216:219], v[188:191]
    v_mfma_f32_16x16x32_bf16 v[192:195], a[24:27], v[216:219], v[192:195]
    v_mfma_f32_16x16x32_bf16 v[196:199], a[28:31], v[216:219], v[196:199]
    v_mfma_f32_16x16x32_bf16 v[200:203], v[224:227], v[216:219], v[200:203]
    s_waitcnt lgkmcnt(2)
    v_mfma_f32_16x16x32_bf16 v[164:167], a[32:35], v[204:207], v[164:167]
    ds_read_b128 v[212:215], v241 offset:3072
    v_mfma_f32_16x16x32_bf16 v[168:171], a[36:39], v[204:207], v[168:171]
    ds_read_b128 v[216:219], v241 offset:27648
    v_mfma_f32_16x16x32_bf16 v[172:175], a[40:43], v[204:207], v[172:175]
    ds_read_b128 v[224:227], v242 offset:3072
    v_mfma_f32_16x16x32_bf16 v[176:179], a[44:47], v[204:207], v[176:179]
    s_waitcnt lgkmcnt(3)
    v_mfma_f32_16x16x32_bf16 v[180:183], v[220:223], v[204:207], v[180:183]
    v_mfma_f32_16x16x32_bf16 v[184:187], a[32:35], v[208:211], v[184:187]
    v_mfma_f32_16x16x32_bf16 v[188:191], a[36:39], v[208:211], v[188:191]
    v_mfma_f32_16x16x32_bf16 v[192:195], a[40:43], v[208:211], v[192:195]
    v_mfma_f32_16x16x32_bf16 v[196:199], a[44:47], v[208:211], v[196:199]
    v_mfma_f32_16x16x32_bf16 v[200:203], v[220:223], v[208:211], v[200:203]
    s_waitcnt vmcnt(6)
    s_cmp_lg_u32 s73, 0
    s_cbranch_scc1 L_Tall
    s_waitcnt vmcnt(0)
L_Tall:
    s_barrier
    s_waitcnt lgkmcnt(2)
    v_mfma_f32_16x16x32_bf16 v[164:167], a[48:51], v[212:215], v[164:167]
    ds_read_b128 v[204:207], v241 offset:4096
    v_mfma_f32_16x16x32_bf16 v[168:171], a[52:55], v[212:215], v[168:171]
    ds_read_b128 v[208:211], v241 offset:28672
    v_mfma_f32_16x16x32_bf16 v[172:175], a[56:59], v[212:215], v[172:175]
    ds_read_b128 v[220:223], v242 offset:4096
    v_mfma_f32_16x16x32_bf16 v[176:179], a[60:63], v[212:215], v[176:179]
    s_waitcnt lgkmcnt(3)
    v_mfma_f32_16x16x32_bf16 v[180:183], v[224:227], v[212:215], v[180:183]
    v_mfma_f32_16x16x32_bf16 v[184:187], a[48:51], v[216:219], v[184:187]
    v_mfma_f32_16x16x32_bf16 v[188:191], a[52:55], v[216:219], v[188:191]
    v_mfma_f32_16x16x32_bf16 v[192:195], a[56:59], v[216:219], v[192:195]
    v_mfma_f32_16x16x32_bf16 v[196:199], a[60:63], v[216:219], v[196:199]
    v_mfma_f32_16x16x32_bf16 v[200:203], v[224:227], v[216:219], v[200:203]
    s_waitcnt lgkmcnt(2)
    v_mfma_f32_16x16x32_bf16 v[164:167], a[64:67], v[204:207], v[164:167]
    ds_read_b128 v[212:215], v241 offset:5120
    v_mfma_f32_16x16x32_bf16 v[168:171], a[68:71], v[204:207], v[168:171]
    ds_read_b128 v[216:219], v241 offset:29696
    v_mfma_f32_16x16x32_bf16 v[172:175], a[72:75], v[204:207], v[172:175]
    ds_read_b128 v[224:227], v242 offset:5120
    v_mfma_f32_16x16x32_bf16 v[176:179], a[76:79], v[204:207], v[176:179]
    s_waitcnt lgkmcnt(3)
    v_mfma_f32_16x16x32_bf16 v[180:183], v[220:223], v[204:207], v[180:183]
    v_mfma_f32_16x16x32_bf16 v[184:187], a[64:67], v[208:211], v[184:187]
    v_mfma_f32_16x16x32_bf16 v[188:191], a[68:71], v[208:211], v[188:191]
    v_mfma_f32_16x16x32_bf16 v[192:195], a[72:75], v[208:211], v[192:195]
    v_mfma_f32_16x16x32_bf16 v[196:199], a[76:79], v[208:211], v[196:199]
    v_mfma_f32_16x16x32_bf16 v[200:203], v[220:223], v[208:211], v[200:203]
    s_waitcnt lgkmcnt(2)
    v_mfma_f32_16x16x32_bf16 v[164:167], a[80:83], v[212:215], v[164:167]
    ds_read_b128 v[204:207], v241 offset:6144
    v_mfma_f32_16x16x32_bf16 v[168:171], a[84:87], v[212:215], v[168:171]
    ds_read_b128 v[208:211], v241 offset:30720
    v_mfma_f32_16x16x32_bf16 v[172:175], a[88:91], v[212:215], v[172:175]
    ds_read_b128 v[220:223], v242 offset:6144
    v_mfma_f32_16x16x32_bf16 v[176:179], a[92:95], v[212:215], v[176:179]
    s_waitcnt lgkmcnt(3)
    v_mfma_f32_16x16x32_bf16 v[180:183], v[224:227], v[212:215], v[180:183]
    v_mfma_f32_16x16x32_bf16 v[184:187], a[80:83], v[216:219], v[184:187]
    v_mfma_f32_16x16x32_bf16 v[188:191], a[84:87], v[216:219], v[188:191]
    v_mfma_f32_16x16x32_bf16 v[192:195], a[88:91], v[216:219], v[192:195]
    v_mfma_f32_16x16x32_bf16 v[196:199], a[92:95], v[216:219], v[196:199]
    v_mfma_f32_16x16x32_bf16 v[200:203], v[224:227], v[216:219], v[200:203]
    s_waitcnt lgkmcnt(2)
    v_mfma_f32_16x16x32_bf16 v[164:167], a[96:99], v[204:207], v[164:167]
    ds_read_b128 v[212:215], v241 offset:7168
    v_mfma_f32_16x16x32_bf16 v[168:171], a[100:103], v[204:207], v[168:171]
    ds_read_b128 v[216:219], v241 offset:31744
    v_mfma_f32_16x16x32_bf16 v[172:175], a[104:107], v[204:207], v[172:175]
    ds_read_b128 v[224:227], v242 offset:7168
    v_mfma_f32_16x16x32_bf16 v[176:179], a[108:111], v[204:207], v[176:179]
    s_waitcnt lgkmcnt(3)
    v_mfma_f32_16x16x32_bf16 v[180:183], v[220:223], v[204:207], v[180:183]
    v_mfma_f32_16x16x32_bf16 v[184:187], a[96:99], v[208:211], v[184:187]
    v_mfma_f32_16x16x32_bf16 v[188:191], a[100:103], v[208:211], v[188:191]
    v_mfma_f32_16x16x32_bf16 v[192:195], a[104:107], v[208:211], v[192:195]
    v_mfma_f32_16x16x32_bf16 v[196:199], a[108:111], v[208:211], v[196:199]
    v_mfma_f32_16x16x32_bf16 v[200:203], v[220:223], v[208:211], v[200:203]
    s_cmp_eq_u32 s73, 0
    s_cbranch_scc1 L_Tnofl
    s_waitcnt vmcnt(0)
    v_mov_b32 v228, s62
    s_mov_b64 exec, 1
    buffer_store_dword v228, off, s[4:7], s63 sc1
    buffer_store_dword v228, off, s[4:7], s3
    s_mov_b64 exec, -1
L_Tnofl:
    s_waitcnt lgkmcnt(2)
    v_mfma_f32_16x16x32_bf16 v[164:167], a[112:115], v[212:215], v[164:167]
    ds_read_b128 v[204:207], v241 offset:8192
    v_mfma_f32_16x16x32_bf16 v[168:171], a[116:119], v[212:215], v[168:171]
    ds_read_b128 v[208:211], v241 offset:32768
    v_mfma_f32_16x16x32_bf16 v[172:175], a[120:123], v[212:215], v[172:175]
    ds_read_b128 v[220:223], v242 offset:8192
    v_mfma_f32_16x16x32_bf16 v[176:179], a[124:127], v[212:215], v[176:179]
    s_waitcnt lgkmcnt(3)
    v_mfma_f32_16x16x32_bf16 v[180:183], v[224:227], v[212:215], v[180:183]
    v_mfma_f32_16x16x32_bf16 v[184:187], a[112:115], v[216:219], v[184:187]
    v_mfma_f32_16x16x32_bf16 v[188:191], a[116:119], v[216:219], v[188:191]
    v_mfma_f32_16x16x32_bf16 v[192:195], a[120:123], v[216:219], v[192:195]
    v_mfma_f32_16x16x32_bf16 v[196:199], a[124:127], v[216:219], v[196:199]
    v_mfma_f32_16x16x32_bf16 v[200:203], v[224:227], v[216:219], v[200:203]
    s_waitcnt lgkmcnt(2)
    v_mfma_f32_16x16x32_bf16 v[164:167], a[128:131], v[204:207], v[164:167]
    ds_read_b128 v[212:215], v241 offset:9216
    v_mfma_f32_16x16x32_bf16 v[168:171], a[132:135], v[204:207], v[168:171]
    ds_read_b128 v[216:219], v241 offset:33792
    v_mfma_f32_16x16x32_bf16 v[172:175], a[136:139], v[204:207], v[172:175]
    ds_read_b128 v[224:227], v242 offset:9216
    v_mfma_f32_16x16x32_bf16 v[176:179], a[140:143], v[204:207], v[176:179]
    s_waitcnt lgkmcnt(3)
    v_mfma_f32_16x16x32_bf16 v[180:183], v[220:223], v[204:207], v[180:183]
    v_mfma_f32_16x16x32_bf16 v[184:187], a[128:131], v[208:211], v[184:187]
    v_mfma_f32_16x16x32_bf16 v[188:191], a[132:135], v[208:211], v[188:191]
    v_mfma_f32_16x16x32_bf16 v[192:195], a[136:139], v[208:211], v[192:195]
    v_mfma_f32_16x16x32_bf16 v[196:199], a[140:143], v[208:211], v[196:199]
    v_mfma_f32_16x16x32_bf16 v[200:203], v[220:223], v[208:211], v[200:203]
    s_waitcnt lgkmcnt(2)
    v_mfma_f32_16x16x32_bf16 v[164:167], a[144:147], v[212:215], v[164:167]
    ds_read_b128 v[204:207], v241 offset:10240
    v_mfma_f32_16x16x32_bf16 v[168:171], a[148:151], v[212:215], v[168:171]
    ds_read_b128 v[208:211], v241 offset:34816
    v_mfma_f32_16x16x32_bf16 v[172:175], a[152:155], v[212:215], v[172:175]
    ds_read_b128 v[220:223], v242 offset:10240
    v_mfma_f32_16x16x32_bf16 v[176:179], a[156:159], v[212:215], v[176:179]
    s_waitcnt lgkmcnt(3)
    v_mfma_f32_16x16x32_bf16 v[180:183], v[224:227], v[212:215], v[180:183]
    v_mfma_f32_16x16x32_bf16 v[184:187], a[144:147], v[216:219], v[184:187]
    v_mfma_f32_16x16x32_bf16 v[188:191], a[148:151], v[216:219], v[188:191]
    v_mfma_f32_16x16x32_bf16 v[192:195], a[152:155], v[216:219], v[192:195]
    v_mfma_f32_16x16x32_bf16 v[196:199], a[156:159], v[216:219], v[196:199]
    v_mfma_f32_16x16x32_bf16 v[200:203], v[224:227], v[216:219], v[200:203]
    s_waitcnt lgkmcnt(2)
    v_mfma_f32_16x16x32_bf16 v[164:167], a[160:163], v[204:207], v[164:167]
    ds_read_b128 v[212:215], v241 offset:11264
    v_mfma_f32_16x16x32_bf16 v[168:171], a[164:167], v[204:207], v[168:171]
    ds_read_b128 v[216:219], v241 offset:35840
    v_mfma_f32_16x16x32_bf16 v[172:175], a[168:171], v[204:207], v[172:175]
    ds_read_b128 v[224:227], v242 offset:11264
    v_mfma_f32_16x16x32_bf16 v[176:179], a[172:175], v[204:207], v[176:179]
    s_waitcnt lgkmcnt(3)
    v_mfma_f32_16x16x32_bf16 v[180:183], v[220:223], v[204:207], v[180:183]
    v_mfma_f32_16x16x32_bf16 v[184:187], a[160:163], v[208:211], v[184:187]
    v_mfma_f32_16x16x32_bf16 v[188:191], a[164:167], v[208:211], v[188:191]
    v_mfma_f32_16x16x32_bf16 v[192:195], a[168:171], v[208:211], v[192:195]
    v_mfma_f32_16x16x32_bf16 v[196:199], a[172:175], v[208:211], v[196:199]
    v_mfma_f32_16x16x32_bf16 v[200:203], v[220:223], v[208:211], v[200:203]
    s_waitcnt lgkmcnt(2)
    v_mfma_f32_16x16x32_bf16 v[164:167], a[176:179], v[212:215], v[164:167]
    ds_read_b128 v[204:207], v241 offset:12288
    v_mfma_f32_16x16x32_bf16 v[168:171], a[180:183], v[212:215], v[168:171]
    ds_read_b128 v[208:211], v241 offset:36864
    v_mfma_f32_16x16x32_bf16 v[172:175], a[184:187], v[212:215], v[172:175]
    ds_read_b128 v[220:223], v242 offset:12288
    v_mfma_f32_16x16x32_bf16 v[176:179], a[188:191], v[212:215], v[176:179]
    s_waitcnt lgkmcnt(3)
    v_mfma_f32_16x16x32_bf16 v[180:183], v[224:227], v[212:215], v[180:183]
    v_mfma_f32_16x16x32_bf16 v[184:187], a[176:179], v[216:219], v[184:187]
    v_mfma_f32_16x16x32_bf16 v[188:191], a[180:183], v[216:219], v[188:191]
    v_mfma_f32_16x16x32_bf16 v[192:195], a[184:187], v[216:219], v[192:195]
    v_mfma_f32_16x16x32_bf16 v[196:199], a[188:191], v[216:219], v[196:199]
    v_mfma_f32_16x16x32_bf16 v[200:203], v[224:227], v[216:219], v[200:203]
    s_waitcnt lgkmcnt(2)
    v_mfma_f32_16x16x32_bf16 v[164:167], a[192:195], v[204:207], v[164:167]
    ds_read_b128 v[212:215], v241 offset:13312
    v_mfma_f32_16x16x32_bf16 v[168:171], a[196:199], v[204:207], v[168:171]
    ds_read_b128 v[216:219], v241 offset:37888
    v_mfma_f32_16x16x32_bf16 v[172:175], a[200:203], v[204:207], v[172:175]
    ds_read_b128 v[224:227], v242 offset:13312
    v_mfma_f32_16x16x32_bf16 v[176:179], a[204:207], v[204:207], v[176:179]
    s_waitcnt lgkmcnt(3)
    v_mfma_f32_16x16x32_bf16 v[180:183], v[220:223], v[204:207], v[180:183]
    v_mfma_f32_16x16x32_bf16 v[184:187], a[192:195], v[208:211], v[184:187]
    v_mfma_f32_16x16x32_bf16 v[188:191], a[196:199], v[208:211], v[188:191]
    v_mfma_f32_16x16x32_bf16 v[192:195], a[200:203], v[208:211], v[192:195]
    v_mfma_f32_16x16x32_bf16 v[196:199], a[204:207], v[208:211], v[196:199]
    v_mfma_f32_16x16x32_bf16 v[200:203], v[220:223], v[208:211], v[200:203]
    s_waitcnt lgkmcnt(2)
    v_mfma_f32_16x16x32_bf16 v[164:167], a[208:211], v[212:215], v[164:167]
    ds_read_b128 v[204:207], v241 offset:14336
    v_mfma_f32_16x16x32_bf16 v[168:171], a[212:215], v[212:215], v[168:171]
    ds_read_b128 v[208:211], v241 offset:38912
    v_mfma_f32_16x16x32_bf16 v[172:175], a[216:219], v[212:215], v[172:175]
    ds_read_b128 v[220:223], v242 offset:14336
    v_mfma_f32_16x16x32_bf16 v[176:179], a[220:223], v[212:215], v[176:179]
    s_waitcnt lgkmcnt(3)
    v_mfma_f32_16x16x32_bf16 v[180:183], v[224:227], v[212:215], v[180:183]
    v_mfma_f32_16x16x32_bf16 v[184:187], a[208:211], v[216:219], v[184:187]
    v_mfma_f32_16x16x32_bf16 v[188:191], a[212:215], v[216:219], v[188:191]
    v_mfma_f32_16x16x32_bf16 v[192:195], a[216:219], v[216:219], v[192:195]
    v_mfma_f32_16x16x32_bf16 v[196:199], a[220:223], v[216:219], v[196:199]
    v_mfma_f32_16x16x32_bf16 v[200:203], v[224:227], v[216:219], v[200:203]
    s_waitcnt lgkmcnt(2)
    v_mfma_f32_16x16x32_bf16 v[164:167], a[224:227], v[204:207], v[164:167]
    ds_read_b128 v[212:215], v241 offset:15360
    v_mfma_f32_16x16x32_bf16 v[168:171], a[228:231], v[204:207], v[168:171]
    ds_read_b128 v[216:219], v241 offset:39936
    v_mfma_f32_16x16x32_bf16 v[172:175], a[232:235], v[204:207], v[172:175]
    ds_read_b128 v[224:227], v242 offset:15360
    v_mfma_f32_16x16x32_bf16 v[176:179], a[236:239], v[204:207], v[176:179]
    s_waitcnt lgkmcnt(3)
    v_mfma_f32_16x16x32_bf16 v[180:183], v[220:223], v[204:207], v[180:183]
    v_mfma_f32_16x16x32_bf16 v[184:187], a[224:227], v[208:211], v[184:187]
    v_mfma_f32_16x16x32_bf16 v[188:191], a[228:231], v[208:211], v[188:191]
    v_mfma_f32_16x16x32_bf16 v[192:195], a[232:235], v[208:211], v[192:195]
    v_mfma_f32_16x16x32_bf16 v[196:199], a[236:239], v[208:211], v[196:199]
    v_mfma_f32_16x16x32_bf16 v[200:203], v[220:223], v[208:211], v[200:203]
    buffer_load_dword v246, v245, s[4:7], 0 offen sc1
    s_waitcnt lgkmcnt(2)
    v_mfma_f32_16x16x32_bf16 v[164:167], a[240:243], v[212:215], v[164:167]
    ds_read_b128 v[204:207], v241 offset:16384
    v_mfma_f32_16x16x32_bf16 v[168:171], a[244:247], v[212:215], v[168:171]
    ds_read_b128 v[208:211], v241 offset:40960
    v_mfma_f32_16x16x32_bf16 v[172:175], a[248:251], v[212:215], v[172:175]
    v_mfma_f32_16x16x32_bf16 v[176:179], a[252:255], v[212:215], v[176:179]
    s_waitcnt lgkmcnt(2)
    v_mfma_f32_16x16x32_bf16 v[180:183], v[224:227], v[212:215], v[180:183]
    v_mfma_f32_16x16x32_bf16 v[184:187], a[240:243], v[216:219], v[184:187]
    v_mfma_f32_16x16x32_bf16 v[188:191], a[244:247], v[216:219], v[188:191]
    v_mfma_f32_16x16x32_bf16 v[192:195], a[248:251], v[216:219], v[192:195]
    v_mfma_f32_16x16x32_bf16 v[196:199], a[252:255], v[216:219], v[196:199]
    v_mfma_f32_16x16x32_bf16 v[200:203], v[224:227], v[216:219], v[200:203]
    s_waitcnt lgkmcnt(1)
    v_mfma_f32_16x16x32_bf16 v[164:167], v[4:7], v[204:207], v[164:167]
    ds_read_b128 v[212:215], v241 offset:17408
    v_mfma_f32_16x16x32_bf16 v[168:171], v[8:11], v[204:207], v[168:171]
    ds_read_b128 v[216:219], v241 offset:41984
    v_mfma_f32_16x16x32_bf16 v[172:175], v[12:15], v[204:207], v[172:175]
    v_mfma_f32_16x16x32_bf16 v[176:179], v[16:19], v[204:207], v[176:179]
    v_mfma_f32_16x16x32_bf16 v[180:183], v[132:135], v[204:207], v[180:183]
    s_waitcnt lgkmcnt(2)
    v_mfma_f32_16x16x32_bf16 v[184:187], v[4:7], v[208:211], v[184:187]
    v_mfma_f32_16x16x32_bf16 v[188:191], v[8:11], v[208:211], v[188:191]
    v_mfma_f32_16x16x32_bf16 v[192:195], v[12:15], v[208:211], v[192:195]
    v_mfma_f32_16x16x32_bf16 v[196:199], v[16:19], v[208:211], v[196:199]
    v_mfma_f32_16x16x32_bf16 v[200:203], v[132:135], v[208:211], v[200:203]
    s_waitcnt lgkmcnt(1)
    v_mfma_f32_16x16x32_bf16 v[164:167], v[20:23], v[212:215], v[164:167]
    ds_read_b128 v[204:207], v241 offset:18432
    v_mfma_f32_16x16x32_bf16 v[168:171], v[24:27], v[212:215], v[168:171]
    ds_read_b128 v[208:211], v241 offset:43008
    v_mfma_f32_16x16x32_bf16 v[172:175], v[28:31], v[212:215], v[172:175]
    v_mfma_f32_16x16x32_bf16 v[176:179], v[32:35], v[212:215], v[176:179]
    v_mfma_f32_16x16x32_bf16 v[180:183], v[136:139], v[212:215], v[180:183]
    s_waitcnt lgkmcnt(2)
    v_mfma_f32_16x16x32_bf16 v[184:187], v[20:23], v[216:219], v[184:187]
    v_mfma_f32_16x16x32_bf16 v[188:191], v[24:27], v[216:219], v[188:191]
    v_mfma_f32_16x16x32_bf16 v[192:195], v[28:31], v[216:219], v[192:195]
    v_mfma_f32_16x16x32_bf16 v[196:199], v[32:35], v[216:219], v[196:199]
    v_mfma_f32_16x16x32_bf16 v[200:203], v[136:139], v[216:219], v[200:203]
    s_add_u32 s65, s62, 2
    s_waitcnt vmcnt(0)
    v_cmp_gt_u32 vcc, s65, v246
    s_cmp_eq_u64 vcc, 0
    s_cselect_b32 s73, 1, 0
    s_waitcnt lgkmcnt(1)
    v_mfma_f32_16x16x32_bf16 v[164:167], v[36:39], v[204:207], v[164:167]
    ds_read_b128 v[212:215], v241 offset:19456
    v_mfma_f32_16x16x32_bf16 v[168:171], v[40:43], v[204:207], v[168:171]
    ds_read_b128 v[216:219], v241 offset:44032
    v_mfma_f32_16x16x32_bf16 v[172:175], v[44:47], v[204:207], v[172:175]
    v_mfma_f32_16x16x32_bf16 v[176:179], v[48:51], v[204:207], v[176:179]
    s_cbranch_vccnz Lnp_49
    s_add_u32 m0, s72, 0
    s_add_u32 s64, s70, 0
    buffer_load_dwordx4 v240, s[4:7], s64 offen sc1 lds
Lnp_49:
    v_mfma_f32_16x16x32_bf16 v[180:183], v[140:143], v[204:207], v[180:183]
    s_waitcnt lgkmcnt(2)
    v_mfma_f32_16x16x32_bf16 v[184:187], v[36:39], v[208:211], v[184:187]
    v_mfma_f32_16x16x32_bf16 v[188:191], v[40:43], v[208:211], v[188:191]
    s_cbranch_vccnz Lnp_50
    s_add_u32 m0, s72, 24576
    s_add_u32 s64, s70, 24576
    buffer_load_dwordx4 v240, s[4:7], s64 offen sc1 lds
Lnp_50:
    v_mfma_f32_16x16x32_bf16 v[192:195], v[44:47], v[208:211], v[192:195]
    v_mfma_f32_16x16x32_bf16 v[196:199], v[48:51], v[208:211], v[196:199]
    v_mfma_f32_16x16x32_bf16 v[200:203], v[140:143], v[208:211], v[200:203]
    s_cbranch_vccnz Lnp_51
    s_add_u32 m0, s72, 4096
    s_add_u32 s64, s70, 4096
    buffer_load_dwordx4 v240, s[4:7], s64 offen sc1 lds
Lnp_51:
    s_waitcnt lgkmcnt(1)
    v_mfma_f32_16x16x32_bf16 v[164:167], v[52:55], v[212:215], v[164:167]
    ds_read_b128 v[204:207], v241 offset:20480
    v_mfma_f32_16x16x32_bf16 v[168:171], v[56:59], v[212:215], v[168:171]
    ds_read_b128 v[208:211], v241 offset:45056
    v_mfma_f32_16x16x32_bf16 v[172:175], v[60:63], v[212:215], v[172:175]
    v_mfma_f32_16x16x32_bf16 v[176:179], v[64:67], v[212:215], v[176:179]
    s_cbranch_vccnz Lnp_52
    s_add_u32 m0, s72, 28672
    s_add_u32 s64, s70, 28672
    buffer_load_dwordx4 v240, s[4:7], s64 offen sc1 lds
Lnp_52:
    v_mfma_f32_16x16x32_bf16 v[180:183], v[144:147], v[212:215], v[180:183]
    s_waitcnt lgkmcnt(2)
    v_mfma_f32_16x16x32_bf16 v[184:187], v[52:55], v[216:219], v[184:187]
    v_mfma_f32_16x16x32_bf16 v[188:191], v[56:59], v[216:219], v[188:191]
    s_cbranch_vccnz Lnp_53
    s_add_u32 m0, s72, 8192
    s_add_u32 s64, s70, 8192
    buffer_load_dwordx4 v240, s[4:7], s64 offen sc1 lds
Lnp_53:
    v_mfma_f32_16x16x32_bf16 v[192:195], v[60:63], v[216:219], v[192:195]
    v_mfma_f32_16x16x32_bf16 v[196:199], v[64:67], v[216:219], v[196:199]
    v_mfma_f32_16x16x32_bf16 v[200:203], v[144:147], v[216:219], v[200:203]
    s_waitcnt lgkmcnt(1)
    v_mfma_f32_16x16x32_bf16 v[164:167], v[68:71], v[204:207], v[164:167]
    ds_read_b128 v[212:215], v241 offset:21504
    v_mfma_f32_16x16x32_bf16 v[168:171], v[72:75], v[204:207], v[168:171]
    ds_read_b128 v[216:219], v241 offset:46080
    v_mfma_f32_16x16x32_bf16 v[172:175], v[76:79], v[204:207], v[172:175]
    v_mfma_f32_16x16x32_bf16 v[176:179], v[80:83], v[204:207], v[176:179]
    s_cbranch_vccnz Lnp_54
    s_add_u32 m0, s72, 32768
    s_add_u32 s64, s70, 32768
    buffer_load_dwordx4 v240, s[4:7], s64 offen sc1 lds
Lnp_54:
    v_mfma_f32_16x16x32_bf16 v[180:183], v[148:151], v[204:207], v[180:183]
    s_waitcnt lgkmcnt(2)
    v_mfma_f32_16x16x32_bf16 v[184:187], v[68:71], v[208:211], v[184:187]
    v_mfma_f32_16x16x32_bf16 v[188:191], v[72:75], v[208:211], v[188:191]
    s_cbranch_vccnz Lnp_55
    s_add_u32 m0, s72, 12288
    s_add_u32 s64, s70, 12288
    buffer_load_dwordx4 v240, s[4:7], s64 offen sc1 lds
Lnp_55:
    v_mfma_f32_16x16x32_bf16 v[192:195], v[76:79], v[208:211], v[192:195]
    v_mfma_f32_16x16x32_bf16 v[196:199], v[80:83], v[208:211], v[196:199]
    v_mfma_f32_16x16x32_bf16 v[200:203], v[148:151], v[208:211], v[200:203]
    s_waitcnt lgkmcnt(1)
    v_mfma_f32_16x16x32_bf16 v[164:167], v[84:87], v[212:215], v[164:167]
    ds_read_b128 v[204:207], v241 offset:22528
    v_mfma_f32_16x16x32_bf16 v[168:171], v[88:91], v[212:215], v[168:171]
    ds_read_b128 v[208:211], v241 offset:47104
    v_mfma_f32_16x16x32_bf16 v[172:175], v[92:95], v[212:215], v[172:175]
    v_mfma_f32_16x16x32_bf16 v[176:179], v[96:99], v[212:215], v[176:179]
    s_cbranch_vccnz Lnp_56
    s_add_u32 m0, s72, 36864
    s_add_u32 s64, s70, 36864
    buffer_load_dwordx4 v240, s[4:7], s64 offen sc1 lds
Lnp_56:
    v_mfma_f32_16x16x32_bf16 v[180:183], v[152:155], v[212:215], v[180:183]
    s_waitcnt lgkmcnt(2)
    v_mfma_f32_16x16x32_bf16 v[184:187], v[84:87], v[216:219], v[184:187]
    v_mfma_f32_16x16x32_bf16 v[188:191], v[88:91], v[216:219], v[188:191]
    s_cbranch_vccnz Lnp_57
    s_add_u32 m0, s72, 16384
    s_add_u32 s64, s70, 16384
    buffer_load_dwordx4 v240, s[4:7], s64 offen sc1 lds
Lnp_57:
    v_mfma_f32_16x16x32_bf16 v[192:195], v[92:95], v[216:219], v[192:195]
    v_mfma_f32_16x16x32_bf16 v[196:199], v[96:99], v[216:219], v[196:199]
    v_mfma_f32_16x16x32_bf16 v[200:203], v[152:155], v[216:219], v[200:203]
    s_waitcnt lgkmcnt(1)
    v_mfma_f32_16x16x32_bf16 v[164:167], v[100:103], v[204:207], v[164:167]
    ds_read_b128 v[212:215], v241 offset:23552
    v_mfma_f32_16x16x32_bf16 v[168:171], v[104:107], v[204:207], v[168:171]
    ds_read_b128 v[216:219], v241 offset:48128
    v_mfma_f32_16x16x32_bf16 v[172:175], v[108:111], v[204:207], v[172:175]
    v_mfma_f32_16x16x32_bf16 v[176:179], v[112:115], v[204:207], v[176:179]
    s_cbranch_vccnz Lnp_58
    s_add_u32 m0, s72, 40960
    s_add_u32 s64, s70, 40960
    buffer_load_dwordx4 v240, s[4:7], s64 offen sc1 lds
Lnp_58:
    v_mfma_f32_16x16x32_bf16 v[180:183], v[156:159], v[204:207], v[180:183]
    s_waitcnt lgkmcnt(2)
    v_mfma_f32_16x16x32_bf16 v[184:187], v[100:103], v[208:211], v[184:187]
    v_mfma_f32_16x16x32_bf16 v[188:191], v[104:107], v[208:211], v[188:191]
    s_cbranch_vccnz Lnp_59
    s_add_u32 m0, s72, 20480
    s_add_u32 s64, s70, 20480
    buffer_load_dwordx4 v240, s[4:7], s64 offen sc1 lds
Lnp_59:
    v_mfma_f32_16x16x32_bf16 v[192:195], v[108:111], v[208:211], v[192:195]
    v_mfma_f32_16x16x32_bf16 v[196:199], v[112:115], v[208:211], v[196:199]
    v_mfma_f32_16x16x32_bf16 v[200:203], v[156:159], v[208:211], v[200:203]
    s_waitcnt lgkmcnt(1)
    v_mfma_f32_16x16x32_bf16 v[164:167], v[116:119], v[212:215], v[164:167]
    v_mfma_f32_16x16x32_bf16 v[168:171], v[120:123], v[212:215], v[168:171]
    v_mfma_f32_16x16x32_bf16 v[172:175], v[124:127], v[212:215], v[172:175]
    v_mfma_f32_16x16x32_bf16 v[176:179], v[128:131], v[212:215], v[176:179]
    v_mfma_f32_16x16x32_bf16 v[180:183], v[160:163], v[212:215], v[180:183]
    s_waitcnt lgkmcnt(0)
    v_mfma_f32_16x16x32_bf16 v[184:187], v[116:119], v[216:219], v[184:187]
    s_cbranch_vccnz Lnp_60
    s_add_u32 m0, s72, 45056
    s_add_u32 s64, s70, 45056
    buffer_load_dwordx4 v240, s[4:7], s64 offen sc1 lds
Lnp_60:
    v_mfma_f32_16x16x32_bf16 v[188:191], v[120:123], v[216:219], v[188:191]
    v_mfma_f32_16x16x32_bf16 v[192:195], v[124:127], v[216:219], v[192:195]
    v_mfma_f32_16x16x32_bf16 v[196:199], v[128:131], v[216:219], v[196:199]
    s_cbranch_vccnz Lnp_61
    s_add_u32 s70, s70, 393216
    s_add_u32 s66, s62, 2
    s_and_b32 s66, s66, 7
    s_cselect_b32 s66, 0, 3145728
    s_sub_u32 s70, s70, s66
    s_xor_b32 s72, s72, 49152
Lnp_61:
    v_mfma_f32_16x16x32_bf16 v[200:203], v[160:163], v[216:219], v[200:203]
    v_xor_b32 v241, 49152, v241
    v_cvt_pk_bf16_f32 v164, v164, v165
    v_cvt_pk_bf16_f32 v165, v166, v167
    v_cvt_pk_bf16_f32 v166, v168, v169
    v_cvt_pk_bf16_f32 v167, v170, v171
    buffer_store_dwordx4 v[164:167], v243, s[4:7], s71 offen offset:0 sc1
    v_cvt_pk_bf16_f32 v168, v172, v173
    v_cvt_pk_bf16_f32 v169, v174, v175
    v_cvt_pk_bf16_f32 v170, v176, v177
    v_cvt_pk_bf16_f32 v171, v178, v179
    buffer_store_dwordx4 v[168:171], v243, s[4:7], s71 offen offset:2048 sc1
    v_cvt_pk_bf16_f32 v172, v180, v181
    v_cvt_pk_bf16_f32 v173, v182, v183
    buffer_store_dwordx2 v[172:173], v244, s[4:7], s71 offen offset:0 sc1
    v_cvt_pk_bf16_f32 v184, v184, v185
    v_cvt_pk_bf16_f32 v185, v186, v187
    v_cvt_pk_bf16_f32 v186, v188, v189
    v_cvt_pk_bf16_f32 v187, v190, v191
    buffer_store_dwordx4 v[184:187], v243, s[4:7], s71 offen offset:1024 sc1
    v_cvt_pk_bf16_f32 v188, v192, v193
    v_cvt_pk_bf16_f32 v189, v194, v195
    v_cvt_pk_bf16_f32 v190, v196, v197
    v_cvt_pk_bf16_f32 v191, v198, v199
    buffer_store_dwordx4 v[188:191], v243, s[4:7], s71 offen offset:3072 sc1
    v_cvt_pk_bf16_f32 v192, v200, v201
    v_cvt_pk_bf16_f32 v193, v202, v203
    buffer_store_dwordx2 v[192:193], v244, s[4:7], s71 offen offset:512 sc1
    s_add_u32 s71, s71, 327680
    s_add_u32 s62, s62, 1
    s_cmp_lt_u32 s62, 64
    s_cbranch_scc1 L_Tseg
    s_waitcnt vmcnt(0)
    v_mov_b32 v228, s62
    s_mov_b64 exec, 1
    buffer_store_dword v228, off, s[4:7], s63 sc1
    buffer_store_dword v228, off, s[4:7], s3
    s_mov_b64 exec, -1
    s_endpgm
Lgrty_46:
    s_sleep 4
    buffer_load_dword v2, v3, s[8:11], 0 offen sc1
    s_sub_u32 s61, s61, 1
    s_mov_b32 s67, 1
    s_cbranch_scc1 L_fail
    s_branch Lgchk_45
Lfrty_48:
    s_sleep 4
    buffer_load_dword v246, v245, s[4:7], 0 offen sc1
    s_sub_u32 s61, s61, 1
    s_mov_b32 s67, 20
    s_cbranch_scc1 L_fail
    s_waitcnt vmcnt(0)
    s_branch Lfchk_47
L_roleB:
    s_mov_b32 s20, s48
    s_mov_b32 s21, s49
    s_mov_b32 s22, 2457600
    s_mov_b32 s23, 0x20000
    s_mov_b32 s24, s50
    s_mov_b32 s25, s51
    s_mov_b32 s26, 819200
    s_mov_b32 s27, 0x20000
    v_mov_b32 v2, 0
    s_mov_b64 exec, 1
    buffer_store_dword v2, off, s[4:7], s63 sc1
    buffer_store_dword v2, off, s[4:7], s3
    s_mov_b64 exec, -1
    s_waitcnt vmcnt(0)
    s_barrier
    s_cmp_lg_u32 s60, 0
    s_cbranch_scc1 Larr_62
    s_mov_b64 exec, 1
    v_mov_b32 v2, 1
    v_mov_b32 v3, 20
    buffer_atomic_add v2, v3, s[8:11], 0 offen
    s_mov_b64 exec, -1
Larr_62:
    v_and_b32 v1, 63, v0
    s_lshl_b32 s74, s69, 1
    s_and_b32 s64, s59, 1
    s_add_u32 s74, s74, s64
    v_lshrrev_b32 v176, 4, v1
    v_bfe_u32 v177, v1, 2, 2
    v_and_b32 v178, 3, v1
    v_lshlrev_b32 v245, 4, v1
    v_and_b32 v169, 31, v1
    v_mul_u32_u24 v170, 26, v169
    v_lshrrev_b32 v170, 8, v170
    v_mul_u32_u24 v168, 1120, v170
    v_lshl_add_u32 v168, v169, 4, v168
    v_lshrrev_b32 v170, 5, v0
    v_mul_u32_u24 v170, 3840, v170
    s_mul_i32 s64, s74, 160
    v_add3_u32 v168, v168, v170, s64
    v_mov_b32 v170, 0x80000000
    v_cmp_gt_u32 vcc, 30, v169
    s_nop 1
    v_cndmask_b32 v168, v170, v168, vcc
    v_lshl_add_u32 v169, v176, 3, v177
    v_lshlrev_b32 v169, 9, v169
    s_mul_i32 s64, s60, 40
    v_mul_u32_u24 v171, 160, v178
    s_add_u32 s65, s64, 32
    v_mov_b32 v172, s65
    v_cmp_gt_u32 vcc, 3, v178
    s_nop 1
    v_cndmask_b32 v172, 0, v172, vcc
    v_add3_u32 v171, v171, v172, v169
    v_lshl_add_u32 v169, v178, 3, v169
    v_add_u32 v169, s64, v169
    v_add_u32 v170, 65536, v169
    v_add_u32 v172, 65536, v171
    v_lshl_add_u32 v173, v178, 2, v177
    v_lshl_add_u32 v173, v176, 4, v173
    v_lshlrev_b32 v173, 2, v173
    s_lshl_b32 s70, s60, 10
    s_mov_b32 s64, 0
    s_add_u32 m0, s70, 0
    s_nop 0
    buffer_load_dwordx4 v168, s[20:23], s64 offen lds
    s_mov_b32 s64, 30720
    s_add_u32 m0, s70, 4096
    s_nop 0
    buffer_load_dwordx4 v168, s[20:23], s64 offen lds
    s_mov_b32 s64, 61440
    s_add_u32 m0, s70, 8192
    s_nop 0
    buffer_load_dwordx4 v168, s[20:23], s64 offen lds
    s_mov_b32 s64, 92160
    s_add_u32 m0, s70, 12288
    s_nop 0
    buffer_load_dwordx4 v168, s[20:23], s64 offen lds
    s_mov_b32 s64, 122880
    s_add_u32 m0, s70, 16384
    s_nop 0
    buffer_load_dwordx4 v168, s[20:23], s64 offen lds
    s_mov_b32 s64, 153600
    s_add_u32 m0, s70, 20480
    s_nop 0
    buffer_load_dwordx4 v168, s[20:23], s64 offen lds
    s_mov_b32 s64, 184320
    s_add_u32 m0, s70, 24576
    s_nop 0
    buffer_load_dwordx4 v168, s[20:23], s64 offen lds
    s_mov_b32 s64, 215040
    s_add_u32 m0, s70, 28672
    s_nop 0
    buffer_load_dwordx4 v168, s[20:23], s64 offen lds
    s_mov_b32 s64, 245760
    s_add_u32 m0, s70, 32768
    s_nop 0
    buffer_load_dwordx4 v168, s[20:23], s64 offen lds
    s_mov_b32 s64, 276480
    s_add_u32 m0, s70, 36864
    s_nop 0
    buffer_load_dwordx4 v168, s[20:23], s64 offen lds
    s_mov_b32 s64, 307200
    s_add_u32 m0, s70, 40960
    s_nop 0
    buffer_load_dwordx4 v168, s[20:23], s64 offen lds
    s_mov_b32 s64, 337920
    s_add_u32 m0, s70, 45056
    s_nop 0
    buffer_load_dwordx4 v168, s[20:23], s64 offen lds
    s_mov_b32 s64, 368640
    s_add_u32 m0, s70, 49152
    s_nop 0
    buffer_load_dwordx4 v168, s[20:23], s64 offen lds
    s_mov_b32 s64, 399360
    s_add_u32 m0, s70, 53248
    s_nop 0
    buffer_load_dwordx4 v168, s[20:23], s64 offen lds
    s_mov_b32 s64, 430080
    s_add_u32 m0, s70, 57344
    s_nop 0
    buffer_load_dwordx4 v168, s[20:23], s64 offen lds
    s_mov_b32 s64, 460800
    s_add_u32 m0, s70, 61440
    s_nop 0
    buffer_load_dwordx4 v168, s[20:23], s64 offen lds
    s_mov_b32 s64, 491520
    s_add_u32 m0, s70, 65536
    s_nop 0
    buffer_load_dwordx4 v168, s[20:23], s64 offen lds
    s_mov_b32 s64, 522240
    s_add_u32 m0, s70, 69632
    s_nop 0
    buffer_load_dwordx4 v168, s[20:23], s64 offen lds
    s_mov_b32 s64, 552960
    s_add_u32 m0, s70, 73728
    s_nop 0
    buffer_load_dwordx4 v168, s[20:23], s64 offen lds
    s_mov_b32 s64, 583680
    s_add_u32 m0, s70, 77824
    s_nop 0
    buffer_load_dwordx4 v168, s[20:23], s64 offen lds
    s_mov_b32 s64, 614400
    s_add_u32 m0, s70, 81920
    s_nop 0
    buffer_load_dwordx4 v168, s[20:23], s64 offen lds
    s_mov_b32 s64, 645120
    s_add_u32 m0, s70, 86016
    s_nop 0
    buffer_load_dwordx4 v168, s[20:23], s64 offen lds
    s_mov_b32 s64, 675840
    s_add_u32 m0, s70, 90112
    s_nop 0
    buffer_load_dwordx4 v168, s[20:23], s64 offen lds
    s_mov_b32 s64, 706560
    s_add_u32 m0, s70, 94208
    s_nop 0
    buffer_load_dwordx4 v168, s[20:23], s64 offen lds
    s_mov_b32 s64, 737280
    s_add_u32 m0, s70, 98304
    s_nop 0
    buffer_load_dwordx4 v168, s[20:23], s64 offen lds
    s_mov_b32 s64, 768000
    s_add_u32 m0, s70, 102400
    s_nop 0
    buffer_load_dwordx4 v168, s[20:23], s64 offen lds
    s_mov_b32 s64, 798720
    s_add_u32 m0, s70, 106496
    s_nop 0
    buffer_load_dwordx4 v168, s[20:23], s64 offen lds
    s_mov_b32 s64, 829440
    s_add_u32 m0, s70, 110592
    s_nop 0
    buffer_load_dwordx4 v168, s[20:23], s64 offen lds
    s_waitcnt vmcnt(24)
    s_waitcnt lgkmcnt(0)
    s_barrier
    s_mov_b32 s64, 860160
    s_add_u32 m0, s70, 114688
    s_nop 0
    buffer_load_dwordx4 v168, s[20:23], s64 offen lds
    s_mov_b32 s64, 890880
    s_add_u32 m0, s70, 118784
    s_nop 0
    buffer_load_dwordx4 v168, s[20:23], s64 offen lds
    s_mov_b32 s64, 921600
    s_add_u32 m0, s70, 122880
    s_nop 0
    buffer_load_dwordx4 v168, s[20:23], s64 offen lds
    s_mov_b32 s64, 952320
    s_add_u32 m0, s70, 126976
    s_nop 0
    buffer_load_dwordx4 v168, s[20:23], s64 offen lds
    ds_read_b64_tr_b16 v[200:201], v171 offset:0
    ds_read_b64_tr_b16 v[202:203], v171 offset:2048
    ds_read_b64_tr_b16 a[0:1], v169 offset:0
    ds_read_b64_tr_b16 a[2:3], v169 offset:2048
    ds_read_b64_tr_b16 a[80:81], v169 offset:160
    ds_read_b64_tr_b16 a[82:83], v169 offset:2208
    ds_read_b64_tr_b16 a[160:161], v169 offset:320
    ds_read_b64_tr_b16 a[162:163], v169 offset:2368
    s_waitcnt lgkmcnt(7)
    ds_bpermute_b32 v4, v173, v200
    ds_bpermute_b32 v5, v173, v201
    s_waitcnt lgkmcnt(8)
    ds_bpermute_b32 v6, v173, v202
    ds_bpermute_b32 v7, v173, v203
    s_waitcnt vmcnt(24)
    s_waitcnt lgkmcnt(0)
    s_barrier
    s_mov_b32 s64, 983040
    s_add_u32 m0, s70, 0
    s_nop 0
    buffer_load_dwordx4 v168, s[20:23], s64 offen lds
    s_mov_b32 s64, 1013760
    s_add_u32 m0, s70, 4096
    s_nop 0
    buffer_load_dwordx4 v168, s[20:23], s64 offen lds
    s_mov_b32 s64, 1044480
    s_add_u32 m0, s70, 8192
    s_nop 0
    buffer_load_dwordx4 v168, s[20:23], s64 offen lds
    s_mov_b32 s64, 1075200
    s_add_u32 m0, s70, 12288
    s_nop 0
    buffer_load_dwordx4 v168, s[20:23], s64 offen lds
    ds_read_b64_tr_b16 v[200:201], v171 offset:16384
    ds_read_b64_tr_b16 v[202:203], v171 offset:18432
    ds_read_b64_tr_b16 a[4:5], v169 offset:16384
    ds_read_b64_tr_b16 a[6:7], v169 offset:18432
    ds_read_b64_tr_b16 a[84:85], v169 offset:16544
    ds_read_b64_tr_b16 a[86:87], v169 offset:18592
    ds_read_b64_tr_b16 a[164:165], v169 offset:16704
    ds_read_b64_tr_b16 a[166:167], v169 offset:18752
    s_waitcnt lgkmcnt(7)
    ds_bpermute_b32 v8, v173, v200
    ds_bpermute_b32 v9, v173, v201
    s_waitcnt lgkmcnt(8)
    ds_bpermute_b32 v10, v173, v202
    ds_bpermute_b32 v11, v173, v203
    s_waitcnt vmcnt(24)
    s_waitcnt lgkmcnt(0)
    s_barrier
    s_mov_b32 s64, 1105920
    s_add_u32 m0, s70, 16384
    s_nop 0
    buffer_load_dwordx4 v168, s[20:23], s64 offen lds
    s_mov_b32 s64, 1136640
    s_add_u32 m0, s70, 20480
    s_nop 0
    buffer_load_dwordx4 v168, s[20:23], s64 offen lds
    s_mov_b32 s64, 1167360
    s_add_u32 m0, s70, 24576
    s_nop 0
    buffer_load_dwordx4 v168, s[20:23], s64 offen lds
    s_mov_b32 s64, 1198080
    s_add_u32 m0, s70, 28672
    s_nop 0
    buffer_load_dwordx4 v168, s[20:23], s64 offen lds
    ds_read_b64_tr_b16 v[200:201], v171 offset:32768
    ds_read_b64_tr_b16 v[202:203], v171 offset:34816
    ds_read_b64_tr_b16 a[8:9], v169 offset:32768
    ds_read_b64_tr_b16 a[10:11], v169 offset:34816
    ds_read_b64_tr_b16 a[88:89], v169 offset:32928
    ds_read_b64_tr_b16 a[90:91], v169 offset:34976
    ds_read_b64_tr_b16 a[168:169], v169 offset:33088
    ds_read_b64_tr_b16 a[170:171], v169 offset:35136
    s_waitcnt lgkmcnt(7)
    ds_bpermute_b32 v12, v173, v200
    ds_bpermute_b32 v13, v173, v201
    s_waitcnt lgkmcnt(8)
    ds_bpermute_b32 v14, v173, v202
    ds_bpermute_b32 v15, v173, v203
    s_waitcnt vmcnt(24)
    s_waitcnt lgkmcnt(0)
    s_barrier
    s_mov_b32 s64, 1228800
    s_add_u32 m0, s70, 32768
    s_nop 0
    buffer_load_dwordx4 v168, s[20:23], s64 offen lds
    s_mov_b32 s64, 1259520
    s_add_u32 m0, s70, 36864
    s_nop 0
    buffer_load_dwordx4 v168, s[20:23], s64 offen lds
    s_mov_b32 s64, 1290240
    s_add_u32 m0, s70, 40960
    s_nop 0
    buffer_load_dwordx4 v168, s[20:23], s64 offen lds
    s_mov_b32 s64, 1320960
    s_add_u32 m0, s70, 45056
    s_nop 0
    buffer_load_dwordx4 v168, s[20:23], s64 offen lds
    ds_read_b64_tr_b16 v[200:201], v171 offset:49152
    ds_read_b64_tr_b16 v[202:203], v171 offset:51200
    ds_read_b64_tr_b16 a[12:13], v169 offset:49152
    ds_read_b64_tr_b16 a[14:15], v169 offset:51200
    ds_read_b64_tr_b16 a[92:93], v169 offset:49312
    ds_read_b64_tr_b16 a[94:95], v169 offset:51360
    ds_read_b64_tr_b16 a[172:173], v169 offset:49472
    ds_read_b64_tr_b16 a[174:175], v169 offset:51520
    s_waitcnt lgkmcnt(7)
    ds_bpermute_b32 v16, v173, v200
    ds_bpermute_b32 v17, v173, v201
    s_waitcnt lgkmcnt(8)
    ds_bpermute_b32 v18, v173, v202
    ds_bpermute_b32 v19, v173, v203
    s_waitcnt vmcnt(24)
    s_waitcnt lgkmcnt(0)
    s_barrier
    s_mov_b32 s64, 1351680
    s_add_u32 m0, s70, 49152
    s_nop 0
    buffer_load_dwordx4 v168, s[20:23], s64 offen lds
    s_mov_b32 s64, 1382400
    s_add_u32 m0, s70, 53248
    s_nop 0
    buffer_load_dwordx4 v168, s[20:23], s64 offen lds
    s_mov_b32 s64, 1413120
    s_add_u32 m0, s70, 57344
    s_nop 0
    buffer_load_dwordx4 v168, s[20:23], s64 offen lds
    s_mov_b32 s64, 1443840
    s_add_u32 m0, s70, 61440
    s_nop 0
    buffer_load_dwordx4 v168, s[20:23], s64 offen lds
    ds_read_b64_tr_b16 v[200:201], v172 offset:0
    ds_read_b64_tr_b16 v[202:203], v172 offset:2048
    ds_read_b64_tr_b16 a[16:17], v170 offset:0
    ds_read_b64_tr_b16 a[18:19], v170 offset:2048
    ds_read_b64_tr_b16 a[96:97], v170 offset:160
    ds_read_b64_tr_b16 a[98:99], v170 offset:2208
    ds_read_b64_tr_b16 a[176:177], v170 offset:320
    ds_read_b64_tr_b16 a[178:179], v170 offset:2368
    s_waitcnt lgkmcnt(7)
    ds_bpermute_b32 v20, v173, v200
    ds_bpermute_b32 v21, v173, v201
    s_waitcnt lgkmcnt(8)
    ds_bpermute_b32 v22, v173, v202
    ds_bpermute_b32 v23, v173, v203
    s_waitcnt vmcnt(24)
    s_waitcnt lgkmcnt(0)
    s_barrier
    s_mov_b32 s64, 1474560
    s_add_u32 m0, s70, 65536
    s_nop 0
    buffer_load_dwordx4 v168, s[20:23], s64 offen lds
    s_mov_b32 s64, 1505280
    s_add_u32 m0, s70, 69632
    s_nop 0
    buffer_load_dwordx4 v168, s[20:23], s64 offen lds
    s_mov_b32 s64, 1536000
    s_add_u32 m0, s70, 73728
    s_nop 0
    buffer_load_dwordx4 v168, s[20:23], s64 offen lds
    s_mov_b32 s64, 1566720
    s_add_u32 m0, s70, 77824
    s_nop 0
    buffer_load_dwordx4 v168, s[20:23], s64 offen lds
    ds_read_b64_tr_b16 v[200:201], v172 offset:16384
    ds_read_b64_tr_b16 v[202:203], v172 offset:18432
    ds_read_b64_tr_b16 a[20:21], v170 offset:16384
    ds_read_b64_tr_b16 a[22:23], v170 offset:18432
    ds_read_b64_tr_b16 a[100:101], v170 offset:16544
    ds_read_b64_tr_b16 a[102:103], v170 offset:18592
    ds_read_b64_tr_b16 a[180:181], v170 offset:16704
    ds_read_b64_tr_b16 a[182:183], v170 offset:18752
    s_waitcnt lgkmcnt(7)
    ds_bpermute_b32 v24, v173, v200
    ds_bpermute_b32 v25, v173, v201
    s_waitcnt lgkmcnt(8)
    ds_bpermute_b32 v26, v173, v202
    ds_bpermute_b32 v27, v173, v203
    s_waitcnt vmcnt(24)
    s_waitcnt lgkmcnt(0)
    s_barrier
    s_mov_b32 s64, 1597440
    s_add_u32 m0, s70, 81920
    s_nop 0
    buffer_load_dwordx4 v168, s[20:23], s64 offen lds
    s_mov_b32 s64, 1628160
    s_add_u32 m0, s70, 86016
    s_nop 0
    buffer_load_dwordx4 v168, s[20:23], s64 offen lds
    s_mov_b32 s64, 1658880
    s_add_u32 m0, s70, 90112
    s_nop 0
    buffer_load_dwordx4 v168, s[20:23], s64 offen lds
    s_mov_b32 s64, 1689600
    s_add_u32 m0, s70, 94208
    s_nop 0
    buffer_load_dwordx4 v168, s[20:23], s64 offen lds
    ds_read_b64_tr_b16 v[200:201], v172 offset:32768
    ds_read_b64_tr_b16 v[202:203], v172 offset:34816
    ds_read_b64_tr_b16 a[24:25], v170 offset:32768
    ds_read_b64_tr_b16 a[26:27], v170 offset:34816
    ds_read_b64_tr_b16 a[104:105], v170 offset:32928
    ds_read_b64_tr_b16 a[106:107], v170 offset:34976
    ds_read_b64_tr_b16 a[184:185], v170 offset:33088
    ds_read_b64_tr_b16 a[186:187], v170 offset:35136
    s_waitcnt lgkmcnt(7)
    ds_bpermute_b32 v28, v173, v200
    ds_bpermute_b32 v29, v173, v201
    s_waitcnt lgkmcnt(8)
    ds_bpermute_b32 v30, v173, v202
    ds_bpermute_b32 v31, v173, v203
    s_waitcnt vmcnt(24)
    s_waitcnt lgkmcnt(0)
    s_barrier
    s_mov_b32 s64, 1720320
    s_add_u32 m0, s70, 98304
    s_nop 0
    buffer_load_dwordx4 v168, s[20:23], s64 offen lds
    s_mov_b32 s64, 1751040
    s_add_u32 m0, s70, 102400
    s_nop 0
    buffer_load_dwordx4 v168, s[20:23], s64 offen lds
    s_mov_b32 s64, 1781760
    s_add_u32 m0, s70, 106496
    s_nop 0
    buffer_load_dwordx4 v168, s[20:23], s64 offen lds
    s_mov_b32 s64, 1812480
    s_add_u32 m0, s70, 110592
    s_nop 0
    buffer_load_dwordx4 v168, s[20:23], s64 offen lds
    ds_read_b64_tr_b16 v[200:201], v172 offset:49152
    ds_read_b64_tr_b16 v[202:203], v172 offset:51200
    ds_read_b64_tr_b16 a[28:29], v170 offset:49152
    ds_read_b64_tr_b16 a[30:31], v170 offset:51200
    ds_read_b64_tr_b16 a[108:109], v170 offset:49312
    ds_read_b64_tr_b16 a[110:111], v170 offset:51360
    ds_read_b64_tr_b16 a[188:189], v170 offset:49472
    ds_read_b64_tr_b16 a[190:191], v170 offset:51520
    s_waitcnt lgkmcnt(7)
    ds_bpermute_b32 v32, v173, v200
    ds_bpermute_b32 v33, v173, v201
    s_waitcnt lgkmcnt(8)
    ds_bpermute_b32 v34, v173, v202
    ds_bpermute_b32 v35, v173, v203
    s_waitcnt vmcnt(24)
    s_waitcnt lgkmcnt(0)
    s_barrier
    s_mov_b32 s64, 1843200
    s_add_u32 m0, s70, 114688
    s_nop 0
    buffer_load_dwordx4 v168, s[20:23], s64 offen lds
    s_mov_b32 s64, 1873920
    s_add_u32 m0, s70, 118784
    s_nop 0
    buffer_load_dwordx4 v168, s[20:23], s64 offen lds
    s_mov_b32 s64, 1904640
    s_add_u32 m0, s70, 122880
    s_nop 0
    buffer_load_dwordx4 v168, s[20:23], s64 offen lds
    s_mov_b32 s64, 1935360
    s_add_u32 m0, s70, 126976
    s_nop 0
    buffer_load_dwordx4 v168, s[20:23], s64 offen lds
    ds_read_b64_tr_b16 v[200:201], v171 offset:0
    ds_read_b64_tr_b16 v[202:203], v171 offset:2048
    ds_read_b64_tr_b16 a[32:33], v169 offset:0
    ds_read_b64_tr_b16 a[34:35], v169 offset:2048
    ds_read_b64_tr_b16 a[112:113], v169 offset:160
    ds_read_b64_tr_b16 a[114:115], v169 offset:2208
    ds_read_b64_tr_b16 a[192:193], v169 offset:320
    ds_read_b64_tr_b16 a[194:195], v169 offset:2368
    s_waitcnt lgkmcnt(7)
    ds_bpermute_b32 v36, v173, v200
    ds_bpermute_b32 v37, v173, v201
    s_waitcnt lgkmcnt(8)
    ds_bpermute_b32 v38, v173, v202
    ds_bpermute_b32 v39, v173, v203
    s_waitcnt vmcnt(24)
    s_waitcnt lgkmcnt(0)
    s_barrier
    s_mov_b32 s64, 1966080
    s_add_u32 m0, s70, 0
    s_nop 0
    buffer_load_dwordx4 v168, s[20:23], s64 offen lds
    s_mov_b32 s64, 1996800
    s_add_u32 m0, s70, 4096
    s_nop 0
    buffer_load_dwordx4 v168, s[20:23], s64 offen lds
    s_mov_b32 s64, 2027520
    s_add_u32 m0, s70, 8192
    s_nop 0
    buffer_load_dwordx4 v168, s[20:23], s64 offen lds
    s_mov_b32 s64, 2058240
    s_add_u32 m0, s70, 12288
    s_nop 0
    buffer_load_dwordx4 v168, s[20:23], s64 offen lds
    ds_read_b64_tr_b16 v[200:201], v171 offset:16384
    ds_read_b64_tr_b16 v[202:203], v171 offset:18432
    ds_read_b64_tr_b16 a[36:37], v169 offset:16384
    ds_read_b64_tr_b16 a[38:39], v169 offset:18432
    ds_read_b64_tr_b16 a[116:117], v169 offset:16544
    ds_read_b64_tr_b16 a[118:119], v169 offset:18592
    ds_read_b64_tr_b16 a[196:197], v169 offset:16704
    ds_read_b64_tr_b16 a[198:199], v169 offset:18752
    s_waitcnt lgkmcnt(7)
    ds_bpermute_b32 v40, v173, v200
    ds_bpermute_b32 v41, v173, v201
    s_waitcnt lgkmcnt(8)
    ds_bpermute_b32 v42, v173, v202
    ds_bpermute_b32 v43, v173, v203
    s_waitcnt vmcnt(24)
    s_waitcnt lgkmcnt(0)
    s_barrier
    s_mov_b32 s64, 2088960
    s_add_u32 m0, s70, 16384
    s_nop 0
    buffer_load_dwordx4 v168, s[20:23], s64 offen lds
    s_mov_b32 s64, 2119680
    s_add_u32 m0, s70, 20480
    s_nop 0
    buffer_load_dwordx4 v168, s[20:23], s64 offen lds
    s_mov_b32 s64, 2150400
    s_add_u32 m0, s70, 24576
    s_nop 0
    buffer_load_dwordx4 v168, s[20:23], s64 offen lds
    s_mov_b32 s64, 2181120
    s_add_u32 m0, s70, 28672
    s_nop 0
    buffer_load_dwordx4 v168, s[20:23], s64 offen lds
    ds_read_b64_tr_b16 v[200:201], v171 offset:32768
    ds_read_b64_tr_b16 v[202:203], v171 offset:34816
    ds_read_b64_tr_b16 a[40:41], v169 offset:32768
    ds_read_b64_tr_b16 a[42:43], v169 offset:34816
    ds_read_b64_tr_b16 a[120:121], v169 offset:32928
    ds_read_b64_tr_b16 a[122:123], v169 offset:34976
    ds_read_b64_tr_b16 a[200:201], v169 offset:33088
    ds_read_b64_tr_b16 a[202:203], v169 offset:35136
    s_waitcnt lgkmcnt(7)
    ds_bpermute_b32 v44, v173, v200
    ds_bpermute_b32 v45, v173, v201
    s_waitcnt lgkmcnt(8)
    ds_bpermute_b32 v46, v173, v202
    ds_bpermute_b32 v47, v173, v203
    s_waitcnt vmcnt(24)
    s_waitcnt lgkmcnt(0)
    s_barrier
    s_mov_b32 s64, 2211840
    s_add_u32 m0, s70, 32768
    s_nop 0
    buffer_load_dwordx4 v168, s[20:23], s64 offen lds
    s_mov_b32 s64, 2242560
    s_add_u32 m0, s70, 36864
    s_nop 0
    buffer_load_dwordx4 v168, s[20:23], s64 offen lds
    s_mov_b32 s64, 2273280
    s_add_u32 m0, s70, 40960
    s_nop 0
    buffer_load_dwordx4 v168, s[20:23], s64 offen lds
    s_mov_b32 s64, 2304000
    s_add_u32 m0, s70, 45056
    s_nop 0
    buffer_load_dwordx4 v168, s[20:23], s64 offen lds
    ds_read_b64_tr_b16 v[200:201], v171 offset:49152
    ds_read_b64_tr_b16 v[202:203], v171 offset:51200
    ds_read_b64_tr_b16 a[44:45], v169 offset:49152
    ds_read_b64_tr_b16 a[46:47], v169 offset:51200
    ds_read_b64_tr_b16 a[124:125], v169 offset:49312
    ds_read_b64_tr_b16 a[126:127], v169 offset:51360
    ds_read_b64_tr_b16 a[204:205], v169 offset:49472
    ds_read_b64_tr_b16 a[206:207], v169 offset:51520
    s_waitcnt lgkmcnt(7)
    ds_bpermute_b32 v48, v173, v200
    ds_bpermute_b32 v49, v173, v201
    s_waitcnt lgkmcnt(8)
    ds_bpermute_b32 v50, v173, v202
    ds_bpermute_b32 v51, v173, v203
    s_waitcnt vmcnt(24)
    s_waitcnt lgkmcnt(0)
    s_barrier
    s_mov_b32 s64, 2334720
    s_add_u32 m0, s70, 49152
    s_nop 0
    buffer_load_dwordx4 v168, s[20:23], s64 offen lds
    s_mov_b32 s64, 2365440
    s_add_u32 m0, s70, 53248
    s_nop 0
    buffer_load_dwordx4 v168, s[20:23], s64 offen lds
    s_mov_b32 s64, 2396160
    s_add_u32 m0, s70, 57344
    s_nop 0
    buffer_load_dwordx4 v168, s[20:23], s64 offen lds
    s_mov_b32 s64, 2426880
    s_add_u32 m0, s70, 61440
    s_nop 0
    buffer_load_dwordx4 v168, s[20:23], s64 offen lds
    ds_read_b64_tr_b16 v[200:201], v172 offset:0
    ds_read_b64_tr_b16 v[202:203], v172 offset:2048
    ds_read_b64_tr_b16 a[48:49], v170 offset:0
    ds_read_b64_tr_b16 a[50:51], v170 offset:2048
    ds_read_b64_tr_b16 a[128:129], v170 offset:160
    ds_read_b64_tr_b16 a[130:131], v170 offset:2208
    ds_read_b64_tr_b16 a[208:209], v170 offset:320
    ds_read_b64_tr_b16 a[210:211], v170 offset:2368
    s_waitcnt lgkmcnt(7)
    ds_bpermute_b32 v52, v173, v200
    ds_bpermute_b32 v53, v173, v201
    s_waitcnt lgkmcnt(8)
    ds_bpermute_b32 v54, v173, v202
    ds_bpermute_b32 v55, v173, v203
    s_waitcnt vmcnt(24)
    s_waitcnt lgkmcnt(0)
    s_barrier
    ds_read_b64_tr_b16 v[200:201], v172 offset:16384
    ds_read_b64_tr_b16 v[202:203], v172 offset:18432
    ds_read_b64_tr_b16 a[52:53], v170 offset:16384
    ds_read_b64_tr_b16 a[54:55], v170 offset:18432
    ds_read_b64_tr_b16 a[132:133], v170 offset:16544
    ds_read_b64_tr_b16 a[134:135], v170 offset:18592
    ds_read_b64_tr_b16 a[212:213], v170 offset:16704
    ds_read_b64_tr_b16 a[214:215], v170 offset:18752
    s_waitcnt lgkmcnt(7)
    ds_bpermute_b32 v56, v173, v200
    ds_bpermute_b32 v57, v173, v201
    s_waitcnt lgkmcnt(8)
    ds_bpermute_b32 v58, v173, v202
    ds_bpermute_b32 v59, v173, v203
    s_waitcnt vmcnt(20)
    s_waitcnt lgkmcnt(0)
    s_barrier
    ds_read_b64_tr_b16 v[200:201], v172 offset:32768
    ds_read_b64_tr_b16 v[202:203], v172 offset:34816
    ds_read_b64_tr_b16 a[56:57], v170 offset:32768
    ds_read_b64_tr_b16 a[58:59], v170 offset:34816
    ds_read_b64_tr_b16 a[136:137], v170 offset:32928
    ds_read_b64_tr_b16 a[138:139], v170 offset:34976
    ds_read_b64_tr_b16 a[216:217], v170 offset:33088
    ds_read_b64_tr_b16 a[218:219], v170 offset:35136
    s_waitcnt lgkmcnt(7)
    ds_bpermute_b32 v60, v173, v200
    ds_bpermute_b32 v61, v173, v201
    s_waitcnt lgkmcnt(8)
    ds_bpermute_b32 v62, v173, v202
    ds_bpermute_b32 v63, v173, v203
    s_waitcnt vmcnt(16)
    s_waitcnt lgkmcnt(0)
    s_barrier
    ds_read_b64_tr_b16 v[200:201], v172 offset:49152
    ds_read_b64_tr_b16 v[202:203], v172 offset:51200
    ds_read_b64_tr_b16 a[60:61], v170 offset:49152
    ds_read_b64_tr_b16 a[62:63], v170 offset:51200
    ds_read_b64_tr_b16 a[140:141], v170 offset:49312
    ds_read_b64_tr_b16 a[142:143], v170 offset:51360
    ds_read_b64_tr_b16 a[220:221], v170 offset:49472
    ds_read_b64_tr_b16 a[222:223], v170 offset:51520
    s_waitcnt lgkmcnt(7)
    ds_bpermute_b32 v64, v173, v200
    ds_bpermute_b32 v65, v173, v201
    s_waitcnt lgkmcnt(8)
    ds_bpermute_b32 v66, v173, v202
    ds_bpermute_b32 v67, v173, v203
    s_waitcnt vmcnt(12)
    s_waitcnt lgkmcnt(0)
    s_barrier
    ds_read_b64_tr_b16 v[200:201], v171 offset:0
    ds_read_b64_tr_b16 v[202:203], v171 offset:2048
    ds_read_b64_tr_b16 a[64:65], v169 offset:0
    ds_read_b64_tr_b16 a[66:67], v169 offset:2048
    ds_read_b64_tr_b16 a[144:145], v169 offset:160
    ds_read_b64_tr_b16 a[146:147], v169 offset:2208
    ds_read_b64_tr_b16 a[224:225], v169 offset:320
    ds_read_b64_tr_b16 a[226:227], v169 offset:2368
    s_waitcnt lgkmcnt(7)
    ds_bpermute_b32 v68, v173, v200
    ds_bpermute_b32 v69, v173, v201
    s_waitcnt lgkmcnt(8)
    ds_bpermute_b32 v70, v173, v202
    ds_bpermute_b32 v71, v173, v203
    s_waitcnt vmcnt(8)
    s_waitcnt lgkmcnt(0)
    s_barrier
    ds_read_b64_tr_b16 v[200:201], v171 offset:16384
    ds_read_b64_tr_b16 v[202:203], v171 offset:18432
    ds_read_b64_tr_b16 a[68:69], v169 offset:16384
    ds_read_b64_tr_b16 a[70:71], v169 offset:18432
    ds_read_b64_tr_b16 a[148:149], v169 offset:16544
    ds_read_b64_tr_b16 a[150:151], v169 offset:18592
    ds_read_b64_tr_b16 a[228:229], v169 offset:16704
    ds_read_b64_tr_b16 a[230:231], v169 offset:18752
    s_waitcnt lgkmcnt(7)
    ds_bpermute_b32 v72, v173, v200
    ds_bpermute_b32 v73, v173, v201
    s_waitcnt lgkmcnt(8)
    ds_bpermute_b32 v74, v173, v202
    ds_bpermute_b32 v75, v173, v203
    s_waitcnt vmcnt(4)
    s_waitcnt lgkmcnt(0)
    s_barrier
    ds_read_b64_tr_b16 v[200:201], v171 offset:32768
    ds_read_b64_tr_b16 v[202:203], v171 offset:34816
    ds_read_b64_tr_b16 a[72:73], v169 offset:32768
    ds_read_b64_tr_b16 a[74:75], v169 offset:34816
    ds_read_b64_tr_b16 a[152:153], v169 offset:32928
    ds_read_b64_tr_b16 a[154:155], v169 offset:34976
    ds_read_b64_tr_b16 a[232:233], v169 offset:33088
    ds_read_b64_tr_b16 a[234:235], v169 offset:35136
    s_waitcnt lgkmcnt(7)
    ds_bpermute_b32 v76, v173, v200
    ds_bpermute_b32 v77, v173, v201
    s_waitcnt lgkmcnt(8)
    ds_bpermute_b32 v78, v173, v202
    ds_bpermute_b32 v79, v173, v203
    s_waitcnt vmcnt(0)
    s_waitcnt lgkmcnt(0)
    s_barrier
    ds_read_b64_tr_b16 v[200:201], v171 offset:49152
    ds_read_b64_tr_b16 v[202:203], v171 offset:51200
    ds_read_b64_tr_b16 a[76:77], v169 offset:49152
    ds_read_b64_tr_b16 a[78:79], v169 offset:51200
    ds_read_b64_tr_b16 a[156:157], v169 offset:49312
    ds_read_b64_tr_b16 a[158:159], v169 offset:51360
    ds_read_b64_tr_b16 a[236:237], v169 offset:49472
    ds_read_b64_tr_b16 a[238:239], v169 offset:51520
    s_waitcnt lgkmcnt(7)
    ds_bpermute_b32 v80, v173, v200
    ds_bpermute_b32 v81, v173, v201
    s_waitcnt lgkmcnt(8)
    ds_bpermute_b32 v82, v173, v202
    ds_bpermute_b32 v83, v173, v203
    s_waitcnt lgkmcnt(0)
    s_barrier
    v_lshlrev_b32 v168, 4, v0
    s_mul_i32 s64, s74, 102400
    s_add_u32 s65, s64, 102400
    s_mov_b32 m0, s70
Lstgb_63:
    s_nop 0
    buffer_load_dwordx4 v168, s[24:27], s64 offen lds
    s_add_u32 m0, m0, 4096
    s_add_u32 s64, s64, 4096
    s_cmp_lt_u32 s64, s65
    s_cbranch_scc1 Lstgb_63
    v_lshl_add_u32 v169, v176, 2, v177
    v_mul_u32_u24 v169, 1280, v169
    v_mul_u32_u24 v171, 20, v177
    v_add3_u32 v171, v171, v176, 16
    v_mul_u32_u24 v171, 1280, v171
    s_lshl_b32 s64, s60, 6
    v_lshl_add_u32 v173, v178, 3, s64
    v_add_u32 v170, v169, v173
    v_add_u32 v172, v171, v173
    v_lshl_add_u32 v169, v173, 1, v169
    v_lshl_add_u32 v171, v173, 1, v171
    v_add_u32 v174, 51200, v169
    v_add_u32 v175, 51200, v170
    s_waitcnt vmcnt(0)
    s_barrier
    ds_read_b64_tr_b16 v[84:85], v169 offset:0
    ds_read_b64_tr_b16 v[86:87], v169 offset:25600
    ds_read_b64_tr_b16 v[88:89], v174 offset:0
    ds_read_b64_tr_b16 v[90:91], v174 offset:25600
    ds_read_b64_tr_b16 a[240:241], v171 offset:0
    ds_read_b64_tr_b16 v[92:93], v169 offset:8
    ds_read_b64_tr_b16 v[94:95], v169 offset:25608
    ds_read_b64_tr_b16 v[96:97], v174 offset:8
    ds_read_b64_tr_b16 v[98:99], v174 offset:25608
    ds_read_b64_tr_b16 a[242:243], v171 offset:8
    ds_read_b64_tr_b16 v[100:101], v169 offset:512
    ds_read_b64_tr_b16 v[102:103], v169 offset:26112
    ds_read_b64_tr_b16 v[104:105], v174 offset:512
    ds_read_b64_tr_b16 v[106:107], v174 offset:26112
    ds_read_b64_tr_b16 a[244:245], v171 offset:512
    ds_read_b64_tr_b16 v[108:109], v169 offset:520
    ds_read_b64_tr_b16 v[110:111], v169 offset:26120
    ds_read_b64_tr_b16 v[112:113], v174 offset:520
    ds_read_b64_tr_b16 v[114:115], v174 offset:26120
    ds_read_b64_tr_b16 a[246:247], v171 offset:520
    ds_read_b64_tr_b16 v[116:117], v170 offset:1024
    ds_read_b64_tr_b16 v[118:119], v170 offset:26624
    ds_read_b64_tr_b16 v[120:121], v175 offset:1024
    ds_read_b64_tr_b16 v[122:123], v175 offset:26624
    ds_read_b64_tr_b16 a[248:249], v172 offset:1024
    ds_read_b64_tr_b16 v[124:125], v169 offset:64
    ds_read_b64_tr_b16 v[126:127], v169 offset:25664
    ds_read_b64_tr_b16 v[128:129], v174 offset:64
    ds_read_b64_tr_b16 v[130:131], v174 offset:25664
    ds_read_b64_tr_b16 a[250:251], v171 offset:64
    ds_read_b64_tr_b16 v[132:133], v169 offset:72
    ds_read_b64_tr_b16 v[134:135], v169 offset:25672
    ds_read_b64_tr_b16 v[136:137], v174 offset:72
    ds_read_b64_tr_b16 v[138:139], v174 offset:25672
    ds_read_b64_tr_b16 a[252:253], v171 offset:72
    ds_read_b64_tr_b16 v[140:141], v169 offset:576
    ds_read_b64_tr_b16 v[142:143], v169 offset:26176
    ds_read_b64_tr_b16 v[144:145], v174 offset:576
    ds_read_b64_tr_b16 v[146:147], v174 offset:26176
    ds_read_b64_tr_b16 a[254:255], v171 offset:576
    ds_read_b64_tr_b16 v[148:149], v169 offset:584
    ds_read_b64_tr_b16 v[150:151], v169 offset:26184
    ds_read_b64_tr_b16 v[152:153], v174 offset:584
    ds_read_b64_tr_b16 v[154:155], v174 offset:26184
    ds_read_b64_tr_b16 v[164:165], v171 offset:584
    ds_read_b64_tr_b16 v[156:157], v170 offset:1056
    ds_read_b64_tr_b16 v[158:159], v170 offset:26656
    ds_read_b64_tr_b16 v[160:161], v175 offset:1056
    ds_read_b64_tr_b16 v[162:163], v175 offset:26656
    ds_read_b64_tr_b16 v[166:167], v172 offset:1056
    s_waitcnt lgkmcnt(0)
    s_barrier
    v_and_b32 v179, 7, v1
    v_bfe_u32 v180, v1, 3, 1
    v_lshrrev_b32 v181, 3, v0
    v_mul_u32_u24 v242, 1280, v181
    v_and_b32 v181, 7, v181
    v_xor_b32 v181, v181, v179
    v_lshl_add_u32 v242, v181, 4, v242
    v_mul_u32_u24 v243, 10240, v180
    v_lshl_add_u32 v243, v179, 7, v243
    v_xor_b32 v181, v176, v179
    v_lshl_add_u32 v243, v181, 4, v243
    v_xor_b32 v244, 64, v243
    v_and_b32 v168, 15, v1
    v_lshlrev_b32 v181, 2, v176
    v_cmp_eq_u32 vcc, v168, v181
    s_nop 1
    v_cndmask_b32 v240, 0, 1.0, vcc
    v_mov_b32 v182, 0x3f803f80
    v_cmp_eq_u32 vcc, 1, v178
    s_nop 1
    v_cndmask_b32 v241, 0, v182, vcc
    v_sub_u32 v181, v168, v181
    v_mov_b32 v182, 0xff800000
    v_add_u32 v169, 16, v181
    v_and_b32 v169, 0xfffffff1, v169
    v_cmp_eq_u32 vcc, 0, v169
    s_nop 1
    v_cndmask_b32 v200, v182, 0, vcc
    v_add_u32 v169, 15, v181
    v_and_b32 v169, 0xfffffff1, v169
    v_cmp_eq_u32 vcc, 0, v169
    s_nop 1
    v_cndmask_b32 v201, v182, 0, vcc
    v_add_u32 v169, 14, v181
    v_and_b32 v169, 0xfffffff1, v169
    v_cmp_eq_u32 vcc, 0, v169
    s_nop 1
    v_cndmask_b32 v202, v182, 0, vcc
    v_add_u32 v169, 13, v181
    v_and_b32 v169, 0xfffffff1, v169
    v_cmp_eq_u32 vcc, 0, v169
    s_nop 1
    v_cndmask_b32 v203, v182, 0, vcc
    v_add_u32 v169, 0, v181
    v_and_b32 v169, 0xfffffff1, v169
    v_cmp_eq_u32 vcc, 0, v169
    s_nop 1
    v_cndmask_b32 v204, v182, 0, vcc
    v_add_u32 v169, -1, v181
    v_and_b32 v169, 0xfffffff1, v169
    v_cmp_eq_u32 vcc, 0, v169
    s_nop 1
    v_cndmask_b32 v205, v182, 0, vcc
    v_add_u32 v169, -2, v181
    v_and_b32 v169, 0xfffffff1, v169
    v_cmp_eq_u32 vcc, 0, v169
    s_nop 1
    v_cndmask_b32 v206, v182, 0, vcc
    v_add_u32 v169, -3, v181
    v_and_b32 v169, 0xfffffff1, v169
    v_cmp_eq_u32 vcc, 0, v169
    s_nop 1
    v_cndmask_b32 v207, v182, 0, vcc
    v_mov_b32 v208, v182
    v_mov_b32 v224, 0
    v_mov_b32 v209, v182
    v_mov_b32 v225, 0
    v_mov_b32 v210, v182
    v_mov_b32 v226, 0
    v_mov_b32 v211, v182
    v_mov_b32 v227, 0
    ds_write_b128 v245, v[200:203] offset:5120
    ds_write_b128 v245, v[204:207] offset:6144
    ds_write_b128 v245, v[208:211] offset:7168
    v_mov_b32 v228, 0
    v_mov_b32 v229, 0
    v_mov_b32 v234, 0
    v_mov_b32 v235, 0
    v_add_u32 v246, 2048, v245
    s_lshr_b32 s64, s60, 1
    s_lshl_b32 s64, s64, 10
    s_and_b32 s65, s60, 1
    s_lshl_b32 s65, s65, 3
    s_add_u32 s64, s64, s65
    v_add_u32 v247, s64, v245
    s_lshl_b32 s64, s60, 1
    v_lshl_add_u32 v248, v1, 3, s64
    v_lshlrev_b32 v250, 5, v168
    v_lshl_add_u32 v250, v176, 3, v250
    v_lshlrev_b32 v249, 1, v250
    s_mul_i32 s64, s60, 10240
    v_add_u32 v249, s64, v249
    s_add_u32 s64, s64, 4096
    v_add_u32 v250, s64, v250
    s_mul_i32 s70, s68, 2621440
    s_add_u32 s70, s70, 23068672
    s_lshl_b32 s64, s68, 9
    s_add_u32 s64, s64, s74
    s_mul_i32 s71, s64, 40960
    s_add_u32 s71, s71, 134217728
    s_mul_i32 s72, s60, 10240
    s_mov_b32 s76, 40960
    s_mov_b32 s77, 40960
    s_mov_b32 s75, 0x3ea52b5c
    s_mov_b32 s73, 0
    v_bfe_u32 v181, v0, 4, 2
    v_lshlrev_b32 v181, 5, v181
    v_add_u32 v181, 30, v181
    v_and_b32 v251, 3, v0
    v_lshl_add_u32 v251, v181, 2, v251
    v_lshlrev_b32 v251, 7, v251
    v_add_u32 v251, 8388608, v251
    s_lshl_b32 s64, s68, 16
    v_add_u32 v251, s64, v251
    v_bfe_u32 v181, v0, 4, 2
    v_cmp_eq_u32 vcc, s69, v181
    s_nop 1
    v_cndmask_b32 v181, 0, 1, vcc
    v_lshl_add_u32 v251, v181, 17, v251
    s_cmp_eq_u32 s60, 0
    s_cselect_b64 exec, 1, 0
    v_mov_b32 v2, 1
    s_cbranch_execz Lld_64
    buffer_atomic_add v2, off, s[8:11], 0 offset:28
Lld_64:
    s_mov_b64 exec, -1
    v_mov_b32 v3, 20
    buffer_load_dword v2, v3, s[8:11], 0 offen sc1
Lgchk_65:
    s_waitcnt vmcnt(0)
    v_cmp_gt_u32 vcc, 256, v2
    s_cbranch_vccnz Lgrty_66
L_Bseg:
    s_cmp_lg_u32 s73, 0
    s_cbranch_scc1 L_Bhave
    s_add_u32 s65, s62, 1
    buffer_load_dword v252, v251, s[4:7], 0 offen sc1
    s_waitcnt vmcnt(0)
    v_mov_b32 v2, s62
    s_mov_b64 exec, 1
    buffer_store_dword v2, off, s[4:7], s63 sc1
    buffer_store_dword v2, off, s[4:7], s3
    s_mov_b64 exec, -1
Lfchk_67:
    v_cmp_gt_u32 vcc, s65, v252
    s_cbranch_vccnz Lfrty_68
    s_add_u32 m0, s72, 8192
    s_nop 0
    buffer_load_dwordx4 v242, s[4:7], s70 offen offset:0 sc1 lds
    s_add_u32 m0, s72, 9088
    s_nop 0
    buffer_load_dwordx4 v242, s[4:7], s70 offen offset:128 sc1 lds
    s_add_u32 m0, s72, 9984
    s_nop 0
    buffer_load_dwordx4 v242, s[4:7], s70 offen offset:256 sc1 lds
    s_add_u32 m0, s72, 10880
    s_nop 0
    buffer_load_dwordx4 v242, s[4:7], s70 offen offset:384 sc1 lds
    s_add_u32 m0, s72, 11776
    s_nop 0
    buffer_load_dwordx4 v242, s[4:7], s70 offen offset:512 sc1 lds
    s_add_u32 m0, s72, 12672
    s_nop 0
    buffer_load_dwordx4 v242, s[4:7], s70 offen offset:640 sc1 lds
    s_add_u32 m0, s72, 13568
    s_nop 0
    buffer_load_dwordx4 v242, s[4:7], s70 offen offset:768 sc1 lds
    s_add_u32 m0, s72, 14464
    s_nop 0
    buffer_load_dwordx4 v242, s[4:7], s70 offen offset:896 sc1 lds
    s_add_u32 m0, s72, 15360
    s_nop 0
    buffer_load_dwordx4 v242, s[4:7], s70 offen offset:1024 sc1 lds
    s_add_u32 m0, s72, 16256
    s_nop 0
    buffer_load_dwordx4 v242, s[4:7], s70 offen offset:1152 sc1 lds
    s_add_u32 s70, s70, 40960
    s_add_u32 s72, s72, s77
    s_sub_u32 s77, 0, s77
    s_waitcnt vmcnt(7)
L_Bhave:
    s_waitcnt vmcnt(19) lgkmcnt(0)
    s_barrier
    ds_read_b128 v[200:203], v243 offset:8192
    ds_read_b128 v[204:207], v243 offset:28672
    ds_read_b128 v[208:211], v244 offset:8192
    ds_read_b128 v[212:215], v244 offset:28672
    s_waitcnt lgkmcnt(3)
    v_mfma_f32_16x16x32_bf16 v[168:171], a[0:3], v[200:203], 0
    ds_read_b128 v[216:219], v243 offset:9216
    v_mfma_f32_16x16x32_bf16 v[172:175], a[80:83], v[200:203], 0
    ds_read_b128 v[220:223], v243 offset:29696
    v_mfma_f32_16x16x32_bf16 v[176:179], v[200:203], a[160:163], 0
    v_mfma_f32_16x16x32_bf16 v[180:183], v[4:7], v[200:203], 0
    s_waitcnt lgkmcnt(4)
    v_mfma_f32_16x16x32_bf16 v[184:187], a[0:3], v[204:207], 0
    v_mfma_f32_16x16x32_bf16 v[188:191], a[80:83], v[204:207], 0
    v_mfma_f32_16x16x32_bf16 v[192:195], v[204:207], a[160:163], 0
    v_mfma_f32_16x16x32_bf16 v[196:199], v[4:7], v[204:207], 0
    s_waitcnt lgkmcnt(3)
    v_mfma_f32_16x16x32_bf16 v[168:171], a[4:7], v[208:211], v[168:171]
    ds_read_b128 v[200:203], v244 offset:9216
    v_mfma_f32_16x16x32_bf16 v[172:175], a[84:87], v[208:211], v[172:175]
    ds_read_b128 v[204:207], v244 offset:29696
    v_mfma_f32_16x16x32_bf16 v[176:179], v[208:211], a[164:167], v[176:179]
    v_mfma_f32_16x16x32_bf16 v[180:183], v[8:11], v[208:211], v[180:183]
    s_waitcnt lgkmcnt(4)
    v_mfma_f32_16x16x32_bf16 v[184:187], a[4:7], v[212:215], v[184:187]
    v_mfma_f32_16x16x32_bf16 v[188:191], a[84:87], v[212:215], v[188:191]
    v_mfma_f32_16x16x32_bf16 v[192:195], v[212:215], a[164:167], v[192:195]
    v_mfma_f32_16x16x32_bf16 v[196:199], v[8:11], v[212:215], v[196:199]
    s_waitcnt lgkmcnt(3)
    v_mfma_f32_16x16x32_bf16 v[168:171], a[8:11], v[216:219], v[168:171]
    ds_read_b128 v[208:211], v243 offset:10240
    v_mfma_f32_16x16x32_bf16 v[172:175], a[88:91], v[216:219], v[172:175]
    ds_read_b128 v[212:215], v243 offset:30720
    v_mfma_f32_16x16x32_bf16 v[176:179], v[216:219], a[168:171], v[176:179]
    v_mfma_f32_16x16x32_bf16 v[180:183], v[12:15], v[216:219], v[180:183]
    s_waitcnt lgkmcnt(4)
    v_mfma_f32_16x16x32_bf16 v[184:187], a[8:11], v[220:223], v[184:187]
    v_mfma_f32_16x16x32_bf16 v[188:191], a[88:91], v[220:223], v[188:191]
    v_mfma_f32_16x16x32_bf16 v[192:195], v[220:223], a[168:171], v[192:195]
    v_mfma_f32_16x16x32_bf16 v[196:199], v[12:15], v[220:223], v[196:199]
    s_waitcnt lgkmcnt(3)
    v_mfma_f32_16x16x32_bf16 v[168:171], a[12:15], v[200:203], v[168:171]
    ds_read_b128 v[216:219], v244 offset:10240
    v_mfma_f32_16x16x32_bf16 v[172:175], a[92:95], v[200:203], v[172:175]
    ds_read_b128 v[220:223], v244 offset:30720
    v_mfma_f32_16x16x32_bf16 v[176:179], v[200:203], a[172:175], v[176:179]
    v_mfma_f32_16x16x32_bf16 v[180:183], v[16:19], v[200:203], v[180:183]
    s_waitcnt lgkmcnt(4)
    v_mfma_f32_16x16x32_bf16 v[184:187], a[12:15], v[204:207], v[184:187]
    v_mfma_f32_16x16x32_bf16 v[188:191], a[92:95], v[204:207], v[188:191]
    v_mfma_f32_16x16x32_bf16 v[192:195], v[204:207], a[172:175], v[192:195]
    v_mfma_f32_16x16x32_bf16 v[196:199], v[16:19], v[204:207], v[196:199]
    s_waitcnt vmcnt(6)
    s_cmp_lg_u32 s73, 0
    s_cbranch_scc1 L_Ball
    s_waitcnt vmcnt(0)
L_Ball:
    s_barrier
    s_waitcnt lgkmcnt(3)
    v_mfma_f32_16x16x32_bf16 v[168:171], a[16:19], v[208:211], v[168:171]
    ds_read_b128 v[200:203], v243 offset:11264
    v_mfma_f32_16x16x32_bf16 v[172:175], a[96:99], v[208:211], v[172:175]
    ds_read_b128 v[204:207], v243 offset:31744
    v_mfma_f32_16x16x32_bf16 v[176:179], v[208:211], a[176:179], v[176:179]
    v_mfma_f32_16x16x32_bf16 v[180:183], v[20:23], v[208:211], v[180:183]
    s_waitcnt lgkmcnt(4)
    v_mfma_f32_16x16x32_bf16 v[184:187], a[16:19], v[212:215], v[184:187]
    v_mfma_f32_16x16x32_bf16 v[188:191], a[96:99], v[212:215], v[188:191]
    v_mfma_f32_16x16x32_bf16 v[192:195], v[212:215], a[176:179], v[192:195]
    v_mfma_f32_16x16x32_bf16 v[196:199], v[20:23], v[212:215], v[196:199]
    s_waitcnt lgkmcnt(3)
    v_mfma_f32_16x16x32_bf16 v[168:171], a[20:23], v[216:219], v[168:171]
    ds_read_b128 v[208:211], v244 offset:11264
    v_mfma_f32_16x16x32_bf16 v[172:175], a[100:103], v[216:219], v[172:175]
    ds_read_b128 v[212:215], v244 offset:31744
    v_mfma_f32_16x16x32_bf16 v[176:179], v[216:219], a[180:183], v[176:179]
    v_mfma_f32_16x16x32_bf16 v[180:183], v[24:27], v[216:219], v[180:183]
    s_waitcnt lgkmcnt(4)
    v_mfma_f32_16x16x32_bf16 v[184:187], a[20:23], v[220:223], v[184:187]
    v_mfma_f32_16x16x32_bf16 v[188:191], a[100:103], v[220:223], v[188:191]
    v_mfma_f32_16x16x32_bf16 v[192:195], v[220:223], a[180:183], v[192:195]
    v_mfma_f32_16x16x32_bf16 v[196:199], v[24:27], v[220:223], v[196:199]
    s_waitcnt lgkmcnt(3)
    v_mfma_f32_16x16x32_bf16 v[168:171], a[24:27], v[200:203], v[168:171]
    ds_read_b128 v[216:219], v243 offset:12288
    v_mfma_f32_16x16x32_bf16 v[172:175], a[104:107], v[200:203], v[172:175]
    ds_read_b128 v[220:223], v243 offset:32768
    v_mfma_f32_16x16x32_bf16 v[176:179], v[200:203], a[184:187], v[176:179]
    v_mfma_f32_16x16x32_bf16 v[180:183], v[28:31], v[200:203], v[180:183]
    s_waitcnt lgkmcnt(4)
    v_mfma_f32_16x16x32_bf16 v[184:187], a[24:27], v[204:207], v[184:187]
    v_mfma_f32_16x16x32_bf16 v[188:191], a[104:107], v[204:207], v[188:191]
    v_mfma_f32_16x16x32_bf16 v[192:195], v[204:207], a[184:187], v[192:195]
    v_mfma_f32_16x16x32_bf16 v[196:199], v[28:31], v[204:207], v[196:199]
    s_waitcnt lgkmcnt(3)
    v_mfma_f32_16x16x32_bf16 v[168:171], a[28:31], v[208:211], v[168:171]
    ds_read_b128 v[200:203], v244 offset:12288
    v_mfma_f32_16x16x32_bf16 v[172:175], a[108:111], v[208:211], v[172:175]
    ds_read_b128 v[204:207], v244 offset:32768
    v_mfma_f32_16x16x32_bf16 v[176:179], v[208:211], a[188:191], v[176:179]
    v_mfma_f32_16x16x32_bf16 v[180:183], v[32:35], v[208:211], v[180:183]
    s_waitcnt lgkmcnt(4)
    v_mfma_f32_16x16x32_bf16 v[184:187], a[28:31], v[212:215], v[184:187]
    v_mfma_f32_16x16x32_bf16 v[188:191], a[108:111], v[212:215], v[188:191]
    v_mfma_f32_16x16x32_bf16 v[192:195], v[212:215], a[188:191], v[192:195]
    v_mfma_f32_16x16x32_bf16 v[196:199], v[32:35], v[212:215], v[196:199]
    s_cmp_eq_u32 s73, 0
    s_cbranch_scc1 L_Bnofl
    s_waitcnt vmcnt(0)
    v_mov_b32 v2, s62
    s_mov_b64 exec, 1
    buffer_store_dword v2, off, s[4:7], s63 sc1
    buffer_store_dword v2, off, s[4:7], s3
    s_mov_b64 exec, -1
L_Bnofl:
    s_waitcnt lgkmcnt(3)
    v_mfma_f32_16x16x32_bf16 v[168:171], a[32:35], v[216:219], v[168:171]
    ds_read_b128 v[208:211], v243 offset:13312
    v_mfma_f32_16x16x32_bf16 v[172:175], a[112:115], v[216:219], v[172:175]
    ds_read_b128 v[212:215], v243 offset:33792
    v_mfma_f32_16x16x32_bf16 v[176:179], v[216:219], a[192:195], v[176:179]
    v_mfma_f32_16x16x32_bf16 v[180:183], v[36:39], v[216:219], v[180:183]
    s_waitcnt lgkmcnt(4)
    v_mfma_f32_16x16x32_bf16 v[184:187], a[32:35], v[220:223], v[184:187]
    v_mfma_f32_16x16x32_bf16 v[188:191], a[112:115], v[220:223], v[188:191]
    v_mfma_f32_16x16x32_bf16 v[192:195], v[220:223], a[192:195], v[192:195]
    v_mfma_f32_16x16x32_bf16 v[196:199], v[36:39], v[220:223], v[196:199]
    s_waitcnt lgkmcnt(3)
    v_mfma_f32_16x16x32_bf16 v[168:171], a[36:39], v[200:203], v[168:171]
    ds_read_b128 v[216:219], v244 offset:13312
    v_mfma_f32_16x16x32_bf16 v[172:175], a[116:119], v[200:203], v[172:175]
    ds_read_b128 v[220:223], v244 offset:33792
    v_mfma_f32_16x16x32_bf16 v[176:179], v[200:203], a[196:199], v[176:179]
    v_mfma_f32_16x16x32_bf16 v[180:183], v[40:43], v[200:203], v[180:183]
    s_waitcnt lgkmcnt(4)
    v_mfma_f32_16x16x32_bf16 v[184:187], a[36:39], v[204:207], v[184:187]
    v_mfma_f32_16x16x32_bf16 v[188:191], a[116:119], v[204:207], v[188:191]
    v_mfma_f32_16x16x32_bf16 v[192:195], v[204:207], a[196:199], v[192:195]
    v_mfma_f32_16x16x32_bf16 v[196:199], v[40:43], v[204:207], v[196:199]
    s_waitcnt lgkmcnt(3)
    v_mfma_f32_16x16x32_bf16 v[168:171], a[40:43], v[208:211], v[168:171]
    ds_read_b128 v[200:203], v243 offset:14336
    v_mfma_f32_16x16x32_bf16 v[172:175], a[120:123], v[208:211], v[172:175]
    ds_read_b128 v[204:207], v243 offset:34816
    v_mfma_f32_16x16x32_bf16 v[176:179], v[208:211], a[200:203], v[176:179]
    v_mfma_f32_16x16x32_bf16 v[180:183], v[44:47], v[208:211], v[180:183]
    s_waitcnt lgkmcnt(4)
    v_mfma_f32_16x16x32_bf16 v[184:187], a[40:43], v[212:215], v[184:187]
    v_mfma_f32_16x16x32_bf16 v[188:191], a[120:123], v[212:215], v[188:191]
    v_mfma_f32_16x16x32_bf16 v[192:195], v[212:215], a[200:203], v[192:195]
    v_mfma_f32_16x16x32_bf16 v[196:199], v[44:47], v[212:215], v[196:199]
    s_waitcnt lgkmcnt(3)
    v_mfma_f32_16x16x32_bf16 v[168:171], a[44:47], v[216:219], v[168:171]
    ds_read_b128 v[208:211], v244 offset:14336
    v_mfma_f32_16x16x32_bf16 v[172:175], a[124:127], v[216:219], v[172:175]
    ds_read_b128 v[212:215], v244 offset:34816
    v_mfma_f32_16x16x32_bf16 v[176:179], v[216:219], a[204:207], v[176:179]
    v_mfma_f32_16x16x32_bf16 v[180:183], v[48:51], v[216:219], v[180:183]
    s_waitcnt lgkmcnt(4)
    v_mfma_f32_16x16x32_bf16 v[184:187], a[44:47], v[220:223], v[184:187]
    v_mfma_f32_16x16x32_bf16 v[188:191], a[124:127], v[220:223], v[188:191]
    v_mfma_f32_16x16x32_bf16 v[192:195], v[220:223], a[204:207], v[192:195]
    v_mfma_f32_16x16x32_bf16 v[196:199], v[48:51], v[220:223], v[196:199]
    s_waitcnt lgkmcnt(3)
    v_mfma_f32_16x16x32_bf16 v[168:171], a[48:51], v[200:203], v[168:171]
    ds_read_b128 v[216:219], v243 offset:15360
    v_mfma_f32_16x16x32_bf16 v[172:175], a[128:131], v[200:203], v[172:175]
    ds_read_b128 v[220:223], v243 offset:35840
    v_mfma_f32_16x16x32_bf16 v[176:179], v[200:203], a[208:211], v[176:179]
    v_mfma_f32_16x16x32_bf16 v[180:183], v[52:55], v[200:203], v[180:183]
    s_waitcnt lgkmcnt(4)
    v_mfma_f32_16x16x32_bf16 v[184:187], a[48:51], v[204:207], v[184:187]
    v_mfma_f32_16x16x32_bf16 v[188:191], a[128:131], v[204:207], v[188:191]
    v_mfma_f32_16x16x32_bf16 v[192:195], v[204:207], a[208:211], v[192:195]
    v_mfma_f32_16x16x32_bf16 v[196:199], v[52:55], v[204:207], v[196:199]
    s_waitcnt lgkmcnt(3)
    v_mfma_f32_16x16x32_bf16 v[168:171], a[52:55], v[208:211], v[168:171]
    ds_read_b128 v[200:203], v244 offset:15360
    v_mfma_f32_16x16x32_bf16 v[172:175], a[132:135], v[208:211], v[172:175]
    ds_read_b128 v[204:207], v244 offset:35840
    v_mfma_f32_16x16x32_bf16 v[176:179], v[208:211], a[212:215], v[176:179]
    v_mfma_f32_16x16x32_bf16 v[180:183], v[56:59], v[208:211], v[180:183]
    s_waitcnt lgkmcnt(4)
    v_mfma_f32_16x16x32_bf16 v[184:187], a[52:55], v[212:215], v[184:187]
    v_mfma_f32_16x16x32_bf16 v[188:191], a[132:135], v[212:215], v[188:191]
    v_mfma_f32_16x16x32_bf16 v[192:195], v[212:215], a[212:215], v[192:195]
    v_mfma_f32_16x16x32_bf16 v[196:199], v[56:59], v[212:215], v[196:199]
    s_waitcnt lgkmcnt(3)
    v_mfma_f32_16x16x32_bf16 v[168:171], a[56:59], v[216:219], v[168:171]
    ds_read_b128 v[208:211], v243 offset:16384
    v_mfma_f32_16x16x32_bf16 v[172:175], a[136:139], v[216:219], v[172:175]
    ds_read_b128 v[212:215], v243 offset:36864
    v_mfma_f32_16x16x32_bf16 v[176:179], v[216:219], a[216:219], v[176:179]
    v_mfma_f32_16x16x32_bf16 v[180:183], v[60:63], v[216:219], v[180:183]
    s_waitcnt lgkmcnt(4)
    v_mfma_f32_16x16x32_bf16 v[184:187], a[56:59], v[220:223], v[184:187]
    v_mfma_f32_16x16x32_bf16 v[188:191], a[136:139], v[220:223], v[188:191]
    v_mfma_f32_16x16x32_bf16 v[192:195], v[220:223], a[216:219], v[192:195]
    v_mfma_f32_16x16x32_bf16 v[196:199], v[60:63], v[220:223], v[196:199]
    s_waitcnt lgkmcnt(3)
    v_mfma_f32_16x16x32_bf16 v[168:171], a[60:63], v[200:203], v[168:171]
    ds_read_b128 v[216:219], v244 offset:16384
    v_mfma_f32_16x16x32_bf16 v[172:175], a[140:143], v[200:203], v[172:175]
    ds_read_b128 v[220:223], v244 offset:36864
    v_mfma_f32_16x16x32_bf16 v[176:179], v[200:203], a[220:223], v[176:179]
    v_mfma_f32_16x16x32_bf16 v[180:183], v[64:67], v[200:203], v[180:183]
    s_waitcnt lgkmcnt(4)
    v_mfma_f32_16x16x32_bf16 v[184:187], a[60:63], v[204:207], v[184:187]
    v_mfma_f32_16x16x32_bf16 v[188:191], a[140:143], v[204:207], v[188:191]
    v_mfma_f32_16x16x32_bf16 v[192:195], v[204:207], a[220:223], v[192:195]
    v_mfma_f32_16x16x32_bf16 v[196:199], v[64:67], v[204:207], v[196:199]
    s_waitcnt lgkmcnt(3)
    v_mfma_f32_16x16x32_bf16 v[168:171], a[64:67], v[208:211], v[168:171]
    ds_read_b128 v[200:203], v243 offset:17408
    v_mfma_f32_16x16x32_bf16 v[172:175], a[144:147], v[208:211], v[172:175]
    ds_read_b128 v[204:207], v243 offset:37888
    v_mfma_f32_16x16x32_bf16 v[176:179], v[208:211], a[224:227], v[176:179]
    v_mfma_f32_16x16x32_bf16 v[180:183], v[68:71], v[208:211], v[180:183]
    s_waitcnt lgkmcnt(4)
    v_mfma_f32_16x16x32_bf16 v[184:187], a[64:67], v[212:215], v[184:187]
    v_mfma_f32_16x16x32_bf16 v[188:191], a[144:147], v[212:215], v[188:191]
    v_mfma_f32_16x16x32_bf16 v[192:195], v[212:215], a[224:227], v[192:195]
    v_mfma_f32_16x16x32_bf16 v[196:199], v[68:71], v[212:215], v[196:199]
    s_waitcnt lgkmcnt(3)
    v_mfma_f32_16x16x32_bf16 v[168:171], a[68:71], v[216:219], v[168:171]
    ds_read_b128 v[208:211], v244 offset:17408
    v_mfma_f32_16x16x32_bf16 v[172:175], a[148:151], v[216:219], v[172:175]
    ds_read_b128 v[212:215], v244 offset:37888
    v_mfma_f32_16x16x32_bf16 v[176:179], v[216:219], a[228:231], v[176:179]
    v_mfma_f32_16x16x32_bf16 v[180:183], v[72:75], v[216:219], v[180:183]
    s_waitcnt lgkmcnt(4)
    v_mfma_f32_16x16x32_bf16 v[184:187], a[68:71], v[220:223], v[184:187]
    v_mfma_f32_16x16x32_bf16 v[188:191], a[148:151], v[220:223], v[188:191]
    v_mfma_f32_16x16x32_bf16 v[192:195], v[220:223], a[228:231], v[192:195]
    v_mfma_f32_16x16x32_bf16 v[196:199], v[72:75], v[220:223], v[196:199]
    s_waitcnt lgkmcnt(3)
    v_mfma_f32_16x16x32_bf16 v[168:171], a[72:75], v[200:203], v[168:171]
    v_mfma_f32_16x16x32_bf16 v[172:175], a[152:155], v[200:203], v[172:175]
    v_mfma_f32_16x16x32_bf16 v[176:179], v[200:203], a[232:235], v[176:179]
    v_mfma_f32_16x16x32_bf16 v[180:183], v[76:79], v[200:203], v[180:183]
    s_waitcnt lgkmcnt(2)
    v_mfma_f32_16x16x32_bf16 v[184:187], a[72:75], v[204:207], v[184:187]
    v_mfma_f32_16x16x32_bf16 v[188:191], a[152:155], v[204:207], v[188:191]
    v_mfma_f32_16x16x32_bf16 v[192:195], v[204:207], a[232:235], v[192:195]
    v_mfma_f32_16x16x32_bf16 v[196:199], v[76:79], v[204:207], v[196:199]
    s_waitcnt lgkmcnt(1)
    v_mfma_f32_16x16x32_bf16 v[168:171], a[76:79], v[208:211], v[168:171]
    v_mfma_f32_16x16x32_bf16 v[172:175], a[156:159], v[208:211], v[172:175]
    v_mfma_f32_16x16x32_bf16 v[176:179], v[208:211], a[236:239], v[176:179]
    v_mfma_f32_16x16x32_bf16 v[180:183], v[80:83], v[208:211], v[180:183]
    s_waitcnt lgkmcnt(0)
    v_mfma_f32_16x16x32_bf16 v[184:187], a[76:79], v[212:215], v[184:187]
    v_mfma_f32_16x16x32_bf16 v[188:191], a[156:159], v[212:215], v[188:191]
    v_mfma_f32_16x16x32_bf16 v[192:195], v[212:215], a[236:239], v[192:195]
    v_mfma_f32_16x16x32_bf16 v[196:199], v[80:83], v[212:215], v[196:199]
    buffer_load_dword v252, v251, s[4:7], 0 offen sc1
    v_add_u32 v243, s76, v243
    v_add_u32 v244, s76, v244
    s_sub_u32 s76, 0, s76
    v_mfma_f32_16x16x4_f32 v[216:219], v182, v240, 0
    v_cvt_pk_bf16_f32 v200, v168, v169
    v_cvt_pk_bf16_f32 v201, v170, v171
    v_cvt_pk_bf16_f32 v202, v180, 0
    v_mov_b32 v203, 0
    v_cvt_pk_bf16_f32 v208, v172, v173
    v_cvt_pk_bf16_f32 v209, v174, v175
    v_cvt_pk_bf16_f32 v210, v181, 0
    v_mov_b32 v211, 0
    v_cvt_pk_bf16_f32 v230, v176, v177
    v_cvt_pk_bf16_f32 v231, v178, v179
    ds_read_b128 v[168:171], v246 offset:5120
    ds_read_b128 v[172:175], v245 offset:6144
    v_mfma_f32_16x16x4_f32 v[220:223], v198, v240, 0
    v_cvt_pk_bf16_f32 v204, v184, v185
    v_cvt_pk_bf16_f32 v205, v186, v187
    v_cvt_pk_bf16_f32 v206, v196, 0
    v_mov_b32 v207, 0
    v_cvt_pk_bf16_f32 v212, v188, v189
    v_cvt_pk_bf16_f32 v213, v190, v191
    v_cvt_pk_bf16_f32 v214, v197, 0
    v_mov_b32 v215, 0
    v_cvt_pk_bf16_f32 v232, v192, v193
    v_cvt_pk_bf16_f32 v233, v194, v195
    ds_read_b128 v[184:187], v245 offset:5120
    ds_read_b128 v[188:191], v245 offset:6144
    v_cvt_pk_bf16_f32 v236, v216, v217
    v_cvt_pk_bf16_f32 v237, v218, v219
    v_or_b32 v236, v241, v236
    v_or_b32 v237, v241, v237
    v_cvt_pk_bf16_f32 v238, v220, v221
    v_cvt_pk_bf16_f32 v239, v222, v223
    v_or_b32 v238, v241, v238
    v_or_b32 v239, v241, v239
    s_waitcnt lgkmcnt(3)
    v_mfma_f32_16x16x32_bf16 v[168:171], v[224:227], v[200:203], v[168:171]
    s_waitcnt lgkmcnt(2)
    v_mfma_f32_16x16x32_bf16 v[172:175], v[208:211], v[200:203], v[172:175]
    s_waitcnt lgkmcnt(1)
    v_mfma_f32_16x16x32_bf16 v[184:187], v[208:211], v[204:207], v[184:187]
    s_waitcnt lgkmcnt(0)
    v_mfma_f32_16x16x32_bf16 v[188:191], v[212:215], v[204:207], v[188:191]
    v_mov_b32 v246, v245
    v_mov_b32 v224, v212
    v_mov_b32 v225, v213
    v_mov_b32 v226, v214
    v_max3_f32 v216, v168, v169, v170
    s_nop 0
    v_max3_f32 v218, v184, v185, v186
    v_max3_f32 v217, v171, v172, v173
    v_max3_f32 v219, v187, v188, v189
    v_max3_f32 v216, v216, v174, v175
    v_max3_f32 v218, v218, v190, v191
    v_max_f32 v216, v216, v217
    v_max_f32 v218, v218, v219
    v_mov_b32 v217, v216
    v_mov_b32 v219, v218
    s_nop 0
    v_permlane16_swap_b32 v216, v217
    v_permlane16_swap_b32 v218, v219
    v_max_f32 v216, v216, v217
    v_max_f32 v218, v218, v219
    v_mov_b32 v217, v216
    v_mov_b32 v219, v218
    s_nop 0
    v_permlane32_swap_b32 v216, v217
    v_permlane32_swap_b32 v218, v219
    v_max_f32 v216, v216, v217
    v_max_f32 v218, v218, v219
    v_mul_f32 v216, s75, v216
    v_mul_f32 v218, s75, v218
    v_fma_f32 v168, v168, s75, -v216
    v_fma_f32 v184, v184, s75, -v218
    v_fma_f32 v169, v169, s75, -v216
    v_fma_f32 v185, v185, s75, -v218
    v_fma_f32 v170, v170, s75, -v216
    v_fma_f32 v186, v186, s75, -v218
    v_fma_f32 v171, v171, s75, -v216
    v_fma_f32 v187, v187, s75, -v218
    v_fma_f32 v172, v172, s75, -v216
    v_fma_f32 v188, v188, s75, -v218
    v_fma_f32 v173, v173, s75, -v216
    v_fma_f32 v189, v189, s75, -v218
    v_fma_f32 v174, v174, s75, -v216
    v_fma_f32 v190, v190, s75, -v218
    v_fma_f32 v175, v175, s75, -v216
    v_fma_f32 v191, v191, s75, -v218
    v_exp_f32 v168, v168
    v_exp_f32 v184, v184
    v_exp_f32 v169, v169
    v_exp_f32 v185, v185
    v_exp_f32 v170, v170
    v_exp_f32 v186, v186
    v_exp_f32 v171, v171
    v_exp_f32 v187, v187
    v_exp_f32 v172, v172
    v_exp_f32 v188, v188
    v_exp_f32 v173, v173
    v_exp_f32 v189, v189
    v_exp_f32 v174, v174
    v_exp_f32 v190, v190
    v_exp_f32 v175, v175
    v_exp_f32 v191, v191
    v_cvt_pk_bf16_f32 v168, v168, v169
    v_cvt_pk_bf16_f32 v184, v184, v185
    v_cvt_pk_bf16_f32 v169, v170, v171
    v_cvt_pk_bf16_f32 v185, v186, v187
    v_cvt_pk_bf16_f32 v170, v172, v173
    v_cvt_pk_bf16_f32 v186, v188, v189
    v_cvt_pk_bf16_f32 v171, v174, v175
    v_cvt_pk_bf16_f32 v187, v190, v191
    s_nop 0
    v_mfma_f32_16x16x32_bf16 v[180:183], v[234:237], v[168:171], 0
    v_mfma_f32_16x16x32_bf16 v[196:199], v[236:239], v[184:187], 0
    v_mfma_f32_16x16x32_bf16 v[176:179], v[228:231], v[168:171], 0
    v_mfma_f32_16x16x32_bf16 v[192:195], v[230:233], v[184:187], 0
    v_mov_b32 v228, v232
    v_mov_b32 v229, v233
    v_mov_b32 v234, v238
    v_mov_b32 v235, v239
    s_add_u32 s65, s62, 2
    v_rcp_f32 v181, v181
    v_rcp_f32 v197, v197
    v_mul_f32 v176, v176, v181
    v_mul_f32 v192, v192, v197
    v_mul_f32 v177, v177, v181
    v_mul_f32 v193, v193, v197
    v_mul_f32 v178, v178, v181
    v_mul_f32 v194, v194, v197
    v_mul_f32 v179, v179, v181
    v_mul_f32 v195, v195, v197
    v_mul_f32 v180, v180, v181
    v_mul_f32 v196, v196, v197
    v_cvt_pk_bf16_f32 v168, v176, v177
    v_cvt_pk_bf16_f32 v184, v192, v193
    v_cvt_pk_bf16_f32 v169, v178, v179
    v_cvt_pk_bf16_f32 v185, v194, v195
    v_cvt_pk_bf16_f32 v170, v180, v180
    v_cvt_pk_bf16_f32 v186, v196, v196
    ds_write_b64 v247, v[168:169] offset:0
    ds_write_b64 v247, v[184:185] offset:2048
    ds_write_b16 v248, v170 offset:4096
    ds_write_b16 v248, v186 offset:4608
    v_lshrrev_b32 v3, 1, v245
    s_waitcnt lgkmcnt(0)
    s_barrier
    ds_read_b64 v[208:209], v3 offset:4096
    ds_read_b128 v[200:203], v245 offset:0
    ds_read_b128 v[204:207], v245 offset:1024
    ds_read_b64 v[218:219], v3 offset:4608
    ds_read_b128 v[210:213], v245 offset:2048
    ds_read_b128 v[214:217], v245 offset:3072
    s_waitcnt vmcnt(0)
    v_cmp_gt_u32 vcc, s65, v252
    s_cmp_eq_u64 vcc, 0
    s_cselect_b32 s73, 1, 0
    s_add_u32 s65, s71, 5120
    s_waitcnt lgkmcnt(5)
    v_mfma_f32_16x16x16_bf16 v[168:171], a[240:241], v[208:209], 0
    v_mfma_f32_16x16x16_bf16 v[172:175], a[242:243], v[208:209], 0
    s_cbranch_vccnz Lnp_69
    s_add_u32 m0, s72, 8192
    s_nop 0
    buffer_load_dwordx4 v242, s[4:7], s70 offen offset:0 sc1 lds
Lnp_69:
    v_mfma_f32_16x16x16_bf16 v[176:179], a[244:245], v[208:209], 0
    v_mfma_f32_16x16x16_bf16 v[180:183], a[246:247], v[208:209], 0
    v_mfma_f32_16x16x16_bf16 v[220:223], a[248:249], v[208:209], 0
    s_cbranch_vccnz Lnp_70
    s_add_u32 m0, s72, 9088
    s_nop 0
    buffer_load_dwordx4 v242, s[4:7], s70 offen offset:128 sc1 lds
Lnp_70:
    s_waitcnt lgkmcnt(4)
    v_mfma_f32_16x16x32_bf16 v[168:171], v[84:87], v[200:203], v[168:171]
    v_mfma_f32_16x16x32_bf16 v[172:175], v[92:95], v[200:203], v[172:175]
    v_mfma_f32_16x16x32_bf16 v[176:179], v[100:103], v[200:203], v[176:179]
    s_cbranch_vccnz Lnp_71
    s_add_u32 m0, s72, 9984
    s_nop 0
    buffer_load_dwordx4 v242, s[4:7], s70 offen offset:256 sc1 lds
Lnp_71:
    v_mfma_f32_16x16x32_bf16 v[180:183], v[108:111], v[200:203], v[180:183]
    v_mfma_f32_16x16x32_bf16 v[220:223], v[116:119], v[200:203], v[220:223]
    s_waitcnt lgkmcnt(3)
    v_mfma_f32_16x16x32_bf16 v[168:171], v[88:91], v[204:207], v[168:171]
    s_cbranch_vccnz Lnp_72
    s_add_u32 m0, s72, 10880
    s_nop 0
    buffer_load_dwordx4 v242, s[4:7], s70 offen offset:384 sc1 lds
Lnp_72:
    v_mfma_f32_16x16x32_bf16 v[172:175], v[96:99], v[204:207], v[172:175]
    v_mfma_f32_16x16x32_bf16 v[176:179], v[104:107], v[204:207], v[176:179]
    v_mfma_f32_16x16x32_bf16 v[180:183], v[112:115], v[204:207], v[180:183]
    s_cbranch_vccnz Lnp_73
    s_add_u32 m0, s72, 11776
    s_nop 0
    buffer_load_dwordx4 v242, s[4:7], s70 offen offset:512 sc1 lds
Lnp_73:
    v_mfma_f32_16x16x32_bf16 v[220:223], v[120:123], v[204:207], v[220:223]
    v_mfma_f32_16x16x16_bf16 v[184:187], a[250:251], v[208:209], 0
    v_mfma_f32_16x16x16_bf16 v[188:191], a[252:253], v[208:209], 0
    s_cbranch_vccnz Lnp_74
    s_add_u32 m0, s72, 12672
    s_nop 0
    buffer_load_dwordx4 v242, s[4:7], s70 offen offset:640 sc1 lds
Lnp_74:
    v_cvt_pk_bf16_f32 v168, v168, v169
    v_mfma_f32_16x16x16_bf16 v[192:195], a[254:255], v[208:209], 0
    v_cvt_pk_bf16_f32 v169, v170, v171
    v_mfma_f32_16x16x16_bf16 v[196:199], v[164:165], v[208:209], 0
    v_cvt_pk_bf16_f32 v170, v172, v173
    v_mfma_f32_16x16x16_bf16 v[252:255], v[166:167], v[208:209], 0
    v_cvt_pk_bf16_f32 v171, v174, v175
    v_mfma_f32_16x16x32_bf16 v[184:187], v[124:127], v[200:203], v[184:187]
    buffer_store_dwordx4 v[168:171], v249, s[4:7], s71 offen offset:0 sc1
    v_mfma_f32_16x16x32_bf16 v[188:191], v[132:135], v[200:203], v[188:191]
    v_cvt_pk_bf16_f32 v176, v176, v177
    v_mfma_f32_16x16x32_bf16 v[192:195], v[140:143], v[200:203], v[192:195]
    s_cbranch_vccnz Lnp_75
    s_add_u32 m0, s72, 13568
    s_nop 0
    buffer_load_dwordx4 v242, s[4:7], s70 offen offset:768 sc1 lds
Lnp_75:
    v_cvt_pk_bf16_f32 v177, v178, v179
    v_mfma_f32_16x16x32_bf16 v[196:199], v[148:151], v[200:203], v[196:199]
    v_cvt_pk_bf16_f32 v178, v180, v181
    v_mfma_f32_16x16x32_bf16 v[252:255], v[156:159], v[200:203], v[252:255]
    v_cvt_pk_bf16_f32 v179, v182, v183
    v_mfma_f32_16x16x32_bf16 v[184:187], v[128:131], v[204:207], v[184:187]
    buffer_store_dwordx4 v[176:179], v249, s[4:7], s71 offen offset:2048 sc1
    v_mfma_f32_16x16x32_bf16 v[188:191], v[136:139], v[204:207], v[188:191]
    v_cvt_pk_bf16_f32 v220, v220, v221
    v_mfma_f32_16x16x32_bf16 v[192:195], v[144:147], v[204:207], v[192:195]
    v_cvt_pk_bf16_f32 v221, v222, v223
    v_mfma_f32_16x16x32_bf16 v[196:199], v[152:155], v[204:207], v[196:199]
    buffer_store_dwordx2 v[220:221], v250, s[4:7], s71 offen offset:0 sc1
    v_mfma_f32_16x16x32_bf16 v[252:255], v[160:163], v[204:207], v[252:255]
    s_waitcnt lgkmcnt(2)
    v_mfma_f32_16x16x16_bf16 v[168:171], a[240:241], v[218:219], 0
    v_mfma_f32_16x16x16_bf16 v[172:175], a[242:243], v[218:219], 0
    s_cbranch_vccnz Lnp_76
    s_add_u32 m0, s72, 14464
    s_nop 0
    buffer_load_dwordx4 v242, s[4:7], s70 offen offset:896 sc1 lds
Lnp_76:
    v_cvt_pk_bf16_f32 v184, v184, v185
    v_mfma_f32_16x16x16_bf16 v[176:179], a[244:245], v[218:219], 0
    v_cvt_pk_bf16_f32 v185, v186, v187
    v_mfma_f32_16x16x16_bf16 v[180:183], a[246:247], v[218:219], 0
    v_cvt_pk_bf16_f32 v186, v188, v189
    v_mfma_f32_16x16x16_bf16 v[220:223], a[248:249], v[218:219], 0
    v_cvt_pk_bf16_f32 v187, v190, v191
    s_waitcnt lgkmcnt(1)
    v_mfma_f32_16x16x32_bf16 v[168:171], v[84:87], v[210:213], v[168:171]
    buffer_store_dwordx4 v[184:187], v249, s[4:7], s65 offen offset:0 sc1
    v_mfma_f32_16x16x32_bf16 v[172:175], v[92:95], v[210:213], v[172:175]
    v_cvt_pk_bf16_f32 v192, v192, v193
    v_mfma_f32_16x16x32_bf16 v[176:179], v[100:103], v[210:213], v[176:179]
    s_cbranch_vccnz Lnp_77
    s_add_u32 m0, s72, 15360
    s_nop 0
    buffer_load_dwordx4 v242, s[4:7], s70 offen offset:1024 sc1 lds
Lnp_77:
    v_cvt_pk_bf16_f32 v193, v194, v195
    v_mfma_f32_16x16x32_bf16 v[180:183], v[108:111], v[210:213], v[180:183]
    v_cvt_pk_bf16_f32 v194, v196, v197
    v_mfma_f32_16x16x32_bf16 v[220:223], v[116:119], v[210:213], v[220:223]
    v_cvt_pk_bf16_f32 v195, v198, v199
    s_waitcnt lgkmcnt(0)
    v_mfma_f32_16x16x32_bf16 v[168:171], v[88:91], v[214:217], v[168:171]
    buffer_store_dwordx4 v[192:195], v249, s[4:7], s65 offen offset:2048 sc1
    v_mfma_f32_16x16x32_bf16 v[172:175], v[96:99], v[214:217], v[172:175]
    v_cvt_pk_bf16_f32 v252, v252, v253
    v_mfma_f32_16x16x32_bf16 v[176:179], v[104:107], v[214:217], v[176:179]
    v_cvt_pk_bf16_f32 v253, v254, v255
    v_mfma_f32_16x16x32_bf16 v[180:183], v[112:115], v[214:217], v[180:183]
    buffer_store_dwordx2 v[252:253], v250, s[4:7], s65 offen offset:0 sc1
    v_mfma_f32_16x16x32_bf16 v[220:223], v[120:123], v[214:217], v[220:223]
    v_mfma_f32_16x16x16_bf16 v[184:187], a[250:251], v[218:219], 0
    v_mfma_f32_16x16x16_bf16 v[188:191], a[252:253], v[218:219], 0
    s_cbranch_vccnz Lnp_78
    s_add_u32 m0, s72, 16256
    s_nop 0
    buffer_load_dwordx4 v242, s[4:7], s70 offen offset:1152 sc1 lds
Lnp_78:
    v_cvt_pk_bf16_f32 v168, v168, v169
    v_mfma_f32_16x16x16_bf16 v[192:195], a[254:255], v[218:219], 0
    v_cvt_pk_bf16_f32 v169, v170, v171
    v_mfma_f32_16x16x16_bf16 v[196:199], v[164:165], v[218:219], 0
    v_cvt_pk_bf16_f32 v170, v172, v173
    v_mfma_f32_16x16x16_bf16 v[252:255], v[166:167], v[218:219], 0
    v_cvt_pk_bf16_f32 v171, v174, v175
    v_mfma_f32_16x16x32_bf16 v[184:187], v[124:127], v[210:213], v[184:187]
    buffer_store_dwordx4 v[168:171], v249, s[4:7], s71 offen offset:1024 sc1
    v_mfma_f32_16x16x32_bf16 v[188:191], v[132:135], v[210:213], v[188:191]
    v_cvt_pk_bf16_f32 v176, v176, v177
    v_mfma_f32_16x16x32_bf16 v[192:195], v[140:143], v[210:213], v[192:195]
    s_cbranch_vccnz Lnp_79
    s_add_u32 s70, s70, 40960
    s_add_u32 s72, s72, s77
    s_sub_u32 s77, 0, s77
Lnp_79:
    v_cvt_pk_bf16_f32 v177, v178, v179
    v_mfma_f32_16x16x32_bf16 v[196:199], v[148:151], v[210:213], v[196:199]
    v_cvt_pk_bf16_f32 v178, v180, v181
    v_mfma_f32_16x16x32_bf16 v[252:255], v[156:159], v[210:213], v[252:255]
    v_cvt_pk_bf16_f32 v179, v182, v183
    v_mfma_f32_16x16x32_bf16 v[184:187], v[128:131], v[214:217], v[184:187]
    buffer_store_dwordx4 v[176:179], v249, s[4:7], s71 offen offset:3072 sc1
    v_mfma_f32_16x16x32_bf16 v[188:191], v[136:139], v[214:217], v[188:191]
    v_cvt_pk_bf16_f32 v220, v220, v221
    v_mfma_f32_16x16x32_bf16 v[192:195], v[144:147], v[214:217], v[192:195]
    v_cvt_pk_bf16_f32 v221, v222, v223
    v_mfma_f32_16x16x32_bf16 v[196:199], v[152:155], v[214:217], v[196:199]
    buffer_store_dwordx2 v[220:221], v250, s[4:7], s71 offen offset:512 sc1
    v_mfma_f32_16x16x32_bf16 v[252:255], v[160:163], v[214:217], v[252:255]
    v_cvt_pk_bf16_f32 v184, v184, v185
    v_cvt_pk_bf16_f32 v185, v186, v187
    v_cvt_pk_bf16_f32 v186, v188, v189
    v_cvt_pk_bf16_f32 v187, v190, v191
    buffer_store_dwordx4 v[184:187], v249, s[4:7], s65 offen offset:1024 sc1
    v_cvt_pk_bf16_f32 v192, v192, v193
    v_cvt_pk_bf16_f32 v193, v194, v195
    v_cvt_pk_bf16_f32 v194, v196, v197
    v_cvt_pk_bf16_f32 v195, v198, v199
    buffer_store_dwordx4 v[192:195], v249, s[4:7], s65 offen offset:3072 sc1
    v_cvt_pk_bf16_f32 v252, v252, v253
    v_cvt_pk_bf16_f32 v253, v254, v255
    buffer_store_dwordx2 v[252:253], v250, s[4:7], s65 offen offset:512 sc1
    s_add_u32 s71, s71, 327680
    s_add_u32 s62, s62, 1
    s_cmp_lt_u32 s62, 64
    s_cbranch_scc1 L_Bseg
    s_waitcnt vmcnt(0)
    v_mov_b32 v2, s62
    s_mov_b64 exec, 1
    buffer_store_dword v2, off, s[4:7], s63 sc1
    buffer_store_dword v2, off, s[4:7], s3
    s_mov_b64 exec, -1
    s_endpgm
Lgrty_66:
    s_sleep 4
    buffer_load_dword v2, v3, s[8:11], 0 offen sc1
    s_sub_u32 s61, s61, 1
    s_mov_b32 s67, 1
    s_cbranch_scc1 L_fail
    s_branch Lgchk_65
Lfrty_68:
    s_sleep 4
    buffer_load_dword v252, v251, s[4:7], 0 offen sc1
    s_sub_u32 s61, s61, 1
    s_mov_b32 s67, 30
    s_cbranch_scc1 L_fail
    s_waitcnt vmcnt(0)
    s_branch Lfchk_67
L_roleR:
    v_mov_b32 v2, 0
    s_mov_b64 exec, 1
    buffer_store_dword v2, off, s[4:7], s63 sc1
    buffer_store_dword v2, off, s[4:7], s3
    s_mov_b64 exec, -1
    s_waitcnt vmcnt(0)
    s_barrier
    s_cmp_lg_u32 s60, 0
    s_cbranch_scc1 Larr_80
    s_mov_b64 exec, 1
    v_mov_b32 v2, 1
    v_mov_b32 v3, 20
    buffer_atomic_add v2, v3, s[8:11], 0 offen
    s_mov_b64 exec, -1
Larr_80:
    s_add_u32 s64, s69, s60
    s_lshl_b32 s64, s64, 5
    s_add_u32 s64, s64, s59
    s_cmp_lg_u32 s64, 30
    s_cbranch_scc1 Lnoprobe_84
    buffer_load_dword v2, off, s[8:11], 0 offset:28 sc1
Lpchk_81:
    s_waitcnt vmcnt(0)
    v_cmp_gt_u32 vcc, 240, v2
    s_cbranch_vccnz Lprty_82
    s_lshl_b32 s64, s68, 20
    s_add_u32 s64, s64, 14729216
    s_add_u32 s66, s64, 262144
    v_lshlrev_b32 v3, 4, v0
    s_mov_b64 exec, 0xff
    buffer_store_dwordx4 v[8:11], v3, s[4:7], s66 offen sc1
    s_mov_b32 s2, 0
    s_waitcnt vmcnt(0)
Lprobe_83:
    buffer_store_dwordx4 v[8:11], v3, s[4:7], s64 offen sc1
    s_bitcmp1_b32 s64, 13
    s_cselect_b32 s67, -1, 1
Lprobe_83w:
    s_add_u32 s2, s2, s67
    s_sub_u32 s61, s61, 1
    s_cbranch_scc1 L_fail
    s_getreg_b32 s65, hwreg(HW_REG_IB_STS, 0, 4)
    s_cmp_lg_u32 s65, 0
    s_cbranch_scc1 Lprobe_83w
    s_waitcnt vmcnt(0)
    s_add_u32 s64, s64, 0x1000
    s_or_b32 s64, s64, 0xc000
    s_cmp_lt_u32 s64, s66
    s_cbranch_scc1 Lprobe_83
    s_cmp_gt_i32 s2, 0
    s_cselect_b32 s65, 2, 1
    s_mov_b64 exec, 1
    v_mov_b32 v4, s65
    s_lshl_b32 s64, s68, 2
    buffer_store_dword v4, off, s[8:11], s64 offset:8 sc1
    s_mov_b64 exec, -1
Lnoprobe_84:
    s_and_b32 s64, s59, 1
    s_lshl_b32 s74, s68, 1
    s_add_u32 s74, s74, s64
    s_cmp_eq_u32 s74, 0
    s_cselect_b32 s16, s32, s56
    s_cselect_b32 s17, s33, s57
    s_cselect_b32 s18, 2621440, s6
    s_mov_b32 s19, 0x20000
    s_cmp_eq_u32 s74, 3
    s_cselect_b32 s20, s52, s56
    s_cselect_b32 s21, s53, s57
    s_cselect_b32 s22, 2621440, s6
    s_mov_b32 s23, 0x20000
    s_mov_b32 s71, 0
    s_mov_b32 s72, 29360128
    s_mov_b32 s73, 23068672
    s_cmp_eq_u32 s74, 1
    s_cselect_b32 s71, 29360128, s71
    s_cselect_b32 s72, 35651584, s72
    s_cselect_b32 s73, 19398656, s73
    s_cmp_eq_u32 s74, 2
    s_cselect_b32 s71, 35651584, s71
    s_cselect_b32 s72, 31981568, s72
    s_cselect_b32 s73, 25690112, s73
    s_cmp_eq_u32 s74, 3
    s_cselect_b32 s71, 31981568, s71
    s_cselect_b32 s72, 0, s72
    s_cselect_b32 s73, 0, s73
    s_mov_b32 s70, 134217728
    s_cmp_eq_u32 s64, 0
    s_cselect_b32 s70, 92274688, s70
    s_cselect_b32 s65, 24, 28
    s_cselect_b32 s66, 15, 7
    s_mul_i32 s64, s68, 20971520
    s_add_u32 s70, s70, s64
    v_lshrrev_b32 v96, 5, v0
    s_lshl_b32 s64, s69, 3
    v_add_u32 v96, s64, v96
    v_and_b32 v97, 31, v0
    v_mul_u32_u24 v98, 1280, v96
    v_lshl_add_u32 v122, v97, 4, v98
    v_lshl_add_u32 v123, v97, 3, v98
    v_lshrrev_b32 v98, 2, v97
    v_mul_u32_u24 v98, 5120, v98
    v_and_b32 v99, 3, v97
    v_lshlrev_b32 v99, 3, v99
    v_lshl_add_u32 v99, v96, 5, v99
    v_lshl_add_u32 v120, v99, 1, v98
    v_add_u32 v121, v99, v98
    v_add_u32 v121, 4096, v121
    s_mov_b32 s75, 0x3f80
    s_mov_b32 s76, 0x3f800000
    v_bfe_u32 v98, v0, 4, 2
    v_lshlrev_b32 v98, 5, v98
    v_add_u32 v98, s65, v98
    v_and_b32 v124, s66, v0
    v_lshl_add_u32 v124, v98, 2, v124
    v_lshlrev_b32 v124, 7, v124
    v_add_u32 v124, 8388608, v124
    s_lshl_b32 s64, s68, 16
    v_add_u32 v124, s64, v124
    v_bfe_u32 v98, v0, 4, 2
    v_cmp_eq_u32 vcc, s69, v98
    s_nop 1
    v_cndmask_b32 v98, 0, 1, vcc
    v_lshl_add_u32 v124, v98, 17, v124
    v_mov_b32 v3, 20
    buffer_load_dword v2, v3, s[8:11], 0 offen sc1
Lgchk_85:
    s_waitcnt vmcnt(0)
    v_cmp_gt_u32 vcc, 256, v2
    s_cbranch_vccnz Lgrty_86
L_Rseg:
    s_add_u32 s65, s62, 1
    buffer_load_dword v126, v124, s[4:7], 0 offen sc1
Lfchk_87:
    s_waitcnt vmcnt(0)
    v_cmp_gt_u32 vcc, s65, v126
    s_cbranch_vccnz Lfrty_88
    buffer_load_dwordx4 v[84:87], v122, s[16:19], s71 offen sc1
    buffer_load_dwordx4 v[88:91], v122, s[16:19], s71 offen offset:512 sc1
    buffer_load_dwordx2 v[92:93], v123, s[16:19], s71 offen offset:1024 sc1
    buffer_load_dwordx4 v[4:7], v120, s[4:7], s70 offen sc1
    buffer_load_dwordx4 v[8:11], v120, s[4:7], s70 offen offset:2048 sc1
    buffer_load_dwordx2 v[12:13], v121, s[4:7], s70 offen sc1
    s_add_u32 s70, s70, 40960
    buffer_load_dwordx4 v[14:17], v120, s[4:7], s70 offen sc1
    buffer_load_dwordx4 v[18:21], v120, s[4:7], s70 offen offset:2048 sc1
    buffer_load_dwordx2 v[22:23], v121, s[4:7], s70 offen sc1
    s_add_u32 s70, s70, 40960
    buffer_load_dwordx4 v[24:27], v120, s[4:7], s70 offen sc1
    buffer_load_dwordx4 v[28:31], v120, s[4:7], s70 offen offset:2048 sc1
    buffer_load_dwordx2 v[32:33], v121, s[4:7], s70 offen sc1
    s_add_u32 s70, s70, 40960
    buffer_load_dwordx4 v[34:37], v120, s[4:7], s70 offen sc1
    buffer_load_dwordx4 v[38:41], v120, s[4:7], s70 offen offset:2048 sc1
    buffer_load_dwordx2 v[42:43], v121, s[4:7], s70 offen sc1
    s_add_u32 s70, s70, 40960
    buffer_load_dwordx4 v[44:47], v120, s[4:7], s70 offen sc1
    buffer_load_dwordx4 v[48:51], v120, s[4:7], s70 offen offset:2048 sc1
    buffer_load_dwordx2 v[52:53], v121, s[4:7], s70 offen sc1
    s_add_u32 s70, s70, 40960
    buffer_load_dwordx4 v[54:57], v120, s[4:7], s70 offen sc1
    buffer_load_dwordx4 v[58:61], v120, s[4:7], s70 offen offset:2048 sc1
    buffer_load_dwordx2 v[62:63], v121, s[4:7], s70 offen sc1
    s_add_u32 s70, s70, 40960
    buffer_load_dwordx4 v[64:67], v120, s[4:7], s70 offen sc1
    buffer_load_dwordx4 v[68:71], v120, s[4:7], s70 offen offset:2048 sc1
    buffer_load_dwordx2 v[72:73], v121, s[4:7], s70 offen sc1
    s_add_u32 s70, s70, 40960
    buffer_load_dwordx4 v[74:77], v120, s[4:7], s70 offen sc1
    buffer_load_dwordx4 v[78:81], v120, s[4:7], s70 offen offset:2048 sc1
    buffer_load_dwordx2 v[82:83], v121, s[4:7], s70 offen sc1
    s_add_u32 s70, s70, 40960
    s_add_u32 s71, s71, 40960
    s_waitcnt vmcnt(26)
    v_lshlrev_b32 v96, 16, v84
    v_and_b32 v97, 0xffff0000, v84
    v_lshlrev_b32 v98, 16, v85
    v_and_b32 v99, 0xffff0000, v85
    v_lshlrev_b32 v100, 16, v86
    v_and_b32 v101, 0xffff0000, v86
    v_lshlrev_b32 v102, 16, v87
    v_and_b32 v103, 0xffff0000, v87
    s_waitcnt vmcnt(25)
    v_lshlrev_b32 v104, 16, v88
    v_and_b32 v105, 0xffff0000, v88
    v_lshlrev_b32 v106, 16, v89
    v_and_b32 v107, 0xffff0000, v89
    v_lshlrev_b32 v108, 16, v90
    v_and_b32 v109, 0xffff0000, v90
    v_lshlrev_b32 v110, 16, v91
    v_and_b32 v111, 0xffff0000, v91
    s_waitcnt vmcnt(24)
    v_lshlrev_b32 v112, 16, v92
    v_and_b32 v113, 0xffff0000, v92
    v_lshlrev_b32 v114, 16, v93
    v_and_b32 v115, 0xffff0000, v93
    s_waitcnt vmcnt(23)
    v_dot2_f32_bf16 v96, v4, s75, v96
    v_dot2_f32_bf16 v97, v4, s76, v97
    v_dot2_f32_bf16 v98, v5, s75, v98
    v_dot2_f32_bf16 v99, v5, s76, v99
    v_dot2_f32_bf16 v100, v6, s75, v100
    v_dot2_f32_bf16 v101, v6, s76, v101
    v_dot2_f32_bf16 v102, v7, s75, v102
    v_dot2_f32_bf16 v103, v7, s76, v103
    s_waitcnt vmcnt(22)
    v_dot2_f32_bf16 v104, v8, s75, v104
    v_dot2_f32_bf16 v105, v8, s76, v105
    v_dot2_f32_bf16 v106, v9, s75, v106
    v_dot2_f32_bf16 v107, v9, s76, v107
    v_dot2_f32_bf16 v108, v10, s75, v108
    v_dot2_f32_bf16 v109, v10, s76, v109
    v_dot2_f32_bf16 v110, v11, s75, v110
    v_dot2_f32_bf16 v111, v11, s76, v111
    s_waitcnt vmcnt(21)
    v_dot2_f32_bf16 v112, v12, s75, v112
    v_dot2_f32_bf16 v113, v12, s76, v113
    v_dot2_f32_bf16 v114, v13, s75, v114
    v_dot2_f32_bf16 v115, v13, s76, v115
    s_waitcnt vmcnt(20)
    v_dot2_f32_bf16 v96, v14, s75, v96
    v_dot2_f32_bf16 v97, v14, s76, v97
    v_dot2_f32_bf16 v98, v15, s75, v98
    v_dot2_f32_bf16 v99, v15, s76, v99
    v_dot2_f32_bf16 v100, v16, s75, v100
    v_dot2_f32_bf16 v101, v16, s76, v101
    v_dot2_f32_bf16 v102, v17, s75, v102
    v_dot2_f32_bf16 v103, v17, s76, v103
    s_waitcnt vmcnt(19)
    v_dot2_f32_bf16 v104, v18, s75, v104
    v_dot2_f32_bf16 v105, v18, s76, v105
    v_dot2_f32_bf16 v106, v19, s75, v106
    v_dot2_f32_bf16 v107, v19, s76, v107
    v_dot2_f32_bf16 v108, v20, s75, v108
    v_dot2_f32_bf16 v109, v20, s76, v109
    v_dot2_f32_bf16 v110, v21, s75, v110
    v_dot2_f32_bf16 v111, v21, s76, v111
    s_waitcnt vmcnt(18)
    v_dot2_f32_bf16 v112, v22, s75, v112
    v_dot2_f32_bf16 v113, v22, s76, v113
    v_dot2_f32_bf16 v114, v23, s75, v114
    v_dot2_f32_bf16 v115, v23, s76, v115
    s_waitcnt vmcnt(17)
    v_dot2_f32_bf16 v96, v24, s75, v96
    v_dot2_f32_bf16 v97, v24, s76, v97
    v_dot2_f32_bf16 v98, v25, s75, v98
    v_dot2_f32_bf16 v99, v25, s76, v99
    v_dot2_f32_bf16 v100, v26, s75, v100
    v_dot2_f32_bf16 v101, v26, s76, v101
    v_dot2_f32_bf16 v102, v27, s75, v102
    v_dot2_f32_bf16 v103, v27, s76, v103
    s_waitcnt vmcnt(16)
    v_dot2_f32_bf16 v104, v28, s75, v104
    v_dot2_f32_bf16 v105, v28, s76, v105
    v_dot2_f32_bf16 v106, v29, s75, v106
    v_dot2_f32_bf16 v107, v29, s76, v107
    v_dot2_f32_bf16 v108, v30, s75, v108
    v_dot2_f32_bf16 v109, v30, s76, v109
    v_dot2_f32_bf16 v110, v31, s75, v110
    v_dot2_f32_bf16 v111, v31, s76, v111
    s_waitcnt vmcnt(15)
    v_dot2_f32_bf16 v112, v32, s75, v112
    v_dot2_f32_bf16 v113, v32, s76, v113
    v_dot2_f32_bf16 v114, v33, s75, v114
    v_dot2_f32_bf16 v115, v33, s76, v115
    s_waitcnt vmcnt(14)
    v_dot2_f32_bf16 v96, v34, s75, v96
    v_dot2_f32_bf16 v97, v34, s76, v97
    v_dot2_f32_bf16 v98, v35, s75, v98
    v_dot2_f32_bf16 v99, v35, s76, v99
    v_dot2_f32_bf16 v100, v36, s75, v100
    v_dot2_f32_bf16 v101, v36, s76, v101
    v_dot2_f32_bf16 v102, v37, s75, v102
    v_dot2_f32_bf16 v103, v37, s76, v103
    s_waitcnt vmcnt(13)
    v_dot2_f32_bf16 v104, v38, s75, v104
    v_dot2_f32_bf16 v105, v38, s76, v105
    v_dot2_f32_bf16 v106, v39, s75, v106
    v_dot2_f32_bf16 v107, v39, s76, v107
    v_dot2_f32_bf16 v108, v40, s75, v108
    v_dot2_f32_bf16 v109, v40, s76, v109
    v_dot2_f32_bf16 v110, v41, s75, v110
    v_dot2_f32_bf16 v111, v41, s76, v111
    s_waitcnt vmcnt(12)
    v_dot2_f32_bf16 v112, v42, s75, v112
    v_dot2_f32_bf16 v113, v42, s76, v113
    v_dot2_f32_bf16 v114, v43, s75, v114
    v_dot2_f32_bf16 v115, v43, s76, v115
    s_waitcnt vmcnt(11)
    v_dot2_f32_bf16 v96, v44, s75, v96
    v_dot2_f32_bf16 v97, v44, s76, v97
    v_dot2_f32_bf16 v98, v45, s75, v98
    v_dot2_f32_bf16 v99, v45, s76, v99
    v_dot2_f32_bf16 v100, v46, s75, v100
    v_dot2_f32_bf16 v101, v46, s76, v101
    v_dot2_f32_bf16 v102, v47, s75, v102
    v_dot2_f32_bf16 v103, v47, s76, v103
    s_waitcnt vmcnt(10)
    v_dot2_f32_bf16 v104, v48, s75, v104
    v_dot2_f32_bf16 v105, v48, s76, v105
    v_dot2_f32_bf16 v106, v49, s75, v106
    v_dot2_f32_bf16 v107, v49, s76, v107
    v_dot2_f32_bf16 v108, v50, s75, v108
    v_dot2_f32_bf16 v109, v50, s76, v109
    v_dot2_f32_bf16 v110, v51, s75, v110
    v_dot2_f32_bf16 v111, v51, s76, v111
    s_waitcnt vmcnt(9)
    v_dot2_f32_bf16 v112, v52, s75, v112
    v_dot2_f32_bf16 v113, v52, s76, v113
    v_dot2_f32_bf16 v114, v53, s75, v114
    v_dot2_f32_bf16 v115, v53, s76, v115
    s_waitcnt vmcnt(8)
    v_dot2_f32_bf16 v96, v54, s75, v96
    v_dot2_f32_bf16 v97, v54, s76, v97
    v_dot2_f32_bf16 v98, v55, s75, v98
    v_dot2_f32_bf16 v99, v55, s76, v99
    v_dot2_f32_bf16 v100, v56, s75, v100
    v_dot2_f32_bf16 v101, v56, s76, v101
    v_dot2_f32_bf16 v102, v57, s75, v102
    v_dot2_f32_bf16 v103, v57, s76, v103
    s_waitcnt vmcnt(7)
    v_dot2_f32_bf16 v104, v58, s75, v104
    v_dot2_f32_bf16 v105, v58, s76, v105
    v_dot2_f32_bf16 v106, v59, s75, v106
    v_dot2_f32_bf16 v107, v59, s76, v107
    v_dot2_f32_bf16 v108, v60, s75, v108
    v_dot2_f32_bf16 v109, v60, s76, v109
    v_dot2_f32_bf16 v110, v61, s75, v110
    v_dot2_f32_bf16 v111, v61, s76, v111
    s_waitcnt vmcnt(6)
    v_dot2_f32_bf16 v112, v62, s75, v112
    v_dot2_f32_bf16 v113, v62, s76, v113
    v_dot2_f32_bf16 v114, v63, s75, v114
    v_dot2_f32_bf16 v115, v63, s76, v115
    s_waitcnt vmcnt(5)
    v_dot2_f32_bf16 v96, v64, s75, v96
    v_dot2_f32_bf16 v97, v64, s76, v97
    v_dot2_f32_bf16 v98, v65, s75, v98
    v_dot2_f32_bf16 v99, v65, s76, v99
    v_dot2_f32_bf16 v100, v66, s75, v100
    v_dot2_f32_bf16 v101, v66, s76, v101
    v_dot2_f32_bf16 v102, v67, s75, v102
    v_dot2_f32_bf16 v103, v67, s76, v103
    s_waitcnt vmcnt(4)
    v_dot2_f32_bf16 v104, v68, s75, v104
    v_dot2_f32_bf16 v105, v68, s76, v105
    v_dot2_f32_bf16 v106, v69, s75, v106
    v_dot2_f32_bf16 v107, v69, s76, v107
    v_dot2_f32_bf16 v108, v70, s75, v108
    v_dot2_f32_bf16 v109, v70, s76, v109
    v_dot2_f32_bf16 v110, v71, s75, v110
    v_dot2_f32_bf16 v111, v71, s76, v111
    s_waitcnt vmcnt(3)
    v_dot2_f32_bf16 v112, v72, s75, v112
    v_dot2_f32_bf16 v113, v72, s76, v113
    v_dot2_f32_bf16 v114, v73, s75, v114
    v_dot2_f32_bf16 v115, v73, s76, v115
    s_waitcnt vmcnt(2)
    v_dot2_f32_bf16 v96, v74, s75, v96
    v_dot2_f32_bf16 v97, v74, s76, v97
    v_dot2_f32_bf16 v98, v75, s75, v98
    v_dot2_f32_bf16 v99, v75, s76, v99
    v_dot2_f32_bf16 v100, v76, s75, v100
    v_dot2_f32_bf16 v101, v76, s76, v101
    v_dot2_f32_bf16 v102, v77, s75, v102
    v_dot2_f32_bf16 v103, v77, s76, v103
    s_waitcnt vmcnt(1)
    v_dot2_f32_bf16 v104, v78, s75, v104
    v_dot2_f32_bf16 v105, v78, s76, v105
    v_dot2_f32_bf16 v106, v79, s75, v106
    v_dot2_f32_bf16 v107, v79, s76, v107
    v_dot2_f32_bf16 v108, v80, s75, v108
    v_dot2_f32_bf16 v109, v80, s76, v109
    v_dot2_f32_bf16 v110, v81, s75, v110
    v_dot2_f32_bf16 v111, v81, s76, v111
    s_waitcnt vmcnt(0)
    v_dot2_f32_bf16 v112, v82, s75, v112
    v_dot2_f32_bf16 v113, v82, s76, v113
    v_dot2_f32_bf16 v114, v83, s75, v114
    v_dot2_f32_bf16 v115, v83, s76, v115
    v_cvt_pk_bf16_f32 v84, v96, v97
    v_cvt_pk_bf16_f32 v85, v98, v99
    v_cvt_pk_bf16_f32 v86, v100, v101
    v_cvt_pk_bf16_f32 v87, v102, v103
    v_cvt_pk_bf16_f32 v88, v104, v105
    v_cvt_pk_bf16_f32 v89, v106, v107
    v_cvt_pk_bf16_f32 v90, v108, v109
    v_cvt_pk_bf16_f32 v91, v110, v111
    v_cvt_pk_bf16_f32 v92, v112, v113
    v_cvt_pk_bf16_f32 v93, v114, v115
    buffer_store_dwordx4 v[84:87], v122, s[20:23], s72 offen sc1
    buffer_store_dwordx4 v[88:91], v122, s[20:23], s72 offen offset:512 sc1
    buffer_store_dwordx2 v[92:93], v123, s[20:23], s72 offen offset:1024 sc1
    s_add_u32 s72, s72, 40960
    s_cmp_eq_u32 s74, 3
    s_cbranch_scc1 L_Rnext
    v_lshlrev_b32 v96, 16, v84
    v_and_b32 v97, 0xffff0000, v84
    v_lshlrev_b32 v98, 16, v85
    v_and_b32 v99, 0xffff0000, v85
    v_lshlrev_b32 v100, 16, v86
    v_and_b32 v101, 0xffff0000, v86
    v_lshlrev_b32 v102, 16, v87
    v_and_b32 v103, 0xffff0000, v87
    v_lshlrev_b32 v104, 16, v88
    v_and_b32 v105, 0xffff0000, v88
    v_lshlrev_b32 v106, 16, v89
    v_and_b32 v107, 0xffff0000, v89
    v_lshlrev_b32 v108, 16, v90
    v_and_b32 v109, 0xffff0000, v90
    v_lshlrev_b32 v110, 16, v91
    v_and_b32 v111, 0xffff0000, v91
    v_lshlrev_b32 v112, 16, v92
    v_and_b32 v113, 0xffff0000, v92
    v_lshlrev_b32 v114, 16, v93
    v_and_b32 v115, 0xffff0000, v93
    v_add_f32 v116, v96, v97
    v_add_f32 v117, v98, v99
    v_add_f32 v116, v116, v100
    v_add_f32 v117, v117, v101
    v_add_f32 v116, v116, v102
    v_add_f32 v117, v117, v103
    v_add_f32 v116, v116, v104
    v_add_f32 v117, v117, v105
    v_add_f32 v116, v116, v106
    v_add_f32 v117, v117, v107
    v_add_f32 v116, v116, v108
    v_add_f32 v117, v117, v109
    v_add_f32 v116, v116, v110
    v_add_f32 v117, v117, v111
    v_add_f32 v116, v116, v112
    v_add_f32 v117, v117, v113
    v_add_f32 v116, v116, v114
    v_add_f32 v117, v117, v115
    v_add_f32 v116, v116, v117
    s_nop 1
    v_add_f32_dpp v116, v116, v116 quad_perm:[1,0,3,2] row_mask:0xf bank_mask:0xf
    s_nop 1
    v_add_f32_dpp v116, v116, v116 quad_perm:[2,3,0,1] row_mask:0xf bank_mask:0xf
    s_nop 1
    v_add_f32_dpp v116, v116, v116 row_half_mirror row_mask:0xf bank_mask:0xf
    s_nop 1
    v_add_f32_dpp v116, v116, v116 row_mirror row_mask:0xf bank_mask:0xf
    v_mov_b32 v117, v116
    s_nop 1
    v_permlane16_swap_b32 v116, v117
    v_add_f32 v116, v116, v117
    v_mul_f32 v116, 0x3acccccd, v116
    v_sub_f32 v96, v96, v116
    v_sub_f32 v97, v97, v116
    v_sub_f32 v98, v98, v116
    v_sub_f32 v99, v99, v116
    v_sub_f32 v100, v100, v116
    v_sub_f32 v101, v101, v116
    v_sub_f32 v102, v102, v116
    v_sub_f32 v103, v103, v116
    v_sub_f32 v104, v104, v116
    v_sub_f32 v105, v105, v116
    v_sub_f32 v106, v106, v116
    v_sub_f32 v107, v107, v116
    v_sub_f32 v108, v108, v116
    v_sub_f32 v109, v109, v116
    v_sub_f32 v110, v110, v116
    v_sub_f32 v111, v111, v116
    v_sub_f32 v112, v112, v116
    v_sub_f32 v113, v113, v116
    v_sub_f32 v114, v114, v116
    v_sub_f32 v115, v115, v116
    v_mul_f32 v116, v96, v96
    v_mul_f32 v117, v97, v97
    v_fmac_f32 v116, v98, v98
    v_fmac_f32 v117, v99, v99
    v_fmac_f32 v116, v100, v100
    v_fmac_f32 v117, v101, v101
    v_fmac_f32 v116, v102, v102
    v_fmac_f32 v117, v103, v103
    v_fmac_f32 v116, v104, v104
    v_fmac_f32 v117, v105, v105
    v_fmac_f32 v116, v106, v106
    v_fmac_f32 v117, v107, v107
    v_fmac_f32 v116, v108, v108
    v_fmac_f32 v117, v109, v109
    v_fmac_f32 v116, v110, v110
    v_fmac_f32 v117, v111, v111
    v_fmac_f32 v116, v112, v112
    v_fmac_f32 v117, v113, v113
    v_fmac_f32 v116, v114, v114
    v_fmac_f32 v117, v115, v115
    v_add_f32 v116, v116, v117
    s_nop 1
    v_add_f32_dpp v116, v116, v116 quad_perm:[1,0,3,2] row_mask:0xf bank_mask:0xf
    s_nop 1
    v_add_f32_dpp v116, v116, v116 quad_perm:[2,3,0,1] row_mask:0xf bank_mask:0xf
    s_nop 1
    v_add_f32_dpp v116, v116, v116 row_half_mirror row_mask:0xf bank_mask:0xf
    s_nop 1
    v_add_f32_dpp v116, v116, v116 row_mirror row_mask:0xf bank_mask:0xf
    v_mov_b32 v117, v116
    s_nop 1
    v_permlane16_swap_b32 v116, v117
    v_add_f32 v116, v116, v117
    v_mov_b32 v117, 0x3727c5ac
    v_fmac_f32 v117, 0x3acccccd, v116
    v_rsq_f32 v116, v117
    s_nop 0
    v_mul_f32 v96, v96, v116
    v_mul_f32 v97, v97, v116
    v_mul_f32 v98, v98, v116
    v_mul_f32 v99, v99, v116
    v_mul_f32 v100, v100, v116
    v_mul_f32 v101, v101, v116
    v_mul_f32 v102, v102, v116
    v_mul_f32 v103, v103, v116
    v_mul_f32 v104, v104, v116
    v_mul_f32 v105, v105, v116
    v_mul_f32 v106, v106, v116
    v_mul_f32 v107, v107, v116
    v_mul_f32 v108, v108, v116
    v_mul_f32 v109, v109, v116
    v_mul_f32 v110, v110, v116
    v_mul_f32 v111, v111, v116
    v_mul_f32 v112, v112, v116
    v_mul_f32 v113, v113, v116
    v_mul_f32 v114, v114, v116
    v_mul_f32 v115, v115, v116
    v_cvt_pk_bf16_f32 v84, v96, v97
    v_cvt_pk_bf16_f32 v85, v98, v99
    v_cvt_pk_bf16_f32 v86, v100, v101
    v_cvt_pk_bf16_f32 v87, v102, v103
    v_cvt_pk_bf16_f32 v88, v104, v105
    v_cvt_pk_bf16_f32 v89, v106, v107
    v_cvt_pk_bf16_f32 v90, v108, v109
    v_cvt_pk_bf16_f32 v91, v110, v111
    v_cvt_pk_bf16_f32 v92, v112, v113
    v_cvt_pk_bf16_f32 v93, v114, v115
    buffer_store_dwordx4 v[84:87], v122, s[4:7], s73 offen sc1
    buffer_store_dwordx4 v[88:91], v122, s[4:7], s73 offen offset:512 sc1
    buffer_store_dwordx2 v[92:93], v123, s[4:7], s73 offen offset:1024 sc1
    s_add_u32 s73, s73, 40960
    s_waitcnt vmcnt(0)
    s_add_u32 s64, s62, 1
    v_mov_b32 v116, s64
    s_mov_b64 exec, 1
    buffer_store_dword v116, off, s[4:7], s63 sc1
    buffer_store_dword v116, off, s[4:7], s3
    s_mov_b64 exec, -1
L_Rnext:
    s_add_u32 s62, s62, 1
    s_cmp_lt_u32 s62, 64
    s_cbranch_scc1 L_Rseg
    s_endpgm
Lprty_82:
    s_sleep 8
    buffer_load_dword v2, off, s[8:11], 0 offset:28 sc1
    s_sub_u32 s61, s61, 1
    s_mov_b32 s67, 3
    s_cbranch_scc1 L_fail
    s_branch Lpchk_81
Lgrty_86:
    s_sleep 4
    buffer_load_dword v2, v3, s[8:11], 0 offen sc1
    s_sub_u32 s61, s61, 1
    s_mov_b32 s67, 1
    s_cbranch_scc1 L_fail
    s_branch Lgchk_85
Lfrty_88:
    s_sleep 4
    buffer_load_dword v126, v124, s[4:7], 0 offen sc1
    s_sub_u32 s61, s61, 1
    s_mov_b32 s67, 40
    s_cbranch_scc1 L_fail
    s_waitcnt vmcnt(0)
    s_branch Lfchk_87
.section .rodata,"a"
.p2align 6
.amdhsa_kernel interleave_layers__memory_aug_recurrent_mem_tr__sliding_local_dilated__prompt_kernel
  .amdhsa_next_free_vgpr 512
  .amdhsa_next_free_sgpr 102
  .amdhsa_accum_offset 256
  .amdhsa_group_segment_fixed_size 0
  .amdhsa_kernarg_size 104
  .amdhsa_user_sgpr_count 2
  .amdhsa_user_sgpr_kernarg_segment_ptr 1
  .amdhsa_system_sgpr_workgroup_id_x 1
  .amdhsa_float_denorm_mode_32 3
.end_amdhsa_kernel
```

```asm
; @launch grid=(256,1,1) block=(256,1,1) lds=163840
.amdgcn_target "amdgcn-amd-amdhsa--gfx950"
.text
.globl interleave_layers__memory_aug_recurrent_mem_tr__sliding_local_dilated__prompt_kernel
.p2align 8
.type interleave_layers__memory_aug_recurrent_mem_tr__sliding_local_dilated__prompt_kernel,@function
interleave_layers__memory_aug_recurrent_mem_tr__sliding_local_dilated__prompt_kernel:
    s_cmp_ge_u32 s2, 256
    s_cbranch_scc1 L_end
    s_load_dwordx16 s[32:47], s[0:1], 0
    s_load_dwordx8 s[48:55], s[0:1], 64
    s_load_dwordx2 s[56:57], s[0:1], 96
    s_getreg_b32 s58, hwreg(HW_REG_XCC_ID)
    s_and_b32 s58, s58, 7
    v_lshrrev_b32 v1, 6, v0
    s_nop 0
    v_readfirstlane_b32 s60, v1
    s_mov_b32 s61, 0x100000
    s_waitcnt lgkmcnt(0)
    s_mov_b32 s4, s56
    s_mov_b32 s5, s57
    s_mov_b32 s6, 268435456
    s_mov_b32 s7, 0x20000
    s_mov_b32 s8, s54
    s_mov_b32 s9, s55
    s_mov_b32 s10, 256
    s_mov_b32 s11, 0x20000
    s_mov_b32 s12, s32
    s_mov_b32 s13, s33
    s_mov_b32 s14, 2621440
    s_mov_b32 s15, 0x20000
    s_cmp_lg_u32 s60, 0
    s_cbranch_scc1 L_notick
    s_mov_b64 exec, 1
    v_mov_b32 v2, 1
    s_lshl_b32 s64, s58, 5
    buffer_atomic_add v2, off, s[8:11], s64 sc0
    s_mov_b64 exec, -1
L_notick:
    v_lshrrev_b32 v4, 5, v0
    s_lshl_b32 s64, s2, 3
    v_add_u32 v4, s64, v4
    v_mul_u32_u24 v4, 1280, v4
    v_and_b32 v5, 31, v0
    v_lshl_add_u32 v6, v5, 3, v4
    v_lshl_add_u32 v5, v5, 4, v4
    buffer_load_dwordx4 v[8:11], v5, s[12:15], 0 offen
    buffer_load_dwordx4 v[12:15], v5, s[12:15], 0 offen offset:512
    buffer_load_dwordx2 v[16:17], v6, s[12:15], 0 offen offset:1024
    v_mov_b32 v44, -1
    v_mov_b32 v45, -1
    v_mov_b32 v46, -1
    v_mov_b32 v47, -1
    v_mov_b32 v48, 0
    v_lshlrev_b32 v7, 4, v0
    v_lshlrev_b32 v18, 2, v0
    s_lshr_b32 s64, s2, 5
    s_lshl_b32 s64, s64, 20
    s_bfe_u32 s65, s2, 0x10004
    s_lshl_b32 s65, s65, 18
    s_add_u32 s64, s64, s65
    s_and_b32 s65, s2, 15
    s_mul_i32 s65, s65, 11776
    s_add_u32 s64, s64, s65
    buffer_store_dwordx4 v[44:47], v7, s[4:7], s64 offen sc1
    s_add_u32 s64, s64, 4096
    buffer_store_dwordx4 v[44:47], v7, s[4:7], s64 offen sc1
    s_add_u32 s64, s64, 4096
    buffer_store_dwordx4 v[44:47], v7, s[4:7], s64 offen sc1
    s_add_u32 s64, s64, 4096
    s_lshr_b32 s64, s2, 5
    s_lshl_b32 s64, s64, 18
    s_and_b32 s65, s2, 31
    s_lshl_b32 s65, s65, 12
    s_add_u32 s64, s64, s65
    s_add_u32 s64, s64, 14680064
    buffer_store_dwordx4 v[44:47], v7, s[4:7], s64 offen sc1
    s_lshl_b32 s64, s2, 10
    s_add_u32 s64, s64, 8388608
    buffer_store_dword v48, v18, s[4:7], s64 offen sc1
    s_cmp_lg_u32 s60, 0
    s_cbranch_scc1 L_notick2
    v_mov_b32 v3, 0
    s_mov_b64 exec, 1
    s_waitcnt vmcnt(8)
    ds_write_b32 v3, v2
    s_mov_b64 exec, -1
L_notick2:
    s_waitcnt lgkmcnt(0)
    s_barrier
    v_mov_b32 v3, 0
    s_waitcnt vmcnt(8)
    ds_read_b32 v2, v3
    s_waitcnt lgkmcnt(0)
    v_readfirstlane_b32 s59, v2
    s_waitcnt lgkmcnt(0)
    s_barrier
    s_waitcnt vmcnt(7)
    v_lshlrev_b32 v20, 16, v8
    v_and_b32 v21, 0xffff0000, v8
    v_lshlrev_b32 v22, 16, v9
    v_and_b32 v23, 0xffff0000, v9
    v_lshlrev_b32 v24, 16, v10
    v_and_b32 v25, 0xffff0000, v10
    v_lshlrev_b32 v26, 16, v11
    v_and_b32 v27, 0xffff0000, v11
    s_waitcnt vmcnt(6)
    v_lshlrev_b32 v28, 16, v12
    v_and_b32 v29, 0xffff0000, v12
    v_lshlrev_b32 v30, 16, v13
    v_and_b32 v31, 0xffff0000, v13
    v_lshlrev_b32 v32, 16, v14
    v_and_b32 v33, 0xffff0000, v14
    v_lshlrev_b32 v34, 16, v15
    v_and_b32 v35, 0xffff0000, v15
    s_waitcnt vmcnt(5)
    v_lshlrev_b32 v36, 16, v16
    v_and_b32 v37, 0xffff0000, v16
    v_lshlrev_b32 v38, 16, v17
    v_and_b32 v39, 0xffff0000, v17
    v_add_f32 v40, v20, v21
    v_add_f32 v41, v22, v23
    v_add_f32 v40, v40, v24
    v_add_f32 v41, v41, v25
    v_add_f32 v40, v40, v26
    v_add_f32 v41, v41, v27
    v_add_f32 v40, v40, v28
    v_add_f32 v41, v41, v29
    v_add_f32 v40, v40, v30
    v_add_f32 v41, v41, v31
    v_add_f32 v40, v40, v32
    v_add_f32 v41, v41, v33
    v_add_f32 v40, v40, v34
    v_add_f32 v41, v41, v35
    v_add_f32 v40, v40, v36
    v_add_f32 v41, v41, v37
    v_add_f32 v40, v40, v38
    v_add_f32 v41, v41, v39
    v_add_f32 v40, v40, v41
    s_nop 1
    v_add_f32_dpp v40, v40, v40 quad_perm:[1,0,3,2] row_mask:0xf bank_mask:0xf
    s_nop 1
    v_add_f32_dpp v40, v40, v40 quad_perm:[2,3,0,1] row_mask:0xf bank_mask:0xf
    s_nop 1
    v_add_f32_dpp v40, v40, v40 row_half_mirror row_mask:0xf bank_mask:0xf
    s_nop 1
    v_add_f32_dpp v40, v40, v40 row_mirror row_mask:0xf bank_mask:0xf
    v_mov_b32 v41, v40
    s_nop 1
    v_permlane16_swap_b32 v40, v41
    v_add_f32 v40, v40, v41
    v_mul_f32 v40, 0x3acccccd, v40
    v_sub_f32 v20, v20, v40
    v_sub_f32 v21, v21, v40
    v_sub_f32 v22, v22, v40
    v_sub_f32 v23, v23, v40
    v_sub_f32 v24, v24, v40
    v_sub_f32 v25, v25, v40
    v_sub_f32 v26, v26, v40
    v_sub_f32 v27, v27, v40
    v_sub_f32 v28, v28, v40
    v_sub_f32 v29, v29, v40
    v_sub_f32 v30, v30, v40
    v_sub_f32 v31, v31, v40
    v_sub_f32 v32, v32, v40
    v_sub_f32 v33, v33, v40
    v_sub_f32 v34, v34, v40
    v_sub_f32 v35, v35, v40
    v_sub_f32 v36, v36, v40
    v_sub_f32 v37, v37, v40
    v_sub_f32 v38, v38, v40
    v_sub_f32 v39, v39, v40
    v_mul_f32 v40, v20, v20
    v_mul_f32 v41, v21, v21
    v_fmac_f32 v40, v22, v22
    v_fmac_f32 v41, v23, v23
    v_fmac_f32 v40, v24, v24
    v_fmac_f32 v41, v25, v25
    v_fmac_f32 v40, v26, v26
    v_fmac_f32 v41, v27, v27
    v_fmac_f32 v40, v28, v28
    v_fmac_f32 v41, v29, v29
    v_fmac_f32 v40, v30, v30
    v_fmac_f32 v41, v31, v31
    v_fmac_f32 v40, v32, v32
    v_fmac_f32 v41, v33, v33
    v_fmac_f32 v40, v34, v34
    v_fmac_f32 v41, v35, v35
    v_fmac_f32 v40, v36, v36
    v_fmac_f32 v41, v37, v37
    v_fmac_f32 v40, v38, v38
    v_fmac_f32 v41, v39, v39
    v_add_f32 v40, v40, v41
    s_nop 1
    v_add_f32_dpp v40, v40, v40 quad_perm:[1,0,3,2] row_mask:0xf bank_mask:0xf
    s_nop 1
    v_add_f32_dpp v40, v40, v40 quad_perm:[2,3,0,1] row_mask:0xf bank_mask:0xf
    s_nop 1
    v_add_f32_dpp v40, v40, v40 row_half_mirror row_mask:0xf bank_mask:0xf
    s_nop 1
    v_add_f32_dpp v40, v40, v40 row_mirror row_mask:0xf bank_mask:0xf
    v_mov_b32 v41, v40
    s_nop 1
    v_permlane16_swap_b32 v40, v41
    v_add_f32 v40, v40, v41
    v_mov_b32 v41, 0x3727c5ac
    v_fmac_f32 v41, 0x3acccccd, v40
    v_rsq_f32 v40, v41
    s_nop 0
    v_mul_f32 v20, v20, v40
    v_mul_f32 v21, v21, v40
    v_mul_f32 v22, v22, v40
    v_mul_f32 v23, v23, v40
    v_mul_f32 v24, v24, v40
    v_mul_f32 v25, v25, v40
    v_mul_f32 v26, v26, v40
    v_mul_f32 v27, v27, v40
    v_mul_f32 v28, v28, v40
    v_mul_f32 v29, v29, v40
    v_mul_f32 v30, v30, v40
    v_mul_f32 v31, v31, v40
    v_mul_f32 v32, v32, v40
    v_mul_f32 v33, v33, v40
    v_mul_f32 v34, v34, v40
    v_mul_f32 v35, v35, v40
    v_mul_f32 v36, v36, v40
    v_mul_f32 v37, v37, v40
    v_mul_f32 v38, v38, v40
    v_mul_f32 v39, v39, v40
    v_cvt_pk_bf16_f32 v8, v20, v21
    v_cvt_pk_bf16_f32 v9, v22, v23
    v_cvt_pk_bf16_f32 v10, v24, v25
    v_cvt_pk_bf16_f32 v11, v26, v27
    v_cvt_pk_bf16_f32 v12, v28, v29
    v_cvt_pk_bf16_f32 v13, v30, v31
    v_cvt_pk_bf16_f32 v14, v32, v33
    v_cvt_pk_bf16_f32 v15, v34, v35
    v_cvt_pk_bf16_f32 v16, v36, v37
    v_cvt_pk_bf16_f32 v17, v38, v39
    s_mov_b32 s64, 16777216
    buffer_store_dwordx4 v[8:11], v5, s[4:7], s64 offen sc1
    buffer_store_dwordx4 v[12:15], v5, s[4:7], s64 offen offset:512 sc1
    buffer_store_dwordx2 v[16:17], v6, s[4:7], s64 offen offset:1024 sc1
    s_lshr_b32 s68, s58, 2
    s_and_b32 s69, s58, 3
    s_lshl_b32 s63, s58, 5
    s_add_u32 s63, s63, s59
    s_lshl_b32 s63, s63, 2
    s_add_u32 s63, s63, s60
    s_lshl_b32 s63, s63, 7
    s_add_u32 s63, s63, 8388608
    s_add_u32 s3, s63, 131072
    s_mov_b32 s62, 0
    s_cmp_eq_u32 s68, 0
    s_cbranch_scc1 Lnowarm_1
    s_waitcnt vmcnt(0)
    s_barrier
    s_cmp_lg_u32 s60, 0
    s_cbranch_scc1 Lcnt_2
    s_mov_b64 exec, 1
    v_mov_b32 v2, 1
    buffer_atomic_add v2, off, s[8:11], 0 offset:4 sc0
    v_mov_b32 v3, 0x80000000
    s_waitcnt vmcnt(0)
    v_cmp_ne_u32 vcc, 255, v2
    s_nop 1
    v_cndmask_b32 v3, 4, v3, vcc
    buffer_store_dword v2, v3, s[8:11], 0 offen offset:128 sc1
    s_mov_b64 exec, -1
Lcnt_2:
    s_lshl_b32 s64, s60, 5
    s_add_u32 s64, s64, s59
    s_lshr_b32 s64, s64, 3
    s_cmp_lg_u32 s64, 3
    s_cbranch_scc1 Lnoprobe_4
    s_lshl_b32 s64, s69, 3
    s_and_b32 s65, s59, 7
    s_add_u32 s64, s64, s65
    s_lshl_b32 s64, s64, 7
    s_add_u32 s64, s64, 14860288
    s_add_u32 s66, s64, 131072
    v_lshlrev_b32 v3, 4, v0
    s_mov_b64 exec, 0xff
    s_mov_b32 s70, -1
    s_mov_b32 s71, -1
Lprobe_3:
    buffer_store_dwordx4 v[8:11], v3, s[4:7], s64 offen sc1
    s_mov_b32 s0, 0
Lprobe_3w:
    s_add_u32 s0, s0, 1
    s_sub_u32 s61, s61, 1
    s_cbranch_scc1 L_fail
    s_getreg_b32 s65, hwreg(HW_REG_IB_STS, 0, 4)
    s_cmp_lg_u32 s65, 0
    s_cbranch_scc1 Lprobe_3w
    s_waitcnt vmcnt(0)
    s_bitcmp1_b32 s64, 13
    s_cselect_b32 s65, -1, s0
    s_cselect_b32 s0, s0, -1
    s_min_u32 s70, s70, s65
    s_min_u32 s71, s71, s0
    s_add_u32 s64, s64, 0x1000
    s_or_b32 s64, s64, 0xc000
    s_cmp_lt_u32 s64, s66
    s_cbranch_scc1 Lprobe_3
    s_cmp_gt_u32 s70, s71
    s_cselect_b32 s65, 65, 64
    s_mov_b64 exec, 1
    v_mov_b32 v2, s65
    buffer_atomic_add v2, off, s[8:11], 0 offset:72 sc0
    s_waitcnt vmcnt(0)
    v_add_u32 v2, s65, v2
    v_subrev_u32 v2, 2047, v2
    v_mov_b32 v3, 0x80000000
    v_cmp_lt_i32 vcc, 0, v2
    s_nop 1
    v_cndmask_b32 v3, v3, 0, vcc
    buffer_store_dword v2, v3, s[8:11], 0 offen offset:140 sc1
    s_mov_b64 exec, -1
Lnoprobe_4:
    s_cmp_lg_u32 s60, 0
    s_cbranch_scc1 Lgskip_7
    buffer_load_dword v2, off, s[8:11], 0 offset:136 sc1
Lgchk_5:
    s_waitcnt vmcnt(0)
    v_cmp_eq_u32 vcc, 0, v2
    s_cbranch_vccnz Lgrty_6
Lgskip_7:
    s_waitcnt lgkmcnt(0)
    s_barrier
Lnowarm_1:
    s_cmp_lt_u32 s59, 24
    s_cbranch_scc1 L_roleC
    s_cmp_lt_u32 s59, 28
    s_cbranch_scc1 L_roleT
    s_cmp_lt_u32 s59, 30
    s_cbranch_scc1 L_roleB
    s_cmp_lt_u32 s59, 32
    s_cbranch_scc1 L_roleR
    s_mov_b32 s67, 2
L_fail:
    s_mov_b64 exec, 1
    s_lshl_b32 s67, s67, 8
    s_add_u32 s67, s67, s59
    s_lshl_b32 s67, s67, 8
    s_add_u32 s67, s67, s58
    s_lshl_b32 s67, s67, 8
    s_add_u32 s67, s67, s62
    s_waitcnt vmcnt(0)
    v_mov_b32 v2, s67
    buffer_store_dword v2, off, s[8:11], 0 offset:40
L_end:
    s_endpgm
L_roleC:
    s_mov_b32 s12, s36
    s_mov_b32 s13, s37
    s_mov_b32 s14, 7864320
    s_mov_b32 s15, 0x20000
    s_mov_b32 s16, s38
    s_mov_b32 s17, s39
    s_mov_b32 s18, 7864320
    s_mov_b32 s19, 0x20000
    s_mov_b32 s20, s40
    s_mov_b32 s21, s41
    s_mov_b32 s22, 7864320
    s_mov_b32 s23, 0x20000
    s_mov_b32 s24, s42
    s_mov_b32 s25, s43
    s_mov_b32 s26, 7864320
    s_mov_b32 s27, 0x20000
    s_mov_b32 s28, s34
    s_mov_b32 s29, s35
    s_mov_b32 s30, 10240
    s_mov_b32 s31, 0x20000
    v_and_b32 v1, 63, v0
    s_mul_i32 s64, s69, 3072
    s_lshl_b32 s65, s59, 7
    s_add_u32 s64, s64, s65
    s_mul_i32 s65, s60, 98304
    s_add_u32 s64, s64, s65
    v_lshrrev_b32 v192, 3, v1
    v_mul_u32_u24 v192, 12288, v192
    v_and_b32 v193, 7, v1
    v_lshl_add_u32 v192, v193, 4, v192
    v_add_u32 v192, s64, v192
    s_lshl_b32 s82, s60, 10
    s_lshl_b32 s64, s69, 2
    s_add_u32 s64, s64, s60
    s_mul_i32 s64, s64, 491520
    s_lshl_b32 s65, s59, 6
    s_add_u32 s64, s64, s65
    s_cmp_lt_u32 s59, 20
    s_cselect_b32 s64, s64, 0x80000000
    v_lshrrev_b32 v195, 2, v1
    v_mul_u32_u24 v195, 1280, v195
    v_and_b32 v196, 3, v1
    v_lshl_add_u32 v195, v196, 4, v195
    v_add_u32 v195, s64, v195
    s_lshl_b32 s83, s60, 12
    s_add_u32 m0, s83, 0
    s_mov_b32 s65, 0
    buffer_load_dwordx4 v195, s[24:27], s65 offen lds
    s_add_u32 m0, s83, 1024
    s_mov_b32 s65, 20480
    buffer_load_dwordx4 v195, s[24:27], s65 offen lds
    s_add_u32 m0, s83, 2048
    s_mov_b32 s65, 40960
    buffer_load_dwordx4 v195, s[24:27], s65 offen lds
    s_add_u32 m0, s83, 3072
    s_mov_b32 s65, 61440
    buffer_load_dwordx4 v195, s[24:27], s65 offen lds
    s_add_u32 m0, s83, 16384
    s_mov_b32 s65, 81920
    buffer_load_dwordx4 v195, s[24:27], s65 offen lds
    s_add_u32 m0, s83, 17408
    s_mov_b32 s65, 102400
    buffer_load_dwordx4 v195, s[24:27], s65 offen lds
    s_add_u32 m0, s83, 18432
    s_mov_b32 s65, 122880
    buffer_load_dwordx4 v195, s[24:27], s65 offen lds
    s_add_u32 m0, s83, 19456
    s_mov_b32 s65, 143360
    buffer_load_dwordx4 v195, s[24:27], s65 offen lds
    s_add_u32 m0, s83, 32768
    s_mov_b32 s65, 163840
    buffer_load_dwordx4 v195, s[24:27], s65 offen lds
    s_add_u32 m0, s83, 33792
    s_mov_b32 s65, 184320
    buffer_load_dwordx4 v195, s[24:27], s65 offen lds
    s_add_u32 m0, s83, 34816
    s_mov_b32 s65, 204800
    buffer_load_dwordx4 v195, s[24:27], s65 offen lds
    s_add_u32 m0, s83, 35840
    s_mov_b32 s65, 225280
    buffer_load_dwordx4 v195, s[24:27], s65 offen lds
    s_add_u32 m0, s83, 49152
    s_mov_b32 s65, 245760
    buffer_load_dwordx4 v195, s[24:27], s65 offen lds
    s_add_u32 m0, s83, 50176
    s_mov_b32 s65, 266240
    buffer_load_dwordx4 v195, s[24:27], s65 offen lds
    s_add_u32 m0, s83, 51200
    s_mov_b32 s65, 286720
    buffer_load_dwordx4 v195, s[24:27], s65 offen lds
    s_add_u32 m0, s83, 52224
    s_mov_b32 s65, 307200
    buffer_load_dwordx4 v195, s[24:27], s65 offen lds
    v_and_b32 v84, 7, v1
    v_bfe_u32 v85, v1, 3, 1
    v_lshrrev_b32 v86, 4, v1
    v_and_b32 v87, 15, v1
    v_lshlrev_b32 v235, 4, v0
    v_lshlrev_b32 v236, 3, v0
    v_add_u32 v236, 8192, v236
    v_lshlrev_b32 v237, 4, v1
    v_lshlrev_b32 v241, 3, v1
    v_lshlrev_b32 v238, 2, v1
    s_add_u32 s64, s60, 1
    s_mul_i32 s64, s64, 1280
    v_add_u32 v239, s64, v237
    v_add_u32 v240, s64, v238
    v_cmp_eq_u32 s[98:99], 1, v85
    v_cmp_lt_u32 s[100:101], 1, v86
    v_mov_b32 v88, 0x4444
    v_mov_b32 v89, 0xeeee
    v_cndmask_b32 v225, v88, v89, s[98:99]
    v_mov_b32 v88, 0xffff
    v_mov_b32 v89, 0xffff0000
    v_cndmask_b32 v231, v88, v89, s[98:99]
    v_lshrrev_b32 v88, 3, v0
    v_mul_u32_u24 v232, 1280, v88
    v_and_b32 v88, 7, v88
    v_xor_b32 v88, v88, v84
    v_lshl_add_u32 v232, v88, 4, v232
    v_mul_u32_u24 v233, 10240, v85
    v_lshl_add_u32 v233, v84, 7, v233
    v_xor_b32 v88, v86, v84
    v_lshl_add_u32 v233, v88, 4, v233
    v_add_u32 v233, 32768, v233
    v_xor_b32 v234, 64, v233
    v_lshrrev_b32 v88, 5, v1
    v_and_b32 v89, 1, v86
    v_lshlrev_b32 v90, 4, v87
    v_lshl_add_u32 v90, v89, 3, v90
    v_lshl_add_u32 v242, v88, 10, v90
    s_lshl_b32 s64, s60, 8
    v_add_u32 v242, s64, v242
    v_lshl_add_u32 v244, v88, 8, v90
    s_lshl_b32 s64, s60, 9
    v_add_u32 v244, s64, v244
    v_mul_u32_u24 v253, 24576, v88
    v_and_b32 v90, 31, v1
    v_lshl_add_u32 v253, v90, 4, v253
    v_add_u32 v253, s64, v253
    v_lshlrev_b32 v250, 9, v89
    v_lshl_add_u32 v250, v88, 6, v250
    v_bfe_u32 v90, v1, 1, 1
    v_lshl_add_u32 v250, v90, 5, v250
    v_bfe_u32 v90, v1, 2, 2
    v_lshl_add_u32 v250, v90, 3, v250
    v_and_b32 v89, 1, v1
    v_lshl_add_u32 v250, v89, 2, v250
    s_lshl_b32 s64, s60, 10
    s_add_u32 s64, s64, 18432
    v_add_u32 v250, s64, v250
    v_lshl_add_u32 v243, v86, 3, v90
    v_lshlrev_b32 v243, 4, v243
    v_lshl_add_u32 v243, v89, 3, v243
    v_bfe_u32 v88, v1, 1, 2
    v_lshlrev_b32 v251, 7, v88
    v_lshrrev_b32 v88, 3, v1
    v_lshl_add_u32 v251, v88, 4, v251
    v_lshl_add_u32 v251, v89, 3, v251
    s_lshl_b32 s64, s59, 9
    s_add_u32 s64, s64, 178176
    v_add_u32 v251, s64, v251
    s_lshl_b32 s66, s59, 10
    s_and_b32 s64, s66, 0x6000
    s_add_u32 s64, s64, s66
    s_lshl_b32 s65, s68, 20
    s_add_u32 s64, s64, s65
    s_add_u32 s64, s64, 14680064
    v_add_u32 v252, s64, v237
    s_and_b32 s64, s60, 1
    s_lshl_b32 s64, s64, 3
    s_lshr_b32 s65, s60, 1
    v_lshl_add_u32 v89, v86, 4, v84
    v_add_u32 v89, s64, v89
    s_lshl_b32 s64, s65, 11
    v_lshl_add_u32 v245, v89, 4, s64
    s_mul_i32 s64, s65, 1536
    v_lshlrev_b32 v247, 4, v89
    v_lshlrev_b32 v246, 3, v89
    v_add_u32 v246, 1024, v246
    v_cndmask_b32 v246, v247, v246, s[98:99]
    v_add_u32 v246, s64, v246
    v_lshl_add_u32 v247, v85, 1, v247
    v_add_u32 v247, s64, v247
    s_lshl_b32 s64, s60, 8
    s_add_u32 s64, s64, s66
    s_add_u32 s64, s64, 153600
    v_lshlrev_b32 v88, 5, v84
    v_lshl_add_u32 v248, v86, 3, v88
    v_add_u32 v248, s64, v248
    v_mov_b32 v89, 0x80000000
    v_cndmask_b32 v248, v248, v89, s[98:99]
    v_lshl_add_u32 v249, v86, 8, v88
    v_lshl_add_u32 v249, v85, 4, v249
    s_mul_i32 s64, s60, 6144
    s_add_u32 s64, s64, 153600
    v_add_u32 v249, s64, v249
    s_lshl_b32 s64, s59, 2
    s_add_u32 s64, s64, s60
    s_sub_u32 s64, s64, 80
    s_mul_i32 s64, s64, 2560
    v_add_u32 v89, s64, v237
    s_cmp_lt_u32 s59, 20
    s_cselect_b64 vcc, -1, 0
    v_cndmask_b32 v249, v89, v249, vcc
    s_cmp_ge_u32 s59, 12
    s_cselect_b32 s66, 24576, 0
    s_lshl_b32 s75, s59, 11
    s_add_u32 s75, s75, s66
    s_mul_i32 s66, s69, 98304
    s_add_u32 s75, s75, s66
    s_mul_i32 s66, s68, 25165824
    s_add_u32 s75, s75, s66
    s_add_u32 s75, s75, 41943040
    v_lshlrev_b32 v88, 2, v86
    v_lshl_add_u32 v88, v85, 4, v88
    s_lshl_b32 s66, s60, 3
    v_add_u32 v89, s66, v84
    v_cmp_gt_u32 s[90:91], v88, v89
    v_add_u32 v88, 1, v88
    v_cmp_gt_u32 s[92:93], v88, v89
    v_add_u32 v88, 1, v88
    v_cmp_gt_u32 s[94:95], v88, v89
    v_add_u32 v88, 1, v88
    v_cmp_gt_u32 s[96:97], v88, v89
    v_add_u32 v88, 1, v88
    v_bfe_u32 v88, v0, 4, 2
    v_lshlrev_b32 v88, 5, v88
    v_add_u32 v88, 31, v88
    v_and_b32 v254, 3, v0
    v_lshl_add_u32 v254, v88, 2, v254
    v_lshlrev_b32 v254, 7, v254
    v_add_u32 v254, 8388608, v254
    v_lshrrev_b32 v88, 2, v1
    v_and_b32 v88, 12, v88
    v_and_b32 v89, 3, v1
    v_add_u32 v88, v88, v89
    s_lshl_b32 s64, s58, 14
    s_add_u32 s64, s64, 8531968
    v_lshl_add_u32 v88, v88, 7, s64
    v_bfe_u32 v89, v1, 2, 1
    v_and_b32 v89, s68, v89
    v_cmp_eq_u32 vcc, 1, v89
    s_nop 1
    v_cndmask_b32 v254, v88, v254, vcc
    v_mov_b32 v88, -10
    v_cndmask_b32 v255, v88, 0, vcc
    v_mov_b32 v180, -1
    v_mov_b32 v184, 0x3f803f80
    v_mov_b32 v181, -1
    v_mov_b32 v185, 0x3f803f80
    v_mov_b32 v182, -1
    v_mov_b32 v186, 0x3f803f80
    v_mov_b32 v183, -1
    v_mov_b32 v187, 0x3f803f80
    v_mov_b32 v175, 0
    v_mov_b32 v179, 0
    v_mov_b32 v191, 0
    s_mov_b32 s70, 0x3dd53b95
    s_mov_b32 s71, 0xd04e79ff
    s_mul_i32 s73, s60, 10240
    s_add_u32 s73, s73, 32768
    s_mul_i32 s74, s68, 2621440
    s_add_u32 s74, s74, 16777216
    s_mul_i32 s64, s59, 43
    s_lshr_b32 s64, s64, 7
    s_mul_i32 s64, s64, 3
    s_add_u32 s65, s64, 3
    s_add_u32 s77, s59, 1
    s_cmp_eq_u32 s77, s65
    s_cselect_b32 s77, s64, s77
    s_add_u32 s78, s77, 1
    s_cmp_eq_u32 s78, s65
    s_cselect_b32 s78, s64, s78
    s_mul_i32 s76, s59, 6400
    s_mul_i32 s77, s77, 6400
    s_mul_i32 s78, s78, 6400
    s_cmp_lg_u32 s68, 0
    s_cbranch_scc1 Larr0_8
    s_waitcnt vmcnt(16)
    s_barrier
    s_cmp_lg_u32 s60, 0
    s_cbranch_scc1 Lcnt_9
    s_mov_b64 exec, 1
    v_mov_b32 v2, 1
    buffer_atomic_add v2, off, s[8:11], 0 offset:4 sc0
    s_mov_b64 exec, -1
Lcnt_9:
Larr0_8:
    s_add_u32 m0, s83, 65536
    s_mov_b32 s65, 327680
    buffer_load_dwordx4 v195, s[24:27], s65 offen lds
    s_add_u32 m0, s83, 66560
    s_mov_b32 s65, 348160
    buffer_load_dwordx4 v195, s[24:27], s65 offen lds
    s_add_u32 m0, s83, 67584
    s_mov_b32 s65, 368640
    buffer_load_dwordx4 v195, s[24:27], s65 offen lds
    s_add_u32 m0, s83, 68608
    s_mov_b32 s65, 389120
    buffer_load_dwordx4 v195, s[24:27], s65 offen lds
    s_add_u32 m0, s83, 81920
    s_mov_b32 s65, 409600
    buffer_load_dwordx4 v195, s[24:27], s65 offen lds
    s_add_u32 m0, s83, 82944
    s_mov_b32 s65, 430080
    buffer_load_dwordx4 v195, s[24:27], s65 offen lds
    s_add_u32 m0, s83, 83968
    s_mov_b32 s65, 450560
    buffer_load_dwordx4 v195, s[24:27], s65 offen lds
    s_add_u32 m0, s83, 84992
    s_mov_b32 s65, 471040
    buffer_load_dwordx4 v195, s[24:27], s65 offen lds
    s_add_u32 m0, s82, 98304
    s_mov_b32 s65, 0
    buffer_load_dwordx4 v192, s[12:15], s65 offen nt lds
    s_add_u32 m0, s82, 102400
    s_mov_b32 s65, 393216
    buffer_load_dwordx4 v192, s[12:15], s65 offen nt lds
    s_add_u32 m0, s82, 106496
    s_mov_b32 s65, 786432
    buffer_load_dwordx4 v192, s[12:15], s65 offen nt lds
    s_add_u32 m0, s82, 110592
    s_mov_b32 s65, 1179648
    buffer_load_dwordx4 v192, s[12:15], s65 offen nt lds
    s_add_u32 m0, s82, 114688
    s_mov_b32 s65, 1572864
    buffer_load_dwordx4 v192, s[12:15], s65 offen nt lds
    s_add_u32 m0, s82, 118784
    s_mov_b32 s65, 1966080
    buffer_load_dwordx4 v192, s[12:15], s65 offen nt lds
    s_add_u32 m0, s82, 122880
    s_mov_b32 s65, 2359296
    buffer_load_dwordx4 v192, s[12:15], s65 offen nt lds
    s_add_u32 m0, s82, 126976
    s_mov_b32 s65, 2752512
    buffer_load_dwordx4 v192, s[12:15], s65 offen nt lds
    s_add_u32 m0, s82, 131072
    s_mov_b32 s65, 3145728
    buffer_load_dwordx4 v192, s[12:15], s65 offen nt lds
    s_add_u32 m0, s82, 135168
    s_mov_b32 s65, 3538944
    buffer_load_dwordx4 v192, s[12:15], s65 offen nt lds
    s_add_u32 m0, s82, 139264
    s_mov_b32 s65, 3932160
    buffer_load_dwordx4 v192, s[12:15], s65 offen nt lds
    s_add_u32 m0, s82, 143360
    s_mov_b32 s65, 4325376
    buffer_load_dwordx4 v192, s[12:15], s65 offen nt lds
    v_bfe_u32 v194, v1, 2, 2
    v_lshl_add_u32 v193, v86, 3, v194
    v_lshlrev_b32 v193, 7, v193
    v_lshl_add_u32 v193, v196, 3, v193
    s_lshl_b32 s64, s60, 5
    v_add_u32 v193, s64, v193
    v_lshrrev_b32 v197, 5, v1
    v_lshlrev_b32 v197, 4, v197
    v_lshl_add_u32 v197, v85, 3, v197
    v_and_b32 v88, 1, v86
    v_lshl_add_u32 v197, v88, 2, v197
    v_bfe_u32 v88, v1, 2, 1
    v_add_u32 v197, v197, v88
    v_lshlrev_b32 v197, 6, v197
    v_lshl_add_u32 v197, v196, 3, v197
    v_add_u32 v197, s83, v197
    s_waitcnt vmcnt(32)
    s_waitcnt lgkmcnt(0)
    s_barrier
    s_add_u32 m0, s82, 147456
    s_mov_b32 s65, 4718592
    buffer_load_dwordx4 v192, s[12:15], s65 offen nt lds
    s_add_u32 m0, s82, 151552
    s_mov_b32 s65, 5111808
    buffer_load_dwordx4 v192, s[12:15], s65 offen nt lds
    s_add_u32 m0, s82, 155648
    s_mov_b32 s65, 5505024
    buffer_load_dwordx4 v192, s[12:15], s65 offen nt lds
    s_add_u32 m0, s82, 159744
    s_mov_b32 s65, 5898240
    buffer_load_dwordx4 v192, s[12:15], s65 offen nt lds
    v_add_u32 v194, 0, v197
    ds_read_b64_tr_b16 a[240:241], v194 offset:0
    ds_read_b64_tr_b16 a[242:243], v194 offset:128
    ds_read_b64_tr_b16 a[244:245], v194 offset:2048
    ds_read_b64_tr_b16 a[246:247], v194 offset:2176
    ds_read_b64_tr_b16 a[248:249], v194 offset:32
    ds_read_b64_tr_b16 a[250:251], v194 offset:160
    ds_read_b64_tr_b16 a[252:253], v194 offset:2080
    ds_read_b64_tr_b16 a[254:255], v194 offset:2208
    s_waitcnt vmcnt(32)
    s_waitcnt lgkmcnt(0)
    s_barrier
    s_add_u32 m0, s82, 0
    s_mov_b32 s65, 6291456
    buffer_load_dwordx4 v192, s[12:15], s65 offen nt lds
    s_add_u32 m0, s82, 4096
    s_mov_b32 s65, 6684672
    buffer_load_dwordx4 v192, s[12:15], s65 offen nt lds
    s_add_u32 m0, s82, 8192
    s_mov_b32 s65, 7077888
    buffer_load_dwordx4 v192, s[12:15], s65 offen nt lds
    s_add_u32 m0, s82, 12288
    s_mov_b32 s65, 7471104
    buffer_load_dwordx4 v192, s[12:15], s65 offen nt lds
    v_add_u32 v194, 16384, v197
    ds_read_b64_tr_b16 v[4:5], v194 offset:0
    ds_read_b64_tr_b16 v[6:7], v194 offset:128
    ds_read_b64_tr_b16 v[8:9], v194 offset:2048
    ds_read_b64_tr_b16 v[10:11], v194 offset:2176
    ds_read_b64_tr_b16 v[12:13], v194 offset:32
    ds_read_b64_tr_b16 v[14:15], v194 offset:160
    ds_read_b64_tr_b16 v[16:17], v194 offset:2080
    ds_read_b64_tr_b16 v[18:19], v194 offset:2208
    s_waitcnt vmcnt(32)
    s_waitcnt lgkmcnt(0)
    s_barrier
    s_add_u32 m0, s82, 16384
    s_mov_b32 s65, 0
    buffer_load_dwordx4 v192, s[16:19], s65 offen nt lds
    s_add_u32 m0, s82, 20480
    s_mov_b32 s65, 393216
    buffer_load_dwordx4 v192, s[16:19], s65 offen nt lds
    s_add_u32 m0, s82, 24576
    s_mov_b32 s65, 786432
    buffer_load_dwordx4 v192, s[16:19], s65 offen nt lds
    s_add_u32 m0, s82, 28672
    s_mov_b32 s65, 1179648
    buffer_load_dwordx4 v192, s[16:19], s65 offen nt lds
    v_add_u32 v194, 32768, v197
    ds_read_b64_tr_b16 v[20:21], v194 offset:0
    ds_read_b64_tr_b16 v[22:23], v194 offset:128
    ds_read_b64_tr_b16 v[24:25], v194 offset:2048
    ds_read_b64_tr_b16 v[26:27], v194 offset:2176
    ds_read_b64_tr_b16 v[28:29], v194 offset:32
    ds_read_b64_tr_b16 v[30:31], v194 offset:160
    ds_read_b64_tr_b16 v[32:33], v194 offset:2080
    ds_read_b64_tr_b16 v[34:35], v194 offset:2208
    s_waitcnt vmcnt(32)
    s_waitcnt lgkmcnt(0)
    s_barrier
    s_add_u32 m0, s82, 32768
    s_mov_b32 s65, 1572864
    buffer_load_dwordx4 v192, s[16:19], s65 offen nt lds
    s_add_u32 m0, s82, 36864
    s_mov_b32 s65, 1966080
    buffer_load_dwordx4 v192, s[16:19], s65 offen nt lds
    s_add_u32 m0, s82, 40960
    s_mov_b32 s65, 2359296
    buffer_load_dwordx4 v192, s[16:19], s65 offen nt lds
    s_add_u32 m0, s82, 45056
    s_mov_b32 s65, 2752512
    buffer_load_dwordx4 v192, s[16:19], s65 offen nt lds
    v_add_u32 v194, 49152, v197
    ds_read_b64_tr_b16 v[36:37], v194 offset:0
    ds_read_b64_tr_b16 v[38:39], v194 offset:128
    ds_read_b64_tr_b16 v[40:41], v194 offset:2048
    ds_read_b64_tr_b16 v[42:43], v194 offset:2176
    ds_read_b64_tr_b16 v[44:45], v194 offset:32
    ds_read_b64_tr_b16 v[46:47], v194 offset:160
    ds_read_b64_tr_b16 v[48:49], v194 offset:2080
    ds_read_b64_tr_b16 v[50:51], v194 offset:2208
    s_waitcnt vmcnt(32)
    s_waitcnt lgkmcnt(0)
    s_barrier
    s_add_u32 m0, s82, 49152
    s_mov_b32 s65, 3145728
    buffer_load_dwordx4 v192, s[16:19], s65 offen nt lds
    s_add_u32 m0, s82, 53248
    s_mov_b32 s65, 3538944
    buffer_load_dwordx4 v192, s[16:19], s65 offen nt lds
    s_add_u32 m0, s82, 57344
    s_mov_b32 s65, 3932160
    buffer_load_dwordx4 v192, s[16:19], s65 offen nt lds
    s_add_u32 m0, s82, 61440
    s_mov_b32 s65, 4325376
    buffer_load_dwordx4 v192, s[16:19], s65 offen nt lds
    s_cmp_lg_u32 s68, 0
    s_cbranch_scc1 Larr0_10
    s_cmp_lg_u32 s60, 0
    s_cbranch_scc1 Lcnt_11
    s_mov_b64 exec, 1
    v_mov_b32 v3, 0x80000000
    v_cmp_ne_u32 vcc, 255, v2
    s_nop 1
    v_cndmask_b32 v3, 4, v3, vcc
    buffer_store_dword v2, v3, s[8:11], 0 offen offset:128 sc1
    s_mov_b64 exec, -1
Lcnt_11:
Larr0_10:
    v_add_u32 v194, 65536, v197
    ds_read_b64_tr_b16 v[52:53], v194 offset:0
    ds_read_b64_tr_b16 v[54:55], v194 offset:128
    ds_read_b64_tr_b16 v[56:57], v194 offset:2048
    ds_read_b64_tr_b16 v[58:59], v194 offset:2176
    ds_read_b64_tr_b16 v[60:61], v194 offset:32
    ds_read_b64_tr_b16 v[62:63], v194 offset:160
    ds_read_b64_tr_b16 v[64:65], v194 offset:2080
    ds_read_b64_tr_b16 v[66:67], v194 offset:2208
    s_waitcnt vmcnt(32)
    s_waitcnt lgkmcnt(0)
    s_barrier
    s_add_u32 m0, s82, 65536
    s_mov_b32 s65, 4718592
    buffer_load_dwordx4 v192, s[16:19], s65 offen nt lds
    s_add_u32 m0, s82, 69632
    s_mov_b32 s65, 5111808
    buffer_load_dwordx4 v192, s[16:19], s65 offen nt lds
    s_add_u32 m0, s82, 73728
    s_mov_b32 s65, 5505024
    buffer_load_dwordx4 v192, s[16:19], s65 offen nt lds
    s_add_u32 m0, s82, 77824
    s_mov_b32 s65, 5898240
    buffer_load_dwordx4 v192, s[16:19], s65 offen nt lds
    v_add_u32 v194, 81920, v197
    ds_read_b64_tr_b16 v[68:69], v194 offset:0
    ds_read_b64_tr_b16 v[70:71], v194 offset:128
    ds_read_b64_tr_b16 v[72:73], v194 offset:2048
    ds_read_b64_tr_b16 v[74:75], v194 offset:2176
    ds_read_b64_tr_b16 v[76:77], v194 offset:32
    ds_read_b64_tr_b16 v[78:79], v194 offset:160
    ds_read_b64_tr_b16 v[80:81], v194 offset:2080
    ds_read_b64_tr_b16 v[82:83], v194 offset:2208
    s_waitcnt vmcnt(32)
    s_waitcnt lgkmcnt(0)
    s_barrier
    s_add_u32 m0, s82, 81920
    s_mov_b32 s65, 6291456
    buffer_load_dwordx4 v192, s[16:19], s65 offen nt lds
    s_add_u32 m0, s82, 86016
    s_mov_b32 s65, 6684672
    buffer_load_dwordx4 v192, s[16:19], s65 offen nt lds
    s_add_u32 m0, s82, 90112
    s_mov_b32 s65, 7077888
    buffer_load_dwordx4 v192, s[16:19], s65 offen nt lds
    s_add_u32 m0, s82, 94208
    s_mov_b32 s65, 7471104
    buffer_load_dwordx4 v192, s[16:19], s65 offen nt lds
    v_add_u32 v194, 98304, v193
    ds_read_b64_tr_b16 a[0:1], v194 offset:0
    ds_read_b64_tr_b16 a[2:3], v194 offset:512
    ds_read_b64_tr_b16 a[4:5], v194 offset:4096
    ds_read_b64_tr_b16 a[6:7], v194 offset:4608
    ds_read_b64_tr_b16 a[8:9], v194 offset:8192
    ds_read_b64_tr_b16 a[10:11], v194 offset:8704
    ds_read_b64_tr_b16 a[12:13], v194 offset:12288
    ds_read_b64_tr_b16 a[14:15], v194 offset:12800
    s_waitcnt vmcnt(32)
    s_waitcnt lgkmcnt(0)
    s_barrier
    s_add_u32 m0, s82, 98304
    s_mov_b32 s65, 0
    buffer_load_dwordx4 v192, s[20:23], s65 offen nt lds
    s_add_u32 m0, s82, 102400
    s_mov_b32 s65, 393216
    buffer_load_dwordx4 v192, s[20:23], s65 offen nt lds
    s_add_u32 m0, s82, 106496
    s_mov_b32 s65, 786432
    buffer_load_dwordx4 v192, s[20:23], s65 offen nt lds
    s_add_u32 m0, s82, 110592
    s_mov_b32 s65, 1179648
    buffer_load_dwordx4 v192, s[20:23], s65 offen nt lds
    buffer_load_dword v218, off, s[8:11], 0 offset:132 sc1
    v_add_u32 v194, 114688, v193
    ds_read_b64_tr_b16 a[16:17], v194 offset:0
    ds_read_b64_tr_b16 a[18:19], v194 offset:512
    ds_read_b64_tr_b16 a[20:21], v194 offset:4096
    ds_read_b64_tr_b16 a[22:23], v194 offset:4608
    ds_read_b64_tr_b16 a[24:25], v194 offset:8192
    ds_read_b64_tr_b16 a[26:27], v194 offset:8704
    ds_read_b64_tr_b16 a[28:29], v194 offset:12288
    ds_read_b64_tr_b16 a[30:31], v194 offset:12800
    s_waitcnt vmcnt(32)
    s_waitcnt lgkmcnt(0)
    s_barrier
    s_add_u32 m0, s82, 114688
    s_mov_b32 s65, 1572864
    buffer_load_dwordx4 v192, s[20:23], s65 offen nt lds
    s_add_u32 m0, s82, 118784
    s_mov_b32 s65, 1966080
    buffer_load_dwordx4 v192, s[20:23], s65 offen nt lds
    s_add_u32 m0, s82, 122880
    s_mov_b32 s65, 2359296
    buffer_load_dwordx4 v192, s[20:23], s65 offen nt lds
    s_add_u32 m0, s82, 126976
    s_mov_b32 s65, 2752512
    buffer_load_dwordx4 v192, s[20:23], s65 offen nt lds
    v_add_u32 v194, 131072, v193
    ds_read_b64_tr_b16 a[32:33], v194 offset:0
    ds_read_b64_tr_b16 a[34:35], v194 offset:512
    ds_read_b64_tr_b16 a[36:37], v194 offset:4096
    ds_read_b64_tr_b16 a[38:39], v194 offset:4608
    ds_read_b64_tr_b16 a[40:41], v194 offset:8192
    ds_read_b64_tr_b16 a[42:43], v194 offset:8704
    ds_read_b64_tr_b16 a[44:45], v194 offset:12288
    ds_read_b64_tr_b16 a[46:47], v194 offset:12800
    s_waitcnt vmcnt(32)
    s_waitcnt lgkmcnt(0)
    s_barrier
    s_add_u32 m0, s82, 131072
    s_mov_b32 s65, 3145728
    buffer_load_dwordx4 v192, s[20:23], s65 offen nt lds
    s_add_u32 m0, s82, 135168
    s_mov_b32 s65, 3538944
    buffer_load_dwordx4 v192, s[20:23], s65 offen nt lds
    s_add_u32 m0, s82, 139264
    s_mov_b32 s65, 3932160
    buffer_load_dwordx4 v192, s[20:23], s65 offen nt lds
    s_add_u32 m0, s82, 143360
    s_mov_b32 s65, 4325376
    buffer_load_dwordx4 v192, s[20:23], s65 offen nt lds
    v_add_u32 v194, 147456, v193
    ds_read_b64_tr_b16 a[48:49], v194 offset:0
    ds_read_b64_tr_b16 a[50:51], v194 offset:512
    ds_read_b64_tr_b16 a[52:53], v194 offset:4096
    ds_read_b64_tr_b16 a[54:55], v194 offset:4608
    ds_read_b64_tr_b16 a[56:57], v194 offset:8192
    ds_read_b64_tr_b16 a[58:59], v194 offset:8704
    ds_read_b64_tr_b16 a[60:61], v194 offset:12288
    ds_read_b64_tr_b16 a[62:63], v194 offset:12800
    s_waitcnt vmcnt(32)
    s_waitcnt lgkmcnt(0)
    s_barrier
    s_add_u32 m0, s82, 147456
    s_mov_b32 s65, 4718592
    buffer_load_dwordx4 v192, s[20:23], s65 offen nt lds
    s_add_u32 m0, s82, 151552
    s_mov_b32 s65, 5111808
    buffer_load_dwordx4 v192, s[20:23], s65 offen nt lds
    s_add_u32 m0, s82, 155648
    s_mov_b32 s65, 5505024
    buffer_load_dwordx4 v192, s[20:23], s65 offen nt lds
    s_add_u32 m0, s82, 159744
    s_mov_b32 s65, 5898240
    buffer_load_dwordx4 v192, s[20:23], s65 offen nt lds
    v_add_u32 v194, 0, v193
    ds_read_b64_tr_b16 a[64:65], v194 offset:0
    ds_read_b64_tr_b16 a[66:67], v194 offset:512
    ds_read_b64_tr_b16 a[68:69], v194 offset:4096
    ds_read_b64_tr_b16 a[70:71], v194 offset:4608
    ds_read_b64_tr_b16 a[72:73], v194 offset:8192
    ds_read_b64_tr_b16 a[74:75], v194 offset:8704
    ds_read_b64_tr_b16 a[76:77], v194 offset:12288
    ds_read_b64_tr_b16 a[78:79], v194 offset:12800
    s_waitcnt vmcnt(32)
    s_waitcnt lgkmcnt(0)
    s_barrier
    s_add_u32 m0, s82, 0
    s_mov_b32 s65, 6291456
    buffer_load_dwordx4 v192, s[20:23], s65 offen nt lds
    s_add_u32 m0, s82, 4096
    s_mov_b32 s65, 6684672
    buffer_load_dwordx4 v192, s[20:23], s65 offen nt lds
    s_add_u32 m0, s82, 8192
    s_mov_b32 s65, 7077888
    buffer_load_dwordx4 v192, s[20:23], s65 offen nt lds
    s_add_u32 m0, s82, 12288
    s_mov_b32 s65, 7471104
    buffer_load_dwordx4 v192, s[20:23], s65 offen nt lds
    v_add_u32 v194, 16384, v193
    ds_read_b64_tr_b16 a[80:81], v194 offset:0
    ds_read_b64_tr_b16 a[82:83], v194 offset:512
    ds_read_b64_tr_b16 a[84:85], v194 offset:4096
    ds_read_b64_tr_b16 a[86:87], v194 offset:4608
    ds_read_b64_tr_b16 a[88:89], v194 offset:8192
    ds_read_b64_tr_b16 a[90:91], v194 offset:8704
    ds_read_b64_tr_b16 a[92:93], v194 offset:12288
    ds_read_b64_tr_b16 a[94:95], v194 offset:12800
    s_waitcnt vmcnt(32)
    s_waitcnt lgkmcnt(0)
    s_barrier
    v_add_u32 v194, 32768, v193
    ds_read_b64_tr_b16 a[96:97], v194 offset:0
    ds_read_b64_tr_b16 a[98:99], v194 offset:512
    ds_read_b64_tr_b16 a[100:101], v194 offset:4096
    ds_read_b64_tr_b16 a[102:103], v194 offset:4608
    ds_read_b64_tr_b16 a[104:105], v194 offset:8192
    ds_read_b64_tr_b16 a[106:107], v194 offset:8704
    ds_read_b64_tr_b16 a[108:109], v194 offset:12288
    ds_read_b64_tr_b16 a[110:111], v194 offset:12800
    s_waitcnt vmcnt(28)
    s_waitcnt lgkmcnt(0)
    s_barrier
    v_add_u32 v194, 49152, v193
    ds_read_b64_tr_b16 a[112:113], v194 offset:0
    ds_read_b64_tr_b16 a[114:115], v194 offset:512
    ds_read_b64_tr_b16 a[116:117], v194 offset:4096
    ds_read_b64_tr_b16 a[118:119], v194 offset:4608
    ds_read_b64_tr_b16 a[120:121], v194 offset:8192
    ds_read_b64_tr_b16 a[122:123], v194 offset:8704
    ds_read_b64_tr_b16 a[124:125], v194 offset:12288
    ds_read_b64_tr_b16 a[126:127], v194 offset:12800
    s_waitcnt vmcnt(24)
    s_waitcnt lgkmcnt(0)
    s_barrier
    v_add_u32 v194, 65536, v193
    ds_read_b64_tr_b16 a[128:129], v194 offset:0
    ds_read_b64_tr_b16 a[130:131], v194 offset:512
    ds_read_b64_tr_b16 a[132:133], v194 offset:4096
    ds_read_b64_tr_b16 a[134:135], v194 offset:4608
    ds_read_b64_tr_b16 a[136:137], v194 offset:8192
    ds_read_b64_tr_b16 a[138:139], v194 offset:8704
    ds_read_b64_tr_b16 a[140:141], v194 offset:12288
    ds_read_b64_tr_b16 a[142:143], v194 offset:12800
Lgchk_12:
    s_waitcnt vmcnt(16)
    v_cmp_eq_u32 vcc, 0, v218
    s_cbranch_vccnz Lgrty_13
    s_waitcnt vmcnt(20)
    s_waitcnt lgkmcnt(0)
    s_barrier
    v_mul_u32_u24 v198, 1280, v84
    v_lshrrev_b32 v199, 4, v0
    v_lshl_add_u32 v198, v199, 5, v198
    v_lshl_add_u32 v198, v85, 2, v198
    buffer_load_dword v200, v198, s[28:31], 0 offen offset:0
    buffer_load_dword v201, v198, s[28:31], 0 offen offset:8
    buffer_load_dword v202, v198, s[28:31], 0 offen offset:16
    buffer_load_dword v203, v198, s[28:31], 0 offen offset:24
    buffer_load_dword v204, v198, s[28:31], 0 offen offset:512
    buffer_load_dword v205, v198, s[28:31], 0 offen offset:520
    buffer_load_dword v206, v198, s[28:31], 0 offen offset:528
    buffer_load_dword v207, v198, s[28:31], 0 offen offset:536
    buffer_load_dword v208, v198, s[28:31], 0 offen offset:1024
    buffer_load_dword v209, v198, s[28:31], 0 offen offset:1032
    buffer_load_dword v210, v198, s[28:31], 0 offen offset:1040
    buffer_load_dword v211, v198, s[28:31], 0 offen offset:1048
    s_cmp_eq_u32 s68, 0
    s_cbranch_scc1 Lt0_14
    s_waitcnt vmcnt(0)
    s_branch Lt0_15
Lt0_14:
    s_add_u32 m0, s73, 0
    s_nop 0
    buffer_load_dwordx4 v232, s[4:7], s74 offen offset:0 sc1 lds
    s_add_u32 m0, s73, 896
    s_nop 0
    buffer_load_dwordx4 v232, s[4:7], s74 offen offset:128 sc1 lds
    s_add_u32 m0, s73, 1792
    s_nop 0
    buffer_load_dwordx4 v232, s[4:7], s74 offen offset:256 sc1 lds
    s_add_u32 m0, s73, 2688
    s_nop 0
    buffer_load_dwordx4 v232, s[4:7], s74 offen offset:384 sc1 lds
    s_add_u32 m0, s73, 3584
    s_nop 0
    buffer_load_dwordx4 v232, s[4:7], s74 offen offset:512 sc1 lds
    s_add_u32 m0, s73, 4480
    s_nop 0
    buffer_load_dwordx4 v232, s[4:7], s74 offen offset:640 sc1 lds
    s_add_u32 m0, s73, 5376
    s_nop 0
    buffer_load_dwordx4 v232, s[4:7], s74 offen offset:768 sc1 lds
    s_add_u32 m0, s73, 6272
    s_nop 0
    buffer_load_dwordx4 v232, s[4:7], s74 offen offset:896 sc1 lds
    s_add_u32 m0, s73, 7168
    s_nop 0
    buffer_load_dwordx4 v232, s[4:7], s74 offen offset:1024 sc1 lds
    s_add_u32 m0, s73, 8064
    s_nop 0
    buffer_load_dwordx4 v232, s[4:7], s74 offen offset:1152 sc1 lds
Lt0_15:
    v_add_u32 v194, 81920, v193
    ds_read_b64_tr_b16 a[144:145], v194 offset:0
    ds_read_b64_tr_b16 a[146:147], v194 offset:512
    ds_read_b64_tr_b16 a[148:149], v194 offset:4096
    ds_read_b64_tr_b16 a[150:151], v194 offset:4608
    ds_read_b64_tr_b16 a[152:153], v194 offset:8192
    ds_read_b64_tr_b16 a[154:155], v194 offset:8704
    ds_read_b64_tr_b16 a[156:157], v194 offset:12288
    ds_read_b64_tr_b16 a[158:159], v194 offset:12800
    s_waitcnt vmcnt(38)
    s_waitcnt lgkmcnt(0)
    s_barrier
    v_add_u32 v194, 98304, v193
    ds_read_b64_tr_b16 a[160:161], v194 offset:0
    ds_read_b64_tr_b16 a[162:163], v194 offset:512
    ds_read_b64_tr_b16 a[164:165], v194 offset:4096
    ds_read_b64_tr_b16 a[166:167], v194 offset:4608
    ds_read_b64_tr_b16 a[168:169], v194 offset:8192
    ds_read_b64_tr_b16 a[170:171], v194 offset:8704
    ds_read_b64_tr_b16 a[172:173], v194 offset:12288
    ds_read_b64_tr_b16 a[174:175], v194 offset:12800
    s_waitcnt vmcnt(34)
    s_waitcnt lgkmcnt(0)
    s_barrier
    v_add_u32 v194, 114688, v193
    ds_read_b64_tr_b16 a[176:177], v194 offset:0
    ds_read_b64_tr_b16 a[178:179], v194 offset:512
    ds_read_b64_tr_b16 a[180:181], v194 offset:4096
    ds_read_b64_tr_b16 a[182:183], v194 offset:4608
    ds_read_b64_tr_b16 a[184:185], v194 offset:8192
    ds_read_b64_tr_b16 a[186:187], v194 offset:8704
    ds_read_b64_tr_b16 a[188:189], v194 offset:12288
    ds_read_b64_tr_b16 a[190:191], v194 offset:12800
    s_waitcnt vmcnt(30)
    s_waitcnt lgkmcnt(0)
    s_barrier
    v_add_u32 v194, 131072, v193
    ds_read_b64_tr_b16 a[192:193], v194 offset:0
    ds_read_b64_tr_b16 a[194:195], v194 offset:512
    ds_read_b64_tr_b16 a[196:197], v194 offset:4096
    ds_read_b64_tr_b16 a[198:199], v194 offset:4608
    ds_read_b64_tr_b16 a[200:201], v194 offset:8192
    ds_read_b64_tr_b16 a[202:203], v194 offset:8704
    ds_read_b64_tr_b16 a[204:205], v194 offset:12288
    ds_read_b64_tr_b16 a[206:207], v194 offset:12800
    s_waitcnt vmcnt(26)
    s_waitcnt lgkmcnt(0)
    s_barrier
    v_add_u32 v194, 147456, v193
    ds_read_b64_tr_b16 a[208:209], v194 offset:0
    ds_read_b64_tr_b16 a[210:211], v194 offset:512
    ds_read_b64_tr_b16 a[212:213], v194 offset:4096
    ds_read_b64_tr_b16 a[214:215], v194 offset:4608
    ds_read_b64_tr_b16 a[216:217], v194 offset:8192
    ds_read_b64_tr_b16 a[218:219], v194 offset:8704
    ds_read_b64_tr_b16 a[220:221], v194 offset:12288
    ds_read_b64_tr_b16 a[222:223], v194 offset:12800
    s_waitcnt vmcnt(22)
    s_waitcnt lgkmcnt(0)
    s_barrier
    v_add_u32 v194, 0, v193
    ds_read_b64_tr_b16 a[224:225], v194 offset:0
    ds_read_b64_tr_b16 a[226:227], v194 offset:512
    ds_read_b64_tr_b16 a[228:229], v194 offset:4096
    ds_read_b64_tr_b16 a[230:231], v194 offset:4608
    ds_read_b64_tr_b16 a[232:233], v194 offset:8192
    ds_read_b64_tr_b16 a[234:235], v194 offset:8704
    ds_read_b64_tr_b16 a[236:237], v194 offset:12288
    ds_read_b64_tr_b16 a[238:239], v194 offset:12800
    s_waitcnt lgkmcnt(0)
    s_barrier
    v_mov_b32 v192, 0x80000000
    s_cmp_lt_u32 s59, 20
    s_cselect_b32 s87, -2, -1
    s_cselect_b32 s64, s60, 0
    s_bitcmp1_b32 s64, 0
    s_cselect_b64 vcc, -1, 0
    v_cndmask_b32 v251, v192, v251, vcc
    v_cndmask_b32 v252, v192, v252, vcc
    s_cmp_eq_u32 s60, 2
    s_cselect_b64 vcc, -1, 0
    v_cndmask_b32 v254, v192, v254, vcc
    v_mov_b32 v192, -1000
    v_cndmask_b32 v255, v192, v255, vcc
    v_mov_b64 v[192:193], 0
    v_mov_b64 v[194:195], 0
    ds_write_b128 v235, v[192:195] offset:14336
    s_waitcnt vmcnt(18)
    ds_write_b128 v235, v[200:203] offset:0
    s_waitcnt vmcnt(14)
    ds_write_b128 v235, v[204:207] offset:4096
    s_waitcnt vmcnt(10)
    ds_write_b128 v235, v[208:211] offset:8192
    s_cmp_lg_u32 s60, 1
    s_cbranch_scc1 Lcnt_17
    s_mov_b64 exec, 1
    v_mov_b32 v218, 1
    buffer_atomic_add v218, off, s[8:11], 0 offset:68 sc0
    s_mov_b64 exec, -1
Lcnt_17:
    s_cmp_eq_u32 s68, 0
    s_cbranch_scc1 Lt0_16
    buffer_load_dword v2, v254, s[4:7], 0 offen sc1
    s_add_u32 s64, s62, 1
    v_add_u32 v3, s64, v255
    v_min_i32 v3, 64, v3
Lfchk_18:
    s_waitcnt vmcnt(0)
    v_cmp_gt_i32 vcc, v3, v2
    s_cbranch_vccnz Lfrty_19
    s_waitcnt lgkmcnt(0)
    s_barrier
    s_add_u32 m0, s73, 0
    s_nop 0
    buffer_load_dwordx4 v232, s[4:7], s74 offen offset:0 sc1 lds
    s_add_u32 m0, s73, 896
    s_nop 0
    buffer_load_dwordx4 v232, s[4:7], s74 offen offset:128 sc1 lds
    s_add_u32 m0, s73, 1792
    s_nop 0
    buffer_load_dwordx4 v232, s[4:7], s74 offen offset:256 sc1 lds
    s_add_u32 m0, s73, 2688
    s_nop 0
    buffer_load_dwordx4 v232, s[4:7], s74 offen offset:384 sc1 lds
    s_add_u32 m0, s73, 3584
    s_nop 0
    buffer_load_dwordx4 v232, s[4:7], s74 offen offset:512 sc1 lds
    s_add_u32 m0, s73, 4480
    s_nop 0
    buffer_load_dwordx4 v232, s[4:7], s74 offen offset:640 sc1 lds
    s_add_u32 m0, s73, 5376
    s_nop 0
    buffer_load_dwordx4 v232, s[4:7], s74 offen offset:768 sc1 lds
    s_add_u32 m0, s73, 6272
    s_nop 0
    buffer_load_dwordx4 v232, s[4:7], s74 offen offset:896 sc1 lds
    s_add_u32 m0, s73, 7168
    s_nop 0
    buffer_load_dwordx4 v232, s[4:7], s74 offen offset:1024 sc1 lds
    s_add_u32 m0, s73, 8064
    s_nop 0
    buffer_load_dwordx4 v232, s[4:7], s74 offen offset:1152 sc1 lds
    buffer_load_dword v2, v254, s[4:7], 0 offen sc1
    s_waitcnt vmcnt(0)
    s_add_u32 s64, s62, 2
    v_add_u32 v3, s64, v255
    v_min_i32 v3, 64, v3
Lfchk_20:
    v_cmp_gt_i32 vcc, v3, v2
    s_cbranch_vccnz Lfrty_21
Lt0_16:
    s_cmp_lg_u32 s60, 1
    s_cbranch_scc1 Lt0_16a
    s_waitcnt vmcnt(1)
    s_branch Lt0_16b
Lt0_16a:
    s_waitcnt vmcnt(0)
Lt0_16b:
    s_waitcnt lgkmcnt(0)
    s_barrier
    s_add_u32 s74, s74, 40960
    s_xor_b32 s73, s73, 65536
    s_add_u32 m0, s73, 0
    s_nop 0
    buffer_load_dwordx4 v232, s[4:7], s74 offen offset:0 sc1 lds
    s_add_u32 m0, s73, 896
    s_nop 0
    buffer_load_dwordx4 v232, s[4:7], s74 offen offset:128 sc1 lds
    s_add_u32 m0, s73, 1792
    s_nop 0
    buffer_load_dwordx4 v232, s[4:7], s74 offen offset:256 sc1 lds
    s_add_u32 m0, s73, 2688
    s_nop 0
    buffer_load_dwordx4 v232, s[4:7], s74 offen offset:384 sc1 lds
    s_add_u32 m0, s73, 3584
    s_nop 0
    buffer_load_dwordx4 v232, s[4:7], s74 offen offset:512 sc1 lds
    s_add_u32 m0, s73, 4480
    s_nop 0
    buffer_load_dwordx4 v232, s[4:7], s74 offen offset:640 sc1 lds
    s_add_u32 m0, s73, 5376
    s_nop 0
    buffer_load_dwordx4 v232, s[4:7], s74 offen offset:768 sc1 lds
    s_add_u32 m0, s73, 6272
    s_nop 0
    buffer_load_dwordx4 v232, s[4:7], s74 offen offset:896 sc1 lds
    s_add_u32 m0, s73, 7168
    s_nop 0
    buffer_load_dwordx4 v232, s[4:7], s74 offen offset:1024 sc1 lds
    s_add_u32 m0, s73, 8064
    s_nop 0
    buffer_load_dwordx4 v232, s[4:7], s74 offen offset:1152 sc1 lds
    s_add_u32 s74, s74, 40960
    s_xor_b32 s73, s73, 65536
    buffer_load_dword v217, off, s[8:11], 0 offset:140 sc1
    ds_read_b128 v[124:127], v233 offset:0
    ds_read_b128 v[128:131], v233 offset:20480
    ds_read_b128 v[132:135], v234 offset:0
    ds_read_b128 v[136:139], v234 offset:20480
    ds_read_b128 v[140:143], v233 offset:1024
    s_waitcnt lgkmcnt(4)
    v_mfma_f32_16x16x32_bf16 v[148:151], a[0:3], v[124:127], 0
    ds_read_b128 v[144:147], v233 offset:21504
    v_mov_b64 v[192:193], 0
    v_mfma_f32_16x16x32_bf16 v[156:159], a[80:83], v[124:127], 0
    v_mov_b64 v[194:195], 0
    v_mov_b64 v[196:197], 0
    v_mfma_f32_16x16x32_bf16 v[164:167], v[124:127], a[160:163], 0
    v_mov_b64 v[198:199], 0
    v_mov_b64 v[200:201], 0
    s_waitcnt lgkmcnt(4)
    v_mfma_f32_16x16x32_bf16 v[152:155], a[0:3], v[128:131], 0
    ds_read_b128 v[124:127], v234 offset:1024
    v_mov_b64 v[202:203], 0
    v_mfma_f32_16x16x32_bf16 v[160:163], a[80:83], v[128:131], 0
    v_mfma_f32_16x16x32_bf16 v[168:171], v[128:131], a[160:163], 0
    s_waitcnt lgkmcnt(4)
    v_mfma_f32_16x16x32_bf16 v[148:151], a[4:7], v[132:135], v[148:151]
    ds_read_b128 v[128:131], v234 offset:21504
    v_mfma_f32_16x16x32_bf16 v[156:159], a[84:87], v[132:135], v[156:159]
    v_mfma_f32_16x16x32_bf16 v[164:167], v[132:135], a[164:167], v[164:167]
    s_waitcnt lgkmcnt(4)
    v_mfma_f32_16x16x32_bf16 v[152:155], a[4:7], v[136:139], v[152:155]
    ds_read_b128 v[132:135], v233 offset:2048
    v_mfma_f32_16x16x32_bf16 v[160:163], a[84:87], v[136:139], v[160:163]
    v_mfma_f32_16x16x32_bf16 v[168:171], v[136:139], a[164:167], v[168:171]
    s_waitcnt lgkmcnt(4)
    v_mfma_f32_16x16x32_bf16 v[148:151], a[8:11], v[140:143], v[148:151]
    ds_read_b128 v[136:139], v233 offset:22528
    v_mfma_f32_16x16x32_bf16 v[156:159], a[88:91], v[140:143], v[156:159]
    v_mfma_f32_16x16x32_bf16 v[164:167], v[140:143], a[168:171], v[164:167]
    s_waitcnt lgkmcnt(4)
    v_mfma_f32_16x16x32_bf16 v[152:155], a[8:11], v[144:147], v[152:155]
    ds_read_b128 v[140:143], v234 offset:2048
    v_mfma_f32_16x16x32_bf16 v[160:163], a[88:91], v[144:147], v[160:163]
    v_mfma_f32_16x16x32_bf16 v[168:171], v[144:147], a[168:171], v[168:171]
    s_waitcnt lgkmcnt(4)
    v_mfma_f32_16x16x32_bf16 v[148:151], a[12:15], v[124:127], v[148:151]
    ds_read_b128 v[144:147], v234 offset:22528
    v_mfma_f32_16x16x32_bf16 v[156:159], a[92:95], v[124:127], v[156:159]
    v_mfma_f32_16x16x32_bf16 v[164:167], v[124:127], a[172:175], v[164:167]
    s_waitcnt lgkmcnt(4)
    v_mfma_f32_16x16x32_bf16 v[152:155], a[12:15], v[128:131], v[152:155]
    ds_read_b128 v[124:127], v233 offset:3072
    v_mfma_f32_16x16x32_bf16 v[160:163], a[92:95], v[128:131], v[160:163]
    v_mfma_f32_16x16x32_bf16 v[168:171], v[128:131], a[172:175], v[168:171]
    s_waitcnt lgkmcnt(4)
    v_mfma_f32_16x16x32_bf16 v[148:151], a[16:19], v[132:135], v[148:151]
    ds_read_b128 v[128:131], v233 offset:23552
    v_mfma_f32_16x16x32_bf16 v[156:159], a[96:99], v[132:135], v[156:159]
    v_mfma_f32_16x16x32_bf16 v[164:167], v[132:135], a[176:179], v[164:167]
    s_waitcnt lgkmcnt(4)
    v_mfma_f32_16x16x32_bf16 v[152:155], a[16:19], v[136:139], v[152:155]
    ds_read_b128 v[132:135], v234 offset:3072
    v_mfma_f32_16x16x32_bf16 v[160:163], a[96:99], v[136:139], v[160:163]
    v_mfma_f32_16x16x32_bf16 v[168:171], v[136:139], a[176:179], v[168:171]
    s_waitcnt lgkmcnt(4)
    v_mfma_f32_16x16x32_bf16 v[148:151], a[20:23], v[140:143], v[148:151]
    ds_read_b128 v[136:139], v234 offset:23552
    v_mfma_f32_16x16x32_bf16 v[156:159], a[100:103], v[140:143], v[156:159]
    v_mfma_f32_16x16x32_bf16 v[164:167], v[140:143], a[180:183], v[164:167]
    s_waitcnt lgkmcnt(4)
    v_mfma_f32_16x16x32_bf16 v[152:155], a[20:23], v[144:147], v[152:155]
    ds_read_b128 v[140:143], v233 offset:4096
    v_mfma_f32_16x16x32_bf16 v[160:163], a[100:103], v[144:147], v[160:163]
    v_mfma_f32_16x16x32_bf16 v[168:171], v[144:147], a[180:183], v[168:171]
    s_waitcnt lgkmcnt(4)
    v_mfma_f32_16x16x32_bf16 v[148:151], a[24:27], v[124:127], v[148:151]
    ds_read_b128 v[144:147], v233 offset:24576
    v_mfma_f32_16x16x32_bf16 v[156:159], a[104:107], v[124:127], v[156:159]
    v_mfma_f32_16x16x32_bf16 v[164:167], v[124:127], a[184:187], v[164:167]
    s_waitcnt lgkmcnt(4)
    v_mfma_f32_16x16x32_bf16 v[152:155], a[24:27], v[128:131], v[152:155]
    ds_read_b128 v[124:127], v234 offset:4096
    v_mfma_f32_16x16x32_bf16 v[160:163], a[104:107], v[128:131], v[160:163]
    v_mfma_f32_16x16x32_bf16 v[168:171], v[128:131], a[184:187], v[168:171]
    s_waitcnt lgkmcnt(4)
    v_mfma_f32_16x16x32_bf16 v[148:151], a[28:31], v[132:135], v[148:151]
    ds_read_b128 v[128:131], v234 offset:24576
    v_mfma_f32_16x16x32_bf16 v[156:159], a[108:111], v[132:135], v[156:159]
    v_mfma_f32_16x16x32_bf16 v[164:167], v[132:135], a[188:191], v[164:167]
    s_waitcnt lgkmcnt(4)
    v_mfma_f32_16x16x32_bf16 v[152:155], a[28:31], v[136:139], v[152:155]
    ds_read_b128 v[132:135], v233 offset:5120
    v_mfma_f32_16x16x32_bf16 v[160:163], a[108:111], v[136:139], v[160:163]
    v_mfma_f32_16x16x32_bf16 v[168:171], v[136:139], a[188:191], v[168:171]
    s_waitcnt lgkmcnt(4)
    v_mfma_f32_16x16x32_bf16 v[148:151], a[32:35], v[140:143], v[148:151]
    ds_read_b128 v[136:139], v233 offset:25600
    v_mfma_f32_16x16x32_bf16 v[156:159], a[112:115], v[140:143], v[156:159]
    v_mfma_f32_16x16x32_bf16 v[164:167], v[140:143], a[192:195], v[164:167]
    s_waitcnt lgkmcnt(4)
    v_mfma_f32_16x16x32_bf16 v[152:155], a[32:35], v[144:147], v[152:155]
    ds_read_b128 v[140:143], v234 offset:5120
    v_mfma_f32_16x16x32_bf16 v[160:163], a[112:115], v[144:147], v[160:163]
    v_mfma_f32_16x16x32_bf16 v[168:171], v[144:147], a[192:195], v[168:171]
    s_waitcnt lgkmcnt(4)
    v_mfma_f32_16x16x32_bf16 v[148:151], a[36:39], v[124:127], v[148:151]
    ds_read_b128 v[144:147], v234 offset:25600
    v_mfma_f32_16x16x32_bf16 v[156:159], a[116:119], v[124:127], v[156:159]
    v_mfma_f32_16x16x32_bf16 v[164:167], v[124:127], a[196:199], v[164:167]
    s_waitcnt lgkmcnt(4)
    v_mfma_f32_16x16x32_bf16 v[152:155], a[36:39], v[128:131], v[152:155]
    ds_read_b128 v[124:127], v233 offset:6144
    v_mfma_f32_16x16x32_bf16 v[160:163], a[116:119], v[128:131], v[160:163]
    v_mfma_f32_16x16x32_bf16 v[168:171], v[128:131], a[196:199], v[168:171]
    s_waitcnt lgkmcnt(4)
    v_mfma_f32_16x16x32_bf16 v[148:151], a[40:43], v[132:135], v[148:151]
    ds_read_b128 v[128:131], v233 offset:26624
    v_mfma_f32_16x16x32_bf16 v[156:159], a[120:123], v[132:135], v[156:159]
    v_mfma_f32_16x16x32_bf16 v[164:167], v[132:135], a[200:203], v[164:167]
    s_waitcnt lgkmcnt(4)
    v_mfma_f32_16x16x32_bf16 v[152:155], a[40:43], v[136:139], v[152:155]
    ds_read_b128 v[132:135], v234 offset:6144
    v_mfma_f32_16x16x32_bf16 v[160:163], a[120:123], v[136:139], v[160:163]
    v_mfma_f32_16x16x32_bf16 v[168:171], v[136:139], a[200:203], v[168:171]
    s_waitcnt lgkmcnt(4)
    v_mfma_f32_16x16x32_bf16 v[148:151], a[44:47], v[140:143], v[148:151]
    ds_read_b128 v[136:139], v234 offset:26624
    v_mfma_f32_16x16x32_bf16 v[156:159], a[124:127], v[140:143], v[156:159]
    v_mfma_f32_16x16x32_bf16 v[164:167], v[140:143], a[204:207], v[164:167]
    s_waitcnt lgkmcnt(4)
    v_mfma_f32_16x16x32_bf16 v[152:155], a[44:47], v[144:147], v[152:155]
    ds_read_b128 v[140:143], v233 offset:7168
    v_mfma_f32_16x16x32_bf16 v[160:163], a[124:127], v[144:147], v[160:163]
    v_mfma_f32_16x16x32_bf16 v[168:171], v[144:147], a[204:207], v[168:171]
    s_waitcnt lgkmcnt(4)
    v_mfma_f32_16x16x32_bf16 v[148:151], a[48:51], v[124:127], v[148:151]
    ds_read_b128 v[144:147], v233 offset:27648
    v_mfma_f32_16x16x32_bf16 v[156:159], a[128:131], v[124:127], v[156:159]
    v_mfma_f32_16x16x32_bf16 v[164:167], v[124:127], a[208:211], v[164:167]
    s_waitcnt lgkmcnt(4)
    v_mfma_f32_16x16x32_bf16 v[152:155], a[48:51], v[128:131], v[152:155]
    ds_read_b128 v[124:127], v234 offset:7168
    v_mfma_f32_16x16x32_bf16 v[160:163], a[128:131], v[128:131], v[160:163]
    v_mfma_f32_16x16x32_bf16 v[168:171], v[128:131], a[208:211], v[168:171]
    s_waitcnt lgkmcnt(4)
    v_mfma_f32_16x16x32_bf16 v[148:151], a[52:55], v[132:135], v[148:151]
    ds_read_b128 v[128:131], v234 offset:27648
    v_mfma_f32_16x16x32_bf16 v[156:159], a[132:135], v[132:135], v[156:159]
    v_mfma_f32_16x16x32_bf16 v[164:167], v[132:135], a[212:215], v[164:167]
    s_waitcnt lgkmcnt(4)
    v_mfma_f32_16x16x32_bf16 v[152:155], a[52:55], v[136:139], v[152:155]
    ds_read_b128 v[132:135], v233 offset:8192
    v_mfma_f32_16x16x32_bf16 v[160:163], a[132:135], v[136:139], v[160:163]
    v_mfma_f32_16x16x32_bf16 v[168:171], v[136:139], a[212:215], v[168:171]
    s_waitcnt lgkmcnt(4)
    v_mfma_f32_16x16x32_bf16 v[148:151], a[56:59], v[140:143], v[148:151]
    ds_read_b128 v[136:139], v233 offset:28672
    v_mfma_f32_16x16x32_bf16 v[156:159], a[136:139], v[140:143], v[156:159]
    v_mfma_f32_16x16x32_bf16 v[164:167], v[140:143], a[216:219], v[164:167]
    s_waitcnt lgkmcnt(4)
    v_mfma_f32_16x16x32_bf16 v[152:155], a[56:59], v[144:147], v[152:155]
    ds_read_b128 v[140:143], v234 offset:8192
    v_mfma_f32_16x16x32_bf16 v[160:163], a[136:139], v[144:147], v[160:163]
    v_mfma_f32_16x16x32_bf16 v[168:171], v[144:147], a[216:219], v[168:171]
    s_waitcnt lgkmcnt(4)
    v_mfma_f32_16x16x32_bf16 v[148:151], a[60:63], v[124:127], v[148:151]
    ds_read_b128 v[144:147], v234 offset:28672
    v_mfma_f32_16x16x32_bf16 v[156:159], a[140:143], v[124:127], v[156:159]
    v_mfma_f32_16x16x32_bf16 v[164:167], v[124:127], a[220:223], v[164:167]
    s_waitcnt lgkmcnt(4)
    v_mfma_f32_16x16x32_bf16 v[152:155], a[60:63], v[128:131], v[152:155]
    ds_read_b128 v[124:127], v233 offset:9216
    v_mfma_f32_16x16x32_bf16 v[160:163], a[140:143], v[128:131], v[160:163]
    v_mfma_f32_16x16x32_bf16 v[168:171], v[128:131], a[220:223], v[168:171]
    s_waitcnt lgkmcnt(4)
    v_mfma_f32_16x16x32_bf16 v[148:151], a[64:67], v[132:135], v[148:151]
    ds_read_b128 v[128:131], v233 offset:29696
    v_mfma_f32_16x16x32_bf16 v[156:159], a[144:147], v[132:135], v[156:159]
    v_mfma_f32_16x16x32_bf16 v[164:167], v[132:135], a[224:227], v[164:167]
    s_waitcnt lgkmcnt(4)
    v_mfma_f32_16x16x32_bf16 v[152:155], a[64:67], v[136:139], v[152:155]
    ds_read_b128 v[132:135], v234 offset:9216
    v_mfma_f32_16x16x32_bf16 v[160:163], a[144:147], v[136:139], v[160:163]
    v_mfma_f32_16x16x32_bf16 v[168:171], v[136:139], a[224:227], v[168:171]
    s_waitcnt lgkmcnt(4)
    v_mfma_f32_16x16x32_bf16 v[148:151], a[68:71], v[140:143], v[148:151]
    ds_read_b128 v[136:139], v234 offset:29696
    v_mfma_f32_16x16x32_bf16 v[156:159], a[148:151], v[140:143], v[156:159]
    v_mfma_f32_16x16x32_bf16 v[164:167], v[140:143], a[228:231], v[164:167]
    s_waitcnt lgkmcnt(4)
    v_mfma_f32_16x16x32_bf16 v[152:155], a[68:71], v[144:147], v[152:155]
    v_mfma_f32_16x16x32_bf16 v[160:163], a[148:151], v[144:147], v[160:163]
    v_mfma_f32_16x16x32_bf16 v[168:171], v[144:147], a[228:231], v[168:171]
    s_waitcnt lgkmcnt(3)
    v_mfma_f32_16x16x32_bf16 v[148:151], a[72:75], v[124:127], v[148:151]
    v_mfma_f32_16x16x32_bf16 v[156:159], a[152:155], v[124:127], v[156:159]
    v_mfma_f32_16x16x32_bf16 v[164:167], v[124:127], a[232:235], v[164:167]
    s_waitcnt lgkmcnt(2)
    v_mfma_f32_16x16x32_bf16 v[152:155], a[72:75], v[128:131], v[152:155]
    v_mfma_f32_16x16x32_bf16 v[160:163], a[152:155], v[128:131], v[160:163]
    v_mfma_f32_16x16x32_bf16 v[168:171], v[128:131], a[232:235], v[168:171]
    s_lshl_b32 s72, s58, 20
    buffer_load_dword v2, v254, s[4:7], 0 offen sc1
    s_waitcnt vmcnt(0) lgkmcnt(0)
    s_add_u32 s64, s62, 3
    v_add_u32 v3, s64, v255
    v_min_i32 v3, 64, v3
Lfchk_22:
    v_cmp_gt_i32 vcc, v3, v2
    s_cbranch_vccnz Lfrty_23
    s_cmp_lg_u32 s60, 1
    s_cbranch_scc1 Lcnt_24
    s_mov_b64 exec, 1
    v_mov_b32 v219, 0x80000000
    v_cmp_ne_u32 vcc, 95, v218
    s_nop 1
    v_cndmask_b32 v219, 8, v219, vcc
    buffer_store_dword v218, v219, s[8:11], 0 offen offset:128 sc1
    s_mov_b64 exec, -1
Lcnt_24:
Lpchk_25:
    v_cmp_eq_u32 vcc, 0, v217
    s_cbranch_vccnz Lprty_26
    v_cmp_lt_u32 vcc, 17, v217
    s_nop 1
    v_cndmask_b32 v217, 1, 0, vcc
    v_xor_b32 v217, s68, v217
    v_lshl_add_u32 v252, v217, 13, v252
    s_cmp_eq_u32 s60, 3
    s_cbranch_scc1 L_Cin3
    s_branch L_Cin0
Lgrty_6:
    s_sleep 16
    buffer_load_dword v2, off, s[8:11], 0 offset:136 sc1
    s_sub_u32 s61, s61, 1
    s_mov_b32 s67, 4
    s_cbranch_scc1 L_fail
    s_branch Lgchk_5
Lgrty_13:
    s_sleep 8
    buffer_load_dword v218, off, s[8:11], 0 offset:132 sc1
    s_sub_u32 s61, s61, 1
    s_mov_b32 s67, 1
    s_cbranch_scc1 L_fail
    s_waitcnt vmcnt(0)
    s_branch Lgchk_12
Lfrty_19:
    s_sleep 4
    buffer_load_dword v2, v254, s[4:7], 0 offen sc1
    s_sub_u32 s61, s61, 1
    s_mov_b32 s67, 10
    s_cbranch_scc1 L_fail
    s_waitcnt vmcnt(0)
    s_branch Lfchk_18
Lfrty_21:
    s_sleep 4
    buffer_load_dword v2, v254, s[4:7], 0 offen sc1
    s_sub_u32 s61, s61, 1
    s_mov_b32 s67, 10
    s_cbranch_scc1 L_fail
    s_waitcnt vmcnt(0)
    s_branch Lfchk_20
Lfrty_23:
    s_sleep 4
    buffer_load_dword v2, v254, s[4:7], 0 offen sc1
    s_sub_u32 s61, s61, 1
    s_mov_b32 s67, 10
    s_cbranch_scc1 L_fail
    s_waitcnt vmcnt(0)
    s_branch Lfchk_22
Lprty_26:
    s_sleep 8
    buffer_load_dword v217, off, s[8:11], 0 offset:140 sc1
    s_sub_u32 s61, s61, 1
    s_mov_b32 s67, 16
    s_cbranch_scc1 L_fail
    s_waitcnt vmcnt(0)
    s_branch Lpchk_25
L_Ctop3:
    v_mfma_f32_16x16x32_bf16 v[164:167], v[132:135], a[224:227], v[164:167]
    buffer_load_dwordx4 v[84:87], v235, s[4:7], s82 offen sc1
    buffer_load_dwordx4 v[88:91], v235, s[4:7], s83 offen sc1
    s_waitcnt lgkmcnt(4)
    v_mfma_f32_16x16x32_bf16 v[152:155], a[64:67], v[136:139], v[152:155]
    ds_read_b128 v[132:135], v234 offset:9216
    buffer_load_dwordx2 v[92:93], v236, s[4:7], s82 offen sc1
    v_mfma_f32_16x16x32_bf16 v[160:163], a[144:147], v[136:139], v[160:163]
    v_mfma_f32_16x16x32_bf16 v[168:171], v[136:139], a[224:227], v[168:171]
    s_waitcnt lgkmcnt(4)
    v_mfma_f32_16x16x32_bf16 v[148:151], a[68:71], v[140:143], v[148:151]
    ds_read_b128 v[136:139], v234 offset:29696
    v_mfma_f32_16x16x32_bf16 v[156:159], a[148:151], v[140:143], v[156:159]
    v_mfma_f32_16x16x32_bf16 v[164:167], v[140:143], a[228:231], v[164:167]
    s_waitcnt lgkmcnt(4)
    v_mfma_f32_16x16x32_bf16 v[152:155], a[68:71], v[144:147], v[152:155]
    v_mfma_f32_16x16x32_bf16 v[160:163], a[148:151], v[144:147], v[160:163]
    v_mfma_f32_16x16x32_bf16 v[168:171], v[144:147], a[228:231], v[168:171]
    s_waitcnt lgkmcnt(3)
    v_mfma_f32_16x16x32_bf16 v[148:151], a[72:75], v[124:127], v[148:151]
    v_mfma_f32_16x16x32_bf16 v[156:159], a[152:155], v[124:127], v[156:159]
    s_waitcnt vmcnt(2)
    ds_write_b128 v235, v[84:87] offset:0
    s_waitcnt vmcnt(1)
    ds_write_b128 v235, v[88:91] offset:4096
    s_waitcnt vmcnt(0)
    ds_write_b64 v236, v[92:93] offset:0
    v_max3_u32 v96, v84, v85, v86
    v_max3_u32 v96, v96, v87, v88
    v_max3_u32 v96, v96, v89, v90
    v_max3_u32 v96, v96, v91, v92
    v_max_u32 v96, v96, v93
    v_cmp_eq_u32 vcc, -1, v96
    s_cbranch_vccnz Lrty_28
Lok_27:
    v_mfma_f32_16x16x32_bf16 v[164:167], v[124:127], a[232:235], v[164:167]
    s_waitcnt lgkmcnt(5)
    v_mfma_f32_16x16x32_bf16 v[152:155], a[72:75], v[128:131], v[152:155]
    v_mfma_f32_16x16x32_bf16 v[160:163], a[152:155], v[128:131], v[160:163]
    v_mfma_f32_16x16x32_bf16 v[168:171], v[128:131], a[232:235], v[168:171]
L_Cin3:
    s_waitcnt lgkmcnt(0)
    s_barrier
    ds_read_b128 v[84:87], v237 offset:0
    ds_read_b128 v[88:91], v237 offset:1024
    ds_read_b128 v[92:95], v237 offset:2048
    v_mfma_f32_16x16x32_bf16 v[148:151], a[76:79], v[132:135], v[148:151]
    ds_read_b128 v[96:99], v237 offset:3072
    ds_read_b128 v[100:103], v237 offset:4096
    v_mfma_f32_16x16x32_bf16 v[156:159], a[156:159], v[132:135], v[156:159]
    ds_read_b128 v[104:107], v237 offset:5120
    ds_read_b128 v[108:111], v237 offset:6144
    v_mfma_f32_16x16x32_bf16 v[164:167], v[132:135], a[236:239], v[164:167]
    ds_read_b128 v[112:115], v237 offset:7168
    ds_read_b128 v[116:119], v237 offset:8192
    v_mfma_f32_16x16x32_bf16 v[152:155], a[76:79], v[136:139], v[152:155]
    ds_read_b128 v[120:123], v237 offset:9216
    v_mfma_f32_16x16x32_bf16 v[160:163], a[156:159], v[136:139], v[160:163]
    v_mfma_f32_16x16x32_bf16 v[168:171], v[136:139], a[236:239], v[168:171]
    s_waitcnt lgkmcnt(9)
    v_smfmac_f32_16x16x64_bf16 v[192:195], v[84:87], a[0:7], v225
    s_add_u32 m0, s73, 0
    v_xor_b32 v233, 0x10000, v233
    v_smfmac_f32_16x16x64_bf16 v[196:199], v[84:87], a[80:87], v225
    buffer_load_dwordx4 v232, s[4:7], s74 offen offset:0 sc1 lds
    s_add_u32 m0, s73, 896
    s_waitcnt lgkmcnt(8)
    v_smfmac_f32_16x16x64_bf16 v[192:195], v[88:91], a[8:15], v225
    v_xor_b32 v234, 0x10000, v234
    v_cvt_pk_bf16_f32 v148, v148, v149
    v_smfmac_f32_16x16x64_bf16 v[196:199], v[88:91], a[88:95], v225
    v_cvt_pk_bf16_f32 v149, v150, v151
    s_waitcnt lgkmcnt(7)
    v_smfmac_f32_16x16x64_bf16 v[192:195], v[92:95], a[16:23], v225
    buffer_load_dwordx4 v232, s[4:7], s74 offen offset:128 sc1 lds
    s_add_u32 m0, s73, 1792
    v_smfmac_f32_16x16x64_bf16 v[196:199], v[92:95], a[96:103], v225
    ds_write_b64 v244, v[148:149] offset:22528
    v_cvt_pk_bf16_f32 v156, v156, v157
    s_waitcnt lgkmcnt(7)
    v_smfmac_f32_16x16x64_bf16 v[192:195], v[96:99], a[24:31], v225
    v_cvt_pk_bf16_f32 v157, v158, v159
    v_smfmac_f32_16x16x64_bf16 v[196:199], v[96:99], a[104:111], v225
    buffer_load_dwordx4 v232, s[4:7], s74 offen offset:256 sc1 lds
    s_add_u32 m0, s73, 2688
    s_waitcnt lgkmcnt(6)
    v_smfmac_f32_16x16x64_bf16 v[192:195], v[100:103], a[32:39], v225
    ds_write_b64 v244, v[156:157] offset:26624
    v_cvt_pk_bf16_f32 v172, v164, v165
    v_smfmac_f32_16x16x64_bf16 v[196:199], v[100:103], a[112:119], v225
    v_cvt_pk_bf16_f32 v173, v166, v167
    v_cvt_pk_bf16_f32 v152, v152, v153
    s_waitcnt lgkmcnt(6)
    v_smfmac_f32_16x16x64_bf16 v[192:195], v[104:107], a[40:47], v225
    v_cvt_pk_bf16_f32 v153, v154, v155
    v_smfmac_f32_16x16x64_bf16 v[196:199], v[104:107], a[120:127], v225
    ds_write_b64 v244, v[152:153] offset:24576
    v_cvt_pk_bf16_f32 v160, v160, v161
    s_waitcnt lgkmcnt(6)
    v_smfmac_f32_16x16x64_bf16 v[192:195], v[108:111], a[48:55], v225
    v_cvt_pk_bf16_f32 v161, v162, v163
    v_smfmac_f32_16x16x64_bf16 v[196:199], v[108:111], a[128:135], v225
    ds_write_b64 v244, v[160:161] offset:28672
    v_cvt_pk_bf16_f32 v176, v168, v169
    s_waitcnt lgkmcnt(6)
    v_smfmac_f32_16x16x64_bf16 v[192:195], v[112:115], a[56:63], v225
    v_cvt_pk_bf16_f32 v177, v170, v171
    v_smfmac_f32_16x16x64_bf16 v[196:199], v[112:115], a[136:143], v225
    s_waitcnt lgkmcnt(5)
    v_smfmac_f32_16x16x64_bf16 v[192:195], v[116:119], a[64:71], v225
    v_smfmac_f32_16x16x64_bf16 v[196:199], v[116:119], a[144:151], v225
    s_waitcnt lgkmcnt(4)
    v_smfmac_f32_16x16x64_bf16 v[192:195], v[120:123], a[72:79], v225
    v_smfmac_f32_16x16x64_bf16 v[196:199], v[120:123], a[152:159], v225
    v_smfmac_f32_16x16x64_bf16 v[200:203], v[84:87], a[160:167], v225
    s_add_u32 s79, s72, s76
    s_add_u32 s80, s72, s77
    s_add_u32 s81, s72, s78
    s_add_u32 s85, s74, 40960
    s_cmp_lt_u32 s59, 20
    s_cselect_b32 s85, s72, s85
    s_cselect_b32 s86, 4096, 0
    v_permlane32_swap_b32 v192, v196
    v_permlane32_swap_b32 v193, v197
    v_permlane32_swap_b32 v194, v198
    v_permlane32_swap_b32 v195, v199
    v_pk_add_f32 v[192:193], v[192:193], v[196:197]
    v_pk_add_f32 v[194:195], v[194:195], v[198:199]
    v_cvt_pk_bf16_f32 v192, v192, v193
    v_cvt_pk_bf16_f32 v193, v194, v195
    ds_write_b64 v242, v[192:193] offset:12288
    v_smfmac_f32_16x16x64_bf16 v[200:203], v[88:91], a[168:175], v225
    s_add_u32 s86, s86, s85
    v_smfmac_f32_16x16x64_bf16 v[200:203], v[92:95], a[176:183], v225
    buffer_load_dwordx4 v232, s[4:7], s74 offen offset:384 sc1 lds
    s_add_u32 m0, s73, 3584
    v_smfmac_f32_16x16x64_bf16 v[200:203], v[96:99], a[184:191], v225
    v_smfmac_f32_16x16x64_bf16 v[200:203], v[100:103], a[192:199], v225
    s_waitcnt lgkmcnt(0)
    s_barrier
    ds_read_b64_tr_b16 v[124:125], v243 offset:12288
    ds_read_b64_tr_b16 v[126:127], v243 offset:12352
    ds_read_b64_tr_b16 v[132:133], v243 offset:13312
    ds_read_b64_tr_b16 v[134:135], v243 offset:13376
    ds_read_b128 v[148:151], v237 offset:26624
    ds_read_b128 v[156:159], v237 offset:28672
    v_smfmac_f32_16x16x64_bf16 v[200:203], v[104:107], a[200:207], v225
    ds_read_b64_tr_b16 v[128:129], v243 offset:12800
    ds_read_b64_tr_b16 v[130:131], v243 offset:12864
    v_smfmac_f32_16x16x64_bf16 v[200:203], v[108:111], a[208:215], v225
    ds_read_b64_tr_b16 v[136:137], v243 offset:13824
    ds_read_b64_tr_b16 v[138:139], v243 offset:13888
    v_smfmac_f32_16x16x64_bf16 v[200:203], v[112:115], a[216:223], v225
    ds_read_b128 v[152:155], v237 offset:27648
    ds_read_b128 v[160:163], v237 offset:29696
    v_smfmac_f32_16x16x64_bf16 v[200:203], v[116:119], a[224:231], v225
    ds_read_b128 v[164:167], v245 offset:22528
    ds_read_b128 v[168:171], v245 offset:23552
    v_smfmac_f32_16x16x64_bf16 v[200:203], v[120:123], a[232:239], v225
    s_waitcnt lgkmcnt(10)
    v_mfma_f32_16x16x32_bf16 v[212:215], v[132:135], v[124:127], 0
    s_waitcnt lgkmcnt(9)
    v_mfma_f32_16x16x32_bf16 v[204:207], v[148:151], v[124:127], 0
    s_waitcnt lgkmcnt(8)
    v_mfma_f32_16x16x32_bf16 v[208:211], v[156:159], v[124:127], 0
    s_waitcnt lgkmcnt(4)
    v_mfma_f32_16x16x32_bf16 v[212:215], v[136:139], v[128:131], v[212:215]
    s_waitcnt lgkmcnt(3)
    v_mfma_f32_16x16x32_bf16 v[204:207], v[152:155], v[128:131], v[204:207]
    s_waitcnt lgkmcnt(2)
    v_mfma_f32_16x16x32_bf16 v[208:211], v[160:163], v[128:131], v[208:211]
    v_permlane32_swap_b32 v200, v202
    v_permlane32_swap_b32 v201, v203
    v_add_f32 v200, v200, v202
    v_add_f32 v201, v201, v203
    v_cvt_pk_bf16_f32 v174, v200, v201
    v_cvt_pk_bf16_f32 v178, v200, v201
    v_cndmask_b32 v212, v212, v213, s[98:99]
    v_cndmask_b32 v214, v214, v215, s[98:99]
    v_cndmask_b32 v224, v212, v214, s[100:101]
    v_cndmask_b32 v220, v204, v208, s[98:99]
    v_cndmask_b32 v221, v205, v209, s[98:99]
    v_cndmask_b32 v222, v206, v210, s[98:99]
    v_cndmask_b32 v223, v207, v211, s[98:99]
    buffer_store_dwordx4 v[220:223], v237, s[4:7], s79 offen
    buffer_store_dword v224, v238, s[4:7], s79 offen offset:1024
    ds_read_b128 v[124:127], v233 offset:0
    ds_read_b128 v[128:131], v233 offset:20480
    ds_read_b128 v[140:143], v233 offset:1024
    s_waitcnt lgkmcnt(4)
    v_mfma_f32_16x16x32_bf16 v[212:215], v[132:135], v[164:167], 0
    v_mfma_f32_16x16x32_bf16 v[204:207], v[148:151], v[164:167], 0
    v_mfma_f32_16x16x32_bf16 v[208:211], v[156:159], v[164:167], 0
    s_waitcnt lgkmcnt(3)
    v_mfma_f32_16x16x32_bf16 v[212:215], v[136:139], v[168:171], v[212:215]
    ds_read_b128 v[132:135], v234 offset:0
    ds_read_b128 v[136:139], v234 offset:20480
    v_mfma_f32_16x16x32_bf16 v[204:207], v[152:155], v[168:171], v[204:207]
    v_mfma_f32_16x16x32_bf16 v[208:211], v[160:163], v[168:171], v[208:211]
    s_waitcnt lgkmcnt(4)
    v_mfma_f32_16x16x32_bf16 v[148:151], a[0:3], v[124:127], 0
    ds_read_b128 v[144:147], v233 offset:21504
    v_mfma_f32_16x16x32_bf16 v[156:159], a[80:83], v[124:127], 0
    v_mfma_f32_16x16x32_bf16 v[164:167], v[124:127], a[160:163], 0
    s_waitcnt lgkmcnt(4)
    v_mfma_f32_16x16x32_bf16 v[152:155], a[0:3], v[128:131], 0
    ds_read_b128 v[124:127], v234 offset:1024
    v_mfma_f32_16x16x32_bf16 v[160:163], a[80:83], v[128:131], 0
    v_mfma_f32_16x16x32_bf16 v[168:171], v[128:131], a[160:163], 0
    s_waitcnt lgkmcnt(3)
    v_mfma_f32_16x16x32_bf16 v[148:151], a[4:7], v[132:135], v[148:151]
    ds_read_b128 v[128:131], v234 offset:21504
    buffer_load_dwordx4 v[84:87], v237, s[4:7], s80 offen sc1
    v_mfma_f32_16x16x32_bf16 v[156:159], a[84:87], v[132:135], v[156:159]
    buffer_load_dwordx4 v[88:91], v237, s[4:7], s81 offen sc1
    buffer_load_dword v92, v238, s[4:7], s80 offen offset:1024 sc1
    v_mfma_f32_16x16x32_bf16 v[164:167], v[132:135], a[164:167], v[164:167]
    buffer_load_dword v93, v238, s[4:7], s81 offen offset:1024 sc1
    v_cndmask_b32 v212, v212, v213, s[98:99]
    s_waitcnt lgkmcnt(3)
    v_mfma_f32_16x16x32_bf16 v[152:155], a[4:7], v[136:139], v[152:155]
    ds_read_b128 v[132:135], v233 offset:2048
    v_cndmask_b32 v214, v214, v215, s[98:99]
    v_mfma_f32_16x16x32_bf16 v[160:163], a[84:87], v[136:139], v[160:163]
    v_cndmask_b32 v230, v212, v214, s[100:101]
    v_cndmask_b32 v226, v204, v208, s[98:99]
    v_mfma_f32_16x16x32_bf16 v[168:171], v[136:139], a[164:167], v[168:171]
    v_cndmask_b32 v227, v205, v209, s[98:99]
    v_cndmask_b32 v228, v206, v210, s[98:99]
    v_mfma_f32_16x16x32_bf16 v[148:151], a[8:11], v[140:143], v[148:151]
    ds_read_b128 v[136:139], v233 offset:22528
    v_cndmask_b32 v229, v207, v211, s[98:99]
    v_mfma_f32_16x16x32_bf16 v[156:159], a[88:91], v[140:143], v[156:159]
    buffer_store_dwordx4 v[226:229], v239, s[4:7], s79 offen
    v_mfma_f32_16x16x32_bf16 v[164:167], v[140:143], a[168:171], v[164:167]
    buffer_store_dword v230, v240, s[4:7], s79 offen offset:1024
    s_waitcnt lgkmcnt(4)
    v_mfma_f32_16x16x32_bf16 v[152:155], a[8:11], v[144:147], v[152:155]
    ds_read_b128 v[140:143], v234 offset:2048
    v_mfma_f32_16x16x32_bf16 v[160:163], a[88:91], v[144:147], v[160:163]
    v_mfma_f32_16x16x32_bf16 v[168:171], v[144:147], a[168:171], v[168:171]
    s_waitcnt lgkmcnt(4)
    v_mfma_f32_16x16x32_bf16 v[148:151], a[12:15], v[124:127], v[148:151]
    ds_read_b128 v[144:147], v234 offset:22528
    v_mfma_f32_16x16x32_bf16 v[156:159], a[92:95], v[124:127], v[156:159]
    v_mfma_f32_16x16x32_bf16 v[164:167], v[124:127], a[172:175], v[164:167]
    s_waitcnt vmcnt(5)
    v_max3_u32 v216, v84, v85, v86
    s_waitcnt vmcnt(4)
    v_max3_u32 v216, v216, v87, v88
    v_max3_u32 v216, v216, v89, v90
    s_waitcnt vmcnt(3)
    v_max3_u32 v216, v216, v91, v92
    s_waitcnt vmcnt(2)
    v_max_u32 v216, v216, v93
    v_cmp_eq_u32 vcc, -1, v216
    s_cbranch_vccnz Lrty_30
Lok_29:
    v_pk_add_f32 v[84:85], v[84:85], v[88:89]
    v_pk_add_f32 v[86:87], v[86:87], v[90:91]
    v_add_f32 v92, v92, v93
    v_pk_add_f32 v[220:221], v[220:221], v[84:85]
    v_pk_add_f32 v[222:223], v[222:223], v[86:87]
    v_add_f32 v224, v224, v92
    v_max3_f32 v216, v220, v221, v222
    v_max3_f32 v216, v216, v223, v224
    buffer_load_dwordx4 v[108:111], v239, s[4:7], s80 offen sc1
    buffer_load_dwordx4 v[112:115], v239, s[4:7], s81 offen sc1
    v_max_f32_dpp v216, v216, v216 row_ror:8 row_mask:0xf bank_mask:0xf
    v_mov_b32 v217, v216
    buffer_load_dword v116, v240, s[4:7], s80 offen offset:1024 sc1
    buffer_load_dword v117, v240, s[4:7], s81 offen offset:1024 sc1
    v_permlane16_swap_b32 v216, v217
    v_max_f32 v216, v216, v217
    v_mov_b32 v217, v216
    v_mov_b64 v[204:205], 0
    v_mov_b64 v[206:207], 0
    v_permlane32_swap_b32 v216, v217
    v_max_f32 v216, v216, v217
    v_mul_f32 v216, s70, v216
    v_fma_f32 v224, v224, s70, -v216
    v_fma_f32 v220, v220, s70, -v216
    v_fma_f32 v221, v221, s70, -v216
    v_fma_f32 v222, v222, s70, -v216
    v_fma_f32 v223, v223, s70, -v216
    v_exp_f32 v224, v224
    v_exp_f32 v220, v220
    v_exp_f32 v221, v221
    v_exp_f32 v222, v222
    v_exp_f32 v223, v223
    v_cvt_pk_bf16_f32 v190, v224, v224
    v_cvt_pk_bf16_f32 v188, v220, v221
    v_and_b32 v190, v231, v190
    v_cvt_pk_bf16_f32 v189, v222, v223
    v_mov_b64 v[208:209], 0
    v_mov_b64 v[210:211], 0
    v_mfma_f32_16x16x32_bf16 v[200:203], v[184:187], v[188:191], 0
    v_mfma_f32_16x16x32_bf16 v[192:195], v[172:175], v[188:191], 0
    v_mfma_f32_16x16x32_bf16 v[196:199], v[176:179], v[188:191], 0
    s_xor_b32 s88, s72, 524288
    s_xor_b32 s89, s79, 524288
    s_nop 3
    v_add_f32_dpp v200, v200, v200 row_ror:8 row_mask:0xf bank_mask:0xf
    v_rcp_f32 v200, v200
    v_add_f32_dpp v192, v196, v192 row_ror:8 row_mask:0xf bank_mask:0xf
    v_add_f32_dpp v193, v197, v193 row_ror:8 row_mask:0xf bank_mask:0xf
    v_add_f32_dpp v194, v198, v194 row_ror:8 row_mask:0xf bank_mask:0xf
    v_add_f32_dpp v195, v199, v195 row_ror:8 row_mask:0xf bank_mask:0xf
    v_pk_mul_f32 v[192:193], v[192:193], v[200:201] op_sel_hi:[1,0]
    v_pk_mul_f32 v[194:195], v[194:195], v[200:201] op_sel_hi:[1,0]
    v_cvt_pk_bf16_f32 v192, v192, v193
    v_cvt_pk_bf16_f32 v193, v194, v195
    v_min_u32 v192, -2, v192
    v_min_u32 v193, -2, v193
    buffer_store_dwordx2 v[192:193], v248, s[4:7], s72 offen
    s_waitcnt vmcnt(4)
    v_max3_u32 v216, v108, v109, v110
    s_waitcnt vmcnt(3)
    v_max3_u32 v216, v216, v111, v112
    v_max3_u32 v216, v216, v113, v114
    s_waitcnt vmcnt(2)
    v_max3_u32 v216, v216, v115, v116
    s_waitcnt vmcnt(1)
    v_max_u32 v216, v216, v117
    v_cmp_eq_u32 vcc, -1, v216
    s_cbranch_vccnz Lrty_32
Lok_31:
    s_waitcnt lgkmcnt(4)
    v_mfma_f32_16x16x32_bf16 v[152:155], a[12:15], v[128:131], v[152:155]
    ds_read_b128 v[124:127], v233 offset:3072
    v_add_f32 v108, v108, v112
    v_mfma_f32_16x16x32_bf16 v[160:163], a[92:95], v[128:131], v[160:163]
    v_add_f32 v109, v109, v113
    v_add_f32 v110, v110, v114
    v_add_f32 v111, v111, v115
    v_mfma_f32_16x16x32_bf16 v[168:171], v[128:131], a[172:175], v[168:171]
    v_add_f32 v116, v116, v117
    v_add_f32 v226, v226, v108
    v_add_f32 v227, v227, v109
    s_waitcnt lgkmcnt(4)
    v_mfma_f32_16x16x32_bf16 v[148:151], a[16:19], v[132:135], v[148:151]
    ds_read_b128 v[128:131], v233 offset:23552
    v_add_f32 v228, v228, v110
    v_mfma_f32_16x16x32_bf16 v[156:159], a[96:99], v[132:135], v[156:159]
    v_add_f32 v229, v229, v111
    v_add_f32 v230, v230, v116
    v_mov_b32 v216, s71
    v_mfma_f32_16x16x32_bf16 v[164:167], v[132:135], a[176:179], v[164:167]
    buffer_load_dwordx4 v[84:87], v249, s[4:7], s85 offen offset:0 sc1
    v_cndmask_b32 v226, v226, v216, s[90:91]
    v_cndmask_b32 v227, v227, v216, s[92:93]
    s_waitcnt lgkmcnt(4)
    v_mfma_f32_16x16x32_bf16 v[152:155], a[16:19], v[136:139], v[152:155]
    ds_read_b128 v[132:135], v234 offset:3072
    v_cndmask_b32 v228, v228, v216, s[94:95]
    v_mfma_f32_16x16x32_bf16 v[160:163], a[96:99], v[136:139], v[160:163]
    buffer_load_dwordx4 v[88:91], v249, s[4:7], s85 offen offset:1024 sc1
    v_cndmask_b32 v229, v229, v216, s[96:97]
    v_max3_f32 v216, v226, v227, v228
    v_mfma_f32_16x16x32_bf16 v[168:171], v[136:139], a[176:179], v[168:171]
    v_max3_f32 v216, v216, v229, v230
    buffer_load_dwordx4 v[92:95], v249, s[4:7], s85 offen offset:2048 sc1
    s_nop 0
    v_max_f32_dpp v216, v216, v216 row_ror:8 row_mask:0xf bank_mask:0xf
    s_waitcnt lgkmcnt(4)
    v_mfma_f32_16x16x32_bf16 v[148:151], a[20:23], v[140:143], v[148:151]
    ds_read_b128 v[136:139], v234 offset:23552
    v_mov_b32 v217, v216
    v_mfma_f32_16x16x32_bf16 v[156:159], a[100:103], v[140:143], v[156:159]
    s_nop 0
    v_permlane16_swap_b32 v216, v217
    buffer_load_dwordx4 v[96:99], v249, s[4:7], s85 offen offset:3072 sc1
    v_mfma_f32_16x16x32_bf16 v[164:167], v[140:143], a[180:183], v[164:167]
    v_max_f32 v216, v216, v217
    v_mov_b32 v217, v216
    s_waitcnt lgkmcnt(4)
    v_mfma_f32_16x16x32_bf16 v[152:155], a[20:23], v[144:147], v[152:155]
    ds_read_b128 v[140:143], v233 offset:4096
    v_permlane32_swap_b32 v216, v217
    v_mfma_f32_16x16x32_bf16 v[160:163], a[100:103], v[144:147], v[160:163]
    buffer_load_dwordx4 v[100:103], v249, s[4:7], s86 offen offset:0 sc1
    v_max_f32 v216, v216, v217
    v_mul_f32 v216, s70, v216
    v_mfma_f32_16x16x32_bf16 v[168:171], v[144:147], a[180:183], v[168:171]
    v_fma_f32 v230, v230, s70, -v216
    buffer_load_dwordx4 v[104:107], v249, s[4:7], s86 offen offset:1024 sc1
    s_waitcnt lgkmcnt(4)
    v_mfma_f32_16x16x32_bf16 v[148:151], a[24:27], v[124:127], v[148:151]
    ds_read_b128 v[144:147], v233 offset:24576
    v_fma_f32 v226, v226, s70, -v216
    v_fma_f32 v227, v227, s70, -v216
    v_mfma_f32_16x16x32_bf16 v[156:159], a[104:107], v[124:127], v[156:159]
    v_fma_f32 v228, v228, s70, -v216
    v_fma_f32 v229, v229, s70, -v216
    v_mfma_f32_16x16x32_bf16 v[164:167], v[124:127], a[184:187], v[164:167]
    v_exp_f32 v230, v230
    s_waitcnt lgkmcnt(4)
    v_mfma_f32_16x16x32_bf16 v[152:155], a[24:27], v[128:131], v[152:155]
    ds_read_b128 v[124:127], v234 offset:4096
    v_exp_f32 v226, v226
    v_mfma_f32_16x16x32_bf16 v[160:163], a[104:107], v[128:131], v[160:163]
    v_exp_f32 v227, v227
    v_mfma_f32_16x16x32_bf16 v[168:171], v[128:131], a[184:187], v[168:171]
    v_exp_f32 v228, v228
    v_exp_f32 v229, v229
    s_waitcnt lgkmcnt(4)
    v_mfma_f32_16x16x32_bf16 v[148:151], a[28:31], v[132:135], v[148:151]
    ds_read_b128 v[128:131], v234 offset:24576
    v_cvt_pk_bf16_f32 v198, v230, v230
    v_cvt_pk_bf16_f32 v196, v226, v227
    v_mfma_f32_16x16x32_bf16 v[156:159], a[108:111], v[132:135], v[156:159]
    v_cvt_pk_bf16_f32 v197, v228, v229
    v_mfma_f32_16x16x32_bf16 v[164:167], v[132:135], a[188:191], v[164:167]
    ds_write_b16 v247, v198 offset:14344
    ds_write_b64 v246, v[196:197] offset:14336
Lwchk_33:
    s_waitcnt vmcnt(5)
    v_max3_u32 v192, v84, v85, v86
    v_max_u32 v192, v192, v87
    v_cmp_lt_u32 vcc, s87, v192
    s_cbranch_vccnz Lwrty_34
    v_smfmac_f32_16x16x64_bf16 v[204:207], v[84:87], a[240:247], v225
    v_smfmac_f32_16x16x64_bf16 v[208:211], v[84:87], a[248:255], v225
Lwchk_35:
    s_waitcnt vmcnt(4)
    v_max3_u32 v192, v88, v89, v90
    v_max_u32 v192, v192, v91
    v_cmp_lt_u32 vcc, s87, v192
    s_cbranch_vccnz Lwrty_36
    v_smfmac_f32_16x16x64_bf16 v[204:207], v[88:91], v[4:11], v225
    v_smfmac_f32_16x16x64_bf16 v[208:211], v[88:91], v[12:19], v225
Lwchk_37:
    s_waitcnt vmcnt(3)
    v_max3_u32 v192, v92, v93, v94
    v_max_u32 v192, v192, v95
    v_cmp_lt_u32 vcc, s87, v192
    s_cbranch_vccnz Lwrty_38
    v_smfmac_f32_16x16x64_bf16 v[204:207], v[92:95], v[20:27], v225
    v_smfmac_f32_16x16x64_bf16 v[208:211], v[92:95], v[28:35], v225
Lwchk_39:
    s_waitcnt vmcnt(2)
    v_max3_u32 v192, v96, v97, v98
    v_max_u32 v192, v192, v99
    v_cmp_lt_u32 vcc, s87, v192
    s_cbranch_vccnz Lwrty_40
    v_smfmac_f32_16x16x64_bf16 v[204:207], v[96:99], v[36:43], v225
    v_smfmac_f32_16x16x64_bf16 v[208:211], v[96:99], v[44:51], v225
Lwchk_41:
    s_waitcnt vmcnt(1)
    v_max3_u32 v192, v100, v101, v102
    v_max_u32 v192, v192, v103
    v_cmp_lt_u32 vcc, s87, v192
    s_cbranch_vccnz Lwrty_42
    v_smfmac_f32_16x16x64_bf16 v[204:207], v[100:103], v[52:59], v225
    v_smfmac_f32_16x16x64_bf16 v[208:211], v[100:103], v[60:67], v225
Lwchk_43:
    s_waitcnt vmcnt(0)
    v_max3_u32 v192, v104, v105, v106
    v_max_u32 v192, v192, v107
    v_cmp_lt_u32 vcc, s87, v192
    s_cbranch_vccnz Lwrty_44
    v_smfmac_f32_16x16x64_bf16 v[204:207], v[104:107], v[68:75], v225
    v_smfmac_f32_16x16x64_bf16 v[208:211], v[104:107], v[76:83], v225
    s_lshr_b32 s65, s72, 2
    s_and_b32 s65, s65, 0xf0000
    s_xor_b32 s82, s65, 262144
    s_xor_b32 s83, s65, 524288
    s_xor_b32 s84, s65, 786432
    s_nop 2
    v_permlane32_swap_b32 v204, v208
    v_permlane32_swap_b32 v205, v209
    v_permlane32_swap_b32 v206, v210
    v_permlane32_swap_b32 v207, v211
    v_pk_add_f32 v[204:205], v[204:205], v[208:209]
    v_pk_add_f32 v[206:207], v[206:207], v[210:211]
    ds_write2_b32 v250, v204, v205 offset0:0 offset1:32
    ds_write2_b32 v250, v206, v207 offset0:64 offset1:96
    s_waitcnt lgkmcnt(8)
    v_mfma_f32_16x16x32_bf16 v[152:155], a[28:31], v[136:139], v[152:155]
    ds_read_b128 v[132:135], v233 offset:5120
    v_mfma_f32_16x16x32_bf16 v[160:163], a[108:111], v[136:139], v[160:163]
    v_mfma_f32_16x16x32_bf16 v[168:171], v[136:139], a[188:191], v[168:171]
    s_waitcnt lgkmcnt(8)
    v_mfma_f32_16x16x32_bf16 v[148:151], a[32:35], v[140:143], v[148:151]
    ds_read_b128 v[136:139], v233 offset:25600
    s_waitcnt lgkmcnt(2)
    s_barrier
    ds_read_b128 v[96:99], v237 offset:18432
    ds_read_b128 v[100:103], v237 offset:19456
    ds_read_b128 v[104:107], v237 offset:20480
    ds_read_b128 v[108:111], v237 offset:21504
    v_mfma_f32_16x16x32_bf16 v[156:159], a[112:115], v[140:143], v[156:159]
    ds_read_b64 v[120:121], v241 offset:16896
    ds_read_b128 v[112:115], v237 offset:14336
    v_mfma_f32_16x16x32_bf16 v[164:167], v[140:143], a[192:195], v[164:167]
    ds_read_b128 v[116:119], v237 offset:15872
    v_mfma_f32_16x16x32_bf16 v[152:155], a[32:35], v[144:147], v[152:155]
    ds_read_b128 v[140:143], v234 offset:5120
    v_mfma_f32_16x16x32_bf16 v[160:163], a[112:115], v[144:147], v[160:163]
    v_mfma_f32_16x16x32_bf16 v[168:171], v[144:147], a[192:195], v[168:171]
    s_waitcnt lgkmcnt(6)
    v_pk_add_f32 v[96:97], v[96:97], v[100:101]
    v_pk_add_f32 v[98:99], v[98:99], v[102:103]
    s_waitcnt lgkmcnt(4)
    v_pk_add_f32 v[104:105], v[104:105], v[108:109]
    v_pk_add_f32 v[106:107], v[106:107], v[110:111]
    v_pk_add_f32 v[96:97], v[96:97], v[104:105]
    v_pk_add_f32 v[98:99], v[98:99], v[106:107]
    buffer_store_dwordx4 v[96:99], v252, s[4:7], s65 offen sc1
    s_waitcnt lgkmcnt(3)
    v_mfma_f32_16x16x16_bf16 v[204:207], v[184:185], v[120:121], 0
    v_mfma_f32_16x16x16_bf16 v[196:199], v[176:177], v[120:121], 0
    s_waitcnt lgkmcnt(2)
    v_mfma_f32_16x16x32_bf16 v[200:203], v[184:187], v[112:115], 0
    v_mfma_f32_16x16x32_bf16 v[192:195], v[172:175], v[112:115], 0
    v_mfma_f32_16x16x32_bf16 v[148:151], a[36:39], v[124:127], v[148:151]
    ds_read_b128 v[144:147], v234 offset:25600
    v_mfma_f32_16x16x32_bf16 v[156:159], a[116:119], v[124:127], v[156:159]
    v_mfma_f32_16x16x32_bf16 v[164:167], v[124:127], a[196:199], v[164:167]
    s_waitcnt lgkmcnt(2)
    v_mfma_f32_16x16x32_bf16 v[204:207], v[184:187], v[116:119], v[204:207]
    v_mfma_f32_16x16x32_bf16 v[196:199], v[172:175], v[116:119], v[196:199]
    v_mfma_f32_16x16x32_bf16 v[152:155], a[36:39], v[128:131], v[152:155]
    ds_read_b128 v[124:127], v233 offset:6144
    v_mfma_f32_16x16x32_bf16 v[160:163], a[116:119], v[128:131], v[160:163]
    buffer_load_dwordx4 v232, s[4:7], s74 offen offset:512 sc1 lds
    s_add_u32 m0, s73, 4480
    v_mfma_f32_16x16x32_bf16 v[168:171], v[128:131], a[196:199], v[168:171]
    v_rcp_f32 v200, v200
    s_nop 0
    v_mul_f32 v192, v192, v200
    v_mul_f32 v193, v193, v200
    v_mfma_f32_16x16x32_bf16 v[148:151], a[40:43], v[132:135], v[148:151]
    ds_read_b128 v[128:131], v233 offset:26624
    v_mul_f32 v194, v194, v200
    v_mfma_f32_16x16x32_bf16 v[156:159], a[120:123], v[132:135], v[156:159]
    buffer_load_dwordx4 v232, s[4:7], s74 offen offset:640 sc1 lds
    s_add_u32 m0, s73, 5376
    v_mfma_f32_16x16x32_bf16 v[164:167], v[132:135], a[200:203], v[164:167]
    v_mul_f32 v195, v195, v200
    v_cvt_pk_bf16_f32 v208, v192, v193
    v_mfma_f32_16x16x32_bf16 v[152:155], a[40:43], v[136:139], v[152:155]
    ds_read_b128 v[132:135], v234 offset:6144
    v_cvt_pk_bf16_f32 v209, v194, v195
    v_mfma_f32_16x16x32_bf16 v[160:163], a[120:123], v[136:139], v[160:163]
    v_rcp_f32 v204, v204
    s_nop 0
    v_mul_f32 v196, v196, v204
    v_mfma_f32_16x16x32_bf16 v[168:171], v[136:139], a[200:203], v[168:171]
    v_mul_f32 v197, v197, v204
    v_mul_f32 v198, v198, v204
    buffer_load_dwordx4 v[100:103], v252, s[4:7], s82 offen sc1
    buffer_load_dwordx4 v[104:107], v252, s[4:7], s83 offen sc1
    buffer_load_dwordx4 v[108:111], v252, s[4:7], s84 offen sc1
    s_waitcnt lgkmcnt(4)
    v_mfma_f32_16x16x32_bf16 v[148:151], a[44:47], v[140:143], v[148:151]
    ds_read_b128 v[136:139], v234 offset:26624
    v_mul_f32 v199, v199, v204
    v_mfma_f32_16x16x32_bf16 v[156:159], a[124:127], v[140:143], v[156:159]
    buffer_load_dwordx4 v232, s[4:7], s74 offen offset:768 sc1 lds
    s_add_u32 m0, s73, 6272
    v_mfma_f32_16x16x32_bf16 v[164:167], v[140:143], a[204:207], v[164:167]
    v_cvt_pk_bf16_f32 v210, v196, v197
    v_cvt_pk_bf16_f32 v211, v198, v199
    s_waitcnt lgkmcnt(4)
    v_mfma_f32_16x16x32_bf16 v[152:155], a[44:47], v[144:147], v[152:155]
    ds_read_b128 v[140:143], v233 offset:7168
    v_mfma_f32_16x16x32_bf16 v[160:163], a[124:127], v[144:147], v[160:163]
    buffer_load_dwordx4 v232, s[4:7], s74 offen offset:896 sc1 lds
    s_add_u32 m0, s73, 7168
    v_mfma_f32_16x16x32_bf16 v[168:171], v[144:147], a[204:207], v[168:171]
    v_permlane32_swap_b32 v208, v210
    s_waitcnt lgkmcnt(4)
    v_mfma_f32_16x16x32_bf16 v[148:151], a[48:51], v[124:127], v[148:151]
    ds_read_b128 v[144:147], v233 offset:27648
    v_permlane32_swap_b32 v209, v211
    v_mfma_f32_16x16x32_bf16 v[156:159], a[128:131], v[124:127], v[156:159]
    buffer_load_dwordx4 v232, s[4:7], s74 offen offset:1024 sc1 lds
    s_add_u32 m0, s73, 8064
    v_mfma_f32_16x16x32_bf16 v[164:167], v[124:127], a[208:211], v[164:167]
    buffer_store_dwordx4 v[208:211], v253, s[4:7], s75 offen
    s_waitcnt lgkmcnt(4)
    v_mfma_f32_16x16x32_bf16 v[152:155], a[48:51], v[128:131], v[152:155]
    ds_read_b128 v[124:127], v234 offset:7168
    v_mfma_f32_16x16x32_bf16 v[160:163], a[128:131], v[128:131], v[160:163]
    buffer_load_dwordx4 v232, s[4:7], s74 offen offset:1152 sc1 lds
    v_mfma_f32_16x16x32_bf16 v[168:171], v[128:131], a[208:211], v[168:171]
    s_cmp_eq_u32 s62, 63
    s_cbranch_scc1 L_Clast
    s_waitcnt lgkmcnt(4)
    v_mfma_f32_16x16x32_bf16 v[148:151], a[52:55], v[132:135], v[148:151]
    ds_read_b128 v[128:131], v234 offset:27648
    v_mfma_f32_16x16x32_bf16 v[156:159], a[132:135], v[132:135], v[156:159]
    buffer_store_dwordx4 v[180:183], v239, s[4:7], s89 offen
    v_mfma_f32_16x16x32_bf16 v[164:167], v[132:135], a[212:215], v[164:167]
    buffer_store_dword v180, v240, s[4:7], s89 offen offset:1024
    buffer_store_dwordx2 v[180:181], v248, s[4:7], s88 offen
    s_waitcnt lgkmcnt(4)
    v_mfma_f32_16x16x32_bf16 v[152:155], a[52:55], v[136:139], v[152:155]
    ds_read_b128 v[132:135], v233 offset:8192
    v_mfma_f32_16x16x32_bf16 v[160:163], a[132:135], v[136:139], v[160:163]
    buffer_store_dwordx4 v[180:183], v237, s[4:7], s89 offen
    v_mfma_f32_16x16x32_bf16 v[168:171], v[136:139], a[212:215], v[168:171]
    buffer_store_dword v180, v238, s[4:7], s89 offen offset:1024
    v_mov_b64 v[192:193], 0
    s_waitcnt lgkmcnt(4)
    v_mfma_f32_16x16x32_bf16 v[148:151], a[56:59], v[140:143], v[148:151]
    ds_read_b128 v[136:139], v233 offset:28672
    v_mov_b64 v[194:195], 0
    v_mfma_f32_16x16x32_bf16 v[156:159], a[136:139], v[140:143], v[156:159]
    v_mov_b64 v[196:197], 0
    v_mov_b64 v[198:199], 0
    v_mfma_f32_16x16x32_bf16 v[164:167], v[140:143], a[216:219], v[164:167]
    v_mov_b64 v[200:201], 0
    v_mov_b64 v[202:203], 0
    s_waitcnt lgkmcnt(4)
    v_mfma_f32_16x16x32_bf16 v[152:155], a[56:59], v[144:147], v[152:155]
    ds_read_b128 v[140:143], v234 offset:8192
    s_add_u32 s75, s75, 393216
    v_mfma_f32_16x16x32_bf16 v[160:163], a[136:139], v[144:147], v[160:163]
    s_add_u32 s66, s62, 1
    v_mfma_f32_16x16x32_bf16 v[168:171], v[144:147], a[216:219], v[168:171]
    s_and_b32 s66, s66, 7
    s_cselect_b32 s66, 0, 3145728
    s_sub_u32 s75, s75, s66
    s_waitcnt vmcnt(12)
    v_max3_u32 v112, v100, v101, v102
    s_waitcnt vmcnt(11)
    v_max3_u32 v112, v112, v103, v104
    v_max3_u32 v112, v112, v105, v106
    s_waitcnt vmcnt(10)
    v_max3_u32 v112, v112, v107, v108
    v_max3_u32 v112, v112, v109, v110
    v_max_u32 v112, v112, v111
    v_cmp_eq_u32 vcc, -1, v112
    s_cbranch_vccnz Lrty_46
Lok_45:
    v_pk_add_f32 v[96:97], v[96:97], v[100:101]
    v_pk_add_f32 v[98:99], v[98:99], v[102:103]
    v_pk_add_f32 v[104:105], v[104:105], v[108:109]
    v_pk_add_f32 v[106:107], v[106:107], v[110:111]
    v_pk_add_f32 v[96:97], v[96:97], v[104:105]
    v_pk_add_f32 v[98:99], v[98:99], v[106:107]
    v_cvt_pk_bf16_f32 v96, v96, v97
    v_cvt_pk_bf16_f32 v97, v98, v99
    v_min_u32 v96, -2, v96
    v_min_u32 v97, -2, v97
    buffer_store_dwordx2 v[96:97], v251, s[4:7], s72 offen
    s_waitcnt lgkmcnt(4)
    v_mfma_f32_16x16x32_bf16 v[148:151], a[60:63], v[124:127], v[148:151]
    ds_read_b128 v[144:147], v234 offset:28672
    v_mfma_f32_16x16x32_bf16 v[156:159], a[140:143], v[124:127], v[156:159]
    v_mfma_f32_16x16x32_bf16 v[164:167], v[124:127], a[220:223], v[164:167]
    s_waitcnt lgkmcnt(4)
    v_mfma_f32_16x16x32_bf16 v[152:155], a[60:63], v[128:131], v[152:155]
    ds_read_b128 v[124:127], v233 offset:9216
    s_add_u32 s64, s62, 1
    v_mov_b32 v3, s64
    s_mov_b64 exec, 1
    s_waitcnt vmcnt(7)
    buffer_store_dword v3, off, s[4:7], s3
    s_mov_b64 exec, -1
    v_mfma_f32_16x16x32_bf16 v[160:163], a[140:143], v[128:131], v[160:163]
    s_add_u32 s82, s72, 178176
    s_add_u32 s83, s72, 182272
    s_add_u32 s86, s72, 262144
    v_mfma_f32_16x16x32_bf16 v[168:171], v[128:131], a[220:223], v[168:171]
    s_and_b32 s86, s86, 786432
    s_andn2_b32 s72, s72, 786432
    s_waitcnt lgkmcnt(4)
    v_mfma_f32_16x16x32_bf16 v[148:151], a[64:67], v[132:135], v[148:151]
    ds_read_b128 v[128:131], v233 offset:29696
    s_or_b32 s72, s72, s86
    v_mfma_f32_16x16x32_bf16 v[156:159], a[144:147], v[132:135], v[156:159]
    s_add_u32 s74, s74, 40960
    s_xor_b32 s73, s73, 65536
    s_add_u32 s62, s62, 1
    s_branch L_Ctop3
Lrty_28:
    buffer_load_dwordx4 v[84:87], v235, s[4:7], s82 offen sc1
    buffer_load_dwordx4 v[88:91], v235, s[4:7], s83 offen sc1
    buffer_load_dwordx2 v[92:93], v236, s[4:7], s82 offen sc1
    s_sub_u32 s61, s61, 1
    s_mov_b32 s67, 15
    s_cbranch_scc1 L_fail
    s_waitcnt vmcnt(2)
    v_max3_u32 v96, v84, v85, v86
    s_waitcnt vmcnt(1)
    v_max3_u32 v96, v96, v87, v88
    v_max3_u32 v96, v96, v89, v90
    s_waitcnt vmcnt(0)
    v_max3_u32 v96, v96, v91, v92
    v_max_u32 v96, v96, v93
    v_cmp_eq_u32 vcc, -1, v96
    s_cbranch_vccnz Lrty_28
    ds_write_b128 v235, v[84:87] offset:0
    ds_write_b128 v235, v[88:91] offset:4096
    ds_write_b64 v236, v[92:93] offset:0
    s_branch Lok_27
Lrty_30:
    buffer_load_dwordx4 v[84:87], v237, s[4:7], s80 offen sc1
    buffer_load_dwordx4 v[88:91], v237, s[4:7], s81 offen sc1
    buffer_load_dword v92, v238, s[4:7], s80 offen offset:1024 sc1
    buffer_load_dword v93, v238, s[4:7], s81 offen offset:1024 sc1
    s_sub_u32 s61, s61, 1
    s_mov_b32 s67, 11
    s_cbranch_scc1 L_fail
    s_waitcnt vmcnt(3)
    v_max3_u32 v216, v84, v85, v86
    s_waitcnt vmcnt(2)
    v_max3_u32 v216, v216, v87, v88
    v_max3_u32 v216, v216, v89, v90
    s_waitcnt vmcnt(1)
    v_max3_u32 v216, v216, v91, v92
    s_waitcnt vmcnt(0)
    v_max_u32 v216, v216, v93
    v_cmp_eq_u32 vcc, -1, v216
    s_cbranch_vccnz Lrty_30
    s_branch Lok_29
Lrty_32:
    buffer_load_dwordx4 v[108:111], v239, s[4:7], s80 offen sc1
    buffer_load_dwordx4 v[112:115], v239, s[4:7], s81 offen sc1
    buffer_load_dword v116, v240, s[4:7], s80 offen offset:1024 sc1
    buffer_load_dword v117, v240, s[4:7], s81 offen offset:1024 sc1
    s_sub_u32 s61, s61, 1
    s_mov_b32 s67, 12
    s_cbranch_scc1 L_fail
    s_waitcnt vmcnt(3)
    v_max3_u32 v216, v108, v109, v110
    s_waitcnt vmcnt(2)
    v_max3_u32 v216, v216, v111, v112
    v_max3_u32 v216, v216, v113, v114
    s_waitcnt vmcnt(1)
    v_max3_u32 v216, v216, v115, v116
    s_waitcnt vmcnt(0)
    v_max_u32 v216, v216, v117
    v_cmp_eq_u32 vcc, -1, v216
    s_cbranch_vccnz Lrty_32
    s_branch Lok_31
Lwrty_34:
    buffer_load_dwordx4 v[84:87], v249, s[4:7], s85 offen offset:0 sc1
    buffer_load_dwordx4 v[88:91], v249, s[4:7], s85 offen offset:1024 sc1
    buffer_load_dwordx4 v[92:95], v249, s[4:7], s85 offen offset:2048 sc1
    buffer_load_dwordx4 v[96:99], v249, s[4:7], s85 offen offset:3072 sc1
    buffer_load_dwordx4 v[100:103], v249, s[4:7], s86 offen offset:0 sc1
    buffer_load_dwordx4 v[104:107], v249, s[4:7], s86 offen offset:1024 sc1
    s_sub_u32 s61, s61, 1
    s_mov_b32 s67, 13
    s_cbranch_scc1 L_fail
    s_branch Lwchk_33
Lwrty_36:
    buffer_load_dwordx4 v[88:91], v249, s[4:7], s85 offen offset:1024 sc1
    buffer_load_dwordx4 v[92:95], v249, s[4:7], s85 offen offset:2048 sc1
    buffer_load_dwordx4 v[96:99], v249, s[4:7], s85 offen offset:3072 sc1
    buffer_load_dwordx4 v[100:103], v249, s[4:7], s86 offen offset:0 sc1
    buffer_load_dwordx4 v[104:107], v249, s[4:7], s86 offen offset:1024 sc1
    s_sub_u32 s61, s61, 1
    s_mov_b32 s67, 13
    s_cbranch_scc1 L_fail
    s_branch Lwchk_35
Lwrty_38:
    buffer_load_dwordx4 v[92:95], v249, s[4:7], s85 offen offset:2048 sc1
    buffer_load_dwordx4 v[96:99], v249, s[4:7], s85 offen offset:3072 sc1
    buffer_load_dwordx4 v[100:103], v249, s[4:7], s86 offen offset:0 sc1
    buffer_load_dwordx4 v[104:107], v249, s[4:7], s86 offen offset:1024 sc1
    s_sub_u32 s61, s61, 1
    s_mov_b32 s67, 13
    s_cbranch_scc1 L_fail
    s_branch Lwchk_37
Lwrty_40:
    buffer_load_dwordx4 v[96:99], v249, s[4:7], s85 offen offset:3072 sc1
    buffer_load_dwordx4 v[100:103], v249, s[4:7], s86 offen offset:0 sc1
    buffer_load_dwordx4 v[104:107], v249, s[4:7], s86 offen offset:1024 sc1
    s_sub_u32 s61, s61, 1
    s_mov_b32 s67, 13
    s_cbranch_scc1 L_fail
    s_branch Lwchk_39
Lwrty_42:
    buffer_load_dwordx4 v[100:103], v249, s[4:7], s86 offen offset:0 sc1
    buffer_load_dwordx4 v[104:107], v249, s[4:7], s86 offen offset:1024 sc1
    s_sub_u32 s61, s61, 1
    s_mov_b32 s67, 13
    s_cbranch_scc1 L_fail
    s_branch Lwchk_41
Lwrty_44:
    buffer_load_dwordx4 v[104:107], v249, s[4:7], s86 offen offset:1024 sc1
    s_sub_u32 s61, s61, 1
    s_mov_b32 s67, 13
    s_cbranch_scc1 L_fail
    s_branch Lwchk_43
Lrty_46:
    buffer_load_dwordx4 v[100:103], v252, s[4:7], s82 offen sc1
    buffer_load_dwordx4 v[104:107], v252, s[4:7], s83 offen sc1
    buffer_load_dwordx4 v[108:111], v252, s[4:7], s84 offen sc1
    s_sub_u32 s61, s61, 1
    s_mov_b32 s67, 14
    s_cbranch_scc1 L_fail
    s_waitcnt vmcnt(2)
    v_max3_u32 v112, v100, v101, v102
    s_waitcnt vmcnt(1)
    v_max3_u32 v112, v112, v103, v104
    v_max3_u32 v112, v112, v105, v106
    s_waitcnt vmcnt(0)
    v_max3_u32 v112, v112, v107, v108
    v_max3_u32 v112, v112, v109, v110
    v_max_u32 v112, v112, v111
    v_cmp_eq_u32 vcc, -1, v112
    s_cbranch_vccnz Lrty_46
    s_branch Lok_45
L_Ctop0:
    v_mfma_f32_16x16x32_bf16 v[164:167], v[132:135], a[224:227], v[164:167]
    buffer_load_dwordx4 v[84:87], v235, s[4:7], s82 offen sc1
    buffer_load_dwordx4 v[88:91], v235, s[4:7], s83 offen sc1
    s_waitcnt lgkmcnt(4)
    v_mfma_f32_16x16x32_bf16 v[152:155], a[64:67], v[136:139], v[152:155]
    ds_read_b128 v[132:135], v234 offset:9216
    buffer_load_dwordx2 v[92:93], v236, s[4:7], s82 offen sc1
    v_mfma_f32_16x16x32_bf16 v[160:163], a[144:147], v[136:139], v[160:163]
    v_mfma_f32_16x16x32_bf16 v[168:171], v[136:139], a[224:227], v[168:171]
    s_waitcnt lgkmcnt(4)
    v_mfma_f32_16x16x32_bf16 v[148:151], a[68:71], v[140:143], v[148:151]
    ds_read_b128 v[136:139], v234 offset:29696
    v_mfma_f32_16x16x32_bf16 v[156:159], a[148:151], v[140:143], v[156:159]
    v_mfma_f32_16x16x32_bf16 v[164:167], v[140:143], a[228:231], v[164:167]
    s_waitcnt lgkmcnt(4)
    v_mfma_f32_16x16x32_bf16 v[152:155], a[68:71], v[144:147], v[152:155]
    v_mfma_f32_16x16x32_bf16 v[160:163], a[148:151], v[144:147], v[160:163]
    v_mfma_f32_16x16x32_bf16 v[168:171], v[144:147], a[228:231], v[168:171]
    s_waitcnt lgkmcnt(3)
    v_mfma_f32_16x16x32_bf16 v[148:151], a[72:75], v[124:127], v[148:151]
    v_mfma_f32_16x16x32_bf16 v[156:159], a[152:155], v[124:127], v[156:159]
    s_waitcnt vmcnt(2)
    ds_write_b128 v235, v[84:87] offset:0
    s_waitcnt vmcnt(1)
    ds_write_b128 v235, v[88:91] offset:4096
    s_waitcnt vmcnt(0)
    ds_write_b64 v236, v[92:93] offset:0
    v_max3_u32 v96, v84, v85, v86
    v_max3_u32 v96, v96, v87, v88
    v_max3_u32 v96, v96, v89, v90
    v_max3_u32 v96, v96, v91, v92
    v_max_u32 v96, v96, v93
    v_cmp_eq_u32 vcc, -1, v96
    s_cbranch_vccnz Lrty_48
Lok_47:
    v_mfma_f32_16x16x32_bf16 v[164:167], v[124:127], a[232:235], v[164:167]
    s_waitcnt lgkmcnt(5)
    v_mfma_f32_16x16x32_bf16 v[152:155], a[72:75], v[128:131], v[152:155]
    v_mfma_f32_16x16x32_bf16 v[160:163], a[152:155], v[128:131], v[160:163]
    v_mfma_f32_16x16x32_bf16 v[168:171], v[128:131], a[232:235], v[168:171]
L_Cin0:
    s_waitcnt lgkmcnt(0)
    s_barrier
    ds_read_b128 v[84:87], v237 offset:0
    ds_read_b128 v[88:91], v237 offset:1024
    ds_read_b128 v[92:95], v237 offset:2048
    v_mfma_f32_16x16x32_bf16 v[148:151], a[76:79], v[132:135], v[148:151]
    ds_read_b128 v[96:99], v237 offset:3072
    ds_read_b128 v[100:103], v237 offset:4096
    v_mfma_f32_16x16x32_bf16 v[156:159], a[156:159], v[132:135], v[156:159]
    ds_read_b128 v[104:107], v237 offset:5120
    ds_read_b128 v[108:111], v237 offset:6144
    v_mfma_f32_16x16x32_bf16 v[164:167], v[132:135], a[236:239], v[164:167]
    ds_read_b128 v[112:115], v237 offset:7168
    ds_read_b128 v[116:119], v237 offset:8192
    v_mfma_f32_16x16x32_bf16 v[152:155], a[76:79], v[136:139], v[152:155]
    ds_read_b128 v[120:123], v237 offset:9216
    v_mfma_f32_16x16x32_bf16 v[160:163], a[156:159], v[136:139], v[160:163]
    v_mfma_f32_16x16x32_bf16 v[168:171], v[136:139], a[236:239], v[168:171]
    s_waitcnt lgkmcnt(9)
    v_smfmac_f32_16x16x64_bf16 v[192:195], v[84:87], a[0:7], v225
    s_add_u32 m0, s73, 0
    v_xor_b32 v233, 0x10000, v233
    v_smfmac_f32_16x16x64_bf16 v[196:199], v[84:87], a[80:87], v225
    buffer_load_dwordx4 v232, s[4:7], s74 offen offset:0 sc1 lds
    s_add_u32 m0, s73, 896
    s_waitcnt lgkmcnt(8)
    v_smfmac_f32_16x16x64_bf16 v[192:195], v[88:91], a[8:15], v225
    v_xor_b32 v234, 0x10000, v234
    v_cvt_pk_bf16_f32 v148, v148, v149
    v_smfmac_f32_16x16x64_bf16 v[196:199], v[88:91], a[88:95], v225
    v_cvt_pk_bf16_f32 v149, v150, v151
    s_waitcnt lgkmcnt(7)
    v_smfmac_f32_16x16x64_bf16 v[192:195], v[92:95], a[16:23], v225
    buffer_load_dwordx4 v232, s[4:7], s74 offen offset:128 sc1 lds
    s_add_u32 m0, s73, 1792
    v_smfmac_f32_16x16x64_bf16 v[196:199], v[92:95], a[96:103], v225
    ds_write_b64 v244, v[148:149] offset:22528
    v_cvt_pk_bf16_f32 v156, v156, v157
    s_waitcnt lgkmcnt(7)
    v_smfmac_f32_16x16x64_bf16 v[192:195], v[96:99], a[24:31], v225
    v_cvt_pk_bf16_f32 v157, v158, v159
    v_smfmac_f32_16x16x64_bf16 v[196:199], v[96:99], a[104:111], v225
    buffer_load_dwordx4 v232, s[4:7], s74 offen offset:256 sc1 lds
    s_add_u32 m0, s73, 2688
    s_waitcnt lgkmcnt(6)
    v_smfmac_f32_16x16x64_bf16 v[192:195], v[100:103], a[32:39], v225
    ds_write_b64 v244, v[156:157] offset:26624
    v_cvt_pk_bf16_f32 v172, v164, v165
    v_smfmac_f32_16x16x64_bf16 v[196:199], v[100:103], a[112:119], v225
    v_cvt_pk_bf16_f32 v173, v166, v167
    v_cvt_pk_bf16_f32 v152, v152, v153
    s_waitcnt lgkmcnt(6)
    v_smfmac_f32_16x16x64_bf16 v[192:195], v[104:107], a[40:47], v225
    v_cvt_pk_bf16_f32 v153, v154, v155
    v_smfmac_f32_16x16x64_bf16 v[196:199], v[104:107], a[120:127], v225
    ds_write_b64 v244, v[152:153] offset:24576
    v_cvt_pk_bf16_f32 v160, v160, v161
    s_waitcnt lgkmcnt(6)
    v_smfmac_f32_16x16x64_bf16 v[192:195], v[108:111], a[48:55], v225
    v_cvt_pk_bf16_f32 v161, v162, v163
    v_smfmac_f32_16x16x64_bf16 v[196:199], v[108:111], a[128:135], v225
    ds_write_b64 v244, v[160:161] offset:28672
    v_cvt_pk_bf16_f32 v176, v168, v169
    s_waitcnt lgkmcnt(6)
    v_smfmac_f32_16x16x64_bf16 v[192:195], v[112:115], a[56:63], v225
    v_cvt_pk_bf16_f32 v177, v170, v171
    v_smfmac_f32_16x16x64_bf16 v[196:199], v[112:115], a[136:143], v225
    s_waitcnt lgkmcnt(5)
    v_smfmac_f32_16x16x64_bf16 v[192:195], v[116:119], a[64:71], v225
    v_smfmac_f32_16x16x64_bf16 v[196:199], v[116:119], a[144:151], v225
    s_waitcnt lgkmcnt(4)
    v_smfmac_f32_16x16x64_bf16 v[192:195], v[120:123], a[72:79], v225
    v_smfmac_f32_16x16x64_bf16 v[196:199], v[120:123], a[152:159], v225
    v_smfmac_f32_16x16x64_bf16 v[200:203], v[84:87], a[160:167], v225
    s_add_u32 s79, s72, s76
    s_add_u32 s80, s72, s77
    s_add_u32 s81, s72, s78
    s_add_u32 s85, s74, 40960
    s_cmp_lt_u32 s59, 20
    s_cselect_b32 s85, s72, s85
    s_cselect_b32 s86, 4096, 0
    v_permlane32_swap_b32 v192, v196
    v_permlane32_swap_b32 v193, v197
    v_permlane32_swap_b32 v194, v198
    v_permlane32_swap_b32 v195, v199
    v_pk_add_f32 v[192:193], v[192:193], v[196:197]
    v_pk_add_f32 v[194:195], v[194:195], v[198:199]
    v_cvt_pk_bf16_f32 v192, v192, v193
    v_cvt_pk_bf16_f32 v193, v194, v195
    ds_write_b64 v242, v[192:193] offset:12288
    v_smfmac_f32_16x16x64_bf16 v[200:203], v[88:91], a[168:175], v225
    s_add_u32 s86, s86, s85
    v_smfmac_f32_16x16x64_bf16 v[200:203], v[92:95], a[176:183], v225
    buffer_load_dwordx4 v232, s[4:7], s74 offen offset:384 sc1 lds
    s_add_u32 m0, s73, 3584
    v_smfmac_f32_16x16x64_bf16 v[200:203], v[96:99], a[184:191], v225
    v_smfmac_f32_16x16x64_bf16 v[200:203], v[100:103], a[192:199], v225
    s_waitcnt lgkmcnt(0)
    s_barrier
    ds_read_b64_tr_b16 v[124:125], v243 offset:12288
    ds_read_b64_tr_b16 v[126:127], v243 offset:12352
    ds_read_b64_tr_b16 v[132:133], v243 offset:13312
    ds_read_b64_tr_b16 v[134:135], v243 offset:13376
    ds_read_b128 v[148:151], v237 offset:26624
    ds_read_b128 v[156:159], v237 offset:28672
    v_smfmac_f32_16x16x64_bf16 v[200:203], v[104:107], a[200:207], v225
    ds_read_b64_tr_b16 v[128:129], v243 offset:12800
    ds_read_b64_tr_b16 v[130:131], v243 offset:12864
    v_smfmac_f32_16x16x64_bf16 v[200:203], v[108:111], a[208:215], v225
    ds_read_b64_tr_b16 v[136:137], v243 offset:13824
    ds_read_b64_tr_b16 v[138:139], v243 offset:13888
    v_smfmac_f32_16x16x64_bf16 v[200:203], v[112:115], a[216:223], v225
    ds_read_b128 v[152:155], v237 offset:27648
    ds_read_b128 v[160:163], v237 offset:29696
    v_smfmac_f32_16x16x64_bf16 v[200:203], v[116:119], a[224:231], v225
    ds_read_b128 v[164:167], v245 offset:22528
    ds_read_b128 v[168:171], v245 offset:23552
    v_smfmac_f32_16x16x64_bf16 v[200:203], v[120:123], a[232:239], v225
    s_waitcnt lgkmcnt(10)
    v_mfma_f32_16x16x32_bf16 v[212:215], v[132:135], v[124:127], 0
    s_waitcnt lgkmcnt(9)
    v_mfma_f32_16x16x32_bf16 v[204:207], v[148:151], v[124:127], 0
    s_waitcnt lgkmcnt(8)
    v_mfma_f32_16x16x32_bf16 v[208:211], v[156:159], v[124:127], 0
    s_waitcnt lgkmcnt(4)
    v_mfma_f32_16x16x32_bf16 v[212:215], v[136:139], v[128:131], v[212:215]
    s_waitcnt lgkmcnt(3)
    v_mfma_f32_16x16x32_bf16 v[204:207], v[152:155], v[128:131], v[204:207]
    s_waitcnt lgkmcnt(2)
    v_mfma_f32_16x16x32_bf16 v[208:211], v[160:163], v[128:131], v[208:211]
    v_permlane32_swap_b32 v200, v202
    v_permlane32_swap_b32 v201, v203
    v_add_f32 v200, v200, v202
    v_add_f32 v201, v201, v203
    v_cvt_pk_bf16_f32 v174, v200, v201
    v_cvt_pk_bf16_f32 v178, v200, v201
    v_cndmask_b32 v212, v212, v213, s[98:99]
    v_cndmask_b32 v214, v214, v215, s[98:99]
    v_cndmask_b32 v224, v212, v214, s[100:101]
    v_cndmask_b32 v220, v204, v208, s[98:99]
    v_cndmask_b32 v221, v205, v209, s[98:99]
    v_cndmask_b32 v222, v206, v210, s[98:99]
    v_cndmask_b32 v223, v207, v211, s[98:99]
    ds_read_b128 v[124:127], v233 offset:0
    ds_read_b128 v[128:131], v233 offset:20480
    ds_read_b128 v[140:143], v233 offset:1024
    s_waitcnt lgkmcnt(4)
    v_mfma_f32_16x16x32_bf16 v[212:215], v[132:135], v[164:167], 0
    v_mfma_f32_16x16x32_bf16 v[204:207], v[148:151], v[164:167], 0
    v_mfma_f32_16x16x32_bf16 v[208:211], v[156:159], v[164:167], 0
    s_waitcnt lgkmcnt(3)
    v_mfma_f32_16x16x32_bf16 v[212:215], v[136:139], v[168:171], v[212:215]
    ds_read_b128 v[132:135], v234 offset:0
    ds_read_b128 v[136:139], v234 offset:20480
    v_mfma_f32_16x16x32_bf16 v[204:207], v[152:155], v[168:171], v[204:207]
    v_mfma_f32_16x16x32_bf16 v[208:211], v[160:163], v[168:171], v[208:211]
    s_waitcnt lgkmcnt(4)
    v_mfma_f32_16x16x32_bf16 v[148:151], a[0:3], v[124:127], 0
    ds_read_b128 v[144:147], v233 offset:21504
    v_mfma_f32_16x16x32_bf16 v[156:159], a[80:83], v[124:127], 0
    v_mfma_f32_16x16x32_bf16 v[164:167], v[124:127], a[160:163], 0
    s_waitcnt lgkmcnt(4)
    v_mfma_f32_16x16x32_bf16 v[152:155], a[0:3], v[128:131], 0
    ds_read_b128 v[124:127], v234 offset:1024
    v_mfma_f32_16x16x32_bf16 v[160:163], a[80:83], v[128:131], 0
    v_mfma_f32_16x16x32_bf16 v[168:171], v[128:131], a[160:163], 0
    s_waitcnt lgkmcnt(3)
    v_mfma_f32_16x16x32_bf16 v[148:151], a[4:7], v[132:135], v[148:151]
    ds_read_b128 v[128:131], v234 offset:21504
    buffer_load_dwordx4 v[84:87], v237, s[4:7], s80 offen sc1
    v_mfma_f32_16x16x32_bf16 v[156:159], a[84:87], v[132:135], v[156:159]
    buffer_load_dwordx4 v[88:91], v237, s[4:7], s81 offen sc1
    buffer_load_dword v92, v238, s[4:7], s80 offen offset:1024 sc1
    v_mfma_f32_16x16x32_bf16 v[164:167], v[132:135], a[164:167], v[164:167]
    buffer_load_dword v93, v238, s[4:7], s81 offen offset:1024 sc1
    v_cndmask_b32 v212, v212, v213, s[98:99]
    s_waitcnt lgkmcnt(3)
    v_mfma_f32_16x16x32_bf16 v[152:155], a[4:7], v[136:139], v[152:155]
    ds_read_b128 v[132:135], v233 offset:2048
    v_cndmask_b32 v214, v214, v215, s[98:99]
    v_mfma_f32_16x16x32_bf16 v[160:163], a[84:87], v[136:139], v[160:163]
    v_cndmask_b32 v230, v212, v214, s[100:101]
    v_cndmask_b32 v226, v204, v208, s[98:99]
    v_mfma_f32_16x16x32_bf16 v[168:171], v[136:139], a[164:167], v[168:171]
    v_cndmask_b32 v227, v205, v209, s[98:99]
    v_cndmask_b32 v228, v206, v210, s[98:99]
    v_mfma_f32_16x16x32_bf16 v[148:151], a[8:11], v[140:143], v[148:151]
    ds_read_b128 v[136:139], v233 offset:22528
    v_cndmask_b32 v229, v207, v211, s[98:99]
    v_mfma_f32_16x16x32_bf16 v[156:159], a[88:91], v[140:143], v[156:159]
    buffer_store_dwordx4 v[226:229], v239, s[4:7], s79 offen
    v_mfma_f32_16x16x32_bf16 v[164:167], v[140:143], a[168:171], v[164:167]
    buffer_store_dword v230, v240, s[4:7], s79 offen offset:1024
    s_waitcnt lgkmcnt(4)
    v_mfma_f32_16x16x32_bf16 v[152:155], a[8:11], v[144:147], v[152:155]
    ds_read_b128 v[140:143], v234 offset:2048
    v_mfma_f32_16x16x32_bf16 v[160:163], a[88:91], v[144:147], v[160:163]
    v_mfma_f32_16x16x32_bf16 v[168:171], v[144:147], a[168:171], v[168:171]
    s_waitcnt lgkmcnt(4)
    v_mfma_f32_16x16x32_bf16 v[148:151], a[12:15], v[124:127], v[148:151]
    ds_read_b128 v[144:147], v234 offset:22528
    v_mfma_f32_16x16x32_bf16 v[156:159], a[92:95], v[124:127], v[156:159]
    v_mfma_f32_16x16x32_bf16 v[164:167], v[124:127], a[172:175], v[164:167]
    s_waitcnt vmcnt(5)
    v_max3_u32 v216, v84, v85, v86
    s_waitcnt vmcnt(4)
    v_max3_u32 v216, v216, v87, v88
    v_max3_u32 v216, v216, v89, v90
    s_waitcnt vmcnt(3)
    v_max3_u32 v216, v216, v91, v92
    s_waitcnt vmcnt(2)
    v_max_u32 v216, v216, v93
    v_cmp_eq_u32 vcc, -1, v216
    s_cbranch_vccnz Lrty_50
Lok_49:
    v_pk_add_f32 v[84:85], v[84:85], v[88:89]
    v_pk_add_f32 v[86:87], v[86:87], v[90:91]
    v_add_f32 v92, v92, v93
    v_pk_add_f32 v[220:221], v[220:221], v[84:85]
    v_pk_add_f32 v[222:223], v[222:223], v[86:87]
    v_add_f32 v224, v224, v92
    v_max3_f32 v216, v220, v221, v222
    v_max3_f32 v216, v216, v223, v224
    buffer_load_dwordx4 v[108:111], v239, s[4:7], s80 offen sc1
    buffer_load_dwordx4 v[112:115], v239, s[4:7], s81 offen sc1
    v_max_f32_dpp v216, v216, v216 row_ror:8 row_mask:0xf bank_mask:0xf
    v_mov_b32 v217, v216
    buffer_load_dword v116, v240, s[4:7], s80 offen offset:1024 sc1
    buffer_load_dword v117, v240, s[4:7], s81 offen offset:1024 sc1
    v_permlane16_swap_b32 v216, v217
    v_max_f32 v216, v216, v217
    v_mov_b32 v217, v216
    v_mov_b64 v[204:205], 0
    v_mov_b64 v[206:207], 0
    v_permlane32_swap_b32 v216, v217
    v_max_f32 v216, v216, v217
    v_mul_f32 v216, s70, v216
    v_fma_f32 v224, v224, s70, -v216
    v_fma_f32 v220, v220, s70, -v216
    v_fma_f32 v221, v221, s70, -v216
    v_fma_f32 v222, v222, s70, -v216
    v_fma_f32 v223, v223, s70, -v216
    v_exp_f32 v224, v224
    v_exp_f32 v220, v220
    v_exp_f32 v221, v221
    v_exp_f32 v222, v222
    v_exp_f32 v223, v223
    v_cvt_pk_bf16_f32 v190, v224, v224
    v_cvt_pk_bf16_f32 v188, v220, v221
    v_and_b32 v190, v231, v190
    v_cvt_pk_bf16_f32 v189, v222, v223
    v_mov_b64 v[208:209], 0
    v_mov_b64 v[210:211], 0
    v_mfma_f32_16x16x32_bf16 v[200:203], v[184:187], v[188:191], 0
    v_mfma_f32_16x16x32_bf16 v[192:195], v[172:175], v[188:191], 0
    v_mfma_f32_16x16x32_bf16 v[196:199], v[176:179], v[188:191], 0
    s_xor_b32 s88, s72, 524288
    s_xor_b32 s89, s79, 524288
    s_nop 3
    v_add_f32_dpp v200, v200, v200 row_ror:8 row_mask:0xf bank_mask:0xf
    v_rcp_f32 v200, v200
    v_add_f32_dpp v192, v196, v192 row_ror:8 row_mask:0xf bank_mask:0xf
    v_add_f32_dpp v193, v197, v193 row_ror:8 row_mask:0xf bank_mask:0xf
    v_add_f32_dpp v194, v198, v194 row_ror:8 row_mask:0xf bank_mask:0xf
    v_add_f32_dpp v195, v199, v195 row_ror:8 row_mask:0xf bank_mask:0xf
    v_pk_mul_f32 v[192:193], v[192:193], v[200:201] op_sel_hi:[1,0]
    v_pk_mul_f32 v[194:195], v[194:195], v[200:201] op_sel_hi:[1,0]
    v_cvt_pk_bf16_f32 v192, v192, v193
    v_cvt_pk_bf16_f32 v193, v194, v195
    v_min_u32 v192, -2, v192
    v_min_u32 v193, -2, v193
    buffer_store_dwordx2 v[192:193], v248, s[4:7], s72 offen
    s_waitcnt vmcnt(4)
    v_max3_u32 v216, v108, v109, v110
    s_waitcnt vmcnt(3)
    v_max3_u32 v216, v216, v111, v112
    v_max3_u32 v216, v216, v113, v114
    s_waitcnt vmcnt(2)
    v_max3_u32 v216, v216, v115, v116
    s_waitcnt vmcnt(1)
    v_max_u32 v216, v216, v117
    v_cmp_eq_u32 vcc, -1, v216
    s_cbranch_vccnz Lrty_52
Lok_51:
    s_waitcnt lgkmcnt(4)
    v_mfma_f32_16x16x32_bf16 v[152:155], a[12:15], v[128:131], v[152:155]
    ds_read_b128 v[124:127], v233 offset:3072
    v_add_f32 v108, v108, v112
    v_mfma_f32_16x16x32_bf16 v[160:163], a[92:95], v[128:131], v[160:163]
    v_add_f32 v109, v109, v113
    v_add_f32 v110, v110, v114
    v_add_f32 v111, v111, v115
    v_mfma_f32_16x16x32_bf16 v[168:171], v[128:131], a[172:175], v[168:171]
    v_add_f32 v116, v116, v117
    v_add_f32 v226, v226, v108
    v_add_f32 v227, v227, v109
    s_waitcnt lgkmcnt(4)
    v_mfma_f32_16x16x32_bf16 v[148:151], a[16:19], v[132:135], v[148:151]
    ds_read_b128 v[128:131], v233 offset:23552
    v_add_f32 v228, v228, v110
    v_mfma_f32_16x16x32_bf16 v[156:159], a[96:99], v[132:135], v[156:159]
    v_add_f32 v229, v229, v111
    v_add_f32 v230, v230, v116
    v_mov_b32 v216, s71
    v_mfma_f32_16x16x32_bf16 v[164:167], v[132:135], a[176:179], v[164:167]
    buffer_load_dwordx4 v[84:87], v249, s[4:7], s85 offen offset:0 sc1
    v_cndmask_b32 v226, v226, v216, s[90:91]
    v_cndmask_b32 v227, v227, v216, s[92:93]
    s_waitcnt lgkmcnt(4)
    v_mfma_f32_16x16x32_bf16 v[152:155], a[16:19], v[136:139], v[152:155]
    ds_read_b128 v[132:135], v234 offset:3072
    v_cndmask_b32 v228, v228, v216, s[94:95]
    v_mfma_f32_16x16x32_bf16 v[160:163], a[96:99], v[136:139], v[160:163]
    buffer_load_dwordx4 v[88:91], v249, s[4:7], s85 offen offset:1024 sc1
    v_cndmask_b32 v229, v229, v216, s[96:97]
    v_max3_f32 v216, v226, v227, v228
    v_mfma_f32_16x16x32_bf16 v[168:171], v[136:139], a[176:179], v[168:171]
    v_max3_f32 v216, v216, v229, v230
    buffer_load_dwordx4 v[92:95], v249, s[4:7], s85 offen offset:2048 sc1
    s_nop 0
    v_max_f32_dpp v216, v216, v216 row_ror:8 row_mask:0xf bank_mask:0xf
    s_waitcnt lgkmcnt(4)
    v_mfma_f32_16x16x32_bf16 v[148:151], a[20:23], v[140:143], v[148:151]
    ds_read_b128 v[136:139], v234 offset:23552
    v_mov_b32 v217, v216
    v_mfma_f32_16x16x32_bf16 v[156:159], a[100:103], v[140:143], v[156:159]
    s_nop 0
    v_permlane16_swap_b32 v216, v217
    buffer_load_dwordx4 v[96:99], v249, s[4:7], s85 offen offset:3072 sc1
    v_mfma_f32_16x16x32_bf16 v[164:167], v[140:143], a[180:183], v[164:167]
    v_max_f32 v216, v216, v217
    v_mov_b32 v217, v216
    s_waitcnt lgkmcnt(4)
    v_mfma_f32_16x16x32_bf16 v[152:155], a[20:23], v[144:147], v[152:155]
    ds_read_b128 v[140:143], v233 offset:4096
    v_permlane32_swap_b32 v216, v217
    v_mfma_f32_16x16x32_bf16 v[160:163], a[100:103], v[144:147], v[160:163]
    buffer_load_dwordx4 v[100:103], v249, s[4:7], s86 offen offset:0 sc1
    v_max_f32 v216, v216, v217
    v_mul_f32 v216, s70, v216
    v_mfma_f32_16x16x32_bf16 v[168:171], v[144:147], a[180:183], v[168:171]
    v_fma_f32 v230, v230, s70, -v216
    buffer_load_dwordx4 v[104:107], v249, s[4:7], s86 offen offset:1024 sc1
    s_waitcnt lgkmcnt(4)
    v_mfma_f32_16x16x32_bf16 v[148:151], a[24:27], v[124:127], v[148:151]
    ds_read_b128 v[144:147], v233 offset:24576
    v_fma_f32 v226, v226, s70, -v216
    v_fma_f32 v227, v227, s70, -v216
    v_mfma_f32_16x16x32_bf16 v[156:159], a[104:107], v[124:127], v[156:159]
    v_fma_f32 v228, v228, s70, -v216
    v_fma_f32 v229, v229, s70, -v216
    v_mfma_f32_16x16x32_bf16 v[164:167], v[124:127], a[184:187], v[164:167]
    v_exp_f32 v230, v230
    s_waitcnt lgkmcnt(4)
    v_mfma_f32_16x16x32_bf16 v[152:155], a[24:27], v[128:131], v[152:155]
    ds_read_b128 v[124:127], v234 offset:4096
    v_exp_f32 v226, v226
    v_mfma_f32_16x16x32_bf16 v[160:163], a[104:107], v[128:131], v[160:163]
    v_exp_f32 v227, v227
    v_mfma_f32_16x16x32_bf16 v[168:171], v[128:131], a[184:187], v[168:171]
    v_exp_f32 v228, v228
    v_exp_f32 v229, v229
    s_waitcnt lgkmcnt(4)
    v_mfma_f32_16x16x32_bf16 v[148:151], a[28:31], v[132:135], v[148:151]
    ds_read_b128 v[128:131], v234 offset:24576
    v_cvt_pk_bf16_f32 v198, v230, v230
    v_cvt_pk_bf16_f32 v196, v226, v227
    v_mfma_f32_16x16x32_bf16 v[156:159], a[108:111], v[132:135], v[156:159]
    v_cvt_pk_bf16_f32 v197, v228, v229
    v_mfma_f32_16x16x32_bf16 v[164:167], v[132:135], a[188:191], v[164:167]
    ds_write_b16 v247, v198 offset:14344
    ds_write_b64 v246, v[196:197] offset:14336
Lwchk_53:
    s_waitcnt vmcnt(5)
    v_max3_u32 v192, v84, v85, v86
    v_max_u32 v192, v192, v87
    v_cmp_lt_u32 vcc, s87, v192
    s_cbranch_vccnz Lwrty_54
    v_smfmac_f32_16x16x64_bf16 v[204:207], v[84:87], a[240:247], v225
    v_smfmac_f32_16x16x64_bf16 v[208:211], v[84:87], a[248:255], v225
Lwchk_55:
    s_waitcnt vmcnt(4)
    v_max3_u32 v192, v88, v89, v90
    v_max_u32 v192, v192, v91
    v_cmp_lt_u32 vcc, s87, v192
    s_cbranch_vccnz Lwrty_56
    v_smfmac_f32_16x16x64_bf16 v[204:207], v[88:91], v[4:11], v225
    v_smfmac_f32_16x16x64_bf16 v[208:211], v[88:91], v[12:19], v225
Lwchk_57:
    s_waitcnt vmcnt(3)
    v_max3_u32 v192, v92, v93, v94
    v_max_u32 v192, v192, v95
    v_cmp_lt_u32 vcc, s87, v192
    s_cbranch_vccnz Lwrty_58
    v_smfmac_f32_16x16x64_bf16 v[204:207], v[92:95], v[20:27], v225
    v_smfmac_f32_16x16x64_bf16 v[208:211], v[92:95], v[28:35], v225
Lwchk_59:
    s_waitcnt vmcnt(2)
    v_max3_u32 v192, v96, v97, v98
    v_max_u32 v192, v192, v99
    v_cmp_lt_u32 vcc, s87, v192
    s_cbranch_vccnz Lwrty_60
    v_smfmac_f32_16x16x64_bf16 v[204:207], v[96:99], v[36:43], v225
    v_smfmac_f32_16x16x64_bf16 v[208:211], v[96:99], v[44:51], v225
Lwchk_61:
    s_waitcnt vmcnt(1)
    v_max3_u32 v192, v100, v101, v102
    v_max_u32 v192, v192, v103
    v_cmp_lt_u32 vcc, s87, v192
    s_cbranch_vccnz Lwrty_62
    v_smfmac_f32_16x16x64_bf16 v[204:207], v[100:103], v[52:59], v225
    v_smfmac_f32_16x16x64_bf16 v[208:211], v[100:103], v[60:67], v225
Lwchk_63:
    s_waitcnt vmcnt(0)
    v_max3_u32 v192, v104, v105, v106
    v_max_u32 v192, v192, v107
    v_cmp_lt_u32 vcc, s87, v192
    s_cbranch_vccnz Lwrty_64
    v_smfmac_f32_16x16x64_bf16 v[204:207], v[104:107], v[68:75], v225
    v_smfmac_f32_16x16x64_bf16 v[208:211], v[104:107], v[76:83], v225
    s_lshr_b32 s65, s88, 2
    s_and_b32 s65, s65, 0xf0000
    s_nop 5
    v_permlane32_swap_b32 v204, v208
    v_permlane32_swap_b32 v205, v209
    v_permlane32_swap_b32 v206, v210
    v_permlane32_swap_b32 v207, v211
    v_pk_add_f32 v[204:205], v[204:205], v[208:209]
    v_pk_add_f32 v[206:207], v[206:207], v[210:211]
    ds_write2_b32 v250, v204, v205 offset0:0 offset1:32
    ds_write2_b32 v250, v206, v207 offset0:64 offset1:96
    s_waitcnt lgkmcnt(8)
    v_mfma_f32_16x16x32_bf16 v[152:155], a[28:31], v[136:139], v[152:155]
    ds_read_b128 v[132:135], v233 offset:5120
    v_mfma_f32_16x16x32_bf16 v[160:163], a[108:111], v[136:139], v[160:163]
    v_mfma_f32_16x16x32_bf16 v[168:171], v[136:139], a[188:191], v[168:171]
    s_waitcnt lgkmcnt(8)
    v_mfma_f32_16x16x32_bf16 v[148:151], a[32:35], v[140:143], v[148:151]
    ds_read_b128 v[136:139], v233 offset:25600
    s_waitcnt lgkmcnt(2)
    s_barrier
    ds_read_b64 v[120:121], v241 offset:16896
    ds_read_b128 v[112:115], v237 offset:14336
    ds_read_b128 v[116:119], v237 offset:15872
    v_mfma_f32_16x16x32_bf16 v[156:159], a[112:115], v[140:143], v[156:159]
    buffer_load_dword v2, v254, s[4:7], 0 offen sc1
    v_mfma_f32_16x16x32_bf16 v[164:167], v[140:143], a[192:195], v[164:167]
    buffer_store_dwordx2 v[180:181], v251, s[4:7], s88 offen
    v_mfma_f32_16x16x32_bf16 v[152:155], a[32:35], v[144:147], v[152:155]
    ds_read_b128 v[140:143], v234 offset:5120
    buffer_store_dwordx4 v[180:183], v252, s[4:7], s65 offen sc1
    v_mfma_f32_16x16x32_bf16 v[160:163], a[112:115], v[144:147], v[160:163]
    v_mfma_f32_16x16x32_bf16 v[168:171], v[144:147], a[192:195], v[168:171]
    s_waitcnt lgkmcnt(3)
    v_mfma_f32_16x16x16_bf16 v[204:207], v[184:185], v[120:121], 0
    v_mfma_f32_16x16x16_bf16 v[196:199], v[176:177], v[120:121], 0
    s_waitcnt lgkmcnt(2)
    v_mfma_f32_16x16x32_bf16 v[200:203], v[184:187], v[112:115], 0
    v_mfma_f32_16x16x32_bf16 v[192:195], v[172:175], v[112:115], 0
    v_mfma_f32_16x16x32_bf16 v[148:151], a[36:39], v[124:127], v[148:151]
    ds_read_b128 v[144:147], v234 offset:25600
    v_mfma_f32_16x16x32_bf16 v[156:159], a[116:119], v[124:127], v[156:159]
    v_mfma_f32_16x16x32_bf16 v[164:167], v[124:127], a[196:199], v[164:167]
    s_waitcnt lgkmcnt(2)
    v_mfma_f32_16x16x32_bf16 v[204:207], v[184:187], v[116:119], v[204:207]
    v_mfma_f32_16x16x32_bf16 v[196:199], v[172:175], v[116:119], v[196:199]
    v_mfma_f32_16x16x32_bf16 v[152:155], a[36:39], v[128:131], v[152:155]
    ds_read_b128 v[124:127], v233 offset:6144
    v_mfma_f32_16x16x32_bf16 v[160:163], a[116:119], v[128:131], v[160:163]
    buffer_load_dwordx4 v232, s[4:7], s74 offen offset:512 sc1 lds
    s_add_u32 m0, s73, 4480
    v_mfma_f32_16x16x32_bf16 v[168:171], v[128:131], a[196:199], v[168:171]
    v_rcp_f32 v200, v200
    s_nop 0
    v_mul_f32 v192, v192, v200
    v_mfma_f32_16x16x32_bf16 v[148:151], a[40:43], v[132:135], v[148:151]
    ds_read_b128 v[128:131], v233 offset:26624
    v_mul_f32 v193, v193, v200
    v_mul_f32 v194, v194, v200
    v_mfma_f32_16x16x32_bf16 v[156:159], a[120:123], v[132:135], v[156:159]
    buffer_load_dwordx4 v232, s[4:7], s74 offen offset:640 sc1 lds
    s_add_u32 m0, s73, 5376
    v_mfma_f32_16x16x32_bf16 v[164:167], v[132:135], a[200:203], v[164:167]
    v_mul_f32 v195, v195, v200
    v_cvt_pk_bf16_f32 v208, v192, v193
    v_mfma_f32_16x16x32_bf16 v[152:155], a[40:43], v[136:139], v[152:155]
    ds_read_b128 v[132:135], v234 offset:6144
    v_cvt_pk_bf16_f32 v209, v194, v195
    v_mfma_f32_16x16x32_bf16 v[160:163], a[120:123], v[136:139], v[160:163]
    buffer_load_dwordx4 v232, s[4:7], s74 offen offset:768 sc1 lds
    s_add_u32 m0, s73, 6272
    v_mfma_f32_16x16x32_bf16 v[168:171], v[136:139], a[200:203], v[168:171]
    v_rcp_f32 v204, v204
    s_waitcnt lgkmcnt(4)
    v_mfma_f32_16x16x32_bf16 v[148:151], a[44:47], v[140:143], v[148:151]
    ds_read_b128 v[136:139], v234 offset:26624
    v_mul_f32 v196, v196, v204
    v_mfma_f32_16x16x32_bf16 v[156:159], a[124:127], v[140:143], v[156:159]
    buffer_load_dwordx4 v232, s[4:7], s74 offen offset:896 sc1 lds
    s_add_u32 m0, s73, 7168
    v_mfma_f32_16x16x32_bf16 v[164:167], v[140:143], a[204:207], v[164:167]
    v_mul_f32 v197, v197, v204
    v_mul_f32 v198, v198, v204
    v_mul_f32 v199, v199, v204
    s_waitcnt lgkmcnt(4)
    v_mfma_f32_16x16x32_bf16 v[152:155], a[44:47], v[144:147], v[152:155]
    ds_read_b128 v[140:143], v233 offset:7168
    v_cvt_pk_bf16_f32 v210, v196, v197
    v_mfma_f32_16x16x32_bf16 v[160:163], a[124:127], v[144:147], v[160:163]
    buffer_load_dwordx4 v232, s[4:7], s74 offen offset:1024 sc1 lds
    s_add_u32 m0, s73, 8064
    v_mfma_f32_16x16x32_bf16 v[168:171], v[144:147], a[204:207], v[168:171]
    v_cvt_pk_bf16_f32 v211, v198, v199
    s_waitcnt lgkmcnt(4)
    v_mfma_f32_16x16x32_bf16 v[148:151], a[48:51], v[124:127], v[148:151]
    ds_read_b128 v[144:147], v233 offset:27648
    v_permlane32_swap_b32 v208, v210
    v_mfma_f32_16x16x32_bf16 v[156:159], a[128:131], v[124:127], v[156:159]
    buffer_load_dwordx4 v232, s[4:7], s74 offen offset:1152 sc1 lds
    v_mfma_f32_16x16x32_bf16 v[164:167], v[124:127], a[208:211], v[164:167]
    v_permlane32_swap_b32 v209, v211
    buffer_store_dwordx4 v[208:211], v253, s[4:7], s75 offen
    s_waitcnt lgkmcnt(4)
    v_mfma_f32_16x16x32_bf16 v[152:155], a[48:51], v[128:131], v[152:155]
    ds_read_b128 v[124:127], v234 offset:7168
    v_mfma_f32_16x16x32_bf16 v[160:163], a[128:131], v[128:131], v[160:163]
    s_add_u32 s82, s72, 178176
    s_add_u32 s83, s72, 182272
    v_mfma_f32_16x16x32_bf16 v[168:171], v[128:131], a[208:211], v[168:171]
    s_waitcnt lgkmcnt(4)
    v_mfma_f32_16x16x32_bf16 v[148:151], a[52:55], v[132:135], v[148:151]
    ds_read_b128 v[128:131], v234 offset:27648
    s_cmp_eq_u32 s62, 63
    s_cbranch_scc1 L_Clast
    v_mfma_f32_16x16x32_bf16 v[156:159], a[132:135], v[132:135], v[156:159]
    s_add_u32 s86, s72, 262144
    s_and_b32 s86, s86, 786432
    v_mfma_f32_16x16x32_bf16 v[164:167], v[132:135], a[212:215], v[164:167]
    buffer_store_dwordx4 v[180:183], v239, s[4:7], s89 offen
    s_waitcnt lgkmcnt(4)
    v_mfma_f32_16x16x32_bf16 v[152:155], a[52:55], v[136:139], v[152:155]
    ds_read_b128 v[132:135], v233 offset:8192
    buffer_store_dword v180, v240, s[4:7], s89 offen offset:1024
    v_mfma_f32_16x16x32_bf16 v[160:163], a[132:135], v[136:139], v[160:163]
    s_andn2_b32 s72, s72, 786432
    s_or_b32 s72, s72, s86
    v_mfma_f32_16x16x32_bf16 v[168:171], v[136:139], a[212:215], v[168:171]
    buffer_store_dwordx2 v[180:181], v248, s[4:7], s88 offen
    s_waitcnt lgkmcnt(4)
    v_mfma_f32_16x16x32_bf16 v[148:151], a[56:59], v[140:143], v[148:151]
    ds_read_b128 v[136:139], v233 offset:28672
    v_mov_b64 v[192:193], 0
    v_mfma_f32_16x16x32_bf16 v[156:159], a[136:139], v[140:143], v[156:159]
    s_add_u32 s74, s74, 40960
    s_xor_b32 s73, s73, 65536
    v_mfma_f32_16x16x32_bf16 v[164:167], v[140:143], a[216:219], v[164:167]
    v_mov_b64 v[194:195], 0
    v_mov_b64 v[196:197], 0
    s_waitcnt lgkmcnt(4)
    v_mfma_f32_16x16x32_bf16 v[152:155], a[56:59], v[144:147], v[152:155]
    ds_read_b128 v[140:143], v234 offset:8192
    v_mov_b64 v[198:199], 0
    v_mov_b64 v[200:201], 0
    v_mfma_f32_16x16x32_bf16 v[160:163], a[136:139], v[144:147], v[160:163]
    v_mov_b64 v[202:203], 0
    s_add_u32 s75, s75, 393216
    v_mfma_f32_16x16x32_bf16 v[168:171], v[144:147], a[216:219], v[168:171]
    s_add_u32 s66, s62, 1
    s_waitcnt lgkmcnt(4)
    v_mfma_f32_16x16x32_bf16 v[148:151], a[60:63], v[124:127], v[148:151]
    ds_read_b128 v[144:147], v234 offset:28672
    s_and_b32 s66, s66, 7
    s_cselect_b32 s66, 0, 3145728
    v_mfma_f32_16x16x32_bf16 v[156:159], a[140:143], v[124:127], v[156:159]
    s_sub_u32 s75, s75, s66
    v_mfma_f32_16x16x32_bf16 v[164:167], v[124:127], a[220:223], v[164:167]
    s_waitcnt lgkmcnt(4)
    v_mfma_f32_16x16x32_bf16 v[152:155], a[60:63], v[128:131], v[152:155]
    ds_read_b128 v[124:127], v233 offset:9216
    v_mfma_f32_16x16x32_bf16 v[160:163], a[140:143], v[128:131], v[160:163]
    s_add_u32 s64, s62, 4
    v_add_u32 v3, s64, v255
    v_min_i32 v3, 64, v3
Lfchk_65:
    s_waitcnt vmcnt(12)
    v_cmp_gt_i32 vcc, v3, v2
    s_cbranch_vccnz Lfrty_66
    v_mfma_f32_16x16x32_bf16 v[168:171], v[128:131], a[220:223], v[168:171]
    s_waitcnt lgkmcnt(4)
    v_mfma_f32_16x16x32_bf16 v[148:151], a[64:67], v[132:135], v[148:151]
    ds_read_b128 v[128:131], v233 offset:29696
    v_mfma_f32_16x16x32_bf16 v[156:159], a[144:147], v[132:135], v[156:159]
    s_add_u32 s64, s62, 1
    v_mov_b32 v216, s64
    s_mov_b64 exec, 1
    s_waitcnt vmcnt(3)
    buffer_store_dword v216, off, s[4:7], s3
    s_mov_b64 exec, -1
    s_add_u32 s62, s62, 1
    s_branch L_Ctop0
Lrty_48:
    buffer_load_dwordx4 v[84:87], v235, s[4:7], s82 offen sc1
    buffer_load_dwordx4 v[88:91], v235, s[4:7], s83 offen sc1
    buffer_load_dwordx2 v[92:93], v236, s[4:7], s82 offen sc1
    s_sub_u32 s61, s61, 1
    s_mov_b32 s67, 15
    s_cbranch_scc1 L_fail
    s_waitcnt vmcnt(2)
    v_max3_u32 v96, v84, v85, v86
    s_waitcnt vmcnt(1)
    v_max3_u32 v96, v96, v87, v88
    v_max3_u32 v96, v96, v89, v90
    s_waitcnt vmcnt(0)
    v_max3_u32 v96, v96, v91, v92
    v_max_u32 v96, v96, v93
    v_cmp_eq_u32 vcc, -1, v96
    s_cbranch_vccnz Lrty_48
    ds_write_b128 v235, v[84:87] offset:0
    ds_write_b128 v235, v[88:91] offset:4096
    ds_write_b64 v236, v[92:93] offset:0
    s_branch Lok_47
Lrty_50:
    buffer_load_dwordx4 v[84:87], v237, s[4:7], s80 offen sc1
    buffer_load_dwordx4 v[88:91], v237, s[4:7], s81 offen sc1
    buffer_load_dword v92, v238, s[4:7], s80 offen offset:1024 sc1
    buffer_load_dword v93, v238, s[4:7], s81 offen offset:1024 sc1
    s_sub_u32 s61, s61, 1
    s_mov_b32 s67, 11
    s_cbranch_scc1 L_fail
    s_waitcnt vmcnt(3)
    v_max3_u32 v216, v84, v85, v86
    s_waitcnt vmcnt(2)
    v_max3_u32 v216, v216, v87, v88
    v_max3_u32 v216, v216, v89, v90
    s_waitcnt vmcnt(1)
    v_max3_u32 v216, v216, v91, v92
    s_waitcnt vmcnt(0)
    v_max_u32 v216, v216, v93
    v_cmp_eq_u32 vcc, -1, v216
    s_cbranch_vccnz Lrty_50
    s_branch Lok_49
Lrty_52:
    buffer_load_dwordx4 v[108:111], v239, s[4:7], s80 offen sc1
    buffer_load_dwordx4 v[112:115], v239, s[4:7], s81 offen sc1
    buffer_load_dword v116, v240, s[4:7], s80 offen offset:1024 sc1
    buffer_load_dword v117, v240, s[4:7], s81 offen offset:1024 sc1
    s_sub_u32 s61, s61, 1
    s_mov_b32 s67, 12
    s_cbranch_scc1 L_fail
    s_waitcnt vmcnt(3)
    v_max3_u32 v216, v108, v109, v110
    s_waitcnt vmcnt(2)
    v_max3_u32 v216, v216, v111, v112
    v_max3_u32 v216, v216, v113, v114
    s_waitcnt vmcnt(1)
    v_max3_u32 v216, v216, v115, v116
    s_waitcnt vmcnt(0)
    v_max_u32 v216, v216, v117
    v_cmp_eq_u32 vcc, -1, v216
    s_cbranch_vccnz Lrty_52
    s_branch Lok_51
Lwrty_54:
    buffer_load_dwordx4 v[84:87], v249, s[4:7], s85 offen offset:0 sc1
    buffer_load_dwordx4 v[88:91], v249, s[4:7], s85 offen offset:1024 sc1
    buffer_load_dwordx4 v[92:95], v249, s[4:7], s85 offen offset:2048 sc1
    buffer_load_dwordx4 v[96:99], v249, s[4:7], s85 offen offset:3072 sc1
    buffer_load_dwordx4 v[100:103], v249, s[4:7], s86 offen offset:0 sc1
    buffer_load_dwordx4 v[104:107], v249, s[4:7], s86 offen offset:1024 sc1
    s_sub_u32 s61, s61, 1
    s_mov_b32 s67, 13
    s_cbranch_scc1 L_fail
    s_branch Lwchk_53
Lwrty_56:
    buffer_load_dwordx4 v[88:91], v249, s[4:7], s85 offen offset:1024 sc1
    buffer_load_dwordx4 v[92:95], v249, s[4:7], s85 offen offset:2048 sc1
    buffer_load_dwordx4 v[96:99], v249, s[4:7], s85 offen offset:3072 sc1
    buffer_load_dwordx4 v[100:103], v249, s[4:7], s86 offen offset:0 sc1
    buffer_load_dwordx4 v[104:107], v249, s[4:7], s86 offen offset:1024 sc1
    s_sub_u32 s61, s61, 1
    s_mov_b32 s67, 13
    s_cbranch_scc1 L_fail
    s_branch Lwchk_55
Lwrty_58:
    buffer_load_dwordx4 v[92:95], v249, s[4:7], s85 offen offset:2048 sc1
    buffer_load_dwordx4 v[96:99], v249, s[4:7], s85 offen offset:3072 sc1
    buffer_load_dwordx4 v[100:103], v249, s[4:7], s86 offen offset:0 sc1
    buffer_load_dwordx4 v[104:107], v249, s[4:7], s86 offen offset:1024 sc1
    s_sub_u32 s61, s61, 1
    s_mov_b32 s67, 13
    s_cbranch_scc1 L_fail
    s_branch Lwchk_57
Lwrty_60:
    buffer_load_dwordx4 v[96:99], v249, s[4:7], s85 offen offset:3072 sc1
    buffer_load_dwordx4 v[100:103], v249, s[4:7], s86 offen offset:0 sc1
    buffer_load_dwordx4 v[104:107], v249, s[4:7], s86 offen offset:1024 sc1
    s_sub_u32 s61, s61, 1
    s_mov_b32 s67, 13
    s_cbranch_scc1 L_fail
    s_branch Lwchk_59
Lwrty_62:
    buffer_load_dwordx4 v[100:103], v249, s[4:7], s86 offen offset:0 sc1
    buffer_load_dwordx4 v[104:107], v249, s[4:7], s86 offen offset:1024 sc1
    s_sub_u32 s61, s61, 1
    s_mov_b32 s67, 13
    s_cbranch_scc1 L_fail
    s_branch Lwchk_61
Lwrty_64:
    buffer_load_dwordx4 v[104:107], v249, s[4:7], s86 offen offset:1024 sc1
    s_sub_u32 s61, s61, 1
    s_mov_b32 s67, 13
    s_cbranch_scc1 L_fail
    s_branch Lwchk_63
Lfrty_66:
    s_sleep 4
    buffer_load_dword v2, v254, s[4:7], 0 offen sc1
    s_sub_u32 s61, s61, 1
    s_mov_b32 s67, 10
    s_cbranch_scc1 L_fail
    s_waitcnt vmcnt(0)
    s_branch Lfchk_65
L_Clast:
    s_waitcnt vmcnt(0)
    s_add_u32 s64, s62, 1
    v_mov_b32 v192, s64
    s_mov_b64 exec, 1
    buffer_store_dword v192, off, s[4:7], s3
    s_mov_b64 exec, -1
    s_endpgm
L_roleT:
    s_mov_b32 s24, s42
    s_mov_b32 s25, s43
    s_mov_b32 s26, 7864320
    s_mov_b32 s27, 0x20000
    v_and_b32 v1, 63, v0
    s_and_b32 s74, s59, 1
    s_bfe_u32 s75, s59, 0x10001
    s_lshl_b32 s64, s69, 1
    s_add_u32 s75, s75, s64
    s_mul_i32 s64, s75, 983040
    s_mul_i32 s65, s60, 10240
    s_add_u32 s64, s64, s65
    s_lshl_b32 s65, s74, 8
    s_add_u32 s65, s65, s64
    v_lshrrev_b32 v164, 4, v1
    v_mul_u32_u24 v164, 1280, v164
    v_and_b32 v166, 15, v1
    v_lshl_add_u32 v164, v166, 4, v164
    v_add_u32 v164, s65, v164
    s_lshl_b32 s65, s74, 7
    s_add_u32 s65, s65, s64
    s_add_u32 s65, s65, 1024
    v_lshrrev_b32 v165, 3, v1
    v_mul_u32_u24 v165, 1280, v165
    v_and_b32 v166, 7, v1
    v_lshl_add_u32 v165, v166, 4, v165
    v_add_u32 v165, s65, v165
    v_lshrrev_b32 v166, 5, v1
    v_lshlrev_b32 v166, 4, v166
    v_bfe_u32 v167, v1, 2, 3
    v_add_u32 v166, v166, v167
    v_and_b32 v167, 3, v1
    v_lshlrev_b32 v168, 7, v166
    v_lshl_add_u32 v168, v167, 3, v168
    s_lshl_b32 s64, s60, 5
    v_add_u32 v168, s64, v168
    v_lshlrev_b32 v166, 1, v168
    v_add_u32 v167, 40960, v166
    v_add_u32 v169, 40960, v168
    v_lshlrev_b32 v240, 4, v0
    v_lshlrev_b32 v241, 4, v1
    s_lshl_b32 s64, s60, 14
    s_add_u32 s64, s64, 98304
    v_add_u32 v242, s64, v241
    s_lshl_b32 s70, s60, 11
    s_lshl_b32 s71, s60, 10
    s_mov_b32 s64, 0
    s_add_u32 m0, s70, 0
    s_nop 0
    buffer_load_dwordx4 v164, s[24:27], s64 offen lds
    s_mov_b32 s64, 5120
    s_add_u32 m0, s70, 1024
    s_nop 0
    buffer_load_dwordx4 v164, s[24:27], s64 offen lds
    s_mov_b32 s64, 512
    s_add_u32 m0, s70, 8192
    s_nop 0
    buffer_load_dwordx4 v164, s[24:27], s64 offen lds
    s_mov_b32 s64, 5632
    s_add_u32 m0, s70, 9216
    s_nop 0
    buffer_load_dwordx4 v164, s[24:27], s64 offen lds
    s_mov_b32 s64, 0
    s_add_u32 m0, s71, 16384
    s_nop 0
    buffer_load_dwordx4 v165, s[24:27], s64 offen lds
    s_mov_b32 s64, 40960
    s_add_u32 m0, s70, 20480
    s_nop 0
    buffer_load_dwordx4 v164, s[24:27], s64 offen lds
    s_mov_b32 s64, 46080
    s_add_u32 m0, s70, 21504
    s_nop 0
    buffer_load_dwordx4 v164, s[24:27], s64 offen lds
    s_mov_b32 s64, 41472
    s_add_u32 m0, s70, 28672
    s_nop 0
    buffer_load_dwordx4 v164, s[24:27], s64 offen lds
    s_mov_b32 s64, 46592
    s_add_u32 m0, s70, 29696
    s_nop 0
    buffer_load_dwordx4 v164, s[24:27], s64 offen lds
    s_mov_b32 s64, 40960
    s_add_u32 m0, s71, 36864
    s_nop 0
    buffer_load_dwordx4 v165, s[24:27], s64 offen lds
    s_mov_b32 s64, 81920
    s_add_u32 m0, s70, 40960
    s_nop 0
    buffer_load_dwordx4 v164, s[24:27], s64 offen lds
    s_mov_b32 s64, 87040
    s_add_u32 m0, s70, 41984
    s_nop 0
    buffer_load_dwordx4 v164, s[24:27], s64 offen lds
    s_mov_b32 s64, 82432
    s_add_u32 m0, s70, 49152
    s_nop 0
    buffer_load_dwordx4 v164, s[24:27], s64 offen lds
    s_mov_b32 s64, 87552
    s_add_u32 m0, s70, 50176
    s_nop 0
    buffer_load_dwordx4 v164, s[24:27], s64 offen lds
    s_mov_b32 s64, 81920
    s_add_u32 m0, s71, 57344
    s_nop 0
    buffer_load_dwordx4 v165, s[24:27], s64 offen lds
    s_cmp_lg_u32 s68, 0
    s_cbranch_scc1 Larr0_67
    s_waitcnt vmcnt(15)
    s_barrier
    s_cmp_lg_u32 s60, 0
    s_cbranch_scc1 Lcnt_68
    s_mov_b64 exec, 1
    v_mov_b32 v2, 1
    buffer_atomic_add v2, off, s[8:11], 0 offset:4 sc0
    s_mov_b64 exec, -1
Lcnt_68:
Larr0_67:
    s_waitcnt vmcnt(10)
    s_waitcnt lgkmcnt(0)
    s_barrier
    s_mov_b32 s64, 122880
    s_add_u32 m0, s70, 61440
    s_nop 0
    buffer_load_dwordx4 v164, s[24:27], s64 offen lds
    s_mov_b32 s64, 128000
    s_add_u32 m0, s70, 62464
    s_nop 0
    buffer_load_dwordx4 v164, s[24:27], s64 offen lds
    s_mov_b32 s64, 123392
    s_add_u32 m0, s70, 69632
    s_nop 0
    buffer_load_dwordx4 v164, s[24:27], s64 offen lds
    s_mov_b32 s64, 128512
    s_add_u32 m0, s70, 70656
    s_nop 0
    buffer_load_dwordx4 v164, s[24:27], s64 offen lds
    s_mov_b32 s64, 122880
    s_add_u32 m0, s71, 77824
    s_nop 0
    buffer_load_dwordx4 v165, s[24:27], s64 offen lds
    ds_read_b64_tr_b16 a[0:1], v166 offset:0
    ds_read_b64_tr_b16 a[2:3], v166 offset:2048
    ds_read_b64_tr_b16 a[4:5], v166 offset:8
    ds_read_b64_tr_b16 a[6:7], v166 offset:2056
    ds_read_b64_tr_b16 a[8:9], v166 offset:8192
    ds_read_b64_tr_b16 a[10:11], v166 offset:10240
    ds_read_b64_tr_b16 a[12:13], v166 offset:8200
    ds_read_b64_tr_b16 a[14:15], v166 offset:10248
    ds_read_b64_tr_b16 v[220:221], v168 offset:16384
    ds_read_b64_tr_b16 v[222:223], v168 offset:17408
    s_waitcnt lgkmcnt(0)
    ds_write_b128 v242, v[220:223] offset:0
    s_waitcnt vmcnt(10)
    s_waitcnt lgkmcnt(0)
    s_barrier
    s_mov_b32 s64, 163840
    s_add_u32 m0, s70, 0
    s_nop 0
    buffer_load_dwordx4 v164, s[24:27], s64 offen lds
    s_mov_b32 s64, 168960
    s_add_u32 m0, s70, 1024
    s_nop 0
    buffer_load_dwordx4 v164, s[24:27], s64 offen lds
    s_mov_b32 s64, 164352
    s_add_u32 m0, s70, 8192
    s_nop 0
    buffer_load_dwordx4 v164, s[24:27], s64 offen lds
    s_mov_b32 s64, 169472
    s_add_u32 m0, s70, 9216
    s_nop 0
    buffer_load_dwordx4 v164, s[24:27], s64 offen lds
    s_mov_b32 s64, 163840
    s_add_u32 m0, s71, 16384
    s_nop 0
    buffer_load_dwordx4 v165, s[24:27], s64 offen lds
    ds_read_b64_tr_b16 a[16:17], v166 offset:20480
    ds_read_b64_tr_b16 a[18:19], v166 offset:22528
    ds_read_b64_tr_b16 a[20:21], v166 offset:20488
    ds_read_b64_tr_b16 a[22:23], v166 offset:22536
    ds_read_b64_tr_b16 a[24:25], v166 offset:28672
    ds_read_b64_tr_b16 a[26:27], v166 offset:30720
    ds_read_b64_tr_b16 a[28:29], v166 offset:28680
    ds_read_b64_tr_b16 a[30:31], v166 offset:30728
    ds_read_b64_tr_b16 v[224:225], v168 offset:36864
    ds_read_b64_tr_b16 v[226:227], v168 offset:37888
    s_waitcnt lgkmcnt(0)
    ds_write_b128 v242, v[224:227] offset:1024
    s_waitcnt vmcnt(10)
    s_waitcnt lgkmcnt(0)
    s_barrier
    s_mov_b32 s64, 204800
    s_add_u32 m0, s70, 20480
    s_nop 0
    buffer_load_dwordx4 v164, s[24:27], s64 offen lds
    s_mov_b32 s64, 209920
    s_add_u32 m0, s70, 21504
    s_nop 0
    buffer_load_dwordx4 v164, s[24:27], s64 offen lds
    s_mov_b32 s64, 205312
    s_add_u32 m0, s70, 28672
    s_nop 0
    buffer_load_dwordx4 v164, s[24:27], s64 offen lds
    s_mov_b32 s64, 210432
    s_add_u32 m0, s70, 29696
    s_nop 0
    buffer_load_dwordx4 v164, s[24:27], s64 offen lds
    s_mov_b32 s64, 204800
    s_add_u32 m0, s71, 36864
    s_nop 0
    buffer_load_dwordx4 v165, s[24:27], s64 offen lds
    s_cmp_lg_u32 s68, 0
    s_cbranch_scc1 Larr0_69
    s_cmp_lg_u32 s60, 0
    s_cbranch_scc1 Lcnt_70
    s_mov_b64 exec, 1
    v_mov_b32 v3, 0x80000000
    v_cmp_ne_u32 vcc, 255, v2
    s_nop 1
    v_cndmask_b32 v3, 4, v3, vcc
    buffer_store_dword v2, v3, s[8:11], 0 offen offset:128 sc1
    s_mov_b64 exec, -1
Lcnt_70:
Larr0_69:
    ds_read_b64_tr_b16 a[32:33], v167 offset:0
    ds_read_b64_tr_b16 a[34:35], v167 offset:2048
    ds_read_b64_tr_b16 a[36:37], v167 offset:8
    ds_read_b64_tr_b16 a[38:39], v167 offset:2056
    ds_read_b64_tr_b16 a[40:41], v167 offset:8192
    ds_read_b64_tr_b16 a[42:43], v167 offset:10240
    ds_read_b64_tr_b16 a[44:45], v167 offset:8200
    ds_read_b64_tr_b16 a[46:47], v167 offset:10248
    ds_read_b64_tr_b16 v[220:221], v169 offset:16384
    ds_read_b64_tr_b16 v[222:223], v169 offset:17408
    s_waitcnt lgkmcnt(0)
    ds_write_b128 v242, v[220:223] offset:2048
    s_waitcnt vmcnt(10)
    s_waitcnt lgkmcnt(0)
    s_barrier
    s_mov_b32 s64, 245760
    s_add_u32 m0, s70, 40960
    s_nop 0
    buffer_load_dwordx4 v164, s[24:27], s64 offen lds
    s_mov_b32 s64, 250880
    s_add_u32 m0, s70, 41984
    s_nop 0
    buffer_load_dwordx4 v164, s[24:27], s64 offen lds
    s_mov_b32 s64, 246272
    s_add_u32 m0, s70, 49152
    s_nop 0
    buffer_load_dwordx4 v164, s[24:27], s64 offen lds
    s_mov_b32 s64, 251392
    s_add_u32 m0, s70, 50176
    s_nop 0
    buffer_load_dwordx4 v164, s[24:27], s64 offen lds
    s_mov_b32 s64, 245760
    s_add_u32 m0, s71, 57344
    s_nop 0
    buffer_load_dwordx4 v165, s[24:27], s64 offen lds
    ds_read_b64_tr_b16 a[48:49], v167 offset:20480
    ds_read_b64_tr_b16 a[50:51], v167 offset:22528
    ds_read_b64_tr_b16 a[52:53], v167 offset:20488
    ds_read_b64_tr_b16 a[54:55], v167 offset:22536
    ds_read_b64_tr_b16 a[56:57], v167 offset:28672
    ds_read_b64_tr_b16 a[58:59], v167 offset:30720
    ds_read_b64_tr_b16 a[60:61], v167 offset:28680
    ds_read_b64_tr_b16 a[62:63], v167 offset:30728
    ds_read_b64_tr_b16 v[224:225], v169 offset:36864
    ds_read_b64_tr_b16 v[226:227], v169 offset:37888
    s_waitcnt lgkmcnt(0)
    ds_write_b128 v242, v[224:227] offset:3072
    s_waitcnt vmcnt(10)
    s_waitcnt lgkmcnt(0)
    s_barrier
    s_mov_b32 s64, 286720
    s_add_u32 m0, s70, 61440
    s_nop 0
    buffer_load_dwordx4 v164, s[24:27], s64 offen lds
    s_mov_b32 s64, 291840
    s_add_u32 m0, s70, 62464
    s_nop 0
    buffer_load_dwordx4 v164, s[24:27], s64 offen lds
    s_mov_b32 s64, 287232
    s_add_u32 m0, s70, 69632
    s_nop 0
    buffer_load_dwordx4 v164, s[24:27], s64 offen lds
    s_mov_b32 s64, 292352
    s_add_u32 m0, s70, 70656
    s_nop 0
    buffer_load_dwordx4 v164, s[24:27], s64 offen lds
    s_mov_b32 s64, 286720
    s_add_u32 m0, s71, 77824
    s_nop 0
    buffer_load_dwordx4 v165, s[24:27], s64 offen lds
    ds_read_b64_tr_b16 a[64:65], v166 offset:0
    ds_read_b64_tr_b16 a[66:67], v166 offset:2048
    ds_read_b64_tr_b16 a[68:69], v166 offset:8
    ds_read_b64_tr_b16 a[70:71], v166 offset:2056
    ds_read_b64_tr_b16 a[72:73], v166 offset:8192
    ds_read_b64_tr_b16 a[74:75], v166 offset:10240
    ds_read_b64_tr_b16 a[76:77], v166 offset:8200
    ds_read_b64_tr_b16 a[78:79], v166 offset:10248
    ds_read_b64_tr_b16 v[220:221], v168 offset:16384
    ds_read_b64_tr_b16 v[222:223], v168 offset:17408
    s_waitcnt lgkmcnt(0)
    ds_write_b128 v242, v[220:223] offset:4096
    s_waitcnt vmcnt(10)
    s_waitcnt lgkmcnt(0)
    s_barrier
    s_mov_b32 s64, 327680
    s_add_u32 m0, s70, 0
    s_nop 0
    buffer_load_dwordx4 v164, s[24:27], s64 offen lds
    s_mov_b32 s64, 332800
    s_add_u32 m0, s70, 1024
    s_nop 0
    buffer_load_dwordx4 v164, s[24:27], s64 offen lds
    s_mov_b32 s64, 328192
    s_add_u32 m0, s70, 8192
    s_nop 0
    buffer_load_dwordx4 v164, s[24:27], s64 offen lds
    s_mov_b32 s64, 333312
    s_add_u32 m0, s70, 9216
    s_nop 0
    buffer_load_dwordx4 v164, s[24:27], s64 offen lds
    s_mov_b32 s64, 327680
    s_add_u32 m0, s71, 16384
    s_nop 0
    buffer_load_dwordx4 v165, s[24:27], s64 offen lds
    ds_read_b64_tr_b16 a[80:81], v166 offset:20480
    ds_read_b64_tr_b16 a[82:83], v166 offset:22528
    ds_read_b64_tr_b16 a[84:85], v166 offset:20488
    ds_read_b64_tr_b16 a[86:87], v166 offset:22536
    ds_read_b64_tr_b16 a[88:89], v166 offset:28672
    ds_read_b64_tr_b16 a[90:91], v166 offset:30720
    ds_read_b64_tr_b16 a[92:93], v166 offset:28680
    ds_read_b64_tr_b16 a[94:95], v166 offset:30728
    ds_read_b64_tr_b16 v[224:225], v168 offset:36864
    ds_read_b64_tr_b16 v[226:227], v168 offset:37888
    s_waitcnt lgkmcnt(0)
    ds_write_b128 v242, v[224:227] offset:5120
    s_waitcnt vmcnt(10)
    s_waitcnt lgkmcnt(0)
    s_barrier
    s_mov_b32 s64, 368640
    s_add_u32 m0, s70, 20480
    s_nop 0
    buffer_load_dwordx4 v164, s[24:27], s64 offen lds
    s_mov_b32 s64, 373760
    s_add_u32 m0, s70, 21504
    s_nop 0
    buffer_load_dwordx4 v164, s[24:27], s64 offen lds
    s_mov_b32 s64, 369152
    s_add_u32 m0, s70, 28672
    s_nop 0
    buffer_load_dwordx4 v164, s[24:27], s64 offen lds
    s_mov_b32 s64, 374272
    s_add_u32 m0, s70, 29696
    s_nop 0
    buffer_load_dwordx4 v164, s[24:27], s64 offen lds
    s_mov_b32 s64, 368640
    s_add_u32 m0, s71, 36864
    s_nop 0
    buffer_load_dwordx4 v165, s[24:27], s64 offen lds
    ds_read_b64_tr_b16 a[96:97], v167 offset:0
    ds_read_b64_tr_b16 a[98:99], v167 offset:2048
    ds_read_b64_tr_b16 a[100:101], v167 offset:8
    ds_read_b64_tr_b16 a[102:103], v167 offset:2056
    ds_read_b64_tr_b16 a[104:105], v167 offset:8192
    ds_read_b64_tr_b16 a[106:107], v167 offset:10240
    ds_read_b64_tr_b16 a[108:109], v167 offset:8200
    ds_read_b64_tr_b16 a[110:111], v167 offset:10248
    ds_read_b64_tr_b16 v[220:221], v169 offset:16384
    ds_read_b64_tr_b16 v[222:223], v169 offset:17408
    s_waitcnt lgkmcnt(0)
    ds_write_b128 v242, v[220:223] offset:6144
    s_waitcnt vmcnt(10)
    s_waitcnt lgkmcnt(0)
    s_barrier
    s_mov_b32 s64, 409600
    s_add_u32 m0, s70, 40960
    s_nop 0
    buffer_load_dwordx4 v164, s[24:27], s64 offen lds
    s_mov_b32 s64, 414720
    s_add_u32 m0, s70, 41984
    s_nop 0
    buffer_load_dwordx4 v164, s[24:27], s64 offen lds
    s_mov_b32 s64, 410112
    s_add_u32 m0, s70, 49152
    s_nop 0
    buffer_load_dwordx4 v164, s[24:27], s64 offen lds
    s_mov_b32 s64, 415232
    s_add_u32 m0, s70, 50176
    s_nop 0
    buffer_load_dwordx4 v164, s[24:27], s64 offen lds
    s_mov_b32 s64, 409600
    s_add_u32 m0, s71, 57344
    s_nop 0
    buffer_load_dwordx4 v165, s[24:27], s64 offen lds
    ds_read_b64_tr_b16 a[112:113], v167 offset:20480
    ds_read_b64_tr_b16 a[114:115], v167 offset:22528
    ds_read_b64_tr_b16 a[116:117], v167 offset:20488
    ds_read_b64_tr_b16 a[118:119], v167 offset:22536
    ds_read_b64_tr_b16 a[120:121], v167 offset:28672
    ds_read_b64_tr_b16 a[122:123], v167 offset:30720
    ds_read_b64_tr_b16 a[124:125], v167 offset:28680
    ds_read_b64_tr_b16 a[126:127], v167 offset:30728
    ds_read_b64_tr_b16 v[224:225], v169 offset:36864
    ds_read_b64_tr_b16 v[226:227], v169 offset:37888
    s_waitcnt lgkmcnt(0)
    ds_write_b128 v242, v[224:227] offset:7168
    s_waitcnt vmcnt(10)
    s_waitcnt lgkmcnt(0)
    s_barrier
    s_mov_b32 s64, 450560
    s_add_u32 m0, s70, 61440
    s_nop 0
    buffer_load_dwordx4 v164, s[24:27], s64 offen lds
    s_mov_b32 s64, 455680
    s_add_u32 m0, s70, 62464
    s_nop 0
    buffer_load_dwordx4 v164, s[24:27], s64 offen lds
    s_mov_b32 s64, 451072
    s_add_u32 m0, s70, 69632
    s_nop 0
    buffer_load_dwordx4 v164, s[24:27], s64 offen lds
    s_mov_b32 s64, 456192
    s_add_u32 m0, s70, 70656
    s_nop 0
    buffer_load_dwordx4 v164, s[24:27], s64 offen lds
    s_mov_b32 s64, 450560
    s_add_u32 m0, s71, 77824
    s_nop 0
    buffer_load_dwordx4 v165, s[24:27], s64 offen lds
    ds_read_b64_tr_b16 a[128:129], v166 offset:0
    ds_read_b64_tr_b16 a[130:131], v166 offset:2048
    ds_read_b64_tr_b16 a[132:133], v166 offset:8
    ds_read_b64_tr_b16 a[134:135], v166 offset:2056
    ds_read_b64_tr_b16 a[136:137], v166 offset:8192
    ds_read_b64_tr_b16 a[138:139], v166 offset:10240
    ds_read_b64_tr_b16 a[140:141], v166 offset:8200
    ds_read_b64_tr_b16 a[142:143], v166 offset:10248
    ds_read_b64_tr_b16 v[220:221], v168 offset:16384
    ds_read_b64_tr_b16 v[222:223], v168 offset:17408
    s_waitcnt lgkmcnt(0)
    ds_write_b128 v242, v[220:223] offset:8192
    s_waitcnt vmcnt(10)
    s_waitcnt lgkmcnt(0)
    s_barrier
    s_mov_b32 s64, 491520
    s_add_u32 m0, s70, 0
    s_nop 0
    buffer_load_dwordx4 v164, s[24:27], s64 offen lds
    s_mov_b32 s64, 496640
    s_add_u32 m0, s70, 1024
    s_nop 0
    buffer_load_dwordx4 v164, s[24:27], s64 offen lds
    s_mov_b32 s64, 492032
    s_add_u32 m0, s70, 8192
    s_nop 0
    buffer_load_dwordx4 v164, s[24:27], s64 offen lds
    s_mov_b32 s64, 497152
    s_add_u32 m0, s70, 9216
    s_nop 0
    buffer_load_dwordx4 v164, s[24:27], s64 offen lds
    s_mov_b32 s64, 491520
    s_add_u32 m0, s71, 16384
    s_nop 0
    buffer_load_dwordx4 v165, s[24:27], s64 offen lds
    ds_read_b64_tr_b16 a[144:145], v166 offset:20480
    ds_read_b64_tr_b16 a[146:147], v166 offset:22528
    ds_read_b64_tr_b16 a[148:149], v166 offset:20488
    ds_read_b64_tr_b16 a[150:151], v166 offset:22536
    ds_read_b64_tr_b16 a[152:153], v166 offset:28672
    ds_read_b64_tr_b16 a[154:155], v166 offset:30720
    ds_read_b64_tr_b16 a[156:157], v166 offset:28680
    ds_read_b64_tr_b16 a[158:159], v166 offset:30728
    ds_read_b64_tr_b16 v[224:225], v168 offset:36864
    ds_read_b64_tr_b16 v[226:227], v168 offset:37888
    s_waitcnt lgkmcnt(0)
    ds_write_b128 v242, v[224:227] offset:9216
    s_waitcnt vmcnt(10)
    s_waitcnt lgkmcnt(0)
    s_barrier
    s_mov_b32 s64, 532480
    s_add_u32 m0, s70, 20480
    s_nop 0
    buffer_load_dwordx4 v164, s[24:27], s64 offen lds
    s_mov_b32 s64, 537600
    s_add_u32 m0, s70, 21504
    s_nop 0
    buffer_load_dwordx4 v164, s[24:27], s64 offen lds
    s_mov_b32 s64, 532992
    s_add_u32 m0, s70, 28672
    s_nop 0
    buffer_load_dwordx4 v164, s[24:27], s64 offen lds
    s_mov_b32 s64, 538112
    s_add_u32 m0, s70, 29696
    s_nop 0
    buffer_load_dwordx4 v164, s[24:27], s64 offen lds
    s_mov_b32 s64, 532480
    s_add_u32 m0, s71, 36864
    s_nop 0
    buffer_load_dwordx4 v165, s[24:27], s64 offen lds
    ds_read_b64_tr_b16 a[160:161], v167 offset:0
    ds_read_b64_tr_b16 a[162:163], v167 offset:2048
    ds_read_b64_tr_b16 a[164:165], v167 offset:8
    ds_read_b64_tr_b16 a[166:167], v167 offset:2056
    ds_read_b64_tr_b16 a[168:169], v167 offset:8192
    ds_read_b64_tr_b16 a[170:171], v167 offset:10240
    ds_read_b64_tr_b16 a[172:173], v167 offset:8200
    ds_read_b64_tr_b16 a[174:175], v167 offset:10248
    ds_read_b64_tr_b16 v[220:221], v169 offset:16384
    ds_read_b64_tr_b16 v[222:223], v169 offset:17408
    s_waitcnt lgkmcnt(0)
    ds_write_b128 v242, v[220:223] offset:10240
    s_waitcnt vmcnt(10)
    s_waitcnt lgkmcnt(0)
    s_barrier
    s_mov_b32 s64, 573440
    s_add_u32 m0, s70, 40960
    s_nop 0
    buffer_load_dwordx4 v164, s[24:27], s64 offen lds
    s_mov_b32 s64, 578560
    s_add_u32 m0, s70, 41984
    s_nop 0
    buffer_load_dwordx4 v164, s[24:27], s64 offen lds
    s_mov_b32 s64, 573952
    s_add_u32 m0, s70, 49152
    s_nop 0
    buffer_load_dwordx4 v164, s[24:27], s64 offen lds
    s_mov_b32 s64, 579072
    s_add_u32 m0, s70, 50176
    s_nop 0
    buffer_load_dwordx4 v164, s[24:27], s64 offen lds
    s_mov_b32 s64, 573440
    s_add_u32 m0, s71, 57344
    s_nop 0
    buffer_load_dwordx4 v165, s[24:27], s64 offen lds
    ds_read_b64_tr_b16 a[176:177], v167 offset:20480
    ds_read_b64_tr_b16 a[178:179], v167 offset:22528
    ds_read_b64_tr_b16 a[180:181], v167 offset:20488
    ds_read_b64_tr_b16 a[182:183], v167 offset:22536
    ds_read_b64_tr_b16 a[184:185], v167 offset:28672
    ds_read_b64_tr_b16 a[186:187], v167 offset:30720
    ds_read_b64_tr_b16 a[188:189], v167 offset:28680
    ds_read_b64_tr_b16 a[190:191], v167 offset:30728
    ds_read_b64_tr_b16 v[224:225], v169 offset:36864
    ds_read_b64_tr_b16 v[226:227], v169 offset:37888
    s_waitcnt lgkmcnt(0)
    ds_write_b128 v242, v[224:227] offset:11264
    s_waitcnt vmcnt(10)
    s_waitcnt lgkmcnt(0)
    s_barrier
    s_mov_b32 s64, 614400
    s_add_u32 m0, s70, 61440
    s_nop 0
    buffer_load_dwordx4 v164, s[24:27], s64 offen lds
    s_mov_b32 s64, 619520
    s_add_u32 m0, s70, 62464
    s_nop 0
    buffer_load_dwordx4 v164, s[24:27], s64 offen lds
    s_mov_b32 s64, 614912
    s_add_u32 m0, s70, 69632
    s_nop 0
    buffer_load_dwordx4 v164, s[24:27], s64 offen lds
    s_mov_b32 s64, 620032
    s_add_u32 m0, s70, 70656
    s_nop 0
    buffer_load_dwordx4 v164, s[24:27], s64 offen lds
    s_mov_b32 s64, 614400
    s_add_u32 m0, s71, 77824
    s_nop 0
    buffer_load_dwordx4 v165, s[24:27], s64 offen lds
    ds_read_b64_tr_b16 a[192:193], v166 offset:0
    ds_read_b64_tr_b16 a[194:195], v166 offset:2048
    ds_read_b64_tr_b16 a[196:197], v166 offset:8
    ds_read_b64_tr_b16 a[198:199], v166 offset:2056
    ds_read_b64_tr_b16 a[200:201], v166 offset:8192
    ds_read_b64_tr_b16 a[202:203], v166 offset:10240
    ds_read_b64_tr_b16 a[204:205], v166 offset:8200
    ds_read_b64_tr_b16 a[206:207], v166 offset:10248
    ds_read_b64_tr_b16 v[220:221], v168 offset:16384
    ds_read_b64_tr_b16 v[222:223], v168 offset:17408
    s_waitcnt lgkmcnt(0)
    ds_write_b128 v242, v[220:223] offset:12288
    s_waitcnt vmcnt(10)
    s_waitcnt lgkmcnt(0)
    s_barrier
    s_mov_b32 s64, 655360
    s_add_u32 m0, s70, 0
    s_nop 0
    buffer_load_dwordx4 v164, s[24:27], s64 offen lds
    s_mov_b32 s64, 660480
    s_add_u32 m0, s70, 1024
    s_nop 0
    buffer_load_dwordx4 v164, s[24:27], s64 offen lds
    s_mov_b32 s64, 655872
    s_add_u32 m0, s70, 8192
    s_nop 0
    buffer_load_dwordx4 v164, s[24:27], s64 offen lds
    s_mov_b32 s64, 660992
    s_add_u32 m0, s70, 9216
    s_nop 0
    buffer_load_dwordx4 v164, s[24:27], s64 offen lds
    s_mov_b32 s64, 655360
    s_add_u32 m0, s71, 16384
    s_nop 0
    buffer_load_dwordx4 v165, s[24:27], s64 offen lds
    ds_read_b64_tr_b16 a[208:209], v166 offset:20480
    ds_read_b64_tr_b16 a[210:211], v166 offset:22528
    ds_read_b64_tr_b16 a[212:213], v166 offset:20488
    ds_read_b64_tr_b16 a[214:215], v166 offset:22536
    ds_read_b64_tr_b16 a[216:217], v166 offset:28672
    ds_read_b64_tr_b16 a[218:219], v166 offset:30720
    ds_read_b64_tr_b16 a[220:221], v166 offset:28680
    ds_read_b64_tr_b16 a[222:223], v166 offset:30728
    ds_read_b64_tr_b16 v[224:225], v168 offset:36864
    ds_read_b64_tr_b16 v[226:227], v168 offset:37888
    s_waitcnt lgkmcnt(0)
    ds_write_b128 v242, v[224:227] offset:13312
    s_waitcnt vmcnt(10)
    s_waitcnt lgkmcnt(0)
    s_barrier
    s_mov_b32 s64, 696320
    s_add_u32 m0, s70, 20480
    s_nop 0
    buffer_load_dwordx4 v164, s[24:27], s64 offen lds
    s_mov_b32 s64, 701440
    s_add_u32 m0, s70, 21504
    s_nop 0
    buffer_load_dwordx4 v164, s[24:27], s64 offen lds
    s_mov_b32 s64, 696832
    s_add_u32 m0, s70, 28672
    s_nop 0
    buffer_load_dwordx4 v164, s[24:27], s64 offen lds
    s_mov_b32 s64, 701952
    s_add_u32 m0, s70, 29696
    s_nop 0
    buffer_load_dwordx4 v164, s[24:27], s64 offen lds
    s_mov_b32 s64, 696320
    s_add_u32 m0, s71, 36864
    s_nop 0
    buffer_load_dwordx4 v165, s[24:27], s64 offen lds
    ds_read_b64_tr_b16 a[224:225], v167 offset:0
    ds_read_b64_tr_b16 a[226:227], v167 offset:2048
    ds_read_b64_tr_b16 a[228:229], v167 offset:8
    ds_read_b64_tr_b16 a[230:231], v167 offset:2056
    ds_read_b64_tr_b16 a[232:233], v167 offset:8192
    ds_read_b64_tr_b16 a[234:235], v167 offset:10240
    ds_read_b64_tr_b16 a[236:237], v167 offset:8200
    ds_read_b64_tr_b16 a[238:239], v167 offset:10248
    ds_read_b64_tr_b16 v[220:221], v169 offset:16384
    ds_read_b64_tr_b16 v[222:223], v169 offset:17408
    s_waitcnt lgkmcnt(0)
    ds_write_b128 v242, v[220:223] offset:14336
    s_waitcnt vmcnt(10)
    s_waitcnt lgkmcnt(0)
    s_barrier
    s_mov_b32 s64, 737280
    s_add_u32 m0, s70, 40960
    s_nop 0
    buffer_load_dwordx4 v164, s[24:27], s64 offen lds
    s_mov_b32 s64, 742400
    s_add_u32 m0, s70, 41984
    s_nop 0
    buffer_load_dwordx4 v164, s[24:27], s64 offen lds
    s_mov_b32 s64, 737792
    s_add_u32 m0, s70, 49152
    s_nop 0
    buffer_load_dwordx4 v164, s[24:27], s64 offen lds
    s_mov_b32 s64, 742912
    s_add_u32 m0, s70, 50176
    s_nop 0
    buffer_load_dwordx4 v164, s[24:27], s64 offen lds
    s_mov_b32 s64, 737280
    s_add_u32 m0, s71, 57344
    s_nop 0
    buffer_load_dwordx4 v165, s[24:27], s64 offen lds
    ds_read_b64_tr_b16 a[240:241], v167 offset:20480
    ds_read_b64_tr_b16 a[242:243], v167 offset:22528
    ds_read_b64_tr_b16 a[244:245], v167 offset:20488
    ds_read_b64_tr_b16 a[246:247], v167 offset:22536
    ds_read_b64_tr_b16 a[248:249], v167 offset:28672
    ds_read_b64_tr_b16 a[250:251], v167 offset:30720
    ds_read_b64_tr_b16 a[252:253], v167 offset:28680
    ds_read_b64_tr_b16 a[254:255], v167 offset:30728
    ds_read_b64_tr_b16 v[224:225], v169 offset:36864
    ds_read_b64_tr_b16 v[226:227], v169 offset:37888
    s_waitcnt lgkmcnt(0)
    ds_write_b128 v242, v[224:227] offset:15360
    s_waitcnt vmcnt(10)
    s_waitcnt lgkmcnt(0)
    s_barrier
    s_mov_b32 s64, 778240
    s_add_u32 m0, s70, 61440
    s_nop 0
    buffer_load_dwordx4 v164, s[24:27], s64 offen lds
    s_mov_b32 s64, 783360
    s_add_u32 m0, s70, 62464
    s_nop 0
    buffer_load_dwordx4 v164, s[24:27], s64 offen lds
    s_mov_b32 s64, 778752
    s_add_u32 m0, s70, 69632
    s_nop 0
    buffer_load_dwordx4 v164, s[24:27], s64 offen lds
    s_mov_b32 s64, 783872
    s_add_u32 m0, s70, 70656
    s_nop 0
    buffer_load_dwordx4 v164, s[24:27], s64 offen lds
    s_mov_b32 s64, 778240
    s_add_u32 m0, s71, 77824
    s_nop 0
    buffer_load_dwordx4 v165, s[24:27], s64 offen lds
    ds_read_b64_tr_b16 v[4:5], v166 offset:0
    ds_read_b64_tr_b16 v[6:7], v166 offset:2048
    ds_read_b64_tr_b16 v[8:9], v166 offset:8
    ds_read_b64_tr_b16 v[10:11], v166 offset:2056
    ds_read_b64_tr_b16 v[12:13], v166 offset:8192
    ds_read_b64_tr_b16 v[14:15], v166 offset:10240
    ds_read_b64_tr_b16 v[16:17], v166 offset:8200
    ds_read_b64_tr_b16 v[18:19], v166 offset:10248
    ds_read_b64_tr_b16 v[132:133], v168 offset:16384
    ds_read_b64_tr_b16 v[134:135], v168 offset:17408
    s_waitcnt vmcnt(10)
    s_waitcnt lgkmcnt(0)
    s_barrier
    s_mov_b32 s64, 819200
    s_add_u32 m0, s70, 0
    s_nop 0
    buffer_load_dwordx4 v164, s[24:27], s64 offen lds
    s_mov_b32 s64, 824320
    s_add_u32 m0, s70, 1024
    s_nop 0
    buffer_load_dwordx4 v164, s[24:27], s64 offen lds
    s_mov_b32 s64, 819712
    s_add_u32 m0, s70, 8192
    s_nop 0
    buffer_load_dwordx4 v164, s[24:27], s64 offen lds
    s_mov_b32 s64, 824832
    s_add_u32 m0, s70, 9216
    s_nop 0
    buffer_load_dwordx4 v164, s[24:27], s64 offen lds
    s_mov_b32 s64, 819200
    s_add_u32 m0, s71, 16384
    s_nop 0
    buffer_load_dwordx4 v165, s[24:27], s64 offen lds
    ds_read_b64_tr_b16 v[20:21], v166 offset:20480
    ds_read_b64_tr_b16 v[22:23], v166 offset:22528
    ds_read_b64_tr_b16 v[24:25], v166 offset:20488
    ds_read_b64_tr_b16 v[26:27], v166 offset:22536
    ds_read_b64_tr_b16 v[28:29], v166 offset:28672
    ds_read_b64_tr_b16 v[30:31], v166 offset:30720
    ds_read_b64_tr_b16 v[32:33], v166 offset:28680
    ds_read_b64_tr_b16 v[34:35], v166 offset:30728
    ds_read_b64_tr_b16 v[136:137], v168 offset:36864
    ds_read_b64_tr_b16 v[138:139], v168 offset:37888
    s_waitcnt vmcnt(10)
    s_waitcnt lgkmcnt(0)
    s_barrier
    s_mov_b32 s64, 860160
    s_add_u32 m0, s70, 20480
    s_nop 0
    buffer_load_dwordx4 v164, s[24:27], s64 offen lds
    s_mov_b32 s64, 865280
    s_add_u32 m0, s70, 21504
    s_nop 0
    buffer_load_dwordx4 v164, s[24:27], s64 offen lds
    s_mov_b32 s64, 860672
    s_add_u32 m0, s70, 28672
    s_nop 0
    buffer_load_dwordx4 v164, s[24:27], s64 offen lds
    s_mov_b32 s64, 865792
    s_add_u32 m0, s70, 29696
    s_nop 0
    buffer_load_dwordx4 v164, s[24:27], s64 offen lds
    s_mov_b32 s64, 860160
    s_add_u32 m0, s71, 36864
    s_nop 0
    buffer_load_dwordx4 v165, s[24:27], s64 offen lds
    ds_read_b64_tr_b16 v[36:37], v167 offset:0
    ds_read_b64_tr_b16 v[38:39], v167 offset:2048
    ds_read_b64_tr_b16 v[40:41], v167 offset:8
    ds_read_b64_tr_b16 v[42:43], v167 offset:2056
    ds_read_b64_tr_b16 v[44:45], v167 offset:8192
    ds_read_b64_tr_b16 v[46:47], v167 offset:10240
    ds_read_b64_tr_b16 v[48:49], v167 offset:8200
    ds_read_b64_tr_b16 v[50:51], v167 offset:10248
    ds_read_b64_tr_b16 v[140:141], v169 offset:16384
    ds_read_b64_tr_b16 v[142:143], v169 offset:17408
    s_waitcnt vmcnt(10)
    s_waitcnt lgkmcnt(0)
    s_barrier
    s_mov_b32 s64, 901120
    s_add_u32 m0, s70, 40960
    s_nop 0
    buffer_load_dwordx4 v164, s[24:27], s64 offen lds
    s_mov_b32 s64, 906240
    s_add_u32 m0, s70, 41984
    s_nop 0
    buffer_load_dwordx4 v164, s[24:27], s64 offen lds
    s_mov_b32 s64, 901632
    s_add_u32 m0, s70, 49152
    s_nop 0
    buffer_load_dwordx4 v164, s[24:27], s64 offen lds
    s_mov_b32 s64, 906752
    s_add_u32 m0, s70, 50176
    s_nop 0
    buffer_load_dwordx4 v164, s[24:27], s64 offen lds
    s_mov_b32 s64, 901120
    s_add_u32 m0, s71, 57344
    s_nop 0
    buffer_load_dwordx4 v165, s[24:27], s64 offen lds
    ds_read_b64_tr_b16 v[52:53], v167 offset:20480
    ds_read_b64_tr_b16 v[54:55], v167 offset:22528
    ds_read_b64_tr_b16 v[56:57], v167 offset:20488
    ds_read_b64_tr_b16 v[58:59], v167 offset:22536
    ds_read_b64_tr_b16 v[60:61], v167 offset:28672
    ds_read_b64_tr_b16 v[62:63], v167 offset:30720
    ds_read_b64_tr_b16 v[64:65], v167 offset:28680
    ds_read_b64_tr_b16 v[66:67], v167 offset:30728
    ds_read_b64_tr_b16 v[144:145], v169 offset:36864
    ds_read_b64_tr_b16 v[146:147], v169 offset:37888
    s_waitcnt vmcnt(10)
    s_waitcnt lgkmcnt(0)
    s_barrier
    s_mov_b32 s64, 942080
    s_add_u32 m0, s70, 61440
    s_nop 0
    buffer_load_dwordx4 v164, s[24:27], s64 offen lds
    s_mov_b32 s64, 947200
    s_add_u32 m0, s70, 62464
    s_nop 0
    buffer_load_dwordx4 v164, s[24:27], s64 offen lds
    s_mov_b32 s64, 942592
    s_add_u32 m0, s70, 69632
    s_nop 0
    buffer_load_dwordx4 v164, s[24:27], s64 offen lds
    s_mov_b32 s64, 947712
    s_add_u32 m0, s70, 70656
    s_nop 0
    buffer_load_dwordx4 v164, s[24:27], s64 offen lds
    s_mov_b32 s64, 942080
    s_add_u32 m0, s71, 77824
    s_nop 0
    buffer_load_dwordx4 v165, s[24:27], s64 offen lds
    ds_read_b64_tr_b16 v[68:69], v166 offset:0
    ds_read_b64_tr_b16 v[70:71], v166 offset:2048
    ds_read_b64_tr_b16 v[72:73], v166 offset:8
    ds_read_b64_tr_b16 v[74:75], v166 offset:2056
    ds_read_b64_tr_b16 v[76:77], v166 offset:8192
    ds_read_b64_tr_b16 v[78:79], v166 offset:10240
    ds_read_b64_tr_b16 v[80:81], v166 offset:8200
    ds_read_b64_tr_b16 v[82:83], v166 offset:10248
    ds_read_b64_tr_b16 v[148:149], v168 offset:16384
    ds_read_b64_tr_b16 v[150:151], v168 offset:17408
    s_waitcnt vmcnt(10)
    s_waitcnt lgkmcnt(0)
    s_barrier
    ds_read_b64_tr_b16 v[84:85], v166 offset:20480
    ds_read_b64_tr_b16 v[86:87], v166 offset:22528
    ds_read_b64_tr_b16 v[88:89], v166 offset:20488
    ds_read_b64_tr_b16 v[90:91], v166 offset:22536
    ds_read_b64_tr_b16 v[92:93], v166 offset:28672
    ds_read_b64_tr_b16 v[94:95], v166 offset:30720
    ds_read_b64_tr_b16 v[96:97], v166 offset:28680
    ds_read_b64_tr_b16 v[98:99], v166 offset:30728
    ds_read_b64_tr_b16 v[152:153], v168 offset:36864
    ds_read_b64_tr_b16 v[154:155], v168 offset:37888
    s_waitcnt vmcnt(5)
    s_waitcnt lgkmcnt(0)
    s_barrier
    ds_read_b64_tr_b16 v[100:101], v167 offset:0
    ds_read_b64_tr_b16 v[102:103], v167 offset:2048
    ds_read_b64_tr_b16 v[104:105], v167 offset:8
    ds_read_b64_tr_b16 v[106:107], v167 offset:2056
    ds_read_b64_tr_b16 v[108:109], v167 offset:8192
    ds_read_b64_tr_b16 v[110:111], v167 offset:10240
    ds_read_b64_tr_b16 v[112:113], v167 offset:8200
    ds_read_b64_tr_b16 v[114:115], v167 offset:10248
    ds_read_b64_tr_b16 v[156:157], v169 offset:16384
    ds_read_b64_tr_b16 v[158:159], v169 offset:17408
    s_waitcnt vmcnt(0)
    s_waitcnt lgkmcnt(0)
    s_barrier
    ds_read_b64_tr_b16 v[116:117], v167 offset:20480
    ds_read_b64_tr_b16 v[118:119], v167 offset:22528
    ds_read_b64_tr_b16 v[120:121], v167 offset:20488
    ds_read_b64_tr_b16 v[122:123], v167 offset:22536
    ds_read_b64_tr_b16 v[124:125], v167 offset:28672
    ds_read_b64_tr_b16 v[126:127], v167 offset:30720
    ds_read_b64_tr_b16 v[128:129], v167 offset:28680
    ds_read_b64_tr_b16 v[130:131], v167 offset:30728
    ds_read_b64_tr_b16 v[160:161], v169 offset:36864
    ds_read_b64_tr_b16 v[162:163], v169 offset:37888
    v_and_b32 v164, 15, v1
    v_lshrrev_b32 v165, 4, v1
    v_lshlrev_b32 v244, 5, v164
    v_lshl_add_u32 v244, v165, 3, v244
    v_lshlrev_b32 v243, 1, v244
    s_lshl_b32 s64, s74, 2
    s_add_u32 s64, s64, s60
    s_mul_i32 s64, s64, 5120
    v_add_u32 v243, s64, v243
    s_add_u32 s64, s64, 4096
    v_add_u32 v244, s64, v244
    v_min_u32 v245, 47, v1
    s_and_b32 s64, s75, 1
    s_mul_i32 s64, s64, 48
    s_lshl_b32 s65, s58, 7
    s_add_u32 s64, s64, s65
    v_add_u32 v245, s64, v245
    v_lshlrev_b32 v245, 7, v245
    v_add_u32 v245, 8519680, v245
    s_lshl_b32 s64, s68, 9
    s_add_u32 s64, s64, s75
    s_mul_i32 s70, s64, 49152
    s_add_u32 s70, s70, 41943040
    s_mul_i32 s71, s64, 40960
    s_add_u32 s71, s71, 92274688
    s_lshl_b32 s72, s60, 10
    s_mov_b32 s73, 0
    s_cmp_lg_u32 s60, 0
    s_cbranch_scc1 Lgskip_73
    buffer_load_dword v2, off, s[8:11], 0 offset:132 sc1
Lgchk_71:
    s_waitcnt vmcnt(0)
    v_cmp_eq_u32 vcc, 0, v2
    s_cbranch_vccnz Lgrty_72
Lgskip_73:
    s_waitcnt lgkmcnt(0)
    s_barrier
L_Tseg:
    s_cmp_lg_u32 s73, 0
    s_cbranch_scc1 L_Thave
    s_add_u32 s65, s62, 1
    buffer_load_dword v246, v245, s[4:7], 0 offen sc1
    s_waitcnt vmcnt(0)
    v_mov_b32 v228, s62
    s_mov_b64 exec, 1
    buffer_store_dword v228, off, s[4:7], s63 sc1
    buffer_store_dword v228, off, s[4:7], s3
    s_mov_b64 exec, -1
Lfchk_74:
    v_cmp_gt_u32 vcc, s65, v246
    s_cbranch_vccnz Lfrty_75
    s_add_u32 m0, s72, 0
    s_add_u32 s64, s70, 0
    buffer_load_dwordx4 v240, s[4:7], s64 offen sc1 lds
    s_add_u32 m0, s72, 24576
    s_add_u32 s64, s70, 24576
    buffer_load_dwordx4 v240, s[4:7], s64 offen sc1 lds
    s_add_u32 m0, s72, 4096
    s_add_u32 s64, s70, 4096
    buffer_load_dwordx4 v240, s[4:7], s64 offen sc1 lds
    s_add_u32 m0, s72, 28672
    s_add_u32 s64, s70, 28672
    buffer_load_dwordx4 v240, s[4:7], s64 offen sc1 lds
    s_add_u32 m0, s72, 8192
    s_add_u32 s64, s70, 8192
    buffer_load_dwordx4 v240, s[4:7], s64 offen sc1 lds
    s_add_u32 m0, s72, 32768
    s_add_u32 s64, s70, 32768
    buffer_load_dwordx4 v240, s[4:7], s64 offen sc1 lds
    s_add_u32 m0, s72, 12288
    s_add_u32 s64, s70, 12288
    buffer_load_dwordx4 v240, s[4:7], s64 offen sc1 lds
    s_add_u32 m0, s72, 36864
    s_add_u32 s64, s70, 36864
    buffer_load_dwordx4 v240, s[4:7], s64 offen sc1 lds
    s_add_u32 m0, s72, 16384
    s_add_u32 s64, s70, 16384
    buffer_load_dwordx4 v240, s[4:7], s64 offen sc1 lds
    s_add_u32 m0, s72, 40960
    s_add_u32 s64, s70, 40960
    buffer_load_dwordx4 v240, s[4:7], s64 offen sc1 lds
    s_add_u32 m0, s72, 20480
    s_add_u32 s64, s70, 20480
    buffer_load_dwordx4 v240, s[4:7], s64 offen sc1 lds
    s_add_u32 m0, s72, 45056
    s_add_u32 s64, s70, 45056
    buffer_load_dwordx4 v240, s[4:7], s64 offen sc1 lds
    s_add_u32 s70, s70, 393216
    s_add_u32 s66, s62, 1
    s_and_b32 s66, s66, 7
    s_cselect_b32 s66, 0, 3145728
    s_sub_u32 s70, s70, s66
    s_xor_b32 s72, s72, 49152
    s_waitcnt vmcnt(10)
L_Thave:
    s_waitcnt vmcnt(16)
    s_barrier
    ds_read_b128 v[204:207], v241 offset:0
    ds_read_b128 v[208:211], v241 offset:24576
    ds_read_b128 v[220:223], v242 offset:0
    s_waitcnt lgkmcnt(2)
    v_mfma_f32_16x16x32_bf16 v[164:167], a[0:3], v[204:207], 0
    ds_read_b128 v[212:215], v241 offset:1024
    v_mfma_f32_16x16x32_bf16 v[168:171], a[4:7], v[204:207], 0
    ds_read_b128 v[216:219], v241 offset:25600
    v_mfma_f32_16x16x32_bf16 v[172:175], a[8:11], v[204:207], 0
    ds_read_b128 v[224:227], v242 offset:1024
    v_mfma_f32_16x16x32_bf16 v[176:179], a[12:15], v[204:207], 0
    s_waitcnt lgkmcnt(3)
    v_mfma_f32_16x16x32_bf16 v[180:183], v[220:223], v[204:207], 0
    v_mfma_f32_16x16x32_bf16 v[184:187], a[0:3], v[208:211], 0
    v_mfma_f32_16x16x32_bf16 v[188:191], a[4:7], v[208:211], 0
    v_mfma_f32_16x16x32_bf16 v[192:195], a[8:11], v[208:211], 0
    v_mfma_f32_16x16x32_bf16 v[196:199], a[12:15], v[208:211], 0
    v_mfma_f32_16x16x32_bf16 v[200:203], v[220:223], v[208:211], 0
    s_waitcnt lgkmcnt(2)
    v_mfma_f32_16x16x32_bf16 v[164:167], a[16:19], v[212:215], v[164:167]
    ds_read_b128 v[204:207], v241 offset:2048
    v_mfma_f32_16x16x32_bf16 v[168:171], a[20:23], v[212:215], v[168:171]
    ds_read_b128 v[208:211], v241 offset:26624
    v_mfma_f32_16x16x32_bf16 v[172:175], a[24:27], v[212:215], v[172:175]
    ds_read_b128 v[220:223], v242 offset:2048
    v_mfma_f32_16x16x32_bf16 v[176:179], a[28:31], v[212:215], v[176:179]
    s_waitcnt lgkmcnt(3)
    v_mfma_f32_16x16x32_bf16 v[180:183], v[224:227], v[212:215], v[180:183]
    v_mfma_f32_16x16x32_bf16 v[184:187], a[16:19], v[216:219], v[184:187]
    v_mfma_f32_16x16x32_bf16 v[188:191], a[20:23], v[216:219], v[188:191]
    v_mfma_f32_16x16x32_bf16 v[192:195], a[24:27], v[216:219], v[192:195]
    v_mfma_f32_16x16x32_bf16 v[196:199], a[28:31], v[216:219], v[196:199]
    v_mfma_f32_16x16x32_bf16 v[200:203], v[224:227], v[216:219], v[200:203]
    s_waitcnt lgkmcnt(2)
    v_mfma_f32_16x16x32_bf16 v[164:167], a[32:35], v[204:207], v[164:167]
    ds_read_b128 v[212:215], v241 offset:3072
    v_mfma_f32_16x16x32_bf16 v[168:171], a[36:39], v[204:207], v[168:171]
    ds_read_b128 v[216:219], v241 offset:27648
    v_mfma_f32_16x16x32_bf16 v[172:175], a[40:43], v[204:207], v[172:175]
    ds_read_b128 v[224:227], v242 offset:3072
    v_mfma_f32_16x16x32_bf16 v[176:179], a[44:47], v[204:207], v[176:179]
    s_waitcnt lgkmcnt(3)
    v_mfma_f32_16x16x32_bf16 v[180:183], v[220:223], v[204:207], v[180:183]
    v_mfma_f32_16x16x32_bf16 v[184:187], a[32:35], v[208:211], v[184:187]
    v_mfma_f32_16x16x32_bf16 v[188:191], a[36:39], v[208:211], v[188:191]
    v_mfma_f32_16x16x32_bf16 v[192:195], a[40:43], v[208:211], v[192:195]
    v_mfma_f32_16x16x32_bf16 v[196:199], a[44:47], v[208:211], v[196:199]
    v_mfma_f32_16x16x32_bf16 v[200:203], v[220:223], v[208:211], v[200:203]
    s_waitcnt vmcnt(6)
    s_cmp_lg_u32 s73, 0
    s_cbranch_scc1 L_Tall
    s_waitcnt vmcnt(0)
L_Tall:
    s_barrier
    s_waitcnt lgkmcnt(2)
    v_mfma_f32_16x16x32_bf16 v[164:167], a[48:51], v[212:215], v[164:167]
    ds_read_b128 v[204:207], v241 offset:4096
    v_mfma_f32_16x16x32_bf16 v[168:171], a[52:55], v[212:215], v[168:171]
    ds_read_b128 v[208:211], v241 offset:28672
    v_mfma_f32_16x16x32_bf16 v[172:175], a[56:59], v[212:215], v[172:175]
    ds_read_b128 v[220:223], v242 offset:4096
    v_mfma_f32_16x16x32_bf16 v[176:179], a[60:63], v[212:215], v[176:179]
    s_waitcnt lgkmcnt(3)
    v_mfma_f32_16x16x32_bf16 v[180:183], v[224:227], v[212:215], v[180:183]
    v_mfma_f32_16x16x32_bf16 v[184:187], a[48:51], v[216:219], v[184:187]
    v_mfma_f32_16x16x32_bf16 v[188:191], a[52:55], v[216:219], v[188:191]
    v_mfma_f32_16x16x32_bf16 v[192:195], a[56:59], v[216:219], v[192:195]
    v_mfma_f32_16x16x32_bf16 v[196:199], a[60:63], v[216:219], v[196:199]
    v_mfma_f32_16x16x32_bf16 v[200:203], v[224:227], v[216:219], v[200:203]
    s_waitcnt lgkmcnt(2)
    v_mfma_f32_16x16x32_bf16 v[164:167], a[64:67], v[204:207], v[164:167]
    ds_read_b128 v[212:215], v241 offset:5120
    v_mfma_f32_16x16x32_bf16 v[168:171], a[68:71], v[204:207], v[168:171]
    ds_read_b128 v[216:219], v241 offset:29696
    v_mfma_f32_16x16x32_bf16 v[172:175], a[72:75], v[204:207], v[172:175]
    ds_read_b128 v[224:227], v242 offset:5120
    v_mfma_f32_16x16x32_bf16 v[176:179], a[76:79], v[204:207], v[176:179]
    s_waitcnt lgkmcnt(3)
    v_mfma_f32_16x16x32_bf16 v[180:183], v[220:223], v[204:207], v[180:183]
    v_mfma_f32_16x16x32_bf16 v[184:187], a[64:67], v[208:211], v[184:187]
    v_mfma_f32_16x16x32_bf16 v[188:191], a[68:71], v[208:211], v[188:191]
    v_mfma_f32_16x16x32_bf16 v[192:195], a[72:75], v[208:211], v[192:195]
    v_mfma_f32_16x16x32_bf16 v[196:199], a[76:79], v[208:211], v[196:199]
    v_mfma_f32_16x16x32_bf16 v[200:203], v[220:223], v[208:211], v[200:203]
    s_waitcnt lgkmcnt(2)
    v_mfma_f32_16x16x32_bf16 v[164:167], a[80:83], v[212:215], v[164:167]
    ds_read_b128 v[204:207], v241 offset:6144
    v_mfma_f32_16x16x32_bf16 v[168:171], a[84:87], v[212:215], v[168:171]
    ds_read_b128 v[208:211], v241 offset:30720
    v_mfma_f32_16x16x32_bf16 v[172:175], a[88:91], v[212:215], v[172:175]
    ds_read_b128 v[220:223], v242 offset:6144
    v_mfma_f32_16x16x32_bf16 v[176:179], a[92:95], v[212:215], v[176:179]
    s_waitcnt lgkmcnt(3)
    v_mfma_f32_16x16x32_bf16 v[180:183], v[224:227], v[212:215], v[180:183]
    v_mfma_f32_16x16x32_bf16 v[184:187], a[80:83], v[216:219], v[184:187]
    v_mfma_f32_16x16x32_bf16 v[188:191], a[84:87], v[216:219], v[188:191]
    v_mfma_f32_16x16x32_bf16 v[192:195], a[88:91], v[216:219], v[192:195]
    v_mfma_f32_16x16x32_bf16 v[196:199], a[92:95], v[216:219], v[196:199]
    v_mfma_f32_16x16x32_bf16 v[200:203], v[224:227], v[216:219], v[200:203]
    s_waitcnt lgkmcnt(2)
    v_mfma_f32_16x16x32_bf16 v[164:167], a[96:99], v[204:207], v[164:167]
    ds_read_b128 v[212:215], v241 offset:7168
    v_mfma_f32_16x16x32_bf16 v[168:171], a[100:103], v[204:207], v[168:171]
    ds_read_b128 v[216:219], v241 offset:31744
    v_mfma_f32_16x16x32_bf16 v[172:175], a[104:107], v[204:207], v[172:175]
    ds_read_b128 v[224:227], v242 offset:7168
    v_mfma_f32_16x16x32_bf16 v[176:179], a[108:111], v[204:207], v[176:179]
    s_waitcnt lgkmcnt(3)
    v_mfma_f32_16x16x32_bf16 v[180:183], v[220:223], v[204:207], v[180:183]
    v_mfma_f32_16x16x32_bf16 v[184:187], a[96:99], v[208:211], v[184:187]
    v_mfma_f32_16x16x32_bf16 v[188:191], a[100:103], v[208:211], v[188:191]
    v_mfma_f32_16x16x32_bf16 v[192:195], a[104:107], v[208:211], v[192:195]
    v_mfma_f32_16x16x32_bf16 v[196:199], a[108:111], v[208:211], v[196:199]
    v_mfma_f32_16x16x32_bf16 v[200:203], v[220:223], v[208:211], v[200:203]
    s_cmp_eq_u32 s73, 0
    s_cbranch_scc1 L_Tnofl
    s_waitcnt vmcnt(0)
    v_mov_b32 v228, s62
    s_mov_b64 exec, 1
    buffer_store_dword v228, off, s[4:7], s63 sc1
    buffer_store_dword v228, off, s[4:7], s3
    s_mov_b64 exec, -1
L_Tnofl:
    s_waitcnt lgkmcnt(2)
    v_mfma_f32_16x16x32_bf16 v[164:167], a[112:115], v[212:215], v[164:167]
    ds_read_b128 v[204:207], v241 offset:8192
    v_mfma_f32_16x16x32_bf16 v[168:171], a[116:119], v[212:215], v[168:171]
    ds_read_b128 v[208:211], v241 offset:32768
    v_mfma_f32_16x16x32_bf16 v[172:175], a[120:123], v[212:215], v[172:175]
    ds_read_b128 v[220:223], v242 offset:8192
    v_mfma_f32_16x16x32_bf16 v[176:179], a[124:127], v[212:215], v[176:179]
    s_waitcnt lgkmcnt(3)
    v_mfma_f32_16x16x32_bf16 v[180:183], v[224:227], v[212:215], v[180:183]
    v_mfma_f32_16x16x32_bf16 v[184:187], a[112:115], v[216:219], v[184:187]
    v_mfma_f32_16x16x32_bf16 v[188:191], a[116:119], v[216:219], v[188:191]
    v_mfma_f32_16x16x32_bf16 v[192:195], a[120:123], v[216:219], v[192:195]
    v_mfma_f32_16x16x32_bf16 v[196:199], a[124:127], v[216:219], v[196:199]
    v_mfma_f32_16x16x32_bf16 v[200:203], v[224:227], v[216:219], v[200:203]
    s_waitcnt lgkmcnt(2)
    v_mfma_f32_16x16x32_bf16 v[164:167], a[128:131], v[204:207], v[164:167]
    ds_read_b128 v[212:215], v241 offset:9216
    v_mfma_f32_16x16x32_bf16 v[168:171], a[132:135], v[204:207], v[168:171]
    ds_read_b128 v[216:219], v241 offset:33792
    v_mfma_f32_16x16x32_bf16 v[172:175], a[136:139], v[204:207], v[172:175]
    ds_read_b128 v[224:227], v242 offset:9216
    v_mfma_f32_16x16x32_bf16 v[176:179], a[140:143], v[204:207], v[176:179]
    s_waitcnt lgkmcnt(3)
    v_mfma_f32_16x16x32_bf16 v[180:183], v[220:223], v[204:207], v[180:183]
    v_mfma_f32_16x16x32_bf16 v[184:187], a[128:131], v[208:211], v[184:187]
    v_mfma_f32_16x16x32_bf16 v[188:191], a[132:135], v[208:211], v[188:191]
    v_mfma_f32_16x16x32_bf16 v[192:195], a[136:139], v[208:211], v[192:195]
    v_mfma_f32_16x16x32_bf16 v[196:199], a[140:143], v[208:211], v[196:199]
    v_mfma_f32_16x16x32_bf16 v[200:203], v[220:223], v[208:211], v[200:203]
    s_waitcnt lgkmcnt(2)
    v_mfma_f32_16x16x32_bf16 v[164:167], a[144:147], v[212:215], v[164:167]
    ds_read_b128 v[204:207], v241 offset:10240
    v_mfma_f32_16x16x32_bf16 v[168:171], a[148:151], v[212:215], v[168:171]
    ds_read_b128 v[208:211], v241 offset:34816
    v_mfma_f32_16x16x32_bf16 v[172:175], a[152:155], v[212:215], v[172:175]
    ds_read_b128 v[220:223], v242 offset:10240
    v_mfma_f32_16x16x32_bf16 v[176:179], a[156:159], v[212:215], v[176:179]
    s_waitcnt lgkmcnt(3)
    v_mfma_f32_16x16x32_bf16 v[180:183], v[224:227], v[212:215], v[180:183]
    v_mfma_f32_16x16x32_bf16 v[184:187], a[144:147], v[216:219], v[184:187]
    v_mfma_f32_16x16x32_bf16 v[188:191], a[148:151], v[216:219], v[188:191]
    v_mfma_f32_16x16x32_bf16 v[192:195], a[152:155], v[216:219], v[192:195]
    v_mfma_f32_16x16x32_bf16 v[196:199], a[156:159], v[216:219], v[196:199]
    v_mfma_f32_16x16x32_bf16 v[200:203], v[224:227], v[216:219], v[200:203]
    s_waitcnt lgkmcnt(2)
    v_mfma_f32_16x16x32_bf16 v[164:167], a[160:163], v[204:207], v[164:167]
    ds_read_b128 v[212:215], v241 offset:11264
    v_mfma_f32_16x16x32_bf16 v[168:171], a[164:167], v[204:207], v[168:171]
    ds_read_b128 v[216:219], v241 offset:35840
    v_mfma_f32_16x16x32_bf16 v[172:175], a[168:171], v[204:207], v[172:175]
    ds_read_b128 v[224:227], v242 offset:11264
    v_mfma_f32_16x16x32_bf16 v[176:179], a[172:175], v[204:207], v[176:179]
    s_waitcnt lgkmcnt(3)
    v_mfma_f32_16x16x32_bf16 v[180:183], v[220:223], v[204:207], v[180:183]
    v_mfma_f32_16x16x32_bf16 v[184:187], a[160:163], v[208:211], v[184:187]
    v_mfma_f32_16x16x32_bf16 v[188:191], a[164:167], v[208:211], v[188:191]
    v_mfma_f32_16x16x32_bf16 v[192:195], a[168:171], v[208:211], v[192:195]
    v_mfma_f32_16x16x32_bf16 v[196:199], a[172:175], v[208:211], v[196:199]
    v_mfma_f32_16x16x32_bf16 v[200:203], v[220:223], v[208:211], v[200:203]
    s_waitcnt lgkmcnt(2)
    v_mfma_f32_16x16x32_bf16 v[164:167], a[176:179], v[212:215], v[164:167]
    ds_read_b128 v[204:207], v241 offset:12288
    v_mfma_f32_16x16x32_bf16 v[168:171], a[180:183], v[212:215], v[168:171]
    ds_read_b128 v[208:211], v241 offset:36864
    v_mfma_f32_16x16x32_bf16 v[172:175], a[184:187], v[212:215], v[172:175]
    ds_read_b128 v[220:223], v242 offset:12288
    v_mfma_f32_16x16x32_bf16 v[176:179], a[188:191], v[212:215], v[176:179]
    s_waitcnt lgkmcnt(3)
    v_mfma_f32_16x16x32_bf16 v[180:183], v[224:227], v[212:215], v[180:183]
    v_mfma_f32_16x16x32_bf16 v[184:187], a[176:179], v[216:219], v[184:187]
    v_mfma_f32_16x16x32_bf16 v[188:191], a[180:183], v[216:219], v[188:191]
    v_mfma_f32_16x16x32_bf16 v[192:195], a[184:187], v[216:219], v[192:195]
    v_mfma_f32_16x16x32_bf16 v[196:199], a[188:191], v[216:219], v[196:199]
    v_mfma_f32_16x16x32_bf16 v[200:203], v[224:227], v[216:219], v[200:203]
    s_waitcnt lgkmcnt(2)
    v_mfma_f32_16x16x32_bf16 v[164:167], a[192:195], v[204:207], v[164:167]
    ds_read_b128 v[212:215], v241 offset:13312
    v_mfma_f32_16x16x32_bf16 v[168:171], a[196:199], v[204:207], v[168:171]
    ds_read_b128 v[216:219], v241 offset:37888
    v_mfma_f32_16x16x32_bf16 v[172:175], a[200:203], v[204:207], v[172:175]
    ds_read_b128 v[224:227], v242 offset:13312
    v_mfma_f32_16x16x32_bf16 v[176:179], a[204:207], v[204:207], v[176:179]
    s_waitcnt lgkmcnt(3)
    v_mfma_f32_16x16x32_bf16 v[180:183], v[220:223], v[204:207], v[180:183]
    v_mfma_f32_16x16x32_bf16 v[184:187], a[192:195], v[208:211], v[184:187]
    v_mfma_f32_16x16x32_bf16 v[188:191], a[196:199], v[208:211], v[188:191]
    v_mfma_f32_16x16x32_bf16 v[192:195], a[200:203], v[208:211], v[192:195]
    v_mfma_f32_16x16x32_bf16 v[196:199], a[204:207], v[208:211], v[196:199]
    v_mfma_f32_16x16x32_bf16 v[200:203], v[220:223], v[208:211], v[200:203]
    s_waitcnt lgkmcnt(2)
    v_mfma_f32_16x16x32_bf16 v[164:167], a[208:211], v[212:215], v[164:167]
    ds_read_b128 v[204:207], v241 offset:14336
    v_mfma_f32_16x16x32_bf16 v[168:171], a[212:215], v[212:215], v[168:171]
    ds_read_b128 v[208:211], v241 offset:38912
    v_mfma_f32_16x16x32_bf16 v[172:175], a[216:219], v[212:215], v[172:175]
    ds_read_b128 v[220:223], v242 offset:14336
    v_mfma_f32_16x16x32_bf16 v[176:179], a[220:223], v[212:215], v[176:179]
    s_waitcnt lgkmcnt(3)
    v_mfma_f32_16x16x32_bf16 v[180:183], v[224:227], v[212:215], v[180:183]
    v_mfma_f32_16x16x32_bf16 v[184:187], a[208:211], v[216:219], v[184:187]
    v_mfma_f32_16x16x32_bf16 v[188:191], a[212:215], v[216:219], v[188:191]
    v_mfma_f32_16x16x32_bf16 v[192:195], a[216:219], v[216:219], v[192:195]
    v_mfma_f32_16x16x32_bf16 v[196:199], a[220:223], v[216:219], v[196:199]
    v_mfma_f32_16x16x32_bf16 v[200:203], v[224:227], v[216:219], v[200:203]
    s_waitcnt lgkmcnt(2)
    v_mfma_f32_16x16x32_bf16 v[164:167], a[224:227], v[204:207], v[164:167]
    ds_read_b128 v[212:215], v241 offset:15360
    v_mfma_f32_16x16x32_bf16 v[168:171], a[228:231], v[204:207], v[168:171]
    ds_read_b128 v[216:219], v241 offset:39936
    v_mfma_f32_16x16x32_bf16 v[172:175], a[232:235], v[204:207], v[172:175]
    ds_read_b128 v[224:227], v242 offset:15360
    v_mfma_f32_16x16x32_bf16 v[176:179], a[236:239], v[204:207], v[176:179]
    s_waitcnt lgkmcnt(3)
    v_mfma_f32_16x16x32_bf16 v[180:183], v[220:223], v[204:207], v[180:183]
    v_mfma_f32_16x16x32_bf16 v[184:187], a[224:227], v[208:211], v[184:187]
    v_mfma_f32_16x16x32_bf16 v[188:191], a[228:231], v[208:211], v[188:191]
    v_mfma_f32_16x16x32_bf16 v[192:195], a[232:235], v[208:211], v[192:195]
    v_mfma_f32_16x16x32_bf16 v[196:199], a[236:239], v[208:211], v[196:199]
    v_mfma_f32_16x16x32_bf16 v[200:203], v[220:223], v[208:211], v[200:203]
    buffer_load_dword v246, v245, s[4:7], 0 offen sc1
    s_waitcnt lgkmcnt(2)
    v_mfma_f32_16x16x32_bf16 v[164:167], a[240:243], v[212:215], v[164:167]
    ds_read_b128 v[204:207], v241 offset:16384
    v_mfma_f32_16x16x32_bf16 v[168:171], a[244:247], v[212:215], v[168:171]
    ds_read_b128 v[208:211], v241 offset:40960
    v_mfma_f32_16x16x32_bf16 v[172:175], a[248:251], v[212:215], v[172:175]
    v_mfma_f32_16x16x32_bf16 v[176:179], a[252:255], v[212:215], v[176:179]
    s_waitcnt lgkmcnt(2)
    v_mfma_f32_16x16x32_bf16 v[180:183], v[224:227], v[212:215], v[180:183]
    v_mfma_f32_16x16x32_bf16 v[184:187], a[240:243], v[216:219], v[184:187]
    v_mfma_f32_16x16x32_bf16 v[188:191], a[244:247], v[216:219], v[188:191]
    v_mfma_f32_16x16x32_bf16 v[192:195], a[248:251], v[216:219], v[192:195]
    v_mfma_f32_16x16x32_bf16 v[196:199], a[252:255], v[216:219], v[196:199]
    v_mfma_f32_16x16x32_bf16 v[200:203], v[224:227], v[216:219], v[200:203]
    s_waitcnt lgkmcnt(1)
    v_mfma_f32_16x16x32_bf16 v[164:167], v[4:7], v[204:207], v[164:167]
    ds_read_b128 v[212:215], v241 offset:17408
    v_mfma_f32_16x16x32_bf16 v[168:171], v[8:11], v[204:207], v[168:171]
    ds_read_b128 v[216:219], v241 offset:41984
    v_mfma_f32_16x16x32_bf16 v[172:175], v[12:15], v[204:207], v[172:175]
    v_mfma_f32_16x16x32_bf16 v[176:179], v[16:19], v[204:207], v[176:179]
    v_mfma_f32_16x16x32_bf16 v[180:183], v[132:135], v[204:207], v[180:183]
    s_waitcnt lgkmcnt(2)
    v_mfma_f32_16x16x32_bf16 v[184:187], v[4:7], v[208:211], v[184:187]
    v_mfma_f32_16x16x32_bf16 v[188:191], v[8:11], v[208:211], v[188:191]
    v_mfma_f32_16x16x32_bf16 v[192:195], v[12:15], v[208:211], v[192:195]
    v_mfma_f32_16x16x32_bf16 v[196:199], v[16:19], v[208:211], v[196:199]
    v_mfma_f32_16x16x32_bf16 v[200:203], v[132:135], v[208:211], v[200:203]
    s_waitcnt lgkmcnt(1)
    v_mfma_f32_16x16x32_bf16 v[164:167], v[20:23], v[212:215], v[164:167]
    ds_read_b128 v[204:207], v241 offset:18432
    v_mfma_f32_16x16x32_bf16 v[168:171], v[24:27], v[212:215], v[168:171]
    ds_read_b128 v[208:211], v241 offset:43008
    v_mfma_f32_16x16x32_bf16 v[172:175], v[28:31], v[212:215], v[172:175]
    v_mfma_f32_16x16x32_bf16 v[176:179], v[32:35], v[212:215], v[176:179]
    v_mfma_f32_16x16x32_bf16 v[180:183], v[136:139], v[212:215], v[180:183]
    s_waitcnt lgkmcnt(2)
    v_mfma_f32_16x16x32_bf16 v[184:187], v[20:23], v[216:219], v[184:187]
    v_mfma_f32_16x16x32_bf16 v[188:191], v[24:27], v[216:219], v[188:191]
    v_mfma_f32_16x16x32_bf16 v[192:195], v[28:31], v[216:219], v[192:195]
    v_mfma_f32_16x16x32_bf16 v[196:199], v[32:35], v[216:219], v[196:199]
    v_mfma_f32_16x16x32_bf16 v[200:203], v[136:139], v[216:219], v[200:203]
    s_add_u32 s65, s62, 2
    s_waitcnt vmcnt(0)
    v_cmp_gt_u32 vcc, s65, v246
    s_cmp_eq_u64 vcc, 0
    s_cselect_b32 s73, 1, 0
    s_waitcnt lgkmcnt(1)
    v_mfma_f32_16x16x32_bf16 v[164:167], v[36:39], v[204:207], v[164:167]
    ds_read_b128 v[212:215], v241 offset:19456
    v_mfma_f32_16x16x32_bf16 v[168:171], v[40:43], v[204:207], v[168:171]
    ds_read_b128 v[216:219], v241 offset:44032
    v_mfma_f32_16x16x32_bf16 v[172:175], v[44:47], v[204:207], v[172:175]
    v_mfma_f32_16x16x32_bf16 v[176:179], v[48:51], v[204:207], v[176:179]
    s_cbranch_vccnz Lnp_76
    s_add_u32 m0, s72, 0
    s_add_u32 s64, s70, 0
    buffer_load_dwordx4 v240, s[4:7], s64 offen sc1 lds
Lnp_76:
    v_mfma_f32_16x16x32_bf16 v[180:183], v[140:143], v[204:207], v[180:183]
    s_waitcnt lgkmcnt(2)
    v_mfma_f32_16x16x32_bf16 v[184:187], v[36:39], v[208:211], v[184:187]
    v_mfma_f32_16x16x32_bf16 v[188:191], v[40:43], v[208:211], v[188:191]
    s_cbranch_vccnz Lnp_77
    s_add_u32 m0, s72, 24576
    s_add_u32 s64, s70, 24576
    buffer_load_dwordx4 v240, s[4:7], s64 offen sc1 lds
Lnp_77:
    v_mfma_f32_16x16x32_bf16 v[192:195], v[44:47], v[208:211], v[192:195]
    v_mfma_f32_16x16x32_bf16 v[196:199], v[48:51], v[208:211], v[196:199]
    v_mfma_f32_16x16x32_bf16 v[200:203], v[140:143], v[208:211], v[200:203]
    s_cbranch_vccnz Lnp_78
    s_add_u32 m0, s72, 4096
    s_add_u32 s64, s70, 4096
    buffer_load_dwordx4 v240, s[4:7], s64 offen sc1 lds
Lnp_78:
    s_waitcnt lgkmcnt(1)
    v_mfma_f32_16x16x32_bf16 v[164:167], v[52:55], v[212:215], v[164:167]
    ds_read_b128 v[204:207], v241 offset:20480
    v_mfma_f32_16x16x32_bf16 v[168:171], v[56:59], v[212:215], v[168:171]
    ds_read_b128 v[208:211], v241 offset:45056
    v_mfma_f32_16x16x32_bf16 v[172:175], v[60:63], v[212:215], v[172:175]
    v_mfma_f32_16x16x32_bf16 v[176:179], v[64:67], v[212:215], v[176:179]
    s_cbranch_vccnz Lnp_79
    s_add_u32 m0, s72, 28672
    s_add_u32 s64, s70, 28672
    buffer_load_dwordx4 v240, s[4:7], s64 offen sc1 lds
Lnp_79:
    v_mfma_f32_16x16x32_bf16 v[180:183], v[144:147], v[212:215], v[180:183]
    s_waitcnt lgkmcnt(2)
    v_mfma_f32_16x16x32_bf16 v[184:187], v[52:55], v[216:219], v[184:187]
    v_mfma_f32_16x16x32_bf16 v[188:191], v[56:59], v[216:219], v[188:191]
    s_cbranch_vccnz Lnp_80
    s_add_u32 m0, s72, 8192
    s_add_u32 s64, s70, 8192
    buffer_load_dwordx4 v240, s[4:7], s64 offen sc1 lds
Lnp_80:
    v_mfma_f32_16x16x32_bf16 v[192:195], v[60:63], v[216:219], v[192:195]
    v_mfma_f32_16x16x32_bf16 v[196:199], v[64:67], v[216:219], v[196:199]
    v_mfma_f32_16x16x32_bf16 v[200:203], v[144:147], v[216:219], v[200:203]
    s_waitcnt lgkmcnt(1)
    v_mfma_f32_16x16x32_bf16 v[164:167], v[68:71], v[204:207], v[164:167]
    ds_read_b128 v[212:215], v241 offset:21504
    v_mfma_f32_16x16x32_bf16 v[168:171], v[72:75], v[204:207], v[168:171]
    ds_read_b128 v[216:219], v241 offset:46080
    v_mfma_f32_16x16x32_bf16 v[172:175], v[76:79], v[204:207], v[172:175]
    v_mfma_f32_16x16x32_bf16 v[176:179], v[80:83], v[204:207], v[176:179]
    s_cbranch_vccnz Lnp_81
    s_add_u32 m0, s72, 32768
    s_add_u32 s64, s70, 32768
    buffer_load_dwordx4 v240, s[4:7], s64 offen sc1 lds
Lnp_81:
    v_mfma_f32_16x16x32_bf16 v[180:183], v[148:151], v[204:207], v[180:183]
    s_waitcnt lgkmcnt(2)
    v_mfma_f32_16x16x32_bf16 v[184:187], v[68:71], v[208:211], v[184:187]
    v_mfma_f32_16x16x32_bf16 v[188:191], v[72:75], v[208:211], v[188:191]
    s_cbranch_vccnz Lnp_82
    s_add_u32 m0, s72, 12288
    s_add_u32 s64, s70, 12288
    buffer_load_dwordx4 v240, s[4:7], s64 offen sc1 lds
Lnp_82:
    v_mfma_f32_16x16x32_bf16 v[192:195], v[76:79], v[208:211], v[192:195]
    v_mfma_f32_16x16x32_bf16 v[196:199], v[80:83], v[208:211], v[196:199]
    v_mfma_f32_16x16x32_bf16 v[200:203], v[148:151], v[208:211], v[200:203]
    s_waitcnt lgkmcnt(1)
    v_mfma_f32_16x16x32_bf16 v[164:167], v[84:87], v[212:215], v[164:167]
    ds_read_b128 v[204:207], v241 offset:22528
    v_mfma_f32_16x16x32_bf16 v[168:171], v[88:91], v[212:215], v[168:171]
    ds_read_b128 v[208:211], v241 offset:47104
    v_mfma_f32_16x16x32_bf16 v[172:175], v[92:95], v[212:215], v[172:175]
    v_mfma_f32_16x16x32_bf16 v[176:179], v[96:99], v[212:215], v[176:179]
    s_cbranch_vccnz Lnp_83
    s_add_u32 m0, s72, 36864
    s_add_u32 s64, s70, 36864
    buffer_load_dwordx4 v240, s[4:7], s64 offen sc1 lds
Lnp_83:
    v_mfma_f32_16x16x32_bf16 v[180:183], v[152:155], v[212:215], v[180:183]
    s_waitcnt lgkmcnt(2)
    v_mfma_f32_16x16x32_bf16 v[184:187], v[84:87], v[216:219], v[184:187]
    v_mfma_f32_16x16x32_bf16 v[188:191], v[88:91], v[216:219], v[188:191]
    s_cbranch_vccnz Lnp_84
    s_add_u32 m0, s72, 16384
    s_add_u32 s64, s70, 16384
    buffer_load_dwordx4 v240, s[4:7], s64 offen sc1 lds
Lnp_84:
    v_mfma_f32_16x16x32_bf16 v[192:195], v[92:95], v[216:219], v[192:195]
    v_mfma_f32_16x16x32_bf16 v[196:199], v[96:99], v[216:219], v[196:199]
    v_mfma_f32_16x16x32_bf16 v[200:203], v[152:155], v[216:219], v[200:203]
    s_waitcnt lgkmcnt(1)
    v_mfma_f32_16x16x32_bf16 v[164:167], v[100:103], v[204:207], v[164:167]
    ds_read_b128 v[212:215], v241 offset:23552
    v_mfma_f32_16x16x32_bf16 v[168:171], v[104:107], v[204:207], v[168:171]
    ds_read_b128 v[216:219], v241 offset:48128
    v_mfma_f32_16x16x32_bf16 v[172:175], v[108:111], v[204:207], v[172:175]
    v_mfma_f32_16x16x32_bf16 v[176:179], v[112:115], v[204:207], v[176:179]
    s_cbranch_vccnz Lnp_85
    s_add_u32 m0, s72, 40960
    s_add_u32 s64, s70, 40960
    buffer_load_dwordx4 v240, s[4:7], s64 offen sc1 lds
Lnp_85:
    v_mfma_f32_16x16x32_bf16 v[180:183], v[156:159], v[204:207], v[180:183]
    s_waitcnt lgkmcnt(2)
    v_mfma_f32_16x16x32_bf16 v[184:187], v[100:103], v[208:211], v[184:187]
    v_mfma_f32_16x16x32_bf16 v[188:191], v[104:107], v[208:211], v[188:191]
    s_cbranch_vccnz Lnp_86
    s_add_u32 m0, s72, 20480
    s_add_u32 s64, s70, 20480
    buffer_load_dwordx4 v240, s[4:7], s64 offen sc1 lds
Lnp_86:
    v_mfma_f32_16x16x32_bf16 v[192:195], v[108:111], v[208:211], v[192:195]
    v_mfma_f32_16x16x32_bf16 v[196:199], v[112:115], v[208:211], v[196:199]
    v_mfma_f32_16x16x32_bf16 v[200:203], v[156:159], v[208:211], v[200:203]
    s_waitcnt lgkmcnt(1)
    v_mfma_f32_16x16x32_bf16 v[164:167], v[116:119], v[212:215], v[164:167]
    v_mfma_f32_16x16x32_bf16 v[168:171], v[120:123], v[212:215], v[168:171]
    v_mfma_f32_16x16x32_bf16 v[172:175], v[124:127], v[212:215], v[172:175]
    v_mfma_f32_16x16x32_bf16 v[176:179], v[128:131], v[212:215], v[176:179]
    v_mfma_f32_16x16x32_bf16 v[180:183], v[160:163], v[212:215], v[180:183]
    s_waitcnt lgkmcnt(0)
    v_mfma_f32_16x16x32_bf16 v[184:187], v[116:119], v[216:219], v[184:187]
    s_cbranch_vccnz Lnp_87
    s_add_u32 m0, s72, 45056
    s_add_u32 s64, s70, 45056
    buffer_load_dwordx4 v240, s[4:7], s64 offen sc1 lds
Lnp_87:
    v_mfma_f32_16x16x32_bf16 v[188:191], v[120:123], v[216:219], v[188:191]
    v_mfma_f32_16x16x32_bf16 v[192:195], v[124:127], v[216:219], v[192:195]
    v_mfma_f32_16x16x32_bf16 v[196:199], v[128:131], v[216:219], v[196:199]
    s_cbranch_vccnz Lnp_88
    s_add_u32 s70, s70, 393216
    s_add_u32 s66, s62, 2
    s_and_b32 s66, s66, 7
    s_cselect_b32 s66, 0, 3145728
    s_sub_u32 s70, s70, s66
    s_xor_b32 s72, s72, 49152
Lnp_88:
    v_mfma_f32_16x16x32_bf16 v[200:203], v[160:163], v[216:219], v[200:203]
    v_xor_b32 v241, 49152, v241
    v_cvt_pk_bf16_f32 v164, v164, v165
    v_cvt_pk_bf16_f32 v165, v166, v167
    v_cvt_pk_bf16_f32 v166, v168, v169
    v_cvt_pk_bf16_f32 v167, v170, v171
    buffer_store_dwordx4 v[164:167], v243, s[4:7], s71 offen offset:0 sc1
    v_cvt_pk_bf16_f32 v168, v172, v173
    v_cvt_pk_bf16_f32 v169, v174, v175
    v_cvt_pk_bf16_f32 v170, v176, v177
    v_cvt_pk_bf16_f32 v171, v178, v179
    buffer_store_dwordx4 v[168:171], v243, s[4:7], s71 offen offset:2048 sc1
    v_cvt_pk_bf16_f32 v172, v180, v181
    v_cvt_pk_bf16_f32 v173, v182, v183
    buffer_store_dwordx2 v[172:173], v244, s[4:7], s71 offen offset:0 sc1
    v_cvt_pk_bf16_f32 v184, v184, v185
    v_cvt_pk_bf16_f32 v185, v186, v187
    v_cvt_pk_bf16_f32 v186, v188, v189
    v_cvt_pk_bf16_f32 v187, v190, v191
    buffer_store_dwordx4 v[184:187], v243, s[4:7], s71 offen offset:1024 sc1
    v_cvt_pk_bf16_f32 v188, v192, v193
    v_cvt_pk_bf16_f32 v189, v194, v195
    v_cvt_pk_bf16_f32 v190, v196, v197
    v_cvt_pk_bf16_f32 v191, v198, v199
    buffer_store_dwordx4 v[188:191], v243, s[4:7], s71 offen offset:3072 sc1
    v_cvt_pk_bf16_f32 v192, v200, v201
    v_cvt_pk_bf16_f32 v193, v202, v203
    buffer_store_dwordx2 v[192:193], v244, s[4:7], s71 offen offset:512 sc1
    s_add_u32 s71, s71, 327680
    s_add_u32 s62, s62, 1
    s_cmp_lt_u32 s62, 64
    s_cbranch_scc1 L_Tseg
    s_waitcnt vmcnt(0)
    v_mov_b32 v228, s62
    s_mov_b64 exec, 1
    buffer_store_dword v228, off, s[4:7], s63 sc1
    buffer_store_dword v228, off, s[4:7], s3
    s_mov_b64 exec, -1
    s_endpgm
Lgrty_72:
    s_sleep 16
    buffer_load_dword v2, off, s[8:11], 0 offset:132 sc1
    s_sub_u32 s61, s61, 1
    s_mov_b32 s67, 1
    s_cbranch_scc1 L_fail
    s_branch Lgchk_71
Lfrty_75:
    s_sleep 4
    buffer_load_dword v246, v245, s[4:7], 0 offen sc1
    s_sub_u32 s61, s61, 1
    s_mov_b32 s67, 20
    s_cbranch_scc1 L_fail
    s_waitcnt vmcnt(0)
    s_branch Lfchk_74
L_roleB:
    s_mov_b32 s20, s48
    s_mov_b32 s21, s49
    s_mov_b32 s22, 2457600
    s_mov_b32 s23, 0x20000
    s_mov_b32 s24, s50
    s_mov_b32 s25, s51
    s_mov_b32 s26, 819200
    s_mov_b32 s27, 0x20000
    v_and_b32 v1, 63, v0
    s_lshl_b32 s74, s69, 1
    s_and_b32 s64, s59, 1
    s_add_u32 s74, s74, s64
    v_lshrrev_b32 v176, 4, v1
    v_bfe_u32 v177, v1, 2, 2
    v_and_b32 v178, 3, v1
    v_lshlrev_b32 v245, 4, v1
    v_and_b32 v169, 31, v1
    v_mul_u32_u24 v170, 26, v169
    v_lshrrev_b32 v170, 8, v170
    v_mul_u32_u24 v168, 1120, v170
    v_lshl_add_u32 v168, v169, 4, v168
    v_lshrrev_b32 v170, 5, v0
    v_mul_u32_u24 v170, 3840, v170
    s_mul_i32 s64, s74, 160
    v_add3_u32 v168, v168, v170, s64
    v_mov_b32 v170, 0x80000000
    v_cmp_gt_u32 vcc, 30, v169
    s_nop 1
    v_cndmask_b32 v168, v170, v168, vcc
    v_lshl_add_u32 v169, v176, 3, v177
    v_lshlrev_b32 v169, 9, v169
    s_mul_i32 s64, s60, 40
    v_mul_u32_u24 v171, 160, v178
    s_add_u32 s65, s64, 32
    v_mov_b32 v172, s65
    v_cmp_gt_u32 vcc, 3, v178
    s_nop 1
    v_cndmask_b32 v172, 0, v172, vcc
    v_add3_u32 v171, v171, v172, v169
    v_lshl_add_u32 v169, v178, 3, v169
    v_add_u32 v169, s64, v169
    v_add_u32 v170, 65536, v169
    v_add_u32 v172, 65536, v171
    v_lshl_add_u32 v173, v178, 2, v177
    v_lshl_add_u32 v173, v176, 4, v173
    v_lshlrev_b32 v173, 2, v173
    s_lshl_b32 s70, s60, 10
    s_cmp_lg_u32 s68, 0
    s_cbranch_scc1 Larr0_89
    s_waitcnt vmcnt(0)
    s_barrier
    s_cmp_lg_u32 s60, 0
    s_cbranch_scc1 Lcnt_90
    s_mov_b64 exec, 1
    v_mov_b32 v2, 1
    buffer_atomic_add v2, off, s[8:11], 0 offset:4 sc0
    v_mov_b32 v3, 0x80000000
    s_waitcnt vmcnt(0)
    v_cmp_ne_u32 vcc, 255, v2
    s_nop 1
    v_cndmask_b32 v3, 4, v3, vcc
    buffer_store_dword v2, v3, s[8:11], 0 offen offset:128 sc1
    s_mov_b64 exec, -1
Lcnt_90:
Larr0_89:
    s_mov_b32 s64, 0
    s_add_u32 m0, s70, 0
    s_nop 0
    buffer_load_dwordx4 v168, s[20:23], s64 offen nt lds
    s_mov_b32 s64, 30720
    s_add_u32 m0, s70, 4096
    s_nop 0
    buffer_load_dwordx4 v168, s[20:23], s64 offen nt lds
    s_mov_b32 s64, 61440
    s_add_u32 m0, s70, 8192
    s_nop 0
    buffer_load_dwordx4 v168, s[20:23], s64 offen nt lds
    s_mov_b32 s64, 92160
    s_add_u32 m0, s70, 12288
    s_nop 0
    buffer_load_dwordx4 v168, s[20:23], s64 offen nt lds
    s_mov_b32 s64, 122880
    s_add_u32 m0, s70, 16384
    s_nop 0
    buffer_load_dwordx4 v168, s[20:23], s64 offen nt lds
    s_mov_b32 s64, 153600
    s_add_u32 m0, s70, 20480
    s_nop 0
    buffer_load_dwordx4 v168, s[20:23], s64 offen nt lds
    s_mov_b32 s64, 184320
    s_add_u32 m0, s70, 24576
    s_nop 0
    buffer_load_dwordx4 v168, s[20:23], s64 offen nt lds
    s_mov_b32 s64, 215040
    s_add_u32 m0, s70, 28672
    s_nop 0
    buffer_load_dwordx4 v168, s[20:23], s64 offen nt lds
    s_mov_b32 s64, 245760
    s_add_u32 m0, s70, 32768
    s_nop 0
    buffer_load_dwordx4 v168, s[20:23], s64 offen nt lds
    s_mov_b32 s64, 276480
    s_add_u32 m0, s70, 36864
    s_nop 0
    buffer_load_dwordx4 v168, s[20:23], s64 offen nt lds
    s_mov_b32 s64, 307200
    s_add_u32 m0, s70, 40960
    s_nop 0
    buffer_load_dwordx4 v168, s[20:23], s64 offen nt lds
    s_mov_b32 s64, 337920
    s_add_u32 m0, s70, 45056
    s_nop 0
    buffer_load_dwordx4 v168, s[20:23], s64 offen nt lds
    s_mov_b32 s64, 368640
    s_add_u32 m0, s70, 49152
    s_nop 0
    buffer_load_dwordx4 v168, s[20:23], s64 offen nt lds
    s_mov_b32 s64, 399360
    s_add_u32 m0, s70, 53248
    s_nop 0
    buffer_load_dwordx4 v168, s[20:23], s64 offen nt lds
    s_mov_b32 s64, 430080
    s_add_u32 m0, s70, 57344
    s_nop 0
    buffer_load_dwordx4 v168, s[20:23], s64 offen nt lds
    s_mov_b32 s64, 460800
    s_add_u32 m0, s70, 61440
    s_nop 0
    buffer_load_dwordx4 v168, s[20:23], s64 offen nt lds
    s_mov_b32 s64, 491520
    s_add_u32 m0, s70, 65536
    s_nop 0
    buffer_load_dwordx4 v168, s[20:23], s64 offen nt lds
    s_mov_b32 s64, 522240
    s_add_u32 m0, s70, 69632
    s_nop 0
    buffer_load_dwordx4 v168, s[20:23], s64 offen nt lds
    s_mov_b32 s64, 552960
    s_add_u32 m0, s70, 73728
    s_nop 0
    buffer_load_dwordx4 v168, s[20:23], s64 offen nt lds
    s_mov_b32 s64, 583680
    s_add_u32 m0, s70, 77824
    s_nop 0
    buffer_load_dwordx4 v168, s[20:23], s64 offen nt lds
    s_mov_b32 s64, 614400
    s_add_u32 m0, s70, 81920
    s_nop 0
    buffer_load_dwordx4 v168, s[20:23], s64 offen nt lds
    s_mov_b32 s64, 645120
    s_add_u32 m0, s70, 86016
    s_nop 0
    buffer_load_dwordx4 v168, s[20:23], s64 offen nt lds
    s_mov_b32 s64, 675840
    s_add_u32 m0, s70, 90112
    s_nop 0
    buffer_load_dwordx4 v168, s[20:23], s64 offen nt lds
    s_mov_b32 s64, 706560
    s_add_u32 m0, s70, 94208
    s_nop 0
    buffer_load_dwordx4 v168, s[20:23], s64 offen nt lds
    s_mov_b32 s64, 737280
    s_add_u32 m0, s70, 98304
    s_nop 0
    buffer_load_dwordx4 v168, s[20:23], s64 offen nt lds
    s_mov_b32 s64, 768000
    s_add_u32 m0, s70, 102400
    s_nop 0
    buffer_load_dwordx4 v168, s[20:23], s64 offen nt lds
    s_mov_b32 s64, 798720
    s_add_u32 m0, s70, 106496
    s_nop 0
    buffer_load_dwordx4 v168, s[20:23], s64 offen nt lds
    s_mov_b32 s64, 829440
    s_add_u32 m0, s70, 110592
    s_nop 0
    buffer_load_dwordx4 v168, s[20:23], s64 offen nt lds
    s_waitcnt vmcnt(24)
    s_waitcnt lgkmcnt(0)
    s_barrier
    s_mov_b32 s64, 860160
    s_add_u32 m0, s70, 114688
    s_nop 0
    buffer_load_dwordx4 v168, s[20:23], s64 offen nt lds
    s_mov_b32 s64, 890880
    s_add_u32 m0, s70, 118784
    s_nop 0
    buffer_load_dwordx4 v168, s[20:23], s64 offen nt lds
    s_mov_b32 s64, 921600
    s_add_u32 m0, s70, 122880
    s_nop 0
    buffer_load_dwordx4 v168, s[20:23], s64 offen nt lds
    s_mov_b32 s64, 952320
    s_add_u32 m0, s70, 126976
    s_nop 0
    buffer_load_dwordx4 v168, s[20:23], s64 offen nt lds
    ds_read_b64_tr_b16 v[200:201], v171 offset:0
    ds_read_b64_tr_b16 v[202:203], v171 offset:2048
    ds_read_b64_tr_b16 a[0:1], v169 offset:0
    ds_read_b64_tr_b16 a[2:3], v169 offset:2048
    ds_read_b64_tr_b16 a[80:81], v169 offset:160
    ds_read_b64_tr_b16 a[82:83], v169 offset:2208
    ds_read_b64_tr_b16 a[160:161], v169 offset:320
    ds_read_b64_tr_b16 a[162:163], v169 offset:2368
    s_waitcnt lgkmcnt(7)
    ds_bpermute_b32 v4, v173, v200
    ds_bpermute_b32 v5, v173, v201
    s_waitcnt lgkmcnt(8)
    ds_bpermute_b32 v6, v173, v202
    ds_bpermute_b32 v7, v173, v203
    s_waitcnt vmcnt(24)
    s_waitcnt lgkmcnt(0)
    s_barrier
    s_mov_b32 s64, 983040
    s_add_u32 m0, s70, 0
    s_nop 0
    buffer_load_dwordx4 v168, s[20:23], s64 offen nt lds
    s_mov_b32 s64, 1013760
    s_add_u32 m0, s70, 4096
    s_nop 0
    buffer_load_dwordx4 v168, s[20:23], s64 offen nt lds
    s_mov_b32 s64, 1044480
    s_add_u32 m0, s70, 8192
    s_nop 0
    buffer_load_dwordx4 v168, s[20:23], s64 offen nt lds
    s_mov_b32 s64, 1075200
    s_add_u32 m0, s70, 12288
    s_nop 0
    buffer_load_dwordx4 v168, s[20:23], s64 offen nt lds
    ds_read_b64_tr_b16 v[200:201], v171 offset:16384
    ds_read_b64_tr_b16 v[202:203], v171 offset:18432
    ds_read_b64_tr_b16 a[4:5], v169 offset:16384
    ds_read_b64_tr_b16 a[6:7], v169 offset:18432
    ds_read_b64_tr_b16 a[84:85], v169 offset:16544
    ds_read_b64_tr_b16 a[86:87], v169 offset:18592
    ds_read_b64_tr_b16 a[164:165], v169 offset:16704
    ds_read_b64_tr_b16 a[166:167], v169 offset:18752
    s_waitcnt lgkmcnt(7)
    ds_bpermute_b32 v8, v173, v200
    ds_bpermute_b32 v9, v173, v201
    s_waitcnt lgkmcnt(8)
    ds_bpermute_b32 v10, v173, v202
    ds_bpermute_b32 v11, v173, v203
    s_waitcnt vmcnt(24)
    s_waitcnt lgkmcnt(0)
    s_barrier
    s_mov_b32 s64, 1105920
    s_add_u32 m0, s70, 16384
    s_nop 0
    buffer_load_dwordx4 v168, s[20:23], s64 offen nt lds
    s_mov_b32 s64, 1136640
    s_add_u32 m0, s70, 20480
    s_nop 0
    buffer_load_dwordx4 v168, s[20:23], s64 offen nt lds
    s_mov_b32 s64, 1167360
    s_add_u32 m0, s70, 24576
    s_nop 0
    buffer_load_dwordx4 v168, s[20:23], s64 offen nt lds
    s_mov_b32 s64, 1198080
    s_add_u32 m0, s70, 28672
    s_nop 0
    buffer_load_dwordx4 v168, s[20:23], s64 offen nt lds
    ds_read_b64_tr_b16 v[200:201], v171 offset:32768
    ds_read_b64_tr_b16 v[202:203], v171 offset:34816
    ds_read_b64_tr_b16 a[8:9], v169 offset:32768
    ds_read_b64_tr_b16 a[10:11], v169 offset:34816
    ds_read_b64_tr_b16 a[88:89], v169 offset:32928
    ds_read_b64_tr_b16 a[90:91], v169 offset:34976
    ds_read_b64_tr_b16 a[168:169], v169 offset:33088
    ds_read_b64_tr_b16 a[170:171], v169 offset:35136
    s_waitcnt lgkmcnt(7)
    ds_bpermute_b32 v12, v173, v200
    ds_bpermute_b32 v13, v173, v201
    s_waitcnt lgkmcnt(8)
    ds_bpermute_b32 v14, v173, v202
    ds_bpermute_b32 v15, v173, v203
    s_waitcnt vmcnt(24)
    s_waitcnt lgkmcnt(0)
    s_barrier
    s_mov_b32 s64, 1228800
    s_add_u32 m0, s70, 32768
    s_nop 0
    buffer_load_dwordx4 v168, s[20:23], s64 offen nt lds
    s_mov_b32 s64, 1259520
    s_add_u32 m0, s70, 36864
    s_nop 0
    buffer_load_dwordx4 v168, s[20:23], s64 offen nt lds
    s_mov_b32 s64, 1290240
    s_add_u32 m0, s70, 40960
    s_nop 0
    buffer_load_dwordx4 v168, s[20:23], s64 offen nt lds
    s_mov_b32 s64, 1320960
    s_add_u32 m0, s70, 45056
    s_nop 0
    buffer_load_dwordx4 v168, s[20:23], s64 offen nt lds
    ds_read_b64_tr_b16 v[200:201], v171 offset:49152
    ds_read_b64_tr_b16 v[202:203], v171 offset:51200
    ds_read_b64_tr_b16 a[12:13], v169 offset:49152
    ds_read_b64_tr_b16 a[14:15], v169 offset:51200
    ds_read_b64_tr_b16 a[92:93], v169 offset:49312
    ds_read_b64_tr_b16 a[94:95], v169 offset:51360
    ds_read_b64_tr_b16 a[172:173], v169 offset:49472
    ds_read_b64_tr_b16 a[174:175], v169 offset:51520
    s_waitcnt lgkmcnt(7)
    ds_bpermute_b32 v16, v173, v200
    ds_bpermute_b32 v17, v173, v201
    s_waitcnt lgkmcnt(8)
    ds_bpermute_b32 v18, v173, v202
    ds_bpermute_b32 v19, v173, v203
    s_waitcnt vmcnt(24)
    s_waitcnt lgkmcnt(0)
    s_barrier
    s_mov_b32 s64, 1351680
    s_add_u32 m0, s70, 49152
    s_nop 0
    buffer_load_dwordx4 v168, s[20:23], s64 offen nt lds
    s_mov_b32 s64, 1382400
    s_add_u32 m0, s70, 53248
    s_nop 0
    buffer_load_dwordx4 v168, s[20:23], s64 offen nt lds
    s_mov_b32 s64, 1413120
    s_add_u32 m0, s70, 57344
    s_nop 0
    buffer_load_dwordx4 v168, s[20:23], s64 offen nt lds
    s_mov_b32 s64, 1443840
    s_add_u32 m0, s70, 61440
    s_nop 0
    buffer_load_dwordx4 v168, s[20:23], s64 offen nt lds
    ds_read_b64_tr_b16 v[200:201], v172 offset:0
    ds_read_b64_tr_b16 v[202:203], v172 offset:2048
    ds_read_b64_tr_b16 a[16:17], v170 offset:0
    ds_read_b64_tr_b16 a[18:19], v170 offset:2048
    ds_read_b64_tr_b16 a[96:97], v170 offset:160
    ds_read_b64_tr_b16 a[98:99], v170 offset:2208
    ds_read_b64_tr_b16 a[176:177], v170 offset:320
    ds_read_b64_tr_b16 a[178:179], v170 offset:2368
    s_waitcnt lgkmcnt(7)
    ds_bpermute_b32 v20, v173, v200
    ds_bpermute_b32 v21, v173, v201
    s_waitcnt lgkmcnt(8)
    ds_bpermute_b32 v22, v173, v202
    ds_bpermute_b32 v23, v173, v203
    s_waitcnt vmcnt(24)
    s_waitcnt lgkmcnt(0)
    s_barrier
    s_mov_b32 s64, 1474560
    s_add_u32 m0, s70, 65536
    s_nop 0
    buffer_load_dwordx4 v168, s[20:23], s64 offen nt lds
    s_mov_b32 s64, 1505280
    s_add_u32 m0, s70, 69632
    s_nop 0
    buffer_load_dwordx4 v168, s[20:23], s64 offen nt lds
    s_mov_b32 s64, 1536000
    s_add_u32 m0, s70, 73728
    s_nop 0
    buffer_load_dwordx4 v168, s[20:23], s64 offen nt lds
    s_mov_b32 s64, 1566720
    s_add_u32 m0, s70, 77824
    s_nop 0
    buffer_load_dwordx4 v168, s[20:23], s64 offen nt lds
    ds_read_b64_tr_b16 v[200:201], v172 offset:16384
    ds_read_b64_tr_b16 v[202:203], v172 offset:18432
    ds_read_b64_tr_b16 a[20:21], v170 offset:16384
    ds_read_b64_tr_b16 a[22:23], v170 offset:18432
    ds_read_b64_tr_b16 a[100:101], v170 offset:16544
    ds_read_b64_tr_b16 a[102:103], v170 offset:18592
    ds_read_b64_tr_b16 a[180:181], v170 offset:16704
    ds_read_b64_tr_b16 a[182:183], v170 offset:18752
    s_waitcnt lgkmcnt(7)
    ds_bpermute_b32 v24, v173, v200
    ds_bpermute_b32 v25, v173, v201
    s_waitcnt lgkmcnt(8)
    ds_bpermute_b32 v26, v173, v202
    ds_bpermute_b32 v27, v173, v203
    s_waitcnt vmcnt(24)
    s_waitcnt lgkmcnt(0)
    s_barrier
    s_mov_b32 s64, 1597440
    s_add_u32 m0, s70, 81920
    s_nop 0
    buffer_load_dwordx4 v168, s[20:23], s64 offen nt lds
    s_mov_b32 s64, 1628160
    s_add_u32 m0, s70, 86016
    s_nop 0
    buffer_load_dwordx4 v168, s[20:23], s64 offen nt lds
    s_mov_b32 s64, 1658880
    s_add_u32 m0, s70, 90112
    s_nop 0
    buffer_load_dwordx4 v168, s[20:23], s64 offen nt lds
    s_mov_b32 s64, 1689600
    s_add_u32 m0, s70, 94208
    s_nop 0
    buffer_load_dwordx4 v168, s[20:23], s64 offen nt lds
    ds_read_b64_tr_b16 v[200:201], v172 offset:32768
    ds_read_b64_tr_b16 v[202:203], v172 offset:34816
    ds_read_b64_tr_b16 a[24:25], v170 offset:32768
    ds_read_b64_tr_b16 a[26:27], v170 offset:34816
    ds_read_b64_tr_b16 a[104:105], v170 offset:32928
    ds_read_b64_tr_b16 a[106:107], v170 offset:34976
    ds_read_b64_tr_b16 a[184:185], v170 offset:33088
    ds_read_b64_tr_b16 a[186:187], v170 offset:35136
    s_waitcnt lgkmcnt(7)
    ds_bpermute_b32 v28, v173, v200
    ds_bpermute_b32 v29, v173, v201
    s_waitcnt lgkmcnt(8)
    ds_bpermute_b32 v30, v173, v202
    ds_bpermute_b32 v31, v173, v203
    s_waitcnt vmcnt(24)
    s_waitcnt lgkmcnt(0)
    s_barrier
    s_mov_b32 s64, 1720320
    s_add_u32 m0, s70, 98304
    s_nop 0
    buffer_load_dwordx4 v168, s[20:23], s64 offen nt lds
    s_mov_b32 s64, 1751040
    s_add_u32 m0, s70, 102400
    s_nop 0
    buffer_load_dwordx4 v168, s[20:23], s64 offen nt lds
    s_mov_b32 s64, 1781760
    s_add_u32 m0, s70, 106496
    s_nop 0
    buffer_load_dwordx4 v168, s[20:23], s64 offen nt lds
    s_mov_b32 s64, 1812480
    s_add_u32 m0, s70, 110592
    s_nop 0
    buffer_load_dwordx4 v168, s[20:23], s64 offen nt lds
    ds_read_b64_tr_b16 v[200:201], v172 offset:49152
    ds_read_b64_tr_b16 v[202:203], v172 offset:51200
    ds_read_b64_tr_b16 a[28:29], v170 offset:49152
    ds_read_b64_tr_b16 a[30:31], v170 offset:51200
    ds_read_b64_tr_b16 a[108:109], v170 offset:49312
    ds_read_b64_tr_b16 a[110:111], v170 offset:51360
    ds_read_b64_tr_b16 a[188:189], v170 offset:49472
    ds_read_b64_tr_b16 a[190:191], v170 offset:51520
    s_waitcnt lgkmcnt(7)
    ds_bpermute_b32 v32, v173, v200
    ds_bpermute_b32 v33, v173, v201
    s_waitcnt lgkmcnt(8)
    ds_bpermute_b32 v34, v173, v202
    ds_bpermute_b32 v35, v173, v203
    s_waitcnt vmcnt(24)
    s_waitcnt lgkmcnt(0)
    s_barrier
    s_mov_b32 s64, 1843200
    s_add_u32 m0, s70, 114688
    s_nop 0
    buffer_load_dwordx4 v168, s[20:23], s64 offen nt lds
    s_mov_b32 s64, 1873920
    s_add_u32 m0, s70, 118784
    s_nop 0
    buffer_load_dwordx4 v168, s[20:23], s64 offen nt lds
    s_mov_b32 s64, 1904640
    s_add_u32 m0, s70, 122880
    s_nop 0
    buffer_load_dwordx4 v168, s[20:23], s64 offen nt lds
    s_mov_b32 s64, 1935360
    s_add_u32 m0, s70, 126976
    s_nop 0
    buffer_load_dwordx4 v168, s[20:23], s64 offen nt lds
    ds_read_b64_tr_b16 v[200:201], v171 offset:0
    ds_read_b64_tr_b16 v[202:203], v171 offset:2048
    ds_read_b64_tr_b16 a[32:33], v169 offset:0
    ds_read_b64_tr_b16 a[34:35], v169 offset:2048
    ds_read_b64_tr_b16 a[112:113], v169 offset:160
    ds_read_b64_tr_b16 a[114:115], v169 offset:2208
    ds_read_b64_tr_b16 a[192:193], v169 offset:320
    ds_read_b64_tr_b16 a[194:195], v169 offset:2368
    s_waitcnt lgkmcnt(7)
    ds_bpermute_b32 v36, v173, v200
    ds_bpermute_b32 v37, v173, v201
    s_waitcnt lgkmcnt(8)
    ds_bpermute_b32 v38, v173, v202
    ds_bpermute_b32 v39, v173, v203
    s_waitcnt vmcnt(24)
    s_waitcnt lgkmcnt(0)
    s_barrier
    s_mov_b32 s64, 1966080
    s_add_u32 m0, s70, 0
    s_nop 0
    buffer_load_dwordx4 v168, s[20:23], s64 offen nt lds
    s_mov_b32 s64, 1996800
    s_add_u32 m0, s70, 4096
    s_nop 0
    buffer_load_dwordx4 v168, s[20:23], s64 offen nt lds
    s_mov_b32 s64, 2027520
    s_add_u32 m0, s70, 8192
    s_nop 0
    buffer_load_dwordx4 v168, s[20:23], s64 offen nt lds
    s_mov_b32 s64, 2058240
    s_add_u32 m0, s70, 12288
    s_nop 0
    buffer_load_dwordx4 v168, s[20:23], s64 offen nt lds
    ds_read_b64_tr_b16 v[200:201], v171 offset:16384
    ds_read_b64_tr_b16 v[202:203], v171 offset:18432
    ds_read_b64_tr_b16 a[36:37], v169 offset:16384
    ds_read_b64_tr_b16 a[38:39], v169 offset:18432
    ds_read_b64_tr_b16 a[116:117], v169 offset:16544
    ds_read_b64_tr_b16 a[118:119], v169 offset:18592
    ds_read_b64_tr_b16 a[196:197], v169 offset:16704
    ds_read_b64_tr_b16 a[198:199], v169 offset:18752
    s_waitcnt lgkmcnt(7)
    ds_bpermute_b32 v40, v173, v200
    ds_bpermute_b32 v41, v173, v201
    s_waitcnt lgkmcnt(8)
    ds_bpermute_b32 v42, v173, v202
    ds_bpermute_b32 v43, v173, v203
    s_waitcnt vmcnt(24)
    s_waitcnt lgkmcnt(0)
    s_barrier
    s_mov_b32 s64, 2088960
    s_add_u32 m0, s70, 16384
    s_nop 0
    buffer_load_dwordx4 v168, s[20:23], s64 offen nt lds
    s_mov_b32 s64, 2119680
    s_add_u32 m0, s70, 20480
    s_nop 0
    buffer_load_dwordx4 v168, s[20:23], s64 offen nt lds
    s_mov_b32 s64, 2150400
    s_add_u32 m0, s70, 24576
    s_nop 0
    buffer_load_dwordx4 v168, s[20:23], s64 offen nt lds
    s_mov_b32 s64, 2181120
    s_add_u32 m0, s70, 28672
    s_nop 0
    buffer_load_dwordx4 v168, s[20:23], s64 offen nt lds
    ds_read_b64_tr_b16 v[200:201], v171 offset:32768
    ds_read_b64_tr_b16 v[202:203], v171 offset:34816
    ds_read_b64_tr_b16 a[40:41], v169 offset:32768
    ds_read_b64_tr_b16 a[42:43], v169 offset:34816
    ds_read_b64_tr_b16 a[120:121], v169 offset:32928
    ds_read_b64_tr_b16 a[122:123], v169 offset:34976
    ds_read_b64_tr_b16 a[200:201], v169 offset:33088
    ds_read_b64_tr_b16 a[202:203], v169 offset:35136
    s_waitcnt lgkmcnt(7)
    ds_bpermute_b32 v44, v173, v200
    ds_bpermute_b32 v45, v173, v201
    s_waitcnt lgkmcnt(8)
    ds_bpermute_b32 v46, v173, v202
    ds_bpermute_b32 v47, v173, v203
    s_waitcnt vmcnt(24)
    s_waitcnt lgkmcnt(0)
    s_barrier
    s_mov_b32 s64, 2211840
    s_add_u32 m0, s70, 32768
    s_nop 0
    buffer_load_dwordx4 v168, s[20:23], s64 offen nt lds
    s_mov_b32 s64, 2242560
    s_add_u32 m0, s70, 36864
    s_nop 0
    buffer_load_dwordx4 v168, s[20:23], s64 offen nt lds
    s_mov_b32 s64, 2273280
    s_add_u32 m0, s70, 40960
    s_nop 0
    buffer_load_dwordx4 v168, s[20:23], s64 offen nt lds
    s_mov_b32 s64, 2304000
    s_add_u32 m0, s70, 45056
    s_nop 0
    buffer_load_dwordx4 v168, s[20:23], s64 offen nt lds
    ds_read_b64_tr_b16 v[200:201], v171 offset:49152
    ds_read_b64_tr_b16 v[202:203], v171 offset:51200
    ds_read_b64_tr_b16 a[44:45], v169 offset:49152
    ds_read_b64_tr_b16 a[46:47], v169 offset:51200
    ds_read_b64_tr_b16 a[124:125], v169 offset:49312
    ds_read_b64_tr_b16 a[126:127], v169 offset:51360
    ds_read_b64_tr_b16 a[204:205], v169 offset:49472
    ds_read_b64_tr_b16 a[206:207], v169 offset:51520
    s_waitcnt lgkmcnt(7)
    ds_bpermute_b32 v48, v173, v200
    ds_bpermute_b32 v49, v173, v201
    s_waitcnt lgkmcnt(8)
    ds_bpermute_b32 v50, v173, v202
    ds_bpermute_b32 v51, v173, v203
    s_waitcnt vmcnt(24)
    s_waitcnt lgkmcnt(0)
    s_barrier
    s_mov_b32 s64, 2334720
    s_add_u32 m0, s70, 49152
    s_nop 0
    buffer_load_dwordx4 v168, s[20:23], s64 offen nt lds
    s_mov_b32 s64, 2365440
    s_add_u32 m0, s70, 53248
    s_nop 0
    buffer_load_dwordx4 v168, s[20:23], s64 offen nt lds
    s_mov_b32 s64, 2396160
    s_add_u32 m0, s70, 57344
    s_nop 0
    buffer_load_dwordx4 v168, s[20:23], s64 offen nt lds
    s_mov_b32 s64, 2426880
    s_add_u32 m0, s70, 61440
    s_nop 0
    buffer_load_dwordx4 v168, s[20:23], s64 offen nt lds
    ds_read_b64_tr_b16 v[200:201], v172 offset:0
    ds_read_b64_tr_b16 v[202:203], v172 offset:2048
    ds_read_b64_tr_b16 a[48:49], v170 offset:0
    ds_read_b64_tr_b16 a[50:51], v170 offset:2048
    ds_read_b64_tr_b16 a[128:129], v170 offset:160
    ds_read_b64_tr_b16 a[130:131], v170 offset:2208
    ds_read_b64_tr_b16 a[208:209], v170 offset:320
    ds_read_b64_tr_b16 a[210:211], v170 offset:2368
    s_waitcnt lgkmcnt(7)
    ds_bpermute_b32 v52, v173, v200
    ds_bpermute_b32 v53, v173, v201
    s_waitcnt lgkmcnt(8)
    ds_bpermute_b32 v54, v173, v202
    ds_bpermute_b32 v55, v173, v203
    s_waitcnt vmcnt(24)
    s_waitcnt lgkmcnt(0)
    s_barrier
    ds_read_b64_tr_b16 v[200:201], v172 offset:16384
    ds_read_b64_tr_b16 v[202:203], v172 offset:18432
    ds_read_b64_tr_b16 a[52:53], v170 offset:16384
    ds_read_b64_tr_b16 a[54:55], v170 offset:18432
    ds_read_b64_tr_b16 a[132:133], v170 offset:16544
    ds_read_b64_tr_b16 a[134:135], v170 offset:18592
    ds_read_b64_tr_b16 a[212:213], v170 offset:16704
    ds_read_b64_tr_b16 a[214:215], v170 offset:18752
    s_waitcnt lgkmcnt(7)
    ds_bpermute_b32 v56, v173, v200
    ds_bpermute_b32 v57, v173, v201
    s_waitcnt lgkmcnt(8)
    ds_bpermute_b32 v58, v173, v202
    ds_bpermute_b32 v59, v173, v203
    s_waitcnt vmcnt(20)
    s_waitcnt lgkmcnt(0)
    s_barrier
    ds_read_b64_tr_b16 v[200:201], v172 offset:32768
    ds_read_b64_tr_b16 v[202:203], v172 offset:34816
    ds_read_b64_tr_b16 a[56:57], v170 offset:32768
    ds_read_b64_tr_b16 a[58:59], v170 offset:34816
    ds_read_b64_tr_b16 a[136:137], v170 offset:32928
    ds_read_b64_tr_b16 a[138:139], v170 offset:34976
    ds_read_b64_tr_b16 a[216:217], v170 offset:33088
    ds_read_b64_tr_b16 a[218:219], v170 offset:35136
    s_waitcnt lgkmcnt(7)
    ds_bpermute_b32 v60, v173, v200
    ds_bpermute_b32 v61, v173, v201
    s_waitcnt lgkmcnt(8)
    ds_bpermute_b32 v62, v173, v202
    ds_bpermute_b32 v63, v173, v203
    s_waitcnt vmcnt(16)
    s_waitcnt lgkmcnt(0)
    s_barrier
    ds_read_b64_tr_b16 v[200:201], v172 offset:49152
    ds_read_b64_tr_b16 v[202:203], v172 offset:51200
    ds_read_b64_tr_b16 a[60:61], v170 offset:49152
    ds_read_b64_tr_b16 a[62:63], v170 offset:51200
    ds_read_b64_tr_b16 a[140:141], v170 offset:49312
    ds_read_b64_tr_b16 a[142:143], v170 offset:51360
    ds_read_b64_tr_b16 a[220:221], v170 offset:49472
    ds_read_b64_tr_b16 a[222:223], v170 offset:51520
    s_waitcnt lgkmcnt(7)
    ds_bpermute_b32 v64, v173, v200
    ds_bpermute_b32 v65, v173, v201
    s_waitcnt lgkmcnt(8)
    ds_bpermute_b32 v66, v173, v202
    ds_bpermute_b32 v67, v173, v203
    s_waitcnt vmcnt(12)
    s_waitcnt lgkmcnt(0)
    s_barrier
    ds_read_b64_tr_b16 v[200:201], v171 offset:0
    ds_read_b64_tr_b16 v[202:203], v171 offset:2048
    ds_read_b64_tr_b16 a[64:65], v169 offset:0
    ds_read_b64_tr_b16 a[66:67], v169 offset:2048
    ds_read_b64_tr_b16 a[144:145], v169 offset:160
    ds_read_b64_tr_b16 a[146:147], v169 offset:2208
    ds_read_b64_tr_b16 a[224:225], v169 offset:320
    ds_read_b64_tr_b16 a[226:227], v169 offset:2368
    s_waitcnt lgkmcnt(7)
    ds_bpermute_b32 v68, v173, v200
    ds_bpermute_b32 v69, v173, v201
    s_waitcnt lgkmcnt(8)
    ds_bpermute_b32 v70, v173, v202
    ds_bpermute_b32 v71, v173, v203
    s_waitcnt vmcnt(8)
    s_waitcnt lgkmcnt(0)
    s_barrier
    ds_read_b64_tr_b16 v[200:201], v171 offset:16384
    ds_read_b64_tr_b16 v[202:203], v171 offset:18432
    ds_read_b64_tr_b16 a[68:69], v169 offset:16384
    ds_read_b64_tr_b16 a[70:71], v169 offset:18432
    ds_read_b64_tr_b16 a[148:149], v169 offset:16544
    ds_read_b64_tr_b16 a[150:151], v169 offset:18592
    ds_read_b64_tr_b16 a[228:229], v169 offset:16704
    ds_read_b64_tr_b16 a[230:231], v169 offset:18752
    s_waitcnt lgkmcnt(7)
    ds_bpermute_b32 v72, v173, v200
    ds_bpermute_b32 v73, v173, v201
    s_waitcnt lgkmcnt(8)
    ds_bpermute_b32 v74, v173, v202
    ds_bpermute_b32 v75, v173, v203
    s_waitcnt vmcnt(4)
    s_waitcnt lgkmcnt(0)
    s_barrier
    ds_read_b64_tr_b16 v[200:201], v171 offset:32768
    ds_read_b64_tr_b16 v[202:203], v171 offset:34816
    ds_read_b64_tr_b16 a[72:73], v169 offset:32768
    ds_read_b64_tr_b16 a[74:75], v169 offset:34816
    ds_read_b64_tr_b16 a[152:153], v169 offset:32928
    ds_read_b64_tr_b16 a[154:155], v169 offset:34976
    ds_read_b64_tr_b16 a[232:233], v169 offset:33088
    ds_read_b64_tr_b16 a[234:235], v169 offset:35136
    s_waitcnt lgkmcnt(7)
    ds_bpermute_b32 v76, v173, v200
    ds_bpermute_b32 v77, v173, v201
    s_waitcnt lgkmcnt(8)
    ds_bpermute_b32 v78, v173, v202
    ds_bpermute_b32 v79, v173, v203
    s_waitcnt vmcnt(0)
    s_waitcnt lgkmcnt(0)
    s_barrier
    ds_read_b64_tr_b16 v[200:201], v171 offset:49152
    ds_read_b64_tr_b16 v[202:203], v171 offset:51200
    ds_read_b64_tr_b16 a[76:77], v169 offset:49152
    ds_read_b64_tr_b16 a[78:79], v169 offset:51200
    ds_read_b64_tr_b16 a[156:157], v169 offset:49312
    ds_read_b64_tr_b16 a[158:159], v169 offset:51360
    ds_read_b64_tr_b16 a[236:237], v169 offset:49472
    ds_read_b64_tr_b16 a[238:239], v169 offset:51520
    s_waitcnt lgkmcnt(7)
    ds_bpermute_b32 v80, v173, v200
    ds_bpermute_b32 v81, v173, v201
    s_waitcnt lgkmcnt(8)
    ds_bpermute_b32 v82, v173, v202
    ds_bpermute_b32 v83, v173, v203
    s_waitcnt lgkmcnt(0)
    s_barrier
    v_lshlrev_b32 v168, 4, v0
    s_mul_i32 s64, s74, 102400
    s_add_u32 s65, s64, 102400
    s_mov_b32 m0, s70
Lstgb_91:
    s_nop 0
    buffer_load_dwordx4 v168, s[24:27], s64 offen nt lds
    s_add_u32 m0, m0, 4096
    s_add_u32 s64, s64, 4096
    s_cmp_lt_u32 s64, s65
    s_cbranch_scc1 Lstgb_91
    v_lshl_add_u32 v169, v176, 2, v177
    v_mul_u32_u24 v169, 1280, v169
    v_mul_u32_u24 v171, 20, v177
    v_add3_u32 v171, v171, v176, 16
    v_mul_u32_u24 v171, 1280, v171
    s_lshl_b32 s64, s60, 6
    v_lshl_add_u32 v173, v178, 3, s64
    v_add_u32 v170, v169, v173
    v_add_u32 v172, v171, v173
    v_lshl_add_u32 v169, v173, 1, v169
    v_lshl_add_u32 v171, v173, 1, v171
    v_add_u32 v174, 51200, v169
    v_add_u32 v175, 51200, v170
    s_waitcnt vmcnt(0)
    s_barrier
    ds_read_b64_tr_b16 v[84:85], v169 offset:0
    ds_read_b64_tr_b16 v[86:87], v169 offset:25600
    ds_read_b64_tr_b16 v[88:89], v174 offset:0
    ds_read_b64_tr_b16 v[90:91], v174 offset:25600
    ds_read_b64_tr_b16 a[240:241], v171 offset:0
    ds_read_b64_tr_b16 v[92:93], v169 offset:8
    ds_read_b64_tr_b16 v[94:95], v169 offset:25608
    ds_read_b64_tr_b16 v[96:97], v174 offset:8
    ds_read_b64_tr_b16 v[98:99], v174 offset:25608
    ds_read_b64_tr_b16 a[242:243], v171 offset:8
    ds_read_b64_tr_b16 v[100:101], v169 offset:512
    ds_read_b64_tr_b16 v[102:103], v169 offset:26112
    ds_read_b64_tr_b16 v[104:105], v174 offset:512
    ds_read_b64_tr_b16 v[106:107], v174 offset:26112
    ds_read_b64_tr_b16 a[244:245], v171 offset:512
    ds_read_b64_tr_b16 v[108:109], v169 offset:520
    ds_read_b64_tr_b16 v[110:111], v169 offset:26120
    ds_read_b64_tr_b16 v[112:113], v174 offset:520
    ds_read_b64_tr_b16 v[114:115], v174 offset:26120
    ds_read_b64_tr_b16 a[246:247], v171 offset:520
    ds_read_b64_tr_b16 v[116:117], v170 offset:1024
    ds_read_b64_tr_b16 v[118:119], v170 offset:26624
    ds_read_b64_tr_b16 v[120:121], v175 offset:1024
    ds_read_b64_tr_b16 v[122:123], v175 offset:26624
    ds_read_b64_tr_b16 a[248:249], v172 offset:1024
    ds_read_b64_tr_b16 v[124:125], v169 offset:64
    ds_read_b64_tr_b16 v[126:127], v169 offset:25664
    ds_read_b64_tr_b16 v[128:129], v174 offset:64
    ds_read_b64_tr_b16 v[130:131], v174 offset:25664
    ds_read_b64_tr_b16 a[250:251], v171 offset:64
    ds_read_b64_tr_b16 v[132:133], v169 offset:72
    ds_read_b64_tr_b16 v[134:135], v169 offset:25672
    ds_read_b64_tr_b16 v[136:137], v174 offset:72
    ds_read_b64_tr_b16 v[138:139], v174 offset:25672
    ds_read_b64_tr_b16 a[252:253], v171 offset:72
    ds_read_b64_tr_b16 v[140:141], v169 offset:576
    ds_read_b64_tr_b16 v[142:143], v169 offset:26176
    ds_read_b64_tr_b16 v[144:145], v174 offset:576
    ds_read_b64_tr_b16 v[146:147], v174 offset:26176
    ds_read_b64_tr_b16 a[254:255], v171 offset:576
    ds_read_b64_tr_b16 v[148:149], v169 offset:584
    ds_read_b64_tr_b16 v[150:151], v169 offset:26184
    ds_read_b64_tr_b16 v[152:153], v174 offset:584
    ds_read_b64_tr_b16 v[154:155], v174 offset:26184
    ds_read_b64_tr_b16 v[164:165], v171 offset:584
    ds_read_b64_tr_b16 v[156:157], v170 offset:1056
    ds_read_b64_tr_b16 v[158:159], v170 offset:26656
    ds_read_b64_tr_b16 v[160:161], v175 offset:1056
    ds_read_b64_tr_b16 v[162:163], v175 offset:26656
    ds_read_b64_tr_b16 v[166:167], v172 offset:1056
    s_waitcnt lgkmcnt(0)
    s_barrier
    v_and_b32 v179, 7, v1
    v_bfe_u32 v180, v1, 3, 1
    v_lshrrev_b32 v181, 3, v0
    v_mul_u32_u24 v242, 1280, v181
    v_and_b32 v181, 7, v181
    v_xor_b32 v181, v181, v179
    v_lshl_add_u32 v242, v181, 4, v242
    v_mul_u32_u24 v243, 10240, v180
    v_lshl_add_u32 v243, v179, 7, v243
    v_xor_b32 v181, v176, v179
    v_lshl_add_u32 v243, v181, 4, v243
    v_xor_b32 v244, 64, v243
    v_and_b32 v168, 15, v1
    v_lshlrev_b32 v181, 2, v176
    v_cmp_eq_u32 vcc, v168, v181
    s_nop 1
    v_cndmask_b32 v240, 0, 1.0, vcc
    v_mov_b32 v182, 0x3f803f80
    v_cmp_eq_u32 vcc, 1, v178
    s_nop 1
    v_cndmask_b32 v241, 0, v182, vcc
    v_sub_u32 v181, v168, v181
    v_mov_b32 v182, 0xff800000
    v_add_u32 v169, 16, v181
    v_and_b32 v169, 0xfffffff1, v169
    v_cmp_eq_u32 vcc, 0, v169
    s_nop 1
    v_cndmask_b32 v200, v182, 0, vcc
    v_add_u32 v169, 15, v181
    v_and_b32 v169, 0xfffffff1, v169
    v_cmp_eq_u32 vcc, 0, v169
    s_nop 1
    v_cndmask_b32 v201, v182, 0, vcc
    v_add_u32 v169, 14, v181
    v_and_b32 v169, 0xfffffff1, v169
    v_cmp_eq_u32 vcc, 0, v169
    s_nop 1
    v_cndmask_b32 v202, v182, 0, vcc
    v_add_u32 v169, 13, v181
    v_and_b32 v169, 0xfffffff1, v169
    v_cmp_eq_u32 vcc, 0, v169
    s_nop 1
    v_cndmask_b32 v203, v182, 0, vcc
    v_add_u32 v169, 0, v181
    v_and_b32 v169, 0xfffffff1, v169
    v_cmp_eq_u32 vcc, 0, v169
    s_nop 1
    v_cndmask_b32 v204, v182, 0, vcc
    v_add_u32 v169, -1, v181
    v_and_b32 v169, 0xfffffff1, v169
    v_cmp_eq_u32 vcc, 0, v169
    s_nop 1
    v_cndmask_b32 v205, v182, 0, vcc
    v_add_u32 v169, -2, v181
    v_and_b32 v169, 0xfffffff1, v169
    v_cmp_eq_u32 vcc, 0, v169
    s_nop 1
    v_cndmask_b32 v206, v182, 0, vcc
    v_add_u32 v169, -3, v181
    v_and_b32 v169, 0xfffffff1, v169
    v_cmp_eq_u32 vcc, 0, v169
    s_nop 1
    v_cndmask_b32 v207, v182, 0, vcc
    v_mov_b32 v208, v182
    v_mov_b32 v224, 0
    v_mov_b32 v209, v182
    v_mov_b32 v225, 0
    v_mov_b32 v210, v182
    v_mov_b32 v226, 0
    v_mov_b32 v211, v182
    v_mov_b32 v227, 0
    ds_write_b128 v245, v[200:203] offset:5120
    ds_write_b128 v245, v[204:207] offset:6144
    ds_write_b128 v245, v[208:211] offset:7168
    v_mov_b32 v228, 0
    v_mov_b32 v229, 0
    v_mov_b32 v234, 0
    v_mov_b32 v235, 0
    v_add_u32 v246, 2048, v245
    s_lshr_b32 s64, s60, 1
    s_lshl_b32 s64, s64, 10
    s_and_b32 s65, s60, 1
    s_lshl_b32 s65, s65, 3
    s_add_u32 s64, s64, s65
    v_add_u32 v247, s64, v245
    s_lshl_b32 s64, s60, 1
    v_lshl_add_u32 v248, v1, 3, s64
    v_lshlrev_b32 v250, 5, v168
    v_lshl_add_u32 v250, v176, 3, v250
    v_lshlrev_b32 v249, 1, v250
    s_mul_i32 s64, s60, 10240
    v_add_u32 v249, s64, v249
    s_add_u32 s64, s64, 4096
    v_add_u32 v250, s64, v250
    s_mul_i32 s70, s68, 2621440
    s_add_u32 s70, s70, 23068672
    s_lshl_b32 s64, s68, 9
    s_add_u32 s64, s64, s74
    s_mul_i32 s71, s64, 40960
    s_add_u32 s71, s71, 134217728
    s_mul_i32 s72, s60, 10240
    s_mov_b32 s76, 40960
    s_mov_b32 s77, 40960
    s_mov_b32 s75, 0x3ea52b5c
    s_mov_b32 s73, 0
    v_bfe_u32 v181, v0, 4, 2
    v_lshlrev_b32 v181, 5, v181
    v_add_u32 v181, 30, v181
    v_and_b32 v251, 3, v0
    v_lshl_add_u32 v251, v181, 2, v251
    v_lshlrev_b32 v251, 7, v251
    v_add_u32 v251, 8388608, v251
    s_lshl_b32 s64, s68, 16
    v_add_u32 v251, s64, v251
    v_bfe_u32 v181, v0, 4, 2
    v_cmp_eq_u32 vcc, s69, v181
    s_nop 1
    v_cndmask_b32 v181, 0, 1, vcc
    v_lshl_add_u32 v251, v181, 17, v251
    s_cmp_lg_u32 s60, 0
    s_cbranch_scc1 Lgskip_94
    buffer_load_dword v2, off, s[8:11], 0 offset:132 sc1
Lgchk_92:
    s_waitcnt vmcnt(0)
    v_cmp_eq_u32 vcc, 0, v2
    s_cbranch_vccnz Lgrty_93
Lgskip_94:
    s_waitcnt lgkmcnt(0)
    s_barrier
L_Bseg:
    s_cmp_lg_u32 s73, 0
    s_cbranch_scc1 L_Bhave
    s_add_u32 s65, s62, 1
    buffer_load_dword v252, v251, s[4:7], 0 offen sc1
    s_waitcnt vmcnt(0)
    v_mov_b32 v2, s62
    s_mov_b64 exec, 1
    buffer_store_dword v2, off, s[4:7], s63 sc1
    buffer_store_dword v2, off, s[4:7], s3
    s_mov_b64 exec, -1
Lfchk_95:
    v_cmp_gt_u32 vcc, s65, v252
    s_cbranch_vccnz Lfrty_96
    s_add_u32 m0, s72, 8192
    s_nop 0
    buffer_load_dwordx4 v242, s[4:7], s70 offen offset:0 sc1 lds
    s_add_u32 m0, s72, 9088
    s_nop 0
    buffer_load_dwordx4 v242, s[4:7], s70 offen offset:128 sc1 lds
    s_add_u32 m0, s72, 9984
    s_nop 0
    buffer_load_dwordx4 v242, s[4:7], s70 offen offset:256 sc1 lds
    s_add_u32 m0, s72, 10880
    s_nop 0
    buffer_load_dwordx4 v242, s[4:7], s70 offen offset:384 sc1 lds
    s_add_u32 m0, s72, 11776
    s_nop 0
    buffer_load_dwordx4 v242, s[4:7], s70 offen offset:512 sc1 lds
    s_add_u32 m0, s72, 12672
    s_nop 0
    buffer_load_dwordx4 v242, s[4:7], s70 offen offset:640 sc1 lds
    s_add_u32 m0, s72, 13568
    s_nop 0
    buffer_load_dwordx4 v242, s[4:7], s70 offen offset:768 sc1 lds
    s_add_u32 m0, s72, 14464
    s_nop 0
    buffer_load_dwordx4 v242, s[4:7], s70 offen offset:896 sc1 lds
    s_add_u32 m0, s72, 15360
    s_nop 0
    buffer_load_dwordx4 v242, s[4:7], s70 offen offset:1024 sc1 lds
    s_add_u32 m0, s72, 16256
    s_nop 0
    buffer_load_dwordx4 v242, s[4:7], s70 offen offset:1152 sc1 lds
    s_add_u32 s70, s70, 40960
    s_add_u32 s72, s72, s77
    s_sub_u32 s77, 0, s77
    s_waitcnt vmcnt(7)
L_Bhave:
    s_waitcnt vmcnt(19) lgkmcnt(0)
    s_barrier
    ds_read_b128 v[200:203], v243 offset:8192
    ds_read_b128 v[204:207], v243 offset:28672
    ds_read_b128 v[208:211], v244 offset:8192
    ds_read_b128 v[212:215], v244 offset:28672
    s_waitcnt lgkmcnt(3)
    v_mfma_f32_16x16x32_bf16 v[168:171], a[0:3], v[200:203], 0
    ds_read_b128 v[216:219], v243 offset:9216
    v_mfma_f32_16x16x32_bf16 v[172:175], a[80:83], v[200:203], 0
    ds_read_b128 v[220:223], v243 offset:29696
    v_mfma_f32_16x16x32_bf16 v[176:179], v[200:203], a[160:163], 0
    v_mfma_f32_16x16x32_bf16 v[180:183], v[4:7], v[200:203], 0
    s_waitcnt lgkmcnt(4)
    v_mfma_f32_16x16x32_bf16 v[184:187], a[0:3], v[204:207], 0
    v_mfma_f32_16x16x32_bf16 v[188:191], a[80:83], v[204:207], 0
    v_mfma_f32_16x16x32_bf16 v[192:195], v[204:207], a[160:163], 0
    v_mfma_f32_16x16x32_bf16 v[196:199], v[4:7], v[204:207], 0
    s_waitcnt lgkmcnt(3)
    v_mfma_f32_16x16x32_bf16 v[168:171], a[4:7], v[208:211], v[168:171]
    ds_read_b128 v[200:203], v244 offset:9216
    v_mfma_f32_16x16x32_bf16 v[172:175], a[84:87], v[208:211], v[172:175]
    ds_read_b128 v[204:207], v244 offset:29696
    v_mfma_f32_16x16x32_bf16 v[176:179], v[208:211], a[164:167], v[176:179]
    v_mfma_f32_16x16x32_bf16 v[180:183], v[8:11], v[208:211], v[180:183]
    s_waitcnt lgkmcnt(4)
    v_mfma_f32_16x16x32_bf16 v[184:187], a[4:7], v[212:215], v[184:187]
    v_mfma_f32_16x16x32_bf16 v[188:191], a[84:87], v[212:215], v[188:191]
    v_mfma_f32_16x16x32_bf16 v[192:195], v[212:215], a[164:167], v[192:195]
    v_mfma_f32_16x16x32_bf16 v[196:199], v[8:11], v[212:215], v[196:199]
    s_waitcnt lgkmcnt(3)
    v_mfma_f32_16x16x32_bf16 v[168:171], a[8:11], v[216:219], v[168:171]
    ds_read_b128 v[208:211], v243 offset:10240
    v_mfma_f32_16x16x32_bf16 v[172:175], a[88:91], v[216:219], v[172:175]
    ds_read_b128 v[212:215], v243 offset:30720
    v_mfma_f32_16x16x32_bf16 v[176:179], v[216:219], a[168:171], v[176:179]
    v_mfma_f32_16x16x32_bf16 v[180:183], v[12:15], v[216:219], v[180:183]
    s_waitcnt lgkmcnt(4)
    v_mfma_f32_16x16x32_bf16 v[184:187], a[8:11], v[220:223], v[184:187]
    v_mfma_f32_16x16x32_bf16 v[188:191], a[88:91], v[220:223], v[188:191]
    v_mfma_f32_16x16x32_bf16 v[192:195], v[220:223], a[168:171], v[192:195]
    v_mfma_f32_16x16x32_bf16 v[196:199], v[12:15], v[220:223], v[196:199]
    s_waitcnt lgkmcnt(3)
    v_mfma_f32_16x16x32_bf16 v[168:171], a[12:15], v[200:203], v[168:171]
    ds_read_b128 v[216:219], v244 offset:10240
    v_mfma_f32_16x16x32_bf16 v[172:175], a[92:95], v[200:203], v[172:175]
    ds_read_b128 v[220:223], v244 offset:30720
    v_mfma_f32_16x16x32_bf16 v[176:179], v[200:203], a[172:175], v[176:179]
    v_mfma_f32_16x16x32_bf16 v[180:183], v[16:19], v[200:203], v[180:183]
    s_waitcnt lgkmcnt(4)
    v_mfma_f32_16x16x32_bf16 v[184:187], a[12:15], v[204:207], v[184:187]
    v_mfma_f32_16x16x32_bf16 v[188:191], a[92:95], v[204:207], v[188:191]
    v_mfma_f32_16x16x32_bf16 v[192:195], v[204:207], a[172:175], v[192:195]
    v_mfma_f32_16x16x32_bf16 v[196:199], v[16:19], v[204:207], v[196:199]
    s_waitcnt vmcnt(6)
    s_cmp_lg_u32 s73, 0
    s_cbranch_scc1 L_Ball
    s_waitcnt vmcnt(0)
L_Ball:
    s_barrier
    s_waitcnt lgkmcnt(3)
    v_mfma_f32_16x16x32_bf16 v[168:171], a[16:19], v[208:211], v[168:171]
    ds_read_b128 v[200:203], v243 offset:11264
    v_mfma_f32_16x16x32_bf16 v[172:175], a[96:99], v[208:211], v[172:175]
    ds_read_b128 v[204:207], v243 offset:31744
    v_mfma_f32_16x16x32_bf16 v[176:179], v[208:211], a[176:179], v[176:179]
    v_mfma_f32_16x16x32_bf16 v[180:183], v[20:23], v[208:211], v[180:183]
    s_waitcnt lgkmcnt(4)
    v_mfma_f32_16x16x32_bf16 v[184:187], a[16:19], v[212:215], v[184:187]
    v_mfma_f32_16x16x32_bf16 v[188:191], a[96:99], v[212:215], v[188:191]
    v_mfma_f32_16x16x32_bf16 v[192:195], v[212:215], a[176:179], v[192:195]
    v_mfma_f32_16x16x32_bf16 v[196:199], v[20:23], v[212:215], v[196:199]
    s_waitcnt lgkmcnt(3)
    v_mfma_f32_16x16x32_bf16 v[168:171], a[20:23], v[216:219], v[168:171]
    ds_read_b128 v[208:211], v244 offset:11264
    v_mfma_f32_16x16x32_bf16 v[172:175], a[100:103], v[216:219], v[172:175]
    ds_read_b128 v[212:215], v244 offset:31744
    v_mfma_f32_16x16x32_bf16 v[176:179], v[216:219], a[180:183], v[176:179]
    v_mfma_f32_16x16x32_bf16 v[180:183], v[24:27], v[216:219], v[180:183]
    s_waitcnt lgkmcnt(4)
    v_mfma_f32_16x16x32_bf16 v[184:187], a[20:23], v[220:223], v[184:187]
    v_mfma_f32_16x16x32_bf16 v[188:191], a[100:103], v[220:223], v[188:191]
    v_mfma_f32_16x16x32_bf16 v[192:195], v[220:223], a[180:183], v[192:195]
    v_mfma_f32_16x16x32_bf16 v[196:199], v[24:27], v[220:223], v[196:199]
    s_waitcnt lgkmcnt(3)
    v_mfma_f32_16x16x32_bf16 v[168:171], a[24:27], v[200:203], v[168:171]
    ds_read_b128 v[216:219], v243 offset:12288
    v_mfma_f32_16x16x32_bf16 v[172:175], a[104:107], v[200:203], v[172:175]
    ds_read_b128 v[220:223], v243 offset:32768
    v_mfma_f32_16x16x32_bf16 v[176:179], v[200:203], a[184:187], v[176:179]
    v_mfma_f32_16x16x32_bf16 v[180:183], v[28:31], v[200:203], v[180:183]
    s_waitcnt lgkmcnt(4)
    v_mfma_f32_16x16x32_bf16 v[184:187], a[24:27], v[204:207], v[184:187]
    v_mfma_f32_16x16x32_bf16 v[188:191], a[104:107], v[204:207], v[188:191]
    v_mfma_f32_16x16x32_bf16 v[192:195], v[204:207], a[184:187], v[192:195]
    v_mfma_f32_16x16x32_bf16 v[196:199], v[28:31], v[204:207], v[196:199]
    s_waitcnt lgkmcnt(3)
    v_mfma_f32_16x16x32_bf16 v[168:171], a[28:31], v[208:211], v[168:171]
    ds_read_b128 v[200:203], v244 offset:12288
    v_mfma_f32_16x16x32_bf16 v[172:175], a[108:111], v[208:211], v[172:175]
    ds_read_b128 v[204:207], v244 offset:32768
    v_mfma_f32_16x16x32_bf16 v[176:179], v[208:211], a[188:191], v[176:179]
    v_mfma_f32_16x16x32_bf16 v[180:183], v[32:35], v[208:211], v[180:183]
    s_waitcnt lgkmcnt(4)
    v_mfma_f32_16x16x32_bf16 v[184:187], a[28:31], v[212:215], v[184:187]
    v_mfma_f32_16x16x32_bf16 v[188:191], a[108:111], v[212:215], v[188:191]
    v_mfma_f32_16x16x32_bf16 v[192:195], v[212:215], a[188:191], v[192:195]
    v_mfma_f32_16x16x32_bf16 v[196:199], v[32:35], v[212:215], v[196:199]
    s_cmp_eq_u32 s73, 0
    s_cbranch_scc1 L_Bnofl
    s_waitcnt vmcnt(0)
    v_mov_b32 v2, s62
    s_mov_b64 exec, 1
    buffer_store_dword v2, off, s[4:7], s63 sc1
    buffer_store_dword v2, off, s[4:7], s3
    s_mov_b64 exec, -1
L_Bnofl:
    s_waitcnt lgkmcnt(3)
    v_mfma_f32_16x16x32_bf16 v[168:171], a[32:35], v[216:219], v[168:171]
    ds_read_b128 v[208:211], v243 offset:13312
    v_mfma_f32_16x16x32_bf16 v[172:175], a[112:115], v[216:219], v[172:175]
    ds_read_b128 v[212:215], v243 offset:33792
    v_mfma_f32_16x16x32_bf16 v[176:179], v[216:219], a[192:195], v[176:179]
    v_mfma_f32_16x16x32_bf16 v[180:183], v[36:39], v[216:219], v[180:183]
    s_waitcnt lgkmcnt(4)
    v_mfma_f32_16x16x32_bf16 v[184:187], a[32:35], v[220:223], v[184:187]
    v_mfma_f32_16x16x32_bf16 v[188:191], a[112:115], v[220:223], v[188:191]
    v_mfma_f32_16x16x32_bf16 v[192:195], v[220:223], a[192:195], v[192:195]
    v_mfma_f32_16x16x32_bf16 v[196:199], v[36:39], v[220:223], v[196:199]
    s_waitcnt lgkmcnt(3)
    v_mfma_f32_16x16x32_bf16 v[168:171], a[36:39], v[200:203], v[168:171]
    ds_read_b128 v[216:219], v244 offset:13312
    v_mfma_f32_16x16x32_bf16 v[172:175], a[116:119], v[200:203], v[172:175]
    ds_read_b128 v[220:223], v244 offset:33792
    v_mfma_f32_16x16x32_bf16 v[176:179], v[200:203], a[196:199], v[176:179]
    v_mfma_f32_16x16x32_bf16 v[180:183], v[40:43], v[200:203], v[180:183]
    s_waitcnt lgkmcnt(4)
    v_mfma_f32_16x16x32_bf16 v[184:187], a[36:39], v[204:207], v[184:187]
    v_mfma_f32_16x16x32_bf16 v[188:191], a[116:119], v[204:207], v[188:191]
    v_mfma_f32_16x16x32_bf16 v[192:195], v[204:207], a[196:199], v[192:195]
    v_mfma_f32_16x16x32_bf16 v[196:199], v[40:43], v[204:207], v[196:199]
    s_waitcnt lgkmcnt(3)
    v_mfma_f32_16x16x32_bf16 v[168:171], a[40:43], v[208:211], v[168:171]
    ds_read_b128 v[200:203], v243 offset:14336
    v_mfma_f32_16x16x32_bf16 v[172:175], a[120:123], v[208:211], v[172:175]
    ds_read_b128 v[204:207], v243 offset:34816
    v_mfma_f32_16x16x32_bf16 v[176:179], v[208:211], a[200:203], v[176:179]
    v_mfma_f32_16x16x32_bf16 v[180:183], v[44:47], v[208:211], v[180:183]
    s_waitcnt lgkmcnt(4)
    v_mfma_f32_16x16x32_bf16 v[184:187], a[40:43], v[212:215], v[184:187]
    v_mfma_f32_16x16x32_bf16 v[188:191], a[120:123], v[212:215], v[188:191]
    v_mfma_f32_16x16x32_bf16 v[192:195], v[212:215], a[200:203], v[192:195]
    v_mfma_f32_16x16x32_bf16 v[196:199], v[44:47], v[212:215], v[196:199]
    s_waitcnt lgkmcnt(3)
    v_mfma_f32_16x16x32_bf16 v[168:171], a[44:47], v[216:219], v[168:171]
    ds_read_b128 v[208:211], v244 offset:14336
    v_mfma_f32_16x16x32_bf16 v[172:175], a[124:127], v[216:219], v[172:175]
    ds_read_b128 v[212:215], v244 offset:34816
    v_mfma_f32_16x16x32_bf16 v[176:179], v[216:219], a[204:207], v[176:179]
    v_mfma_f32_16x16x32_bf16 v[180:183], v[48:51], v[216:219], v[180:183]
    s_waitcnt lgkmcnt(4)
    v_mfma_f32_16x16x32_bf16 v[184:187], a[44:47], v[220:223], v[184:187]
    v_mfma_f32_16x16x32_bf16 v[188:191], a[124:127], v[220:223], v[188:191]
    v_mfma_f32_16x16x32_bf16 v[192:195], v[220:223], a[204:207], v[192:195]
    v_mfma_f32_16x16x32_bf16 v[196:199], v[48:51], v[220:223], v[196:199]
    s_waitcnt lgkmcnt(3)
    v_mfma_f32_16x16x32_bf16 v[168:171], a[48:51], v[200:203], v[168:171]
    ds_read_b128 v[216:219], v243 offset:15360
    v_mfma_f32_16x16x32_bf16 v[172:175], a[128:131], v[200:203], v[172:175]
    ds_read_b128 v[220:223], v243 offset:35840
    v_mfma_f32_16x16x32_bf16 v[176:179], v[200:203], a[208:211], v[176:179]
    v_mfma_f32_16x16x32_bf16 v[180:183], v[52:55], v[200:203], v[180:183]
    s_waitcnt lgkmcnt(4)
    v_mfma_f32_16x16x32_bf16 v[184:187], a[48:51], v[204:207], v[184:187]
    v_mfma_f32_16x16x32_bf16 v[188:191], a[128:131], v[204:207], v[188:191]
    v_mfma_f32_16x16x32_bf16 v[192:195], v[204:207], a[208:211], v[192:195]
    v_mfma_f32_16x16x32_bf16 v[196:199], v[52:55], v[204:207], v[196:199]
    s_waitcnt lgkmcnt(3)
    v_mfma_f32_16x16x32_bf16 v[168:171], a[52:55], v[208:211], v[168:171]
    ds_read_b128 v[200:203], v244 offset:15360
    v_mfma_f32_16x16x32_bf16 v[172:175], a[132:135], v[208:211], v[172:175]
    ds_read_b128 v[204:207], v244 offset:35840
    v_mfma_f32_16x16x32_bf16 v[176:179], v[208:211], a[212:215], v[176:179]
    v_mfma_f32_16x16x32_bf16 v[180:183], v[56:59], v[208:211], v[180:183]
    s_waitcnt lgkmcnt(4)
    v_mfma_f32_16x16x32_bf16 v[184:187], a[52:55], v[212:215], v[184:187]
    v_mfma_f32_16x16x32_bf16 v[188:191], a[132:135], v[212:215], v[188:191]
    v_mfma_f32_16x16x32_bf16 v[192:195], v[212:215], a[212:215], v[192:195]
    v_mfma_f32_16x16x32_bf16 v[196:199], v[56:59], v[212:215], v[196:199]
    s_waitcnt lgkmcnt(3)
    v_mfma_f32_16x16x32_bf16 v[168:171], a[56:59], v[216:219], v[168:171]
    ds_read_b128 v[208:211], v243 offset:16384
    v_mfma_f32_16x16x32_bf16 v[172:175], a[136:139], v[216:219], v[172:175]
    ds_read_b128 v[212:215], v243 offset:36864
    v_mfma_f32_16x16x32_bf16 v[176:179], v[216:219], a[216:219], v[176:179]
    v_mfma_f32_16x16x32_bf16 v[180:183], v[60:63], v[216:219], v[180:183]
    s_waitcnt lgkmcnt(4)
    v_mfma_f32_16x16x32_bf16 v[184:187], a[56:59], v[220:223], v[184:187]
    v_mfma_f32_16x16x32_bf16 v[188:191], a[136:139], v[220:223], v[188:191]
    v_mfma_f32_16x16x32_bf16 v[192:195], v[220:223], a[216:219], v[192:195]
    v_mfma_f32_16x16x32_bf16 v[196:199], v[60:63], v[220:223], v[196:199]
    s_waitcnt lgkmcnt(3)
    v_mfma_f32_16x16x32_bf16 v[168:171], a[60:63], v[200:203], v[168:171]
    ds_read_b128 v[216:219], v244 offset:16384
    v_mfma_f32_16x16x32_bf16 v[172:175], a[140:143], v[200:203], v[172:175]
    ds_read_b128 v[220:223], v244 offset:36864
    v_mfma_f32_16x16x32_bf16 v[176:179], v[200:203], a[220:223], v[176:179]
    v_mfma_f32_16x16x32_bf16 v[180:183], v[64:67], v[200:203], v[180:183]
    s_waitcnt lgkmcnt(4)
    v_mfma_f32_16x16x32_bf16 v[184:187], a[60:63], v[204:207], v[184:187]
    v_mfma_f32_16x16x32_bf16 v[188:191], a[140:143], v[204:207], v[188:191]
    v_mfma_f32_16x16x32_bf16 v[192:195], v[204:207], a[220:223], v[192:195]
    v_mfma_f32_16x16x32_bf16 v[196:199], v[64:67], v[204:207], v[196:199]
    s_waitcnt lgkmcnt(3)
    v_mfma_f32_16x16x32_bf16 v[168:171], a[64:67], v[208:211], v[168:171]
    ds_read_b128 v[200:203], v243 offset:17408
    v_mfma_f32_16x16x32_bf16 v[172:175], a[144:147], v[208:211], v[172:175]
    ds_read_b128 v[204:207], v243 offset:37888
    v_mfma_f32_16x16x32_bf16 v[176:179], v[208:211], a[224:227], v[176:179]
    v_mfma_f32_16x16x32_bf16 v[180:183], v[68:71], v[208:211], v[180:183]
    s_waitcnt lgkmcnt(4)
    v_mfma_f32_16x16x32_bf16 v[184:187], a[64:67], v[212:215], v[184:187]
    v_mfma_f32_16x16x32_bf16 v[188:191], a[144:147], v[212:215], v[188:191]
    v_mfma_f32_16x16x32_bf16 v[192:195], v[212:215], a[224:227], v[192:195]
    v_mfma_f32_16x16x32_bf16 v[196:199], v[68:71], v[212:215], v[196:199]
    s_waitcnt lgkmcnt(3)
    v_mfma_f32_16x16x32_bf16 v[168:171], a[68:71], v[216:219], v[168:171]
    ds_read_b128 v[208:211], v244 offset:17408
    v_mfma_f32_16x16x32_bf16 v[172:175], a[148:151], v[216:219], v[172:175]
    ds_read_b128 v[212:215], v244 offset:37888
    v_mfma_f32_16x16x32_bf16 v[176:179], v[216:219], a[228:231], v[176:179]
    v_mfma_f32_16x16x32_bf16 v[180:183], v[72:75], v[216:219], v[180:183]
    s_waitcnt lgkmcnt(4)
    v_mfma_f32_16x16x32_bf16 v[184:187], a[68:71], v[220:223], v[184:187]
    v_mfma_f32_16x16x32_bf16 v[188:191], a[148:151], v[220:223], v[188:191]
    v_mfma_f32_16x16x32_bf16 v[192:195], v[220:223], a[228:231], v[192:195]
    v_mfma_f32_16x16x32_bf16 v[196:199], v[72:75], v[220:223], v[196:199]
    s_waitcnt lgkmcnt(3)
    v_mfma_f32_16x16x32_bf16 v[168:171], a[72:75], v[200:203], v[168:171]
    v_mfma_f32_16x16x32_bf16 v[172:175], a[152:155], v[200:203], v[172:175]
    v_mfma_f32_16x16x32_bf16 v[176:179], v[200:203], a[232:235], v[176:179]
    v_mfma_f32_16x16x32_bf16 v[180:183], v[76:79], v[200:203], v[180:183]
    s_waitcnt lgkmcnt(2)
    v_mfma_f32_16x16x32_bf16 v[184:187], a[72:75], v[204:207], v[184:187]
    v_mfma_f32_16x16x32_bf16 v[188:191], a[152:155], v[204:207], v[188:191]
    v_mfma_f32_16x16x32_bf16 v[192:195], v[204:207], a[232:235], v[192:195]
    v_mfma_f32_16x16x32_bf16 v[196:199], v[76:79], v[204:207], v[196:199]
    s_waitcnt lgkmcnt(1)
    v_mfma_f32_16x16x32_bf16 v[168:171], a[76:79], v[208:211], v[168:171]
    v_mfma_f32_16x16x32_bf16 v[172:175], a[156:159], v[208:211], v[172:175]
    v_mfma_f32_16x16x32_bf16 v[176:179], v[208:211], a[236:239], v[176:179]
    v_mfma_f32_16x16x32_bf16 v[180:183], v[80:83], v[208:211], v[180:183]
    s_waitcnt lgkmcnt(0)
    v_mfma_f32_16x16x32_bf16 v[184:187], a[76:79], v[212:215], v[184:187]
    v_mfma_f32_16x16x32_bf16 v[188:191], a[156:159], v[212:215], v[188:191]
    v_mfma_f32_16x16x32_bf16 v[192:195], v[212:215], a[236:239], v[192:195]
    v_mfma_f32_16x16x32_bf16 v[196:199], v[80:83], v[212:215], v[196:199]
    buffer_load_dword v252, v251, s[4:7], 0 offen sc1
    v_add_u32 v243, s76, v243
    v_add_u32 v244, s76, v244
    s_sub_u32 s76, 0, s76
    v_mfma_f32_16x16x4_f32 v[216:219], v182, v240, 0
    v_cvt_pk_bf16_f32 v200, v168, v169
    v_cvt_pk_bf16_f32 v201, v170, v171
    v_cvt_pk_bf16_f32 v202, v180, 0
    v_mov_b32 v203, 0
    v_cvt_pk_bf16_f32 v208, v172, v173
    v_cvt_pk_bf16_f32 v209, v174, v175
    v_cvt_pk_bf16_f32 v210, v181, 0
    v_mov_b32 v211, 0
    v_cvt_pk_bf16_f32 v230, v176, v177
    v_cvt_pk_bf16_f32 v231, v178, v179
    ds_read_b128 v[168:171], v246 offset:5120
    ds_read_b128 v[172:175], v245 offset:6144
    v_mfma_f32_16x16x4_f32 v[220:223], v198, v240, 0
    v_cvt_pk_bf16_f32 v204, v184, v185
    v_cvt_pk_bf16_f32 v205, v186, v187
    v_cvt_pk_bf16_f32 v206, v196, 0
    v_mov_b32 v207, 0
    v_cvt_pk_bf16_f32 v212, v188, v189
    v_cvt_pk_bf16_f32 v213, v190, v191
    v_cvt_pk_bf16_f32 v214, v197, 0
    v_mov_b32 v215, 0
    v_cvt_pk_bf16_f32 v232, v192, v193
    v_cvt_pk_bf16_f32 v233, v194, v195
    ds_read_b128 v[184:187], v245 offset:5120
    ds_read_b128 v[188:191], v245 offset:6144
    v_cvt_pk_bf16_f32 v236, v216, v217
    v_cvt_pk_bf16_f32 v237, v218, v219
    v_or_b32 v236, v241, v236
    v_or_b32 v237, v241, v237
    v_cvt_pk_bf16_f32 v238, v220, v221
    v_cvt_pk_bf16_f32 v239, v222, v223
    v_or_b32 v238, v241, v238
    v_or_b32 v239, v241, v239
    s_waitcnt lgkmcnt(3)
    v_mfma_f32_16x16x32_bf16 v[168:171], v[224:227], v[200:203], v[168:171]
    s_waitcnt lgkmcnt(2)
    v_mfma_f32_16x16x32_bf16 v[172:175], v[208:211], v[200:203], v[172:175]
    s_waitcnt lgkmcnt(1)
    v_mfma_f32_16x16x32_bf16 v[184:187], v[208:211], v[204:207], v[184:187]
    s_waitcnt lgkmcnt(0)
    v_mfma_f32_16x16x32_bf16 v[188:191], v[212:215], v[204:207], v[188:191]
    v_mov_b32 v246, v245
    v_mov_b32 v224, v212
    v_mov_b32 v225, v213
    v_mov_b32 v226, v214
    v_max3_f32 v216, v168, v169, v170
    s_nop 0
    v_max3_f32 v218, v184, v185, v186
    v_max3_f32 v217, v171, v172, v173
    v_max3_f32 v219, v187, v188, v189
    v_max3_f32 v216, v216, v174, v175
    v_max3_f32 v218, v218, v190, v191
    v_max_f32 v216, v216, v217
    v_max_f32 v218, v218, v219
    v_mov_b32 v217, v216
    v_mov_b32 v219, v218
    s_nop 0
    v_permlane16_swap_b32 v216, v217
    v_permlane16_swap_b32 v218, v219
    v_max_f32 v216, v216, v217
    v_max_f32 v218, v218, v219
    v_mov_b32 v217, v216
    v_mov_b32 v219, v218
    s_nop 0
    v_permlane32_swap_b32 v216, v217
    v_permlane32_swap_b32 v218, v219
    v_max_f32 v216, v216, v217
    v_max_f32 v218, v218, v219
    v_mul_f32 v216, s75, v216
    v_mul_f32 v218, s75, v218
    v_fma_f32 v168, v168, s75, -v216
    v_fma_f32 v184, v184, s75, -v218
    v_fma_f32 v169, v169, s75, -v216
    v_fma_f32 v185, v185, s75, -v218
    v_fma_f32 v170, v170, s75, -v216
    v_fma_f32 v186, v186, s75, -v218
    v_fma_f32 v171, v171, s75, -v216
    v_fma_f32 v187, v187, s75, -v218
    v_fma_f32 v172, v172, s75, -v216
    v_fma_f32 v188, v188, s75, -v218
    v_fma_f32 v173, v173, s75, -v216
    v_fma_f32 v189, v189, s75, -v218
    v_fma_f32 v174, v174, s75, -v216
    v_fma_f32 v190, v190, s75, -v218
    v_fma_f32 v175, v175, s75, -v216
    v_fma_f32 v191, v191, s75, -v218
    v_exp_f32 v168, v168
    v_exp_f32 v184, v184
    v_exp_f32 v169, v169
    v_exp_f32 v185, v185
    v_exp_f32 v170, v170
    v_exp_f32 v186, v186
    v_exp_f32 v171, v171
    v_exp_f32 v187, v187
    v_exp_f32 v172, v172
    v_exp_f32 v188, v188
    v_exp_f32 v173, v173
    v_exp_f32 v189, v189
    v_exp_f32 v174, v174
    v_exp_f32 v190, v190
    v_exp_f32 v175, v175
    v_exp_f32 v191, v191
    v_cvt_pk_bf16_f32 v168, v168, v169
    v_cvt_pk_bf16_f32 v184, v184, v185
    v_cvt_pk_bf16_f32 v169, v170, v171
    v_cvt_pk_bf16_f32 v185, v186, v187
    v_cvt_pk_bf16_f32 v170, v172, v173
    v_cvt_pk_bf16_f32 v186, v188, v189
    v_cvt_pk_bf16_f32 v171, v174, v175
    v_cvt_pk_bf16_f32 v187, v190, v191
    s_nop 0
    v_mfma_f32_16x16x32_bf16 v[180:183], v[234:237], v[168:171], 0
    v_mfma_f32_16x16x32_bf16 v[196:199], v[236:239], v[184:187], 0
    v_mfma_f32_16x16x32_bf16 v[176:179], v[228:231], v[168:171], 0
    v_mfma_f32_16x16x32_bf16 v[192:195], v[230:233], v[184:187], 0
    v_mov_b32 v228, v232
    v_mov_b32 v229, v233
    v_mov_b32 v234, v238
    v_mov_b32 v235, v239
    s_add_u32 s65, s62, 2
    v_rcp_f32 v181, v181
    v_rcp_f32 v197, v197
    v_mul_f32 v176, v176, v181
    v_mul_f32 v192, v192, v197
    v_mul_f32 v177, v177, v181
    v_mul_f32 v193, v193, v197
    v_mul_f32 v178, v178, v181
    v_mul_f32 v194, v194, v197
    v_mul_f32 v179, v179, v181
    v_mul_f32 v195, v195, v197
    v_mul_f32 v180, v180, v181
    v_mul_f32 v196, v196, v197
    v_cvt_pk_bf16_f32 v168, v176, v177
    v_cvt_pk_bf16_f32 v184, v192, v193
    v_cvt_pk_bf16_f32 v169, v178, v179
    v_cvt_pk_bf16_f32 v185, v194, v195
    v_cvt_pk_bf16_f32 v170, v180, v180
    v_cvt_pk_bf16_f32 v186, v196, v196
    ds_write_b64 v247, v[168:169] offset:0
    ds_write_b64 v247, v[184:185] offset:2048
    ds_write_b16 v248, v170 offset:4096
    ds_write_b16 v248, v186 offset:4608
    v_lshrrev_b32 v3, 1, v245
    s_waitcnt lgkmcnt(0)
    s_barrier
    ds_read_b64 v[208:209], v3 offset:4096
    ds_read_b128 v[200:203], v245 offset:0
    ds_read_b128 v[204:207], v245 offset:1024
    ds_read_b64 v[218:219], v3 offset:4608
    ds_read_b128 v[210:213], v245 offset:2048
    ds_read_b128 v[214:217], v245 offset:3072
    s_waitcnt vmcnt(0)
    v_cmp_gt_u32 vcc, s65, v252
    s_cmp_eq_u64 vcc, 0
    s_cselect_b32 s73, 1, 0
    s_add_u32 s65, s71, 5120
    s_waitcnt lgkmcnt(5)
    v_mfma_f32_16x16x16_bf16 v[168:171], a[240:241], v[208:209], 0
    v_mfma_f32_16x16x16_bf16 v[172:175], a[242:243], v[208:209], 0
    s_cbranch_vccnz Lnp_97
    s_add_u32 m0, s72, 8192
    s_nop 0
    buffer_load_dwordx4 v242, s[4:7], s70 offen offset:0 sc1 lds
Lnp_97:
    v_mfma_f32_16x16x16_bf16 v[176:179], a[244:245], v[208:209], 0
    v_mfma_f32_16x16x16_bf16 v[180:183], a[246:247], v[208:209], 0
    v_mfma_f32_16x16x16_bf16 v[220:223], a[248:249], v[208:209], 0
    s_cbranch_vccnz Lnp_98
    s_add_u32 m0, s72, 9088
    s_nop 0
    buffer_load_dwordx4 v242, s[4:7], s70 offen offset:128 sc1 lds
Lnp_98:
    s_waitcnt lgkmcnt(4)
    v_mfma_f32_16x16x32_bf16 v[168:171], v[84:87], v[200:203], v[168:171]
    v_mfma_f32_16x16x32_bf16 v[172:175], v[92:95], v[200:203], v[172:175]
    v_mfma_f32_16x16x32_bf16 v[176:179], v[100:103], v[200:203], v[176:179]
    s_cbranch_vccnz Lnp_99
    s_add_u32 m0, s72, 9984
    s_nop 0
    buffer_load_dwordx4 v242, s[4:7], s70 offen offset:256 sc1 lds
Lnp_99:
    v_mfma_f32_16x16x32_bf16 v[180:183], v[108:111], v[200:203], v[180:183]
    v_mfma_f32_16x16x32_bf16 v[220:223], v[116:119], v[200:203], v[220:223]
    s_waitcnt lgkmcnt(3)
    v_mfma_f32_16x16x32_bf16 v[168:171], v[88:91], v[204:207], v[168:171]
    s_cbranch_vccnz Lnp_100
    s_add_u32 m0, s72, 10880
    s_nop 0
    buffer_load_dwordx4 v242, s[4:7], s70 offen offset:384 sc1 lds
Lnp_100:
    v_mfma_f32_16x16x32_bf16 v[172:175], v[96:99], v[204:207], v[172:175]
    v_mfma_f32_16x16x32_bf16 v[176:179], v[104:107], v[204:207], v[176:179]
    v_mfma_f32_16x16x32_bf16 v[180:183], v[112:115], v[204:207], v[180:183]
    s_cbranch_vccnz Lnp_101
    s_add_u32 m0, s72, 11776
    s_nop 0
    buffer_load_dwordx4 v242, s[4:7], s70 offen offset:512 sc1 lds
Lnp_101:
    v_mfma_f32_16x16x32_bf16 v[220:223], v[120:123], v[204:207], v[220:223]
    v_mfma_f32_16x16x16_bf16 v[184:187], a[250:251], v[208:209], 0
    v_mfma_f32_16x16x16_bf16 v[188:191], a[252:253], v[208:209], 0
    s_cbranch_vccnz Lnp_102
    s_add_u32 m0, s72, 12672
    s_nop 0
    buffer_load_dwordx4 v242, s[4:7], s70 offen offset:640 sc1 lds
Lnp_102:
    v_cvt_pk_bf16_f32 v168, v168, v169
    v_mfma_f32_16x16x16_bf16 v[192:195], a[254:255], v[208:209], 0
    v_cvt_pk_bf16_f32 v169, v170, v171
    v_mfma_f32_16x16x16_bf16 v[196:199], v[164:165], v[208:209], 0
    v_cvt_pk_bf16_f32 v170, v172, v173
    v_mfma_f32_16x16x16_bf16 v[252:255], v[166:167], v[208:209], 0
    v_cvt_pk_bf16_f32 v171, v174, v175
    v_mfma_f32_16x16x32_bf16 v[184:187], v[124:127], v[200:203], v[184:187]
    buffer_store_dwordx4 v[168:171], v249, s[4:7], s71 offen offset:0 sc1
    v_mfma_f32_16x16x32_bf16 v[188:191], v[132:135], v[200:203], v[188:191]
    v_cvt_pk_bf16_f32 v176, v176, v177
    v_mfma_f32_16x16x32_bf16 v[192:195], v[140:143], v[200:203], v[192:195]
    s_cbranch_vccnz Lnp_103
    s_add_u32 m0, s72, 13568
    s_nop 0
    buffer_load_dwordx4 v242, s[4:7], s70 offen offset:768 sc1 lds
Lnp_103:
    v_cvt_pk_bf16_f32 v177, v178, v179
    v_mfma_f32_16x16x32_bf16 v[196:199], v[148:151], v[200:203], v[196:199]
    v_cvt_pk_bf16_f32 v178, v180, v181
    v_mfma_f32_16x16x32_bf16 v[252:255], v[156:159], v[200:203], v[252:255]
    v_cvt_pk_bf16_f32 v179, v182, v183
    v_mfma_f32_16x16x32_bf16 v[184:187], v[128:131], v[204:207], v[184:187]
    buffer_store_dwordx4 v[176:179], v249, s[4:7], s71 offen offset:2048 sc1
    v_mfma_f32_16x16x32_bf16 v[188:191], v[136:139], v[204:207], v[188:191]
    v_cvt_pk_bf16_f32 v220, v220, v221
    v_mfma_f32_16x16x32_bf16 v[192:195], v[144:147], v[204:207], v[192:195]
    v_cvt_pk_bf16_f32 v221, v222, v223
    v_mfma_f32_16x16x32_bf16 v[196:199], v[152:155], v[204:207], v[196:199]
    buffer_store_dwordx2 v[220:221], v250, s[4:7], s71 offen offset:0 sc1
    v_mfma_f32_16x16x32_bf16 v[252:255], v[160:163], v[204:207], v[252:255]
    s_waitcnt lgkmcnt(2)
    v_mfma_f32_16x16x16_bf16 v[168:171], a[240:241], v[218:219], 0
    v_mfma_f32_16x16x16_bf16 v[172:175], a[242:243], v[218:219], 0
    s_cbranch_vccnz Lnp_104
    s_add_u32 m0, s72, 14464
    s_nop 0
    buffer_load_dwordx4 v242, s[4:7], s70 offen offset:896 sc1 lds
Lnp_104:
    v_cvt_pk_bf16_f32 v184, v184, v185
    v_mfma_f32_16x16x16_bf16 v[176:179], a[244:245], v[218:219], 0
    v_cvt_pk_bf16_f32 v185, v186, v187
    v_mfma_f32_16x16x16_bf16 v[180:183], a[246:247], v[218:219], 0
    v_cvt_pk_bf16_f32 v186, v188, v189
    v_mfma_f32_16x16x16_bf16 v[220:223], a[248:249], v[218:219], 0
    v_cvt_pk_bf16_f32 v187, v190, v191
    s_waitcnt lgkmcnt(1)
    v_mfma_f32_16x16x32_bf16 v[168:171], v[84:87], v[210:213], v[168:171]
    buffer_store_dwordx4 v[184:187], v249, s[4:7], s65 offen offset:0 sc1
    v_mfma_f32_16x16x32_bf16 v[172:175], v[92:95], v[210:213], v[172:175]
    v_cvt_pk_bf16_f32 v192, v192, v193
    v_mfma_f32_16x16x32_bf16 v[176:179], v[100:103], v[210:213], v[176:179]
    s_cbranch_vccnz Lnp_105
    s_add_u32 m0, s72, 15360
    s_nop 0
    buffer_load_dwordx4 v242, s[4:7], s70 offen offset:1024 sc1 lds
Lnp_105:
    v_cvt_pk_bf16_f32 v193, v194, v195
    v_mfma_f32_16x16x32_bf16 v[180:183], v[108:111], v[210:213], v[180:183]
    v_cvt_pk_bf16_f32 v194, v196, v197
    v_mfma_f32_16x16x32_bf16 v[220:223], v[116:119], v[210:213], v[220:223]
    v_cvt_pk_bf16_f32 v195, v198, v199
    s_waitcnt lgkmcnt(0)
    v_mfma_f32_16x16x32_bf16 v[168:171], v[88:91], v[214:217], v[168:171]
    buffer_store_dwordx4 v[192:195], v249, s[4:7], s65 offen offset:2048 sc1
    v_mfma_f32_16x16x32_bf16 v[172:175], v[96:99], v[214:217], v[172:175]
    v_cvt_pk_bf16_f32 v252, v252, v253
    v_mfma_f32_16x16x32_bf16 v[176:179], v[104:107], v[214:217], v[176:179]
    v_cvt_pk_bf16_f32 v253, v254, v255
    v_mfma_f32_16x16x32_bf16 v[180:183], v[112:115], v[214:217], v[180:183]
    buffer_store_dwordx2 v[252:253], v250, s[4:7], s65 offen offset:0 sc1
    v_mfma_f32_16x16x32_bf16 v[220:223], v[120:123], v[214:217], v[220:223]
    v_mfma_f32_16x16x16_bf16 v[184:187], a[250:251], v[218:219], 0
    v_mfma_f32_16x16x16_bf16 v[188:191], a[252:253], v[218:219], 0
    s_cbranch_vccnz Lnp_106
    s_add_u32 m0, s72, 16256
    s_nop 0
    buffer_load_dwordx4 v242, s[4:7], s70 offen offset:1152 sc1 lds
Lnp_106:
    v_cvt_pk_bf16_f32 v168, v168, v169
    v_mfma_f32_16x16x16_bf16 v[192:195], a[254:255], v[218:219], 0
    v_cvt_pk_bf16_f32 v169, v170, v171
    v_mfma_f32_16x16x16_bf16 v[196:199], v[164:165], v[218:219], 0
    v_cvt_pk_bf16_f32 v170, v172, v173
    v_mfma_f32_16x16x16_bf16 v[252:255], v[166:167], v[218:219], 0
    v_cvt_pk_bf16_f32 v171, v174, v175
    v_mfma_f32_16x16x32_bf16 v[184:187], v[124:127], v[210:213], v[184:187]
    buffer_store_dwordx4 v[168:171], v249, s[4:7], s71 offen offset:1024 sc1
    v_mfma_f32_16x16x32_bf16 v[188:191], v[132:135], v[210:213], v[188:191]
    v_cvt_pk_bf16_f32 v176, v176, v177
    v_mfma_f32_16x16x32_bf16 v[192:195], v[140:143], v[210:213], v[192:195]
    s_cbranch_vccnz Lnp_107
    s_add_u32 s70, s70, 40960
    s_add_u32 s72, s72, s77
    s_sub_u32 s77, 0, s77
Lnp_107:
    v_cvt_pk_bf16_f32 v177, v178, v179
    v_mfma_f32_16x16x32_bf16 v[196:199], v[148:151], v[210:213], v[196:199]
    v_cvt_pk_bf16_f32 v178, v180, v181
    v_mfma_f32_16x16x32_bf16 v[252:255], v[156:159], v[210:213], v[252:255]
    v_cvt_pk_bf16_f32 v179, v182, v183
    v_mfma_f32_16x16x32_bf16 v[184:187], v[128:131], v[214:217], v[184:187]
    buffer_store_dwordx4 v[176:179], v249, s[4:7], s71 offen offset:3072 sc1
    v_mfma_f32_16x16x32_bf16 v[188:191], v[136:139], v[214:217], v[188:191]
    v_cvt_pk_bf16_f32 v220, v220, v221
    v_mfma_f32_16x16x32_bf16 v[192:195], v[144:147], v[214:217], v[192:195]
    v_cvt_pk_bf16_f32 v221, v222, v223
    v_mfma_f32_16x16x32_bf16 v[196:199], v[152:155], v[214:217], v[196:199]
    buffer_store_dwordx2 v[220:221], v250, s[4:7], s71 offen offset:512 sc1
    v_mfma_f32_16x16x32_bf16 v[252:255], v[160:163], v[214:217], v[252:255]
    v_cvt_pk_bf16_f32 v184, v184, v185
    v_cvt_pk_bf16_f32 v185, v186, v187
    v_cvt_pk_bf16_f32 v186, v188, v189
    v_cvt_pk_bf16_f32 v187, v190, v191
    buffer_store_dwordx4 v[184:187], v249, s[4:7], s65 offen offset:1024 sc1
    v_cvt_pk_bf16_f32 v192, v192, v193
    v_cvt_pk_bf16_f32 v193, v194, v195
    v_cvt_pk_bf16_f32 v194, v196, v197
    v_cvt_pk_bf16_f32 v195, v198, v199
    buffer_store_dwordx4 v[192:195], v249, s[4:7], s65 offen offset:3072 sc1
    v_cvt_pk_bf16_f32 v252, v252, v253
    v_cvt_pk_bf16_f32 v253, v254, v255
    buffer_store_dwordx2 v[252:253], v250, s[4:7], s65 offen offset:512 sc1
    s_add_u32 s71, s71, 327680
    s_add_u32 s62, s62, 1
    s_cmp_lt_u32 s62, 64
    s_cbranch_scc1 L_Bseg
    s_waitcnt vmcnt(0)
    v_mov_b32 v2, s62
    s_mov_b64 exec, 1
    buffer_store_dword v2, off, s[4:7], s63 sc1
    buffer_store_dword v2, off, s[4:7], s3
    s_mov_b64 exec, -1
    s_endpgm
Lgrty_93:
    s_sleep 16
    buffer_load_dword v2, off, s[8:11], 0 offset:132 sc1
    s_sub_u32 s61, s61, 1
    s_mov_b32 s67, 1
    s_cbranch_scc1 L_fail
    s_branch Lgchk_92
Lfrty_96:
    s_sleep 4
    buffer_load_dword v252, v251, s[4:7], 0 offen sc1
    s_sub_u32 s61, s61, 1
    s_mov_b32 s67, 30
    s_cbranch_scc1 L_fail
    s_waitcnt vmcnt(0)
    s_branch Lfchk_95
L_roleR:
    s_cmp_lg_u32 s68, 0
    s_cbranch_scc1 Larr0_108
    s_waitcnt vmcnt(0)
    s_barrier
    s_cmp_lg_u32 s60, 0
    s_cbranch_scc1 Lcnt_109
    s_mov_b64 exec, 1
    v_mov_b32 v2, 1
    buffer_atomic_add v2, off, s[8:11], 0 offset:4 sc0
    v_mov_b32 v3, 0x80000000
    s_waitcnt vmcnt(0)
    v_cmp_ne_u32 vcc, 255, v2
    s_nop 1
    v_cndmask_b32 v3, 4, v3, vcc
    buffer_store_dword v2, v3, s[8:11], 0 offen offset:128 sc1
    s_mov_b64 exec, -1
Lcnt_109:
Larr0_108:
    s_and_b32 s64, s59, 1
    s_lshl_b32 s74, s68, 1
    s_add_u32 s74, s74, s64
    s_cmp_eq_u32 s74, 0
    s_cselect_b32 s16, s32, s56
    s_cselect_b32 s17, s33, s57
    s_cselect_b32 s18, 2621440, s6
    s_mov_b32 s19, 0x20000
    s_cmp_eq_u32 s74, 3
    s_cselect_b32 s20, s52, s56
    s_cselect_b32 s21, s53, s57
    s_cselect_b32 s22, 2621440, s6
    s_mov_b32 s23, 0x20000
    s_mov_b32 s71, 0
    s_mov_b32 s72, 29360128
    s_mov_b32 s73, 23068672
    s_cmp_eq_u32 s74, 1
    s_cselect_b32 s71, 29360128, s71
    s_cselect_b32 s72, 35651584, s72
    s_cselect_b32 s73, 19398656, s73
    s_cmp_eq_u32 s74, 2
    s_cselect_b32 s71, 35651584, s71
    s_cselect_b32 s72, 31981568, s72
    s_cselect_b32 s73, 25690112, s73
    s_cmp_eq_u32 s74, 3
    s_cselect_b32 s71, 31981568, s71
    s_cselect_b32 s72, 0, s72
    s_cselect_b32 s73, 0, s73
    s_mov_b32 s70, 134217728
    s_cmp_eq_u32 s64, 0
    s_cselect_b32 s70, 92274688, s70
    s_cselect_b32 s65, 24, 28
    s_cselect_b32 s66, 15, 7
    s_mul_i32 s64, s68, 20971520
    s_add_u32 s70, s70, s64
    v_lshrrev_b32 v96, 5, v0
    s_lshl_b32 s64, s69, 3
    v_add_u32 v96, s64, v96
    v_and_b32 v97, 31, v0
    v_mul_u32_u24 v98, 1280, v96
    v_lshl_add_u32 v122, v97, 4, v98
    v_lshl_add_u32 v123, v97, 3, v98
    v_lshrrev_b32 v98, 2, v97
    v_mul_u32_u24 v98, 5120, v98
    v_and_b32 v99, 3, v97
    v_lshlrev_b32 v99, 3, v99
    v_lshl_add_u32 v99, v96, 5, v99
    v_lshl_add_u32 v120, v99, 1, v98
    v_add_u32 v121, v99, v98
    v_add_u32 v121, 4096, v121
    s_mov_b32 s75, 0x3f80
    s_mov_b32 s76, 0x3f800000
    v_bfe_u32 v98, v0, 4, 2
    v_lshlrev_b32 v98, 5, v98
    v_add_u32 v98, s65, v98
    v_and_b32 v124, s66, v0
    v_lshl_add_u32 v124, v98, 2, v124
    v_lshlrev_b32 v124, 7, v124
    v_add_u32 v124, 8388608, v124
    s_lshl_b32 s64, s68, 16
    v_add_u32 v124, s64, v124
    v_bfe_u32 v98, v0, 4, 2
    v_cmp_eq_u32 vcc, s69, v98
    s_nop 1
    v_cndmask_b32 v98, 0, 1, vcc
    v_lshl_add_u32 v124, v98, 17, v124
    s_cmp_lg_u32 s60, 0
    s_cbranch_scc1 Lgskip_112
    buffer_load_dword v2, off, s[8:11], 0 offset:132 sc1
Lgchk_110:
    s_waitcnt vmcnt(0)
    v_cmp_eq_u32 vcc, 0, v2
    s_cbranch_vccnz Lgrty_111
Lgskip_112:
    s_waitcnt lgkmcnt(0)
    s_barrier
L_Rseg:
    s_add_u32 s65, s62, 1
    buffer_load_dword v126, v124, s[4:7], 0 offen sc1
Lfchk_113:
    s_waitcnt vmcnt(0)
    v_cmp_gt_u32 vcc, s65, v126
    s_cbranch_vccnz Lfrty_114
    buffer_load_dwordx4 v[84:87], v122, s[16:19], s71 offen sc1
    buffer_load_dwordx4 v[88:91], v122, s[16:19], s71 offen offset:512 sc1
    buffer_load_dwordx2 v[92:93], v123, s[16:19], s71 offen offset:1024 sc1
    buffer_load_dwordx4 v[4:7], v120, s[4:7], s70 offen sc1
    buffer_load_dwordx4 v[8:11], v120, s[4:7], s70 offen offset:2048 sc1
    buffer_load_dwordx2 v[12:13], v121, s[4:7], s70 offen sc1
    s_add_u32 s70, s70, 40960
    buffer_load_dwordx4 v[14:17], v120, s[4:7], s70 offen sc1
    buffer_load_dwordx4 v[18:21], v120, s[4:7], s70 offen offset:2048 sc1
    buffer_load_dwordx2 v[22:23], v121, s[4:7], s70 offen sc1
    s_add_u32 s70, s70, 40960
    buffer_load_dwordx4 v[24:27], v120, s[4:7], s70 offen sc1
    buffer_load_dwordx4 v[28:31], v120, s[4:7], s70 offen offset:2048 sc1
    buffer_load_dwordx2 v[32:33], v121, s[4:7], s70 offen sc1
    s_add_u32 s70, s70, 40960
    buffer_load_dwordx4 v[34:37], v120, s[4:7], s70 offen sc1
    buffer_load_dwordx4 v[38:41], v120, s[4:7], s70 offen offset:2048 sc1
    buffer_load_dwordx2 v[42:43], v121, s[4:7], s70 offen sc1
    s_add_u32 s70, s70, 40960
    buffer_load_dwordx4 v[44:47], v120, s[4:7], s70 offen sc1
    buffer_load_dwordx4 v[48:51], v120, s[4:7], s70 offen offset:2048 sc1
    buffer_load_dwordx2 v[52:53], v121, s[4:7], s70 offen sc1
    s_add_u32 s70, s70, 40960
    buffer_load_dwordx4 v[54:57], v120, s[4:7], s70 offen sc1
    buffer_load_dwordx4 v[58:61], v120, s[4:7], s70 offen offset:2048 sc1
    buffer_load_dwordx2 v[62:63], v121, s[4:7], s70 offen sc1
    s_add_u32 s70, s70, 40960
    buffer_load_dwordx4 v[64:67], v120, s[4:7], s70 offen sc1
    buffer_load_dwordx4 v[68:71], v120, s[4:7], s70 offen offset:2048 sc1
    buffer_load_dwordx2 v[72:73], v121, s[4:7], s70 offen sc1
    s_add_u32 s70, s70, 40960
    buffer_load_dwordx4 v[74:77], v120, s[4:7], s70 offen sc1
    buffer_load_dwordx4 v[78:81], v120, s[4:7], s70 offen offset:2048 sc1
    buffer_load_dwordx2 v[82:83], v121, s[4:7], s70 offen sc1
    s_add_u32 s70, s70, 40960
    s_add_u32 s71, s71, 40960
    s_waitcnt vmcnt(26)
    v_lshlrev_b32 v96, 16, v84
    v_and_b32 v97, 0xffff0000, v84
    v_lshlrev_b32 v98, 16, v85
    v_and_b32 v99, 0xffff0000, v85
    v_lshlrev_b32 v100, 16, v86
    v_and_b32 v101, 0xffff0000, v86
    v_lshlrev_b32 v102, 16, v87
    v_and_b32 v103, 0xffff0000, v87
    s_waitcnt vmcnt(25)
    v_lshlrev_b32 v104, 16, v88
    v_and_b32 v105, 0xffff0000, v88
    v_lshlrev_b32 v106, 16, v89
    v_and_b32 v107, 0xffff0000, v89
    v_lshlrev_b32 v108, 16, v90
    v_and_b32 v109, 0xffff0000, v90
    v_lshlrev_b32 v110, 16, v91
    v_and_b32 v111, 0xffff0000, v91
    s_waitcnt vmcnt(24)
    v_lshlrev_b32 v112, 16, v92
    v_and_b32 v113, 0xffff0000, v92
    v_lshlrev_b32 v114, 16, v93
    v_and_b32 v115, 0xffff0000, v93
    s_waitcnt vmcnt(23)
    v_dot2_f32_bf16 v96, v4, s75, v96
    v_dot2_f32_bf16 v97, v4, s76, v97
    v_dot2_f32_bf16 v98, v5, s75, v98
    v_dot2_f32_bf16 v99, v5, s76, v99
    v_dot2_f32_bf16 v100, v6, s75, v100
    v_dot2_f32_bf16 v101, v6, s76, v101
    v_dot2_f32_bf16 v102, v7, s75, v102
    v_dot2_f32_bf16 v103, v7, s76, v103
    s_waitcnt vmcnt(22)
    v_dot2_f32_bf16 v104, v8, s75, v104
    v_dot2_f32_bf16 v105, v8, s76, v105
    v_dot2_f32_bf16 v106, v9, s75, v106
    v_dot2_f32_bf16 v107, v9, s76, v107
    v_dot2_f32_bf16 v108, v10, s75, v108
    v_dot2_f32_bf16 v109, v10, s76, v109
    v_dot2_f32_bf16 v110, v11, s75, v110
    v_dot2_f32_bf16 v111, v11, s76, v111
    s_waitcnt vmcnt(21)
    v_dot2_f32_bf16 v112, v12, s75, v112
    v_dot2_f32_bf16 v113, v12, s76, v113
    v_dot2_f32_bf16 v114, v13, s75, v114
    v_dot2_f32_bf16 v115, v13, s76, v115
    s_waitcnt vmcnt(20)
    v_dot2_f32_bf16 v96, v14, s75, v96
    v_dot2_f32_bf16 v97, v14, s76, v97
    v_dot2_f32_bf16 v98, v15, s75, v98
    v_dot2_f32_bf16 v99, v15, s76, v99
    v_dot2_f32_bf16 v100, v16, s75, v100
    v_dot2_f32_bf16 v101, v16, s76, v101
    v_dot2_f32_bf16 v102, v17, s75, v102
    v_dot2_f32_bf16 v103, v17, s76, v103
    s_waitcnt vmcnt(19)
    v_dot2_f32_bf16 v104, v18, s75, v104
    v_dot2_f32_bf16 v105, v18, s76, v105
    v_dot2_f32_bf16 v106, v19, s75, v106
    v_dot2_f32_bf16 v107, v19, s76, v107
    v_dot2_f32_bf16 v108, v20, s75, v108
    v_dot2_f32_bf16 v109, v20, s76, v109
    v_dot2_f32_bf16 v110, v21, s75, v110
    v_dot2_f32_bf16 v111, v21, s76, v111
    s_waitcnt vmcnt(18)
    v_dot2_f32_bf16 v112, v22, s75, v112
    v_dot2_f32_bf16 v113, v22, s76, v113
    v_dot2_f32_bf16 v114, v23, s75, v114
    v_dot2_f32_bf16 v115, v23, s76, v115
    s_waitcnt vmcnt(17)
    v_dot2_f32_bf16 v96, v24, s75, v96
    v_dot2_f32_bf16 v97, v24, s76, v97
    v_dot2_f32_bf16 v98, v25, s75, v98
    v_dot2_f32_bf16 v99, v25, s76, v99
    v_dot2_f32_bf16 v100, v26, s75, v100
    v_dot2_f32_bf16 v101, v26, s76, v101
    v_dot2_f32_bf16 v102, v27, s75, v102
    v_dot2_f32_bf16 v103, v27, s76, v103
    s_waitcnt vmcnt(16)
    v_dot2_f32_bf16 v104, v28, s75, v104
    v_dot2_f32_bf16 v105, v28, s76, v105
    v_dot2_f32_bf16 v106, v29, s75, v106
    v_dot2_f32_bf16 v107, v29, s76, v107
    v_dot2_f32_bf16 v108, v30, s75, v108
    v_dot2_f32_bf16 v109, v30, s76, v109
    v_dot2_f32_bf16 v110, v31, s75, v110
    v_dot2_f32_bf16 v111, v31, s76, v111
    s_waitcnt vmcnt(15)
    v_dot2_f32_bf16 v112, v32, s75, v112
    v_dot2_f32_bf16 v113, v32, s76, v113
    v_dot2_f32_bf16 v114, v33, s75, v114
    v_dot2_f32_bf16 v115, v33, s76, v115
    s_waitcnt vmcnt(14)
    v_dot2_f32_bf16 v96, v34, s75, v96
    v_dot2_f32_bf16 v97, v34, s76, v97
    v_dot2_f32_bf16 v98, v35, s75, v98
    v_dot2_f32_bf16 v99, v35, s76, v99
    v_dot2_f32_bf16 v100, v36, s75, v100
    v_dot2_f32_bf16 v101, v36, s76, v101
    v_dot2_f32_bf16 v102, v37, s75, v102
    v_dot2_f32_bf16 v103, v37, s76, v103
    s_waitcnt vmcnt(13)
    v_dot2_f32_bf16 v104, v38, s75, v104
    v_dot2_f32_bf16 v105, v38, s76, v105
    v_dot2_f32_bf16 v106, v39, s75, v106
    v_dot2_f32_bf16 v107, v39, s76, v107
    v_dot2_f32_bf16 v108, v40, s75, v108
    v_dot2_f32_bf16 v109, v40, s76, v109
    v_dot2_f32_bf16 v110, v41, s75, v110
    v_dot2_f32_bf16 v111, v41, s76, v111
    s_waitcnt vmcnt(12)
    v_dot2_f32_bf16 v112, v42, s75, v112
    v_dot2_f32_bf16 v113, v42, s76, v113
    v_dot2_f32_bf16 v114, v43, s75, v114
    v_dot2_f32_bf16 v115, v43, s76, v115
    s_waitcnt vmcnt(11)
    v_dot2_f32_bf16 v96, v44, s75, v96
    v_dot2_f32_bf16 v97, v44, s76, v97
    v_dot2_f32_bf16 v98, v45, s75, v98
    v_dot2_f32_bf16 v99, v45, s76, v99
    v_dot2_f32_bf16 v100, v46, s75, v100
    v_dot2_f32_bf16 v101, v46, s76, v101
    v_dot2_f32_bf16 v102, v47, s75, v102
    v_dot2_f32_bf16 v103, v47, s76, v103
    s_waitcnt vmcnt(10)
    v_dot2_f32_bf16 v104, v48, s75, v104
    v_dot2_f32_bf16 v105, v48, s76, v105
    v_dot2_f32_bf16 v106, v49, s75, v106
    v_dot2_f32_bf16 v107, v49, s76, v107
    v_dot2_f32_bf16 v108, v50, s75, v108
    v_dot2_f32_bf16 v109, v50, s76, v109
    v_dot2_f32_bf16 v110, v51, s75, v110
    v_dot2_f32_bf16 v111, v51, s76, v111
    s_waitcnt vmcnt(9)
    v_dot2_f32_bf16 v112, v52, s75, v112
    v_dot2_f32_bf16 v113, v52, s76, v113
    v_dot2_f32_bf16 v114, v53, s75, v114
    v_dot2_f32_bf16 v115, v53, s76, v115
    s_waitcnt vmcnt(8)
    v_dot2_f32_bf16 v96, v54, s75, v96
    v_dot2_f32_bf16 v97, v54, s76, v97
    v_dot2_f32_bf16 v98, v55, s75, v98
    v_dot2_f32_bf16 v99, v55, s76, v99
    v_dot2_f32_bf16 v100, v56, s75, v100
    v_dot2_f32_bf16 v101, v56, s76, v101
    v_dot2_f32_bf16 v102, v57, s75, v102
    v_dot2_f32_bf16 v103, v57, s76, v103
    s_waitcnt vmcnt(7)
    v_dot2_f32_bf16 v104, v58, s75, v104
    v_dot2_f32_bf16 v105, v58, s76, v105
    v_dot2_f32_bf16 v106, v59, s75, v106
    v_dot2_f32_bf16 v107, v59, s76, v107
    v_dot2_f32_bf16 v108, v60, s75, v108
    v_dot2_f32_bf16 v109, v60, s76, v109
    v_dot2_f32_bf16 v110, v61, s75, v110
    v_dot2_f32_bf16 v111, v61, s76, v111
    s_waitcnt vmcnt(6)
    v_dot2_f32_bf16 v112, v62, s75, v112
    v_dot2_f32_bf16 v113, v62, s76, v113
    v_dot2_f32_bf16 v114, v63, s75, v114
    v_dot2_f32_bf16 v115, v63, s76, v115
    s_waitcnt vmcnt(5)
    v_dot2_f32_bf16 v96, v64, s75, v96
    v_dot2_f32_bf16 v97, v64, s76, v97
    v_dot2_f32_bf16 v98, v65, s75, v98
    v_dot2_f32_bf16 v99, v65, s76, v99
    v_dot2_f32_bf16 v100, v66, s75, v100
    v_dot2_f32_bf16 v101, v66, s76, v101
    v_dot2_f32_bf16 v102, v67, s75, v102
    v_dot2_f32_bf16 v103, v67, s76, v103
    s_waitcnt vmcnt(4)
    v_dot2_f32_bf16 v104, v68, s75, v104
    v_dot2_f32_bf16 v105, v68, s76, v105
    v_dot2_f32_bf16 v106, v69, s75, v106
    v_dot2_f32_bf16 v107, v69, s76, v107
    v_dot2_f32_bf16 v108, v70, s75, v108
    v_dot2_f32_bf16 v109, v70, s76, v109
    v_dot2_f32_bf16 v110, v71, s75, v110
    v_dot2_f32_bf16 v111, v71, s76, v111
    s_waitcnt vmcnt(3)
    v_dot2_f32_bf16 v112, v72, s75, v112
    v_dot2_f32_bf16 v113, v72, s76, v113
    v_dot2_f32_bf16 v114, v73, s75, v114
    v_dot2_f32_bf16 v115, v73, s76, v115
    s_waitcnt vmcnt(2)
    v_dot2_f32_bf16 v96, v74, s75, v96
    v_dot2_f32_bf16 v97, v74, s76, v97
    v_dot2_f32_bf16 v98, v75, s75, v98
    v_dot2_f32_bf16 v99, v75, s76, v99
    v_dot2_f32_bf16 v100, v76, s75, v100
    v_dot2_f32_bf16 v101, v76, s76, v101
    v_dot2_f32_bf16 v102, v77, s75, v102
    v_dot2_f32_bf16 v103, v77, s76, v103
    s_waitcnt vmcnt(1)
    v_dot2_f32_bf16 v104, v78, s75, v104
    v_dot2_f32_bf16 v105, v78, s76, v105
    v_dot2_f32_bf16 v106, v79, s75, v106
    v_dot2_f32_bf16 v107, v79, s76, v107
    v_dot2_f32_bf16 v108, v80, s75, v108
    v_dot2_f32_bf16 v109, v80, s76, v109
    v_dot2_f32_bf16 v110, v81, s75, v110
    v_dot2_f32_bf16 v111, v81, s76, v111
    s_waitcnt vmcnt(0)
    v_dot2_f32_bf16 v112, v82, s75, v112
    v_dot2_f32_bf16 v113, v82, s76, v113
    v_dot2_f32_bf16 v114, v83, s75, v114
    v_dot2_f32_bf16 v115, v83, s76, v115
    v_cvt_pk_bf16_f32 v84, v96, v97
    v_cvt_pk_bf16_f32 v85, v98, v99
    v_cvt_pk_bf16_f32 v86, v100, v101
    v_cvt_pk_bf16_f32 v87, v102, v103
    v_cvt_pk_bf16_f32 v88, v104, v105
    v_cvt_pk_bf16_f32 v89, v106, v107
    v_cvt_pk_bf16_f32 v90, v108, v109
    v_cvt_pk_bf16_f32 v91, v110, v111
    v_cvt_pk_bf16_f32 v92, v112, v113
    v_cvt_pk_bf16_f32 v93, v114, v115
    buffer_store_dwordx4 v[84:87], v122, s[20:23], s72 offen sc1
    buffer_store_dwordx4 v[88:91], v122, s[20:23], s72 offen offset:512 sc1
    buffer_store_dwordx2 v[92:93], v123, s[20:23], s72 offen offset:1024 sc1
    s_add_u32 s72, s72, 40960
    s_cmp_eq_u32 s74, 3
    s_cbranch_scc1 L_Rnext
    v_lshlrev_b32 v96, 16, v84
    v_and_b32 v97, 0xffff0000, v84
    v_lshlrev_b32 v98, 16, v85
    v_and_b32 v99, 0xffff0000, v85
    v_lshlrev_b32 v100, 16, v86
    v_and_b32 v101, 0xffff0000, v86
    v_lshlrev_b32 v102, 16, v87
    v_and_b32 v103, 0xffff0000, v87
    v_lshlrev_b32 v104, 16, v88
    v_and_b32 v105, 0xffff0000, v88
    v_lshlrev_b32 v106, 16, v89
    v_and_b32 v107, 0xffff0000, v89
    v_lshlrev_b32 v108, 16, v90
    v_and_b32 v109, 0xffff0000, v90
    v_lshlrev_b32 v110, 16, v91
    v_and_b32 v111, 0xffff0000, v91
    v_lshlrev_b32 v112, 16, v92
    v_and_b32 v113, 0xffff0000, v92
    v_lshlrev_b32 v114, 16, v93
    v_and_b32 v115, 0xffff0000, v93
    v_add_f32 v116, v96, v97
    v_add_f32 v117, v98, v99
    v_add_f32 v116, v116, v100
    v_add_f32 v117, v117, v101
    v_add_f32 v116, v116, v102
    v_add_f32 v117, v117, v103
    v_add_f32 v116, v116, v104
    v_add_f32 v117, v117, v105
    v_add_f32 v116, v116, v106
    v_add_f32 v117, v117, v107
    v_add_f32 v116, v116, v108
    v_add_f32 v117, v117, v109
    v_add_f32 v116, v116, v110
    v_add_f32 v117, v117, v111
    v_add_f32 v116, v116, v112
    v_add_f32 v117, v117, v113
    v_add_f32 v116, v116, v114
    v_add_f32 v117, v117, v115
    v_add_f32 v116, v116, v117
    s_nop 1
    v_add_f32_dpp v116, v116, v116 quad_perm:[1,0,3,2] row_mask:0xf bank_mask:0xf
    s_nop 1
    v_add_f32_dpp v116, v116, v116 quad_perm:[2,3,0,1] row_mask:0xf bank_mask:0xf
    s_nop 1
    v_add_f32_dpp v116, v116, v116 row_half_mirror row_mask:0xf bank_mask:0xf
    s_nop 1
    v_add_f32_dpp v116, v116, v116 row_mirror row_mask:0xf bank_mask:0xf
    v_mov_b32 v117, v116
    s_nop 1
    v_permlane16_swap_b32 v116, v117
    v_add_f32 v116, v116, v117
    v_mul_f32 v116, 0x3acccccd, v116
    v_sub_f32 v96, v96, v116
    v_sub_f32 v97, v97, v116
    v_sub_f32 v98, v98, v116
    v_sub_f32 v99, v99, v116
    v_sub_f32 v100, v100, v116
    v_sub_f32 v101, v101, v116
    v_sub_f32 v102, v102, v116
    v_sub_f32 v103, v103, v116
    v_sub_f32 v104, v104, v116
    v_sub_f32 v105, v105, v116
    v_sub_f32 v106, v106, v116
    v_sub_f32 v107, v107, v116
    v_sub_f32 v108, v108, v116
    v_sub_f32 v109, v109, v116
    v_sub_f32 v110, v110, v116
    v_sub_f32 v111, v111, v116
    v_sub_f32 v112, v112, v116
    v_sub_f32 v113, v113, v116
    v_sub_f32 v114, v114, v116
    v_sub_f32 v115, v115, v116
    v_mul_f32 v116, v96, v96
    v_mul_f32 v117, v97, v97
    v_fmac_f32 v116, v98, v98
    v_fmac_f32 v117, v99, v99
    v_fmac_f32 v116, v100, v100
    v_fmac_f32 v117, v101, v101
    v_fmac_f32 v116, v102, v102
    v_fmac_f32 v117, v103, v103
    v_fmac_f32 v116, v104, v104
    v_fmac_f32 v117, v105, v105
    v_fmac_f32 v116, v106, v106
    v_fmac_f32 v117, v107, v107
    v_fmac_f32 v116, v108, v108
    v_fmac_f32 v117, v109, v109
    v_fmac_f32 v116, v110, v110
    v_fmac_f32 v117, v111, v111
    v_fmac_f32 v116, v112, v112
    v_fmac_f32 v117, v113, v113
    v_fmac_f32 v116, v114, v114
    v_fmac_f32 v117, v115, v115
    v_add_f32 v116, v116, v117
    s_nop 1
    v_add_f32_dpp v116, v116, v116 quad_perm:[1,0,3,2] row_mask:0xf bank_mask:0xf
    s_nop 1
    v_add_f32_dpp v116, v116, v116 quad_perm:[2,3,0,1] row_mask:0xf bank_mask:0xf
    s_nop 1
    v_add_f32_dpp v116, v116, v116 row_half_mirror row_mask:0xf bank_mask:0xf
    s_nop 1
    v_add_f32_dpp v116, v116, v116 row_mirror row_mask:0xf bank_mask:0xf
    v_mov_b32 v117, v116
    s_nop 1
    v_permlane16_swap_b32 v116, v117
    v_add_f32 v116, v116, v117
    v_mov_b32 v117, 0x3727c5ac
    v_fmac_f32 v117, 0x3acccccd, v116
    v_rsq_f32 v116, v117
    s_nop 0
    v_mul_f32 v96, v96, v116
    v_mul_f32 v97, v97, v116
    v_mul_f32 v98, v98, v116
    v_mul_f32 v99, v99, v116
    v_mul_f32 v100, v100, v116
    v_mul_f32 v101, v101, v116
    v_mul_f32 v102, v102, v116
    v_mul_f32 v103, v103, v116
    v_mul_f32 v104, v104, v116
    v_mul_f32 v105, v105, v116
    v_mul_f32 v106, v106, v116
    v_mul_f32 v107, v107, v116
    v_mul_f32 v108, v108, v116
    v_mul_f32 v109, v109, v116
    v_mul_f32 v110, v110, v116
    v_mul_f32 v111, v111, v116
    v_mul_f32 v112, v112, v116
    v_mul_f32 v113, v113, v116
    v_mul_f32 v114, v114, v116
    v_mul_f32 v115, v115, v116
    v_cvt_pk_bf16_f32 v84, v96, v97
    v_cvt_pk_bf16_f32 v85, v98, v99
    v_cvt_pk_bf16_f32 v86, v100, v101
    v_cvt_pk_bf16_f32 v87, v102, v103
    v_cvt_pk_bf16_f32 v88, v104, v105
    v_cvt_pk_bf16_f32 v89, v106, v107
    v_cvt_pk_bf16_f32 v90, v108, v109
    v_cvt_pk_bf16_f32 v91, v110, v111
    v_cvt_pk_bf16_f32 v92, v112, v113
    v_cvt_pk_bf16_f32 v93, v114, v115
    buffer_store_dwordx4 v[84:87], v122, s[4:7], s73 offen sc1
    buffer_store_dwordx4 v[88:91], v122, s[4:7], s73 offen offset:512 sc1
    buffer_store_dwordx2 v[92:93], v123, s[4:7], s73 offen offset:1024 sc1
    s_add_u32 s73, s73, 40960
    s_waitcnt vmcnt(0)
    s_add_u32 s64, s62, 1
    v_mov_b32 v116, s64
    s_mov_b64 exec, 1
    buffer_store_dword v116, off, s[4:7], s63 sc1
    buffer_store_dword v116, off, s[4:7], s3
    s_mov_b64 exec, -1
L_Rnext:
    s_add_u32 s62, s62, 1
    s_cmp_lt_u32 s62, 64
    s_cbranch_scc1 L_Rseg
    s_endpgm
Lgrty_111:
    s_sleep 16
    buffer_load_dword v2, off, s[8:11], 0 offset:132 sc1
    s_sub_u32 s61, s61, 1
    s_mov_b32 s67, 1
    s_cbranch_scc1 L_fail
    s_branch Lgchk_110
Lfrty_114:
    s_sleep 4
    buffer_load_dword v126, v124, s[4:7], 0 offen sc1
    s_sub_u32 s61, s61, 1
    s_mov_b32 s67, 40
    s_cbranch_scc1 L_fail
    s_waitcnt vmcnt(0)
    s_branch Lfchk_113
.section .rodata,"a"
.p2align 6
.amdhsa_kernel interleave_layers__memory_aug_recurrent_mem_tr__sliding_local_dilated__prompt_kernel
  .amdhsa_next_free_vgpr 512
  .amdhsa_next_free_sgpr 102
  .amdhsa_accum_offset 256
  .amdhsa_group_segment_fixed_size 0
  .amdhsa_kernarg_size 104
  .amdhsa_user_sgpr_count 2
  .amdhsa_user_sgpr_kernarg_segment_ptr 1
  .amdhsa_system_sgpr_workgroup_id_x 1
  .amdhsa_float_denorm_mode_32 3
.end_amdhsa_kernel
```

```asm
; @launch grid=(256,1,1) block=(256,1,1) lds=163840
.amdgcn_target "amdgcn-amd-amdhsa--gfx950"
.text
.globl interleave_layers__memory_aug_recurrent_mem_tr__sliding_local_dilated__prompt_kernel
.p2align 8
.type interleave_layers__memory_aug_recurrent_mem_tr__sliding_local_dilated__prompt_kernel,@function
interleave_layers__memory_aug_recurrent_mem_tr__sliding_local_dilated__prompt_kernel:
    s_cmp_ge_u32 s2, 256
    s_cbranch_scc1 L_end
    s_load_dwordx16 s[32:47], s[0:1], 0
    s_load_dwordx8 s[48:55], s[0:1], 64
    s_load_dwordx2 s[56:57], s[0:1], 96
    s_getreg_b32 s58, hwreg(HW_REG_XCC_ID)
    s_and_b32 s58, s58, 7
    v_lshrrev_b32 v1, 6, v0
    s_nop 0
    v_readfirstlane_b32 s60, v1
    s_mov_b32 s61, 0x100000
    s_waitcnt lgkmcnt(0)
    s_mov_b32 s4, s56
    s_mov_b32 s5, s57
    s_mov_b32 s6, 268435456
    s_mov_b32 s7, 0x20000
    s_mov_b32 s8, s54
    s_mov_b32 s9, s55
    s_mov_b32 s10, 256
    s_mov_b32 s11, 0x20000
    s_mov_b32 s12, s32
    s_mov_b32 s13, s33
    s_mov_b32 s14, 2621440
    s_mov_b32 s15, 0x20000
    s_cmp_lg_u32 s60, 0
    s_cbranch_scc1 L_notick
    s_mov_b64 exec, 1
    v_mov_b32 v2, 1
    s_lshl_b32 s64, s58, 5
    buffer_atomic_add v2, off, s[8:11], s64 sc0
    s_mov_b64 exec, -1
L_notick:
    v_lshrrev_b32 v4, 5, v0
    s_lshl_b32 s64, s2, 3
    v_add_u32 v4, s64, v4
    v_mul_u32_u24 v4, 1280, v4
    v_and_b32 v5, 31, v0
    v_lshl_add_u32 v6, v5, 3, v4
    v_lshl_add_u32 v5, v5, 4, v4
    buffer_load_dwordx4 v[8:11], v5, s[12:15], 0 offen
    buffer_load_dwordx4 v[12:15], v5, s[12:15], 0 offen offset:512
    buffer_load_dwordx2 v[16:17], v6, s[12:15], 0 offen offset:1024
    v_mov_b32 v44, -1
    v_mov_b32 v45, -1
    v_mov_b32 v46, -1
    v_mov_b32 v47, -1
    v_mov_b32 v48, 0
    v_lshlrev_b32 v7, 4, v0
    v_lshlrev_b32 v18, 2, v0
    s_lshr_b32 s64, s2, 5
    s_lshl_b32 s64, s64, 20
    s_bfe_u32 s65, s2, 0x10004
    s_lshl_b32 s65, s65, 18
    s_add_u32 s64, s64, s65
    s_and_b32 s65, s2, 15
    s_mul_i32 s65, s65, 11776
    s_add_u32 s64, s64, s65
    buffer_store_dwordx4 v[44:47], v7, s[4:7], s64 offen sc1
    s_add_u32 s64, s64, 4096
    buffer_store_dwordx4 v[44:47], v7, s[4:7], s64 offen sc1
    s_add_u32 s64, s64, 4096
    buffer_store_dwordx4 v[44:47], v7, s[4:7], s64 offen sc1
    s_add_u32 s64, s64, 4096
    s_lshr_b32 s64, s2, 5
    s_lshl_b32 s64, s64, 18
    s_and_b32 s65, s2, 31
    s_lshl_b32 s65, s65, 12
    s_add_u32 s64, s64, s65
    s_add_u32 s64, s64, 14680064
    buffer_store_dwordx4 v[44:47], v7, s[4:7], s64 offen sc1
    s_and_b32 s64, s2, 127
    s_lshl_b32 s64, s64, 10
    s_add_u32 s64, s64, 8388608
    s_bfe_u32 s65, s2, 0x30004
    s_lshl_b32 s65, s65, 18
    s_and_b32 s66, s2, 15
    s_lshl_b32 s66, s66, 10
    s_add_u32 s65, s65, s66
    s_add_u32 s65, s65, 14811136
    s_cmp_lt_u32 s2, 128
    s_cselect_b32 s64, s64, s65
    buffer_store_dword v48, v18, s[4:7], s64 offen sc1
    v_bfe_u32 v49, v0, 5, 3
    s_and_b32 s64, s2, 3
    s_mul_i32 s64, s64, 10
    v_bfe_u32 v50, v0, 3, 2
    v_add_u32 v50, s64, v50
    v_add_u32 v51, 4, v50
    v_bfe_u32 v52, v0, 4, 1
    v_add3_u32 v52, v52, s64, 8
    v_lshrrev_b32 v53, 3, v50
    v_lshlrev_b32 v50, 10, v50
    v_lshl_add_u32 v50, v53, 13, v50
    v_lshrrev_b32 v53, 3, v51
    v_lshlrev_b32 v51, 10, v51
    v_lshl_add_u32 v51, v53, 13, v51
    v_lshrrev_b32 v53, 3, v52
    v_lshlrev_b32 v52, 10, v52
    v_lshl_add_u32 v52, v53, 13, v52
    v_and_b32 v53, 7, v0
    v_xor_b32 v53, v53, v49
    v_lshlrev_b32 v53, 4, v53
    v_lshl_add_u32 v53, v49, 7, v53
    v_add_u32 v50, v50, v53
    v_add_u32 v51, v51, v53
    v_bfe_u32 v53, v0, 1, 3
    v_xor_b32 v53, v53, v49
    v_lshlrev_b32 v53, 4, v53
    v_lshl_add_u32 v53, v49, 7, v53
    v_and_b32 v54, 1, v0
    v_lshl_add_u32 v53, v54, 3, v53
    v_add_u32 v52, v52, v53
    s_cmp_lg_u32 s60, 0
    s_cbranch_scc1 L_notick2
    v_mov_b32 v3, 0
    s_mov_b64 exec, 1
    s_waitcnt vmcnt(8)
    ds_write_b32 v3, v2
    s_mov_b64 exec, -1
L_notick2:
    s_waitcnt lgkmcnt(0)
    s_barrier
    v_mov_b32 v3, 0
    s_waitcnt vmcnt(8)
    ds_read_b32 v2, v3
    s_waitcnt lgkmcnt(0)
    v_readfirstlane_b32 s59, v2
    s_waitcnt lgkmcnt(0)
    s_barrier
    s_waitcnt vmcnt(7)
    v_lshlrev_b32 v20, 16, v8
    v_and_b32 v21, 0xffff0000, v8
    v_lshlrev_b32 v22, 16, v9
    v_and_b32 v23, 0xffff0000, v9
    v_lshlrev_b32 v24, 16, v10
    v_and_b32 v25, 0xffff0000, v10
    v_lshlrev_b32 v26, 16, v11
    v_and_b32 v27, 0xffff0000, v11
    s_waitcnt vmcnt(6)
    v_lshlrev_b32 v28, 16, v12
    v_and_b32 v29, 0xffff0000, v12
    v_lshlrev_b32 v30, 16, v13
    v_and_b32 v31, 0xffff0000, v13
    v_lshlrev_b32 v32, 16, v14
    v_and_b32 v33, 0xffff0000, v14
    v_lshlrev_b32 v34, 16, v15
    v_and_b32 v35, 0xffff0000, v15
    s_waitcnt vmcnt(5)
    v_lshlrev_b32 v36, 16, v16
    v_and_b32 v37, 0xffff0000, v16
    v_lshlrev_b32 v38, 16, v17
    v_and_b32 v39, 0xffff0000, v17
    v_pk_add_f32 v[40:41], v[20:21], v[22:23]
    v_pk_add_f32 v[40:41], v[40:41], v[24:25]
    v_pk_add_f32 v[40:41], v[40:41], v[26:27]
    v_pk_add_f32 v[40:41], v[40:41], v[28:29]
    v_pk_add_f32 v[40:41], v[40:41], v[30:31]
    v_pk_add_f32 v[40:41], v[40:41], v[32:33]
    v_pk_add_f32 v[40:41], v[40:41], v[34:35]
    v_pk_add_f32 v[40:41], v[40:41], v[36:37]
    v_pk_add_f32 v[40:41], v[40:41], v[38:39]
    v_add_f32 v40, v40, v41
    s_nop 1
    v_add_f32_dpp v40, v40, v40 quad_perm:[1,0,3,2] row_mask:0xf bank_mask:0xf
    s_nop 1
    v_add_f32_dpp v40, v40, v40 quad_perm:[2,3,0,1] row_mask:0xf bank_mask:0xf
    s_nop 1
    v_add_f32_dpp v40, v40, v40 row_half_mirror row_mask:0xf bank_mask:0xf
    s_nop 1
    v_add_f32_dpp v40, v40, v40 row_mirror row_mask:0xf bank_mask:0xf
    v_mov_b32 v41, v40
    s_nop 1
    v_permlane16_swap_b32 v40, v41
    v_add_f32 v40, v40, v41
    v_mul_f32 v40, 0xbacccccd, v40
    v_pk_add_f32 v[20:21], v[20:21], v[40:41] op_sel_hi:[1,0]
    v_pk_add_f32 v[22:23], v[22:23], v[40:41] op_sel_hi:[1,0]
    v_pk_add_f32 v[24:25], v[24:25], v[40:41] op_sel_hi:[1,0]
    v_pk_add_f32 v[26:27], v[26:27], v[40:41] op_sel_hi:[1,0]
    v_pk_add_f32 v[28:29], v[28:29], v[40:41] op_sel_hi:[1,0]
    v_pk_add_f32 v[30:31], v[30:31], v[40:41] op_sel_hi:[1,0]
    v_pk_add_f32 v[32:33], v[32:33], v[40:41] op_sel_hi:[1,0]
    v_pk_add_f32 v[34:35], v[34:35], v[40:41] op_sel_hi:[1,0]
    v_pk_add_f32 v[36:37], v[36:37], v[40:41] op_sel_hi:[1,0]
    v_pk_add_f32 v[38:39], v[38:39], v[40:41] op_sel_hi:[1,0]
    v_pk_mul_f32 v[40:41], v[20:21], v[20:21]
    v_pk_fma_f32 v[40:41], v[22:23], v[22:23], v[40:41]
    v_pk_fma_f32 v[40:41], v[24:25], v[24:25], v[40:41]
    v_pk_fma_f32 v[40:41], v[26:27], v[26:27], v[40:41]
    v_pk_fma_f32 v[40:41], v[28:29], v[28:29], v[40:41]
    v_pk_fma_f32 v[40:41], v[30:31], v[30:31], v[40:41]
    v_pk_fma_f32 v[40:41], v[32:33], v[32:33], v[40:41]
    v_pk_fma_f32 v[40:41], v[34:35], v[34:35], v[40:41]
    v_pk_fma_f32 v[40:41], v[36:37], v[36:37], v[40:41]
    v_pk_fma_f32 v[40:41], v[38:39], v[38:39], v[40:41]
    v_add_f32 v40, v40, v41
    s_nop 1
    v_add_f32_dpp v40, v40, v40 quad_perm:[1,0,3,2] row_mask:0xf bank_mask:0xf
    s_nop 1
    v_add_f32_dpp v40, v40, v40 quad_perm:[2,3,0,1] row_mask:0xf bank_mask:0xf
    s_nop 1
    v_add_f32_dpp v40, v40, v40 row_half_mirror row_mask:0xf bank_mask:0xf
    s_nop 1
    v_add_f32_dpp v40, v40, v40 row_mirror row_mask:0xf bank_mask:0xf
    v_mov_b32 v41, v40
    s_nop 1
    v_permlane16_swap_b32 v40, v41
    v_add_f32 v40, v40, v41
    v_mov_b32 v41, 0x3727c5ac
    v_fmac_f32 v41, 0x3acccccd, v40
    v_rsq_f32 v40, v41
    s_nop 0
    v_pk_mul_f32 v[20:21], v[20:21], v[40:41] op_sel_hi:[1,0]
    v_pk_mul_f32 v[22:23], v[22:23], v[40:41] op_sel_hi:[1,0]
    v_pk_mul_f32 v[24:25], v[24:25], v[40:41] op_sel_hi:[1,0]
    v_pk_mul_f32 v[26:27], v[26:27], v[40:41] op_sel_hi:[1,0]
    v_pk_mul_f32 v[28:29], v[28:29], v[40:41] op_sel_hi:[1,0]
    v_pk_mul_f32 v[30:31], v[30:31], v[40:41] op_sel_hi:[1,0]
    v_pk_mul_f32 v[32:33], v[32:33], v[40:41] op_sel_hi:[1,0]
    v_pk_mul_f32 v[34:35], v[34:35], v[40:41] op_sel_hi:[1,0]
    v_pk_mul_f32 v[36:37], v[36:37], v[40:41] op_sel_hi:[1,0]
    v_pk_mul_f32 v[38:39], v[38:39], v[40:41] op_sel_hi:[1,0]
    v_cvt_pk_bf16_f32 v8, v20, v21
    v_cvt_pk_bf16_f32 v9, v22, v23
    v_cvt_pk_bf16_f32 v10, v24, v25
    v_cvt_pk_bf16_f32 v11, v26, v27
    v_cvt_pk_bf16_f32 v12, v28, v29
    v_cvt_pk_bf16_f32 v13, v30, v31
    v_cvt_pk_bf16_f32 v14, v32, v33
    v_cvt_pk_bf16_f32 v15, v34, v35
    v_cvt_pk_bf16_f32 v16, v36, v37
    v_cvt_pk_bf16_f32 v17, v38, v39
    s_lshr_b32 s64, s2, 2
    s_lshl_b32 s64, s64, 17
    s_add_u32 s64, s64, 16777216
    buffer_store_dwordx4 v[8:11], v50, s[4:7], s64 offen sc1
    buffer_store_dwordx4 v[12:15], v51, s[4:7], s64 offen sc1
    buffer_store_dwordx2 v[16:17], v52, s[4:7], s64 offen sc1
    s_lshr_b32 s68, s58, 2
    s_and_b32 s69, s58, 3
    s_lshl_b32 s63, s58, 5
    s_add_u32 s63, s63, s59
    s_lshl_b32 s63, s63, 2
    s_add_u32 s63, s63, s60
    s_lshl_b32 s63, s63, 7
    s_add_u32 s3, s63, 8388608
    s_mov_b32 s62, 0
    s_cmp_eq_u32 s68, 0
    s_cbranch_scc1 Lnowarm_1
    s_waitcnt vmcnt(0)
    s_barrier
    s_cmp_lg_u32 s60, 0
    s_cbranch_scc1 Lcnt_2
    s_mov_b64 exec, 1
    v_mov_b32 v2, 1
    buffer_atomic_add v2, off, s[8:11], 0 offset:4 sc0
    v_mov_b32 v3, 0x80000000
    s_waitcnt vmcnt(0)
    v_cmp_ne_u32 vcc, 255, v2
    s_nop 1
    v_cndmask_b32 v3, 4, v3, vcc
    buffer_store_dword v2, v3, s[8:11], 0 offen offset:128 sc1
    s_mov_b64 exec, -1
Lcnt_2:
    s_lshl_b32 s64, s60, 5
    s_add_u32 s64, s64, s59
    s_lshr_b32 s64, s64, 3
    s_cmp_lg_u32 s64, 3
    s_cbranch_scc1 Lnoprobe_4
    s_lshl_b32 s64, s69, 3
    s_and_b32 s65, s59, 7
    s_add_u32 s64, s64, s65
    s_lshl_b32 s64, s64, 7
    s_add_u32 s64, s64, 14860288
    s_add_u32 s66, s64, 131072
    v_lshlrev_b32 v3, 4, v0
    s_mov_b64 exec, 0xff
    s_mov_b32 s70, -1
    s_mov_b32 s71, -1
Lprobe_3:
    buffer_store_dwordx4 v[8:11], v3, s[4:7], s64 offen sc1
    s_mov_b32 s0, 0
Lprobe_3w:
    s_add_u32 s0, s0, 1
    s_sub_u32 s61, s61, 1
    s_cbranch_scc1 L_fail
    s_getreg_b32 s65, hwreg(HW_REG_IB_STS, 0, 4)
    s_cmp_lg_u32 s65, 0
    s_cbranch_scc1 Lprobe_3w
    s_waitcnt vmcnt(0)
    s_bitcmp1_b32 s64, 13
    s_cselect_b32 s65, -1, s0
    s_cselect_b32 s0, s0, -1
    s_min_u32 s70, s70, s65
    s_min_u32 s71, s71, s0
    s_add_u32 s64, s64, 0x1000
    s_or_b32 s64, s64, 0xc000
    s_cmp_lt_u32 s64, s66
    s_cbranch_scc1 Lprobe_3
    s_cmp_gt_u32 s70, s71
    s_cselect_b32 s65, 65, 64
    s_mov_b64 exec, 1
    v_mov_b32 v2, s65
    buffer_atomic_add v2, off, s[8:11], 0 offset:72 sc0
    s_waitcnt vmcnt(0)
    v_add_u32 v2, s65, v2
    v_subrev_u32 v2, 2047, v2
    v_mov_b32 v3, 0x80000000
    v_cmp_lt_i32 vcc, 0, v2
    s_nop 1
    v_cndmask_b32 v3, v3, 0, vcc
    buffer_store_dword v2, v3, s[8:11], 0 offen offset:140 sc1
    s_mov_b64 exec, -1
Lnoprobe_4:
    s_cmp_lg_u32 s60, 0
    s_cbranch_scc1 Lgskip_7
    buffer_load_dword v2, off, s[8:11], 0 offset:136 sc1
Lgchk_5:
    s_waitcnt vmcnt(0)
    v_cmp_eq_u32 vcc, 0, v2
    s_cbranch_vccnz Lgrty_6
Lgskip_7:
    s_waitcnt lgkmcnt(0)
    s_barrier
Lnowarm_1:
    s_cmp_lt_u32 s59, 24
    s_cbranch_scc1 L_roleC
    s_cmp_lt_u32 s59, 28
    s_cbranch_scc1 L_roleT
    s_cmp_lt_u32 s59, 30
    s_cbranch_scc1 L_roleB
    s_cmp_lt_u32 s59, 32
    s_cbranch_scc1 L_roleR
    s_mov_b32 s67, 2
L_fail:
    s_mov_b64 exec, 1
    s_lshl_b32 s67, s67, 8
    s_add_u32 s67, s67, s59
    s_lshl_b32 s67, s67, 8
    s_add_u32 s67, s67, s58
    s_lshl_b32 s67, s67, 8
    s_add_u32 s67, s67, s62
    s_waitcnt vmcnt(0)
    v_mov_b32 v2, s67
    buffer_store_dword v2, off, s[8:11], 0 offset:40
L_end:
    s_endpgm
L_roleC:
    s_mov_b32 s12, s36
    s_mov_b32 s13, s37
    s_mov_b32 s14, 7864320
    s_mov_b32 s15, 0x20000
    s_mov_b32 s16, s38
    s_mov_b32 s17, s39
    s_mov_b32 s18, 7864320
    s_mov_b32 s19, 0x20000
    s_mov_b32 s20, s40
    s_mov_b32 s21, s41
    s_mov_b32 s22, 7864320
    s_mov_b32 s23, 0x20000
    s_mov_b32 s24, s42
    s_mov_b32 s25, s43
    s_mov_b32 s26, 7864320
    s_mov_b32 s27, 0x20000
    s_mov_b32 s28, s34
    s_mov_b32 s29, s35
    s_mov_b32 s30, 10240
    s_mov_b32 s31, 0x20000
    v_and_b32 v1, 63, v0
    s_mul_i32 s64, s69, 3072
    s_lshl_b32 s65, s59, 7
    s_add_u32 s64, s64, s65
    s_mul_i32 s65, s60, 98304
    s_add_u32 s64, s64, s65
    v_lshrrev_b32 v194, 3, v1
    v_mul_u32_u24 v194, 12288, v194
    v_and_b32 v195, 7, v1
    v_lshl_add_u32 v194, v195, 4, v194
    v_add_u32 v194, s64, v194
    s_lshl_b32 s82, s60, 10
    s_lshl_b32 s64, s69, 2
    s_add_u32 s64, s64, s60
    s_mul_i32 s64, s64, 491520
    s_lshl_b32 s65, s59, 6
    s_add_u32 s64, s64, s65
    s_cmp_lt_u32 s59, 20
    s_cselect_b32 s64, s64, 0x80000000
    v_lshrrev_b32 v197, 2, v1
    v_mul_u32_u24 v197, 1280, v197
    v_and_b32 v198, 3, v1
    v_lshl_add_u32 v197, v198, 4, v197
    v_add_u32 v197, s64, v197
    s_lshl_b32 s83, s60, 12
    s_add_u32 m0, s83, 0
    s_mov_b32 s65, 0
    buffer_load_dwordx4 v197, s[24:27], s65 offen lds
    s_add_u32 m0, s83, 1024
    s_mov_b32 s65, 20480
    buffer_load_dwordx4 v197, s[24:27], s65 offen lds
    s_add_u32 m0, s83, 2048
    s_mov_b32 s65, 40960
    buffer_load_dwordx4 v197, s[24:27], s65 offen lds
    s_add_u32 m0, s83, 3072
    s_mov_b32 s65, 61440
    buffer_load_dwordx4 v197, s[24:27], s65 offen lds
    s_add_u32 m0, s83, 16384
    s_mov_b32 s65, 81920
    buffer_load_dwordx4 v197, s[24:27], s65 offen lds
    s_add_u32 m0, s83, 17408
    s_mov_b32 s65, 102400
    buffer_load_dwordx4 v197, s[24:27], s65 offen lds
    s_add_u32 m0, s83, 18432
    s_mov_b32 s65, 122880
    buffer_load_dwordx4 v197, s[24:27], s65 offen lds
    s_add_u32 m0, s83, 19456
    s_mov_b32 s65, 143360
    buffer_load_dwordx4 v197, s[24:27], s65 offen lds
    s_add_u32 m0, s83, 32768
    s_mov_b32 s65, 163840
    buffer_load_dwordx4 v197, s[24:27], s65 offen lds
    s_add_u32 m0, s83, 33792
    s_mov_b32 s65, 184320
    buffer_load_dwordx4 v197, s[24:27], s65 offen lds
    s_add_u32 m0, s83, 34816
    s_mov_b32 s65, 204800
    buffer_load_dwordx4 v197, s[24:27], s65 offen lds
    s_add_u32 m0, s83, 35840
    s_mov_b32 s65, 225280
    buffer_load_dwordx4 v197, s[24:27], s65 offen lds
    s_add_u32 m0, s83, 49152
    s_mov_b32 s65, 245760
    buffer_load_dwordx4 v197, s[24:27], s65 offen lds
    s_add_u32 m0, s83, 50176
    s_mov_b32 s65, 266240
    buffer_load_dwordx4 v197, s[24:27], s65 offen lds
    s_add_u32 m0, s83, 51200
    s_mov_b32 s65, 286720
    buffer_load_dwordx4 v197, s[24:27], s65 offen lds
    s_add_u32 m0, s83, 52224
    s_mov_b32 s65, 307200
    buffer_load_dwordx4 v197, s[24:27], s65 offen lds
    v_and_b32 v84, 7, v1
    v_bfe_u32 v85, v1, 3, 1
    v_lshrrev_b32 v86, 4, v1
    v_and_b32 v87, 15, v1
    v_lshlrev_b32 v234, 4, v0
    v_lshlrev_b32 v235, 3, v0
    v_add_u32 v235, 8192, v235
    v_lshlrev_b32 v236, 4, v1
    v_lshlrev_b32 v240, 3, v1
    v_lshlrev_b32 v237, 2, v1
    s_add_u32 s64, s60, 1
    s_mul_i32 s64, s64, 1280
    v_add_u32 v238, s64, v236
    v_add_u32 v239, s64, v237
    v_cmp_eq_u32 s[98:99], 1, v85
    v_cmp_lt_u32 s[100:101], 1, v86
    v_mov_b32 v88, 0x4444
    v_mov_b32 v89, 0xeeee
    v_cndmask_b32 v187, v88, v89, s[98:99]
    v_mov_b32 v88, 0xffff
    v_mov_b32 v89, 0xffff0000
    v_cndmask_b32 v231, v88, v89, s[98:99]
    v_mul_u32_u24 v232, 10240, v85
    v_lshl_add_u32 v232, v84, 7, v232
    v_xor_b32 v88, v86, v84
    v_lshl_add_u32 v232, v88, 4, v232
    v_add_u32 v232, 32768, v232
    v_xor_b32 v233, 64, v232
    v_lshrrev_b32 v88, 5, v1
    v_and_b32 v89, 1, v86
    v_lshlrev_b32 v90, 4, v87
    v_lshl_add_u32 v90, v89, 3, v90
    v_lshl_add_u32 v241, v88, 10, v90
    s_lshl_b32 s64, s60, 8
    v_add_u32 v241, s64, v241
    v_lshl_add_u32 v243, v88, 8, v90
    s_lshl_b32 s64, s60, 9
    v_add_u32 v243, s64, v243
    v_lshlrev_b32 v249, 9, v89
    v_lshl_add_u32 v249, v88, 6, v249
    v_bfe_u32 v90, v1, 1, 1
    v_lshl_add_u32 v249, v90, 5, v249
    v_bfe_u32 v90, v1, 2, 2
    v_lshl_add_u32 v249, v90, 3, v249
    v_and_b32 v89, 1, v1
    v_lshl_add_u32 v249, v89, 2, v249
    s_lshl_b32 s64, s60, 10
    s_add_u32 s64, s64, 18432
    v_add_u32 v249, s64, v249
    v_lshl_add_u32 v242, v86, 3, v90
    v_lshlrev_b32 v242, 4, v242
    v_lshl_add_u32 v242, v89, 3, v242
    v_bfe_u32 v88, v1, 1, 2
    v_lshlrev_b32 v250, 7, v88
    v_lshrrev_b32 v88, 3, v1
    v_lshl_add_u32 v250, v88, 4, v250
    v_lshl_add_u32 v250, v89, 3, v250
    s_lshl_b32 s64, s59, 9
    s_add_u32 s64, s64, 178176
    v_add_u32 v250, s64, v250
    s_lshl_b32 s66, s59, 10
    s_and_b32 s64, s66, 0x6000
    s_add_u32 s64, s64, s66
    s_lshl_b32 s65, s68, 20
    s_add_u32 s64, s64, s65
    s_add_u32 s64, s64, 14680064
    v_add_u32 v251, s64, v236
    s_and_b32 s64, s60, 1
    s_lshl_b32 s64, s64, 3
    s_lshr_b32 s65, s60, 1
    v_lshl_add_u32 v89, v86, 4, v84
    v_add_u32 v89, s64, v89
    s_lshl_b32 s64, s65, 11
    v_lshl_add_u32 v244, v89, 4, s64
    s_mul_i32 s64, s65, 1536
    v_lshlrev_b32 v246, 4, v89
    v_lshlrev_b32 v245, 3, v89
    v_add_u32 v245, 1024, v245
    v_cndmask_b32 v245, v246, v245, s[98:99]
    v_add_u32 v245, s64, v245
    v_lshl_add_u32 v246, v85, 1, v246
    v_add_u32 v246, s64, v246
    s_lshl_b32 s64, s60, 8
    s_add_u32 s64, s64, s66
    s_add_u32 s64, s64, 153600
    v_lshlrev_b32 v88, 5, v84
    v_lshl_add_u32 v247, v86, 3, v88
    v_add_u32 v247, s64, v247
    v_mov_b32 v89, 0x80000000
    v_cndmask_b32 v247, v247, v89, s[98:99]
    v_lshl_add_u32 v248, v86, 8, v88
    v_lshl_add_u32 v248, v85, 4, v248
    s_mul_i32 s64, s60, 6144
    s_add_u32 s64, s64, 153600
    v_add_u32 v248, s64, v248
    s_lshl_b32 s64, s59, 2
    s_add_u32 s64, s64, s60
    s_sub_u32 s64, s64, 80
    s_lshl_b32 s66, s64, 12
    s_and_b32 s65, s66, 0xe000
    s_add_u32 s66, s66, s65
    s_cmp_lt_u32 s64, 10
    s_cselect_b32 s64, s66, 0x80000000
    v_add_u32 v89, s64, v236
    s_cmp_lt_u32 s59, 20
    s_cselect_b64 vcc, -1, 0
    v_cndmask_b32 v248, v89, v248, vcc
    s_lshl_b32 s75, s59, 12
    s_mul_i32 s66, s69, 98304
    s_add_u32 s75, s75, s66
    s_mul_i32 s66, s68, 6291456
    s_add_u32 s75, s75, s66
    s_add_u32 s75, s75, 60817408
    v_lshlrev_b32 v88, 2, v86
    v_lshl_add_u32 v88, v85, 4, v88
    s_lshl_b32 s66, s60, 3
    v_add_u32 v89, s66, v84
    v_mov_b32 v90, 0xcf89a6aa
    v_cmp_gt_u32 vcc, v88, v89
    s_nop 1
    v_cndmask_b32 v188, 0, v90, vcc
    v_add_u32 v88, 1, v88
    v_cmp_gt_u32 vcc, v88, v89
    s_nop 1
    v_cndmask_b32 v189, 0, v90, vcc
    v_add_u32 v88, 1, v88
    v_cmp_gt_u32 vcc, v88, v89
    s_nop 1
    v_cndmask_b32 v190, 0, v90, vcc
    v_add_u32 v88, 1, v88
    v_cmp_gt_u32 vcc, v88, v89
    s_nop 1
    v_cndmask_b32 v191, 0, v90, vcc
    v_add_u32 v88, 1, v88
    v_mov_b32 v180, 0x3f803f80
    v_mov_b32 v181, 0x3f803f80
    v_mov_b32 v182, 0x3f803f80
    v_mov_b32 v183, 0
    v_mov_b32 v175, 0
    v_mov_b32 v179, 0
    s_mov_b32 s70, 0x3dd53b95
    s_cmp_lt_u32 s59, 20
    s_cselect_b32 s89, 4096, 0
    s_lshl_b32 s73, s60, 10
    s_add_u32 s73, s73, 32768
    s_lshl_b32 s91, s68, 23
    s_add_u32 s91, s91, 16777216
    s_mov_b32 s74, s91
    s_mul_i32 s64, s59, 43
    s_lshr_b32 s64, s64, 7
    s_mul_i32 s64, s64, 3
    s_add_u32 s65, s64, 3
    s_add_u32 s77, s59, 1
    s_cmp_eq_u32 s77, s65
    s_cselect_b32 s77, s64, s77
    s_add_u32 s78, s77, 1
    s_cmp_eq_u32 s78, s65
    s_cselect_b32 s78, s64, s78
    s_mul_i32 s76, s59, 6400
    s_mul_i32 s77, s77, 6400
    s_mul_i32 s78, s78, 6400
    s_cmp_lg_u32 s68, 0
    s_cbranch_scc1 Larr0_8
    s_waitcnt vmcnt(16)
    s_barrier
    s_cmp_lg_u32 s60, 0
    s_cbranch_scc1 Lcnt_9
    s_mov_b64 exec, 1
    v_mov_b32 v2, 1
    buffer_atomic_add v2, off, s[8:11], 0 offset:4 sc0
    s_mov_b64 exec, -1
Lcnt_9:
Larr0_8:
    s_add_u32 m0, s83, 65536
    s_mov_b32 s65, 327680
    buffer_load_dwordx4 v197, s[24:27], s65 offen lds
    s_add_u32 m0, s83, 66560
    s_mov_b32 s65, 348160
    buffer_load_dwordx4 v197, s[24:27], s65 offen lds
    s_add_u32 m0, s83, 67584
    s_mov_b32 s65, 368640
    buffer_load_dwordx4 v197, s[24:27], s65 offen lds
    s_add_u32 m0, s83, 68608
    s_mov_b32 s65, 389120
    buffer_load_dwordx4 v197, s[24:27], s65 offen lds
    s_add_u32 m0, s83, 81920
    s_mov_b32 s65, 409600
    buffer_load_dwordx4 v197, s[24:27], s65 offen lds
    s_add_u32 m0, s83, 82944
    s_mov_b32 s65, 430080
    buffer_load_dwordx4 v197, s[24:27], s65 offen lds
    s_add_u32 m0, s83, 83968
    s_mov_b32 s65, 450560
    buffer_load_dwordx4 v197, s[24:27], s65 offen lds
    s_add_u32 m0, s83, 84992
    s_mov_b32 s65, 471040
    buffer_load_dwordx4 v197, s[24:27], s65 offen lds
    s_add_u32 m0, s82, 98304
    s_mov_b32 s65, 0
    buffer_load_dwordx4 v194, s[12:15], s65 offen nt lds
    s_add_u32 m0, s82, 102400
    s_mov_b32 s65, 393216
    buffer_load_dwordx4 v194, s[12:15], s65 offen nt lds
    s_add_u32 m0, s82, 106496
    s_mov_b32 s65, 786432
    buffer_load_dwordx4 v194, s[12:15], s65 offen nt lds
    s_add_u32 m0, s82, 110592
    s_mov_b32 s65, 1179648
    buffer_load_dwordx4 v194, s[12:15], s65 offen nt lds
    s_add_u32 m0, s82, 114688
    s_mov_b32 s65, 1572864
    buffer_load_dwordx4 v194, s[12:15], s65 offen nt lds
    s_add_u32 m0, s82, 118784
    s_mov_b32 s65, 1966080
    buffer_load_dwordx4 v194, s[12:15], s65 offen nt lds
    s_add_u32 m0, s82, 122880
    s_mov_b32 s65, 2359296
    buffer_load_dwordx4 v194, s[12:15], s65 offen nt lds
    s_add_u32 m0, s82, 126976
    s_mov_b32 s65, 2752512
    buffer_load_dwordx4 v194, s[12:15], s65 offen nt lds
    s_add_u32 m0, s82, 131072
    s_mov_b32 s65, 3145728
    buffer_load_dwordx4 v194, s[12:15], s65 offen nt lds
    s_add_u32 m0, s82, 135168
    s_mov_b32 s65, 3538944
    buffer_load_dwordx4 v194, s[12:15], s65 offen nt lds
    s_add_u32 m0, s82, 139264
    s_mov_b32 s65, 3932160
    buffer_load_dwordx4 v194, s[12:15], s65 offen nt lds
    s_add_u32 m0, s82, 143360
    s_mov_b32 s65, 4325376
    buffer_load_dwordx4 v194, s[12:15], s65 offen nt lds
    v_bfe_u32 v196, v1, 2, 2
    v_lshl_add_u32 v195, v86, 3, v196
    v_lshlrev_b32 v195, 7, v195
    v_lshl_add_u32 v195, v198, 3, v195
    s_lshl_b32 s64, s60, 5
    v_add_u32 v195, s64, v195
    v_lshrrev_b32 v199, 5, v1
    v_lshlrev_b32 v199, 4, v199
    v_lshl_add_u32 v199, v85, 3, v199
    v_and_b32 v88, 1, v86
    v_lshl_add_u32 v199, v88, 2, v199
    v_bfe_u32 v88, v1, 2, 1
    v_add_u32 v199, v199, v88
    v_lshlrev_b32 v199, 6, v199
    v_lshl_add_u32 v199, v198, 3, v199
    v_add_u32 v199, s83, v199
    s_waitcnt vmcnt(32)
    s_waitcnt lgkmcnt(0)
    s_barrier
    s_add_u32 m0, s82, 147456
    s_mov_b32 s65, 4718592
    buffer_load_dwordx4 v194, s[12:15], s65 offen nt lds
    s_add_u32 m0, s82, 151552
    s_mov_b32 s65, 5111808
    buffer_load_dwordx4 v194, s[12:15], s65 offen nt lds
    s_add_u32 m0, s82, 155648
    s_mov_b32 s65, 5505024
    buffer_load_dwordx4 v194, s[12:15], s65 offen nt lds
    s_add_u32 m0, s82, 159744
    s_mov_b32 s65, 5898240
    buffer_load_dwordx4 v194, s[12:15], s65 offen nt lds
    v_add_u32 v196, 0, v199
    ds_read_b64_tr_b16 a[240:241], v196 offset:0
    ds_read_b64_tr_b16 a[242:243], v196 offset:128
    ds_read_b64_tr_b16 a[244:245], v196 offset:2048
    ds_read_b64_tr_b16 a[246:247], v196 offset:2176
    ds_read_b64_tr_b16 a[248:249], v196 offset:32
    ds_read_b64_tr_b16 a[250:251], v196 offset:160
    ds_read_b64_tr_b16 a[252:253], v196 offset:2080
    ds_read_b64_tr_b16 a[254:255], v196 offset:2208
    s_waitcnt vmcnt(32)
    s_waitcnt lgkmcnt(0)
    s_barrier
    s_add_u32 m0, s82, 0
    s_mov_b32 s65, 6291456
    buffer_load_dwordx4 v194, s[12:15], s65 offen nt lds
    s_add_u32 m0, s82, 4096
    s_mov_b32 s65, 6684672
    buffer_load_dwordx4 v194, s[12:15], s65 offen nt lds
    s_add_u32 m0, s82, 8192
    s_mov_b32 s65, 7077888
    buffer_load_dwordx4 v194, s[12:15], s65 offen nt lds
    s_add_u32 m0, s82, 12288
    s_mov_b32 s65, 7471104
    buffer_load_dwordx4 v194, s[12:15], s65 offen nt lds
    v_add_u32 v196, 16384, v199
    ds_read_b64_tr_b16 v[4:5], v196 offset:0
    ds_read_b64_tr_b16 v[6:7], v196 offset:128
    ds_read_b64_tr_b16 v[8:9], v196 offset:2048
    ds_read_b64_tr_b16 v[10:11], v196 offset:2176
    ds_read_b64_tr_b16 v[12:13], v196 offset:32
    ds_read_b64_tr_b16 v[14:15], v196 offset:160
    ds_read_b64_tr_b16 v[16:17], v196 offset:2080
    ds_read_b64_tr_b16 v[18:19], v196 offset:2208
    s_waitcnt vmcnt(32)
    s_waitcnt lgkmcnt(0)
    s_barrier
    s_add_u32 m0, s82, 16384
    s_mov_b32 s65, 0
    buffer_load_dwordx4 v194, s[16:19], s65 offen nt lds
    s_add_u32 m0, s82, 20480
    s_mov_b32 s65, 393216
    buffer_load_dwordx4 v194, s[16:19], s65 offen nt lds
    s_add_u32 m0, s82, 24576
    s_mov_b32 s65, 786432
    buffer_load_dwordx4 v194, s[16:19], s65 offen nt lds
    s_add_u32 m0, s82, 28672
    s_mov_b32 s65, 1179648
    buffer_load_dwordx4 v194, s[16:19], s65 offen nt lds
    v_add_u32 v196, 32768, v199
    ds_read_b64_tr_b16 v[20:21], v196 offset:0
    ds_read_b64_tr_b16 v[22:23], v196 offset:128
    ds_read_b64_tr_b16 v[24:25], v196 offset:2048
    ds_read_b64_tr_b16 v[26:27], v196 offset:2176
    ds_read_b64_tr_b16 v[28:29], v196 offset:32
    ds_read_b64_tr_b16 v[30:31], v196 offset:160
    ds_read_b64_tr_b16 v[32:33], v196 offset:2080
    ds_read_b64_tr_b16 v[34:35], v196 offset:2208
    s_waitcnt vmcnt(32)
    s_waitcnt lgkmcnt(0)
    s_barrier
    s_add_u32 m0, s82, 32768
    s_mov_b32 s65, 1572864
    buffer_load_dwordx4 v194, s[16:19], s65 offen nt lds
    s_add_u32 m0, s82, 36864
    s_mov_b32 s65, 1966080
    buffer_load_dwordx4 v194, s[16:19], s65 offen nt lds
    s_add_u32 m0, s82, 40960
    s_mov_b32 s65, 2359296
    buffer_load_dwordx4 v194, s[16:19], s65 offen nt lds
    s_add_u32 m0, s82, 45056
    s_mov_b32 s65, 2752512
    buffer_load_dwordx4 v194, s[16:19], s65 offen nt lds
    v_add_u32 v196, 49152, v199
    ds_read_b64_tr_b16 v[36:37], v196 offset:0
    ds_read_b64_tr_b16 v[38:39], v196 offset:128
    ds_read_b64_tr_b16 v[40:41], v196 offset:2048
    ds_read_b64_tr_b16 v[42:43], v196 offset:2176
    ds_read_b64_tr_b16 v[44:45], v196 offset:32
    ds_read_b64_tr_b16 v[46:47], v196 offset:160
    ds_read_b64_tr_b16 v[48:49], v196 offset:2080
    ds_read_b64_tr_b16 v[50:51], v196 offset:2208
    s_waitcnt vmcnt(32)
    s_waitcnt lgkmcnt(0)
    s_barrier
    s_add_u32 m0, s82, 49152
    s_mov_b32 s65, 3145728
    buffer_load_dwordx4 v194, s[16:19], s65 offen nt lds
    s_add_u32 m0, s82, 53248
    s_mov_b32 s65, 3538944
    buffer_load_dwordx4 v194, s[16:19], s65 offen nt lds
    s_add_u32 m0, s82, 57344
    s_mov_b32 s65, 3932160
    buffer_load_dwordx4 v194, s[16:19], s65 offen nt lds
    s_add_u32 m0, s82, 61440
    s_mov_b32 s65, 4325376
    buffer_load_dwordx4 v194, s[16:19], s65 offen nt lds
    s_cmp_lg_u32 s68, 0
    s_cbranch_scc1 Larr0_10
    s_cmp_lg_u32 s60, 0
    s_cbranch_scc1 Lcnt_11
    s_mov_b64 exec, 1
    v_mov_b32 v3, 0x80000000
    v_cmp_ne_u32 vcc, 255, v2
    s_nop 1
    v_cndmask_b32 v3, 4, v3, vcc
    buffer_store_dword v2, v3, s[8:11], 0 offen offset:128 sc1
    s_mov_b64 exec, -1
Lcnt_11:
Larr0_10:
    v_add_u32 v196, 65536, v199
    ds_read_b64_tr_b16 v[52:53], v196 offset:0
    ds_read_b64_tr_b16 v[54:55], v196 offset:128
    ds_read_b64_tr_b16 v[56:57], v196 offset:2048
    ds_read_b64_tr_b16 v[58:59], v196 offset:2176
    ds_read_b64_tr_b16 v[60:61], v196 offset:32
    ds_read_b64_tr_b16 v[62:63], v196 offset:160
    ds_read_b64_tr_b16 v[64:65], v196 offset:2080
    ds_read_b64_tr_b16 v[66:67], v196 offset:2208
    s_waitcnt vmcnt(32)
    s_waitcnt lgkmcnt(0)
    s_barrier
    s_add_u32 m0, s82, 65536
    s_mov_b32 s65, 4718592
    buffer_load_dwordx4 v194, s[16:19], s65 offen nt lds
    s_add_u32 m0, s82, 69632
    s_mov_b32 s65, 5111808
    buffer_load_dwordx4 v194, s[16:19], s65 offen nt lds
    s_add_u32 m0, s82, 73728
    s_mov_b32 s65, 5505024
    buffer_load_dwordx4 v194, s[16:19], s65 offen nt lds
    s_add_u32 m0, s82, 77824
    s_mov_b32 s65, 5898240
    buffer_load_dwordx4 v194, s[16:19], s65 offen nt lds
    v_add_u32 v196, 81920, v199
    ds_read_b64_tr_b16 v[68:69], v196 offset:0
    ds_read_b64_tr_b16 v[70:71], v196 offset:128
    ds_read_b64_tr_b16 v[72:73], v196 offset:2048
    ds_read_b64_tr_b16 v[74:75], v196 offset:2176
    ds_read_b64_tr_b16 v[76:77], v196 offset:32
    ds_read_b64_tr_b16 v[78:79], v196 offset:160
    ds_read_b64_tr_b16 v[80:81], v196 offset:2080
    ds_read_b64_tr_b16 v[82:83], v196 offset:2208
    s_waitcnt vmcnt(32)
    s_waitcnt lgkmcnt(0)
    s_barrier
    s_add_u32 m0, s82, 81920
    s_mov_b32 s65, 6291456
    buffer_load_dwordx4 v194, s[16:19], s65 offen nt lds
    s_add_u32 m0, s82, 86016
    s_mov_b32 s65, 6684672
    buffer_load_dwordx4 v194, s[16:19], s65 offen nt lds
    s_add_u32 m0, s82, 90112
    s_mov_b32 s65, 7077888
    buffer_load_dwordx4 v194, s[16:19], s65 offen nt lds
    s_add_u32 m0, s82, 94208
    s_mov_b32 s65, 7471104
    buffer_load_dwordx4 v194, s[16:19], s65 offen nt lds
    v_add_u32 v196, 98304, v195
    ds_read_b64_tr_b16 a[0:1], v196 offset:0
    ds_read_b64_tr_b16 a[2:3], v196 offset:512
    ds_read_b64_tr_b16 a[4:5], v196 offset:4096
    ds_read_b64_tr_b16 a[6:7], v196 offset:4608
    ds_read_b64_tr_b16 a[8:9], v196 offset:8192
    ds_read_b64_tr_b16 a[10:11], v196 offset:8704
    ds_read_b64_tr_b16 a[12:13], v196 offset:12288
    ds_read_b64_tr_b16 a[14:15], v196 offset:12800
    s_waitcnt vmcnt(32)
    s_waitcnt lgkmcnt(0)
    s_barrier
    s_add_u32 m0, s82, 98304
    s_mov_b32 s65, 0
    buffer_load_dwordx4 v194, s[20:23], s65 offen nt lds
    s_add_u32 m0, s82, 102400
    s_mov_b32 s65, 393216
    buffer_load_dwordx4 v194, s[20:23], s65 offen nt lds
    s_add_u32 m0, s82, 106496
    s_mov_b32 s65, 786432
    buffer_load_dwordx4 v194, s[20:23], s65 offen nt lds
    s_add_u32 m0, s82, 110592
    s_mov_b32 s65, 1179648
    buffer_load_dwordx4 v194, s[20:23], s65 offen nt lds
    buffer_load_dwordx3 v[216:218], off, s[8:11], 0 offset:132 sc1
    v_add_u32 v196, 114688, v195
    ds_read_b64_tr_b16 a[16:17], v196 offset:0
    ds_read_b64_tr_b16 a[18:19], v196 offset:512
    ds_read_b64_tr_b16 a[20:21], v196 offset:4096
    ds_read_b64_tr_b16 a[22:23], v196 offset:4608
    ds_read_b64_tr_b16 a[24:25], v196 offset:8192
    ds_read_b64_tr_b16 a[26:27], v196 offset:8704
    ds_read_b64_tr_b16 a[28:29], v196 offset:12288
    ds_read_b64_tr_b16 a[30:31], v196 offset:12800
    s_waitcnt vmcnt(32)
    s_waitcnt lgkmcnt(0)
    s_barrier
    s_add_u32 m0, s82, 114688
    s_mov_b32 s65, 1572864
    buffer_load_dwordx4 v194, s[20:23], s65 offen nt lds
    s_add_u32 m0, s82, 118784
    s_mov_b32 s65, 1966080
    buffer_load_dwordx4 v194, s[20:23], s65 offen nt lds
    s_add_u32 m0, s82, 122880
    s_mov_b32 s65, 2359296
    buffer_load_dwordx4 v194, s[20:23], s65 offen nt lds
    s_add_u32 m0, s82, 126976
    s_mov_b32 s65, 2752512
    buffer_load_dwordx4 v194, s[20:23], s65 offen nt lds
    v_add_u32 v196, 131072, v195
    ds_read_b64_tr_b16 a[32:33], v196 offset:0
    ds_read_b64_tr_b16 a[34:35], v196 offset:512
    ds_read_b64_tr_b16 a[36:37], v196 offset:4096
    ds_read_b64_tr_b16 a[38:39], v196 offset:4608
    ds_read_b64_tr_b16 a[40:41], v196 offset:8192
    ds_read_b64_tr_b16 a[42:43], v196 offset:8704
    ds_read_b64_tr_b16 a[44:45], v196 offset:12288
    ds_read_b64_tr_b16 a[46:47], v196 offset:12800
    s_waitcnt vmcnt(32)
    s_waitcnt lgkmcnt(0)
    s_barrier
    s_add_u32 m0, s82, 131072
    s_mov_b32 s65, 3145728
    buffer_load_dwordx4 v194, s[20:23], s65 offen nt lds
    s_add_u32 m0, s82, 135168
    s_mov_b32 s65, 3538944
    buffer_load_dwordx4 v194, s[20:23], s65 offen nt lds
    s_add_u32 m0, s82, 139264
    s_mov_b32 s65, 3932160
    buffer_load_dwordx4 v194, s[20:23], s65 offen nt lds
    s_add_u32 m0, s82, 143360
    s_mov_b32 s65, 4325376
    buffer_load_dwordx4 v194, s[20:23], s65 offen nt lds
    v_add_u32 v196, 147456, v195
    ds_read_b64_tr_b16 a[48:49], v196 offset:0
    ds_read_b64_tr_b16 a[50:51], v196 offset:512
    ds_read_b64_tr_b16 a[52:53], v196 offset:4096
    ds_read_b64_tr_b16 a[54:55], v196 offset:4608
    ds_read_b64_tr_b16 a[56:57], v196 offset:8192
    ds_read_b64_tr_b16 a[58:59], v196 offset:8704
    ds_read_b64_tr_b16 a[60:61], v196 offset:12288
    ds_read_b64_tr_b16 a[62:63], v196 offset:12800
    s_waitcnt vmcnt(32)
    s_waitcnt lgkmcnt(0)
    s_barrier
    s_add_u32 m0, s82, 147456
    s_mov_b32 s65, 4718592
    buffer_load_dwordx4 v194, s[20:23], s65 offen nt lds
    s_add_u32 m0, s82, 151552
    s_mov_b32 s65, 5111808
    buffer_load_dwordx4 v194, s[20:23], s65 offen nt lds
    s_add_u32 m0, s82, 155648
    s_mov_b32 s65, 5505024
    buffer_load_dwordx4 v194, s[20:23], s65 offen nt lds
    s_add_u32 m0, s82, 159744
    s_mov_b32 s65, 5898240
    buffer_load_dwordx4 v194, s[20:23], s65 offen nt lds
    v_add_u32 v196, 0, v195
    ds_read_b64_tr_b16 a[64:65], v196 offset:0
    ds_read_b64_tr_b16 a[66:67], v196 offset:512
    ds_read_b64_tr_b16 a[68:69], v196 offset:4096
    ds_read_b64_tr_b16 a[70:71], v196 offset:4608
    ds_read_b64_tr_b16 a[72:73], v196 offset:8192
    ds_read_b64_tr_b16 a[74:75], v196 offset:8704
    ds_read_b64_tr_b16 a[76:77], v196 offset:12288
    ds_read_b64_tr_b16 a[78:79], v196 offset:12800
    s_waitcnt vmcnt(32)
    s_waitcnt lgkmcnt(0)
    s_barrier
    s_add_u32 m0, s82, 0
    s_mov_b32 s65, 6291456
    buffer_load_dwordx4 v194, s[20:23], s65 offen nt lds
    s_add_u32 m0, s82, 4096
    s_mov_b32 s65, 6684672
    buffer_load_dwordx4 v194, s[20:23], s65 offen nt lds
    s_add_u32 m0, s82, 8192
    s_mov_b32 s65, 7077888
    buffer_load_dwordx4 v194, s[20:23], s65 offen nt lds
    s_add_u32 m0, s82, 12288
    s_mov_b32 s65, 7471104
    buffer_load_dwordx4 v194, s[20:23], s65 offen nt lds
    v_add_u32 v196, 16384, v195
    ds_read_b64_tr_b16 a[80:81], v196 offset:0
    ds_read_b64_tr_b16 a[82:83], v196 offset:512
    ds_read_b64_tr_b16 a[84:85], v196 offset:4096
    ds_read_b64_tr_b16 a[86:87], v196 offset:4608
    ds_read_b64_tr_b16 a[88:89], v196 offset:8192
    ds_read_b64_tr_b16 a[90:91], v196 offset:8704
    ds_read_b64_tr_b16 a[92:93], v196 offset:12288
    ds_read_b64_tr_b16 a[94:95], v196 offset:12800
    s_waitcnt vmcnt(32)
    s_waitcnt lgkmcnt(0)
    s_barrier
    v_add_u32 v196, 32768, v195
    ds_read_b64_tr_b16 a[96:97], v196 offset:0
    ds_read_b64_tr_b16 a[98:99], v196 offset:512
    ds_read_b64_tr_b16 a[100:101], v196 offset:4096
    ds_read_b64_tr_b16 a[102:103], v196 offset:4608
    ds_read_b64_tr_b16 a[104:105], v196 offset:8192
    ds_read_b64_tr_b16 a[106:107], v196 offset:8704
    ds_read_b64_tr_b16 a[108:109], v196 offset:12288
    ds_read_b64_tr_b16 a[110:111], v196 offset:12800
    s_waitcnt vmcnt(28)
    s_waitcnt lgkmcnt(0)
    s_barrier
    v_add_u32 v196, 49152, v195
    ds_read_b64_tr_b16 a[112:113], v196 offset:0
    ds_read_b64_tr_b16 a[114:115], v196 offset:512
    ds_read_b64_tr_b16 a[116:117], v196 offset:4096
    ds_read_b64_tr_b16 a[118:119], v196 offset:4608
    ds_read_b64_tr_b16 a[120:121], v196 offset:8192
    ds_read_b64_tr_b16 a[122:123], v196 offset:8704
    ds_read_b64_tr_b16 a[124:125], v196 offset:12288
    ds_read_b64_tr_b16 a[126:127], v196 offset:12800
    s_waitcnt vmcnt(24)
    s_waitcnt lgkmcnt(0)
    s_barrier
    v_add_u32 v196, 65536, v195
    ds_read_b64_tr_b16 a[128:129], v196 offset:0
    ds_read_b64_tr_b16 a[130:131], v196 offset:512
    ds_read_b64_tr_b16 a[132:133], v196 offset:4096
    ds_read_b64_tr_b16 a[134:135], v196 offset:4608
    ds_read_b64_tr_b16 a[136:137], v196 offset:8192
    ds_read_b64_tr_b16 a[138:139], v196 offset:8704
    ds_read_b64_tr_b16 a[140:141], v196 offset:12288
    ds_read_b64_tr_b16 a[142:143], v196 offset:12800
Lgchk_12:
    s_waitcnt vmcnt(16)
    v_min_u32 v214, v216, v218
    v_cmp_eq_u32 vcc, 0, v214
    s_cbranch_vccnz Lgrty_13
    s_waitcnt vmcnt(20)
    s_waitcnt lgkmcnt(0)
    s_barrier
    v_mul_u32_u24 v200, 1280, v84
    v_lshrrev_b32 v201, 4, v0
    v_lshl_add_u32 v200, v201, 5, v200
    v_lshl_add_u32 v200, v85, 2, v200
    buffer_load_dword v202, v200, s[28:31], 0 offen offset:0
    buffer_load_dword v203, v200, s[28:31], 0 offen offset:8
    buffer_load_dword v204, v200, s[28:31], 0 offen offset:16
    buffer_load_dword v205, v200, s[28:31], 0 offen offset:24
    buffer_load_dword v206, v200, s[28:31], 0 offen offset:512
    buffer_load_dword v207, v200, s[28:31], 0 offen offset:520
    buffer_load_dword v208, v200, s[28:31], 0 offen offset:528
    buffer_load_dword v209, v200, s[28:31], 0 offen offset:536
    buffer_load_dword v210, v200, s[28:31], 0 offen offset:1024
    buffer_load_dword v211, v200, s[28:31], 0 offen offset:1032
    buffer_load_dword v212, v200, s[28:31], 0 offen offset:1040
    buffer_load_dword v213, v200, s[28:31], 0 offen offset:1048
    s_cmp_eq_u32 s68, 0
    s_cbranch_scc1 Lt0_14
    s_waitcnt vmcnt(0)
    s_branch Lt0_15
Lt0_14:
    s_add_u32 m0, s73, 0
    s_add_u32 s94, s74, 0
    buffer_load_dwordx4 v234, s[4:7], s94 offen sc1 lds
    s_add_u32 m0, s73, 4096
    s_add_u32 s94, s74, 4096
    buffer_load_dwordx4 v234, s[4:7], s94 offen sc1 lds
    s_add_u32 m0, s73, 8192
    s_add_u32 s94, s74, 16384
    buffer_load_dwordx4 v234, s[4:7], s94 offen sc1 lds
    s_add_u32 m0, s73, 12288
    s_add_u32 s94, s74, 20480
    buffer_load_dwordx4 v234, s[4:7], s94 offen sc1 lds
    s_add_u32 m0, s73, 16384
    s_add_u32 s94, s74, 32768
    buffer_load_dwordx4 v234, s[4:7], s94 offen sc1 lds
    s_add_u32 m0, s73, 20480
    s_add_u32 s94, s74, 36864
    buffer_load_dwordx4 v234, s[4:7], s94 offen sc1 lds
    s_add_u32 m0, s73, 24576
    s_add_u32 s94, s74, 49152
    buffer_load_dwordx4 v234, s[4:7], s94 offen sc1 lds
    s_add_u32 m0, s73, 28672
    s_add_u32 s94, s74, 53248
    buffer_load_dwordx4 v234, s[4:7], s94 offen sc1 lds
    s_add_u32 m0, s73, 32768
    s_add_u32 s94, s74, 65536
    buffer_load_dwordx4 v234, s[4:7], s94 offen sc1 lds
    s_add_u32 m0, s73, 36864
    s_add_u32 s94, s74, 69632
    buffer_load_dwordx4 v234, s[4:7], s94 offen sc1 lds
Lt0_15:
    v_add_u32 v196, 81920, v195
    ds_read_b64_tr_b16 a[144:145], v196 offset:0
    ds_read_b64_tr_b16 a[146:147], v196 offset:512
    ds_read_b64_tr_b16 a[148:149], v196 offset:4096
    ds_read_b64_tr_b16 a[150:151], v196 offset:4608
    ds_read_b64_tr_b16 a[152:153], v196 offset:8192
    ds_read_b64_tr_b16 a[154:155], v196 offset:8704
    ds_read_b64_tr_b16 a[156:157], v196 offset:12288
    ds_read_b64_tr_b16 a[158:159], v196 offset:12800
    s_waitcnt vmcnt(38)
    s_waitcnt lgkmcnt(0)
    s_barrier
    v_add_u32 v196, 98304, v195
    ds_read_b64_tr_b16 a[160:161], v196 offset:0
    ds_read_b64_tr_b16 a[162:163], v196 offset:512
    ds_read_b64_tr_b16 a[164:165], v196 offset:4096
    ds_read_b64_tr_b16 a[166:167], v196 offset:4608
    ds_read_b64_tr_b16 a[168:169], v196 offset:8192
    ds_read_b64_tr_b16 a[170:171], v196 offset:8704
    ds_read_b64_tr_b16 a[172:173], v196 offset:12288
    ds_read_b64_tr_b16 a[174:175], v196 offset:12800
    s_waitcnt vmcnt(34)
    s_waitcnt lgkmcnt(0)
    s_barrier
    v_add_u32 v196, 114688, v195
    ds_read_b64_tr_b16 a[176:177], v196 offset:0
    ds_read_b64_tr_b16 a[178:179], v196 offset:512
    ds_read_b64_tr_b16 a[180:181], v196 offset:4096
    ds_read_b64_tr_b16 a[182:183], v196 offset:4608
    ds_read_b64_tr_b16 a[184:185], v196 offset:8192
    ds_read_b64_tr_b16 a[186:187], v196 offset:8704
    ds_read_b64_tr_b16 a[188:189], v196 offset:12288
    ds_read_b64_tr_b16 a[190:191], v196 offset:12800
    s_waitcnt vmcnt(30)
    s_waitcnt lgkmcnt(0)
    s_barrier
    v_add_u32 v196, 131072, v195
    ds_read_b64_tr_b16 a[192:193], v196 offset:0
    ds_read_b64_tr_b16 a[194:195], v196 offset:512
    ds_read_b64_tr_b16 a[196:197], v196 offset:4096
    ds_read_b64_tr_b16 a[198:199], v196 offset:4608
    ds_read_b64_tr_b16 a[200:201], v196 offset:8192
    ds_read_b64_tr_b16 a[202:203], v196 offset:8704
    ds_read_b64_tr_b16 a[204:205], v196 offset:12288
    ds_read_b64_tr_b16 a[206:207], v196 offset:12800
    s_waitcnt vmcnt(26)
    s_waitcnt lgkmcnt(0)
    s_barrier
    v_add_u32 v196, 147456, v195
    ds_read_b64_tr_b16 a[208:209], v196 offset:0
    ds_read_b64_tr_b16 a[210:211], v196 offset:512
    ds_read_b64_tr_b16 a[212:213], v196 offset:4096
    ds_read_b64_tr_b16 a[214:215], v196 offset:4608
    ds_read_b64_tr_b16 a[216:217], v196 offset:8192
    ds_read_b64_tr_b16 a[218:219], v196 offset:8704
    ds_read_b64_tr_b16 a[220:221], v196 offset:12288
    ds_read_b64_tr_b16 a[222:223], v196 offset:12800
    s_waitcnt vmcnt(22)
    s_waitcnt lgkmcnt(0)
    s_barrier
    v_add_u32 v196, 0, v195
    ds_read_b64_tr_b16 a[224:225], v196 offset:0
    ds_read_b64_tr_b16 a[226:227], v196 offset:512
    ds_read_b64_tr_b16 a[228:229], v196 offset:4096
    ds_read_b64_tr_b16 a[230:231], v196 offset:4608
    ds_read_b64_tr_b16 a[232:233], v196 offset:8192
    ds_read_b64_tr_b16 a[234:235], v196 offset:8704
    ds_read_b64_tr_b16 a[236:237], v196 offset:12288
    ds_read_b64_tr_b16 a[238:239], v196 offset:12800
    s_waitcnt lgkmcnt(0)
    s_barrier
    v_readfirstlane_b32 s1, v218
    s_cmp_gt_u32 s1, 17
    s_cselect_b32 s1, 1, 0
    s_xor_b32 s1, s1, s68
    s_lshl_b32 s1, s1, 13
    s_lshl_b32 s93, s68, 13
    s_xor_b32 s64, s1, 0x2000
    v_add_u32 v251, s64, v251
    s_lshr_b32 s74, s91, 8
    s_xor_b32 s74, s74, s1
    s_and_b32 s74, s74, s93
    s_or_b32 s74, s74, s91
    s_add_u32 s91, s91, 131072
    s_lshr_b32 s92, s91, 8
    s_xor_b32 s92, s92, s1
    s_and_b32 s92, s92, s93
    s_or_b32 s92, s92, s91
    v_and_b32 v252, 3, v0
    v_mov_b32 v88, 31
    v_lshl_add_u32 v252, v88, 2, v252
    v_lshlrev_b32 v252, 7, v252
    v_bfe_u32 v88, v0, 4, 2
    v_cmp_eq_u32 vcc, s69, v88
    s_xor_b32 s64, s1, 0x2000
    s_add_u32 s64, s64, 14798848
    v_lshl_add_u32 v88, v88, 18, s64
    v_add_u32 v252, v252, v88
    v_lshrrev_b32 v88, 2, v1
    v_and_b32 v88, 12, v88
    v_and_b32 v89, 3, v1
    v_add_u32 v88, v88, v89
    s_lshl_b32 s64, s58, 14
    s_add_u32 s64, s64, 8400896
    v_lshl_add_u32 v88, v88, 7, s64
    v_bfe_u32 v89, v1, 2, 1
    v_and_b32 v89, s68, v89
    v_cmp_eq_u32 vcc, 1, v89
    s_nop 1
    v_cndmask_b32 v252, v88, v252, vcc
    v_mov_b32 v88, -12
    v_cndmask_b32 v225, v88, 8, vcc
    v_mov_b32 v194, 0x80000000
    s_cmp_lt_u32 s59, 20
    s_cselect_b32 s87, -2, -1
    s_cselect_b64 vcc, -1, 0
    v_mov_b32 v192, -1
    v_cndmask_b32 v193, 0, 1, vcc
    v_cndmask_b32 v250, v194, v250, vcc
    v_cndmask_b32 v251, v194, v251, vcc
    s_cmp_eq_u32 s60, 2
    s_cselect_b64 vcc, -1, 0
    v_cndmask_b32 v252, v194, v252, vcc
    v_cmp_ne_u32 s[96:97], 0, v1
    s_nop 1
    v_cndmask_b32 v1, 0, v194, s[96:97]
    v_mov_b32 v194, -1000
    v_cndmask_b32 v225, v194, v225, vcc
    v_mov_b64 v[194:195], 0
    v_mov_b64 v[196:197], 0
    ds_write_b128 v234, v[194:197] offset:14336
    s_waitcnt vmcnt(18)
    ds_write_b128 v234, v[202:205] offset:0
    s_waitcnt vmcnt(14)
    ds_write_b128 v234, v[206:209] offset:4096
    s_waitcnt vmcnt(10)
    ds_write_b128 v234, v[210:213] offset:8192
    s_cmp_lg_u32 s60, 1
    s_cbranch_scc1 Lcnt_17
    s_mov_b64 exec, 1
    v_mov_b32 v216, 1
    buffer_atomic_add v216, off, s[8:11], 0 offset:68 sc0
    s_mov_b64 exec, -1
Lcnt_17:
    s_cmp_eq_u32 s68, 0
    s_cbranch_scc1 Lt0_16
    buffer_load_dword v2, v252, s[4:7], 0 offen sc1
    v_lshl_add_u32 v3, s62, 1, v225
    v_add_u32 v3, -6, v3
    v_min_i32 v3, 128, v3
Lfchk_18:
    s_waitcnt vmcnt(0)
    v_cmp_gt_i32 vcc, v3, v2
    s_cbranch_vccnz Lfrty_19
    s_waitcnt lgkmcnt(0)
    s_barrier
    s_add_u32 m0, s73, 0
    s_add_u32 s94, s74, 0
    buffer_load_dwordx4 v234, s[4:7], s94 offen sc1 lds
    s_add_u32 m0, s73, 4096
    s_add_u32 s94, s74, 4096
    buffer_load_dwordx4 v234, s[4:7], s94 offen sc1 lds
    s_add_u32 m0, s73, 8192
    s_add_u32 s94, s74, 16384
    buffer_load_dwordx4 v234, s[4:7], s94 offen sc1 lds
    s_add_u32 m0, s73, 12288
    s_add_u32 s94, s74, 20480
    buffer_load_dwordx4 v234, s[4:7], s94 offen sc1 lds
    s_add_u32 m0, s73, 16384
    s_add_u32 s94, s74, 32768
    buffer_load_dwordx4 v234, s[4:7], s94 offen sc1 lds
    s_add_u32 m0, s73, 20480
    s_add_u32 s94, s74, 36864
    buffer_load_dwordx4 v234, s[4:7], s94 offen sc1 lds
    s_add_u32 m0, s73, 24576
    s_add_u32 s94, s74, 49152
    buffer_load_dwordx4 v234, s[4:7], s94 offen sc1 lds
    s_add_u32 m0, s73, 28672
    s_add_u32 s94, s74, 53248
    buffer_load_dwordx4 v234, s[4:7], s94 offen sc1 lds
    s_add_u32 m0, s73, 32768
    s_add_u32 s94, s74, 65536
    buffer_load_dwordx4 v234, s[4:7], s94 offen sc1 lds
    s_add_u32 m0, s73, 36864
    s_add_u32 s94, s74, 69632
    buffer_load_dwordx4 v234, s[4:7], s94 offen sc1 lds
    buffer_load_dword v2, v252, s[4:7], 0 offen sc1
    s_waitcnt vmcnt(0)
    v_lshl_add_u32 v3, s62, 1, v225
    v_add_u32 v3, -4, v3
    v_min_i32 v3, 128, v3
Lfchk_20:
    v_cmp_gt_i32 vcc, v3, v2
    s_cbranch_vccnz Lfrty_21
Lt0_16:
    s_cmp_lg_u32 s60, 1
    s_cbranch_scc1 Lt0_16a
    s_waitcnt vmcnt(1)
    s_branch Lt0_16b
Lt0_16a:
    s_waitcnt vmcnt(0)
Lt0_16b:
    s_waitcnt lgkmcnt(0)
    s_barrier
    ds_read_b128 v[124:127], v232 offset:0
    ds_read_b128 v[128:131], v232 offset:20480
    ds_read_b128 v[132:135], v233 offset:0
    ds_read_b128 v[136:139], v233 offset:20480
    ds_read_b128 v[140:143], v232 offset:1024
    s_mov_b32 s74, s92
    s_xor_b32 s73, s73, 65536
    s_add_u32 s91, s91, 131072
    s_lshr_b32 s92, s91, 8
    s_xor_b32 s92, s92, s1
    s_and_b32 s92, s92, s93
    s_or_b32 s92, s92, s91
    s_waitcnt lgkmcnt(4)
    v_mfma_f32_16x16x32_bf16 v[148:151], a[0:3], v[124:127], 0
    ds_read_b128 v[144:147], v232 offset:21504
    v_mov_b64 v[194:195], 0
    v_mfma_f32_16x16x32_bf16 v[156:159], a[80:83], v[124:127], 0
    v_mov_b64 v[196:197], 0
    v_mov_b64 v[198:199], 0
    v_mfma_f32_16x16x32_bf16 v[164:167], v[124:127], a[160:163], 0
    s_waitcnt lgkmcnt(4)
    v_mov_b64 v[200:201], 0
    v_mov_b64 v[202:203], 0
    v_mfma_f32_16x16x32_bf16 v[152:155], a[0:3], v[128:131], 0
    ds_read_b128 v[124:127], v233 offset:1024
    v_mov_b64 v[204:205], 0
    v_mfma_f32_16x16x32_bf16 v[160:163], a[80:83], v[128:131], 0
    s_add_u32 m0, s73, 0
    s_add_u32 s94, s74, 0
    buffer_load_dwordx4 v234, s[4:7], s94 offen sc1 lds
    v_mfma_f32_16x16x32_bf16 v[168:171], v[128:131], a[160:163], 0
    s_waitcnt lgkmcnt(4)
    v_mfma_f32_16x16x32_bf16 v[148:151], a[4:7], v[132:135], v[148:151]
    ds_read_b128 v[128:131], v233 offset:21504
    v_mfma_f32_16x16x32_bf16 v[156:159], a[84:87], v[132:135], v[156:159]
    s_add_u32 m0, s73, 4096
    s_add_u32 s94, s74, 4096
    buffer_load_dwordx4 v234, s[4:7], s94 offen sc1 lds
    v_mfma_f32_16x16x32_bf16 v[164:167], v[132:135], a[164:167], v[164:167]
    s_waitcnt lgkmcnt(4)
    v_mfma_f32_16x16x32_bf16 v[152:155], a[4:7], v[136:139], v[152:155]
    ds_read_b128 v[132:135], v232 offset:2048
    v_mfma_f32_16x16x32_bf16 v[160:163], a[84:87], v[136:139], v[160:163]
    s_add_u32 m0, s73, 8192
    s_add_u32 s94, s74, 16384
    buffer_load_dwordx4 v234, s[4:7], s94 offen sc1 lds
    v_mfma_f32_16x16x32_bf16 v[168:171], v[136:139], a[164:167], v[168:171]
    s_waitcnt lgkmcnt(4)
    v_mfma_f32_16x16x32_bf16 v[148:151], a[8:11], v[140:143], v[148:151]
    ds_read_b128 v[136:139], v232 offset:22528
    v_mfma_f32_16x16x32_bf16 v[156:159], a[88:91], v[140:143], v[156:159]
    s_add_u32 m0, s73, 12288
    s_add_u32 s94, s74, 20480
    buffer_load_dwordx4 v234, s[4:7], s94 offen sc1 lds
    v_mfma_f32_16x16x32_bf16 v[164:167], v[140:143], a[168:171], v[164:167]
    s_waitcnt lgkmcnt(4)
    v_mfma_f32_16x16x32_bf16 v[152:155], a[8:11], v[144:147], v[152:155]
    ds_read_b128 v[140:143], v233 offset:2048
    v_mfma_f32_16x16x32_bf16 v[160:163], a[88:91], v[144:147], v[160:163]
    s_add_u32 m0, s73, 16384
    s_add_u32 s94, s74, 32768
    buffer_load_dwordx4 v234, s[4:7], s94 offen sc1 lds
    v_mfma_f32_16x16x32_bf16 v[168:171], v[144:147], a[168:171], v[168:171]
    s_waitcnt lgkmcnt(4)
    v_mfma_f32_16x16x32_bf16 v[148:151], a[12:15], v[124:127], v[148:151]
    ds_read_b128 v[144:147], v233 offset:22528
    v_mfma_f32_16x16x32_bf16 v[156:159], a[92:95], v[124:127], v[156:159]
    s_add_u32 m0, s73, 20480
    s_add_u32 s94, s74, 36864
    buffer_load_dwordx4 v234, s[4:7], s94 offen sc1 lds
    v_mfma_f32_16x16x32_bf16 v[164:167], v[124:127], a[172:175], v[164:167]
    s_waitcnt lgkmcnt(4)
    v_mfma_f32_16x16x32_bf16 v[152:155], a[12:15], v[128:131], v[152:155]
    ds_read_b128 v[124:127], v232 offset:3072
    v_mfma_f32_16x16x32_bf16 v[160:163], a[92:95], v[128:131], v[160:163]
    s_add_u32 m0, s73, 24576
    s_add_u32 s94, s74, 49152
    buffer_load_dwordx4 v234, s[4:7], s94 offen sc1 lds
    v_mfma_f32_16x16x32_bf16 v[168:171], v[128:131], a[172:175], v[168:171]
    s_waitcnt lgkmcnt(4)
    v_mfma_f32_16x16x32_bf16 v[148:151], a[16:19], v[132:135], v[148:151]
    ds_read_b128 v[128:131], v232 offset:23552
    v_mfma_f32_16x16x32_bf16 v[156:159], a[96:99], v[132:135], v[156:159]
    s_add_u32 m0, s73, 28672
    s_add_u32 s94, s74, 53248
    buffer_load_dwordx4 v234, s[4:7], s94 offen sc1 lds
    v_mfma_f32_16x16x32_bf16 v[164:167], v[132:135], a[176:179], v[164:167]
    s_waitcnt lgkmcnt(4)
    v_mfma_f32_16x16x32_bf16 v[152:155], a[16:19], v[136:139], v[152:155]
    ds_read_b128 v[132:135], v233 offset:3072
    v_mfma_f32_16x16x32_bf16 v[160:163], a[96:99], v[136:139], v[160:163]
    s_add_u32 m0, s73, 32768
    s_add_u32 s94, s74, 65536
    buffer_load_dwordx4 v234, s[4:7], s94 offen sc1 lds
    v_mfma_f32_16x16x32_bf16 v[168:171], v[136:139], a[176:179], v[168:171]
    s_waitcnt lgkmcnt(4)
    v_mfma_f32_16x16x32_bf16 v[148:151], a[20:23], v[140:143], v[148:151]
    ds_read_b128 v[136:139], v233 offset:23552
    v_mfma_f32_16x16x32_bf16 v[156:159], a[100:103], v[140:143], v[156:159]
    s_add_u32 m0, s73, 36864
    s_add_u32 s94, s74, 69632
    buffer_load_dwordx4 v234, s[4:7], s94 offen sc1 lds
    v_mfma_f32_16x16x32_bf16 v[164:167], v[140:143], a[180:183], v[164:167]
    s_waitcnt lgkmcnt(4)
    v_mfma_f32_16x16x32_bf16 v[152:155], a[20:23], v[144:147], v[152:155]
    ds_read_b128 v[140:143], v232 offset:4096
    v_mfma_f32_16x16x32_bf16 v[160:163], a[100:103], v[144:147], v[160:163]
    s_mov_b32 s74, s92
    s_xor_b32 s73, s73, 65536
    s_add_u32 s91, s91, 131072
    v_mfma_f32_16x16x32_bf16 v[168:171], v[144:147], a[180:183], v[168:171]
    s_waitcnt lgkmcnt(4)
    s_lshr_b32 s92, s91, 8
    s_xor_b32 s92, s92, s1
    v_mfma_f32_16x16x32_bf16 v[148:151], a[24:27], v[124:127], v[148:151]
    s_and_b32 s92, s92, s93
    ds_read_b128 v[144:147], v232 offset:24576
    s_or_b32 s92, s92, s91
    v_mfma_f32_16x16x32_bf16 v[156:159], a[104:107], v[124:127], v[156:159]
    v_mfma_f32_16x16x32_bf16 v[164:167], v[124:127], a[184:187], v[164:167]
    s_waitcnt lgkmcnt(4)
    v_mfma_f32_16x16x32_bf16 v[152:155], a[24:27], v[128:131], v[152:155]
    ds_read_b128 v[124:127], v233 offset:4096
    v_mfma_f32_16x16x32_bf16 v[160:163], a[104:107], v[128:131], v[160:163]
    v_mfma_f32_16x16x32_bf16 v[168:171], v[128:131], a[184:187], v[168:171]
    s_waitcnt lgkmcnt(4)
    v_mfma_f32_16x16x32_bf16 v[148:151], a[28:31], v[132:135], v[148:151]
    ds_read_b128 v[128:131], v233 offset:24576
    v_mfma_f32_16x16x32_bf16 v[156:159], a[108:111], v[132:135], v[156:159]
    v_mfma_f32_16x16x32_bf16 v[164:167], v[132:135], a[188:191], v[164:167]
    s_waitcnt lgkmcnt(4)
    v_mfma_f32_16x16x32_bf16 v[152:155], a[28:31], v[136:139], v[152:155]
    ds_read_b128 v[132:135], v232 offset:5120
    v_mfma_f32_16x16x32_bf16 v[160:163], a[108:111], v[136:139], v[160:163]
    v_mfma_f32_16x16x32_bf16 v[168:171], v[136:139], a[188:191], v[168:171]
    s_waitcnt lgkmcnt(4)
    v_mfma_f32_16x16x32_bf16 v[148:151], a[32:35], v[140:143], v[148:151]
    ds_read_b128 v[136:139], v232 offset:25600
    v_mfma_f32_16x16x32_bf16 v[156:159], a[112:115], v[140:143], v[156:159]
    v_mfma_f32_16x16x32_bf16 v[164:167], v[140:143], a[192:195], v[164:167]
    s_waitcnt lgkmcnt(4)
    v_mfma_f32_16x16x32_bf16 v[152:155], a[32:35], v[144:147], v[152:155]
    ds_read_b128 v[140:143], v233 offset:5120
    v_mfma_f32_16x16x32_bf16 v[160:163], a[112:115], v[144:147], v[160:163]
    v_mfma_f32_16x16x32_bf16 v[168:171], v[144:147], a[192:195], v[168:171]
    s_waitcnt lgkmcnt(4)
    v_mfma_f32_16x16x32_bf16 v[148:151], a[36:39], v[124:127], v[148:151]
    ds_read_b128 v[144:147], v233 offset:25600
    v_mfma_f32_16x16x32_bf16 v[156:159], a[116:119], v[124:127], v[156:159]
    v_mfma_f32_16x16x32_bf16 v[164:167], v[124:127], a[196:199], v[164:167]
    s_waitcnt lgkmcnt(4)
    v_mfma_f32_16x16x32_bf16 v[152:155], a[36:39], v[128:131], v[152:155]
    ds_read_b128 v[124:127], v232 offset:6144
    v_mfma_f32_16x16x32_bf16 v[160:163], a[116:119], v[128:131], v[160:163]
    v_mfma_f32_16x16x32_bf16 v[168:171], v[128:131], a[196:199], v[168:171]
    s_waitcnt lgkmcnt(4)
    v_mfma_f32_16x16x32_bf16 v[148:151], a[40:43], v[132:135], v[148:151]
    ds_read_b128 v[128:131], v232 offset:26624
    v_mfma_f32_16x16x32_bf16 v[156:159], a[120:123], v[132:135], v[156:159]
    v_mfma_f32_16x16x32_bf16 v[164:167], v[132:135], a[200:203], v[164:167]
    s_waitcnt lgkmcnt(4)
    v_mfma_f32_16x16x32_bf16 v[152:155], a[40:43], v[136:139], v[152:155]
    ds_read_b128 v[132:135], v233 offset:6144
    v_mfma_f32_16x16x32_bf16 v[160:163], a[120:123], v[136:139], v[160:163]
    v_mfma_f32_16x16x32_bf16 v[168:171], v[136:139], a[200:203], v[168:171]
    s_waitcnt lgkmcnt(4)
    v_mfma_f32_16x16x32_bf16 v[148:151], a[44:47], v[140:143], v[148:151]
    ds_read_b128 v[136:139], v233 offset:26624
    v_mfma_f32_16x16x32_bf16 v[156:159], a[124:127], v[140:143], v[156:159]
    v_mfma_f32_16x16x32_bf16 v[164:167], v[140:143], a[204:207], v[164:167]
    s_waitcnt lgkmcnt(4)
    v_mfma_f32_16x16x32_bf16 v[152:155], a[44:47], v[144:147], v[152:155]
    ds_read_b128 v[140:143], v232 offset:7168
    v_mfma_f32_16x16x32_bf16 v[160:163], a[124:127], v[144:147], v[160:163]
    v_mfma_f32_16x16x32_bf16 v[168:171], v[144:147], a[204:207], v[168:171]
    s_waitcnt lgkmcnt(4)
    v_mfma_f32_16x16x32_bf16 v[148:151], a[48:51], v[124:127], v[148:151]
    ds_read_b128 v[144:147], v232 offset:27648
    v_mfma_f32_16x16x32_bf16 v[156:159], a[128:131], v[124:127], v[156:159]
    v_mfma_f32_16x16x32_bf16 v[164:167], v[124:127], a[208:211], v[164:167]
    s_waitcnt lgkmcnt(4)
    v_mfma_f32_16x16x32_bf16 v[152:155], a[48:51], v[128:131], v[152:155]
    ds_read_b128 v[124:127], v233 offset:7168
    v_mfma_f32_16x16x32_bf16 v[160:163], a[128:131], v[128:131], v[160:163]
    v_mfma_f32_16x16x32_bf16 v[168:171], v[128:131], a[208:211], v[168:171]
    s_waitcnt lgkmcnt(4)
    v_mfma_f32_16x16x32_bf16 v[148:151], a[52:55], v[132:135], v[148:151]
    ds_read_b128 v[128:131], v233 offset:27648
    v_mfma_f32_16x16x32_bf16 v[156:159], a[132:135], v[132:135], v[156:159]
    v_mfma_f32_16x16x32_bf16 v[164:167], v[132:135], a[212:215], v[164:167]
    s_waitcnt lgkmcnt(4)
    v_mfma_f32_16x16x32_bf16 v[152:155], a[52:55], v[136:139], v[152:155]
    ds_read_b128 v[132:135], v232 offset:8192
    v_mfma_f32_16x16x32_bf16 v[160:163], a[132:135], v[136:139], v[160:163]
    v_mfma_f32_16x16x32_bf16 v[168:171], v[136:139], a[212:215], v[168:171]
    s_waitcnt lgkmcnt(4)
    v_mfma_f32_16x16x32_bf16 v[148:151], a[56:59], v[140:143], v[148:151]
    ds_read_b128 v[136:139], v232 offset:28672
    v_mfma_f32_16x16x32_bf16 v[156:159], a[136:139], v[140:143], v[156:159]
    v_mfma_f32_16x16x32_bf16 v[164:167], v[140:143], a[216:219], v[164:167]
    s_waitcnt lgkmcnt(4)
    v_mfma_f32_16x16x32_bf16 v[152:155], a[56:59], v[144:147], v[152:155]
    ds_read_b128 v[140:143], v233 offset:8192
    v_mfma_f32_16x16x32_bf16 v[160:163], a[136:139], v[144:147], v[160:163]
    v_mfma_f32_16x16x32_bf16 v[168:171], v[144:147], a[216:219], v[168:171]
    s_waitcnt lgkmcnt(4)
    v_mfma_f32_16x16x32_bf16 v[148:151], a[60:63], v[124:127], v[148:151]
    ds_read_b128 v[144:147], v233 offset:28672
    v_mfma_f32_16x16x32_bf16 v[156:159], a[140:143], v[124:127], v[156:159]
    v_mfma_f32_16x16x32_bf16 v[164:167], v[124:127], a[220:223], v[164:167]
    s_waitcnt lgkmcnt(4)
    v_mfma_f32_16x16x32_bf16 v[152:155], a[60:63], v[128:131], v[152:155]
    ds_read_b128 v[124:127], v232 offset:9216
    v_mfma_f32_16x16x32_bf16 v[160:163], a[140:143], v[128:131], v[160:163]
    v_mfma_f32_16x16x32_bf16 v[168:171], v[128:131], a[220:223], v[168:171]
    s_waitcnt lgkmcnt(4)
    v_mfma_f32_16x16x32_bf16 v[148:151], a[64:67], v[132:135], v[148:151]
    ds_read_b128 v[128:131], v232 offset:29696
    v_mfma_f32_16x16x32_bf16 v[156:159], a[144:147], v[132:135], v[156:159]
    v_mfma_f32_16x16x32_bf16 v[164:167], v[132:135], a[224:227], v[164:167]
    s_waitcnt lgkmcnt(4)
    v_mfma_f32_16x16x32_bf16 v[152:155], a[64:67], v[136:139], v[152:155]
    ds_read_b128 v[132:135], v233 offset:9216
    v_mfma_f32_16x16x32_bf16 v[160:163], a[144:147], v[136:139], v[160:163]
    v_mfma_f32_16x16x32_bf16 v[168:171], v[136:139], a[224:227], v[168:171]
    s_waitcnt lgkmcnt(4)
    v_mfma_f32_16x16x32_bf16 v[148:151], a[68:71], v[140:143], v[148:151]
    ds_read_b128 v[136:139], v233 offset:29696
    v_mfma_f32_16x16x32_bf16 v[156:159], a[148:151], v[140:143], v[156:159]
    v_mfma_f32_16x16x32_bf16 v[164:167], v[140:143], a[228:231], v[164:167]
    s_waitcnt lgkmcnt(4)
    v_mfma_f32_16x16x32_bf16 v[152:155], a[68:71], v[144:147], v[152:155]
    v_mfma_f32_16x16x32_bf16 v[160:163], a[148:151], v[144:147], v[160:163]
    v_mfma_f32_16x16x32_bf16 v[168:171], v[144:147], a[228:231], v[168:171]
    s_waitcnt lgkmcnt(3)
    v_mfma_f32_16x16x32_bf16 v[148:151], a[72:75], v[124:127], v[148:151]
    v_mfma_f32_16x16x32_bf16 v[156:159], a[152:155], v[124:127], v[156:159]
    v_mfma_f32_16x16x32_bf16 v[164:167], v[124:127], a[232:235], v[164:167]
    s_waitcnt lgkmcnt(2)
    v_mfma_f32_16x16x32_bf16 v[152:155], a[72:75], v[128:131], v[152:155]
    v_mfma_f32_16x16x32_bf16 v[160:163], a[152:155], v[128:131], v[160:163]
    v_mfma_f32_16x16x32_bf16 v[168:171], v[128:131], a[232:235], v[168:171]
    s_waitcnt lgkmcnt(1)
    v_mfma_f32_16x16x32_bf16 v[148:151], a[76:79], v[132:135], v[148:151]
    s_lshl_b32 s72, s58, 20
    buffer_load_dword v2, v252, s[4:7], 0 offen sc1
    s_waitcnt vmcnt(0) lgkmcnt(0)
    v_lshl_add_u32 v3, s62, 1, v225
    v_add_u32 v3, -2, v3
    v_min_i32 v3, 128, v3
Lfchk_22:
    v_cmp_gt_i32 vcc, v3, v2
    s_cbranch_vccnz Lfrty_23
    s_cmp_lg_u32 s60, 1
    s_cbranch_scc1 Lcnt_24
    s_mov_b64 exec, 1
    v_mov_b32 v217, 0x80000000
    v_cmp_ne_u32 vcc, 95, v216
    s_nop 1
    v_cndmask_b32 v217, 8, v217, vcc
    buffer_store_dword v216, v217, s[8:11], 0 offen offset:128 sc1
    s_mov_b64 exec, -1
Lcnt_24:
    s_cmp_eq_u32 s60, 3
    s_cbranch_scc1 L_Cin3
    s_branch L_Cin0
Lgrty_6:
    s_sleep 16
    buffer_load_dword v2, off, s[8:11], 0 offset:136 sc1
    s_sub_u32 s61, s61, 1
    s_mov_b32 s67, 4
    s_cbranch_scc1 L_fail
    s_branch Lgchk_5
Lgrty_13:
    s_sleep 8
    buffer_load_dwordx3 v[216:218], off, s[8:11], 0 offset:132 sc1
    s_sub_u32 s61, s61, 1
    s_mov_b32 s67, 1
    s_cbranch_scc1 L_fail
    s_waitcnt vmcnt(0)
    s_branch Lgchk_12
Lfrty_19:
    s_sleep 4
    buffer_load_dword v2, v252, s[4:7], 0 offen sc1
    s_sub_u32 s61, s61, 1
    s_mov_b32 s67, 10
    s_cbranch_scc1 L_fail
    s_waitcnt vmcnt(0)
    s_branch Lfchk_18
Lfrty_21:
    s_sleep 4
    buffer_load_dword v2, v252, s[4:7], 0 offen sc1
    s_sub_u32 s61, s61, 1
    s_mov_b32 s67, 10
    s_cbranch_scc1 L_fail
    s_waitcnt vmcnt(0)
    s_branch Lfchk_20
Lfrty_23:
    s_sleep 4
    buffer_load_dword v2, v252, s[4:7], 0 offen sc1
    s_sub_u32 s61, s61, 1
    s_mov_b32 s67, 10
    s_cbranch_scc1 L_fail
    s_waitcnt vmcnt(0)
    s_branch Lfchk_22
L_Ctop3:
    s_waitcnt vmcnt(5)
    ds_write_b128 v234, v[112:115] offset:0
    s_waitcnt vmcnt(4)
    ds_write_b128 v234, v[116:119] offset:4096
    s_waitcnt vmcnt(3)
    ds_write_b64 v235, v[120:121] offset:0
    v_max3_u32 v218, v112, v114, v116
    v_max3_u32 v218, v218, v118, v120
    v_cmp_eq_u32 vcc, -1, v218
    s_cbranch_vccnz Lrty_26
Lok_25:
    s_waitcnt lgkmcnt(5)
    v_mfma_f32_16x16x32_bf16 v[152:155], a[72:75], v[128:131], v[152:155]
    v_mfma_f32_16x16x32_bf16 v[160:163], a[152:155], v[128:131], v[160:163]
    v_mfma_f32_16x16x32_bf16 v[168:171], v[128:131], a[232:235], v[168:171]
    s_waitcnt lgkmcnt(4)
    v_mfma_f32_16x16x32_bf16 v[148:151], a[76:79], v[132:135], v[148:151]
L_Cin3:
    s_waitcnt lgkmcnt(0)
    s_barrier
    ds_read_b128 v[84:87], v236 offset:0
    ds_read_b128 v[88:91], v236 offset:1024
    v_mfma_f32_16x16x32_bf16 v[156:159], a[156:159], v[132:135], v[156:159]
    s_andn2_b32 s71, s72, 524288
    ds_read_b128 v[92:95], v236 offset:2048
    ds_read_b128 v[96:99], v236 offset:3072
    v_mfma_f32_16x16x32_bf16 v[164:167], v[132:135], a[236:239], v[164:167]
    s_waitcnt vmcnt(2)
    ds_read_b128 v[100:103], v236 offset:4096
    s_waitcnt vmcnt(1)
    ds_read_b128 v[104:107], v236 offset:5120
    v_mfma_f32_16x16x32_bf16 v[152:155], a[76:79], v[136:139], v[152:155]
    s_lshr_b32 s97, s62, 1
    s_waitcnt vmcnt(0)
    ds_read_b128 v[108:111], v236 offset:6144
    ds_read_b128 v[112:115], v236 offset:7168
    v_mfma_f32_16x16x32_bf16 v[160:163], a[156:159], v[136:139], v[160:163]
    s_add_u32 s79, s71, s76
    ds_read_b128 v[116:119], v236 offset:8192
    ds_read_b128 v[120:123], v236 offset:9216
    v_mfma_f32_16x16x32_bf16 v[168:171], v[136:139], a[236:239], v[168:171]
    s_add_u32 s80, s71, s77
    s_add_u32 s81, s71, s78
    s_waitcnt lgkmcnt(9)
    v_smfmac_f32_16x16x64_bf16 v[194:197], v[84:87], a[0:7], v187
    v_xor_b32 v232, 0x10000, v232
    v_smfmac_f32_16x16x64_bf16 v[198:201], v[84:87], a[80:87], v187
    s_waitcnt lgkmcnt(8)
    v_xor_b32 v233, 0x10000, v233
    v_smfmac_f32_16x16x64_bf16 v[194:197], v[88:91], a[8:15], v187
    v_cvt_pk_bf16_f32 v148, v148, v149
    v_smfmac_f32_16x16x64_bf16 v[198:201], v[88:91], a[88:95], v187
    s_waitcnt lgkmcnt(7)
    v_cvt_pk_bf16_f32 v149, v150, v151
    v_smfmac_f32_16x16x64_bf16 v[194:197], v[92:95], a[16:23], v187
    ds_write_b64 v243, v[148:149] offset:22528
    v_smfmac_f32_16x16x64_bf16 v[198:201], v[92:95], a[96:103], v187
    s_waitcnt lgkmcnt(7)
    v_cvt_pk_bf16_f32 v152, v152, v153
    v_smfmac_f32_16x16x64_bf16 v[194:197], v[96:99], a[24:31], v187
    v_cvt_pk_bf16_f32 v153, v154, v155
    v_smfmac_f32_16x16x64_bf16 v[198:201], v[96:99], a[104:111], v187
    s_waitcnt lgkmcnt(6)
    ds_write_b64 v243, v[152:153] offset:24576
    v_smfmac_f32_16x16x64_bf16 v[194:197], v[100:103], a[32:39], v187
    v_cvt_pk_bf16_f32 v156, v156, v157
    v_smfmac_f32_16x16x64_bf16 v[198:201], v[100:103], a[112:119], v187
    s_waitcnt lgkmcnt(6)
    v_cvt_pk_bf16_f32 v157, v158, v159
    v_smfmac_f32_16x16x64_bf16 v[194:197], v[104:107], a[40:47], v187
    ds_write_b64 v243, v[156:157] offset:26624
    v_smfmac_f32_16x16x64_bf16 v[198:201], v[104:107], a[120:127], v187
    s_waitcnt lgkmcnt(6)
    v_cvt_pk_bf16_f32 v160, v160, v161
    v_smfmac_f32_16x16x64_bf16 v[194:197], v[108:111], a[48:55], v187
    v_cvt_pk_bf16_f32 v161, v162, v163
    v_smfmac_f32_16x16x64_bf16 v[198:201], v[108:111], a[128:135], v187
    s_waitcnt lgkmcnt(5)
    ds_write_b64 v243, v[160:161] offset:28672
    v_smfmac_f32_16x16x64_bf16 v[194:197], v[112:115], a[56:63], v187
    v_cvt_pk_bf16_f32 v172, v164, v165
    v_smfmac_f32_16x16x64_bf16 v[198:201], v[112:115], a[136:143], v187
    s_waitcnt lgkmcnt(5)
    v_cvt_pk_bf16_f32 v173, v166, v167
    v_smfmac_f32_16x16x64_bf16 v[194:197], v[116:119], a[64:71], v187
    v_cvt_pk_bf16_f32 v176, v168, v169
    v_smfmac_f32_16x16x64_bf16 v[198:201], v[116:119], a[144:151], v187
    s_waitcnt lgkmcnt(4)
    v_cvt_pk_bf16_f32 v177, v170, v171
    v_smfmac_f32_16x16x64_bf16 v[194:197], v[120:123], a[72:79], v187
    s_cmp_lt_u32 s59, 20
    s_cselect_b32 s85, s72, s92
    s_add_u32 s86, s85, s89
    v_smfmac_f32_16x16x64_bf16 v[198:201], v[120:123], a[152:159], v187
    s_xor_b32 s96, s72, 524288
    s_lshr_b32 s88, s71, 2
    s_and_b32 s88, s88, 0xf0000
    v_smfmac_f32_16x16x64_bf16 v[202:205], v[84:87], a[160:167], v187
    s_xor_b32 s82, s88, 262144
    s_xor_b32 s83, s88, 524288
    s_xor_b32 s84, s88, 786432
    s_nop 0
    v_permlane32_swap_b32 v194, v198
    v_permlane32_swap_b32 v195, v199
    v_permlane32_swap_b32 v196, v200
    v_permlane32_swap_b32 v197, v201
    v_pk_add_f32 v[194:195], v[194:195], v[198:199]
    v_pk_add_f32 v[196:197], v[196:197], v[200:201]
    v_cvt_pk_bf16_f32 v194, v194, v195
    v_cvt_pk_bf16_f32 v195, v196, v197
    ds_write_b64 v241, v[194:195] offset:12288
    v_smfmac_f32_16x16x64_bf16 v[202:205], v[88:91], a[168:175], v187
    v_smfmac_f32_16x16x64_bf16 v[202:205], v[92:95], a[176:183], v187
    v_smfmac_f32_16x16x64_bf16 v[202:205], v[96:99], a[184:191], v187
    v_smfmac_f32_16x16x64_bf16 v[202:205], v[100:103], a[192:199], v187
    v_smfmac_f32_16x16x64_bf16 v[202:205], v[104:107], a[200:207], v187
    s_waitcnt lgkmcnt(0)
    s_barrier
    ds_read_b64_tr_b16 v[124:125], v242 offset:12288
    ds_read_b64_tr_b16 v[126:127], v242 offset:12352
    ds_read_b64_tr_b16 v[132:133], v242 offset:13312
    ds_read_b64_tr_b16 v[134:135], v242 offset:13376
    v_smfmac_f32_16x16x64_bf16 v[202:205], v[108:111], a[208:215], v187
    ds_read_b128 v[148:151], v236 offset:26624
    ds_read_b128 v[156:159], v236 offset:28672
    v_smfmac_f32_16x16x64_bf16 v[202:205], v[112:115], a[216:223], v187
    ds_read_b64_tr_b16 v[128:129], v242 offset:12800
    ds_read_b64_tr_b16 v[130:131], v242 offset:12864
    v_smfmac_f32_16x16x64_bf16 v[202:205], v[116:119], a[224:231], v187
    ds_read_b64_tr_b16 v[136:137], v242 offset:13824
    ds_read_b64_tr_b16 v[138:139], v242 offset:13888
    v_smfmac_f32_16x16x64_bf16 v[202:205], v[120:123], a[232:239], v187
    ds_read_b128 v[152:155], v236 offset:27648
    ds_read_b128 v[160:163], v236 offset:29696
    s_waitcnt lgkmcnt(8)
    v_mfma_f32_16x16x32_bf16 v[214:217], v[132:135], v[124:127], 0
    s_waitcnt lgkmcnt(7)
    v_mfma_f32_16x16x32_bf16 v[206:209], v[148:151], v[124:127], 0
    s_waitcnt lgkmcnt(6)
    v_mfma_f32_16x16x32_bf16 v[210:213], v[156:159], v[124:127], 0
    ds_read_b128 v[164:167], v244 offset:22528
    ds_read_b128 v[168:171], v244 offset:23552
    s_waitcnt lgkmcnt(4)
    v_mfma_f32_16x16x32_bf16 v[214:217], v[136:139], v[128:131], v[214:217]
    s_waitcnt lgkmcnt(3)
    v_mfma_f32_16x16x32_bf16 v[206:209], v[152:155], v[128:131], v[206:209]
    s_waitcnt lgkmcnt(2)
    v_mfma_f32_16x16x32_bf16 v[210:213], v[160:163], v[128:131], v[210:213]
    v_permlane32_swap_b32 v202, v204
    v_permlane32_swap_b32 v203, v205
    v_add_f32 v202, v202, v204
    v_add_f32 v203, v203, v205
    v_cndmask_b32 v214, v214, v215, s[98:99]
    v_cndmask_b32 v216, v216, v217, s[98:99]
    v_cndmask_b32 v224, v214, v216, s[100:101]
    v_bfi_b32 v224, 1, s97, v224
    buffer_store_dword v224, v237, s[4:7], s79 offen offset:1024
    v_cndmask_b32 v220, v206, v210, s[98:99]
    v_cndmask_b32 v221, v207, v211, s[98:99]
    v_cndmask_b32 v222, v208, v212, s[98:99]
    v_cndmask_b32 v223, v209, v213, s[98:99]
    v_bfi_b32 v220, 1, s97, v220
    buffer_store_dwordx4 v[220:223], v236, s[4:7], s79 offen
    v_cvt_pk_bf16_f32 v174, v202, v203
    v_cvt_pk_bf16_f32 v178, v202, v203
    ds_read_b128 v[124:127], v232 offset:0
    ds_read_b128 v[128:131], v232 offset:20480
    s_waitcnt lgkmcnt(3)
    v_mfma_f32_16x16x32_bf16 v[214:217], v[132:135], v[164:167], 0
    ds_read_b128 v[140:143], v232 offset:1024
    v_mfma_f32_16x16x32_bf16 v[206:209], v[148:151], v[164:167], v[188:191]
    v_mfma_f32_16x16x32_bf16 v[210:213], v[156:159], v[164:167], v[188:191]
    s_waitcnt lgkmcnt(3)
    v_mfma_f32_16x16x32_bf16 v[214:217], v[136:139], v[168:171], v[214:217]
    ds_read_b128 v[132:135], v233 offset:0
    v_mfma_f32_16x16x32_bf16 v[206:209], v[152:155], v[168:171], v[206:209]
    ds_read_b128 v[136:139], v233 offset:20480
    v_mfma_f32_16x16x32_bf16 v[210:213], v[160:163], v[168:171], v[210:213]
    s_waitcnt lgkmcnt(4)
    v_mfma_f32_16x16x32_bf16 v[148:151], a[0:3], v[124:127], 0
    ds_read_b128 v[144:147], v232 offset:21504
    s_nop 0
    v_cndmask_b32 v214, v214, v215, s[98:99]
    v_mfma_f32_16x16x32_bf16 v[156:159], a[80:83], v[124:127], 0
    v_cndmask_b32 v216, v216, v217, s[98:99]
    v_cndmask_b32 v230, v214, v216, s[100:101]
    v_mfma_f32_16x16x32_bf16 v[164:167], v[124:127], a[160:163], 0
    s_waitcnt lgkmcnt(4)
    v_bfi_b32 v230, 1, s97, v230
    v_cndmask_b32 v226, v206, v210, s[98:99]
    v_mfma_f32_16x16x32_bf16 v[152:155], a[0:3], v[128:131], 0
    ds_read_b128 v[124:127], v233 offset:1024
    v_cndmask_b32 v227, v207, v211, s[98:99]
    v_mfma_f32_16x16x32_bf16 v[160:163], a[80:83], v[128:131], 0
    v_cndmask_b32 v228, v208, v212, s[98:99]
    v_cndmask_b32 v229, v209, v213, s[98:99]
    v_mfma_f32_16x16x32_bf16 v[168:171], v[128:131], a[160:163], 0
    v_bfi_b32 v226, 1, s97, v226
    s_waitcnt lgkmcnt(3)
    v_mfma_f32_16x16x32_bf16 v[148:151], a[4:7], v[132:135], v[148:151]
    ds_read_b128 v[128:131], v233 offset:21504
    buffer_load_dwordx4 v[84:87], v236, s[4:7], s80 offen sc1
    v_mfma_f32_16x16x32_bf16 v[156:159], a[84:87], v[132:135], v[156:159]
    buffer_load_dwordx4 v[88:91], v236, s[4:7], s81 offen sc1
    buffer_load_dword v92, v237, s[4:7], s80 offen offset:1024 sc1
    v_mfma_f32_16x16x32_bf16 v[164:167], v[132:135], a[164:167], v[164:167]
    s_waitcnt lgkmcnt(3)
    buffer_load_dword v93, v237, s[4:7], s81 offen offset:1024 sc1
    v_mfma_f32_16x16x32_bf16 v[152:155], a[4:7], v[136:139], v[152:155]
    ds_read_b128 v[132:135], v232 offset:2048
    v_mfma_f32_16x16x32_bf16 v[160:163], a[84:87], v[136:139], v[160:163]
    v_mfma_f32_16x16x32_bf16 v[168:171], v[136:139], a[164:167], v[168:171]
    v_mfma_f32_16x16x32_bf16 v[148:151], a[8:11], v[140:143], v[148:151]
    ds_read_b128 v[136:139], v232 offset:22528
    v_mfma_f32_16x16x32_bf16 v[156:159], a[88:91], v[140:143], v[156:159]
    buffer_store_dwordx4 v[226:229], v238, s[4:7], s79 offen
    buffer_store_dword v230, v239, s[4:7], s79 offen offset:1024
    v_mfma_f32_16x16x32_bf16 v[164:167], v[140:143], a[168:171], v[164:167]
    s_waitcnt lgkmcnt(4)
    v_mfma_f32_16x16x32_bf16 v[152:155], a[8:11], v[144:147], v[152:155]
    ds_read_b128 v[140:143], v233 offset:2048
    v_mfma_f32_16x16x32_bf16 v[160:163], a[88:91], v[144:147], v[160:163]
    v_mfma_f32_16x16x32_bf16 v[168:171], v[144:147], a[168:171], v[168:171]
    s_waitcnt vmcnt(4)
    v_bitop3_b32 v218, v84, v88, s97 bitop3:0x7e
    s_waitcnt vmcnt(2)
    v_bitop3_b32 v219, v92, v93, s97 bitop3:0x7e
    v_bitop3_b32 v218, v218, v219, 1 bitop3:0xa8
    v_cmp_eq_u32 vcc, 1, v218
    s_cbranch_vccnz Lrty_29
    v_pk_add_f32 v[84:85], v[84:85], v[88:89]
    v_pk_add_f32 v[86:87], v[86:87], v[90:91]
    v_add_f32 v92, v92, v93
    v_pk_add_f32 v[220:221], v[220:221], v[84:85]
    v_pk_add_f32 v[222:223], v[222:223], v[86:87]
    v_add_f32 v224, v224, v92
Lok_28:
    v_max3_f32 v218, v220, v221, v222
    v_max3_f32 v218, v218, v223, v224
    buffer_load_dwordx4 v[108:111], v238, s[4:7], s80 offen sc1
    buffer_load_dwordx4 v[112:115], v238, s[4:7], s81 offen sc1
    v_max_f32_dpp v218, v218, v218 row_ror:8 row_mask:0xf bank_mask:0xf
    v_mov_b32 v219, v218
    buffer_load_dword v116, v239, s[4:7], s80 offen offset:1024 sc1
    buffer_load_dword v117, v239, s[4:7], s81 offen offset:1024 sc1
    v_permlane16_swap_b32 v218, v219
    v_max_f32 v218, v218, v219
    v_mov_b32 v219, v218
    s_add_u32 m0, s73, 0
    s_add_u32 s94, s74, 0
    buffer_load_dwordx4 v234, s[4:7], s94 offen sc1 lds
    v_permlane32_swap_b32 v218, v219
    v_max_f32 v218, v218, v219
    v_mul_f32 v218, s70, v218
    v_fma_f32 v224, v224, s70, -v218
    v_fma_f32 v220, v220, s70, -v218
    v_fma_f32 v221, v221, s70, -v218
    v_fma_f32 v222, v222, s70, -v218
    v_fma_f32 v223, v223, s70, -v218
    v_exp_f32 v224, v224
    v_exp_f32 v220, v220
    v_exp_f32 v221, v221
    v_exp_f32 v222, v222
    v_exp_f32 v223, v223
    v_cvt_pk_bf16_f32 v186, v224, v224
    v_cvt_pk_bf16_f32 v184, v220, v221
    v_and_b32 v186, v231, v186
    v_cvt_pk_bf16_f32 v185, v222, v223
    s_add_u32 m0, s73, 4096
    s_add_u32 s94, s74, 4096
    buffer_load_dwordx4 v234, s[4:7], s94 offen sc1 lds
    v_mfma_f32_16x16x32_bf16 v[202:205], v[180:183], v[184:187], 0
    s_nop 0
    v_mov_b64 v[206:207], 0
    v_mov_b64 v[208:209], 0
    v_mfma_f32_16x16x32_bf16 v[194:197], v[172:175], v[184:187], 0
    s_nop 0
    v_mov_b64 v[210:211], 0
    v_mov_b64 v[212:213], 0
    v_mfma_f32_16x16x32_bf16 v[198:201], v[176:179], v[184:187], 0
    s_nop 2
    s_waitcnt lgkmcnt(4)
    v_mfma_f32_16x16x32_bf16 v[148:151], a[12:15], v[124:127], v[148:151]
    s_nop 0
    ds_read_b128 v[144:147], v233 offset:22528
    v_add_f32_dpp v202, v202, v202 row_ror:8 row_mask:0xf bank_mask:0xf
    v_rcp_f32 v202, v202
    v_add_f32_dpp v194, v198, v194 row_ror:8 row_mask:0xf bank_mask:0xf
    v_add_f32_dpp v195, v199, v195 row_ror:8 row_mask:0xf bank_mask:0xf
    v_add_f32_dpp v196, v200, v196 row_ror:8 row_mask:0xf bank_mask:0xf
    v_add_f32_dpp v197, v201, v197 row_ror:8 row_mask:0xf bank_mask:0xf
    v_pk_mul_f32 v[194:195], v[194:195], v[202:203] op_sel_hi:[1,0]
    v_pk_mul_f32 v[196:197], v[196:197], v[202:203] op_sel_hi:[1,0]
    v_cvt_pk_bf16_f32 v194, v194, v195
    v_cvt_pk_bf16_f32 v195, v196, v197
    v_min_u32 v194, -2, v194
    buffer_store_dwordx2 v[194:195], v247, s[4:7], s72 offen
    v_mfma_f32_16x16x32_bf16 v[156:159], a[92:95], v[124:127], v[156:159]
    s_waitcnt vmcnt(5)
    v_bitop3_b32 v218, v108, v112, s97 bitop3:0x7e
    s_waitcnt vmcnt(3)
    v_bitop3_b32 v219, v116, v117, s97 bitop3:0x7e
    v_bitop3_b32 v218, v218, v219, 1 bitop3:0xa8
    v_cmp_eq_u32 vcc, 1, v218
    s_cbranch_vccnz Lrty_31
Lok_30:
    v_mfma_f32_16x16x32_bf16 v[164:167], v[124:127], a[172:175], v[164:167]
    s_waitcnt lgkmcnt(4)
    v_add_f32 v108, v108, v112
    v_add_f32 v109, v109, v113
    v_mfma_f32_16x16x32_bf16 v[152:155], a[12:15], v[128:131], v[152:155]
    ds_read_b128 v[124:127], v232 offset:3072
    v_add_f32 v110, v110, v114
    v_mfma_f32_16x16x32_bf16 v[160:163], a[92:95], v[128:131], v[160:163]
    v_add_f32 v111, v111, v115
    v_add_f32 v116, v116, v117
    v_mfma_f32_16x16x32_bf16 v[168:171], v[128:131], a[172:175], v[168:171]
    s_waitcnt lgkmcnt(4)
    v_add_f32 v226, v226, v108
    v_add_f32 v227, v227, v109
    v_mfma_f32_16x16x32_bf16 v[148:151], a[16:19], v[132:135], v[148:151]
    ds_read_b128 v[128:131], v232 offset:23552
    v_add_f32 v228, v228, v110
    v_mfma_f32_16x16x32_bf16 v[156:159], a[96:99], v[132:135], v[156:159]
    v_add_f32 v229, v229, v111
    v_add_f32 v230, v230, v116
    v_mfma_f32_16x16x32_bf16 v[164:167], v[132:135], a[176:179], v[164:167]
    s_waitcnt lgkmcnt(4)
    v_max3_f32 v218, v226, v227, v228
    v_max3_f32 v218, v218, v229, v230
    v_mfma_f32_16x16x32_bf16 v[152:155], a[16:19], v[136:139], v[152:155]
    ds_read_b128 v[132:135], v233 offset:3072
    v_max_f32_dpp v218, v218, v218 row_ror:8 row_mask:0xf bank_mask:0xf
    v_mfma_f32_16x16x32_bf16 v[160:163], a[96:99], v[136:139], v[160:163]
    v_mov_b32 v219, v218
    s_nop 0
    v_mfma_f32_16x16x32_bf16 v[168:171], v[136:139], a[176:179], v[168:171]
    s_waitcnt lgkmcnt(4)
    v_permlane16_swap_b32 v218, v219
    v_mfma_f32_16x16x32_bf16 v[148:151], a[20:23], v[140:143], v[148:151]
    ds_read_b128 v[136:139], v233 offset:23552
    v_max_f32 v218, v218, v219
    v_mfma_f32_16x16x32_bf16 v[156:159], a[100:103], v[140:143], v[156:159]
    buffer_load_dwordx4 v[84:87], v248, s[4:7], s85 offen offset:0 sc1
    v_mov_b32 v219, v218
    v_mfma_f32_16x16x32_bf16 v[164:167], v[140:143], a[180:183], v[164:167]
    s_waitcnt lgkmcnt(4)
    v_permlane32_swap_b32 v218, v219
    v_mfma_f32_16x16x32_bf16 v[152:155], a[20:23], v[144:147], v[152:155]
    ds_read_b128 v[140:143], v232 offset:4096
    buffer_load_dwordx4 v[88:91], v248, s[4:7], s85 offen offset:1024 sc1
    v_mfma_f32_16x16x32_bf16 v[160:163], a[100:103], v[144:147], v[160:163]
    v_max_f32 v218, v218, v219
    v_mul_f32 v218, s70, v218
    v_mfma_f32_16x16x32_bf16 v[168:171], v[144:147], a[180:183], v[168:171]
    s_waitcnt lgkmcnt(4)
    buffer_load_dwordx4 v[92:95], v248, s[4:7], s85 offen offset:2048 sc1
    v_fma_f32 v230, v230, s70, -v218
    v_mfma_f32_16x16x32_bf16 v[148:151], a[24:27], v[124:127], v[148:151]
    ds_read_b128 v[144:147], v232 offset:24576
    v_fma_f32 v226, v226, s70, -v218
    v_mfma_f32_16x16x32_bf16 v[156:159], a[104:107], v[124:127], v[156:159]
    buffer_load_dwordx4 v[96:99], v248, s[4:7], s85 offen offset:3072 sc1
    v_fma_f32 v227, v227, s70, -v218
    v_mfma_f32_16x16x32_bf16 v[164:167], v[124:127], a[184:187], v[164:167]
    v_fma_f32 v228, v228, s70, -v218
    v_fma_f32 v229, v229, s70, -v218
    buffer_load_dwordx4 v[100:103], v248, s[4:7], s86 offen offset:0 sc1
    buffer_load_dwordx4 v[104:107], v248, s[4:7], s86 offen offset:1024 sc1
Lwchk_32:
    s_waitcnt vmcnt(5)
    v_max_u32 v194, v84, v86
    s_waitcnt vmcnt(4)
    v_max3_u32 v194, v194, v88, v90
    v_cmp_lt_u32 vcc, s87, v194
    s_cbranch_vccnz Lwrty_33
    v_smfmac_f32_16x16x64_bf16 v[206:209], v[84:87], a[240:247], v187
    v_exp_f32 v230, v230
    v_smfmac_f32_16x16x64_bf16 v[210:213], v[84:87], a[248:255], v187
    v_exp_f32 v226, v226
    v_smfmac_f32_16x16x64_bf16 v[206:209], v[88:91], v[4:11], v187
    v_exp_f32 v227, v227
    v_smfmac_f32_16x16x64_bf16 v[210:213], v[88:91], v[12:19], v187
Lwchk_34:
    s_waitcnt vmcnt(3)
    v_max_u32 v194, v92, v94
    s_waitcnt vmcnt(2)
    v_max3_u32 v194, v194, v96, v98
    v_cmp_lt_u32 vcc, s87, v194
    s_cbranch_vccnz Lwrty_35
    v_smfmac_f32_16x16x64_bf16 v[206:209], v[92:95], v[20:27], v187
    v_exp_f32 v228, v228
    v_smfmac_f32_16x16x64_bf16 v[210:213], v[92:95], v[28:35], v187
    v_exp_f32 v229, v229
    v_smfmac_f32_16x16x64_bf16 v[206:209], v[96:99], v[36:43], v187
    v_cvt_pk_bf16_f32 v200, v230, v230
    v_smfmac_f32_16x16x64_bf16 v[210:213], v[96:99], v[44:51], v187
Lwchk_36:
    s_waitcnt vmcnt(1)
    v_max_u32 v194, v100, v102
    s_waitcnt vmcnt(0)
    v_max3_u32 v194, v194, v104, v106
    v_cmp_lt_u32 vcc, s87, v194
    s_cbranch_vccnz Lwrty_37
    v_smfmac_f32_16x16x64_bf16 v[206:209], v[100:103], v[52:59], v187
    v_cvt_pk_bf16_f32 v198, v226, v227
    v_smfmac_f32_16x16x64_bf16 v[210:213], v[100:103], v[60:67], v187
    v_cvt_pk_bf16_f32 v199, v228, v229
    v_smfmac_f32_16x16x64_bf16 v[206:209], v[104:107], v[68:75], v187
    ds_write_b16 v246, v200 offset:14344
    v_smfmac_f32_16x16x64_bf16 v[210:213], v[104:107], v[76:83], v187
    s_nop 0
    ds_write_b64 v245, v[198:199] offset:14336
    s_waitcnt lgkmcnt(6)
    v_mfma_f32_16x16x32_bf16 v[152:155], a[24:27], v[128:131], v[152:155]
    s_nop 0
    ds_read_b128 v[124:127], v233 offset:4096
    s_nop 0
    v_mfma_f32_16x16x32_bf16 v[160:163], a[104:107], v[128:131], v[160:163]
    v_permlane32_swap_b32 v206, v210
    v_permlane32_swap_b32 v207, v211
    v_permlane32_swap_b32 v208, v212
    v_permlane32_swap_b32 v209, v213
    v_pk_add_f32 v[206:207], v[206:207], v[210:211]
    v_pk_add_f32 v[208:209], v[208:209], v[212:213]
    ds_write2_b32 v249, v206, v207 offset0:0 offset1:32
    ds_write2_b32 v249, v208, v209 offset0:64 offset1:96
    v_mfma_f32_16x16x32_bf16 v[168:171], v[128:131], a[184:187], v[168:171]
    s_waitcnt lgkmcnt(8)
    v_mfma_f32_16x16x32_bf16 v[148:151], a[28:31], v[132:135], v[148:151]
    ds_read_b128 v[128:131], v233 offset:24576
    v_mfma_f32_16x16x32_bf16 v[156:159], a[108:111], v[132:135], v[156:159]
    v_mfma_f32_16x16x32_bf16 v[164:167], v[132:135], a[188:191], v[164:167]
    s_waitcnt lgkmcnt(1)
    s_barrier
    ds_read_b128 v[96:99], v236 offset:18432
    ds_read_b128 v[100:103], v236 offset:19456
    v_mfma_f32_16x16x32_bf16 v[152:155], a[28:31], v[136:139], v[152:155]
    ds_read_b128 v[132:135], v232 offset:5120
    ds_read_b128 v[104:107], v236 offset:20480
    v_mfma_f32_16x16x32_bf16 v[160:163], a[108:111], v[136:139], v[160:163]
    ds_read_b128 v[108:111], v236 offset:21504
    ds_read_b64 v[120:121], v240 offset:16896
    v_mfma_f32_16x16x32_bf16 v[168:171], v[136:139], a[188:191], v[168:171]
    ds_read_b128 v[112:115], v236 offset:14336
    ds_read_b128 v[116:119], v236 offset:15872
    v_mfma_f32_16x16x32_bf16 v[148:151], a[32:35], v[140:143], v[148:151]
    ds_read_b128 v[136:139], v232 offset:25600
    s_waitcnt lgkmcnt(7)
    v_pk_add_f32 v[96:97], v[96:97], v[100:101]
    v_pk_add_f32 v[98:99], v[98:99], v[102:103]
    s_waitcnt lgkmcnt(4)
    v_pk_add_f32 v[104:105], v[104:105], v[108:109]
    v_pk_add_f32 v[106:107], v[106:107], v[110:111]
    v_pk_add_f32 v[96:97], v[96:97], v[104:105]
    v_pk_add_f32 v[98:99], v[98:99], v[106:107]
    v_bfi_b32 v96, 1, s97, v96
    buffer_store_dwordx4 v[96:99], v251, s[4:7], s88 offen sc1
    s_waitcnt lgkmcnt(3)
    v_mfma_f32_16x16x16_bf16 v[206:209], v[180:181], v[120:121], 0
    v_mfma_f32_16x16x16_bf16 v[198:201], v[176:177], v[120:121], 0
    s_waitcnt lgkmcnt(2)
    v_mfma_f32_16x16x32_bf16 v[202:205], v[180:183], v[112:115], 0
    buffer_store_dword v192, v247, s[4:7], s96 offen
    v_mfma_f32_16x16x32_bf16 v[194:197], v[172:175], v[112:115], 0
    v_mfma_f32_16x16x32_bf16 v[156:159], a[112:115], v[140:143], v[156:159]
    v_mfma_f32_16x16x32_bf16 v[164:167], v[140:143], a[192:195], v[164:167]
    buffer_store_dword v192, v250, s[4:7], s96 offen
    v_mfma_f32_16x16x32_bf16 v[152:155], a[32:35], v[144:147], v[152:155]
    ds_read_b128 v[140:143], v233 offset:5120
    s_waitcnt lgkmcnt(2)
    v_mfma_f32_16x16x32_bf16 v[206:209], v[180:183], v[116:119], v[206:209]
    v_mfma_f32_16x16x32_bf16 v[198:201], v[172:175], v[116:119], v[198:201]
    v_mfma_f32_16x16x32_bf16 v[160:163], a[112:115], v[144:147], v[160:163]
    v_rcp_f32 v202, v202
    v_mfma_f32_16x16x32_bf16 v[168:171], v[144:147], a[192:195], v[168:171]
    v_mul_f32 v194, v194, v202
    v_mul_f32 v195, v195, v202
    v_mfma_f32_16x16x32_bf16 v[148:151], a[36:39], v[124:127], v[148:151]
    ds_read_b128 v[144:147], v233 offset:25600
    v_mul_f32 v196, v196, v202
    v_mfma_f32_16x16x32_bf16 v[156:159], a[116:119], v[124:127], v[156:159]
    v_mul_f32 v197, v197, v202
    v_cvt_pk_bf16_f32 v210, v194, v195
    v_mfma_f32_16x16x32_bf16 v[164:167], v[124:127], a[196:199], v[164:167]
    v_cvt_pk_bf16_f32 v211, v196, v197
    v_mfma_f32_16x16x32_bf16 v[152:155], a[36:39], v[128:131], v[152:155]
    ds_read_b128 v[124:127], v232 offset:6144
    v_mfma_f32_16x16x32_bf16 v[160:163], a[116:119], v[128:131], v[160:163]
    buffer_store_dwordx2 v[210:211], v243, s[4:7], s75 offen offset:0
    v_rcp_f32 v206, v206
    s_nop 0
    v_mfma_f32_16x16x32_bf16 v[168:171], v[128:131], a[196:199], v[168:171]
    v_mul_f32 v198, v198, v206
    v_mul_f32 v199, v199, v206
    v_mfma_f32_16x16x32_bf16 v[148:151], a[40:43], v[132:135], v[148:151]
    ds_read_b128 v[128:131], v232 offset:26624
    v_mul_f32 v200, v200, v206
    v_mfma_f32_16x16x32_bf16 v[156:159], a[120:123], v[132:135], v[156:159]
    v_mul_f32 v201, v201, v206
    v_cvt_pk_bf16_f32 v212, v198, v199
    v_mfma_f32_16x16x32_bf16 v[164:167], v[132:135], a[200:203], v[164:167]
    s_waitcnt lgkmcnt(4)
    v_cvt_pk_bf16_f32 v213, v200, v201
    v_mfma_f32_16x16x32_bf16 v[152:155], a[40:43], v[136:139], v[152:155]
    ds_read_b128 v[132:135], v233 offset:6144
    v_mfma_f32_16x16x32_bf16 v[160:163], a[120:123], v[136:139], v[160:163]
    s_add_u32 m0, s73, 8192
    buffer_load_dwordx4 v[100:103], v251, s[4:7], s82 offen sc1
    buffer_load_dwordx4 v[104:107], v251, s[4:7], s83 offen sc1
    v_mfma_f32_16x16x32_bf16 v[168:171], v[136:139], a[200:203], v[168:171]
    s_waitcnt lgkmcnt(4)
    buffer_load_dwordx4 v[108:111], v251, s[4:7], s84 offen sc1
    s_add_u32 s94, s74, 16384
    v_mfma_f32_16x16x32_bf16 v[148:151], a[44:47], v[140:143], v[148:151]
    ds_read_b128 v[136:139], v233 offset:26624
    buffer_load_dwordx4 v234, s[4:7], s94 offen sc1 lds
    v_mfma_f32_16x16x32_bf16 v[156:159], a[124:127], v[140:143], v[156:159]
    buffer_store_dwordx2 v[212:213], v243, s[4:7], s75 offen offset:2048
    s_cmp_eq_u32 s62, 63
    s_cbranch_scc1 L_Clast
    v_mfma_f32_16x16x32_bf16 v[164:167], v[140:143], a[204:207], v[164:167]
    s_waitcnt lgkmcnt(4)
    s_add_u32 s75, s75, 393216
    s_add_u32 s66, s62, 1
    v_mfma_f32_16x16x32_bf16 v[152:155], a[44:47], v[144:147], v[152:155]
    s_add_u32 m0, s73, 12288
    ds_read_b128 v[140:143], v232 offset:7168
    s_add_u32 s94, s74, 20480
    v_mfma_f32_16x16x32_bf16 v[160:163], a[124:127], v[144:147], v[160:163]
    buffer_load_dwordx4 v234, s[4:7], s94 offen sc1 lds
    v_mfma_f32_16x16x32_bf16 v[168:171], v[144:147], a[204:207], v[168:171]
    s_waitcnt lgkmcnt(4)
    s_and_b32 s66, s66, 7
    s_cselect_b32 s66, 0, 3145728
    v_mfma_f32_16x16x32_bf16 v[148:151], a[48:51], v[124:127], v[148:151]
    s_sub_u32 s75, s75, s66
    ds_read_b128 v[144:147], v232 offset:27648
    v_mov_b64 v[194:195], 0
    v_mfma_f32_16x16x32_bf16 v[156:159], a[128:131], v[124:127], v[156:159]
    s_add_u32 m0, s73, 16384
    s_add_u32 s94, s74, 32768
    buffer_load_dwordx4 v234, s[4:7], s94 offen sc1 lds
    v_mfma_f32_16x16x32_bf16 v[164:167], v[124:127], a[208:211], v[164:167]
    s_waitcnt lgkmcnt(4)
    buffer_load_dwordx4 v[84:87], v251, s[4:7], s82 offen sc1
    buffer_load_dwordx4 v[88:91], v251, s[4:7], s83 offen sc1
    v_mfma_f32_16x16x32_bf16 v[152:155], a[48:51], v[128:131], v[152:155]
    ds_read_b128 v[124:127], v233 offset:7168
    buffer_load_dwordx4 v[92:95], v251, s[4:7], s84 offen sc1
    v_mfma_f32_16x16x32_bf16 v[160:163], a[128:131], v[128:131], v[160:163]
    s_add_u32 m0, s73, 20480
    s_add_u32 s94, s74, 36864
    buffer_load_dwordx4 v234, s[4:7], s94 offen sc1 lds
    v_mfma_f32_16x16x32_bf16 v[168:171], v[128:131], a[208:211], v[168:171]
    s_waitcnt lgkmcnt(4)
    v_mov_b64 v[196:197], 0
    v_mov_b64 v[198:199], 0
    v_mfma_f32_16x16x32_bf16 v[148:151], a[52:55], v[132:135], v[148:151]
    ds_read_b128 v[128:131], v233 offset:27648
    v_mov_b64 v[200:201], 0
    v_mfma_f32_16x16x32_bf16 v[156:159], a[132:135], v[132:135], v[156:159]
    s_add_u32 m0, s73, 24576
    s_add_u32 s94, s74, 49152
    buffer_load_dwordx4 v234, s[4:7], s94 offen sc1 lds
    v_mfma_f32_16x16x32_bf16 v[164:167], v[132:135], a[212:215], v[164:167]
    s_waitcnt lgkmcnt(4)
    v_mov_b64 v[202:203], 0
    v_mov_b64 v[204:205], 0
    v_mfma_f32_16x16x32_bf16 v[152:155], a[52:55], v[136:139], v[152:155]
    ds_read_b128 v[132:135], v232 offset:8192
    v_mfma_f32_16x16x32_bf16 v[160:163], a[132:135], v[136:139], v[160:163]
    s_add_u32 m0, s73, 28672
    s_add_u32 s94, s74, 53248
    buffer_load_dwordx4 v234, s[4:7], s94 offen sc1 lds
    v_mfma_f32_16x16x32_bf16 v[168:171], v[136:139], a[212:215], v[168:171]
    s_waitcnt lgkmcnt(4)
    v_mfma_f32_16x16x32_bf16 v[148:151], a[56:59], v[140:143], v[148:151]
    ds_read_b128 v[136:139], v232 offset:28672
    v_mfma_f32_16x16x32_bf16 v[156:159], a[136:139], v[140:143], v[156:159]
    s_add_u32 m0, s73, 32768
    s_add_u32 s94, s74, 65536
    buffer_load_dwordx4 v234, s[4:7], s94 offen sc1 lds
    v_mfma_f32_16x16x32_bf16 v[164:167], v[140:143], a[216:219], v[164:167]
    s_waitcnt lgkmcnt(4)
    v_mfma_f32_16x16x32_bf16 v[152:155], a[56:59], v[144:147], v[152:155]
    ds_read_b128 v[140:143], v233 offset:8192
    s_waitcnt vmcnt(12)
    v_bitop3_b32 v218, v100, v104, s97 bitop3:0x7e
    s_waitcnt vmcnt(11)
    v_bitop3_b32 v218, v218, v108, s97 bitop3:0xf6
    v_and_b32 v218, v193, v218
    v_cmp_eq_u32 vcc, 1, v218
    s_cbranch_vccnz Lrty_39
    v_pk_add_f32 v[96:97], v[96:97], v[100:101]
    v_pk_add_f32 v[98:99], v[98:99], v[102:103]
    v_pk_add_f32 v[104:105], v[104:105], v[108:109]
    v_pk_add_f32 v[106:107], v[106:107], v[110:111]
    v_pk_add_f32 v[96:97], v[96:97], v[104:105]
    v_pk_add_f32 v[98:99], v[98:99], v[106:107]
Lok_38:
    v_cvt_pk_bf16_f32 v96, v96, v97
    v_cvt_pk_bf16_f32 v97, v98, v99
    v_min_u32 v96, -2, v96
    buffer_store_dwordx2 v[96:97], v250, s[4:7], s72 offen
    s_barrier
    v_mfma_f32_16x16x32_bf16 v[160:163], a[136:139], v[144:147], v[160:163]
    s_add_u32 s82, s72, 178176
    s_add_u32 s83, s72, 182272
    s_add_u32 m0, s73, 36864
    v_mfma_f32_16x16x32_bf16 v[168:171], v[144:147], a[216:219], v[168:171]
    s_waitcnt lgkmcnt(4)
    s_add_u32 s94, s74, 69632
    buffer_load_dwordx4 v234, s[4:7], s94 offen sc1 lds
    v_mfma_f32_16x16x32_bf16 v[148:151], a[60:63], v[124:127], v[148:151]
    ds_read_b128 v[144:147], v233 offset:28672
    v_add_u32_e64 v218, s62, 1
    v_mfma_f32_16x16x32_bf16 v[156:159], a[140:143], v[124:127], v[156:159]
    s_waitcnt vmcnt(11)
    buffer_store_dword v218, v1, s[4:7], s3 offen
    v_mfma_f32_16x16x32_bf16 v[164:167], v[124:127], a[220:223], v[164:167]
    s_waitcnt lgkmcnt(4)
    v_mfma_f32_16x16x32_bf16 v[152:155], a[60:63], v[128:131], v[152:155]
    ds_read_b128 v[124:127], v232 offset:9216
    v_mfma_f32_16x16x32_bf16 v[160:163], a[140:143], v[128:131], v[160:163]
    v_mfma_f32_16x16x32_bf16 v[168:171], v[128:131], a[220:223], v[168:171]
    s_waitcnt lgkmcnt(4)
    v_mfma_f32_16x16x32_bf16 v[148:151], a[64:67], v[132:135], v[148:151]
    ds_read_b128 v[128:131], v232 offset:29696
    v_mfma_f32_16x16x32_bf16 v[156:159], a[144:147], v[132:135], v[156:159]
    v_mfma_f32_16x16x32_bf16 v[164:167], v[132:135], a[224:227], v[164:167]
    s_waitcnt lgkmcnt(4)
    v_mfma_f32_16x16x32_bf16 v[152:155], a[64:67], v[136:139], v[152:155]
    s_add_u32 s86, s72, 262144
    ds_read_b128 v[132:135], v233 offset:9216
    buffer_load_dwordx4 v[112:115], v234, s[4:7], s82 offen sc1
    v_mfma_f32_16x16x32_bf16 v[160:163], a[144:147], v[136:139], v[160:163]
    s_and_b32 s86, s86, 786432
    buffer_load_dwordx4 v[116:119], v234, s[4:7], s83 offen sc1
    buffer_load_dwordx2 v[120:121], v235, s[4:7], s82 offen sc1
    v_mfma_f32_16x16x32_bf16 v[168:171], v[136:139], a[224:227], v[168:171]
    s_waitcnt lgkmcnt(4)
    s_andn2_b32 s72, s72, 786432
    s_or_b32 s72, s72, s86
    v_mfma_f32_16x16x32_bf16 v[148:151], a[68:71], v[140:143], v[148:151]
    s_mov_b32 s74, s92
    ds_read_b128 v[136:139], v233 offset:29696
    s_xor_b32 s73, s73, 65536
    v_mfma_f32_16x16x32_bf16 v[156:159], a[148:151], v[140:143], v[156:159]
    s_add_u32 s91, s91, 131072
    s_lshr_b32 s92, s91, 8
    s_xor_b32 s92, s92, s1
    v_mfma_f32_16x16x32_bf16 v[164:167], v[140:143], a[228:231], v[164:167]
    s_waitcnt lgkmcnt(4)
    s_and_b32 s92, s92, s93
    s_or_b32 s92, s92, s91
    v_mfma_f32_16x16x32_bf16 v[152:155], a[68:71], v[144:147], v[152:155]
    v_mfma_f32_16x16x32_bf16 v[160:163], a[148:151], v[144:147], v[160:163]
    buffer_load_dwordx4 v[100:103], v234, s[4:7], s82 offen sc1
    buffer_load_dwordx4 v[104:107], v234, s[4:7], s83 offen sc1
    v_mfma_f32_16x16x32_bf16 v[168:171], v[144:147], a[228:231], v[168:171]
    s_waitcnt lgkmcnt(3)
    buffer_load_dwordx2 v[108:109], v235, s[4:7], s82 offen sc1
    v_mfma_f32_16x16x32_bf16 v[148:151], a[72:75], v[124:127], v[148:151]
    v_mfma_f32_16x16x32_bf16 v[156:159], a[152:155], v[124:127], v[156:159]
    v_mfma_f32_16x16x32_bf16 v[164:167], v[124:127], a[232:235], v[164:167]
    s_add_u32 s62, s62, 1
    s_branch L_Ctop3
Lrty_26:
    buffer_load_dwordx4 v[112:115], v234, s[4:7], s82 offen sc1
    buffer_load_dwordx4 v[116:119], v234, s[4:7], s83 offen sc1
    buffer_load_dwordx2 v[120:121], v235, s[4:7], s82 offen sc1
    s_sub_u32 s61, s61, 1
    s_mov_b32 s67, 15
    s_cbranch_scc1 L_fail
    s_waitcnt vmcnt(4)
    v_max3_u32 v218, v100, v102, v104
    s_waitcnt vmcnt(3)
    v_max3_u32 v218, v218, v106, v108
    v_cmp_eq_u32 vcc, -1, v218
    s_cbranch_vccnz Lrty_27
    ds_write_b128 v234, v[100:103] offset:0
    ds_write_b128 v234, v[104:107] offset:4096
    ds_write_b64 v235, v[108:109] offset:0
    s_branch Lok_25
Lrty_27:
    buffer_load_dwordx4 v[100:103], v234, s[4:7], s82 offen sc1
    buffer_load_dwordx4 v[104:107], v234, s[4:7], s83 offen sc1
    buffer_load_dwordx2 v[108:109], v235, s[4:7], s82 offen sc1
    s_sub_u32 s61, s61, 1
    s_mov_b32 s67, 15
    s_cbranch_scc1 L_fail
    s_waitcnt vmcnt(4)
    v_max3_u32 v218, v112, v114, v116
    s_waitcnt vmcnt(3)
    v_max3_u32 v218, v218, v118, v120
    v_cmp_eq_u32 vcc, -1, v218
    s_cbranch_vccnz Lrty_26
    ds_write_b128 v234, v[112:115] offset:0
    ds_write_b128 v234, v[116:119] offset:4096
    ds_write_b64 v235, v[120:121] offset:0
    s_branch Lok_25
Lrty_29:
    buffer_load_dwordx4 v[84:87], v236, s[4:7], s80 offen sc1
    buffer_load_dwordx4 v[88:91], v236, s[4:7], s81 offen sc1
    buffer_load_dword v92, v237, s[4:7], s80 offen offset:1024 sc1
    buffer_load_dword v93, v237, s[4:7], s81 offen offset:1024 sc1
    s_sub_u32 s61, s61, 1
    s_mov_b32 s67, 11
    s_cbranch_scc1 L_fail
    s_waitcnt vmcnt(2)
    v_bitop3_b32 v218, v84, v88, s97 bitop3:0x7e
    s_waitcnt vmcnt(0)
    v_bitop3_b32 v219, v92, v93, s97 bitop3:0x7e
    v_bitop3_b32 v218, v218, v219, 1 bitop3:0xa8
    v_cmp_eq_u32 vcc, 1, v218
    s_cbranch_vccnz Lrty_29
    v_pk_add_f32 v[84:85], v[84:85], v[88:89]
    v_pk_add_f32 v[86:87], v[86:87], v[90:91]
    v_add_f32 v92, v92, v93
    v_pk_add_f32 v[220:221], v[220:221], v[84:85]
    v_pk_add_f32 v[222:223], v[222:223], v[86:87]
    v_add_f32 v224, v224, v92
    s_branch Lok_28
Lrty_31:
    buffer_load_dwordx4 v[108:111], v238, s[4:7], s80 offen sc1
    buffer_load_dwordx4 v[112:115], v238, s[4:7], s81 offen sc1
    buffer_load_dword v116, v239, s[4:7], s80 offen offset:1024 sc1
    buffer_load_dword v117, v239, s[4:7], s81 offen offset:1024 sc1
    s_sub_u32 s61, s61, 1
    s_mov_b32 s67, 12
    s_cbranch_scc1 L_fail
    s_waitcnt vmcnt(2)
    v_bitop3_b32 v218, v108, v112, s97 bitop3:0x7e
    s_waitcnt vmcnt(0)
    v_bitop3_b32 v219, v116, v117, s97 bitop3:0x7e
    v_bitop3_b32 v218, v218, v219, 1 bitop3:0xa8
    v_cmp_eq_u32 vcc, 1, v218
    s_cbranch_vccnz Lrty_31
    s_branch Lok_30
Lwrty_33:
    buffer_load_dwordx4 v[84:87], v248, s[4:7], s85 offen offset:0 sc1
    buffer_load_dwordx4 v[88:91], v248, s[4:7], s85 offen offset:1024 sc1
    buffer_load_dwordx4 v[92:95], v248, s[4:7], s85 offen offset:2048 sc1
    buffer_load_dwordx4 v[96:99], v248, s[4:7], s85 offen offset:3072 sc1
    buffer_load_dwordx4 v[100:103], v248, s[4:7], s86 offen offset:0 sc1
    buffer_load_dwordx4 v[104:107], v248, s[4:7], s86 offen offset:1024 sc1
    s_sub_u32 s61, s61, 1
    s_mov_b32 s67, 13
    s_cbranch_scc1 L_fail
    s_branch Lwchk_32
Lwrty_35:
    buffer_load_dwordx4 v[92:95], v248, s[4:7], s85 offen offset:2048 sc1
    buffer_load_dwordx4 v[96:99], v248, s[4:7], s85 offen offset:3072 sc1
    buffer_load_dwordx4 v[100:103], v248, s[4:7], s86 offen offset:0 sc1
    buffer_load_dwordx4 v[104:107], v248, s[4:7], s86 offen offset:1024 sc1
    s_sub_u32 s61, s61, 1
    s_mov_b32 s67, 13
    s_cbranch_scc1 L_fail
    s_branch Lwchk_34
Lwrty_37:
    buffer_load_dwordx4 v[100:103], v248, s[4:7], s86 offen offset:0 sc1
    buffer_load_dwordx4 v[104:107], v248, s[4:7], s86 offen offset:1024 sc1
    s_sub_u32 s61, s61, 1
    s_mov_b32 s67, 13
    s_cbranch_scc1 L_fail
    s_branch Lwchk_36
Lrty_39:
    buffer_load_dwordx4 v[100:103], v251, s[4:7], s82 offen sc1
    buffer_load_dwordx4 v[104:107], v251, s[4:7], s83 offen sc1
    buffer_load_dwordx4 v[108:111], v251, s[4:7], s84 offen sc1
    s_sub_u32 s61, s61, 1
    s_mov_b32 s67, 14
    s_cbranch_scc1 L_fail
    s_waitcnt vmcnt(4)
    v_bitop3_b32 v218, v84, v88, s97 bitop3:0x7e
    s_waitcnt vmcnt(3)
    v_bitop3_b32 v218, v218, v92, s97 bitop3:0xf6
    v_and_b32 v218, v193, v218
    v_cmp_eq_u32 vcc, 1, v218
    s_cbranch_vccnz Lrty_40
    v_pk_add_f32 v[96:97], v[96:97], v[84:85]
    v_pk_add_f32 v[98:99], v[98:99], v[86:87]
    v_pk_add_f32 v[88:89], v[88:89], v[92:93]
    v_pk_add_f32 v[90:91], v[90:91], v[94:95]
    v_pk_add_f32 v[96:97], v[96:97], v[88:89]
    v_pk_add_f32 v[98:99], v[98:99], v[90:91]
    s_branch Lok_38
Lrty_40:
    buffer_load_dwordx4 v[84:87], v251, s[4:7], s82 offen sc1
    buffer_load_dwordx4 v[88:91], v251, s[4:7], s83 offen sc1
    buffer_load_dwordx4 v[92:95], v251, s[4:7], s84 offen sc1
    s_sub_u32 s61, s61, 1
    s_mov_b32 s67, 14
    s_cbranch_scc1 L_fail
    s_waitcnt vmcnt(4)
    v_bitop3_b32 v218, v100, v104, s97 bitop3:0x7e
    s_waitcnt vmcnt(3)
    v_bitop3_b32 v218, v218, v108, s97 bitop3:0xf6
    v_and_b32 v218, v193, v218
    v_cmp_eq_u32 vcc, 1, v218
    s_cbranch_vccnz Lrty_39
    v_pk_add_f32 v[96:97], v[96:97], v[100:101]
    v_pk_add_f32 v[98:99], v[98:99], v[102:103]
    v_pk_add_f32 v[104:105], v[104:105], v[108:109]
    v_pk_add_f32 v[106:107], v[106:107], v[110:111]
    v_pk_add_f32 v[96:97], v[96:97], v[104:105]
    v_pk_add_f32 v[98:99], v[98:99], v[106:107]
    s_branch Lok_38
L_Ctop0:
    s_waitcnt vmcnt(5)
    ds_write_b128 v234, v[112:115] offset:0
    s_waitcnt vmcnt(4)
    ds_write_b128 v234, v[116:119] offset:4096
    s_waitcnt vmcnt(3)
    ds_write_b64 v235, v[120:121] offset:0
    v_max3_u32 v218, v112, v114, v116
    v_max3_u32 v218, v218, v118, v120
    v_cmp_eq_u32 vcc, -1, v218
    s_cbranch_vccnz Lrty_42
Lok_41:
    s_waitcnt lgkmcnt(5)
    v_mfma_f32_16x16x32_bf16 v[152:155], a[72:75], v[128:131], v[152:155]
    v_mfma_f32_16x16x32_bf16 v[160:163], a[152:155], v[128:131], v[160:163]
    v_mfma_f32_16x16x32_bf16 v[168:171], v[128:131], a[232:235], v[168:171]
    s_waitcnt lgkmcnt(4)
    v_mfma_f32_16x16x32_bf16 v[148:151], a[76:79], v[132:135], v[148:151]
L_Cin0:
    s_waitcnt lgkmcnt(0)
    s_barrier
    ds_read_b128 v[84:87], v236 offset:0
    ds_read_b128 v[88:91], v236 offset:1024
    v_mfma_f32_16x16x32_bf16 v[156:159], a[156:159], v[132:135], v[156:159]
    s_andn2_b32 s71, s72, 524288
    ds_read_b128 v[92:95], v236 offset:2048
    ds_read_b128 v[96:99], v236 offset:3072
    v_mfma_f32_16x16x32_bf16 v[164:167], v[132:135], a[236:239], v[164:167]
    s_waitcnt vmcnt(2)
    ds_read_b128 v[100:103], v236 offset:4096
    s_waitcnt vmcnt(1)
    ds_read_b128 v[104:107], v236 offset:5120
    v_mfma_f32_16x16x32_bf16 v[152:155], a[76:79], v[136:139], v[152:155]
    s_lshr_b32 s97, s62, 1
    s_waitcnt vmcnt(0)
    ds_read_b128 v[108:111], v236 offset:6144
    ds_read_b128 v[112:115], v236 offset:7168
    v_mfma_f32_16x16x32_bf16 v[160:163], a[156:159], v[136:139], v[160:163]
    s_add_u32 s79, s71, s76
    ds_read_b128 v[116:119], v236 offset:8192
    ds_read_b128 v[120:123], v236 offset:9216
    v_mfma_f32_16x16x32_bf16 v[168:171], v[136:139], a[236:239], v[168:171]
    s_add_u32 s80, s71, s77
    s_add_u32 s81, s71, s78
    s_waitcnt lgkmcnt(9)
    v_smfmac_f32_16x16x64_bf16 v[194:197], v[84:87], a[0:7], v187
    v_xor_b32 v232, 0x10000, v232
    v_smfmac_f32_16x16x64_bf16 v[198:201], v[84:87], a[80:87], v187
    s_waitcnt lgkmcnt(8)
    v_xor_b32 v233, 0x10000, v233
    v_smfmac_f32_16x16x64_bf16 v[194:197], v[88:91], a[8:15], v187
    v_cvt_pk_bf16_f32 v148, v148, v149
    v_smfmac_f32_16x16x64_bf16 v[198:201], v[88:91], a[88:95], v187
    s_waitcnt lgkmcnt(7)
    v_cvt_pk_bf16_f32 v149, v150, v151
    v_smfmac_f32_16x16x64_bf16 v[194:197], v[92:95], a[16:23], v187
    ds_write_b64 v243, v[148:149] offset:22528
    v_smfmac_f32_16x16x64_bf16 v[198:201], v[92:95], a[96:103], v187
    s_waitcnt lgkmcnt(7)
    v_cvt_pk_bf16_f32 v152, v152, v153
    v_smfmac_f32_16x16x64_bf16 v[194:197], v[96:99], a[24:31], v187
    v_cvt_pk_bf16_f32 v153, v154, v155
    v_smfmac_f32_16x16x64_bf16 v[198:201], v[96:99], a[104:111], v187
    s_waitcnt lgkmcnt(6)
    ds_write_b64 v243, v[152:153] offset:24576
    v_smfmac_f32_16x16x64_bf16 v[194:197], v[100:103], a[32:39], v187
    v_cvt_pk_bf16_f32 v156, v156, v157
    v_smfmac_f32_16x16x64_bf16 v[198:201], v[100:103], a[112:119], v187
    s_waitcnt lgkmcnt(6)
    v_cvt_pk_bf16_f32 v157, v158, v159
    v_smfmac_f32_16x16x64_bf16 v[194:197], v[104:107], a[40:47], v187
    ds_write_b64 v243, v[156:157] offset:26624
    v_smfmac_f32_16x16x64_bf16 v[198:201], v[104:107], a[120:127], v187
    s_waitcnt lgkmcnt(6)
    v_cvt_pk_bf16_f32 v160, v160, v161
    v_smfmac_f32_16x16x64_bf16 v[194:197], v[108:111], a[48:55], v187
    v_cvt_pk_bf16_f32 v161, v162, v163
    v_smfmac_f32_16x16x64_bf16 v[198:201], v[108:111], a[128:135], v187
    s_waitcnt lgkmcnt(5)
    ds_write_b64 v243, v[160:161] offset:28672
    v_smfmac_f32_16x16x64_bf16 v[194:197], v[112:115], a[56:63], v187
    v_cvt_pk_bf16_f32 v172, v164, v165
    v_smfmac_f32_16x16x64_bf16 v[198:201], v[112:115], a[136:143], v187
    s_waitcnt lgkmcnt(5)
    v_cvt_pk_bf16_f32 v173, v166, v167
    v_smfmac_f32_16x16x64_bf16 v[194:197], v[116:119], a[64:71], v187
    v_cvt_pk_bf16_f32 v176, v168, v169
    v_smfmac_f32_16x16x64_bf16 v[198:201], v[116:119], a[144:151], v187
    s_waitcnt lgkmcnt(4)
    v_cvt_pk_bf16_f32 v177, v170, v171
    v_smfmac_f32_16x16x64_bf16 v[194:197], v[120:123], a[72:79], v187
    s_cmp_lt_u32 s59, 20
    s_cselect_b32 s85, s72, s92
    s_add_u32 s86, s85, s89
    v_smfmac_f32_16x16x64_bf16 v[198:201], v[120:123], a[152:159], v187
    s_xor_b32 s96, s72, 524288
    s_nop 1
    v_smfmac_f32_16x16x64_bf16 v[202:205], v[84:87], a[160:167], v187
    s_nop 3
    v_permlane32_swap_b32 v194, v198
    v_permlane32_swap_b32 v195, v199
    v_permlane32_swap_b32 v196, v200
    v_permlane32_swap_b32 v197, v201
    v_pk_add_f32 v[194:195], v[194:195], v[198:199]
    v_pk_add_f32 v[196:197], v[196:197], v[200:201]
    v_cvt_pk_bf16_f32 v194, v194, v195
    v_cvt_pk_bf16_f32 v195, v196, v197
    ds_write_b64 v241, v[194:195] offset:12288
    v_smfmac_f32_16x16x64_bf16 v[202:205], v[88:91], a[168:175], v187
    v_smfmac_f32_16x16x64_bf16 v[202:205], v[92:95], a[176:183], v187
    v_smfmac_f32_16x16x64_bf16 v[202:205], v[96:99], a[184:191], v187
    v_smfmac_f32_16x16x64_bf16 v[202:205], v[100:103], a[192:199], v187
    v_smfmac_f32_16x16x64_bf16 v[202:205], v[104:107], a[200:207], v187
    s_waitcnt lgkmcnt(0)
    s_barrier
    ds_read_b64_tr_b16 v[124:125], v242 offset:12288
    ds_read_b64_tr_b16 v[126:127], v242 offset:12352
    ds_read_b64_tr_b16 v[132:133], v242 offset:13312
    ds_read_b64_tr_b16 v[134:135], v242 offset:13376
    v_smfmac_f32_16x16x64_bf16 v[202:205], v[108:111], a[208:215], v187
    ds_read_b128 v[148:151], v236 offset:26624
    ds_read_b128 v[156:159], v236 offset:28672
    v_smfmac_f32_16x16x64_bf16 v[202:205], v[112:115], a[216:223], v187
    ds_read_b64_tr_b16 v[128:129], v242 offset:12800
    ds_read_b64_tr_b16 v[130:131], v242 offset:12864
    v_smfmac_f32_16x16x64_bf16 v[202:205], v[116:119], a[224:231], v187
    ds_read_b64_tr_b16 v[136:137], v242 offset:13824
    ds_read_b64_tr_b16 v[138:139], v242 offset:13888
    v_smfmac_f32_16x16x64_bf16 v[202:205], v[120:123], a[232:239], v187
    ds_read_b128 v[152:155], v236 offset:27648
    ds_read_b128 v[160:163], v236 offset:29696
    s_waitcnt lgkmcnt(8)
    v_mfma_f32_16x16x32_bf16 v[214:217], v[132:135], v[124:127], 0
    s_waitcnt lgkmcnt(7)
    v_mfma_f32_16x16x32_bf16 v[206:209], v[148:151], v[124:127], 0
    s_waitcnt lgkmcnt(6)
    v_mfma_f32_16x16x32_bf16 v[210:213], v[156:159], v[124:127], 0
    ds_read_b128 v[164:167], v244 offset:22528
    ds_read_b128 v[168:171], v244 offset:23552
    s_waitcnt lgkmcnt(4)
    v_mfma_f32_16x16x32_bf16 v[214:217], v[136:139], v[128:131], v[214:217]
    s_waitcnt lgkmcnt(3)
    v_mfma_f32_16x16x32_bf16 v[206:209], v[152:155], v[128:131], v[206:209]
    s_waitcnt lgkmcnt(2)
    v_mfma_f32_16x16x32_bf16 v[210:213], v[160:163], v[128:131], v[210:213]
    v_permlane32_swap_b32 v202, v204
    v_permlane32_swap_b32 v203, v205
    v_add_f32 v202, v202, v204
    v_add_f32 v203, v203, v205
    v_cndmask_b32 v214, v214, v215, s[98:99]
    v_cndmask_b32 v216, v216, v217, s[98:99]
    v_cndmask_b32 v224, v214, v216, s[100:101]
    s_nop 0
    v_cndmask_b32 v220, v206, v210, s[98:99]
    v_cndmask_b32 v221, v207, v211, s[98:99]
    v_cndmask_b32 v222, v208, v212, s[98:99]
    v_cndmask_b32 v223, v209, v213, s[98:99]
    v_cvt_pk_bf16_f32 v174, v202, v203
    v_cvt_pk_bf16_f32 v178, v202, v203
    ds_read_b128 v[124:127], v232 offset:0
    ds_read_b128 v[128:131], v232 offset:20480
    s_waitcnt lgkmcnt(3)
    v_mfma_f32_16x16x32_bf16 v[214:217], v[132:135], v[164:167], 0
    ds_read_b128 v[140:143], v232 offset:1024
    v_mfma_f32_16x16x32_bf16 v[206:209], v[148:151], v[164:167], v[188:191]
    v_mfma_f32_16x16x32_bf16 v[210:213], v[156:159], v[164:167], v[188:191]
    s_waitcnt lgkmcnt(3)
    v_mfma_f32_16x16x32_bf16 v[214:217], v[136:139], v[168:171], v[214:217]
    ds_read_b128 v[132:135], v233 offset:0
    v_mfma_f32_16x16x32_bf16 v[206:209], v[152:155], v[168:171], v[206:209]
    ds_read_b128 v[136:139], v233 offset:20480
    v_mfma_f32_16x16x32_bf16 v[210:213], v[160:163], v[168:171], v[210:213]
    s_waitcnt lgkmcnt(4)
    v_mfma_f32_16x16x32_bf16 v[148:151], a[0:3], v[124:127], 0
    ds_read_b128 v[144:147], v232 offset:21504
    s_nop 0
    v_cndmask_b32 v214, v214, v215, s[98:99]
    v_mfma_f32_16x16x32_bf16 v[156:159], a[80:83], v[124:127], 0
    v_cndmask_b32 v216, v216, v217, s[98:99]
    v_cndmask_b32 v230, v214, v216, s[100:101]
    v_mfma_f32_16x16x32_bf16 v[164:167], v[124:127], a[160:163], 0
    s_waitcnt lgkmcnt(4)
    v_bfi_b32 v230, 1, s97, v230
    v_cndmask_b32 v226, v206, v210, s[98:99]
    v_mfma_f32_16x16x32_bf16 v[152:155], a[0:3], v[128:131], 0
    ds_read_b128 v[124:127], v233 offset:1024
    v_cndmask_b32 v227, v207, v211, s[98:99]
    v_mfma_f32_16x16x32_bf16 v[160:163], a[80:83], v[128:131], 0
    v_cndmask_b32 v228, v208, v212, s[98:99]
    v_cndmask_b32 v229, v209, v213, s[98:99]
    v_mfma_f32_16x16x32_bf16 v[168:171], v[128:131], a[160:163], 0
    v_bfi_b32 v226, 1, s97, v226
    s_waitcnt lgkmcnt(3)
    v_mfma_f32_16x16x32_bf16 v[148:151], a[4:7], v[132:135], v[148:151]
    ds_read_b128 v[128:131], v233 offset:21504
    buffer_load_dwordx4 v[84:87], v236, s[4:7], s80 offen sc1
    v_mfma_f32_16x16x32_bf16 v[156:159], a[84:87], v[132:135], v[156:159]
    buffer_load_dwordx4 v[88:91], v236, s[4:7], s81 offen sc1
    buffer_load_dword v92, v237, s[4:7], s80 offen offset:1024 sc1
    v_mfma_f32_16x16x32_bf16 v[164:167], v[132:135], a[164:167], v[164:167]
    s_waitcnt lgkmcnt(3)
    buffer_load_dword v93, v237, s[4:7], s81 offen offset:1024 sc1
    v_mfma_f32_16x16x32_bf16 v[152:155], a[4:7], v[136:139], v[152:155]
    ds_read_b128 v[132:135], v232 offset:2048
    v_mfma_f32_16x16x32_bf16 v[160:163], a[84:87], v[136:139], v[160:163]
    v_mfma_f32_16x16x32_bf16 v[168:171], v[136:139], a[164:167], v[168:171]
    v_mfma_f32_16x16x32_bf16 v[148:151], a[8:11], v[140:143], v[148:151]
    ds_read_b128 v[136:139], v232 offset:22528
    v_mfma_f32_16x16x32_bf16 v[156:159], a[88:91], v[140:143], v[156:159]
    buffer_store_dwordx4 v[226:229], v238, s[4:7], s79 offen
    buffer_store_dword v230, v239, s[4:7], s79 offen offset:1024
    v_mfma_f32_16x16x32_bf16 v[164:167], v[140:143], a[168:171], v[164:167]
    s_waitcnt lgkmcnt(4)
    v_mfma_f32_16x16x32_bf16 v[152:155], a[8:11], v[144:147], v[152:155]
    ds_read_b128 v[140:143], v233 offset:2048
    v_mfma_f32_16x16x32_bf16 v[160:163], a[88:91], v[144:147], v[160:163]
    v_mfma_f32_16x16x32_bf16 v[168:171], v[144:147], a[168:171], v[168:171]
    s_waitcnt vmcnt(4)
    v_bitop3_b32 v218, v84, v88, s97 bitop3:0x7e
    s_waitcnt vmcnt(2)
    v_bitop3_b32 v219, v92, v93, s97 bitop3:0x7e
    v_bitop3_b32 v218, v218, v219, 1 bitop3:0xa8
    v_cmp_eq_u32 vcc, 1, v218
    s_cbranch_vccnz Lrty_45
    v_pk_add_f32 v[84:85], v[84:85], v[88:89]
    v_pk_add_f32 v[86:87], v[86:87], v[90:91]
    v_add_f32 v92, v92, v93
    v_pk_add_f32 v[220:221], v[220:221], v[84:85]
    v_pk_add_f32 v[222:223], v[222:223], v[86:87]
    v_add_f32 v224, v224, v92
Lok_44:
    v_max3_f32 v218, v220, v221, v222
    v_max3_f32 v218, v218, v223, v224
    buffer_load_dwordx4 v[108:111], v238, s[4:7], s80 offen sc1
    buffer_load_dwordx4 v[112:115], v238, s[4:7], s81 offen sc1
    v_max_f32_dpp v218, v218, v218 row_ror:8 row_mask:0xf bank_mask:0xf
    v_mov_b32 v219, v218
    buffer_load_dword v116, v239, s[4:7], s80 offen offset:1024 sc1
    buffer_load_dword v117, v239, s[4:7], s81 offen offset:1024 sc1
    v_permlane16_swap_b32 v218, v219
    v_max_f32 v218, v218, v219
    v_mov_b32 v219, v218
    s_add_u32 m0, s73, 0
    s_add_u32 s94, s74, 0
    buffer_load_dwordx4 v234, s[4:7], s94 offen sc1 lds
    v_permlane32_swap_b32 v218, v219
    v_max_f32 v218, v218, v219
    v_mul_f32 v218, s70, v218
    v_fma_f32 v224, v224, s70, -v218
    v_fma_f32 v220, v220, s70, -v218
    v_fma_f32 v221, v221, s70, -v218
    v_fma_f32 v222, v222, s70, -v218
    v_fma_f32 v223, v223, s70, -v218
    v_exp_f32 v224, v224
    v_exp_f32 v220, v220
    v_exp_f32 v221, v221
    v_exp_f32 v222, v222
    v_exp_f32 v223, v223
    v_cvt_pk_bf16_f32 v186, v224, v224
    v_cvt_pk_bf16_f32 v184, v220, v221
    v_and_b32 v186, v231, v186
    v_cvt_pk_bf16_f32 v185, v222, v223
    s_add_u32 m0, s73, 4096
    s_add_u32 s94, s74, 4096
    buffer_load_dwordx4 v234, s[4:7], s94 offen sc1 lds
    v_mfma_f32_16x16x32_bf16 v[202:205], v[180:183], v[184:187], 0
    s_nop 0
    v_mov_b64 v[206:207], 0
    v_mov_b64 v[208:209], 0
    v_mfma_f32_16x16x32_bf16 v[194:197], v[172:175], v[184:187], 0
    s_nop 0
    v_mov_b64 v[210:211], 0
    v_mov_b64 v[212:213], 0
    v_mfma_f32_16x16x32_bf16 v[198:201], v[176:179], v[184:187], 0
    s_nop 2
    s_waitcnt lgkmcnt(4)
    v_mfma_f32_16x16x32_bf16 v[148:151], a[12:15], v[124:127], v[148:151]
    s_nop 0
    ds_read_b128 v[144:147], v233 offset:22528
    v_add_f32_dpp v202, v202, v202 row_ror:8 row_mask:0xf bank_mask:0xf
    v_rcp_f32 v202, v202
    v_add_f32_dpp v194, v198, v194 row_ror:8 row_mask:0xf bank_mask:0xf
    v_add_f32_dpp v195, v199, v195 row_ror:8 row_mask:0xf bank_mask:0xf
    v_add_f32_dpp v196, v200, v196 row_ror:8 row_mask:0xf bank_mask:0xf
    v_add_f32_dpp v197, v201, v197 row_ror:8 row_mask:0xf bank_mask:0xf
    v_pk_mul_f32 v[194:195], v[194:195], v[202:203] op_sel_hi:[1,0]
    v_pk_mul_f32 v[196:197], v[196:197], v[202:203] op_sel_hi:[1,0]
    v_cvt_pk_bf16_f32 v194, v194, v195
    v_cvt_pk_bf16_f32 v195, v196, v197
    v_min_u32 v194, -2, v194
    buffer_store_dwordx2 v[194:195], v247, s[4:7], s72 offen
    v_mfma_f32_16x16x32_bf16 v[156:159], a[92:95], v[124:127], v[156:159]
    s_waitcnt vmcnt(5)
    v_bitop3_b32 v218, v108, v112, s97 bitop3:0x7e
    s_waitcnt vmcnt(3)
    v_bitop3_b32 v219, v116, v117, s97 bitop3:0x7e
    v_bitop3_b32 v218, v218, v219, 1 bitop3:0xa8
    v_cmp_eq_u32 vcc, 1, v218
    s_cbranch_vccnz Lrty_47
Lok_46:
    v_mfma_f32_16x16x32_bf16 v[164:167], v[124:127], a[172:175], v[164:167]
    s_waitcnt lgkmcnt(4)
    v_add_f32 v108, v108, v112
    v_add_f32 v109, v109, v113
    v_mfma_f32_16x16x32_bf16 v[152:155], a[12:15], v[128:131], v[152:155]
    ds_read_b128 v[124:127], v232 offset:3072
    v_add_f32 v110, v110, v114
    v_mfma_f32_16x16x32_bf16 v[160:163], a[92:95], v[128:131], v[160:163]
    v_add_f32 v111, v111, v115
    v_add_f32 v116, v116, v117
    v_mfma_f32_16x16x32_bf16 v[168:171], v[128:131], a[172:175], v[168:171]
    s_waitcnt lgkmcnt(4)
    v_add_f32 v226, v226, v108
    v_add_f32 v227, v227, v109
    v_mfma_f32_16x16x32_bf16 v[148:151], a[16:19], v[132:135], v[148:151]
    ds_read_b128 v[128:131], v232 offset:23552
    v_add_f32 v228, v228, v110
    v_mfma_f32_16x16x32_bf16 v[156:159], a[96:99], v[132:135], v[156:159]
    v_add_f32 v229, v229, v111
    v_add_f32 v230, v230, v116
    v_mfma_f32_16x16x32_bf16 v[164:167], v[132:135], a[176:179], v[164:167]
    s_waitcnt lgkmcnt(4)
    v_max3_f32 v218, v226, v227, v228
    v_max3_f32 v218, v218, v229, v230
    v_mfma_f32_16x16x32_bf16 v[152:155], a[16:19], v[136:139], v[152:155]
    ds_read_b128 v[132:135], v233 offset:3072
    v_max_f32_dpp v218, v218, v218 row_ror:8 row_mask:0xf bank_mask:0xf
    v_mfma_f32_16x16x32_bf16 v[160:163], a[96:99], v[136:139], v[160:163]
    v_mov_b32 v219, v218
    s_nop 0
    v_mfma_f32_16x16x32_bf16 v[168:171], v[136:139], a[176:179], v[168:171]
    s_waitcnt lgkmcnt(4)
    v_permlane16_swap_b32 v218, v219
    v_mfma_f32_16x16x32_bf16 v[148:151], a[20:23], v[140:143], v[148:151]
    ds_read_b128 v[136:139], v233 offset:23552
    v_max_f32 v218, v218, v219
    v_mfma_f32_16x16x32_bf16 v[156:159], a[100:103], v[140:143], v[156:159]
    buffer_load_dwordx4 v[84:87], v248, s[4:7], s85 offen offset:0 sc1
    v_mov_b32 v219, v218
    v_mfma_f32_16x16x32_bf16 v[164:167], v[140:143], a[180:183], v[164:167]
    s_waitcnt lgkmcnt(4)
    v_permlane32_swap_b32 v218, v219
    v_mfma_f32_16x16x32_bf16 v[152:155], a[20:23], v[144:147], v[152:155]
    ds_read_b128 v[140:143], v232 offset:4096
    buffer_load_dwordx4 v[88:91], v248, s[4:7], s85 offen offset:1024 sc1
    v_mfma_f32_16x16x32_bf16 v[160:163], a[100:103], v[144:147], v[160:163]
    v_max_f32 v218, v218, v219
    v_mul_f32 v218, s70, v218
    v_mfma_f32_16x16x32_bf16 v[168:171], v[144:147], a[180:183], v[168:171]
    s_waitcnt lgkmcnt(4)
    buffer_load_dwordx4 v[92:95], v248, s[4:7], s85 offen offset:2048 sc1
    v_fma_f32 v230, v230, s70, -v218
    v_mfma_f32_16x16x32_bf16 v[148:151], a[24:27], v[124:127], v[148:151]
    ds_read_b128 v[144:147], v232 offset:24576
    v_fma_f32 v226, v226, s70, -v218
    v_mfma_f32_16x16x32_bf16 v[156:159], a[104:107], v[124:127], v[156:159]
    buffer_load_dwordx4 v[96:99], v248, s[4:7], s85 offen offset:3072 sc1
    v_fma_f32 v227, v227, s70, -v218
    v_mfma_f32_16x16x32_bf16 v[164:167], v[124:127], a[184:187], v[164:167]
    v_fma_f32 v228, v228, s70, -v218
    v_fma_f32 v229, v229, s70, -v218
    buffer_load_dwordx4 v[100:103], v248, s[4:7], s86 offen offset:0 sc1
    buffer_load_dwordx4 v[104:107], v248, s[4:7], s86 offen offset:1024 sc1
Lwchk_48:
    s_waitcnt vmcnt(5)
    v_max_u32 v194, v84, v86
    s_waitcnt vmcnt(4)
    v_max3_u32 v194, v194, v88, v90
    v_cmp_lt_u32 vcc, s87, v194
    s_cbranch_vccnz Lwrty_49
    v_smfmac_f32_16x16x64_bf16 v[206:209], v[84:87], a[240:247], v187
    v_exp_f32 v230, v230
    v_smfmac_f32_16x16x64_bf16 v[210:213], v[84:87], a[248:255], v187
    v_exp_f32 v226, v226
    v_smfmac_f32_16x16x64_bf16 v[206:209], v[88:91], v[4:11], v187
    v_exp_f32 v227, v227
    v_smfmac_f32_16x16x64_bf16 v[210:213], v[88:91], v[12:19], v187
Lwchk_50:
    s_waitcnt vmcnt(3)
    v_max_u32 v194, v92, v94
    s_waitcnt vmcnt(2)
    v_max3_u32 v194, v194, v96, v98
    v_cmp_lt_u32 vcc, s87, v194
    s_cbranch_vccnz Lwrty_51
    v_smfmac_f32_16x16x64_bf16 v[206:209], v[92:95], v[20:27], v187
    v_exp_f32 v228, v228
    v_smfmac_f32_16x16x64_bf16 v[210:213], v[92:95], v[28:35], v187
    v_exp_f32 v229, v229
    v_smfmac_f32_16x16x64_bf16 v[206:209], v[96:99], v[36:43], v187
    v_cvt_pk_bf16_f32 v200, v230, v230
    v_smfmac_f32_16x16x64_bf16 v[210:213], v[96:99], v[44:51], v187
Lwchk_52:
    s_waitcnt vmcnt(1)
    v_max_u32 v194, v100, v102
    s_waitcnt vmcnt(0)
    v_max3_u32 v194, v194, v104, v106
    v_cmp_lt_u32 vcc, s87, v194
    s_cbranch_vccnz Lwrty_53
    v_smfmac_f32_16x16x64_bf16 v[206:209], v[100:103], v[52:59], v187
    v_cvt_pk_bf16_f32 v198, v226, v227
    v_smfmac_f32_16x16x64_bf16 v[210:213], v[100:103], v[60:67], v187
    v_cvt_pk_bf16_f32 v199, v228, v229
    v_smfmac_f32_16x16x64_bf16 v[206:209], v[104:107], v[68:75], v187
    ds_write_b16 v246, v200 offset:14344
    v_smfmac_f32_16x16x64_bf16 v[210:213], v[104:107], v[76:83], v187
    s_nop 0
    ds_write_b64 v245, v[198:199] offset:14336
    s_waitcnt lgkmcnt(6)
    v_mfma_f32_16x16x32_bf16 v[152:155], a[24:27], v[128:131], v[152:155]
    s_nop 0
    ds_read_b128 v[124:127], v233 offset:4096
    s_nop 0
    v_mfma_f32_16x16x32_bf16 v[160:163], a[104:107], v[128:131], v[160:163]
    v_permlane32_swap_b32 v206, v210
    v_permlane32_swap_b32 v207, v211
    v_permlane32_swap_b32 v208, v212
    v_permlane32_swap_b32 v209, v213
    v_pk_add_f32 v[206:207], v[206:207], v[210:211]
    v_pk_add_f32 v[208:209], v[208:209], v[212:213]
    ds_write2_b32 v249, v206, v207 offset0:0 offset1:32
    ds_write2_b32 v249, v208, v209 offset0:64 offset1:96
    v_mfma_f32_16x16x32_bf16 v[168:171], v[128:131], a[184:187], v[168:171]
    s_waitcnt lgkmcnt(8)
    v_mfma_f32_16x16x32_bf16 v[148:151], a[28:31], v[132:135], v[148:151]
    ds_read_b128 v[128:131], v233 offset:24576
    v_mfma_f32_16x16x32_bf16 v[156:159], a[108:111], v[132:135], v[156:159]
    v_mfma_f32_16x16x32_bf16 v[164:167], v[132:135], a[188:191], v[164:167]
    s_waitcnt lgkmcnt(1)
    s_barrier
    buffer_load_dword v2, v252, s[4:7], 0 offen sc1
    ds_read_b64 v[120:121], v240 offset:16896
    v_mfma_f32_16x16x32_bf16 v[152:155], a[28:31], v[136:139], v[152:155]
    ds_read_b128 v[132:135], v232 offset:5120
    ds_read_b128 v[112:115], v236 offset:14336
    v_mfma_f32_16x16x32_bf16 v[160:163], a[108:111], v[136:139], v[160:163]
    ds_read_b128 v[116:119], v236 offset:15872
    v_mfma_f32_16x16x32_bf16 v[168:171], v[136:139], a[188:191], v[168:171]
    v_mfma_f32_16x16x32_bf16 v[148:151], a[32:35], v[140:143], v[148:151]
    ds_read_b128 v[136:139], v232 offset:25600
    s_waitcnt lgkmcnt(4)
    v_mfma_f32_16x16x16_bf16 v[206:209], v[180:181], v[120:121], 0
    v_mfma_f32_16x16x16_bf16 v[198:201], v[176:177], v[120:121], 0
    s_waitcnt lgkmcnt(2)
    v_mfma_f32_16x16x32_bf16 v[202:205], v[180:183], v[112:115], 0
    buffer_store_dword v192, v247, s[4:7], s96 offen
    v_mfma_f32_16x16x32_bf16 v[194:197], v[172:175], v[112:115], 0
    v_mfma_f32_16x16x32_bf16 v[156:159], a[112:115], v[140:143], v[156:159]
    v_mfma_f32_16x16x32_bf16 v[164:167], v[140:143], a[192:195], v[164:167]
    v_mfma_f32_16x16x32_bf16 v[152:155], a[32:35], v[144:147], v[152:155]
    ds_read_b128 v[140:143], v233 offset:5120
    s_waitcnt lgkmcnt(2)
    v_mfma_f32_16x16x32_bf16 v[206:209], v[180:183], v[116:119], v[206:209]
    v_mfma_f32_16x16x32_bf16 v[198:201], v[172:175], v[116:119], v[198:201]
    v_mfma_f32_16x16x32_bf16 v[160:163], a[112:115], v[144:147], v[160:163]
    v_rcp_f32 v202, v202
    v_mfma_f32_16x16x32_bf16 v[168:171], v[144:147], a[192:195], v[168:171]
    v_mul_f32 v194, v194, v202
    v_mul_f32 v195, v195, v202
    v_mfma_f32_16x16x32_bf16 v[148:151], a[36:39], v[124:127], v[148:151]
    ds_read_b128 v[144:147], v233 offset:25600
    v_mul_f32 v196, v196, v202
    v_mfma_f32_16x16x32_bf16 v[156:159], a[116:119], v[124:127], v[156:159]
    v_mul_f32 v197, v197, v202
    v_cvt_pk_bf16_f32 v210, v194, v195
    v_mfma_f32_16x16x32_bf16 v[164:167], v[124:127], a[196:199], v[164:167]
    v_cvt_pk_bf16_f32 v211, v196, v197
    v_mfma_f32_16x16x32_bf16 v[152:155], a[36:39], v[128:131], v[152:155]
    ds_read_b128 v[124:127], v232 offset:6144
    v_mfma_f32_16x16x32_bf16 v[160:163], a[116:119], v[128:131], v[160:163]
    buffer_store_dwordx2 v[210:211], v243, s[4:7], s75 offen offset:0
    v_rcp_f32 v206, v206
    s_nop 0
    v_mfma_f32_16x16x32_bf16 v[168:171], v[128:131], a[196:199], v[168:171]
    v_mul_f32 v198, v198, v206
    v_mul_f32 v199, v199, v206
    v_mfma_f32_16x16x32_bf16 v[148:151], a[40:43], v[132:135], v[148:151]
    ds_read_b128 v[128:131], v232 offset:26624
    v_mul_f32 v200, v200, v206
    v_mfma_f32_16x16x32_bf16 v[156:159], a[120:123], v[132:135], v[156:159]
    v_mul_f32 v201, v201, v206
    v_cvt_pk_bf16_f32 v212, v198, v199
    v_mfma_f32_16x16x32_bf16 v[164:167], v[132:135], a[200:203], v[164:167]
    s_waitcnt lgkmcnt(4)
    v_cvt_pk_bf16_f32 v213, v200, v201
    v_mfma_f32_16x16x32_bf16 v[152:155], a[40:43], v[136:139], v[152:155]
    ds_read_b128 v[132:135], v233 offset:6144
    v_mfma_f32_16x16x32_bf16 v[160:163], a[120:123], v[136:139], v[160:163]
    buffer_store_dwordx2 v[212:213], v243, s[4:7], s75 offen offset:2048
    s_cmp_eq_u32 s62, 63
    s_cbranch_scc1 L_Clast
    v_mfma_f32_16x16x32_bf16 v[168:171], v[136:139], a[200:203], v[168:171]
    s_waitcnt lgkmcnt(4)
    s_add_u32 s75, s75, 393216
    s_add_u32 s66, s62, 1
    v_mfma_f32_16x16x32_bf16 v[148:151], a[44:47], v[140:143], v[148:151]
    ds_read_b128 v[136:139], v233 offset:26624
    v_mfma_f32_16x16x32_bf16 v[156:159], a[124:127], v[140:143], v[156:159]
    s_and_b32 s66, s66, 7
    s_cselect_b32 s66, 0, 3145728
    s_sub_u32 s75, s75, s66
    v_mfma_f32_16x16x32_bf16 v[164:167], v[140:143], a[204:207], v[164:167]
    s_waitcnt lgkmcnt(4)
    v_mov_b64 v[194:195], 0
    v_mov_b64 v[196:197], 0
    v_mfma_f32_16x16x32_bf16 v[152:155], a[44:47], v[144:147], v[152:155]
    ds_read_b128 v[140:143], v232 offset:7168
    v_mov_b64 v[198:199], 0
    v_mfma_f32_16x16x32_bf16 v[160:163], a[124:127], v[144:147], v[160:163]
    v_mov_b64 v[200:201], 0
    v_mov_b64 v[202:203], 0
    v_mfma_f32_16x16x32_bf16 v[168:171], v[144:147], a[204:207], v[168:171]
    s_waitcnt lgkmcnt(4)
    v_mov_b64 v[204:205], 0
    v_mfma_f32_16x16x32_bf16 v[148:151], a[48:51], v[124:127], v[148:151]
    ds_read_b128 v[144:147], v232 offset:27648
    v_mfma_f32_16x16x32_bf16 v[156:159], a[128:131], v[124:127], v[156:159]
    v_mfma_f32_16x16x32_bf16 v[164:167], v[124:127], a[208:211], v[164:167]
    s_waitcnt lgkmcnt(4)
    v_mfma_f32_16x16x32_bf16 v[152:155], a[48:51], v[128:131], v[152:155]
    ds_read_b128 v[124:127], v233 offset:7168
    v_mfma_f32_16x16x32_bf16 v[160:163], a[128:131], v[128:131], v[160:163]
    v_mfma_f32_16x16x32_bf16 v[168:171], v[128:131], a[208:211], v[168:171]
    s_waitcnt lgkmcnt(4)
    v_mfma_f32_16x16x32_bf16 v[148:151], a[52:55], v[132:135], v[148:151]
    ds_read_b128 v[128:131], v233 offset:27648
    v_mfma_f32_16x16x32_bf16 v[156:159], a[132:135], v[132:135], v[156:159]
    v_add_u32_e64 v218, s62, 1
    v_mfma_f32_16x16x32_bf16 v[164:167], v[132:135], a[212:215], v[164:167]
    s_waitcnt lgkmcnt(4)
    s_waitcnt vmcnt(0)
    buffer_store_dword v218, v1, s[4:7], s3 offen
    v_lshl_add_u32 v3, s62, 1, v225
    v_mfma_f32_16x16x32_bf16 v[152:155], a[52:55], v[136:139], v[152:155]
    ds_read_b128 v[132:135], v232 offset:8192
    v_min_i32 v3, 128, v3
    v_mfma_f32_16x16x32_bf16 v[160:163], a[132:135], v[136:139], v[160:163]
Lfchk_54:
    v_cmp_gt_i32 vcc, v3, v2
    s_cbranch_vccnz Lfrty_55
    v_mfma_f32_16x16x32_bf16 v[168:171], v[136:139], a[212:215], v[168:171]
    s_waitcnt lgkmcnt(4)
    v_mfma_f32_16x16x32_bf16 v[148:151], a[56:59], v[140:143], v[148:151]
    s_add_u32 s82, s72, 178176
    ds_read_b128 v[136:139], v232 offset:28672
    s_add_u32 s83, s72, 182272
    v_mfma_f32_16x16x32_bf16 v[156:159], a[136:139], v[140:143], v[156:159]
    s_add_u32 m0, s73, 8192
    s_add_u32 s94, s74, 16384
    buffer_load_dwordx4 v234, s[4:7], s94 offen sc1 lds
    v_mfma_f32_16x16x32_bf16 v[164:167], v[140:143], a[216:219], v[164:167]
    s_waitcnt lgkmcnt(4)
    v_mfma_f32_16x16x32_bf16 v[152:155], a[56:59], v[144:147], v[152:155]
    ds_read_b128 v[140:143], v233 offset:8192
    s_add_u32 m0, s73, 12288
    s_add_u32 s94, s74, 20480
    buffer_load_dwordx4 v234, s[4:7], s94 offen sc1 lds
    s_add_u32 m0, s73, 16384
    s_add_u32 s94, s74, 32768
    buffer_load_dwordx4 v234, s[4:7], s94 offen sc1 lds
    s_add_u32 m0, s73, 20480
    s_add_u32 s94, s74, 36864
    buffer_load_dwordx4 v234, s[4:7], s94 offen sc1 lds
    s_add_u32 m0, s73, 24576
    s_add_u32 s94, s74, 49152
    buffer_load_dwordx4 v234, s[4:7], s94 offen sc1 lds
    s_add_u32 m0, s73, 28672
    s_add_u32 s94, s74, 53248
    buffer_load_dwordx4 v234, s[4:7], s94 offen sc1 lds
    s_add_u32 m0, s73, 32768
    s_add_u32 s94, s74, 65536
    buffer_load_dwordx4 v234, s[4:7], s94 offen sc1 lds
    s_add_u32 m0, s73, 36864
    s_add_u32 s94, s74, 69632
    buffer_load_dwordx4 v234, s[4:7], s94 offen sc1 lds
    s_barrier
    v_mfma_f32_16x16x32_bf16 v[160:163], a[136:139], v[144:147], v[160:163]
    v_mfma_f32_16x16x32_bf16 v[168:171], v[144:147], a[216:219], v[168:171]
    s_waitcnt lgkmcnt(4)
    v_mfma_f32_16x16x32_bf16 v[148:151], a[60:63], v[124:127], v[148:151]
    ds_read_b128 v[144:147], v233 offset:28672
    v_mfma_f32_16x16x32_bf16 v[156:159], a[140:143], v[124:127], v[156:159]
    v_mfma_f32_16x16x32_bf16 v[164:167], v[124:127], a[220:223], v[164:167]
    s_waitcnt lgkmcnt(4)
    v_mfma_f32_16x16x32_bf16 v[152:155], a[60:63], v[128:131], v[152:155]
    ds_read_b128 v[124:127], v232 offset:9216
    v_mfma_f32_16x16x32_bf16 v[160:163], a[140:143], v[128:131], v[160:163]
    v_mfma_f32_16x16x32_bf16 v[168:171], v[128:131], a[220:223], v[168:171]
    s_waitcnt lgkmcnt(4)
    v_mfma_f32_16x16x32_bf16 v[148:151], a[64:67], v[132:135], v[148:151]
    ds_read_b128 v[128:131], v232 offset:29696
    v_mfma_f32_16x16x32_bf16 v[156:159], a[144:147], v[132:135], v[156:159]
    v_mfma_f32_16x16x32_bf16 v[164:167], v[132:135], a[224:227], v[164:167]
    s_waitcnt lgkmcnt(4)
    v_mfma_f32_16x16x32_bf16 v[152:155], a[64:67], v[136:139], v[152:155]
    s_add_u32 s86, s72, 262144
    ds_read_b128 v[132:135], v233 offset:9216
    buffer_load_dwordx4 v[112:115], v234, s[4:7], s82 offen sc1
    v_mfma_f32_16x16x32_bf16 v[160:163], a[144:147], v[136:139], v[160:163]
    s_and_b32 s86, s86, 786432
    buffer_load_dwordx4 v[116:119], v234, s[4:7], s83 offen sc1
    buffer_load_dwordx2 v[120:121], v235, s[4:7], s82 offen sc1
    v_mfma_f32_16x16x32_bf16 v[168:171], v[136:139], a[224:227], v[168:171]
    s_waitcnt lgkmcnt(4)
    s_andn2_b32 s72, s72, 786432
    s_or_b32 s72, s72, s86
    v_mfma_f32_16x16x32_bf16 v[148:151], a[68:71], v[140:143], v[148:151]
    s_mov_b32 s74, s92
    ds_read_b128 v[136:139], v233 offset:29696
    s_xor_b32 s73, s73, 65536
    v_mfma_f32_16x16x32_bf16 v[156:159], a[148:151], v[140:143], v[156:159]
    s_add_u32 s91, s91, 131072
    s_lshr_b32 s92, s91, 8
    s_xor_b32 s92, s92, s1
    v_mfma_f32_16x16x32_bf16 v[164:167], v[140:143], a[228:231], v[164:167]
    s_waitcnt lgkmcnt(4)
    s_and_b32 s92, s92, s93
    s_or_b32 s92, s92, s91
    v_mfma_f32_16x16x32_bf16 v[152:155], a[68:71], v[144:147], v[152:155]
    v_mfma_f32_16x16x32_bf16 v[160:163], a[148:151], v[144:147], v[160:163]
    buffer_load_dwordx4 v[100:103], v234, s[4:7], s82 offen sc1
    buffer_load_dwordx4 v[104:107], v234, s[4:7], s83 offen sc1
    v_mfma_f32_16x16x32_bf16 v[168:171], v[144:147], a[228:231], v[168:171]
    s_waitcnt lgkmcnt(3)
    buffer_load_dwordx2 v[108:109], v235, s[4:7], s82 offen sc1
    v_mfma_f32_16x16x32_bf16 v[148:151], a[72:75], v[124:127], v[148:151]
    v_mfma_f32_16x16x32_bf16 v[156:159], a[152:155], v[124:127], v[156:159]
    v_mfma_f32_16x16x32_bf16 v[164:167], v[124:127], a[232:235], v[164:167]
    s_add_u32 s62, s62, 1
    s_branch L_Ctop0
Lrty_42:
    buffer_load_dwordx4 v[112:115], v234, s[4:7], s82 offen sc1
    buffer_load_dwordx4 v[116:119], v234, s[4:7], s83 offen sc1
    buffer_load_dwordx2 v[120:121], v235, s[4:7], s82 offen sc1
    s_sub_u32 s61, s61, 1
    s_mov_b32 s67, 15
    s_cbranch_scc1 L_fail
    s_waitcnt vmcnt(4)
    v_max3_u32 v218, v100, v102, v104
    s_waitcnt vmcnt(3)
    v_max3_u32 v218, v218, v106, v108
    v_cmp_eq_u32 vcc, -1, v218
    s_cbranch_vccnz Lrty_43
    ds_write_b128 v234, v[100:103] offset:0
    ds_write_b128 v234, v[104:107] offset:4096
    ds_write_b64 v235, v[108:109] offset:0
    s_branch Lok_41
Lrty_43:
    buffer_load_dwordx4 v[100:103], v234, s[4:7], s82 offen sc1
    buffer_load_dwordx4 v[104:107], v234, s[4:7], s83 offen sc1
    buffer_load_dwordx2 v[108:109], v235, s[4:7], s82 offen sc1
    s_sub_u32 s61, s61, 1
    s_mov_b32 s67, 15
    s_cbranch_scc1 L_fail
    s_waitcnt vmcnt(4)
    v_max3_u32 v218, v112, v114, v116
    s_waitcnt vmcnt(3)
    v_max3_u32 v218, v218, v118, v120
    v_cmp_eq_u32 vcc, -1, v218
    s_cbranch_vccnz Lrty_42
    ds_write_b128 v234, v[112:115] offset:0
    ds_write_b128 v234, v[116:119] offset:4096
    ds_write_b64 v235, v[120:121] offset:0
    s_branch Lok_41
Lrty_45:
    buffer_load_dwordx4 v[84:87], v236, s[4:7], s80 offen sc1
    buffer_load_dwordx4 v[88:91], v236, s[4:7], s81 offen sc1
    buffer_load_dword v92, v237, s[4:7], s80 offen offset:1024 sc1
    buffer_load_dword v93, v237, s[4:7], s81 offen offset:1024 sc1
    s_sub_u32 s61, s61, 1
    s_mov_b32 s67, 11
    s_cbranch_scc1 L_fail
    s_waitcnt vmcnt(2)
    v_bitop3_b32 v218, v84, v88, s97 bitop3:0x7e
    s_waitcnt vmcnt(0)
    v_bitop3_b32 v219, v92, v93, s97 bitop3:0x7e
    v_bitop3_b32 v218, v218, v219, 1 bitop3:0xa8
    v_cmp_eq_u32 vcc, 1, v218
    s_cbranch_vccnz Lrty_45
    v_pk_add_f32 v[84:85], v[84:85], v[88:89]
    v_pk_add_f32 v[86:87], v[86:87], v[90:91]
    v_add_f32 v92, v92, v93
    v_pk_add_f32 v[220:221], v[220:221], v[84:85]
    v_pk_add_f32 v[222:223], v[222:223], v[86:87]
    v_add_f32 v224, v224, v92
    s_branch Lok_44
Lrty_47:
    buffer_load_dwordx4 v[108:111], v238, s[4:7], s80 offen sc1
    buffer_load_dwordx4 v[112:115], v238, s[4:7], s81 offen sc1
    buffer_load_dword v116, v239, s[4:7], s80 offen offset:1024 sc1
    buffer_load_dword v117, v239, s[4:7], s81 offen offset:1024 sc1
    s_sub_u32 s61, s61, 1
    s_mov_b32 s67, 12
    s_cbranch_scc1 L_fail
    s_waitcnt vmcnt(2)
    v_bitop3_b32 v218, v108, v112, s97 bitop3:0x7e
    s_waitcnt vmcnt(0)
    v_bitop3_b32 v219, v116, v117, s97 bitop3:0x7e
    v_bitop3_b32 v218, v218, v219, 1 bitop3:0xa8
    v_cmp_eq_u32 vcc, 1, v218
    s_cbranch_vccnz Lrty_47
    s_branch Lok_46
Lwrty_49:
    buffer_load_dwordx4 v[84:87], v248, s[4:7], s85 offen offset:0 sc1
    buffer_load_dwordx4 v[88:91], v248, s[4:7], s85 offen offset:1024 sc1
    buffer_load_dwordx4 v[92:95], v248, s[4:7], s85 offen offset:2048 sc1
    buffer_load_dwordx4 v[96:99], v248, s[4:7], s85 offen offset:3072 sc1
    buffer_load_dwordx4 v[100:103], v248, s[4:7], s86 offen offset:0 sc1
    buffer_load_dwordx4 v[104:107], v248, s[4:7], s86 offen offset:1024 sc1
    s_sub_u32 s61, s61, 1
    s_mov_b32 s67, 13
    s_cbranch_scc1 L_fail
    s_branch Lwchk_48
Lwrty_51:
    buffer_load_dwordx4 v[92:95], v248, s[4:7], s85 offen offset:2048 sc1
    buffer_load_dwordx4 v[96:99], v248, s[4:7], s85 offen offset:3072 sc1
    buffer_load_dwordx4 v[100:103], v248, s[4:7], s86 offen offset:0 sc1
    buffer_load_dwordx4 v[104:107], v248, s[4:7], s86 offen offset:1024 sc1
    s_sub_u32 s61, s61, 1
    s_mov_b32 s67, 13
    s_cbranch_scc1 L_fail
    s_branch Lwchk_50
Lwrty_53:
    buffer_load_dwordx4 v[100:103], v248, s[4:7], s86 offen offset:0 sc1
    buffer_load_dwordx4 v[104:107], v248, s[4:7], s86 offen offset:1024 sc1
    s_sub_u32 s61, s61, 1
    s_mov_b32 s67, 13
    s_cbranch_scc1 L_fail
    s_branch Lwchk_52
Lfrty_55:
    s_sleep 4
    buffer_load_dword v2, v252, s[4:7], 0 offen sc1
    s_sub_u32 s61, s61, 1
    s_mov_b32 s67, 10
    s_cbranch_scc1 L_fail
    s_waitcnt vmcnt(0)
    s_branch Lfchk_54
L_Clast:
    s_waitcnt vmcnt(0)
    v_mov_b32 v194, 64
    s_mov_b64 exec, 1
    buffer_store_dword v194, off, s[4:7], s3
    s_mov_b64 exec, -1
    s_endpgm
L_roleT:
    s_mov_b32 s24, s42
    s_mov_b32 s25, s43
    s_mov_b32 s26, 7864320
    s_mov_b32 s27, 0x20000
    v_and_b32 v1, 63, v0
    s_and_b32 s75, s59, 1
    s_bfe_u32 s76, s59, 0x10001
    s_lshl_b32 s64, s69, 1
    s_add_u32 s76, s76, s64
    s_mul_i32 s64, s76, 983040
    s_mul_i32 s65, s60, 10240
    s_add_u32 s64, s64, s65
    s_lshl_b32 s65, s75, 8
    s_add_u32 s65, s65, s64
    v_lshrrev_b32 v164, 4, v1
    v_mul_u32_u24 v164, 1280, v164
    v_and_b32 v166, 15, v1
    v_lshl_add_u32 v164, v166, 4, v164
    v_add_u32 v164, s65, v164
    s_lshl_b32 s65, s75, 7
    s_add_u32 s65, s65, s64
    s_add_u32 s65, s65, 1024
    v_lshrrev_b32 v165, 3, v1
    v_mul_u32_u24 v165, 1280, v165
    v_and_b32 v166, 7, v1
    v_lshl_add_u32 v165, v166, 4, v165
    v_add_u32 v165, s65, v165
    v_lshrrev_b32 v166, 4, v1
    v_lshlrev_b32 v166, 3, v166
    v_bfe_u32 v167, v1, 2, 2
    v_add_u32 v166, v166, v167
    v_and_b32 v167, 3, v1
    v_lshlrev_b32 v168, 7, v166
    v_lshl_add_u32 v168, v167, 3, v168
    s_lshl_b32 s64, s60, 5
    v_add_u32 v168, s64, v168
    v_lshlrev_b32 v166, 1, v168
    v_add_u32 v167, 40960, v166
    v_add_u32 v169, 40960, v168
    v_lshlrev_b32 v238, 4, v0
    v_lshlrev_b32 v239, 4, v1
    s_lshl_b32 s64, s60, 14
    s_add_u32 s64, s64, 98304
    v_add_u32 v240, s64, v239
    s_lshl_b32 s70, s60, 11
    s_lshl_b32 s72, s60, 10
    s_mov_b32 s64, 0
    s_add_u32 m0, s70, 0
    s_nop 0
    buffer_load_dwordx4 v164, s[24:27], s64 offen lds
    s_mov_b32 s64, 5120
    s_add_u32 m0, s70, 1024
    s_nop 0
    buffer_load_dwordx4 v164, s[24:27], s64 offen lds
    s_mov_b32 s64, 512
    s_add_u32 m0, s70, 8192
    s_nop 0
    buffer_load_dwordx4 v164, s[24:27], s64 offen lds
    s_mov_b32 s64, 5632
    s_add_u32 m0, s70, 9216
    s_nop 0
    buffer_load_dwordx4 v164, s[24:27], s64 offen lds
    s_mov_b32 s64, 0
    s_add_u32 m0, s72, 16384
    s_nop 0
    buffer_load_dwordx4 v165, s[24:27], s64 offen lds
    s_mov_b32 s64, 40960
    s_add_u32 m0, s70, 20480
    s_nop 0
    buffer_load_dwordx4 v164, s[24:27], s64 offen lds
    s_mov_b32 s64, 46080
    s_add_u32 m0, s70, 21504
    s_nop 0
    buffer_load_dwordx4 v164, s[24:27], s64 offen lds
    s_mov_b32 s64, 41472
    s_add_u32 m0, s70, 28672
    s_nop 0
    buffer_load_dwordx4 v164, s[24:27], s64 offen lds
    s_mov_b32 s64, 46592
    s_add_u32 m0, s70, 29696
    s_nop 0
    buffer_load_dwordx4 v164, s[24:27], s64 offen lds
    s_mov_b32 s64, 40960
    s_add_u32 m0, s72, 36864
    s_nop 0
    buffer_load_dwordx4 v165, s[24:27], s64 offen lds
    s_mov_b32 s64, 81920
    s_add_u32 m0, s70, 40960
    s_nop 0
    buffer_load_dwordx4 v164, s[24:27], s64 offen lds
    s_mov_b32 s64, 87040
    s_add_u32 m0, s70, 41984
    s_nop 0
    buffer_load_dwordx4 v164, s[24:27], s64 offen lds
    s_mov_b32 s64, 82432
    s_add_u32 m0, s70, 49152
    s_nop 0
    buffer_load_dwordx4 v164, s[24:27], s64 offen lds
    s_mov_b32 s64, 87552
    s_add_u32 m0, s70, 50176
    s_nop 0
    buffer_load_dwordx4 v164, s[24:27], s64 offen lds
    s_mov_b32 s64, 81920
    s_add_u32 m0, s72, 57344
    s_nop 0
    buffer_load_dwordx4 v165, s[24:27], s64 offen lds
    s_cmp_lg_u32 s68, 0
    s_cbranch_scc1 Larr0_56
    s_waitcnt vmcnt(15)
    s_barrier
    s_cmp_lg_u32 s60, 0
    s_cbranch_scc1 Lcnt_57
    s_mov_b64 exec, 1
    v_mov_b32 v2, 1
    buffer_atomic_add v2, off, s[8:11], 0 offset:4 sc0
    s_mov_b64 exec, -1
Lcnt_57:
Larr0_56:
    s_waitcnt vmcnt(10)
    s_waitcnt lgkmcnt(0)
    s_barrier
    s_mov_b32 s64, 122880
    s_add_u32 m0, s70, 61440
    s_nop 0
    buffer_load_dwordx4 v164, s[24:27], s64 offen lds
    s_mov_b32 s64, 128000
    s_add_u32 m0, s70, 62464
    s_nop 0
    buffer_load_dwordx4 v164, s[24:27], s64 offen lds
    s_mov_b32 s64, 123392
    s_add_u32 m0, s70, 69632
    s_nop 0
    buffer_load_dwordx4 v164, s[24:27], s64 offen lds
    s_mov_b32 s64, 128512
    s_add_u32 m0, s70, 70656
    s_nop 0
    buffer_load_dwordx4 v164, s[24:27], s64 offen lds
    s_mov_b32 s64, 122880
    s_add_u32 m0, s72, 77824
    s_nop 0
    buffer_load_dwordx4 v165, s[24:27], s64 offen lds
    ds_read_b64_tr_b16 a[0:1], v166 offset:0
    ds_read_b64_tr_b16 a[2:3], v166 offset:1024
    ds_read_b64_tr_b16 a[4:5], v166 offset:8
    ds_read_b64_tr_b16 a[6:7], v166 offset:1032
    ds_read_b64_tr_b16 a[8:9], v166 offset:8192
    ds_read_b64_tr_b16 a[10:11], v166 offset:9216
    ds_read_b64_tr_b16 a[12:13], v166 offset:8200
    ds_read_b64_tr_b16 a[14:15], v166 offset:9224
    ds_read_b64_tr_b16 v[220:221], v168 offset:16384
    ds_read_b64_tr_b16 v[222:223], v168 offset:16896
    s_waitcnt lgkmcnt(0)
    ds_write_b128 v240, v[220:223] offset:0
    s_waitcnt vmcnt(10)
    s_waitcnt lgkmcnt(0)
    s_barrier
    s_mov_b32 s64, 163840
    s_add_u32 m0, s70, 0
    s_nop 0
    buffer_load_dwordx4 v164, s[24:27], s64 offen lds
    s_mov_b32 s64, 168960
    s_add_u32 m0, s70, 1024
    s_nop 0
    buffer_load_dwordx4 v164, s[24:27], s64 offen lds
    s_mov_b32 s64, 164352
    s_add_u32 m0, s70, 8192
    s_nop 0
    buffer_load_dwordx4 v164, s[24:27], s64 offen lds
    s_mov_b32 s64, 169472
    s_add_u32 m0, s70, 9216
    s_nop 0
    buffer_load_dwordx4 v164, s[24:27], s64 offen lds
    s_mov_b32 s64, 163840
    s_add_u32 m0, s72, 16384
    s_nop 0
    buffer_load_dwordx4 v165, s[24:27], s64 offen lds
    ds_read_b64_tr_b16 a[16:17], v166 offset:20480
    ds_read_b64_tr_b16 a[18:19], v166 offset:21504
    ds_read_b64_tr_b16 a[20:21], v166 offset:20488
    ds_read_b64_tr_b16 a[22:23], v166 offset:21512
    ds_read_b64_tr_b16 a[24:25], v166 offset:28672
    ds_read_b64_tr_b16 a[26:27], v166 offset:29696
    ds_read_b64_tr_b16 a[28:29], v166 offset:28680
    ds_read_b64_tr_b16 a[30:31], v166 offset:29704
    ds_read_b64_tr_b16 v[224:225], v168 offset:36864
    ds_read_b64_tr_b16 v[226:227], v168 offset:37376
    s_waitcnt lgkmcnt(0)
    ds_write_b128 v240, v[224:227] offset:1024
    s_waitcnt vmcnt(10)
    s_waitcnt lgkmcnt(0)
    s_barrier
    s_mov_b32 s64, 204800
    s_add_u32 m0, s70, 20480
    s_nop 0
    buffer_load_dwordx4 v164, s[24:27], s64 offen lds
    s_mov_b32 s64, 209920
    s_add_u32 m0, s70, 21504
    s_nop 0
    buffer_load_dwordx4 v164, s[24:27], s64 offen lds
    s_mov_b32 s64, 205312
    s_add_u32 m0, s70, 28672
    s_nop 0
    buffer_load_dwordx4 v164, s[24:27], s64 offen lds
    s_mov_b32 s64, 210432
    s_add_u32 m0, s70, 29696
    s_nop 0
    buffer_load_dwordx4 v164, s[24:27], s64 offen lds
    s_mov_b32 s64, 204800
    s_add_u32 m0, s72, 36864
    s_nop 0
    buffer_load_dwordx4 v165, s[24:27], s64 offen lds
    s_cmp_lg_u32 s68, 0
    s_cbranch_scc1 Larr0_58
    s_cmp_lg_u32 s60, 0
    s_cbranch_scc1 Lcnt_59
    s_mov_b64 exec, 1
    v_mov_b32 v3, 0x80000000
    v_cmp_ne_u32 vcc, 255, v2
    s_nop 1
    v_cndmask_b32 v3, 4, v3, vcc
    buffer_store_dword v2, v3, s[8:11], 0 offen offset:128 sc1
    s_mov_b64 exec, -1
Lcnt_59:
Larr0_58:
    ds_read_b64_tr_b16 a[32:33], v167 offset:0
    ds_read_b64_tr_b16 a[34:35], v167 offset:1024
    ds_read_b64_tr_b16 a[36:37], v167 offset:8
    ds_read_b64_tr_b16 a[38:39], v167 offset:1032
    ds_read_b64_tr_b16 a[40:41], v167 offset:8192
    ds_read_b64_tr_b16 a[42:43], v167 offset:9216
    ds_read_b64_tr_b16 a[44:45], v167 offset:8200
    ds_read_b64_tr_b16 a[46:47], v167 offset:9224
    ds_read_b64_tr_b16 v[228:229], v169 offset:16384
    ds_read_b64_tr_b16 v[230:231], v169 offset:16896
    s_waitcnt lgkmcnt(0)
    ds_write_b128 v240, v[228:231] offset:2048
    s_waitcnt vmcnt(10)
    s_waitcnt lgkmcnt(0)
    s_barrier
    s_mov_b32 s64, 245760
    s_add_u32 m0, s70, 40960
    s_nop 0
    buffer_load_dwordx4 v164, s[24:27], s64 offen lds
    s_mov_b32 s64, 250880
    s_add_u32 m0, s70, 41984
    s_nop 0
    buffer_load_dwordx4 v164, s[24:27], s64 offen lds
    s_mov_b32 s64, 246272
    s_add_u32 m0, s70, 49152
    s_nop 0
    buffer_load_dwordx4 v164, s[24:27], s64 offen lds
    s_mov_b32 s64, 251392
    s_add_u32 m0, s70, 50176
    s_nop 0
    buffer_load_dwordx4 v164, s[24:27], s64 offen lds
    s_mov_b32 s64, 245760
    s_add_u32 m0, s72, 57344
    s_nop 0
    buffer_load_dwordx4 v165, s[24:27], s64 offen lds
    ds_read_b64_tr_b16 a[48:49], v167 offset:20480
    ds_read_b64_tr_b16 a[50:51], v167 offset:21504
    ds_read_b64_tr_b16 a[52:53], v167 offset:20488
    ds_read_b64_tr_b16 a[54:55], v167 offset:21512
    ds_read_b64_tr_b16 a[56:57], v167 offset:28672
    ds_read_b64_tr_b16 a[58:59], v167 offset:29696
    ds_read_b64_tr_b16 a[60:61], v167 offset:28680
    ds_read_b64_tr_b16 a[62:63], v167 offset:29704
    ds_read_b64_tr_b16 v[232:233], v169 offset:36864
    ds_read_b64_tr_b16 v[234:235], v169 offset:37376
    s_waitcnt lgkmcnt(0)
    ds_write_b128 v240, v[232:235] offset:3072
    s_waitcnt vmcnt(10)
    s_waitcnt lgkmcnt(0)
    s_barrier
    s_mov_b32 s64, 286720
    s_add_u32 m0, s70, 61440
    s_nop 0
    buffer_load_dwordx4 v164, s[24:27], s64 offen lds
    s_mov_b32 s64, 291840
    s_add_u32 m0, s70, 62464
    s_nop 0
    buffer_load_dwordx4 v164, s[24:27], s64 offen lds
    s_mov_b32 s64, 287232
    s_add_u32 m0, s70, 69632
    s_nop 0
    buffer_load_dwordx4 v164, s[24:27], s64 offen lds
    s_mov_b32 s64, 292352
    s_add_u32 m0, s70, 70656
    s_nop 0
    buffer_load_dwordx4 v164, s[24:27], s64 offen lds
    s_mov_b32 s64, 286720
    s_add_u32 m0, s72, 77824
    s_nop 0
    buffer_load_dwordx4 v165, s[24:27], s64 offen lds
    ds_read_b64_tr_b16 a[64:65], v166 offset:0
    ds_read_b64_tr_b16 a[66:67], v166 offset:1024
    ds_read_b64_tr_b16 a[68:69], v166 offset:8
    ds_read_b64_tr_b16 a[70:71], v166 offset:1032
    ds_read_b64_tr_b16 a[72:73], v166 offset:8192
    ds_read_b64_tr_b16 a[74:75], v166 offset:9216
    ds_read_b64_tr_b16 a[76:77], v166 offset:8200
    ds_read_b64_tr_b16 a[78:79], v166 offset:9224
    ds_read_b64_tr_b16 v[220:221], v168 offset:16384
    ds_read_b64_tr_b16 v[222:223], v168 offset:16896
    s_waitcnt lgkmcnt(0)
    ds_write_b128 v240, v[220:223] offset:4096
    s_waitcnt vmcnt(10)
    s_waitcnt lgkmcnt(0)
    s_barrier
    s_mov_b32 s64, 327680
    s_add_u32 m0, s70, 0
    s_nop 0
    buffer_load_dwordx4 v164, s[24:27], s64 offen lds
    s_mov_b32 s64, 332800
    s_add_u32 m0, s70, 1024
    s_nop 0
    buffer_load_dwordx4 v164, s[24:27], s64 offen lds
    s_mov_b32 s64, 328192
    s_add_u32 m0, s70, 8192
    s_nop 0
    buffer_load_dwordx4 v164, s[24:27], s64 offen lds
    s_mov_b32 s64, 333312
    s_add_u32 m0, s70, 9216
    s_nop 0
    buffer_load_dwordx4 v164, s[24:27], s64 offen lds
    s_mov_b32 s64, 327680
    s_add_u32 m0, s72, 16384
    s_nop 0
    buffer_load_dwordx4 v165, s[24:27], s64 offen lds
    ds_read_b64_tr_b16 a[80:81], v166 offset:20480
    ds_read_b64_tr_b16 a[82:83], v166 offset:21504
    ds_read_b64_tr_b16 a[84:85], v166 offset:20488
    ds_read_b64_tr_b16 a[86:87], v166 offset:21512
    ds_read_b64_tr_b16 a[88:89], v166 offset:28672
    ds_read_b64_tr_b16 a[90:91], v166 offset:29696
    ds_read_b64_tr_b16 a[92:93], v166 offset:28680
    ds_read_b64_tr_b16 a[94:95], v166 offset:29704
    ds_read_b64_tr_b16 v[224:225], v168 offset:36864
    ds_read_b64_tr_b16 v[226:227], v168 offset:37376
    s_waitcnt lgkmcnt(0)
    ds_write_b128 v240, v[224:227] offset:5120
    s_waitcnt vmcnt(10)
    s_waitcnt lgkmcnt(0)
    s_barrier
    s_mov_b32 s64, 368640
    s_add_u32 m0, s70, 20480
    s_nop 0
    buffer_load_dwordx4 v164, s[24:27], s64 offen lds
    s_mov_b32 s64, 373760
    s_add_u32 m0, s70, 21504
    s_nop 0
    buffer_load_dwordx4 v164, s[24:27], s64 offen lds
    s_mov_b32 s64, 369152
    s_add_u32 m0, s70, 28672
    s_nop 0
    buffer_load_dwordx4 v164, s[24:27], s64 offen lds
    s_mov_b32 s64, 374272
    s_add_u32 m0, s70, 29696
    s_nop 0
    buffer_load_dwordx4 v164, s[24:27], s64 offen lds
    s_mov_b32 s64, 368640
    s_add_u32 m0, s72, 36864
    s_nop 0
    buffer_load_dwordx4 v165, s[24:27], s64 offen lds
    ds_read_b64_tr_b16 a[96:97], v167 offset:0
    ds_read_b64_tr_b16 a[98:99], v167 offset:1024
    ds_read_b64_tr_b16 a[100:101], v167 offset:8
    ds_read_b64_tr_b16 a[102:103], v167 offset:1032
    ds_read_b64_tr_b16 a[104:105], v167 offset:8192
    ds_read_b64_tr_b16 a[106:107], v167 offset:9216
    ds_read_b64_tr_b16 a[108:109], v167 offset:8200
    ds_read_b64_tr_b16 a[110:111], v167 offset:9224
    ds_read_b64_tr_b16 v[228:229], v169 offset:16384
    ds_read_b64_tr_b16 v[230:231], v169 offset:16896
    s_waitcnt lgkmcnt(0)
    ds_write_b128 v240, v[228:231] offset:6144
    s_waitcnt vmcnt(10)
    s_waitcnt lgkmcnt(0)
    s_barrier
    s_mov_b32 s64, 409600
    s_add_u32 m0, s70, 40960
    s_nop 0
    buffer_load_dwordx4 v164, s[24:27], s64 offen lds
    s_mov_b32 s64, 414720
    s_add_u32 m0, s70, 41984
    s_nop 0
    buffer_load_dwordx4 v164, s[24:27], s64 offen lds
    s_mov_b32 s64, 410112
    s_add_u32 m0, s70, 49152
    s_nop 0
    buffer_load_dwordx4 v164, s[24:27], s64 offen lds
    s_mov_b32 s64, 415232
    s_add_u32 m0, s70, 50176
    s_nop 0
    buffer_load_dwordx4 v164, s[24:27], s64 offen lds
    s_mov_b32 s64, 409600
    s_add_u32 m0, s72, 57344
    s_nop 0
    buffer_load_dwordx4 v165, s[24:27], s64 offen lds
    ds_read_b64_tr_b16 a[112:113], v167 offset:20480
    ds_read_b64_tr_b16 a[114:115], v167 offset:21504
    ds_read_b64_tr_b16 a[116:117], v167 offset:20488
    ds_read_b64_tr_b16 a[118:119], v167 offset:21512
    ds_read_b64_tr_b16 a[120:121], v167 offset:28672
    ds_read_b64_tr_b16 a[122:123], v167 offset:29696
    ds_read_b64_tr_b16 a[124:125], v167 offset:28680
    ds_read_b64_tr_b16 a[126:127], v167 offset:29704
    ds_read_b64_tr_b16 v[232:233], v169 offset:36864
    ds_read_b64_tr_b16 v[234:235], v169 offset:37376
    s_waitcnt lgkmcnt(0)
    ds_write_b128 v240, v[232:235] offset:7168
    s_waitcnt vmcnt(10)
    s_waitcnt lgkmcnt(0)
    s_barrier
    s_mov_b32 s64, 450560
    s_add_u32 m0, s70, 61440
    s_nop 0
    buffer_load_dwordx4 v164, s[24:27], s64 offen lds
    s_mov_b32 s64, 455680
    s_add_u32 m0, s70, 62464
    s_nop 0
    buffer_load_dwordx4 v164, s[24:27], s64 offen lds
    s_mov_b32 s64, 451072
    s_add_u32 m0, s70, 69632
    s_nop 0
    buffer_load_dwordx4 v164, s[24:27], s64 offen lds
    s_mov_b32 s64, 456192
    s_add_u32 m0, s70, 70656
    s_nop 0
    buffer_load_dwordx4 v164, s[24:27], s64 offen lds
    s_mov_b32 s64, 450560
    s_add_u32 m0, s72, 77824
    s_nop 0
    buffer_load_dwordx4 v165, s[24:27], s64 offen lds
    ds_read_b64_tr_b16 a[128:129], v166 offset:0
    ds_read_b64_tr_b16 a[130:131], v166 offset:1024
    ds_read_b64_tr_b16 a[132:133], v166 offset:8
    ds_read_b64_tr_b16 a[134:135], v166 offset:1032
    ds_read_b64_tr_b16 a[136:137], v166 offset:8192
    ds_read_b64_tr_b16 a[138:139], v166 offset:9216
    ds_read_b64_tr_b16 a[140:141], v166 offset:8200
    ds_read_b64_tr_b16 a[142:143], v166 offset:9224
    ds_read_b64_tr_b16 v[220:221], v168 offset:16384
    ds_read_b64_tr_b16 v[222:223], v168 offset:16896
    s_waitcnt lgkmcnt(0)
    ds_write_b128 v240, v[220:223] offset:8192
    s_waitcnt vmcnt(10)
    s_waitcnt lgkmcnt(0)
    s_barrier
    s_mov_b32 s64, 491520
    s_add_u32 m0, s70, 0
    s_nop 0
    buffer_load_dwordx4 v164, s[24:27], s64 offen lds
    s_mov_b32 s64, 496640
    s_add_u32 m0, s70, 1024
    s_nop 0
    buffer_load_dwordx4 v164, s[24:27], s64 offen lds
    s_mov_b32 s64, 492032
    s_add_u32 m0, s70, 8192
    s_nop 0
    buffer_load_dwordx4 v164, s[24:27], s64 offen lds
    s_mov_b32 s64, 497152
    s_add_u32 m0, s70, 9216
    s_nop 0
    buffer_load_dwordx4 v164, s[24:27], s64 offen lds
    s_mov_b32 s64, 491520
    s_add_u32 m0, s72, 16384
    s_nop 0
    buffer_load_dwordx4 v165, s[24:27], s64 offen lds
    ds_read_b64_tr_b16 a[144:145], v166 offset:20480
    ds_read_b64_tr_b16 a[146:147], v166 offset:21504
    ds_read_b64_tr_b16 a[148:149], v166 offset:20488
    ds_read_b64_tr_b16 a[150:151], v166 offset:21512
    ds_read_b64_tr_b16 a[152:153], v166 offset:28672
    ds_read_b64_tr_b16 a[154:155], v166 offset:29696
    ds_read_b64_tr_b16 a[156:157], v166 offset:28680
    ds_read_b64_tr_b16 a[158:159], v166 offset:29704
    ds_read_b64_tr_b16 v[224:225], v168 offset:36864
    ds_read_b64_tr_b16 v[226:227], v168 offset:37376
    s_waitcnt lgkmcnt(0)
    ds_write_b128 v240, v[224:227] offset:9216
    s_waitcnt vmcnt(10)
    s_waitcnt lgkmcnt(0)
    s_barrier
    s_mov_b32 s64, 532480
    s_add_u32 m0, s70, 20480
    s_nop 0
    buffer_load_dwordx4 v164, s[24:27], s64 offen lds
    s_mov_b32 s64, 537600
    s_add_u32 m0, s70, 21504
    s_nop 0
    buffer_load_dwordx4 v164, s[24:27], s64 offen lds
    s_mov_b32 s64, 532992
    s_add_u32 m0, s70, 28672
    s_nop 0
    buffer_load_dwordx4 v164, s[24:27], s64 offen lds
    s_mov_b32 s64, 538112
    s_add_u32 m0, s70, 29696
    s_nop 0
    buffer_load_dwordx4 v164, s[24:27], s64 offen lds
    s_mov_b32 s64, 532480
    s_add_u32 m0, s72, 36864
    s_nop 0
    buffer_load_dwordx4 v165, s[24:27], s64 offen lds
    ds_read_b64_tr_b16 a[160:161], v167 offset:0
    ds_read_b64_tr_b16 a[162:163], v167 offset:1024
    ds_read_b64_tr_b16 a[164:165], v167 offset:8
    ds_read_b64_tr_b16 a[166:167], v167 offset:1032
    ds_read_b64_tr_b16 a[168:169], v167 offset:8192
    ds_read_b64_tr_b16 a[170:171], v167 offset:9216
    ds_read_b64_tr_b16 a[172:173], v167 offset:8200
    ds_read_b64_tr_b16 a[174:175], v167 offset:9224
    ds_read_b64_tr_b16 v[228:229], v169 offset:16384
    ds_read_b64_tr_b16 v[230:231], v169 offset:16896
    s_waitcnt lgkmcnt(0)
    ds_write_b128 v240, v[228:231] offset:10240
    s_waitcnt vmcnt(10)
    s_waitcnt lgkmcnt(0)
    s_barrier
    s_mov_b32 s64, 573440
    s_add_u32 m0, s70, 40960
    s_nop 0
    buffer_load_dwordx4 v164, s[24:27], s64 offen lds
    s_mov_b32 s64, 578560
    s_add_u32 m0, s70, 41984
    s_nop 0
    buffer_load_dwordx4 v164, s[24:27], s64 offen lds
    s_mov_b32 s64, 573952
    s_add_u32 m0, s70, 49152
    s_nop 0
    buffer_load_dwordx4 v164, s[24:27], s64 offen lds
    s_mov_b32 s64, 579072
    s_add_u32 m0, s70, 50176
    s_nop 0
    buffer_load_dwordx4 v164, s[24:27], s64 offen lds
    s_mov_b32 s64, 573440
    s_add_u32 m0, s72, 57344
    s_nop 0
    buffer_load_dwordx4 v165, s[24:27], s64 offen lds
    ds_read_b64_tr_b16 a[176:177], v167 offset:20480
    ds_read_b64_tr_b16 a[178:179], v167 offset:21504
    ds_read_b64_tr_b16 a[180:181], v167 offset:20488
    ds_read_b64_tr_b16 a[182:183], v167 offset:21512
    ds_read_b64_tr_b16 a[184:185], v167 offset:28672
    ds_read_b64_tr_b16 a[186:187], v167 offset:29696
    ds_read_b64_tr_b16 a[188:189], v167 offset:28680
    ds_read_b64_tr_b16 a[190:191], v167 offset:29704
    ds_read_b64_tr_b16 v[232:233], v169 offset:36864
    ds_read_b64_tr_b16 v[234:235], v169 offset:37376
    s_waitcnt lgkmcnt(0)
    ds_write_b128 v240, v[232:235] offset:11264
    s_waitcnt vmcnt(10)
    s_waitcnt lgkmcnt(0)
    s_barrier
    s_mov_b32 s64, 614400
    s_add_u32 m0, s70, 61440
    s_nop 0
    buffer_load_dwordx4 v164, s[24:27], s64 offen lds
    s_mov_b32 s64, 619520
    s_add_u32 m0, s70, 62464
    s_nop 0
    buffer_load_dwordx4 v164, s[24:27], s64 offen lds
    s_mov_b32 s64, 614912
    s_add_u32 m0, s70, 69632
    s_nop 0
    buffer_load_dwordx4 v164, s[24:27], s64 offen lds
    s_mov_b32 s64, 620032
    s_add_u32 m0, s70, 70656
    s_nop 0
    buffer_load_dwordx4 v164, s[24:27], s64 offen lds
    s_mov_b32 s64, 614400
    s_add_u32 m0, s72, 77824
    s_nop 0
    buffer_load_dwordx4 v165, s[24:27], s64 offen lds
    ds_read_b64_tr_b16 a[192:193], v166 offset:0
    ds_read_b64_tr_b16 a[194:195], v166 offset:1024
    ds_read_b64_tr_b16 a[196:197], v166 offset:8
    ds_read_b64_tr_b16 a[198:199], v166 offset:1032
    ds_read_b64_tr_b16 a[200:201], v166 offset:8192
    ds_read_b64_tr_b16 a[202:203], v166 offset:9216
    ds_read_b64_tr_b16 a[204:205], v166 offset:8200
    ds_read_b64_tr_b16 a[206:207], v166 offset:9224
    ds_read_b64_tr_b16 v[220:221], v168 offset:16384
    ds_read_b64_tr_b16 v[222:223], v168 offset:16896
    s_waitcnt lgkmcnt(0)
    ds_write_b128 v240, v[220:223] offset:12288
    s_waitcnt vmcnt(10)
    s_waitcnt lgkmcnt(0)
    s_barrier
    s_mov_b32 s64, 655360
    s_add_u32 m0, s70, 0
    s_nop 0
    buffer_load_dwordx4 v164, s[24:27], s64 offen lds
    s_mov_b32 s64, 660480
    s_add_u32 m0, s70, 1024
    s_nop 0
    buffer_load_dwordx4 v164, s[24:27], s64 offen lds
    s_mov_b32 s64, 655872
    s_add_u32 m0, s70, 8192
    s_nop 0
    buffer_load_dwordx4 v164, s[24:27], s64 offen lds
    s_mov_b32 s64, 660992
    s_add_u32 m0, s70, 9216
    s_nop 0
    buffer_load_dwordx4 v164, s[24:27], s64 offen lds
    s_mov_b32 s64, 655360
    s_add_u32 m0, s72, 16384
    s_nop 0
    buffer_load_dwordx4 v165, s[24:27], s64 offen lds
    ds_read_b64_tr_b16 a[208:209], v166 offset:20480
    ds_read_b64_tr_b16 a[210:211], v166 offset:21504
    ds_read_b64_tr_b16 a[212:213], v166 offset:20488
    ds_read_b64_tr_b16 a[214:215], v166 offset:21512
    ds_read_b64_tr_b16 a[216:217], v166 offset:28672
    ds_read_b64_tr_b16 a[218:219], v166 offset:29696
    ds_read_b64_tr_b16 a[220:221], v166 offset:28680
    ds_read_b64_tr_b16 a[222:223], v166 offset:29704
    ds_read_b64_tr_b16 v[224:225], v168 offset:36864
    ds_read_b64_tr_b16 v[226:227], v168 offset:37376
    s_waitcnt lgkmcnt(0)
    ds_write_b128 v240, v[224:227] offset:13312
    s_waitcnt vmcnt(10)
    s_waitcnt lgkmcnt(0)
    s_barrier
    s_mov_b32 s64, 696320
    s_add_u32 m0, s70, 20480
    s_nop 0
    buffer_load_dwordx4 v164, s[24:27], s64 offen lds
    s_mov_b32 s64, 701440
    s_add_u32 m0, s70, 21504
    s_nop 0
    buffer_load_dwordx4 v164, s[24:27], s64 offen lds
    s_mov_b32 s64, 696832
    s_add_u32 m0, s70, 28672
    s_nop 0
    buffer_load_dwordx4 v164, s[24:27], s64 offen lds
    s_mov_b32 s64, 701952
    s_add_u32 m0, s70, 29696
    s_nop 0
    buffer_load_dwordx4 v164, s[24:27], s64 offen lds
    s_mov_b32 s64, 696320
    s_add_u32 m0, s72, 36864
    s_nop 0
    buffer_load_dwordx4 v165, s[24:27], s64 offen lds
    ds_read_b64_tr_b16 a[224:225], v167 offset:0
    ds_read_b64_tr_b16 a[226:227], v167 offset:1024
    ds_read_b64_tr_b16 a[228:229], v167 offset:8
    ds_read_b64_tr_b16 a[230:231], v167 offset:1032
    ds_read_b64_tr_b16 a[232:233], v167 offset:8192
    ds_read_b64_tr_b16 a[234:235], v167 offset:9216
    ds_read_b64_tr_b16 a[236:237], v167 offset:8200
    ds_read_b64_tr_b16 a[238:239], v167 offset:9224
    ds_read_b64_tr_b16 v[228:229], v169 offset:16384
    ds_read_b64_tr_b16 v[230:231], v169 offset:16896
    s_waitcnt lgkmcnt(0)
    ds_write_b128 v240, v[228:231] offset:14336
    s_waitcnt vmcnt(10)
    s_waitcnt lgkmcnt(0)
    s_barrier
    s_mov_b32 s64, 737280
    s_add_u32 m0, s70, 40960
    s_nop 0
    buffer_load_dwordx4 v164, s[24:27], s64 offen lds
    s_mov_b32 s64, 742400
    s_add_u32 m0, s70, 41984
    s_nop 0
    buffer_load_dwordx4 v164, s[24:27], s64 offen lds
    s_mov_b32 s64, 737792
    s_add_u32 m0, s70, 49152
    s_nop 0
    buffer_load_dwordx4 v164, s[24:27], s64 offen lds
    s_mov_b32 s64, 742912
    s_add_u32 m0, s70, 50176
    s_nop 0
    buffer_load_dwordx4 v164, s[24:27], s64 offen lds
    s_mov_b32 s64, 737280
    s_add_u32 m0, s72, 57344
    s_nop 0
    buffer_load_dwordx4 v165, s[24:27], s64 offen lds
    ds_read_b64_tr_b16 a[240:241], v167 offset:20480
    ds_read_b64_tr_b16 a[242:243], v167 offset:21504
    ds_read_b64_tr_b16 a[244:245], v167 offset:20488
    ds_read_b64_tr_b16 a[246:247], v167 offset:21512
    ds_read_b64_tr_b16 a[248:249], v167 offset:28672
    ds_read_b64_tr_b16 a[250:251], v167 offset:29696
    ds_read_b64_tr_b16 a[252:253], v167 offset:28680
    ds_read_b64_tr_b16 a[254:255], v167 offset:29704
    ds_read_b64_tr_b16 v[232:233], v169 offset:36864
    ds_read_b64_tr_b16 v[234:235], v169 offset:37376
    s_waitcnt lgkmcnt(0)
    ds_write_b128 v240, v[232:235] offset:15360
    s_waitcnt vmcnt(10)
    s_waitcnt lgkmcnt(0)
    s_barrier
    s_mov_b32 s64, 778240
    s_add_u32 m0, s70, 61440
    s_nop 0
    buffer_load_dwordx4 v164, s[24:27], s64 offen lds
    s_mov_b32 s64, 783360
    s_add_u32 m0, s70, 62464
    s_nop 0
    buffer_load_dwordx4 v164, s[24:27], s64 offen lds
    s_mov_b32 s64, 778752
    s_add_u32 m0, s70, 69632
    s_nop 0
    buffer_load_dwordx4 v164, s[24:27], s64 offen lds
    s_mov_b32 s64, 783872
    s_add_u32 m0, s70, 70656
    s_nop 0
    buffer_load_dwordx4 v164, s[24:27], s64 offen lds
    s_mov_b32 s64, 778240
    s_add_u32 m0, s72, 77824
    s_nop 0
    buffer_load_dwordx4 v165, s[24:27], s64 offen lds
    ds_read_b64_tr_b16 v[4:5], v166 offset:0
    ds_read_b64_tr_b16 v[6:7], v166 offset:1024
    ds_read_b64_tr_b16 v[8:9], v166 offset:8
    ds_read_b64_tr_b16 v[10:11], v166 offset:1032
    ds_read_b64_tr_b16 v[12:13], v166 offset:8192
    ds_read_b64_tr_b16 v[14:15], v166 offset:9216
    ds_read_b64_tr_b16 v[16:17], v166 offset:8200
    ds_read_b64_tr_b16 v[18:19], v166 offset:9224
    ds_read_b64_tr_b16 v[132:133], v168 offset:16384
    ds_read_b64_tr_b16 v[134:135], v168 offset:16896
    s_waitcnt vmcnt(10)
    s_waitcnt lgkmcnt(0)
    s_barrier
    s_mov_b32 s64, 819200
    s_add_u32 m0, s70, 0
    s_nop 0
    buffer_load_dwordx4 v164, s[24:27], s64 offen lds
    s_mov_b32 s64, 824320
    s_add_u32 m0, s70, 1024
    s_nop 0
    buffer_load_dwordx4 v164, s[24:27], s64 offen lds
    s_mov_b32 s64, 819712
    s_add_u32 m0, s70, 8192
    s_nop 0
    buffer_load_dwordx4 v164, s[24:27], s64 offen lds
    s_mov_b32 s64, 824832
    s_add_u32 m0, s70, 9216
    s_nop 0
    buffer_load_dwordx4 v164, s[24:27], s64 offen lds
    s_mov_b32 s64, 819200
    s_add_u32 m0, s72, 16384
    s_nop 0
    buffer_load_dwordx4 v165, s[24:27], s64 offen lds
    ds_read_b64_tr_b16 v[20:21], v166 offset:20480
    ds_read_b64_tr_b16 v[22:23], v166 offset:21504
    ds_read_b64_tr_b16 v[24:25], v166 offset:20488
    ds_read_b64_tr_b16 v[26:27], v166 offset:21512
    ds_read_b64_tr_b16 v[28:29], v166 offset:28672
    ds_read_b64_tr_b16 v[30:31], v166 offset:29696
    ds_read_b64_tr_b16 v[32:33], v166 offset:28680
    ds_read_b64_tr_b16 v[34:35], v166 offset:29704
    ds_read_b64_tr_b16 v[136:137], v168 offset:36864
    ds_read_b64_tr_b16 v[138:139], v168 offset:37376
    s_waitcnt vmcnt(10)
    s_waitcnt lgkmcnt(0)
    s_barrier
    s_mov_b32 s64, 860160
    s_add_u32 m0, s70, 20480
    s_nop 0
    buffer_load_dwordx4 v164, s[24:27], s64 offen lds
    s_mov_b32 s64, 865280
    s_add_u32 m0, s70, 21504
    s_nop 0
    buffer_load_dwordx4 v164, s[24:27], s64 offen lds
    s_mov_b32 s64, 860672
    s_add_u32 m0, s70, 28672
    s_nop 0
    buffer_load_dwordx4 v164, s[24:27], s64 offen lds
    s_mov_b32 s64, 865792
    s_add_u32 m0, s70, 29696
    s_nop 0
    buffer_load_dwordx4 v164, s[24:27], s64 offen lds
    s_mov_b32 s64, 860160
    s_add_u32 m0, s72, 36864
    s_nop 0
    buffer_load_dwordx4 v165, s[24:27], s64 offen lds
    ds_read_b64_tr_b16 v[36:37], v167 offset:0
    ds_read_b64_tr_b16 v[38:39], v167 offset:1024
    ds_read_b64_tr_b16 v[40:41], v167 offset:8
    ds_read_b64_tr_b16 v[42:43], v167 offset:1032
    ds_read_b64_tr_b16 v[44:45], v167 offset:8192
    ds_read_b64_tr_b16 v[46:47], v167 offset:9216
    ds_read_b64_tr_b16 v[48:49], v167 offset:8200
    ds_read_b64_tr_b16 v[50:51], v167 offset:9224
    ds_read_b64_tr_b16 v[140:141], v169 offset:16384
    ds_read_b64_tr_b16 v[142:143], v169 offset:16896
    s_waitcnt vmcnt(10)
    s_waitcnt lgkmcnt(0)
    s_barrier
    s_mov_b32 s64, 901120
    s_add_u32 m0, s70, 40960
    s_nop 0
    buffer_load_dwordx4 v164, s[24:27], s64 offen lds
    s_mov_b32 s64, 906240
    s_add_u32 m0, s70, 41984
    s_nop 0
    buffer_load_dwordx4 v164, s[24:27], s64 offen lds
    s_mov_b32 s64, 901632
    s_add_u32 m0, s70, 49152
    s_nop 0
    buffer_load_dwordx4 v164, s[24:27], s64 offen lds
    s_mov_b32 s64, 906752
    s_add_u32 m0, s70, 50176
    s_nop 0
    buffer_load_dwordx4 v164, s[24:27], s64 offen lds
    s_mov_b32 s64, 901120
    s_add_u32 m0, s72, 57344
    s_nop 0
    buffer_load_dwordx4 v165, s[24:27], s64 offen lds
    ds_read_b64_tr_b16 v[52:53], v167 offset:20480
    ds_read_b64_tr_b16 v[54:55], v167 offset:21504
    ds_read_b64_tr_b16 v[56:57], v167 offset:20488
    ds_read_b64_tr_b16 v[58:59], v167 offset:21512
    ds_read_b64_tr_b16 v[60:61], v167 offset:28672
    ds_read_b64_tr_b16 v[62:63], v167 offset:29696
    ds_read_b64_tr_b16 v[64:65], v167 offset:28680
    ds_read_b64_tr_b16 v[66:67], v167 offset:29704
    ds_read_b64_tr_b16 v[144:145], v169 offset:36864
    ds_read_b64_tr_b16 v[146:147], v169 offset:37376
    s_waitcnt vmcnt(10)
    s_waitcnt lgkmcnt(0)
    s_barrier
    s_mov_b32 s64, 942080
    s_add_u32 m0, s70, 61440
    s_nop 0
    buffer_load_dwordx4 v164, s[24:27], s64 offen lds
    s_mov_b32 s64, 947200
    s_add_u32 m0, s70, 62464
    s_nop 0
    buffer_load_dwordx4 v164, s[24:27], s64 offen lds
    s_mov_b32 s64, 942592
    s_add_u32 m0, s70, 69632
    s_nop 0
    buffer_load_dwordx4 v164, s[24:27], s64 offen lds
    s_mov_b32 s64, 947712
    s_add_u32 m0, s70, 70656
    s_nop 0
    buffer_load_dwordx4 v164, s[24:27], s64 offen lds
    s_mov_b32 s64, 942080
    s_add_u32 m0, s72, 77824
    s_nop 0
    buffer_load_dwordx4 v165, s[24:27], s64 offen lds
    ds_read_b64_tr_b16 v[68:69], v166 offset:0
    ds_read_b64_tr_b16 v[70:71], v166 offset:1024
    ds_read_b64_tr_b16 v[72:73], v166 offset:8
    ds_read_b64_tr_b16 v[74:75], v166 offset:1032
    ds_read_b64_tr_b16 v[76:77], v166 offset:8192
    ds_read_b64_tr_b16 v[78:79], v166 offset:9216
    ds_read_b64_tr_b16 v[80:81], v166 offset:8200
    ds_read_b64_tr_b16 v[82:83], v166 offset:9224
    ds_read_b64_tr_b16 v[148:149], v168 offset:16384
    ds_read_b64_tr_b16 v[150:151], v168 offset:16896
    s_waitcnt vmcnt(10)
    s_waitcnt lgkmcnt(0)
    s_barrier
    ds_read_b64_tr_b16 v[84:85], v166 offset:20480
    ds_read_b64_tr_b16 v[86:87], v166 offset:21504
    ds_read_b64_tr_b16 v[88:89], v166 offset:20488
    ds_read_b64_tr_b16 v[90:91], v166 offset:21512
    ds_read_b64_tr_b16 v[92:93], v166 offset:28672
    ds_read_b64_tr_b16 v[94:95], v166 offset:29696
    ds_read_b64_tr_b16 v[96:97], v166 offset:28680
    ds_read_b64_tr_b16 v[98:99], v166 offset:29704
    ds_read_b64_tr_b16 v[152:153], v168 offset:36864
    ds_read_b64_tr_b16 v[154:155], v168 offset:37376
    s_waitcnt vmcnt(5)
    s_waitcnt lgkmcnt(0)
    s_barrier
    ds_read_b64_tr_b16 v[100:101], v167 offset:0
    ds_read_b64_tr_b16 v[102:103], v167 offset:1024
    ds_read_b64_tr_b16 v[104:105], v167 offset:8
    ds_read_b64_tr_b16 v[106:107], v167 offset:1032
    ds_read_b64_tr_b16 v[108:109], v167 offset:8192
    ds_read_b64_tr_b16 v[110:111], v167 offset:9216
    ds_read_b64_tr_b16 v[112:113], v167 offset:8200
    ds_read_b64_tr_b16 v[114:115], v167 offset:9224
    ds_read_b64_tr_b16 v[156:157], v169 offset:16384
    ds_read_b64_tr_b16 v[158:159], v169 offset:16896
    s_waitcnt vmcnt(0)
    s_waitcnt lgkmcnt(0)
    s_barrier
    ds_read_b64_tr_b16 v[116:117], v167 offset:20480
    ds_read_b64_tr_b16 v[118:119], v167 offset:21504
    ds_read_b64_tr_b16 v[120:121], v167 offset:20488
    ds_read_b64_tr_b16 v[122:123], v167 offset:21512
    ds_read_b64_tr_b16 v[124:125], v167 offset:28672
    ds_read_b64_tr_b16 v[126:127], v167 offset:29696
    ds_read_b64_tr_b16 v[128:129], v167 offset:28680
    ds_read_b64_tr_b16 v[130:131], v167 offset:29704
    ds_read_b64_tr_b16 v[160:161], v169 offset:36864
    ds_read_b64_tr_b16 v[162:163], v169 offset:37376
    v_and_b32 v164, 15, v1
    v_lshrrev_b32 v165, 4, v1
    v_lshlrev_b32 v242, 5, v164
    v_lshl_add_u32 v242, v165, 3, v242
    v_lshlrev_b32 v241, 1, v242
    s_lshl_b32 s64, s75, 2
    s_add_u32 s64, s64, s60
    s_lshl_b32 s64, s64, 10
    v_add_u32 v241, s64, v241
    s_add_u32 s64, s64, 65536
    v_add_u32 v242, s64, v242
    v_min_u32 v243, 47, v1
    s_and_b32 s64, s76, 1
    s_mul_i32 s64, s64, 48
    s_lshl_b32 s65, s58, 7
    s_add_u32 s64, s64, s65
    v_add_u32 v243, s64, v243
    v_lshlrev_b32 v243, 7, v243
    v_add_u32 v243, 8388608, v243
    s_mul_i32 s70, s76, 49152
    s_mul_i32 s64, s68, 6291456
    s_add_u32 s70, s70, s64
    s_add_u32 s70, s70, 60817408
    s_mul_i32 s71, s76, 81920
    s_add_u32 s71, s71, 75497472
    s_lshr_b32 s73, s60, 1
    s_lshl_b32 s73, s73, 12
    s_and_b32 s64, s60, 1
    s_lshl_b32 s64, s64, 10
    s_add_u32 s73, s73, s64
    v_add_u32 v238, s73, v239
    s_mov_b32 s74, 0
    s_cmp_lg_u32 s60, 0
    s_cbranch_scc1 Lgskip_62
    buffer_load_dword v2, off, s[8:11], 0 offset:132 sc1
Lgchk_60:
    s_waitcnt vmcnt(0)
    v_cmp_eq_u32 vcc, 0, v2
    s_cbranch_vccnz Lgrty_61
Lgskip_62:
    s_waitcnt lgkmcnt(0)
    s_barrier
    buffer_load_dword v2, off, s[8:11], 0 offset:140 sc1
Lpchk_63:
    s_waitcnt vmcnt(0)
    v_cmp_eq_u32 vcc, 0, v2
    s_cbranch_vccnz Lprty_64
    v_readfirstlane_b32 s1, v2
    s_cmp_gt_u32 s1, 17
    s_cselect_b32 s1, 1, 0
    s_xor_b32 s1, s1, s68
    s_lshl_b32 s1, s1, 13
    s_lshl_b32 s63, s58, 18
    s_and_b32 s64, s3, 0xfff
    s_add_u32 s63, s63, s64
    s_add_u32 s63, s63, 14819328
    s_xor_b32 s63, s63, s1
L_Tseg:
    s_cmp_lg_u32 s74, 0
    s_cbranch_scc1 L_Thave
    buffer_load_dword v244, v243, s[4:7], 0 offen sc1
    s_lshl_b32 s65, s62, 1
    s_add_u32 s65, s65, 0
    s_waitcnt vmcnt(0)
    v_mov_b32 v236, s65
    s_mov_b64 exec, 1
    buffer_store_dword v236, off, s[4:7], s63 sc1
    buffer_store_dword v236, off, s[4:7], s3
    s_mov_b64 exec, -1
    s_add_u32 s65, s62, 1
Lfchk_65:
    v_cmp_gt_u32 vcc, s65, v244
    s_cbranch_vccnz Lfrty_66
    s_add_u32 m0, s73, 0
    s_add_u32 s64, s70, 0
    buffer_load_dwordx4 v238, s[4:7], s64 offen sc1 lds
    s_add_u32 m0, s73, 8192
    s_add_u32 s64, s70, 8192
    buffer_load_dwordx4 v238, s[4:7], s64 offen sc1 lds
    s_add_u32 m0, s73, 16384
    s_add_u32 s64, s70, 16384
    buffer_load_dwordx4 v238, s[4:7], s64 offen sc1 lds
    s_add_u32 m0, s73, 24576
    s_add_u32 s64, s70, 24576
    buffer_load_dwordx4 v238, s[4:7], s64 offen sc1 lds
    s_add_u32 m0, s73, 32768
    s_add_u32 s64, s70, 32768
    buffer_load_dwordx4 v238, s[4:7], s64 offen sc1 lds
    s_add_u32 m0, s73, 40960
    s_add_u32 s64, s70, 40960
    buffer_load_dwordx4 v238, s[4:7], s64 offen sc1 lds
    s_add_u32 m0, s73, 2048
    s_add_u32 s64, s70, 2048
    buffer_load_dwordx4 v238, s[4:7], s64 offen sc1 lds
    s_add_u32 m0, s73, 10240
    s_add_u32 s64, s70, 10240
    buffer_load_dwordx4 v238, s[4:7], s64 offen sc1 lds
    s_add_u32 m0, s73, 18432
    s_add_u32 s64, s70, 18432
    buffer_load_dwordx4 v238, s[4:7], s64 offen sc1 lds
    s_add_u32 m0, s73, 26624
    s_add_u32 s64, s70, 26624
    buffer_load_dwordx4 v238, s[4:7], s64 offen sc1 lds
    s_add_u32 m0, s73, 34816
    s_add_u32 s64, s70, 34816
    buffer_load_dwordx4 v238, s[4:7], s64 offen sc1 lds
    s_add_u32 m0, s73, 43008
    s_add_u32 s64, s70, 43008
    buffer_load_dwordx4 v238, s[4:7], s64 offen sc1 lds
    s_add_u32 s70, s70, 393216
    s_add_u32 s66, s62, 1
    s_and_b32 s66, s66, 7
    s_cselect_b32 s66, 0, 3145728
    s_sub_u32 s70, s70, s66
    s_xor_b32 s73, s73, 49152
    s_waitcnt vmcnt(10)
L_Thave:
    s_waitcnt vmcnt(13)
    s_barrier
    ds_read_b128 v[204:207], v239 offset:0
    ds_read_b128 v[220:223], v240 offset:0
    ds_read_b128 v[208:211], v239 offset:1024
    ds_read_b128 v[224:227], v240 offset:1024
    ds_read_b128 v[212:215], v239 offset:4096
    ds_read_b128 v[228:231], v240 offset:2048
    s_waitcnt lgkmcnt(5)
    v_mfma_f32_16x16x32_bf16 v[164:167], a[0:3], v[204:207], 0
    s_lshr_b32 s72, s71, 8
    ds_read_b128 v[216:219], v239 offset:5120
    s_xor_b32 s72, s72, s1
    v_mfma_f32_16x16x32_bf16 v[168:171], a[4:7], v[204:207], 0
    s_and_b32 s72, s72, 0x2000
    ds_read_b128 v[232:235], v240 offset:3072
    s_or_b32 s72, s72, s71
    v_mfma_f32_16x16x32_bf16 v[172:175], a[8:11], v[204:207], 0
    s_add_u32 s71, s71, 1048576
    v_mfma_f32_16x16x32_bf16 v[176:179], a[12:15], v[204:207], 0
    s_waitcnt lgkmcnt(6)
    v_mfma_f32_16x16x32_bf16 v[180:183], v[220:223], v[204:207], 0
    s_waitcnt lgkmcnt(4)
    v_mfma_f32_16x16x32_bf16 v[164:167], a[16:19], v[208:211], v[164:167]
    ds_read_b128 v[204:207], v239 offset:8192
    v_mfma_f32_16x16x32_bf16 v[168:171], a[20:23], v[208:211], v[168:171]
    ds_read_b128 v[220:223], v240 offset:4096
    v_mfma_f32_16x16x32_bf16 v[172:175], a[24:27], v[208:211], v[172:175]
    v_mfma_f32_16x16x32_bf16 v[176:179], a[28:31], v[208:211], v[176:179]
    v_mfma_f32_16x16x32_bf16 v[180:183], v[224:227], v[208:211], v[180:183]
    s_waitcnt lgkmcnt(4)
    v_mfma_f32_16x16x32_bf16 v[164:167], a[32:35], v[212:215], v[164:167]
    ds_read_b128 v[208:211], v239 offset:9216
    v_mfma_f32_16x16x32_bf16 v[168:171], a[36:39], v[212:215], v[168:171]
    ds_read_b128 v[224:227], v240 offset:5120
    v_mfma_f32_16x16x32_bf16 v[172:175], a[40:43], v[212:215], v[172:175]
    v_mfma_f32_16x16x32_bf16 v[176:179], a[44:47], v[212:215], v[176:179]
    v_mfma_f32_16x16x32_bf16 v[180:183], v[228:231], v[212:215], v[180:183]
    s_waitcnt lgkmcnt(4)
    v_mfma_f32_16x16x32_bf16 v[164:167], a[48:51], v[216:219], v[164:167]
    ds_read_b128 v[212:215], v239 offset:12288
    v_mfma_f32_16x16x32_bf16 v[168:171], a[52:55], v[216:219], v[168:171]
    ds_read_b128 v[228:231], v240 offset:6144
    v_mfma_f32_16x16x32_bf16 v[172:175], a[56:59], v[216:219], v[172:175]
    v_mfma_f32_16x16x32_bf16 v[176:179], a[60:63], v[216:219], v[176:179]
    v_mfma_f32_16x16x32_bf16 v[180:183], v[232:235], v[216:219], v[180:183]
    s_waitcnt lgkmcnt(4)
    v_mfma_f32_16x16x32_bf16 v[164:167], a[64:67], v[204:207], v[164:167]
    ds_read_b128 v[216:219], v239 offset:13312
    v_mfma_f32_16x16x32_bf16 v[168:171], a[68:71], v[204:207], v[168:171]
    ds_read_b128 v[232:235], v240 offset:7168
    v_mfma_f32_16x16x32_bf16 v[172:175], a[72:75], v[204:207], v[172:175]
    v_mfma_f32_16x16x32_bf16 v[176:179], a[76:79], v[204:207], v[176:179]
    v_mfma_f32_16x16x32_bf16 v[180:183], v[220:223], v[204:207], v[180:183]
    s_waitcnt vmcnt(6)
    s_barrier
    s_waitcnt lgkmcnt(5)
    v_mfma_f32_16x16x32_bf16 v[164:167], a[80:83], v[208:211], v[164:167]
    ds_read_b128 v[204:207], v239 offset:16384
    v_mfma_f32_16x16x32_bf16 v[168:171], a[84:87], v[208:211], v[168:171]
    ds_read_b128 v[220:223], v240 offset:8192
    v_mfma_f32_16x16x32_bf16 v[172:175], a[88:91], v[208:211], v[172:175]
    v_mfma_f32_16x16x32_bf16 v[176:179], a[92:95], v[208:211], v[176:179]
    s_waitcnt lgkmcnt(6)
    v_mfma_f32_16x16x32_bf16 v[180:183], v[224:227], v[208:211], v[180:183]
    s_waitcnt lgkmcnt(4)
    v_mfma_f32_16x16x32_bf16 v[164:167], a[96:99], v[212:215], v[164:167]
    ds_read_b128 v[208:211], v239 offset:17408
    v_mfma_f32_16x16x32_bf16 v[168:171], a[100:103], v[212:215], v[168:171]
    ds_read_b128 v[224:227], v240 offset:9216
    v_mfma_f32_16x16x32_bf16 v[172:175], a[104:107], v[212:215], v[172:175]
    v_mfma_f32_16x16x32_bf16 v[176:179], a[108:111], v[212:215], v[176:179]
    v_mfma_f32_16x16x32_bf16 v[180:183], v[228:231], v[212:215], v[180:183]
    s_waitcnt lgkmcnt(4)
    v_mfma_f32_16x16x32_bf16 v[164:167], a[112:115], v[216:219], v[164:167]
    ds_read_b128 v[212:215], v239 offset:20480
    v_mfma_f32_16x16x32_bf16 v[168:171], a[116:119], v[216:219], v[168:171]
    ds_read_b128 v[228:231], v240 offset:10240
    v_mfma_f32_16x16x32_bf16 v[172:175], a[120:123], v[216:219], v[172:175]
    v_mfma_f32_16x16x32_bf16 v[176:179], a[124:127], v[216:219], v[176:179]
    v_mfma_f32_16x16x32_bf16 v[180:183], v[232:235], v[216:219], v[180:183]
    s_waitcnt lgkmcnt(4)
    v_mfma_f32_16x16x32_bf16 v[164:167], a[128:131], v[204:207], v[164:167]
    ds_read_b128 v[216:219], v239 offset:21504
    v_mfma_f32_16x16x32_bf16 v[168:171], a[132:135], v[204:207], v[168:171]
    ds_read_b128 v[232:235], v240 offset:11264
    v_mfma_f32_16x16x32_bf16 v[172:175], a[136:139], v[204:207], v[172:175]
    v_mfma_f32_16x16x32_bf16 v[176:179], a[140:143], v[204:207], v[176:179]
    v_mfma_f32_16x16x32_bf16 v[180:183], v[220:223], v[204:207], v[180:183]
    s_waitcnt lgkmcnt(4)
    v_mfma_f32_16x16x32_bf16 v[164:167], a[144:147], v[208:211], v[164:167]
    ds_read_b128 v[204:207], v239 offset:24576
    v_mfma_f32_16x16x32_bf16 v[168:171], a[148:151], v[208:211], v[168:171]
    ds_read_b128 v[220:223], v240 offset:12288
    v_mfma_f32_16x16x32_bf16 v[172:175], a[152:155], v[208:211], v[172:175]
    v_mfma_f32_16x16x32_bf16 v[176:179], a[156:159], v[208:211], v[176:179]
    v_mfma_f32_16x16x32_bf16 v[180:183], v[224:227], v[208:211], v[180:183]
    s_cmp_eq_u32 s74, 0
    s_cbranch_scc1 L_Tnofl
    s_lshl_b32 s65, s62, 1
    s_add_u32 s65, s65, 0
    s_waitcnt vmcnt(0)
    v_mov_b32 v236, s65
    s_mov_b64 exec, 1
    buffer_store_dword v236, off, s[4:7], s63 sc1
    buffer_store_dword v236, off, s[4:7], s3
    s_mov_b64 exec, -1
L_Tnofl:
    s_waitcnt lgkmcnt(5)
    v_mfma_f32_16x16x32_bf16 v[164:167], a[160:163], v[212:215], v[164:167]
    ds_read_b128 v[208:211], v239 offset:25600
    v_mfma_f32_16x16x32_bf16 v[168:171], a[164:167], v[212:215], v[168:171]
    ds_read_b128 v[224:227], v240 offset:13312
    v_mfma_f32_16x16x32_bf16 v[172:175], a[168:171], v[212:215], v[172:175]
    v_mfma_f32_16x16x32_bf16 v[176:179], a[172:175], v[212:215], v[176:179]
    s_waitcnt lgkmcnt(6)
    v_mfma_f32_16x16x32_bf16 v[180:183], v[228:231], v[212:215], v[180:183]
    s_waitcnt lgkmcnt(4)
    v_mfma_f32_16x16x32_bf16 v[164:167], a[176:179], v[216:219], v[164:167]
    ds_read_b128 v[212:215], v239 offset:28672
    v_mfma_f32_16x16x32_bf16 v[168:171], a[180:183], v[216:219], v[168:171]
    ds_read_b128 v[228:231], v240 offset:14336
    v_mfma_f32_16x16x32_bf16 v[172:175], a[184:187], v[216:219], v[172:175]
    v_mfma_f32_16x16x32_bf16 v[176:179], a[188:191], v[216:219], v[176:179]
    v_mfma_f32_16x16x32_bf16 v[180:183], v[232:235], v[216:219], v[180:183]
    s_waitcnt lgkmcnt(4)
    v_mfma_f32_16x16x32_bf16 v[164:167], a[192:195], v[204:207], v[164:167]
    ds_read_b128 v[216:219], v239 offset:29696
    v_mfma_f32_16x16x32_bf16 v[168:171], a[196:199], v[204:207], v[168:171]
    ds_read_b128 v[232:235], v240 offset:15360
    v_mfma_f32_16x16x32_bf16 v[172:175], a[200:203], v[204:207], v[172:175]
    v_mfma_f32_16x16x32_bf16 v[176:179], a[204:207], v[204:207], v[176:179]
    v_mfma_f32_16x16x32_bf16 v[180:183], v[220:223], v[204:207], v[180:183]
    s_waitcnt lgkmcnt(4)
    v_mfma_f32_16x16x32_bf16 v[164:167], a[208:211], v[208:211], v[164:167]
    ds_read_b128 v[204:207], v239 offset:32768
    v_mfma_f32_16x16x32_bf16 v[168:171], a[212:215], v[208:211], v[168:171]
    v_mfma_f32_16x16x32_bf16 v[172:175], a[216:219], v[208:211], v[172:175]
    v_mfma_f32_16x16x32_bf16 v[176:179], a[220:223], v[208:211], v[176:179]
    v_mfma_f32_16x16x32_bf16 v[180:183], v[224:227], v[208:211], v[180:183]
    s_waitcnt lgkmcnt(3)
    v_mfma_f32_16x16x32_bf16 v[164:167], a[224:227], v[212:215], v[164:167]
    ds_read_b128 v[208:211], v239 offset:33792
    v_mfma_f32_16x16x32_bf16 v[168:171], a[228:231], v[212:215], v[168:171]
    v_mfma_f32_16x16x32_bf16 v[172:175], a[232:235], v[212:215], v[172:175]
    v_mfma_f32_16x16x32_bf16 v[176:179], a[236:239], v[212:215], v[176:179]
    v_mfma_f32_16x16x32_bf16 v[180:183], v[228:231], v[212:215], v[180:183]
    s_waitcnt lgkmcnt(2)
    v_mfma_f32_16x16x32_bf16 v[164:167], a[240:243], v[216:219], v[164:167]
    ds_read_b128 v[212:215], v239 offset:36864
    v_mfma_f32_16x16x32_bf16 v[168:171], a[244:247], v[216:219], v[168:171]
    v_mfma_f32_16x16x32_bf16 v[172:175], a[248:251], v[216:219], v[172:175]
    v_mfma_f32_16x16x32_bf16 v[176:179], a[252:255], v[216:219], v[176:179]
    v_mfma_f32_16x16x32_bf16 v[180:183], v[232:235], v[216:219], v[180:183]
    s_waitcnt lgkmcnt(2)
    v_mfma_f32_16x16x32_bf16 v[164:167], v[4:7], v[204:207], v[164:167]
    ds_read_b128 v[216:219], v239 offset:37888
    v_mfma_f32_16x16x32_bf16 v[168:171], v[8:11], v[204:207], v[168:171]
    v_mfma_f32_16x16x32_bf16 v[172:175], v[12:15], v[204:207], v[172:175]
    v_mfma_f32_16x16x32_bf16 v[176:179], v[16:19], v[204:207], v[176:179]
    v_mfma_f32_16x16x32_bf16 v[180:183], v[132:135], v[204:207], v[180:183]
    s_waitcnt lgkmcnt(2)
    v_mfma_f32_16x16x32_bf16 v[164:167], v[20:23], v[208:211], v[164:167]
    ds_read_b128 v[204:207], v239 offset:40960
    v_mfma_f32_16x16x32_bf16 v[168:171], v[24:27], v[208:211], v[168:171]
    v_mfma_f32_16x16x32_bf16 v[172:175], v[28:31], v[208:211], v[172:175]
    v_mfma_f32_16x16x32_bf16 v[176:179], v[32:35], v[208:211], v[176:179]
    v_mfma_f32_16x16x32_bf16 v[180:183], v[136:139], v[208:211], v[180:183]
    s_waitcnt lgkmcnt(2)
    v_mfma_f32_16x16x32_bf16 v[164:167], v[36:39], v[212:215], v[164:167]
    ds_read_b128 v[208:211], v239 offset:41984
    v_mfma_f32_16x16x32_bf16 v[168:171], v[40:43], v[212:215], v[168:171]
    v_mfma_f32_16x16x32_bf16 v[172:175], v[44:47], v[212:215], v[172:175]
    v_mfma_f32_16x16x32_bf16 v[176:179], v[48:51], v[212:215], v[176:179]
    v_mfma_f32_16x16x32_bf16 v[180:183], v[140:143], v[212:215], v[180:183]
    s_waitcnt lgkmcnt(2)
    v_mfma_f32_16x16x32_bf16 v[164:167], v[52:55], v[216:219], v[164:167]
    ds_read_b128 v[212:215], v239 offset:45056
    v_mfma_f32_16x16x32_bf16 v[168:171], v[56:59], v[216:219], v[168:171]
    v_mfma_f32_16x16x32_bf16 v[172:175], v[60:63], v[216:219], v[172:175]
    v_mfma_f32_16x16x32_bf16 v[176:179], v[64:67], v[216:219], v[176:179]
    v_mfma_f32_16x16x32_bf16 v[180:183], v[144:147], v[216:219], v[180:183]
    s_waitcnt lgkmcnt(2)
    v_mfma_f32_16x16x32_bf16 v[164:167], v[68:71], v[204:207], v[164:167]
    ds_read_b128 v[216:219], v239 offset:46080
    v_mfma_f32_16x16x32_bf16 v[168:171], v[72:75], v[204:207], v[168:171]
    v_mfma_f32_16x16x32_bf16 v[172:175], v[76:79], v[204:207], v[172:175]
    v_mfma_f32_16x16x32_bf16 v[176:179], v[80:83], v[204:207], v[176:179]
    v_mfma_f32_16x16x32_bf16 v[180:183], v[148:151], v[204:207], v[180:183]
    s_waitcnt vmcnt(0)
    s_barrier
    s_waitcnt lgkmcnt(2)
    v_mfma_f32_16x16x32_bf16 v[164:167], v[84:87], v[208:211], v[164:167]
    ds_read_b128 v[204:207], v239 offset:2048
    v_mfma_f32_16x16x32_bf16 v[168:171], v[88:91], v[208:211], v[168:171]
    ds_read_b128 v[220:223], v240 offset:0
    v_mfma_f32_16x16x32_bf16 v[172:175], v[92:95], v[208:211], v[172:175]
    v_mfma_f32_16x16x32_bf16 v[176:179], v[96:99], v[208:211], v[176:179]
    v_mfma_f32_16x16x32_bf16 v[180:183], v[152:155], v[208:211], v[180:183]
    s_waitcnt lgkmcnt(3)
    v_mfma_f32_16x16x32_bf16 v[164:167], v[100:103], v[212:215], v[164:167]
    ds_read_b128 v[208:211], v239 offset:3072
    v_mfma_f32_16x16x32_bf16 v[168:171], v[104:107], v[212:215], v[168:171]
    ds_read_b128 v[224:227], v240 offset:1024
    v_mfma_f32_16x16x32_bf16 v[172:175], v[108:111], v[212:215], v[172:175]
    v_mfma_f32_16x16x32_bf16 v[176:179], v[112:115], v[212:215], v[176:179]
    v_mfma_f32_16x16x32_bf16 v[180:183], v[156:159], v[212:215], v[180:183]
    s_waitcnt lgkmcnt(4)
    v_mfma_f32_16x16x32_bf16 v[164:167], v[116:119], v[216:219], v[164:167]
    ds_read_b128 v[212:215], v239 offset:6144
    v_mfma_f32_16x16x32_bf16 v[168:171], v[120:123], v[216:219], v[168:171]
    ds_read_b128 v[228:231], v240 offset:2048
    v_mfma_f32_16x16x32_bf16 v[172:175], v[124:127], v[216:219], v[172:175]
    v_mfma_f32_16x16x32_bf16 v[176:179], v[128:131], v[216:219], v[176:179]
    v_mfma_f32_16x16x32_bf16 v[180:183], v[160:163], v[216:219], v[180:183]
    s_waitcnt lgkmcnt(4)
    v_mfma_f32_16x16x32_bf16 v[184:187], a[0:3], v[204:207], 0
    ds_read_b128 v[216:219], v239 offset:7168
    v_mfma_f32_16x16x32_bf16 v[188:191], a[4:7], v[204:207], 0
    ds_read_b128 v[232:235], v240 offset:3072
    v_mfma_f32_16x16x32_bf16 v[192:195], a[8:11], v[204:207], 0
    v_mfma_f32_16x16x32_bf16 v[196:199], a[12:15], v[204:207], 0
    v_mfma_f32_16x16x32_bf16 v[200:203], v[220:223], v[204:207], 0
    s_waitcnt lgkmcnt(5)
    v_mfma_f32_16x16x32_bf16 v[184:187], a[16:19], v[208:211], v[184:187]
    s_add_u32 s77, s72, 0
    ds_read_b128 v[204:207], v239 offset:10240
    s_add_u32 s78, s72, 32768
    v_mfma_f32_16x16x32_bf16 v[188:191], a[20:23], v[208:211], v[188:191]
    ds_read_b128 v[220:223], v240 offset:4096
    v_cvt_pk_bf16_f32 v164, v164, v165
    v_mfma_f32_16x16x32_bf16 v[192:195], a[24:27], v[208:211], v[192:195]
    v_cvt_pk_bf16_f32 v165, v166, v167
    v_cvt_pk_bf16_f32 v166, v168, v169
    v_mfma_f32_16x16x32_bf16 v[196:199], a[28:31], v[208:211], v[196:199]
    v_cvt_pk_bf16_f32 v167, v170, v171
    s_waitcnt lgkmcnt(6)
    v_mfma_f32_16x16x32_bf16 v[200:203], v[224:227], v[208:211], v[200:203]
    s_waitcnt lgkmcnt(4)
    buffer_store_dwordx4 v[164:167], v241, s[4:7], s77 offen sc1
    v_cvt_pk_bf16_f32 v168, v172, v173
    v_cvt_pk_bf16_f32 v169, v174, v175
    v_cvt_pk_bf16_f32 v170, v176, v177
    v_cvt_pk_bf16_f32 v171, v178, v179
    v_mfma_f32_16x16x32_bf16 v[184:187], a[32:35], v[212:215], v[184:187]
    ds_read_b128 v[208:211], v239 offset:11264
    v_mfma_f32_16x16x32_bf16 v[188:191], a[36:39], v[212:215], v[188:191]
    ds_read_b128 v[224:227], v240 offset:5120
    v_mfma_f32_16x16x32_bf16 v[192:195], a[40:43], v[212:215], v[192:195]
    buffer_store_dwordx4 v[168:171], v241, s[4:7], s78 offen sc1
    v_cvt_pk_bf16_f32 v172, v180, v181
    v_cvt_pk_bf16_f32 v173, v182, v183
    v_mfma_f32_16x16x32_bf16 v[196:199], a[44:47], v[212:215], v[196:199]
    buffer_store_dwordx2 v[172:173], v242, s[4:7], s72 offen offset:0 sc1
    v_mfma_f32_16x16x32_bf16 v[200:203], v[228:231], v[212:215], v[200:203]
    s_waitcnt lgkmcnt(4)
    v_mfma_f32_16x16x32_bf16 v[184:187], a[48:51], v[216:219], v[184:187]
    ds_read_b128 v[212:215], v239 offset:14336
    v_mfma_f32_16x16x32_bf16 v[188:191], a[52:55], v[216:219], v[188:191]
    ds_read_b128 v[228:231], v240 offset:6144
    v_mfma_f32_16x16x32_bf16 v[192:195], a[56:59], v[216:219], v[192:195]
    v_mfma_f32_16x16x32_bf16 v[196:199], a[60:63], v[216:219], v[196:199]
    v_mfma_f32_16x16x32_bf16 v[200:203], v[232:235], v[216:219], v[200:203]
    s_waitcnt lgkmcnt(4)
    v_mfma_f32_16x16x32_bf16 v[184:187], a[64:67], v[204:207], v[184:187]
    ds_read_b128 v[216:219], v239 offset:15360
    v_mfma_f32_16x16x32_bf16 v[188:191], a[68:71], v[204:207], v[188:191]
    ds_read_b128 v[232:235], v240 offset:7168
    v_mfma_f32_16x16x32_bf16 v[192:195], a[72:75], v[204:207], v[192:195]
    v_mfma_f32_16x16x32_bf16 v[196:199], a[76:79], v[204:207], v[196:199]
    v_mfma_f32_16x16x32_bf16 v[200:203], v[220:223], v[204:207], v[200:203]
    s_waitcnt lgkmcnt(4)
    v_mfma_f32_16x16x32_bf16 v[184:187], a[80:83], v[208:211], v[184:187]
    ds_read_b128 v[204:207], v239 offset:18432
    v_mfma_f32_16x16x32_bf16 v[188:191], a[84:87], v[208:211], v[188:191]
    ds_read_b128 v[220:223], v240 offset:8192
    v_mfma_f32_16x16x32_bf16 v[192:195], a[88:91], v[208:211], v[192:195]
    v_mfma_f32_16x16x32_bf16 v[196:199], a[92:95], v[208:211], v[196:199]
    v_mfma_f32_16x16x32_bf16 v[200:203], v[224:227], v[208:211], v[200:203]
    s_waitcnt lgkmcnt(4)
    v_mfma_f32_16x16x32_bf16 v[184:187], a[96:99], v[212:215], v[184:187]
    ds_read_b128 v[208:211], v239 offset:19456
    v_mfma_f32_16x16x32_bf16 v[188:191], a[100:103], v[212:215], v[188:191]
    ds_read_b128 v[224:227], v240 offset:9216
    v_mfma_f32_16x16x32_bf16 v[192:195], a[104:107], v[212:215], v[192:195]
    v_mfma_f32_16x16x32_bf16 v[196:199], a[108:111], v[212:215], v[196:199]
    v_mfma_f32_16x16x32_bf16 v[200:203], v[228:231], v[212:215], v[200:203]
    s_waitcnt lgkmcnt(4)
    v_mfma_f32_16x16x32_bf16 v[184:187], a[112:115], v[216:219], v[184:187]
    ds_read_b128 v[212:215], v239 offset:22528
    v_mfma_f32_16x16x32_bf16 v[188:191], a[116:119], v[216:219], v[188:191]
    ds_read_b128 v[228:231], v240 offset:10240
    v_mfma_f32_16x16x32_bf16 v[192:195], a[120:123], v[216:219], v[192:195]
    v_mfma_f32_16x16x32_bf16 v[196:199], a[124:127], v[216:219], v[196:199]
    v_mfma_f32_16x16x32_bf16 v[200:203], v[232:235], v[216:219], v[200:203]
    s_waitcnt lgkmcnt(4)
    v_mfma_f32_16x16x32_bf16 v[184:187], a[128:131], v[204:207], v[184:187]
    ds_read_b128 v[216:219], v239 offset:23552
    v_mfma_f32_16x16x32_bf16 v[188:191], a[132:135], v[204:207], v[188:191]
    ds_read_b128 v[232:235], v240 offset:11264
    v_mfma_f32_16x16x32_bf16 v[192:195], a[136:139], v[204:207], v[192:195]
    v_mfma_f32_16x16x32_bf16 v[196:199], a[140:143], v[204:207], v[196:199]
    v_mfma_f32_16x16x32_bf16 v[200:203], v[220:223], v[204:207], v[200:203]
    s_waitcnt lgkmcnt(4)
    v_mfma_f32_16x16x32_bf16 v[184:187], a[144:147], v[208:211], v[184:187]
    ds_read_b128 v[204:207], v239 offset:26624
    v_mfma_f32_16x16x32_bf16 v[188:191], a[148:151], v[208:211], v[188:191]
    ds_read_b128 v[220:223], v240 offset:12288
    v_mfma_f32_16x16x32_bf16 v[192:195], a[152:155], v[208:211], v[192:195]
    v_mfma_f32_16x16x32_bf16 v[196:199], a[156:159], v[208:211], v[196:199]
    v_mfma_f32_16x16x32_bf16 v[200:203], v[224:227], v[208:211], v[200:203]
    buffer_load_dword v244, v243, s[4:7], 0 offen sc1
    s_waitcnt lgkmcnt(5)
    v_mfma_f32_16x16x32_bf16 v[184:187], a[160:163], v[212:215], v[184:187]
    ds_read_b128 v[208:211], v239 offset:27648
    v_mfma_f32_16x16x32_bf16 v[188:191], a[164:167], v[212:215], v[188:191]
    ds_read_b128 v[224:227], v240 offset:13312
    v_mfma_f32_16x16x32_bf16 v[192:195], a[168:171], v[212:215], v[192:195]
    v_mfma_f32_16x16x32_bf16 v[196:199], a[172:175], v[212:215], v[196:199]
    s_waitcnt lgkmcnt(6)
    v_mfma_f32_16x16x32_bf16 v[200:203], v[228:231], v[212:215], v[200:203]
    s_waitcnt lgkmcnt(4)
    v_mfma_f32_16x16x32_bf16 v[184:187], a[176:179], v[216:219], v[184:187]
    ds_read_b128 v[212:215], v239 offset:30720
    v_mfma_f32_16x16x32_bf16 v[188:191], a[180:183], v[216:219], v[188:191]
    ds_read_b128 v[228:231], v240 offset:14336
    v_mfma_f32_16x16x32_bf16 v[192:195], a[184:187], v[216:219], v[192:195]
    v_mfma_f32_16x16x32_bf16 v[196:199], a[188:191], v[216:219], v[196:199]
    v_mfma_f32_16x16x32_bf16 v[200:203], v[232:235], v[216:219], v[200:203]
    s_waitcnt lgkmcnt(4)
    v_mfma_f32_16x16x32_bf16 v[184:187], a[192:195], v[204:207], v[184:187]
    ds_read_b128 v[216:219], v239 offset:31744
    v_mfma_f32_16x16x32_bf16 v[188:191], a[196:199], v[204:207], v[188:191]
    ds_read_b128 v[232:235], v240 offset:15360
    v_mfma_f32_16x16x32_bf16 v[192:195], a[200:203], v[204:207], v[192:195]
    v_mfma_f32_16x16x32_bf16 v[196:199], a[204:207], v[204:207], v[196:199]
    v_mfma_f32_16x16x32_bf16 v[200:203], v[220:223], v[204:207], v[200:203]
    s_waitcnt lgkmcnt(4)
    v_mfma_f32_16x16x32_bf16 v[184:187], a[208:211], v[208:211], v[184:187]
    ds_read_b128 v[204:207], v239 offset:34816
    v_mfma_f32_16x16x32_bf16 v[188:191], a[212:215], v[208:211], v[188:191]
    v_mfma_f32_16x16x32_bf16 v[192:195], a[216:219], v[208:211], v[192:195]
    v_mfma_f32_16x16x32_bf16 v[196:199], a[220:223], v[208:211], v[196:199]
    v_mfma_f32_16x16x32_bf16 v[200:203], v[224:227], v[208:211], v[200:203]
    s_lshl_b32 s65, s62, 1
    s_add_u32 s65, s65, 1
    s_waitcnt vmcnt(0)
    v_mov_b32 v236, s65
    s_mov_b64 exec, 1
    buffer_store_dword v236, off, s[4:7], s63 sc1
    buffer_store_dword v236, off, s[4:7], s3
    s_mov_b64 exec, -1
    s_add_u32 s65, s62, 2
    v_cmp_gt_u32 vcc, s65, v244
    s_mov_b32 s74, 0
    s_cbranch_vccz L_Tpre
    s_waitcnt lgkmcnt(4)
    v_mfma_f32_16x16x32_bf16 v[184:187], a[224:227], v[212:215], v[184:187]
    ds_read_b128 v[208:211], v239 offset:35840
    v_mfma_f32_16x16x32_bf16 v[188:191], a[228:231], v[212:215], v[188:191]
    v_mfma_f32_16x16x32_bf16 v[192:195], a[232:235], v[212:215], v[192:195]
    v_mfma_f32_16x16x32_bf16 v[196:199], a[236:239], v[212:215], v[196:199]
    s_waitcnt lgkmcnt(4)
    v_mfma_f32_16x16x32_bf16 v[200:203], v[228:231], v[212:215], v[200:203]
    s_waitcnt lgkmcnt(2)
    v_mfma_f32_16x16x32_bf16 v[184:187], a[240:243], v[216:219], v[184:187]
    ds_read_b128 v[212:215], v239 offset:38912
    v_mfma_f32_16x16x32_bf16 v[188:191], a[244:247], v[216:219], v[188:191]
    v_mfma_f32_16x16x32_bf16 v[192:195], a[248:251], v[216:219], v[192:195]
    v_mfma_f32_16x16x32_bf16 v[196:199], a[252:255], v[216:219], v[196:199]
    v_mfma_f32_16x16x32_bf16 v[200:203], v[232:235], v[216:219], v[200:203]
    s_waitcnt lgkmcnt(2)
    v_mfma_f32_16x16x32_bf16 v[184:187], v[4:7], v[204:207], v[184:187]
    ds_read_b128 v[216:219], v239 offset:39936
    v_mfma_f32_16x16x32_bf16 v[188:191], v[8:11], v[204:207], v[188:191]
    v_mfma_f32_16x16x32_bf16 v[192:195], v[12:15], v[204:207], v[192:195]
    v_mfma_f32_16x16x32_bf16 v[196:199], v[16:19], v[204:207], v[196:199]
    v_mfma_f32_16x16x32_bf16 v[200:203], v[132:135], v[204:207], v[200:203]
    s_waitcnt lgkmcnt(2)
    v_mfma_f32_16x16x32_bf16 v[184:187], v[20:23], v[208:211], v[184:187]
    ds_read_b128 v[204:207], v239 offset:43008
    v_mfma_f32_16x16x32_bf16 v[188:191], v[24:27], v[208:211], v[188:191]
    v_mfma_f32_16x16x32_bf16 v[192:195], v[28:31], v[208:211], v[192:195]
    v_mfma_f32_16x16x32_bf16 v[196:199], v[32:35], v[208:211], v[196:199]
    v_mfma_f32_16x16x32_bf16 v[200:203], v[136:139], v[208:211], v[200:203]
    s_waitcnt lgkmcnt(2)
    v_mfma_f32_16x16x32_bf16 v[184:187], v[36:39], v[212:215], v[184:187]
    ds_read_b128 v[208:211], v239 offset:44032
    v_mfma_f32_16x16x32_bf16 v[188:191], v[40:43], v[212:215], v[188:191]
    v_mfma_f32_16x16x32_bf16 v[192:195], v[44:47], v[212:215], v[192:195]
    v_mfma_f32_16x16x32_bf16 v[196:199], v[48:51], v[212:215], v[196:199]
    v_mfma_f32_16x16x32_bf16 v[200:203], v[140:143], v[212:215], v[200:203]
    s_waitcnt lgkmcnt(2)
    v_mfma_f32_16x16x32_bf16 v[184:187], v[52:55], v[216:219], v[184:187]
    ds_read_b128 v[212:215], v239 offset:47104
    v_mfma_f32_16x16x32_bf16 v[188:191], v[56:59], v[216:219], v[188:191]
    v_mfma_f32_16x16x32_bf16 v[192:195], v[60:63], v[216:219], v[192:195]
    v_mfma_f32_16x16x32_bf16 v[196:199], v[64:67], v[216:219], v[196:199]
    v_mfma_f32_16x16x32_bf16 v[200:203], v[144:147], v[216:219], v[200:203]
    s_waitcnt lgkmcnt(2)
    v_mfma_f32_16x16x32_bf16 v[184:187], v[68:71], v[204:207], v[184:187]
    ds_read_b128 v[216:219], v239 offset:48128
    v_mfma_f32_16x16x32_bf16 v[188:191], v[72:75], v[204:207], v[188:191]
    v_mfma_f32_16x16x32_bf16 v[192:195], v[76:79], v[204:207], v[192:195]
    v_mfma_f32_16x16x32_bf16 v[196:199], v[80:83], v[204:207], v[196:199]
    v_mfma_f32_16x16x32_bf16 v[200:203], v[148:151], v[204:207], v[200:203]
    s_waitcnt lgkmcnt(2)
    v_mfma_f32_16x16x32_bf16 v[184:187], v[84:87], v[208:211], v[184:187]
    v_mfma_f32_16x16x32_bf16 v[188:191], v[88:91], v[208:211], v[188:191]
    v_mfma_f32_16x16x32_bf16 v[192:195], v[92:95], v[208:211], v[192:195]
    v_mfma_f32_16x16x32_bf16 v[196:199], v[96:99], v[208:211], v[196:199]
    v_mfma_f32_16x16x32_bf16 v[200:203], v[152:155], v[208:211], v[200:203]
    s_waitcnt lgkmcnt(1)
    v_mfma_f32_16x16x32_bf16 v[184:187], v[100:103], v[212:215], v[184:187]
    v_mfma_f32_16x16x32_bf16 v[188:191], v[104:107], v[212:215], v[188:191]
    v_mfma_f32_16x16x32_bf16 v[192:195], v[108:111], v[212:215], v[192:195]
    v_mfma_f32_16x16x32_bf16 v[196:199], v[112:115], v[212:215], v[196:199]
    v_mfma_f32_16x16x32_bf16 v[200:203], v[156:159], v[212:215], v[200:203]
    s_waitcnt lgkmcnt(0)
    v_mfma_f32_16x16x32_bf16 v[184:187], v[116:119], v[216:219], v[184:187]
    v_mfma_f32_16x16x32_bf16 v[188:191], v[120:123], v[216:219], v[188:191]
    v_mfma_f32_16x16x32_bf16 v[192:195], v[124:127], v[216:219], v[192:195]
    v_mfma_f32_16x16x32_bf16 v[196:199], v[128:131], v[216:219], v[196:199]
    v_mfma_f32_16x16x32_bf16 v[200:203], v[160:163], v[216:219], v[200:203]
L_Tend:
    v_xor_b32 v239, 49152, v239
    s_add_u32 s77, s72, 16384
    s_add_u32 s78, s72, 49152
    s_nop 0
    v_cvt_pk_bf16_f32 v184, v184, v185
    v_cvt_pk_bf16_f32 v185, v186, v187
    v_cvt_pk_bf16_f32 v186, v188, v189
    v_cvt_pk_bf16_f32 v187, v190, v191
    buffer_store_dwordx4 v[184:187], v241, s[4:7], s77 offen sc1
    v_cvt_pk_bf16_f32 v188, v192, v193
    v_cvt_pk_bf16_f32 v189, v194, v195
    v_cvt_pk_bf16_f32 v190, v196, v197
    v_cvt_pk_bf16_f32 v191, v198, v199
    buffer_store_dwordx4 v[188:191], v241, s[4:7], s78 offen sc1
    v_cvt_pk_bf16_f32 v192, v200, v201
    v_cvt_pk_bf16_f32 v193, v202, v203
    buffer_store_dwordx2 v[192:193], v242, s[4:7], s72 offen offset:512 sc1
    s_add_u32 s62, s62, 1
    s_cmp_lt_u32 s62, 64
    s_cbranch_scc1 L_Tseg
    s_lshl_b32 s65, s62, 1
    s_add_u32 s65, s65, 0
    s_waitcnt vmcnt(0)
    v_mov_b32 v236, s65
    s_mov_b64 exec, 1
    buffer_store_dword v236, off, s[4:7], s63 sc1
    buffer_store_dword v236, off, s[4:7], s3
    s_mov_b64 exec, -1
    s_endpgm
L_Tpre:
    s_mov_b32 s74, 1
    s_waitcnt lgkmcnt(4)
    v_mfma_f32_16x16x32_bf16 v[184:187], a[224:227], v[212:215], v[184:187]
    s_add_u32 m0, s73, 0
    ds_read_b128 v[208:211], v239 offset:35840
    s_add_u32 s64, s70, 0
    v_mfma_f32_16x16x32_bf16 v[188:191], a[228:231], v[212:215], v[188:191]
    buffer_load_dwordx4 v238, s[4:7], s64 offen sc1 lds
    v_mfma_f32_16x16x32_bf16 v[192:195], a[232:235], v[212:215], v[192:195]
    v_mfma_f32_16x16x32_bf16 v[196:199], a[236:239], v[212:215], v[196:199]
    s_add_u32 m0, s73, 8192
    s_add_u32 s64, s70, 8192
    buffer_load_dwordx4 v238, s[4:7], s64 offen sc1 lds
    s_waitcnt lgkmcnt(4)
    v_mfma_f32_16x16x32_bf16 v[200:203], v[228:231], v[212:215], v[200:203]
    s_waitcnt lgkmcnt(2)
    v_mfma_f32_16x16x32_bf16 v[184:187], a[240:243], v[216:219], v[184:187]
    s_add_u32 m0, s73, 16384
    ds_read_b128 v[212:215], v239 offset:38912
    s_add_u32 s64, s70, 16384
    v_mfma_f32_16x16x32_bf16 v[188:191], a[244:247], v[216:219], v[188:191]
    buffer_load_dwordx4 v238, s[4:7], s64 offen sc1 lds
    v_mfma_f32_16x16x32_bf16 v[192:195], a[248:251], v[216:219], v[192:195]
    v_mfma_f32_16x16x32_bf16 v[196:199], a[252:255], v[216:219], v[196:199]
    s_add_u32 m0, s73, 24576
    s_add_u32 s64, s70, 24576
    buffer_load_dwordx4 v238, s[4:7], s64 offen sc1 lds
    v_mfma_f32_16x16x32_bf16 v[200:203], v[232:235], v[216:219], v[200:203]
    s_waitcnt lgkmcnt(2)
    v_mfma_f32_16x16x32_bf16 v[184:187], v[4:7], v[204:207], v[184:187]
    s_add_u32 m0, s73, 32768
    ds_read_b128 v[216:219], v239 offset:39936
    s_add_u32 s64, s70, 32768
    v_mfma_f32_16x16x32_bf16 v[188:191], v[8:11], v[204:207], v[188:191]
    buffer_load_dwordx4 v238, s[4:7], s64 offen sc1 lds
    v_mfma_f32_16x16x32_bf16 v[192:195], v[12:15], v[204:207], v[192:195]
    v_mfma_f32_16x16x32_bf16 v[196:199], v[16:19], v[204:207], v[196:199]
    s_add_u32 m0, s73, 40960
    s_add_u32 s64, s70, 40960
    buffer_load_dwordx4 v238, s[4:7], s64 offen sc1 lds
    v_mfma_f32_16x16x32_bf16 v[200:203], v[132:135], v[204:207], v[200:203]
    s_waitcnt lgkmcnt(2)
    v_mfma_f32_16x16x32_bf16 v[184:187], v[20:23], v[208:211], v[184:187]
    s_add_u32 m0, s73, 2048
    ds_read_b128 v[204:207], v239 offset:43008
    s_add_u32 s64, s70, 2048
    v_mfma_f32_16x16x32_bf16 v[188:191], v[24:27], v[208:211], v[188:191]
    buffer_load_dwordx4 v238, s[4:7], s64 offen sc1 lds
    v_mfma_f32_16x16x32_bf16 v[192:195], v[28:31], v[208:211], v[192:195]
    v_mfma_f32_16x16x32_bf16 v[196:199], v[32:35], v[208:211], v[196:199]
    s_add_u32 m0, s73, 10240
    s_add_u32 s64, s70, 10240
    buffer_load_dwordx4 v238, s[4:7], s64 offen sc1 lds
    v_mfma_f32_16x16x32_bf16 v[200:203], v[136:139], v[208:211], v[200:203]
    s_waitcnt lgkmcnt(2)
    v_mfma_f32_16x16x32_bf16 v[184:187], v[36:39], v[212:215], v[184:187]
    s_add_u32 m0, s73, 18432
    ds_read_b128 v[208:211], v239 offset:44032
    s_add_u32 s64, s70, 18432
    v_mfma_f32_16x16x32_bf16 v[188:191], v[40:43], v[212:215], v[188:191]
    buffer_load_dwordx4 v238, s[4:7], s64 offen sc1 lds
    v_mfma_f32_16x16x32_bf16 v[192:195], v[44:47], v[212:215], v[192:195]
    v_mfma_f32_16x16x32_bf16 v[196:199], v[48:51], v[212:215], v[196:199]
    s_add_u32 m0, s73, 26624
    s_add_u32 s64, s70, 26624
    buffer_load_dwordx4 v238, s[4:7], s64 offen sc1 lds
    v_mfma_f32_16x16x32_bf16 v[200:203], v[140:143], v[212:215], v[200:203]
    s_waitcnt lgkmcnt(2)
    v_mfma_f32_16x16x32_bf16 v[184:187], v[52:55], v[216:219], v[184:187]
    s_add_u32 m0, s73, 34816
    ds_read_b128 v[212:215], v239 offset:47104
    s_add_u32 s64, s70, 34816
    v_mfma_f32_16x16x32_bf16 v[188:191], v[56:59], v[216:219], v[188:191]
    buffer_load_dwordx4 v238, s[4:7], s64 offen sc1 lds
    v_mfma_f32_16x16x32_bf16 v[192:195], v[60:63], v[216:219], v[192:195]
    v_mfma_f32_16x16x32_bf16 v[196:199], v[64:67], v[216:219], v[196:199]
    s_add_u32 m0, s73, 43008
    s_add_u32 s64, s70, 43008
    buffer_load_dwordx4 v238, s[4:7], s64 offen sc1 lds
    v_mfma_f32_16x16x32_bf16 v[200:203], v[144:147], v[216:219], v[200:203]
    s_waitcnt lgkmcnt(2)
    v_mfma_f32_16x16x32_bf16 v[184:187], v[68:71], v[204:207], v[184:187]
    s_add_u32 s70, s70, 393216
    ds_read_b128 v[216:219], v239 offset:48128
    s_add_u32 s66, s62, 2
    v_mfma_f32_16x16x32_bf16 v[188:191], v[72:75], v[204:207], v[188:191]
    s_and_b32 s66, s66, 7
    s_cselect_b32 s66, 0, 3145728
    s_sub_u32 s70, s70, s66
    v_mfma_f32_16x16x32_bf16 v[192:195], v[76:79], v[204:207], v[192:195]
    s_xor_b32 s73, s73, 49152
    v_mfma_f32_16x16x32_bf16 v[196:199], v[80:83], v[204:207], v[196:199]
    v_mfma_f32_16x16x32_bf16 v[200:203], v[148:151], v[204:207], v[200:203]
    s_waitcnt lgkmcnt(2)
    v_mfma_f32_16x16x32_bf16 v[184:187], v[84:87], v[208:211], v[184:187]
    v_mfma_f32_16x16x32_bf16 v[188:191], v[88:91], v[208:211], v[188:191]
    v_mfma_f32_16x16x32_bf16 v[192:195], v[92:95], v[208:211], v[192:195]
    v_mfma_f32_16x16x32_bf16 v[196:199], v[96:99], v[208:211], v[196:199]
    v_mfma_f32_16x16x32_bf16 v[200:203], v[152:155], v[208:211], v[200:203]
    s_waitcnt lgkmcnt(1)
    v_mfma_f32_16x16x32_bf16 v[184:187], v[100:103], v[212:215], v[184:187]
    v_mfma_f32_16x16x32_bf16 v[188:191], v[104:107], v[212:215], v[188:191]
    v_mfma_f32_16x16x32_bf16 v[192:195], v[108:111], v[212:215], v[192:195]
    v_mfma_f32_16x16x32_bf16 v[196:199], v[112:115], v[212:215], v[196:199]
    v_mfma_f32_16x16x32_bf16 v[200:203], v[156:159], v[212:215], v[200:203]
    s_waitcnt lgkmcnt(0)
    v_mfma_f32_16x16x32_bf16 v[184:187], v[116:119], v[216:219], v[184:187]
    v_mfma_f32_16x16x32_bf16 v[188:191], v[120:123], v[216:219], v[188:191]
    v_mfma_f32_16x16x32_bf16 v[192:195], v[124:127], v[216:219], v[192:195]
    v_mfma_f32_16x16x32_bf16 v[196:199], v[128:131], v[216:219], v[196:199]
    v_mfma_f32_16x16x32_bf16 v[200:203], v[160:163], v[216:219], v[200:203]
    s_branch L_Tend
Lgrty_61:
    s_sleep 16
    buffer_load_dword v2, off, s[8:11], 0 offset:132 sc1
    s_sub_u32 s61, s61, 1
    s_mov_b32 s67, 1
    s_cbranch_scc1 L_fail
    s_branch Lgchk_60
Lprty_64:
    s_sleep 16
    buffer_load_dword v2, off, s[8:11], 0 offset:140 sc1
    s_sub_u32 s61, s61, 1
    s_mov_b32 s67, 16
    s_cbranch_scc1 L_fail
    s_branch Lpchk_63
Lfrty_66:
    s_sleep 4
    buffer_load_dword v244, v243, s[4:7], 0 offen sc1
    s_sub_u32 s61, s61, 1
    s_mov_b32 s67, 20
    s_cbranch_scc1 L_fail
    s_waitcnt vmcnt(0)
    s_branch Lfchk_65
L_roleB:
    s_mov_b32 s20, s48
    s_mov_b32 s21, s49
    s_mov_b32 s22, 2457600
    s_mov_b32 s23, 0x20000
    s_mov_b32 s24, s50
    s_mov_b32 s25, s51
    s_mov_b32 s26, 819200
    s_mov_b32 s27, 0x20000
    v_and_b32 v1, 63, v0
    s_lshl_b32 s76, s69, 1
    s_and_b32 s64, s59, 1
    s_add_u32 s76, s76, s64
    v_lshrrev_b32 v176, 4, v1
    v_bfe_u32 v177, v1, 2, 2
    v_and_b32 v178, 3, v1
    v_lshlrev_b32 v247, 4, v1
    v_and_b32 v169, 31, v1
    v_mul_u32_u24 v170, 26, v169
    v_lshrrev_b32 v170, 8, v170
    v_mul_u32_u24 v168, 1120, v170
    v_lshl_add_u32 v168, v169, 4, v168
    v_lshrrev_b32 v170, 5, v0
    v_mul_u32_u24 v170, 3840, v170
    s_mul_i32 s64, s76, 160
    v_add3_u32 v168, v168, v170, s64
    v_mov_b32 v170, 0x80000000
    v_cmp_gt_u32 vcc, 30, v169
    s_nop 1
    v_cndmask_b32 v168, v170, v168, vcc
    v_lshl_add_u32 v169, v176, 3, v177
    v_lshlrev_b32 v169, 9, v169
    s_mul_i32 s64, s60, 40
    v_mul_u32_u24 v171, 160, v178
    s_add_u32 s65, s64, 32
    v_mov_b32 v172, s65
    v_cmp_gt_u32 vcc, 3, v178
    s_nop 1
    v_cndmask_b32 v172, 0, v172, vcc
    v_add3_u32 v171, v171, v172, v169
    v_lshl_add_u32 v169, v178, 3, v169
    v_add_u32 v169, s64, v169
    v_add_u32 v170, 65536, v169
    v_add_u32 v172, 65536, v171
    v_lshl_add_u32 v173, v178, 2, v177
    v_lshl_add_u32 v173, v176, 4, v173
    v_lshlrev_b32 v173, 2, v173
    s_lshl_b32 s70, s60, 10
    s_cmp_lg_u32 s68, 0
    s_cbranch_scc1 Larr0_67
    s_waitcnt vmcnt(0)
    s_barrier
    s_cmp_lg_u32 s60, 0
    s_cbranch_scc1 Lcnt_68
    s_mov_b64 exec, 1
    v_mov_b32 v2, 1
    buffer_atomic_add v2, off, s[8:11], 0 offset:4 sc0
    v_mov_b32 v3, 0x80000000
    s_waitcnt vmcnt(0)
    v_cmp_ne_u32 vcc, 255, v2
    s_nop 1
    v_cndmask_b32 v3, 4, v3, vcc
    buffer_store_dword v2, v3, s[8:11], 0 offen offset:128 sc1
    s_mov_b64 exec, -1
Lcnt_68:
Larr0_67:
    s_mov_b32 s64, 0
    s_add_u32 m0, s70, 0
    s_nop 0
    buffer_load_dwordx4 v168, s[20:23], s64 offen nt lds
    s_mov_b32 s64, 30720
    s_add_u32 m0, s70, 4096
    s_nop 0
    buffer_load_dwordx4 v168, s[20:23], s64 offen nt lds
    s_mov_b32 s64, 61440
    s_add_u32 m0, s70, 8192
    s_nop 0
    buffer_load_dwordx4 v168, s[20:23], s64 offen nt lds
    s_mov_b32 s64, 92160
    s_add_u32 m0, s70, 12288
    s_nop 0
    buffer_load_dwordx4 v168, s[20:23], s64 offen nt lds
    s_mov_b32 s64, 122880
    s_add_u32 m0, s70, 16384
    s_nop 0
    buffer_load_dwordx4 v168, s[20:23], s64 offen nt lds
    s_mov_b32 s64, 153600
    s_add_u32 m0, s70, 20480
    s_nop 0
    buffer_load_dwordx4 v168, s[20:23], s64 offen nt lds
    s_mov_b32 s64, 184320
    s_add_u32 m0, s70, 24576
    s_nop 0
    buffer_load_dwordx4 v168, s[20:23], s64 offen nt lds
    s_mov_b32 s64, 215040
    s_add_u32 m0, s70, 28672
    s_nop 0
    buffer_load_dwordx4 v168, s[20:23], s64 offen nt lds
    s_mov_b32 s64, 245760
    s_add_u32 m0, s70, 32768
    s_nop 0
    buffer_load_dwordx4 v168, s[20:23], s64 offen nt lds
    s_mov_b32 s64, 276480
    s_add_u32 m0, s70, 36864
    s_nop 0
    buffer_load_dwordx4 v168, s[20:23], s64 offen nt lds
    s_mov_b32 s64, 307200
    s_add_u32 m0, s70, 40960
    s_nop 0
    buffer_load_dwordx4 v168, s[20:23], s64 offen nt lds
    s_mov_b32 s64, 337920
    s_add_u32 m0, s70, 45056
    s_nop 0
    buffer_load_dwordx4 v168, s[20:23], s64 offen nt lds
    s_mov_b32 s64, 368640
    s_add_u32 m0, s70, 49152
    s_nop 0
    buffer_load_dwordx4 v168, s[20:23], s64 offen nt lds
    s_mov_b32 s64, 399360
    s_add_u32 m0, s70, 53248
    s_nop 0
    buffer_load_dwordx4 v168, s[20:23], s64 offen nt lds
    s_mov_b32 s64, 430080
    s_add_u32 m0, s70, 57344
    s_nop 0
    buffer_load_dwordx4 v168, s[20:23], s64 offen nt lds
    s_mov_b32 s64, 460800
    s_add_u32 m0, s70, 61440
    s_nop 0
    buffer_load_dwordx4 v168, s[20:23], s64 offen nt lds
    s_mov_b32 s64, 491520
    s_add_u32 m0, s70, 65536
    s_nop 0
    buffer_load_dwordx4 v168, s[20:23], s64 offen nt lds
    s_mov_b32 s64, 522240
    s_add_u32 m0, s70, 69632
    s_nop 0
    buffer_load_dwordx4 v168, s[20:23], s64 offen nt lds
    s_mov_b32 s64, 552960
    s_add_u32 m0, s70, 73728
    s_nop 0
    buffer_load_dwordx4 v168, s[20:23], s64 offen nt lds
    s_mov_b32 s64, 583680
    s_add_u32 m0, s70, 77824
    s_nop 0
    buffer_load_dwordx4 v168, s[20:23], s64 offen nt lds
    s_mov_b32 s64, 614400
    s_add_u32 m0, s70, 81920
    s_nop 0
    buffer_load_dwordx4 v168, s[20:23], s64 offen nt lds
    s_mov_b32 s64, 645120
    s_add_u32 m0, s70, 86016
    s_nop 0
    buffer_load_dwordx4 v168, s[20:23], s64 offen nt lds
    s_mov_b32 s64, 675840
    s_add_u32 m0, s70, 90112
    s_nop 0
    buffer_load_dwordx4 v168, s[20:23], s64 offen nt lds
    s_mov_b32 s64, 706560
    s_add_u32 m0, s70, 94208
    s_nop 0
    buffer_load_dwordx4 v168, s[20:23], s64 offen nt lds
    s_mov_b32 s64, 737280
    s_add_u32 m0, s70, 98304
    s_nop 0
    buffer_load_dwordx4 v168, s[20:23], s64 offen nt lds
    s_mov_b32 s64, 768000
    s_add_u32 m0, s70, 102400
    s_nop 0
    buffer_load_dwordx4 v168, s[20:23], s64 offen nt lds
    s_mov_b32 s64, 798720
    s_add_u32 m0, s70, 106496
    s_nop 0
    buffer_load_dwordx4 v168, s[20:23], s64 offen nt lds
    s_mov_b32 s64, 829440
    s_add_u32 m0, s70, 110592
    s_nop 0
    buffer_load_dwordx4 v168, s[20:23], s64 offen nt lds
    s_waitcnt vmcnt(24)
    s_waitcnt lgkmcnt(0)
    s_barrier
    s_mov_b32 s64, 860160
    s_add_u32 m0, s70, 114688
    s_nop 0
    buffer_load_dwordx4 v168, s[20:23], s64 offen nt lds
    s_mov_b32 s64, 890880
    s_add_u32 m0, s70, 118784
    s_nop 0
    buffer_load_dwordx4 v168, s[20:23], s64 offen nt lds
    s_mov_b32 s64, 921600
    s_add_u32 m0, s70, 122880
    s_nop 0
    buffer_load_dwordx4 v168, s[20:23], s64 offen nt lds
    s_mov_b32 s64, 952320
    s_add_u32 m0, s70, 126976
    s_nop 0
    buffer_load_dwordx4 v168, s[20:23], s64 offen nt lds
    ds_read_b64_tr_b16 v[204:205], v171 offset:0
    ds_read_b64_tr_b16 v[206:207], v171 offset:2048
    ds_read_b64_tr_b16 a[0:1], v169 offset:0
    ds_read_b64_tr_b16 a[2:3], v169 offset:2048
    ds_read_b64_tr_b16 a[80:81], v169 offset:160
    ds_read_b64_tr_b16 a[82:83], v169 offset:2208
    ds_read_b64_tr_b16 a[160:161], v169 offset:320
    ds_read_b64_tr_b16 a[162:163], v169 offset:2368
    s_waitcnt lgkmcnt(7)
    ds_bpermute_b32 v4, v173, v204
    ds_bpermute_b32 v5, v173, v205
    s_waitcnt lgkmcnt(8)
    ds_bpermute_b32 v6, v173, v206
    ds_bpermute_b32 v7, v173, v207
    s_waitcnt vmcnt(24)
    s_waitcnt lgkmcnt(0)
    s_barrier
    s_mov_b32 s64, 983040
    s_add_u32 m0, s70, 0
    s_nop 0
    buffer_load_dwordx4 v168, s[20:23], s64 offen nt lds
    s_mov_b32 s64, 1013760
    s_add_u32 m0, s70, 4096
    s_nop 0
    buffer_load_dwordx4 v168, s[20:23], s64 offen nt lds
    s_mov_b32 s64, 1044480
    s_add_u32 m0, s70, 8192
    s_nop 0
    buffer_load_dwordx4 v168, s[20:23], s64 offen nt lds
    s_mov_b32 s64, 1075200
    s_add_u32 m0, s70, 12288
    s_nop 0
    buffer_load_dwordx4 v168, s[20:23], s64 offen nt lds
    ds_read_b64_tr_b16 v[204:205], v171 offset:16384
    ds_read_b64_tr_b16 v[206:207], v171 offset:18432
    ds_read_b64_tr_b16 a[4:5], v169 offset:16384
    ds_read_b64_tr_b16 a[6:7], v169 offset:18432
    ds_read_b64_tr_b16 a[84:85], v169 offset:16544
    ds_read_b64_tr_b16 a[86:87], v169 offset:18592
    ds_read_b64_tr_b16 a[164:165], v169 offset:16704
    ds_read_b64_tr_b16 a[166:167], v169 offset:18752
    s_waitcnt lgkmcnt(7)
    ds_bpermute_b32 v8, v173, v204
    ds_bpermute_b32 v9, v173, v205
    s_waitcnt lgkmcnt(8)
    ds_bpermute_b32 v10, v173, v206
    ds_bpermute_b32 v11, v173, v207
    s_waitcnt vmcnt(24)
    s_waitcnt lgkmcnt(0)
    s_barrier
    s_mov_b32 s64, 1105920
    s_add_u32 m0, s70, 16384
    s_nop 0
    buffer_load_dwordx4 v168, s[20:23], s64 offen nt lds
    s_mov_b32 s64, 1136640
    s_add_u32 m0, s70, 20480
    s_nop 0
    buffer_load_dwordx4 v168, s[20:23], s64 offen nt lds
    s_mov_b32 s64, 1167360
    s_add_u32 m0, s70, 24576
    s_nop 0
    buffer_load_dwordx4 v168, s[20:23], s64 offen nt lds
    s_mov_b32 s64, 1198080
    s_add_u32 m0, s70, 28672
    s_nop 0
    buffer_load_dwordx4 v168, s[20:23], s64 offen nt lds
    ds_read_b64_tr_b16 v[204:205], v171 offset:32768
    ds_read_b64_tr_b16 v[206:207], v171 offset:34816
    ds_read_b64_tr_b16 a[8:9], v169 offset:32768
    ds_read_b64_tr_b16 a[10:11], v169 offset:34816
    ds_read_b64_tr_b16 a[88:89], v169 offset:32928
    ds_read_b64_tr_b16 a[90:91], v169 offset:34976
    ds_read_b64_tr_b16 a[168:169], v169 offset:33088
    ds_read_b64_tr_b16 a[170:171], v169 offset:35136
    s_waitcnt lgkmcnt(7)
    ds_bpermute_b32 v12, v173, v204
    ds_bpermute_b32 v13, v173, v205
    s_waitcnt lgkmcnt(8)
    ds_bpermute_b32 v14, v173, v206
    ds_bpermute_b32 v15, v173, v207
    s_waitcnt vmcnt(24)
    s_waitcnt lgkmcnt(0)
    s_barrier
    s_mov_b32 s64, 1228800
    s_add_u32 m0, s70, 32768
    s_nop 0
    buffer_load_dwordx4 v168, s[20:23], s64 offen nt lds
    s_mov_b32 s64, 1259520
    s_add_u32 m0, s70, 36864
    s_nop 0
    buffer_load_dwordx4 v168, s[20:23], s64 offen nt lds
    s_mov_b32 s64, 1290240
    s_add_u32 m0, s70, 40960
    s_nop 0
    buffer_load_dwordx4 v168, s[20:23], s64 offen nt lds
    s_mov_b32 s64, 1320960
    s_add_u32 m0, s70, 45056
    s_nop 0
    buffer_load_dwordx4 v168, s[20:23], s64 offen nt lds
    ds_read_b64_tr_b16 v[204:205], v171 offset:49152
    ds_read_b64_tr_b16 v[206:207], v171 offset:51200
    ds_read_b64_tr_b16 a[12:13], v169 offset:49152
    ds_read_b64_tr_b16 a[14:15], v169 offset:51200
    ds_read_b64_tr_b16 a[92:93], v169 offset:49312
    ds_read_b64_tr_b16 a[94:95], v169 offset:51360
    ds_read_b64_tr_b16 a[172:173], v169 offset:49472
    ds_read_b64_tr_b16 a[174:175], v169 offset:51520
    s_waitcnt lgkmcnt(7)
    ds_bpermute_b32 v16, v173, v204
    ds_bpermute_b32 v17, v173, v205
    s_waitcnt lgkmcnt(8)
    ds_bpermute_b32 v18, v173, v206
    ds_bpermute_b32 v19, v173, v207
    s_waitcnt vmcnt(24)
    s_waitcnt lgkmcnt(0)
    s_barrier
    s_mov_b32 s64, 1351680
    s_add_u32 m0, s70, 49152
    s_nop 0
    buffer_load_dwordx4 v168, s[20:23], s64 offen nt lds
    s_mov_b32 s64, 1382400
    s_add_u32 m0, s70, 53248
    s_nop 0
    buffer_load_dwordx4 v168, s[20:23], s64 offen nt lds
    s_mov_b32 s64, 1413120
    s_add_u32 m0, s70, 57344
    s_nop 0
    buffer_load_dwordx4 v168, s[20:23], s64 offen nt lds
    s_mov_b32 s64, 1443840
    s_add_u32 m0, s70, 61440
    s_nop 0
    buffer_load_dwordx4 v168, s[20:23], s64 offen nt lds
    ds_read_b64_tr_b16 v[204:205], v172 offset:0
    ds_read_b64_tr_b16 v[206:207], v172 offset:2048
    ds_read_b64_tr_b16 a[16:17], v170 offset:0
    ds_read_b64_tr_b16 a[18:19], v170 offset:2048
    ds_read_b64_tr_b16 a[96:97], v170 offset:160
    ds_read_b64_tr_b16 a[98:99], v170 offset:2208
    ds_read_b64_tr_b16 a[176:177], v170 offset:320
    ds_read_b64_tr_b16 a[178:179], v170 offset:2368
    s_waitcnt lgkmcnt(7)
    ds_bpermute_b32 v20, v173, v204
    ds_bpermute_b32 v21, v173, v205
    s_waitcnt lgkmcnt(8)
    ds_bpermute_b32 v22, v173, v206
    ds_bpermute_b32 v23, v173, v207
    s_waitcnt vmcnt(24)
    s_waitcnt lgkmcnt(0)
    s_barrier
    s_mov_b32 s64, 1474560
    s_add_u32 m0, s70, 65536
    s_nop 0
    buffer_load_dwordx4 v168, s[20:23], s64 offen nt lds
    s_mov_b32 s64, 1505280
    s_add_u32 m0, s70, 69632
    s_nop 0
    buffer_load_dwordx4 v168, s[20:23], s64 offen nt lds
    s_mov_b32 s64, 1536000
    s_add_u32 m0, s70, 73728
    s_nop 0
    buffer_load_dwordx4 v168, s[20:23], s64 offen nt lds
    s_mov_b32 s64, 1566720
    s_add_u32 m0, s70, 77824
    s_nop 0
    buffer_load_dwordx4 v168, s[20:23], s64 offen nt lds
    ds_read_b64_tr_b16 v[204:205], v172 offset:16384
    ds_read_b64_tr_b16 v[206:207], v172 offset:18432
    ds_read_b64_tr_b16 a[20:21], v170 offset:16384
    ds_read_b64_tr_b16 a[22:23], v170 offset:18432
    ds_read_b64_tr_b16 a[100:101], v170 offset:16544
    ds_read_b64_tr_b16 a[102:103], v170 offset:18592
    ds_read_b64_tr_b16 a[180:181], v170 offset:16704
    ds_read_b64_tr_b16 a[182:183], v170 offset:18752
    s_waitcnt lgkmcnt(7)
    ds_bpermute_b32 v24, v173, v204
    ds_bpermute_b32 v25, v173, v205
    s_waitcnt lgkmcnt(8)
    ds_bpermute_b32 v26, v173, v206
    ds_bpermute_b32 v27, v173, v207
    s_waitcnt vmcnt(24)
    s_waitcnt lgkmcnt(0)
    s_barrier
    s_mov_b32 s64, 1597440
    s_add_u32 m0, s70, 81920
    s_nop 0
    buffer_load_dwordx4 v168, s[20:23], s64 offen nt lds
    s_mov_b32 s64, 1628160
    s_add_u32 m0, s70, 86016
    s_nop 0
    buffer_load_dwordx4 v168, s[20:23], s64 offen nt lds
    s_mov_b32 s64, 1658880
    s_add_u32 m0, s70, 90112
    s_nop 0
    buffer_load_dwordx4 v168, s[20:23], s64 offen nt lds
    s_mov_b32 s64, 1689600
    s_add_u32 m0, s70, 94208
    s_nop 0
    buffer_load_dwordx4 v168, s[20:23], s64 offen nt lds
    ds_read_b64_tr_b16 v[204:205], v172 offset:32768
    ds_read_b64_tr_b16 v[206:207], v172 offset:34816
    ds_read_b64_tr_b16 a[24:25], v170 offset:32768
    ds_read_b64_tr_b16 a[26:27], v170 offset:34816
    ds_read_b64_tr_b16 a[104:105], v170 offset:32928
    ds_read_b64_tr_b16 a[106:107], v170 offset:34976
    ds_read_b64_tr_b16 a[184:185], v170 offset:33088
    ds_read_b64_tr_b16 a[186:187], v170 offset:35136
    s_waitcnt lgkmcnt(7)
    ds_bpermute_b32 v28, v173, v204
    ds_bpermute_b32 v29, v173, v205
    s_waitcnt lgkmcnt(8)
    ds_bpermute_b32 v30, v173, v206
    ds_bpermute_b32 v31, v173, v207
    s_waitcnt vmcnt(24)
    s_waitcnt lgkmcnt(0)
    s_barrier
    s_mov_b32 s64, 1720320
    s_add_u32 m0, s70, 98304
    s_nop 0
    buffer_load_dwordx4 v168, s[20:23], s64 offen nt lds
    s_mov_b32 s64, 1751040
    s_add_u32 m0, s70, 102400
    s_nop 0
    buffer_load_dwordx4 v168, s[20:23], s64 offen nt lds
    s_mov_b32 s64, 1781760
    s_add_u32 m0, s70, 106496
    s_nop 0
    buffer_load_dwordx4 v168, s[20:23], s64 offen nt lds
    s_mov_b32 s64, 1812480
    s_add_u32 m0, s70, 110592
    s_nop 0
    buffer_load_dwordx4 v168, s[20:23], s64 offen nt lds
    ds_read_b64_tr_b16 v[204:205], v172 offset:49152
    ds_read_b64_tr_b16 v[206:207], v172 offset:51200
    ds_read_b64_tr_b16 a[28:29], v170 offset:49152
    ds_read_b64_tr_b16 a[30:31], v170 offset:51200
    ds_read_b64_tr_b16 a[108:109], v170 offset:49312
    ds_read_b64_tr_b16 a[110:111], v170 offset:51360
    ds_read_b64_tr_b16 a[188:189], v170 offset:49472
    ds_read_b64_tr_b16 a[190:191], v170 offset:51520
    s_waitcnt lgkmcnt(7)
    ds_bpermute_b32 v32, v173, v204
    ds_bpermute_b32 v33, v173, v205
    s_waitcnt lgkmcnt(8)
    ds_bpermute_b32 v34, v173, v206
    ds_bpermute_b32 v35, v173, v207
    s_waitcnt vmcnt(24)
    s_waitcnt lgkmcnt(0)
    s_barrier
    s_mov_b32 s64, 1843200
    s_add_u32 m0, s70, 114688
    s_nop 0
    buffer_load_dwordx4 v168, s[20:23], s64 offen nt lds
    s_mov_b32 s64, 1873920
    s_add_u32 m0, s70, 118784
    s_nop 0
    buffer_load_dwordx4 v168, s[20:23], s64 offen nt lds
    s_mov_b32 s64, 1904640
    s_add_u32 m0, s70, 122880
    s_nop 0
    buffer_load_dwordx4 v168, s[20:23], s64 offen nt lds
    s_mov_b32 s64, 1935360
    s_add_u32 m0, s70, 126976
    s_nop 0
    buffer_load_dwordx4 v168, s[20:23], s64 offen nt lds
    ds_read_b64_tr_b16 v[204:205], v171 offset:0
    ds_read_b64_tr_b16 v[206:207], v171 offset:2048
    ds_read_b64_tr_b16 a[32:33], v169 offset:0
    ds_read_b64_tr_b16 a[34:35], v169 offset:2048
    ds_read_b64_tr_b16 a[112:113], v169 offset:160
    ds_read_b64_tr_b16 a[114:115], v169 offset:2208
    ds_read_b64_tr_b16 a[192:193], v169 offset:320
    ds_read_b64_tr_b16 a[194:195], v169 offset:2368
    s_waitcnt lgkmcnt(7)
    ds_bpermute_b32 v36, v173, v204
    ds_bpermute_b32 v37, v173, v205
    s_waitcnt lgkmcnt(8)
    ds_bpermute_b32 v38, v173, v206
    ds_bpermute_b32 v39, v173, v207
    s_waitcnt vmcnt(24)
    s_waitcnt lgkmcnt(0)
    s_barrier
    s_mov_b32 s64, 1966080
    s_add_u32 m0, s70, 0
    s_nop 0
    buffer_load_dwordx4 v168, s[20:23], s64 offen nt lds
    s_mov_b32 s64, 1996800
    s_add_u32 m0, s70, 4096
    s_nop 0
    buffer_load_dwordx4 v168, s[20:23], s64 offen nt lds
    s_mov_b32 s64, 2027520
    s_add_u32 m0, s70, 8192
    s_nop 0
    buffer_load_dwordx4 v168, s[20:23], s64 offen nt lds
    s_mov_b32 s64, 2058240
    s_add_u32 m0, s70, 12288
    s_nop 0
    buffer_load_dwordx4 v168, s[20:23], s64 offen nt lds
    ds_read_b64_tr_b16 v[204:205], v171 offset:16384
    ds_read_b64_tr_b16 v[206:207], v171 offset:18432
    ds_read_b64_tr_b16 a[36:37], v169 offset:16384
    ds_read_b64_tr_b16 a[38:39], v169 offset:18432
    ds_read_b64_tr_b16 a[116:117], v169 offset:16544
    ds_read_b64_tr_b16 a[118:119], v169 offset:18592
    ds_read_b64_tr_b16 a[196:197], v169 offset:16704
    ds_read_b64_tr_b16 a[198:199], v169 offset:18752
    s_waitcnt lgkmcnt(7)
    ds_bpermute_b32 v40, v173, v204
    ds_bpermute_b32 v41, v173, v205
    s_waitcnt lgkmcnt(8)
    ds_bpermute_b32 v42, v173, v206
    ds_bpermute_b32 v43, v173, v207
    s_waitcnt vmcnt(24)
    s_waitcnt lgkmcnt(0)
    s_barrier
    s_mov_b32 s64, 2088960
    s_add_u32 m0, s70, 16384
    s_nop 0
    buffer_load_dwordx4 v168, s[20:23], s64 offen nt lds
    s_mov_b32 s64, 2119680
    s_add_u32 m0, s70, 20480
    s_nop 0
    buffer_load_dwordx4 v168, s[20:23], s64 offen nt lds
    s_mov_b32 s64, 2150400
    s_add_u32 m0, s70, 24576
    s_nop 0
    buffer_load_dwordx4 v168, s[20:23], s64 offen nt lds
    s_mov_b32 s64, 2181120
    s_add_u32 m0, s70, 28672
    s_nop 0
    buffer_load_dwordx4 v168, s[20:23], s64 offen nt lds
    ds_read_b64_tr_b16 v[204:205], v171 offset:32768
    ds_read_b64_tr_b16 v[206:207], v171 offset:34816
    ds_read_b64_tr_b16 a[40:41], v169 offset:32768
    ds_read_b64_tr_b16 a[42:43], v169 offset:34816
    ds_read_b64_tr_b16 a[120:121], v169 offset:32928
    ds_read_b64_tr_b16 a[122:123], v169 offset:34976
    ds_read_b64_tr_b16 a[200:201], v169 offset:33088
    ds_read_b64_tr_b16 a[202:203], v169 offset:35136
    s_waitcnt lgkmcnt(7)
    ds_bpermute_b32 v44, v173, v204
    ds_bpermute_b32 v45, v173, v205
    s_waitcnt lgkmcnt(8)
    ds_bpermute_b32 v46, v173, v206
    ds_bpermute_b32 v47, v173, v207
    s_waitcnt vmcnt(24)
    s_waitcnt lgkmcnt(0)
    s_barrier
    s_mov_b32 s64, 2211840
    s_add_u32 m0, s70, 32768
    s_nop 0
    buffer_load_dwordx4 v168, s[20:23], s64 offen nt lds
    s_mov_b32 s64, 2242560
    s_add_u32 m0, s70, 36864
    s_nop 0
    buffer_load_dwordx4 v168, s[20:23], s64 offen nt lds
    s_mov_b32 s64, 2273280
    s_add_u32 m0, s70, 40960
    s_nop 0
    buffer_load_dwordx4 v168, s[20:23], s64 offen nt lds
    s_mov_b32 s64, 2304000
    s_add_u32 m0, s70, 45056
    s_nop 0
    buffer_load_dwordx4 v168, s[20:23], s64 offen nt lds
    ds_read_b64_tr_b16 v[204:205], v171 offset:49152
    ds_read_b64_tr_b16 v[206:207], v171 offset:51200
    ds_read_b64_tr_b16 a[44:45], v169 offset:49152
    ds_read_b64_tr_b16 a[46:47], v169 offset:51200
    ds_read_b64_tr_b16 a[124:125], v169 offset:49312
    ds_read_b64_tr_b16 a[126:127], v169 offset:51360
    ds_read_b64_tr_b16 a[204:205], v169 offset:49472
    ds_read_b64_tr_b16 a[206:207], v169 offset:51520
    s_waitcnt lgkmcnt(7)
    ds_bpermute_b32 v48, v173, v204
    ds_bpermute_b32 v49, v173, v205
    s_waitcnt lgkmcnt(8)
    ds_bpermute_b32 v50, v173, v206
    ds_bpermute_b32 v51, v173, v207
    s_waitcnt vmcnt(24)
    s_waitcnt lgkmcnt(0)
    s_barrier
    s_mov_b32 s64, 2334720
    s_add_u32 m0, s70, 49152
    s_nop 0
    buffer_load_dwordx4 v168, s[20:23], s64 offen nt lds
    s_mov_b32 s64, 2365440
    s_add_u32 m0, s70, 53248
    s_nop 0
    buffer_load_dwordx4 v168, s[20:23], s64 offen nt lds
    s_mov_b32 s64, 2396160
    s_add_u32 m0, s70, 57344
    s_nop 0
    buffer_load_dwordx4 v168, s[20:23], s64 offen nt lds
    s_mov_b32 s64, 2426880
    s_add_u32 m0, s70, 61440
    s_nop 0
    buffer_load_dwordx4 v168, s[20:23], s64 offen nt lds
    ds_read_b64_tr_b16 v[204:205], v172 offset:0
    ds_read_b64_tr_b16 v[206:207], v172 offset:2048
    ds_read_b64_tr_b16 a[48:49], v170 offset:0
    ds_read_b64_tr_b16 a[50:51], v170 offset:2048
    ds_read_b64_tr_b16 a[128:129], v170 offset:160
    ds_read_b64_tr_b16 a[130:131], v170 offset:2208
    ds_read_b64_tr_b16 a[208:209], v170 offset:320
    ds_read_b64_tr_b16 a[210:211], v170 offset:2368
    s_waitcnt lgkmcnt(7)
    ds_bpermute_b32 v52, v173, v204
    ds_bpermute_b32 v53, v173, v205
    s_waitcnt lgkmcnt(8)
    ds_bpermute_b32 v54, v173, v206
    ds_bpermute_b32 v55, v173, v207
    s_waitcnt vmcnt(24)
    s_waitcnt lgkmcnt(0)
    s_barrier
    ds_read_b64_tr_b16 v[204:205], v172 offset:16384
    ds_read_b64_tr_b16 v[206:207], v172 offset:18432
    ds_read_b64_tr_b16 a[52:53], v170 offset:16384
    ds_read_b64_tr_b16 a[54:55], v170 offset:18432
    ds_read_b64_tr_b16 a[132:133], v170 offset:16544
    ds_read_b64_tr_b16 a[134:135], v170 offset:18592
    ds_read_b64_tr_b16 a[212:213], v170 offset:16704
    ds_read_b64_tr_b16 a[214:215], v170 offset:18752
    s_waitcnt lgkmcnt(7)
    ds_bpermute_b32 v56, v173, v204
    ds_bpermute_b32 v57, v173, v205
    s_waitcnt lgkmcnt(8)
    ds_bpermute_b32 v58, v173, v206
    ds_bpermute_b32 v59, v173, v207
    s_waitcnt vmcnt(20)
    s_waitcnt lgkmcnt(0)
    s_barrier
    ds_read_b64_tr_b16 v[204:205], v172 offset:32768
    ds_read_b64_tr_b16 v[206:207], v172 offset:34816
    ds_read_b64_tr_b16 a[56:57], v170 offset:32768
    ds_read_b64_tr_b16 a[58:59], v170 offset:34816
    ds_read_b64_tr_b16 a[136:137], v170 offset:32928
    ds_read_b64_tr_b16 a[138:139], v170 offset:34976
    ds_read_b64_tr_b16 a[216:217], v170 offset:33088
    ds_read_b64_tr_b16 a[218:219], v170 offset:35136
    s_waitcnt lgkmcnt(7)
    ds_bpermute_b32 v60, v173, v204
    ds_bpermute_b32 v61, v173, v205
    s_waitcnt lgkmcnt(8)
    ds_bpermute_b32 v62, v173, v206
    ds_bpermute_b32 v63, v173, v207
    s_waitcnt vmcnt(16)
    s_waitcnt lgkmcnt(0)
    s_barrier
    ds_read_b64_tr_b16 v[204:205], v172 offset:49152
    ds_read_b64_tr_b16 v[206:207], v172 offset:51200
    ds_read_b64_tr_b16 a[60:61], v170 offset:49152
    ds_read_b64_tr_b16 a[62:63], v170 offset:51200
    ds_read_b64_tr_b16 a[140:141], v170 offset:49312
    ds_read_b64_tr_b16 a[142:143], v170 offset:51360
    ds_read_b64_tr_b16 a[220:221], v170 offset:49472
    ds_read_b64_tr_b16 a[222:223], v170 offset:51520
    s_waitcnt lgkmcnt(7)
    ds_bpermute_b32 v64, v173, v204
    ds_bpermute_b32 v65, v173, v205
    s_waitcnt lgkmcnt(8)
    ds_bpermute_b32 v66, v173, v206
    ds_bpermute_b32 v67, v173, v207
    s_waitcnt vmcnt(12)
    s_waitcnt lgkmcnt(0)
    s_barrier
    ds_read_b64_tr_b16 v[204:205], v171 offset:0
    ds_read_b64_tr_b16 v[206:207], v171 offset:2048
    ds_read_b64_tr_b16 a[64:65], v169 offset:0
    ds_read_b64_tr_b16 a[66:67], v169 offset:2048
    ds_read_b64_tr_b16 a[144:145], v169 offset:160
    ds_read_b64_tr_b16 a[146:147], v169 offset:2208
    ds_read_b64_tr_b16 a[224:225], v169 offset:320
    ds_read_b64_tr_b16 a[226:227], v169 offset:2368
    s_waitcnt lgkmcnt(7)
    ds_bpermute_b32 v68, v173, v204
    ds_bpermute_b32 v69, v173, v205
    s_waitcnt lgkmcnt(8)
    ds_bpermute_b32 v70, v173, v206
    ds_bpermute_b32 v71, v173, v207
    s_waitcnt vmcnt(8)
    s_waitcnt lgkmcnt(0)
    s_barrier
    ds_read_b64_tr_b16 v[204:205], v171 offset:16384
    ds_read_b64_tr_b16 v[206:207], v171 offset:18432
    ds_read_b64_tr_b16 a[68:69], v169 offset:16384
    ds_read_b64_tr_b16 a[70:71], v169 offset:18432
    ds_read_b64_tr_b16 a[148:149], v169 offset:16544
    ds_read_b64_tr_b16 a[150:151], v169 offset:18592
    ds_read_b64_tr_b16 a[228:229], v169 offset:16704
    ds_read_b64_tr_b16 a[230:231], v169 offset:18752
    s_waitcnt lgkmcnt(7)
    ds_bpermute_b32 v72, v173, v204
    ds_bpermute_b32 v73, v173, v205
    s_waitcnt lgkmcnt(8)
    ds_bpermute_b32 v74, v173, v206
    ds_bpermute_b32 v75, v173, v207
    s_waitcnt vmcnt(4)
    s_waitcnt lgkmcnt(0)
    s_barrier
    ds_read_b64_tr_b16 v[204:205], v171 offset:32768
    ds_read_b64_tr_b16 v[206:207], v171 offset:34816
    ds_read_b64_tr_b16 a[72:73], v169 offset:32768
    ds_read_b64_tr_b16 a[74:75], v169 offset:34816
    ds_read_b64_tr_b16 a[152:153], v169 offset:32928
    ds_read_b64_tr_b16 a[154:155], v169 offset:34976
    ds_read_b64_tr_b16 a[232:233], v169 offset:33088
    ds_read_b64_tr_b16 a[234:235], v169 offset:35136
    s_waitcnt lgkmcnt(7)
    ds_bpermute_b32 v76, v173, v204
    ds_bpermute_b32 v77, v173, v205
    s_waitcnt lgkmcnt(8)
    ds_bpermute_b32 v78, v173, v206
    ds_bpermute_b32 v79, v173, v207
    s_waitcnt vmcnt(0)
    s_waitcnt lgkmcnt(0)
    s_barrier
    ds_read_b64_tr_b16 v[204:205], v171 offset:49152
    ds_read_b64_tr_b16 v[206:207], v171 offset:51200
    ds_read_b64_tr_b16 a[76:77], v169 offset:49152
    ds_read_b64_tr_b16 a[78:79], v169 offset:51200
    ds_read_b64_tr_b16 a[156:157], v169 offset:49312
    ds_read_b64_tr_b16 a[158:159], v169 offset:51360
    ds_read_b64_tr_b16 a[236:237], v169 offset:49472
    ds_read_b64_tr_b16 a[238:239], v169 offset:51520
    s_waitcnt lgkmcnt(7)
    ds_bpermute_b32 v80, v173, v204
    ds_bpermute_b32 v81, v173, v205
    s_waitcnt lgkmcnt(8)
    ds_bpermute_b32 v82, v173, v206
    ds_bpermute_b32 v83, v173, v207
    s_waitcnt lgkmcnt(0)
    s_barrier
    v_lshlrev_b32 v168, 4, v0
    s_mul_i32 s64, s76, 102400
    s_add_u32 s65, s64, 102400
    s_mov_b32 m0, s70
Lstgb_69:
    s_nop 0
    buffer_load_dwordx4 v168, s[24:27], s64 offen nt lds
    s_add_u32 m0, m0, 4096
    s_add_u32 s64, s64, 4096
    s_cmp_lt_u32 s64, s65
    s_cbranch_scc1 Lstgb_69
    v_lshl_add_u32 v169, v176, 2, v177
    v_mul_u32_u24 v169, 1280, v169
    v_mul_u32_u24 v171, 20, v177
    v_add3_u32 v171, v171, v176, 16
    v_mul_u32_u24 v171, 1280, v171
    s_lshl_b32 s64, s60, 6
    v_lshl_add_u32 v173, v178, 3, s64
    v_add_u32 v170, v169, v173
    v_add_u32 v172, v171, v173
    v_lshl_add_u32 v169, v173, 1, v169
    v_lshl_add_u32 v171, v173, 1, v171
    v_add_u32 v174, 51200, v169
    v_add_u32 v175, 51200, v170
    s_waitcnt vmcnt(0)
    s_barrier
    ds_read_b64_tr_b16 v[84:85], v169 offset:0
    ds_read_b64_tr_b16 v[86:87], v169 offset:25600
    ds_read_b64_tr_b16 v[88:89], v174 offset:0
    ds_read_b64_tr_b16 v[90:91], v174 offset:25600
    ds_read_b64_tr_b16 a[240:241], v171 offset:0
    ds_read_b64_tr_b16 v[92:93], v169 offset:8
    ds_read_b64_tr_b16 v[94:95], v169 offset:25608
    ds_read_b64_tr_b16 v[96:97], v174 offset:8
    ds_read_b64_tr_b16 v[98:99], v174 offset:25608
    ds_read_b64_tr_b16 a[242:243], v171 offset:8
    ds_read_b64_tr_b16 v[100:101], v169 offset:512
    ds_read_b64_tr_b16 v[102:103], v169 offset:26112
    ds_read_b64_tr_b16 v[104:105], v174 offset:512
    ds_read_b64_tr_b16 v[106:107], v174 offset:26112
    ds_read_b64_tr_b16 a[244:245], v171 offset:512
    ds_read_b64_tr_b16 v[108:109], v169 offset:520
    ds_read_b64_tr_b16 v[110:111], v169 offset:26120
    ds_read_b64_tr_b16 v[112:113], v174 offset:520
    ds_read_b64_tr_b16 v[114:115], v174 offset:26120
    ds_read_b64_tr_b16 a[246:247], v171 offset:520
    ds_read_b64_tr_b16 v[116:117], v170 offset:1024
    ds_read_b64_tr_b16 v[118:119], v170 offset:26624
    ds_read_b64_tr_b16 v[120:121], v175 offset:1024
    ds_read_b64_tr_b16 v[122:123], v175 offset:26624
    ds_read_b64_tr_b16 a[248:249], v172 offset:1024
    ds_read_b64_tr_b16 v[124:125], v169 offset:64
    ds_read_b64_tr_b16 v[126:127], v169 offset:25664
    ds_read_b64_tr_b16 v[128:129], v174 offset:64
    ds_read_b64_tr_b16 v[130:131], v174 offset:25664
    ds_read_b64_tr_b16 a[250:251], v171 offset:64
    ds_read_b64_tr_b16 v[132:133], v169 offset:72
    ds_read_b64_tr_b16 v[134:135], v169 offset:25672
    ds_read_b64_tr_b16 v[136:137], v174 offset:72
    ds_read_b64_tr_b16 v[138:139], v174 offset:25672
    ds_read_b64_tr_b16 a[252:253], v171 offset:72
    ds_read_b64_tr_b16 v[140:141], v169 offset:576
    ds_read_b64_tr_b16 v[142:143], v169 offset:26176
    ds_read_b64_tr_b16 v[144:145], v174 offset:576
    ds_read_b64_tr_b16 v[146:147], v174 offset:26176
    ds_read_b64_tr_b16 a[254:255], v171 offset:576
    ds_read_b64_tr_b16 v[148:149], v169 offset:584
    ds_read_b64_tr_b16 v[150:151], v169 offset:26184
    ds_read_b64_tr_b16 v[152:153], v174 offset:584
    ds_read_b64_tr_b16 v[154:155], v174 offset:26184
    ds_read_b64_tr_b16 v[164:165], v171 offset:584
    ds_read_b64_tr_b16 v[156:157], v170 offset:1056
    ds_read_b64_tr_b16 v[158:159], v170 offset:26656
    ds_read_b64_tr_b16 v[160:161], v175 offset:1056
    ds_read_b64_tr_b16 v[162:163], v175 offset:26656
    ds_read_b64_tr_b16 v[166:167], v172 offset:1056
    s_waitcnt lgkmcnt(0)
    s_barrier
    v_and_b32 v179, 7, v1
    v_bfe_u32 v180, v1, 3, 1
    v_lshlrev_b32 v244, 4, v0
    v_lshlrev_b32 v255, 3, v1
    v_mul_u32_u24 v245, 10240, v180
    v_lshl_add_u32 v245, v179, 7, v245
    v_xor_b32 v181, v176, v179
    v_lshl_add_u32 v245, v181, 4, v245
    v_xor_b32 v246, 64, v245
    v_and_b32 v168, 15, v1
    v_lshlrev_b32 v181, 2, v176
    v_cmp_eq_u32 vcc, v168, v181
    s_nop 1
    v_cndmask_b32 v242, 0, 1.0, vcc
    v_mov_b32 v182, 0x3f803f80
    v_cmp_eq_u32 vcc, 1, v178
    s_nop 1
    v_cndmask_b32 v243, 0, v182, vcc
    v_sub_u32 v181, v168, v181
    v_mov_b32 v182, 0xff800000
    v_add_u32 v169, 16, v181
    v_and_b32 v169, 0xfffffff1, v169
    v_cmp_eq_u32 vcc, 0, v169
    s_nop 1
    v_cndmask_b32 v204, v182, 0, vcc
    v_add_u32 v169, 15, v181
    v_and_b32 v169, 0xfffffff1, v169
    v_cmp_eq_u32 vcc, 0, v169
    s_nop 1
    v_cndmask_b32 v205, v182, 0, vcc
    v_add_u32 v169, 14, v181
    v_and_b32 v169, 0xfffffff1, v169
    v_cmp_eq_u32 vcc, 0, v169
    s_nop 1
    v_cndmask_b32 v206, v182, 0, vcc
    v_add_u32 v169, 13, v181
    v_and_b32 v169, 0xfffffff1, v169
    v_cmp_eq_u32 vcc, 0, v169
    s_nop 1
    v_cndmask_b32 v207, v182, 0, vcc
    v_add_u32 v169, 0, v181
    v_and_b32 v169, 0xfffffff1, v169
    v_cmp_eq_u32 vcc, 0, v169
    s_nop 1
    v_cndmask_b32 v208, v182, 0, vcc
    v_add_u32 v169, -1, v181
    v_and_b32 v169, 0xfffffff1, v169
    v_cmp_eq_u32 vcc, 0, v169
    s_nop 1
    v_cndmask_b32 v209, v182, 0, vcc
    v_add_u32 v169, -2, v181
    v_and_b32 v169, 0xfffffff1, v169
    v_cmp_eq_u32 vcc, 0, v169
    s_nop 1
    v_cndmask_b32 v210, v182, 0, vcc
    v_add_u32 v169, -3, v181
    v_and_b32 v169, 0xfffffff1, v169
    v_cmp_eq_u32 vcc, 0, v169
    s_nop 1
    v_cndmask_b32 v211, v182, 0, vcc
    v_mov_b32 v212, v182
    v_mov_b32 v213, v182
    v_mov_b32 v214, v182
    v_mov_b32 v215, v182
    v_mov_b32 v220, 0
    v_mov_b32 v221, 0
    v_mov_b32 v222, 0
    v_mov_b32 v223, 0
    v_mov_b32 v224, 0
    v_mov_b32 v225, 0
    v_mov_b32 v226, 0
    v_mov_b32 v227, 0
    v_mov_b32 v228, 0
    v_mov_b32 v229, 0
    v_mov_b32 v230, 0
    v_mov_b32 v231, 0
    v_mov_b32 v232, 0
    v_mov_b32 v233, 0
    v_mov_b32 v234, 0
    v_mov_b32 v235, 0
    v_mov_b32 v236, 0
    v_mov_b32 v237, 0
    v_mov_b32 v238, 0
    v_mov_b32 v239, 0
    ds_write_b128 v247, v[204:207] offset:5120
    ds_write_b128 v247, v[208:211] offset:6144
    ds_write_b128 v247, v[212:215] offset:7168
    v_add_u32 v248, 2048, v247
    s_lshr_b32 s64, s60, 1
    s_lshl_b32 s64, s64, 10
    s_and_b32 s65, s60, 1
    s_lshl_b32 s65, s65, 3
    s_add_u32 s64, s64, s65
    v_add_u32 v249, s64, v247
    s_lshl_b32 s64, s60, 1
    v_lshl_add_u32 v250, v1, 3, s64
    v_lshlrev_b32 v252, 5, v168
    v_lshl_add_u32 v252, v176, 3, v252
    v_lshlrev_b32 v251, 1, v252
    s_lshl_b32 s64, s60, 11
    v_add_u32 v251, s64, v251
    s_add_u32 s64, s64, 65536
    v_add_u32 v252, s64, v252
    s_lshl_b32 s71, s68, 23
    s_add_u32 s71, s71, 33554432
    s_mul_i32 s72, s76, 81920
    s_add_u32 s72, s72, 142606336
    s_lshl_b32 s74, s60, 10
    s_mov_b32 s77, 0x3ea52b5c
    s_mov_b32 s75, 0
    s_cmp_lg_u32 s60, 0
    s_cbranch_scc1 Lgskip_72
    buffer_load_dword v2, off, s[8:11], 0 offset:132 sc1
Lgchk_70:
    s_waitcnt vmcnt(0)
    v_cmp_eq_u32 vcc, 0, v2
    s_cbranch_vccnz Lgrty_71
Lgskip_72:
    s_waitcnt lgkmcnt(0)
    s_barrier
    buffer_load_dword v2, off, s[8:11], 0 offset:140 sc1
Lpchk_73:
    s_waitcnt vmcnt(0)
    v_cmp_eq_u32 vcc, 0, v2
    s_cbranch_vccnz Lprty_74
    v_readfirstlane_b32 s1, v2
    s_cmp_gt_u32 s1, 17
    s_cselect_b32 s1, 1, 0
    s_xor_b32 s1, s1, s68
    s_lshl_b32 s1, s1, 13
    s_lshl_b32 s63, s58, 18
    s_and_b32 s64, s3, 0xfff
    s_add_u32 s63, s63, s64
    s_add_u32 s63, s63, 14819328
    s_xor_b32 s63, s63, s1
    v_and_b32 v253, 3, v0
    v_mov_b32 v181, 30
    v_lshl_add_u32 v253, v181, 2, v253
    v_lshlrev_b32 v253, 7, v253
    v_bfe_u32 v181, v0, 4, 2
    v_cmp_eq_u32 vcc, s69, v181
    s_xor_b32 s64, s1, 0x2000
    s_add_u32 s64, s64, 14798848
    v_lshl_add_u32 v181, v181, 18, s64
    s_lshl_b32 s64, s68, 20
    v_add_u32 v181, s64, v181
    s_lshl_b32 s64, s58, 14
    s_add_u32 s64, s64, 8388608
    v_mov_b32 v2, s64
    v_cndmask_b32 v181, v181, v2, vcc
    v_add_u32 v253, v253, v181
    s_lshr_b32 s70, s71, 8
    s_xor_b32 s70, s70, s1
    s_and_b32 s70, s70, 0x2000
    s_or_b32 s70, s70, s71
    s_mov_b32 s80, 0
    s_lshl_b32 s64, s60, 2
    v_mov_b32 v3, s64
    v_and_b32 v1, 12, v1
L_Bh0:
    s_cmp_lg_u32 s75, 0
    s_cbranch_scc1 L_Bhave0
    buffer_load_dword v254, v253, s[4:7], 0 offen sc1
    s_waitcnt vmcnt(0)
    s_cmp_eq_u32 s80, 0
    s_cbranch_scc1 Lowed_75
    s_waitcnt vmcnt(0)
    v_mov_b32 v2, s62
    s_mov_b64 exec, 1
    buffer_store_dword v2, off, s[4:7], s63 sc1
    buffer_store_dword v2, off, s[4:7], s3
    s_mov_b64 exec, -1
    s_mov_b32 s80, 0
Lowed_75:
    s_add_u32 s65, s62, 1
Lfchk_76:
    v_cmp_gt_u32 vcc, s65, v254
    s_cbranch_vccnz Lfrty_77
    s_add_u32 m0, s74, 8192
    s_add_u32 s64, s70, 0
    buffer_load_dwordx4 v244, s[4:7], s64 offen sc1 lds
    s_add_u32 m0, s74, 12288
    s_add_u32 s64, s70, 4096
    buffer_load_dwordx4 v244, s[4:7], s64 offen sc1 lds
    s_add_u32 m0, s74, 16384
    s_add_u32 s64, s70, 16384
    buffer_load_dwordx4 v244, s[4:7], s64 offen sc1 lds
    s_add_u32 m0, s74, 20480
    s_add_u32 s64, s70, 20480
    buffer_load_dwordx4 v244, s[4:7], s64 offen sc1 lds
    s_add_u32 m0, s74, 24576
    s_add_u32 s64, s70, 32768
    buffer_load_dwordx4 v244, s[4:7], s64 offen sc1 lds
    s_waitcnt vmcnt(0)
L_Bhave0:
    s_waitcnt vmcnt(6) lgkmcnt(0)
    s_barrier
    s_mov_b32 s75, 0
    ds_read_b128 v[204:207], v245 offset:8192
    ds_read_b128 v[208:211], v246 offset:8192
    s_waitcnt lgkmcnt(1)
    v_mfma_f32_16x16x32_bf16 v[180:183], v[4:7], v[204:207], 0
    ds_read_b128 v[212:215], v245 offset:9216
    v_mfma_f32_16x16x32_bf16 v[168:171], a[0:3], v[204:207], 0
    v_mfma_f32_16x16x32_bf16 v[172:175], a[80:83], v[204:207], 0
    v_mfma_f32_16x16x32_bf16 v[176:179], v[204:207], a[160:163], 0
    s_waitcnt lgkmcnt(1)
    v_mfma_f32_16x16x32_bf16 v[180:183], v[8:11], v[208:211], v[180:183]
    ds_read_b128 v[204:207], v246 offset:9216
    v_mfma_f32_16x16x32_bf16 v[168:171], a[4:7], v[208:211], v[168:171]
    v_mfma_f32_16x16x32_bf16 v[172:175], a[84:87], v[208:211], v[172:175]
    v_mfma_f32_16x16x32_bf16 v[176:179], v[208:211], a[164:167], v[176:179]
    s_waitcnt lgkmcnt(1)
    v_mfma_f32_16x16x32_bf16 v[180:183], v[12:15], v[212:215], v[180:183]
    ds_read_b128 v[208:211], v245 offset:10240
    buffer_load_dword v254, v253, s[4:7], 0 offen sc1
    v_mfma_f32_16x16x32_bf16 v[168:171], a[8:11], v[212:215], v[168:171]
    v_mfma_f32_16x16x32_bf16 v[172:175], a[88:91], v[212:215], v[172:175]
    v_mfma_f32_16x16x32_bf16 v[176:179], v[212:215], a[168:171], v[176:179]
    s_waitcnt lgkmcnt(1)
    v_mfma_f32_16x16x32_bf16 v[180:183], v[16:19], v[204:207], v[180:183]
    ds_read_b128 v[212:215], v246 offset:10240
    v_mfma_f32_16x16x32_bf16 v[168:171], a[12:15], v[204:207], v[168:171]
    v_mfma_f32_16x16x32_bf16 v[172:175], a[92:95], v[204:207], v[172:175]
    v_mfma_f32_16x16x32_bf16 v[176:179], v[204:207], a[172:175], v[176:179]
    s_waitcnt lgkmcnt(1)
    v_mfma_f32_16x16x32_bf16 v[180:183], v[20:23], v[208:211], v[180:183]
    ds_read_b128 v[204:207], v245 offset:11264
    v_mfma_f32_16x16x32_bf16 v[168:171], a[16:19], v[208:211], v[168:171]
    v_mfma_f32_16x16x32_bf16 v[172:175], a[96:99], v[208:211], v[172:175]
    v_mfma_f32_16x16x32_bf16 v[176:179], v[208:211], a[176:179], v[176:179]
    s_waitcnt lgkmcnt(1)
    v_mfma_f32_16x16x32_bf16 v[180:183], v[24:27], v[212:215], v[180:183]
    ds_read_b128 v[208:211], v246 offset:11264
    v_mfma_f32_16x16x32_bf16 v[168:171], a[20:23], v[212:215], v[168:171]
    v_mfma_f32_16x16x32_bf16 v[172:175], a[100:103], v[212:215], v[172:175]
    v_mfma_f32_16x16x32_bf16 v[176:179], v[212:215], a[180:183], v[176:179]
    s_waitcnt lgkmcnt(1)
    v_mfma_f32_16x16x32_bf16 v[180:183], v[28:31], v[204:207], v[180:183]
    ds_read_b128 v[212:215], v245 offset:12288
    v_mfma_f32_16x16x32_bf16 v[168:171], a[24:27], v[204:207], v[168:171]
    v_mfma_f32_16x16x32_bf16 v[172:175], a[104:107], v[204:207], v[172:175]
    v_mfma_f32_16x16x32_bf16 v[176:179], v[204:207], a[184:187], v[176:179]
    s_waitcnt lgkmcnt(1)
    v_mfma_f32_16x16x32_bf16 v[180:183], v[32:35], v[208:211], v[180:183]
    ds_read_b128 v[204:207], v246 offset:12288
    v_mfma_f32_16x16x32_bf16 v[168:171], a[28:31], v[208:211], v[168:171]
    v_mfma_f32_16x16x32_bf16 v[172:175], a[108:111], v[208:211], v[172:175]
    v_mfma_f32_16x16x32_bf16 v[176:179], v[208:211], a[188:191], v[176:179]
    s_waitcnt lgkmcnt(1)
    v_mfma_f32_16x16x32_bf16 v[180:183], v[36:39], v[212:215], v[180:183]
    ds_read_b128 v[208:211], v245 offset:13312
    v_mfma_f32_16x16x32_bf16 v[168:171], a[32:35], v[212:215], v[168:171]
    v_mfma_f32_16x16x32_bf16 v[172:175], a[112:115], v[212:215], v[172:175]
    v_mfma_f32_16x16x32_bf16 v[176:179], v[212:215], a[192:195], v[176:179]
    s_waitcnt lgkmcnt(1)
    v_mfma_f32_16x16x32_bf16 v[180:183], v[40:43], v[204:207], v[180:183]
    ds_read_b128 v[212:215], v246 offset:13312
    v_mfma_f32_16x16x32_bf16 v[168:171], a[36:39], v[204:207], v[168:171]
    v_mfma_f32_16x16x32_bf16 v[172:175], a[116:119], v[204:207], v[172:175]
    v_mfma_f32_16x16x32_bf16 v[176:179], v[204:207], a[196:199], v[176:179]
    s_waitcnt vmcnt(0)
    s_cmp_eq_u32 s80, 0
    s_cbranch_scc1 Lowed_78
    s_waitcnt vmcnt(0)
    v_mov_b32 v2, s62
    s_mov_b64 exec, 1
    buffer_store_dword v2, off, s[4:7], s63 sc1
    buffer_store_dword v2, off, s[4:7], s3
    s_mov_b64 exec, -1
    s_mov_b32 s80, 0
Lowed_78:
    s_add_u32 s65, s62, s75
    s_add_u32 s65, s65, 2
    v_cmp_gt_u32 vcc, s65, v254
    s_cbranch_vccz Lpre_79
    s_waitcnt lgkmcnt(1)
    v_mfma_f32_16x16x32_bf16 v[180:183], v[44:47], v[208:211], v[180:183]
    ds_read_b128 v[204:207], v245 offset:14336
    ds_read_b128 v[184:187], v248 offset:5120
    v_mfma_f32_16x16x32_bf16 v[168:171], a[40:43], v[208:211], v[168:171]
    ds_read_b128 v[188:191], v247 offset:6144
    v_mfma_f32_16x16x32_bf16 v[172:175], a[120:123], v[208:211], v[172:175]
    v_mfma_f32_16x16x32_bf16 v[176:179], v[208:211], a[200:203], v[176:179]
    s_waitcnt lgkmcnt(3)
    v_mfma_f32_16x16x32_bf16 v[180:183], v[48:51], v[212:215], v[180:183]
    ds_read_b128 v[208:211], v246 offset:14336
    v_mfma_f32_16x16x32_bf16 v[168:171], a[44:47], v[212:215], v[168:171]
    v_mfma_f32_16x16x32_bf16 v[172:175], a[124:127], v[212:215], v[172:175]
    v_mfma_f32_16x16x32_bf16 v[176:179], v[212:215], a[204:207], v[176:179]
    s_waitcnt lgkmcnt(3)
    v_mfma_f32_16x16x32_bf16 v[180:183], v[52:55], v[204:207], v[180:183]
    ds_read_b128 v[212:215], v245 offset:15360
    v_mfma_f32_16x16x32_bf16 v[168:171], a[48:51], v[204:207], v[168:171]
    v_mfma_f32_16x16x32_bf16 v[172:175], a[128:131], v[204:207], v[172:175]
    v_mfma_f32_16x16x32_bf16 v[176:179], v[204:207], a[208:211], v[176:179]
    s_waitcnt lgkmcnt(1)
    v_mfma_f32_16x16x32_bf16 v[180:183], v[56:59], v[208:211], v[180:183]
    ds_read_b128 v[204:207], v246 offset:15360
    v_mfma_f32_16x16x32_bf16 v[168:171], a[52:55], v[208:211], v[168:171]
    v_mfma_f32_16x16x32_bf16 v[172:175], a[132:135], v[208:211], v[172:175]
    v_mfma_f32_16x16x32_bf16 v[176:179], v[208:211], a[212:215], v[176:179]
    s_waitcnt lgkmcnt(1)
    v_mfma_f32_16x16x32_bf16 v[180:183], v[60:63], v[212:215], v[180:183]
    ds_read_b128 v[208:211], v245 offset:16384
    v_mfma_f32_16x16x32_bf16 v[168:171], a[56:59], v[212:215], v[168:171]
    v_mfma_f32_16x16x32_bf16 v[172:175], a[136:139], v[212:215], v[172:175]
    v_mfma_f32_16x16x32_bf16 v[176:179], v[212:215], a[216:219], v[176:179]
    s_waitcnt lgkmcnt(1)
    v_mfma_f32_16x16x32_bf16 v[180:183], v[64:67], v[204:207], v[180:183]
    ds_read_b128 v[212:215], v246 offset:16384
    v_mfma_f32_16x16x32_bf16 v[168:171], a[60:63], v[204:207], v[168:171]
    v_mfma_f32_16x16x32_bf16 v[172:175], a[140:143], v[204:207], v[172:175]
    v_mfma_f32_16x16x32_bf16 v[176:179], v[204:207], a[220:223], v[176:179]
    s_waitcnt lgkmcnt(1)
    v_mfma_f32_16x16x32_bf16 v[180:183], v[68:71], v[208:211], v[180:183]
    ds_read_b128 v[204:207], v245 offset:17408
    v_mfma_f32_16x16x32_bf16 v[168:171], a[64:67], v[208:211], v[168:171]
    v_mfma_f32_16x16x32_bf16 v[172:175], a[144:147], v[208:211], v[172:175]
    v_mfma_f32_16x16x32_bf16 v[176:179], v[208:211], a[224:227], v[176:179]
    s_waitcnt lgkmcnt(1)
    v_mfma_f32_16x16x32_bf16 v[180:183], v[72:75], v[212:215], v[180:183]
    ds_read_b128 v[208:211], v246 offset:17408
    v_mfma_f32_16x16x32_bf16 v[168:171], a[68:71], v[212:215], v[168:171]
    v_mfma_f32_16x16x32_bf16 v[172:175], a[148:151], v[212:215], v[172:175]
    v_mfma_f32_16x16x32_bf16 v[176:179], v[212:215], a[228:231], v[176:179]
    s_waitcnt lgkmcnt(1)
    v_mfma_f32_16x16x32_bf16 v[180:183], v[76:79], v[204:207], v[180:183]
    v_mfma_f32_16x16x32_bf16 v[168:171], a[72:75], v[204:207], v[168:171]
    v_mfma_f32_16x16x32_bf16 v[172:175], a[152:155], v[204:207], v[172:175]
    v_mfma_f32_16x16x32_bf16 v[176:179], v[204:207], a[232:235], v[176:179]
    s_waitcnt lgkmcnt(0)
    v_mfma_f32_16x16x32_bf16 v[180:183], v[80:83], v[208:211], v[180:183]
    s_nop 2
    v_mfma_f32_16x16x32_bf16 v[168:171], a[76:79], v[208:211], v[168:171]
    s_nop 2
    v_mfma_f32_16x16x32_bf16 v[172:175], a[156:159], v[208:211], v[172:175]
    s_nop 2
    v_mfma_f32_16x16x32_bf16 v[176:179], v[208:211], a[236:239], v[176:179]
Lback_80:
    s_waitcnt vmcnt(0)
L_Be0:
    v_mov_b32 v2, s75
    ds_write_b32 v3, v2 offset:2560
    buffer_load_dword v254, v253, s[4:7], 0 offen sc1
    v_mfma_f32_16x16x4_f32 v[192:195], v182, v242, 0
    v_cvt_pk_bf16_f32 v222, v180, 0
    v_cvt_pk_bf16_f32 v226, v181, 0
    v_cvt_pk_bf16_f32 v220, v168, v169
    v_cvt_pk_bf16_f32 v221, v170, v171
    v_mov_b32 v223, 0
    v_cvt_pk_bf16_f32 v224, v172, v173
    v_cvt_pk_bf16_f32 v225, v174, v175
    s_waitcnt lgkmcnt(0)
    s_barrier
    ds_read_b32 v2, v1 offset:2560
    v_mfma_f32_16x16x32_bf16 v[184:187], v[228:231], v[220:223], v[184:187]
    v_cvt_pk_bf16_f32 v234, v176, v177
    v_cvt_pk_bf16_f32 v235, v178, v179
    v_mfma_f32_16x16x32_bf16 v[188:191], v[224:227], v[220:223], v[188:191]
    s_lshr_b32 s73, s72, 8
    s_xor_b32 s73, s73, s1
    s_and_b32 s73, s73, 0x2000
    s_or_b32 s73, s73, s72
    s_add_u32 s72, s72, 1048576
    s_add_u32 s78, s73, 0
    s_add_u32 s79, s73, 32768
    v_mov_b32 v248, v247
    v_cvt_pk_bf16_f32 v238, v192, v193
    v_cvt_pk_bf16_f32 v239, v194, v195
    v_or_b32 v238, v243, v238
    v_or_b32 v239, v243, v239
    s_waitcnt lgkmcnt(0)
    v_cmp_eq_u32 vcc, 0, v2
    s_cbranch_vccz L_Bi0
    v_max3_f32 v192, v184, v185, v186
    v_max3_f32 v193, v188, v189, v190
    v_max3_f32 v192, v192, v187, v191
    v_max_f32 v192, v192, v193
    v_mov_b32 v193, v192
    s_nop 1
    v_permlane16_swap_b32 v192, v193
    v_max_f32 v192, v192, v193
    v_mov_b32 v193, v192
    s_nop 1
    v_permlane32_swap_b32 v192, v193
    v_max_f32 v192, v192, v193
    v_mul_f32 v192, s77, v192
    v_fma_f32 v184, v184, s77, -v192
    v_fma_f32 v185, v185, s77, -v192
    v_fma_f32 v186, v186, s77, -v192
    v_fma_f32 v187, v187, s77, -v192
    v_fma_f32 v188, v188, s77, -v192
    v_fma_f32 v189, v189, s77, -v192
    v_fma_f32 v190, v190, s77, -v192
    v_fma_f32 v191, v191, s77, -v192
    v_exp_f32 v184, v184
    v_exp_f32 v185, v185
    v_exp_f32 v186, v186
    v_exp_f32 v187, v187
    v_exp_f32 v188, v188
    v_exp_f32 v189, v189
    v_exp_f32 v190, v190
    v_exp_f32 v191, v191
    v_cvt_pk_bf16_f32 v184, v184, v185
    v_cvt_pk_bf16_f32 v185, v186, v187
    v_cvt_pk_bf16_f32 v186, v188, v189
    v_cvt_pk_bf16_f32 v187, v190, v191
    s_nop 1
    v_mfma_f32_16x16x32_bf16 v[200:203], v[236:239], v[184:187], 0
    s_nop 2
    v_mfma_f32_16x16x32_bf16 v[196:199], v[232:235], v[184:187], 0
    s_nop 3
    v_rcp_f32 v201, v201
    s_nop 0
    v_mul_f32 v200, v200, v201
    s_nop 0
    v_mul_f32 v196, v196, v201
    v_mul_f32 v197, v197, v201
    v_mul_f32 v198, v198, v201
    v_mul_f32 v199, v199, v201
    v_cvt_pk_bf16_f32 v200, v200, v200
    v_cvt_pk_bf16_f32 v196, v196, v197
    v_cvt_pk_bf16_f32 v197, v198, v199
    ds_write_b16 v250, v200 offset:2048
    ds_write_b64 v249, v[196:197] offset:0
    s_waitcnt lgkmcnt(0)
    s_barrier
    ds_read_b64 v[240:241], v255 offset:2048
    ds_read_b128 v[220:223], v247 offset:0
    ds_read_b128 v[216:219], v247 offset:1024
    s_waitcnt vmcnt(0)
    s_cmp_eq_u32 s80, 0
    s_cbranch_scc1 Lowed_81
    s_waitcnt vmcnt(0)
    v_mov_b32 v2, s62
    s_mov_b64 exec, 1
    buffer_store_dword v2, off, s[4:7], s63 sc1
    buffer_store_dword v2, off, s[4:7], s3
    s_mov_b64 exec, -1
    s_mov_b32 s80, 0
Lowed_81:
    s_add_u32 s65, s62, s75
    s_add_u32 s65, s65, 2
    v_cmp_gt_u32 vcc, s65, v254
    s_cbranch_vccz Lpre_82
    s_waitcnt lgkmcnt(2)
    v_mfma_f32_16x16x16_bf16 v[168:171], a[240:241], v[240:241], 0
    v_mfma_f32_16x16x16_bf16 v[172:175], a[242:243], v[240:241], 0
    v_mfma_f32_16x16x16_bf16 v[176:179], a[244:245], v[240:241], 0
    v_mfma_f32_16x16x16_bf16 v[180:183], a[246:247], v[240:241], 0
    v_mfma_f32_16x16x16_bf16 v[204:207], a[248:249], v[240:241], 0
    v_mfma_f32_16x16x16_bf16 v[184:187], a[250:251], v[240:241], 0
    v_mfma_f32_16x16x16_bf16 v[188:191], a[252:253], v[240:241], 0
    v_mfma_f32_16x16x16_bf16 v[192:195], a[254:255], v[240:241], 0
    v_mfma_f32_16x16x16_bf16 v[196:199], v[164:165], v[240:241], 0
    v_mfma_f32_16x16x16_bf16 v[200:203], v[166:167], v[240:241], 0
Lback_83:
    s_waitcnt lgkmcnt(1)
    v_mfma_f32_16x16x32_bf16 v[168:171], v[84:87], v[220:223], v[168:171]
    v_mfma_f32_16x16x32_bf16 v[172:175], v[92:95], v[220:223], v[172:175]
    s_waitcnt lgkmcnt(0)
    v_mfma_f32_16x16x32_bf16 v[168:171], v[88:91], v[216:219], v[168:171]
    s_nop 2
    v_mfma_f32_16x16x32_bf16 v[172:175], v[96:99], v[216:219], v[172:175]
    s_nop 2
    v_mfma_f32_16x16x32_bf16 v[176:179], v[100:103], v[220:223], v[176:179]
    v_cvt_pk_bf16_f32 v168, v168, v169
    v_cvt_pk_bf16_f32 v169, v170, v171
    v_mfma_f32_16x16x32_bf16 v[180:183], v[108:111], v[220:223], v[180:183]
    s_nop 0
    v_cvt_pk_bf16_f32 v170, v172, v173
    v_cvt_pk_bf16_f32 v171, v174, v175
    v_mfma_f32_16x16x32_bf16 v[176:179], v[104:107], v[216:219], v[176:179]
    buffer_store_dwordx4 v[168:171], v251, s[4:7], s78 offen offset:0 sc1
    s_nop 4
    v_mfma_f32_16x16x32_bf16 v[180:183], v[112:115], v[216:219], v[180:183]
    s_nop 0
    v_cvt_pk_bf16_f32 v176, v176, v177
    v_cvt_pk_bf16_f32 v177, v178, v179
    v_mfma_f32_16x16x32_bf16 v[204:207], v[116:119], v[220:223], v[204:207]
    s_nop 2
    v_mfma_f32_16x16x32_bf16 v[204:207], v[120:123], v[216:219], v[204:207]
    v_cvt_pk_bf16_f32 v178, v180, v181
    v_cvt_pk_bf16_f32 v179, v182, v183
    v_mfma_f32_16x16x32_bf16 v[184:187], v[124:127], v[220:223], v[184:187]
    buffer_store_dwordx4 v[176:179], v251, s[4:7], s79 offen offset:0 sc1
    s_nop 3
    v_cvt_pk_bf16_f32 v204, v204, v205
    v_mfma_f32_16x16x32_bf16 v[188:191], v[132:135], v[220:223], v[188:191]
    v_cvt_pk_bf16_f32 v205, v206, v207
    v_mfma_f32_16x16x32_bf16 v[184:187], v[128:131], v[216:219], v[184:187]
    buffer_store_dwordx2 v[204:205], v252, s[4:7], s73 offen offset:0 sc1
    s_nop 2
    v_mfma_f32_16x16x32_bf16 v[188:191], v[136:139], v[216:219], v[188:191]
    s_nop 2
    v_mfma_f32_16x16x32_bf16 v[192:195], v[140:143], v[220:223], v[192:195]
    v_cvt_pk_bf16_f32 v184, v184, v185
    v_cvt_pk_bf16_f32 v185, v186, v187
    v_mfma_f32_16x16x32_bf16 v[196:199], v[148:151], v[220:223], v[196:199]
    s_nop 0
    v_cvt_pk_bf16_f32 v186, v188, v189
    v_cvt_pk_bf16_f32 v187, v190, v191
    v_mfma_f32_16x16x32_bf16 v[192:195], v[144:147], v[216:219], v[192:195]
    buffer_store_dwordx4 v[184:187], v251, s[4:7], s78 offen offset:1024 sc1
    s_nop 4
    v_mfma_f32_16x16x32_bf16 v[196:199], v[152:155], v[216:219], v[196:199]
    s_nop 0
    v_cvt_pk_bf16_f32 v192, v192, v193
    v_cvt_pk_bf16_f32 v193, v194, v195
    v_mfma_f32_16x16x32_bf16 v[200:203], v[156:159], v[220:223], v[200:203]
    s_nop 2
    v_mfma_f32_16x16x32_bf16 v[200:203], v[160:163], v[216:219], v[200:203]
    v_cvt_pk_bf16_f32 v194, v196, v197
    v_cvt_pk_bf16_f32 v195, v198, v199
    buffer_store_dwordx4 v[192:195], v251, s[4:7], s79 offen offset:1024 sc1
    s_nop 4
    v_cvt_pk_bf16_f32 v200, v200, v201
    v_cvt_pk_bf16_f32 v201, v202, v203
    buffer_store_dwordx2 v[200:201], v252, s[4:7], s73 offen offset:1024 sc1
    s_add_u32 s62, s62, 1
    s_mov_b32 s80, 1
L_Bh1:
    s_cmp_lg_u32 s75, 0
    s_cbranch_scc1 L_Bhave1
    buffer_load_dword v254, v253, s[4:7], 0 offen sc1
    s_waitcnt vmcnt(0)
    s_cmp_eq_u32 s80, 0
    s_cbranch_scc1 Lowed_84
    s_waitcnt vmcnt(0)
    v_mov_b32 v2, s62
    s_mov_b64 exec, 1
    buffer_store_dword v2, off, s[4:7], s63 sc1
    buffer_store_dword v2, off, s[4:7], s3
    s_mov_b64 exec, -1
    s_mov_b32 s80, 0
Lowed_84:
    s_add_u32 s65, s62, 1
Lfchk_85:
    v_cmp_gt_u32 vcc, s65, v254
    s_cbranch_vccnz Lfrty_86
    s_add_u32 m0, s74, 28672
    s_add_u32 s64, s70, 36864
    buffer_load_dwordx4 v244, s[4:7], s64 offen sc1 lds
    s_add_u32 m0, s74, 32768
    s_add_u32 s64, s70, 49152
    buffer_load_dwordx4 v244, s[4:7], s64 offen sc1 lds
    s_add_u32 m0, s74, 36864
    s_add_u32 s64, s70, 53248
    buffer_load_dwordx4 v244, s[4:7], s64 offen sc1 lds
    s_add_u32 m0, s74, 40960
    s_add_u32 s64, s70, 65536
    buffer_load_dwordx4 v244, s[4:7], s64 offen sc1 lds
    s_add_u32 m0, s74, 45056
    s_add_u32 s64, s70, 69632
    buffer_load_dwordx4 v244, s[4:7], s64 offen sc1 lds
    s_add_u32 s71, s71, 131072
    s_lshr_b32 s70, s71, 8
    s_xor_b32 s70, s70, s1
    s_and_b32 s70, s70, 0x2000
    s_or_b32 s70, s70, s71
    s_waitcnt vmcnt(0)
L_Bhave1:
    s_waitcnt vmcnt(6) lgkmcnt(0)
    s_barrier
    s_mov_b32 s75, 0
    ds_read_b128 v[204:207], v245 offset:28672
    ds_read_b128 v[208:211], v246 offset:28672
    s_waitcnt lgkmcnt(1)
    v_mfma_f32_16x16x32_bf16 v[180:183], v[4:7], v[204:207], 0
    ds_read_b128 v[212:215], v245 offset:29696
    v_mfma_f32_16x16x32_bf16 v[168:171], a[0:3], v[204:207], 0
    v_mfma_f32_16x16x32_bf16 v[172:175], a[80:83], v[204:207], 0
    v_mfma_f32_16x16x32_bf16 v[176:179], v[204:207], a[160:163], 0
    s_waitcnt lgkmcnt(1)
    v_mfma_f32_16x16x32_bf16 v[180:183], v[8:11], v[208:211], v[180:183]
    ds_read_b128 v[204:207], v246 offset:29696
    v_mfma_f32_16x16x32_bf16 v[168:171], a[4:7], v[208:211], v[168:171]
    v_mfma_f32_16x16x32_bf16 v[172:175], a[84:87], v[208:211], v[172:175]
    v_mfma_f32_16x16x32_bf16 v[176:179], v[208:211], a[164:167], v[176:179]
    s_waitcnt lgkmcnt(1)
    v_mfma_f32_16x16x32_bf16 v[180:183], v[12:15], v[212:215], v[180:183]
    ds_read_b128 v[208:211], v245 offset:30720
    buffer_load_dword v254, v253, s[4:7], 0 offen sc1
    v_mfma_f32_16x16x32_bf16 v[168:171], a[8:11], v[212:215], v[168:171]
    v_mfma_f32_16x16x32_bf16 v[172:175], a[88:91], v[212:215], v[172:175]
    v_mfma_f32_16x16x32_bf16 v[176:179], v[212:215], a[168:171], v[176:179]
    s_waitcnt lgkmcnt(1)
    v_mfma_f32_16x16x32_bf16 v[180:183], v[16:19], v[204:207], v[180:183]
    ds_read_b128 v[212:215], v246 offset:30720
    v_mfma_f32_16x16x32_bf16 v[168:171], a[12:15], v[204:207], v[168:171]
    v_mfma_f32_16x16x32_bf16 v[172:175], a[92:95], v[204:207], v[172:175]
    v_mfma_f32_16x16x32_bf16 v[176:179], v[204:207], a[172:175], v[176:179]
    s_waitcnt lgkmcnt(1)
    v_mfma_f32_16x16x32_bf16 v[180:183], v[20:23], v[208:211], v[180:183]
    ds_read_b128 v[204:207], v245 offset:31744
    v_mfma_f32_16x16x32_bf16 v[168:171], a[16:19], v[208:211], v[168:171]
    v_mfma_f32_16x16x32_bf16 v[172:175], a[96:99], v[208:211], v[172:175]
    v_mfma_f32_16x16x32_bf16 v[176:179], v[208:211], a[176:179], v[176:179]
    s_waitcnt lgkmcnt(1)
    v_mfma_f32_16x16x32_bf16 v[180:183], v[24:27], v[212:215], v[180:183]
    ds_read_b128 v[208:211], v246 offset:31744
    v_mfma_f32_16x16x32_bf16 v[168:171], a[20:23], v[212:215], v[168:171]
    v_mfma_f32_16x16x32_bf16 v[172:175], a[100:103], v[212:215], v[172:175]
    v_mfma_f32_16x16x32_bf16 v[176:179], v[212:215], a[180:183], v[176:179]
    s_waitcnt lgkmcnt(1)
    v_mfma_f32_16x16x32_bf16 v[180:183], v[28:31], v[204:207], v[180:183]
    ds_read_b128 v[212:215], v245 offset:32768
    v_mfma_f32_16x16x32_bf16 v[168:171], a[24:27], v[204:207], v[168:171]
    v_mfma_f32_16x16x32_bf16 v[172:175], a[104:107], v[204:207], v[172:175]
    v_mfma_f32_16x16x32_bf16 v[176:179], v[204:207], a[184:187], v[176:179]
    s_waitcnt lgkmcnt(1)
    v_mfma_f32_16x16x32_bf16 v[180:183], v[32:35], v[208:211], v[180:183]
    ds_read_b128 v[204:207], v246 offset:32768
    v_mfma_f32_16x16x32_bf16 v[168:171], a[28:31], v[208:211], v[168:171]
    v_mfma_f32_16x16x32_bf16 v[172:175], a[108:111], v[208:211], v[172:175]
    v_mfma_f32_16x16x32_bf16 v[176:179], v[208:211], a[188:191], v[176:179]
    s_waitcnt lgkmcnt(1)
    v_mfma_f32_16x16x32_bf16 v[180:183], v[36:39], v[212:215], v[180:183]
    ds_read_b128 v[208:211], v245 offset:33792
    v_mfma_f32_16x16x32_bf16 v[168:171], a[32:35], v[212:215], v[168:171]
    v_mfma_f32_16x16x32_bf16 v[172:175], a[112:115], v[212:215], v[172:175]
    v_mfma_f32_16x16x32_bf16 v[176:179], v[212:215], a[192:195], v[176:179]
    s_waitcnt lgkmcnt(1)
    v_mfma_f32_16x16x32_bf16 v[180:183], v[40:43], v[204:207], v[180:183]
    ds_read_b128 v[212:215], v246 offset:33792
    v_mfma_f32_16x16x32_bf16 v[168:171], a[36:39], v[204:207], v[168:171]
    v_mfma_f32_16x16x32_bf16 v[172:175], a[116:119], v[204:207], v[172:175]
    v_mfma_f32_16x16x32_bf16 v[176:179], v[204:207], a[196:199], v[176:179]
    s_waitcnt vmcnt(0)
    s_cmp_eq_u32 s80, 0
    s_cbranch_scc1 Lowed_87
    s_waitcnt vmcnt(0)
    v_mov_b32 v2, s62
    s_mov_b64 exec, 1
    buffer_store_dword v2, off, s[4:7], s63 sc1
    buffer_store_dword v2, off, s[4:7], s3
    s_mov_b64 exec, -1
    s_mov_b32 s80, 0
Lowed_87:
    s_add_u32 s65, s62, s75
    s_add_u32 s65, s65, 2
    v_cmp_gt_u32 vcc, s65, v254
    s_cbranch_vccz Lpre_88
    s_waitcnt lgkmcnt(1)
    v_mfma_f32_16x16x32_bf16 v[180:183], v[44:47], v[208:211], v[180:183]
    ds_read_b128 v[204:207], v245 offset:34816
    ds_read_b128 v[188:191], v247 offset:5120
    v_mfma_f32_16x16x32_bf16 v[168:171], a[40:43], v[208:211], v[168:171]
    ds_read_b128 v[184:187], v247 offset:6144
    v_mfma_f32_16x16x32_bf16 v[172:175], a[120:123], v[208:211], v[172:175]
    v_mfma_f32_16x16x32_bf16 v[176:179], v[208:211], a[200:203], v[176:179]
    s_waitcnt lgkmcnt(3)
    v_mfma_f32_16x16x32_bf16 v[180:183], v[48:51], v[212:215], v[180:183]
    ds_read_b128 v[208:211], v246 offset:34816
    v_mfma_f32_16x16x32_bf16 v[168:171], a[44:47], v[212:215], v[168:171]
    v_mfma_f32_16x16x32_bf16 v[172:175], a[124:127], v[212:215], v[172:175]
    v_mfma_f32_16x16x32_bf16 v[176:179], v[212:215], a[204:207], v[176:179]
    s_waitcnt lgkmcnt(3)
    v_mfma_f32_16x16x32_bf16 v[180:183], v[52:55], v[204:207], v[180:183]
    ds_read_b128 v[212:215], v245 offset:35840
    v_mfma_f32_16x16x32_bf16 v[168:171], a[48:51], v[204:207], v[168:171]
    v_mfma_f32_16x16x32_bf16 v[172:175], a[128:131], v[204:207], v[172:175]
    v_mfma_f32_16x16x32_bf16 v[176:179], v[204:207], a[208:211], v[176:179]
    s_waitcnt lgkmcnt(1)
    v_mfma_f32_16x16x32_bf16 v[180:183], v[56:59], v[208:211], v[180:183]
    ds_read_b128 v[204:207], v246 offset:35840
    v_mfma_f32_16x16x32_bf16 v[168:171], a[52:55], v[208:211], v[168:171]
    v_mfma_f32_16x16x32_bf16 v[172:175], a[132:135], v[208:211], v[172:175]
    v_mfma_f32_16x16x32_bf16 v[176:179], v[208:211], a[212:215], v[176:179]
    s_waitcnt lgkmcnt(1)
    v_mfma_f32_16x16x32_bf16 v[180:183], v[60:63], v[212:215], v[180:183]
    ds_read_b128 v[208:211], v245 offset:36864
    v_mfma_f32_16x16x32_bf16 v[168:171], a[56:59], v[212:215], v[168:171]
    v_mfma_f32_16x16x32_bf16 v[172:175], a[136:139], v[212:215], v[172:175]
    v_mfma_f32_16x16x32_bf16 v[176:179], v[212:215], a[216:219], v[176:179]
    s_waitcnt lgkmcnt(1)
    v_mfma_f32_16x16x32_bf16 v[180:183], v[64:67], v[204:207], v[180:183]
    ds_read_b128 v[212:215], v246 offset:36864
    v_mfma_f32_16x16x32_bf16 v[168:171], a[60:63], v[204:207], v[168:171]
    v_mfma_f32_16x16x32_bf16 v[172:175], a[140:143], v[204:207], v[172:175]
    v_mfma_f32_16x16x32_bf16 v[176:179], v[204:207], a[220:223], v[176:179]
    s_waitcnt lgkmcnt(1)
    v_mfma_f32_16x16x32_bf16 v[180:183], v[68:71], v[208:211], v[180:183]
    ds_read_b128 v[204:207], v245 offset:37888
    v_mfma_f32_16x16x32_bf16 v[168:171], a[64:67], v[208:211], v[168:171]
    v_mfma_f32_16x16x32_bf16 v[172:175], a[144:147], v[208:211], v[172:175]
    v_mfma_f32_16x16x32_bf16 v[176:179], v[208:211], a[224:227], v[176:179]
    s_waitcnt lgkmcnt(1)
    v_mfma_f32_16x16x32_bf16 v[180:183], v[72:75], v[212:215], v[180:183]
    ds_read_b128 v[208:211], v246 offset:37888
    v_mfma_f32_16x16x32_bf16 v[168:171], a[68:71], v[212:215], v[168:171]
    v_mfma_f32_16x16x32_bf16 v[172:175], a[148:151], v[212:215], v[172:175]
    v_mfma_f32_16x16x32_bf16 v[176:179], v[212:215], a[228:231], v[176:179]
    s_waitcnt lgkmcnt(1)
    v_mfma_f32_16x16x32_bf16 v[180:183], v[76:79], v[204:207], v[180:183]
    v_mfma_f32_16x16x32_bf16 v[168:171], a[72:75], v[204:207], v[168:171]
    v_mfma_f32_16x16x32_bf16 v[172:175], a[152:155], v[204:207], v[172:175]
    v_mfma_f32_16x16x32_bf16 v[176:179], v[204:207], a[232:235], v[176:179]
    s_waitcnt lgkmcnt(0)
    v_mfma_f32_16x16x32_bf16 v[180:183], v[80:83], v[208:211], v[180:183]
    s_nop 2
    v_mfma_f32_16x16x32_bf16 v[168:171], a[76:79], v[208:211], v[168:171]
    s_nop 2
    v_mfma_f32_16x16x32_bf16 v[172:175], a[156:159], v[208:211], v[172:175]
    s_nop 2
    v_mfma_f32_16x16x32_bf16 v[176:179], v[208:211], a[236:239], v[176:179]
Lback_89:
    s_waitcnt vmcnt(0)
L_Be1:
    v_mov_b32 v2, s75
    ds_write_b32 v3, v2 offset:2560
    buffer_load_dword v254, v253, s[4:7], 0 offen sc1
    v_mfma_f32_16x16x4_f32 v[192:195], v182, v242, 0
    v_cvt_pk_bf16_f32 v222, v180, 0
    v_cvt_pk_bf16_f32 v230, v181, 0
    v_cvt_pk_bf16_f32 v220, v168, v169
    v_cvt_pk_bf16_f32 v221, v170, v171
    v_mov_b32 v223, 0
    v_cvt_pk_bf16_f32 v228, v172, v173
    v_cvt_pk_bf16_f32 v229, v174, v175
    s_waitcnt lgkmcnt(0)
    s_barrier
    ds_read_b32 v2, v1 offset:2560
    v_mfma_f32_16x16x32_bf16 v[188:191], v[224:227], v[220:223], v[188:191]
    v_cvt_pk_bf16_f32 v232, v176, v177
    v_cvt_pk_bf16_f32 v233, v178, v179
    v_mfma_f32_16x16x32_bf16 v[184:187], v[228:231], v[220:223], v[184:187]
    s_add_u32 s78, s73, 16384
    s_add_u32 s79, s73, 49152
    v_mov_b32 v248, v247
    v_cvt_pk_bf16_f32 v236, v192, v193
    v_cvt_pk_bf16_f32 v237, v194, v195
    v_or_b32 v236, v243, v236
    v_or_b32 v237, v243, v237
    s_waitcnt lgkmcnt(0)
    v_cmp_eq_u32 vcc, 0, v2
    s_cbranch_vccz L_Bi1
    v_max3_f32 v192, v184, v185, v186
    v_max3_f32 v193, v188, v189, v190
    v_max3_f32 v192, v192, v187, v191
    v_max_f32 v192, v192, v193
    v_mov_b32 v193, v192
    s_nop 1
    v_permlane16_swap_b32 v192, v193
    v_max_f32 v192, v192, v193
    v_mov_b32 v193, v192
    s_nop 1
    v_permlane32_swap_b32 v192, v193
    v_max_f32 v192, v192, v193
    v_mul_f32 v192, s77, v192
    v_fma_f32 v184, v184, s77, -v192
    v_fma_f32 v185, v185, s77, -v192
    v_fma_f32 v186, v186, s77, -v192
    v_fma_f32 v187, v187, s77, -v192
    v_fma_f32 v188, v188, s77, -v192
    v_fma_f32 v189, v189, s77, -v192
    v_fma_f32 v190, v190, s77, -v192
    v_fma_f32 v191, v191, s77, -v192
    v_exp_f32 v184, v184
    v_exp_f32 v185, v185
    v_exp_f32 v186, v186
    v_exp_f32 v187, v187
    v_exp_f32 v188, v188
    v_exp_f32 v189, v189
    v_exp_f32 v190, v190
    v_exp_f32 v191, v191
    v_cvt_pk_bf16_f32 v184, v184, v185
    v_cvt_pk_bf16_f32 v185, v186, v187
    v_cvt_pk_bf16_f32 v186, v188, v189
    v_cvt_pk_bf16_f32 v187, v190, v191
    s_nop 1
    v_mfma_f32_16x16x32_bf16 v[200:203], v[236:239], v[184:187], 0
    s_nop 2
    v_mfma_f32_16x16x32_bf16 v[196:199], v[232:235], v[184:187], 0
    s_nop 3
    v_rcp_f32 v201, v201
    s_nop 0
    v_mul_f32 v200, v200, v201
    s_nop 0
    v_mul_f32 v196, v196, v201
    v_mul_f32 v197, v197, v201
    v_mul_f32 v198, v198, v201
    v_mul_f32 v199, v199, v201
    v_cvt_pk_bf16_f32 v200, v200, v200
    v_cvt_pk_bf16_f32 v196, v196, v197
    v_cvt_pk_bf16_f32 v197, v198, v199
    ds_write_b16 v250, v200 offset:2048
    ds_write_b64 v249, v[196:197] offset:0
    s_waitcnt lgkmcnt(0)
    s_barrier
    ds_read_b64 v[240:241], v255 offset:2048
    ds_read_b128 v[220:223], v247 offset:0
    ds_read_b128 v[216:219], v247 offset:1024
    s_waitcnt vmcnt(0)
    s_cmp_eq_u32 s80, 0
    s_cbranch_scc1 Lowed_90
    s_waitcnt vmcnt(0)
    v_mov_b32 v2, s62
    s_mov_b64 exec, 1
    buffer_store_dword v2, off, s[4:7], s63 sc1
    buffer_store_dword v2, off, s[4:7], s3
    s_mov_b64 exec, -1
    s_mov_b32 s80, 0
Lowed_90:
    s_add_u32 s65, s62, s75
    s_add_u32 s65, s65, 2
    v_cmp_gt_u32 vcc, s65, v254
    s_cbranch_vccz Lpre_91
    s_waitcnt lgkmcnt(2)
    v_mfma_f32_16x16x16_bf16 v[168:171], a[240:241], v[240:241], 0
    v_mfma_f32_16x16x16_bf16 v[172:175], a[242:243], v[240:241], 0
    v_mfma_f32_16x16x16_bf16 v[176:179], a[244:245], v[240:241], 0
    v_mfma_f32_16x16x16_bf16 v[180:183], a[246:247], v[240:241], 0
    v_mfma_f32_16x16x16_bf16 v[204:207], a[248:249], v[240:241], 0
    v_mfma_f32_16x16x16_bf16 v[184:187], a[250:251], v[240:241], 0
    v_mfma_f32_16x16x16_bf16 v[188:191], a[252:253], v[240:241], 0
    v_mfma_f32_16x16x16_bf16 v[192:195], a[254:255], v[240:241], 0
    v_mfma_f32_16x16x16_bf16 v[196:199], v[164:165], v[240:241], 0
    v_mfma_f32_16x16x16_bf16 v[200:203], v[166:167], v[240:241], 0
Lback_92:
    s_waitcnt lgkmcnt(1)
    v_mfma_f32_16x16x32_bf16 v[168:171], v[84:87], v[220:223], v[168:171]
    v_mfma_f32_16x16x32_bf16 v[172:175], v[92:95], v[220:223], v[172:175]
    s_waitcnt lgkmcnt(0)
    v_mfma_f32_16x16x32_bf16 v[168:171], v[88:91], v[216:219], v[168:171]
    s_nop 2
    v_mfma_f32_16x16x32_bf16 v[172:175], v[96:99], v[216:219], v[172:175]
    s_nop 2
    v_mfma_f32_16x16x32_bf16 v[176:179], v[100:103], v[220:223], v[176:179]
    v_cvt_pk_bf16_f32 v168, v168, v169
    v_cvt_pk_bf16_f32 v169, v170, v171
    v_mfma_f32_16x16x32_bf16 v[180:183], v[108:111], v[220:223], v[180:183]
    s_nop 0
    v_cvt_pk_bf16_f32 v170, v172, v173
    v_cvt_pk_bf16_f32 v171, v174, v175
    v_mfma_f32_16x16x32_bf16 v[176:179], v[104:107], v[216:219], v[176:179]
    buffer_store_dwordx4 v[168:171], v251, s[4:7], s78 offen offset:0 sc1
    s_nop 4
    v_mfma_f32_16x16x32_bf16 v[180:183], v[112:115], v[216:219], v[180:183]
    s_nop 0
    v_cvt_pk_bf16_f32 v176, v176, v177
    v_cvt_pk_bf16_f32 v177, v178, v179
    v_mfma_f32_16x16x32_bf16 v[204:207], v[116:119], v[220:223], v[204:207]
    s_nop 2
    v_mfma_f32_16x16x32_bf16 v[204:207], v[120:123], v[216:219], v[204:207]
    v_cvt_pk_bf16_f32 v178, v180, v181
    v_cvt_pk_bf16_f32 v179, v182, v183
    v_mfma_f32_16x16x32_bf16 v[184:187], v[124:127], v[220:223], v[184:187]
    buffer_store_dwordx4 v[176:179], v251, s[4:7], s79 offen offset:0 sc1
    s_nop 3
    v_cvt_pk_bf16_f32 v204, v204, v205
    v_mfma_f32_16x16x32_bf16 v[188:191], v[132:135], v[220:223], v[188:191]
    v_cvt_pk_bf16_f32 v205, v206, v207
    v_mfma_f32_16x16x32_bf16 v[184:187], v[128:131], v[216:219], v[184:187]
    buffer_store_dwordx2 v[204:205], v252, s[4:7], s73 offen offset:512 sc1
    s_nop 2
    v_mfma_f32_16x16x32_bf16 v[188:191], v[136:139], v[216:219], v[188:191]
    s_nop 2
    v_mfma_f32_16x16x32_bf16 v[192:195], v[140:143], v[220:223], v[192:195]
    v_cvt_pk_bf16_f32 v184, v184, v185
    v_cvt_pk_bf16_f32 v185, v186, v187
    v_mfma_f32_16x16x32_bf16 v[196:199], v[148:151], v[220:223], v[196:199]
    s_nop 0
    v_cvt_pk_bf16_f32 v186, v188, v189
    v_cvt_pk_bf16_f32 v187, v190, v191
    v_mfma_f32_16x16x32_bf16 v[192:195], v[144:147], v[216:219], v[192:195]
    buffer_store_dwordx4 v[184:187], v251, s[4:7], s78 offen offset:1024 sc1
    s_nop 4
    v_mfma_f32_16x16x32_bf16 v[196:199], v[152:155], v[216:219], v[196:199]
    s_nop 0
    v_cvt_pk_bf16_f32 v192, v192, v193
    v_cvt_pk_bf16_f32 v193, v194, v195
    v_mfma_f32_16x16x32_bf16 v[200:203], v[156:159], v[220:223], v[200:203]
    s_nop 2
    v_mfma_f32_16x16x32_bf16 v[200:203], v[160:163], v[216:219], v[200:203]
    v_cvt_pk_bf16_f32 v194, v196, v197
    v_cvt_pk_bf16_f32 v195, v198, v199
    buffer_store_dwordx4 v[192:195], v251, s[4:7], s79 offen offset:1024 sc1
    s_nop 4
    v_cvt_pk_bf16_f32 v200, v200, v201
    v_cvt_pk_bf16_f32 v201, v202, v203
    buffer_store_dwordx2 v[200:201], v252, s[4:7], s73 offen offset:1536 sc1
    s_add_u32 s62, s62, 1
    s_mov_b32 s80, 1
    s_cmp_lt_u32 s62, 128
    s_cbranch_scc1 L_Bh0
    s_waitcnt vmcnt(0)
    v_mov_b32 v2, s62
    s_mov_b64 exec, 1
    buffer_store_dword v2, off, s[4:7], s63 sc1
    buffer_store_dword v2, off, s[4:7], s3
    s_mov_b64 exec, -1
    s_endpgm
L_Bi0:
    s_mov_b32 s75, 0
    ds_read_b128 v[204:207], v245 offset:28672
    ds_read_b128 v[208:211], v246 offset:28672
    v_max3_f32 v192, v184, v185, v186
    v_max3_f32 v193, v188, v189, v190
    v_max3_f32 v192, v192, v187, v191
    v_max_f32 v192, v192, v193
    s_waitcnt lgkmcnt(1)
    v_mfma_f32_16x16x32_bf16 v[180:183], v[4:7], v[204:207], 0
    ds_read_b128 v[212:215], v245 offset:29696
    v_mov_b32 v193, v192
    v_mfma_f32_16x16x32_bf16 v[168:171], a[0:3], v[204:207], 0
    s_nop 0
    v_permlane16_swap_b32 v192, v193
    v_mfma_f32_16x16x32_bf16 v[172:175], a[80:83], v[204:207], 0
    v_max_f32 v192, v192, v193
    v_mov_b32 v193, v192
    v_mfma_f32_16x16x32_bf16 v[176:179], v[204:207], a[160:163], 0
    s_waitcnt lgkmcnt(1)
    v_permlane32_swap_b32 v192, v193
    v_mfma_f32_16x16x32_bf16 v[180:183], v[8:11], v[208:211], v[180:183]
    ds_read_b128 v[204:207], v246 offset:29696
    v_max_f32 v192, v192, v193
    v_mfma_f32_16x16x32_bf16 v[168:171], a[4:7], v[208:211], v[168:171]
    v_mul_f32 v192, s77, v192
    v_fma_f32 v184, v184, s77, -v192
    v_mfma_f32_16x16x32_bf16 v[172:175], a[84:87], v[208:211], v[172:175]
    v_fma_f32 v185, v185, s77, -v192
    v_fma_f32 v186, v186, s77, -v192
    v_mfma_f32_16x16x32_bf16 v[176:179], v[208:211], a[164:167], v[176:179]
    s_waitcnt lgkmcnt(1)
    v_fma_f32 v187, v187, s77, -v192
    v_fma_f32 v188, v188, s77, -v192
    v_mfma_f32_16x16x32_bf16 v[180:183], v[12:15], v[212:215], v[180:183]
    ds_read_b128 v[208:211], v245 offset:30720
    v_fma_f32 v189, v189, s77, -v192
    v_mfma_f32_16x16x32_bf16 v[168:171], a[8:11], v[212:215], v[168:171]
    v_fma_f32 v190, v190, s77, -v192
    v_fma_f32 v191, v191, s77, -v192
    v_mfma_f32_16x16x32_bf16 v[172:175], a[88:91], v[212:215], v[172:175]
    v_exp_f32 v184, v184
    v_mfma_f32_16x16x32_bf16 v[176:179], v[212:215], a[168:171], v[176:179]
    v_exp_f32 v185, v185
    s_waitcnt vmcnt(0)
    s_cmp_eq_u32 s80, 0
    s_cbranch_scc1 Lowed_93
    s_waitcnt vmcnt(0)
    v_mov_b32 v2, s62
    s_mov_b64 exec, 1
    buffer_store_dword v2, off, s[4:7], s63 sc1
    buffer_store_dword v2, off, s[4:7], s3
    s_mov_b64 exec, -1
    s_mov_b32 s80, 0
Lowed_93:
    s_add_u32 s65, s62, s75
    s_add_u32 s65, s65, 3
    v_cmp_gt_u32 vcc, s65, v254
    s_cbranch_vccz Lpre_94
    s_waitcnt lgkmcnt(1)
    v_mfma_f32_16x16x32_bf16 v[180:183], v[16:19], v[204:207], v[180:183]
    ds_read_b128 v[212:215], v246 offset:30720
    v_mfma_f32_16x16x32_bf16 v[168:171], a[12:15], v[204:207], v[168:171]
    v_exp_f32 v186, v186
    v_mfma_f32_16x16x32_bf16 v[172:175], a[92:95], v[204:207], v[172:175]
    v_exp_f32 v187, v187
    v_mfma_f32_16x16x32_bf16 v[176:179], v[204:207], a[172:175], v[176:179]
    s_waitcnt lgkmcnt(1)
    v_exp_f32 v188, v188
    v_mfma_f32_16x16x32_bf16 v[180:183], v[20:23], v[208:211], v[180:183]
    ds_read_b128 v[204:207], v245 offset:31744
    v_mfma_f32_16x16x32_bf16 v[168:171], a[16:19], v[208:211], v[168:171]
    v_exp_f32 v189, v189
    v_mfma_f32_16x16x32_bf16 v[172:175], a[96:99], v[208:211], v[172:175]
    v_exp_f32 v190, v190
    v_mfma_f32_16x16x32_bf16 v[176:179], v[208:211], a[176:179], v[176:179]
    s_waitcnt lgkmcnt(1)
    v_exp_f32 v191, v191
    v_mfma_f32_16x16x32_bf16 v[180:183], v[24:27], v[212:215], v[180:183]
    ds_read_b128 v[208:211], v246 offset:31744
    v_cvt_pk_bf16_f32 v184, v184, v185
    v_mfma_f32_16x16x32_bf16 v[168:171], a[20:23], v[212:215], v[168:171]
    v_cvt_pk_bf16_f32 v185, v186, v187
    v_cvt_pk_bf16_f32 v186, v188, v189
    v_mfma_f32_16x16x32_bf16 v[172:175], a[100:103], v[212:215], v[172:175]
    v_cvt_pk_bf16_f32 v187, v190, v191
    s_nop 0
    v_mfma_f32_16x16x32_bf16 v[176:179], v[212:215], a[180:183], v[176:179]
    v_mfma_f32_16x16x32_bf16 v[200:203], v[236:239], v[184:187], 0
    s_nop 2
    v_mfma_f32_16x16x32_bf16 v[196:199], v[232:235], v[184:187], 0
Lback_95:
    s_waitcnt lgkmcnt(1)
    v_mfma_f32_16x16x32_bf16 v[180:183], v[28:31], v[204:207], v[180:183]
    ds_read_b128 v[212:215], v245 offset:32768
    v_mfma_f32_16x16x32_bf16 v[168:171], a[24:27], v[204:207], v[168:171]
    v_rcp_f32 v201, v201
    v_mfma_f32_16x16x32_bf16 v[172:175], a[104:107], v[204:207], v[172:175]
    v_mul_f32 v200, v200, v201
    s_nop 0
    v_mul_f32 v196, v196, v201
    v_mfma_f32_16x16x32_bf16 v[176:179], v[204:207], a[184:187], v[176:179]
    s_waitcnt lgkmcnt(1)
    v_mul_f32 v197, v197, v201
    v_mul_f32 v198, v198, v201
    v_mfma_f32_16x16x32_bf16 v[180:183], v[32:35], v[208:211], v[180:183]
    ds_read_b128 v[204:207], v246 offset:32768
    v_mul_f32 v199, v199, v201
    v_mfma_f32_16x16x32_bf16 v[168:171], a[28:31], v[208:211], v[168:171]
    v_cvt_pk_bf16_f32 v200, v200, v200
    v_cvt_pk_bf16_f32 v196, v196, v197
    v_mfma_f32_16x16x32_bf16 v[172:175], a[108:111], v[208:211], v[172:175]
    v_cvt_pk_bf16_f32 v197, v198, v199
    v_mfma_f32_16x16x32_bf16 v[176:179], v[208:211], a[188:191], v[176:179]
    s_waitcnt lgkmcnt(1)
    ds_write_b16 v250, v200 offset:2048
    v_mfma_f32_16x16x32_bf16 v[180:183], v[36:39], v[212:215], v[180:183]
    ds_read_b128 v[208:211], v245 offset:33792
    v_mfma_f32_16x16x32_bf16 v[168:171], a[32:35], v[212:215], v[168:171]
    ds_write_b64 v249, v[196:197] offset:0
    v_mfma_f32_16x16x32_bf16 v[172:175], a[112:115], v[212:215], v[172:175]
    v_mfma_f32_16x16x32_bf16 v[176:179], v[212:215], a[192:195], v[176:179]
    s_waitcnt lgkmcnt(3)
    v_mfma_f32_16x16x32_bf16 v[180:183], v[40:43], v[204:207], v[180:183]
    ds_read_b128 v[212:215], v246 offset:33792
    v_mfma_f32_16x16x32_bf16 v[168:171], a[36:39], v[204:207], v[168:171]
    v_mfma_f32_16x16x32_bf16 v[172:175], a[116:119], v[204:207], v[172:175]
    s_waitcnt lgkmcnt(1)
    s_barrier
    ds_read_b64 v[240:241], v255 offset:2048
    ds_read_b128 v[220:223], v247 offset:0
    v_mfma_f32_16x16x32_bf16 v[176:179], v[204:207], a[196:199], v[176:179]
    ds_read_b128 v[216:219], v247 offset:1024
    v_mfma_f32_16x16x32_bf16 v[180:183], v[44:47], v[208:211], v[180:183]
    ds_read_b128 v[204:207], v245 offset:34816
    v_mfma_f32_16x16x32_bf16 v[168:171], a[40:43], v[208:211], v[168:171]
    v_mfma_f32_16x16x32_bf16 v[172:175], a[120:123], v[208:211], v[172:175]
    v_mfma_f32_16x16x32_bf16 v[176:179], v[208:211], a[200:203], v[176:179]
    s_waitcnt lgkmcnt(3)
    v_mfma_f32_16x16x16_bf16 v[184:187], a[240:241], v[240:241], 0
    v_mfma_f32_16x16x16_bf16 v[188:191], a[242:243], v[240:241], 0
    v_mfma_f32_16x16x16_bf16 v[192:195], a[244:245], v[240:241], 0
    v_mfma_f32_16x16x16_bf16 v[196:199], a[246:247], v[240:241], 0
    v_mfma_f32_16x16x16_bf16 v[200:203], a[248:249], v[240:241], 0
    v_mfma_f32_16x16x32_bf16 v[180:183], v[48:51], v[212:215], v[180:183]
    ds_read_b128 v[208:211], v246 offset:34816
    v_mfma_f32_16x16x32_bf16 v[168:171], a[44:47], v[212:215], v[168:171]
    v_mfma_f32_16x16x32_bf16 v[172:175], a[124:127], v[212:215], v[172:175]
    v_mfma_f32_16x16x32_bf16 v[176:179], v[212:215], a[204:207], v[176:179]
    s_waitcnt lgkmcnt(3)
    v_mfma_f32_16x16x32_bf16 v[184:187], v[84:87], v[220:223], v[184:187]
    v_mfma_f32_16x16x32_bf16 v[188:191], v[92:95], v[220:223], v[188:191]
    s_waitcnt lgkmcnt(2)
    v_mfma_f32_16x16x32_bf16 v[184:187], v[88:91], v[216:219], v[184:187]
    s_nop 2
    v_mfma_f32_16x16x32_bf16 v[188:191], v[96:99], v[216:219], v[188:191]
    s_nop 2
    v_mfma_f32_16x16x32_bf16 v[192:195], v[100:103], v[220:223], v[192:195]
    v_cvt_pk_bf16_f32 v184, v184, v185
    v_cvt_pk_bf16_f32 v185, v186, v187
    v_mfma_f32_16x16x32_bf16 v[196:199], v[108:111], v[220:223], v[196:199]
    s_nop 0
    v_cvt_pk_bf16_f32 v186, v188, v189
    v_cvt_pk_bf16_f32 v187, v190, v191
    v_mfma_f32_16x16x32_bf16 v[192:195], v[104:107], v[216:219], v[192:195]
    buffer_store_dwordx4 v[184:187], v251, s[4:7], s78 offen offset:0 sc1
    s_nop 4
    v_mfma_f32_16x16x32_bf16 v[196:199], v[112:115], v[216:219], v[196:199]
    s_nop 0
    v_cvt_pk_bf16_f32 v192, v192, v193
    v_cvt_pk_bf16_f32 v193, v194, v195
    v_mfma_f32_16x16x32_bf16 v[200:203], v[116:119], v[220:223], v[200:203]
    s_nop 2
    v_mfma_f32_16x16x32_bf16 v[200:203], v[120:123], v[216:219], v[200:203]
    v_cvt_pk_bf16_f32 v194, v196, v197
    v_cvt_pk_bf16_f32 v195, v198, v199
    s_waitcnt lgkmcnt(1)
    v_mfma_f32_16x16x32_bf16 v[180:183], v[52:55], v[204:207], v[180:183]
    ds_read_b128 v[212:215], v245 offset:35840
    v_mfma_f32_16x16x32_bf16 v[168:171], a[48:51], v[204:207], v[168:171]
    buffer_store_dwordx4 v[192:195], v251, s[4:7], s79 offen offset:0 sc1
    s_nop 0
    v_cvt_pk_bf16_f32 v200, v200, v201
    v_cvt_pk_bf16_f32 v201, v202, v203
    v_mfma_f32_16x16x32_bf16 v[172:175], a[128:131], v[204:207], v[172:175]
    buffer_store_dwordx2 v[200:201], v252, s[4:7], s73 offen offset:0 sc1
    v_mfma_f32_16x16x32_bf16 v[176:179], v[204:207], a[208:211], v[176:179]
    s_waitcnt lgkmcnt(1)
    v_mfma_f32_16x16x32_bf16 v[180:183], v[56:59], v[208:211], v[180:183]
    ds_read_b128 v[204:207], v246 offset:35840
    v_mfma_f32_16x16x32_bf16 v[168:171], a[52:55], v[208:211], v[168:171]
    v_mfma_f32_16x16x32_bf16 v[172:175], a[132:135], v[208:211], v[172:175]
    v_mfma_f32_16x16x32_bf16 v[176:179], v[208:211], a[212:215], v[176:179]
    v_mfma_f32_16x16x16_bf16 v[184:187], a[250:251], v[240:241], 0
    v_mfma_f32_16x16x16_bf16 v[188:191], a[252:253], v[240:241], 0
    v_mfma_f32_16x16x16_bf16 v[192:195], a[254:255], v[240:241], 0
    v_mfma_f32_16x16x16_bf16 v[196:199], v[164:165], v[240:241], 0
    v_mfma_f32_16x16x16_bf16 v[200:203], v[166:167], v[240:241], 0
    s_waitcnt lgkmcnt(1)
    v_mfma_f32_16x16x32_bf16 v[180:183], v[60:63], v[212:215], v[180:183]
    ds_read_b128 v[208:211], v245 offset:36864
    v_mfma_f32_16x16x32_bf16 v[168:171], a[56:59], v[212:215], v[168:171]
    v_mfma_f32_16x16x32_bf16 v[172:175], a[136:139], v[212:215], v[172:175]
    v_mfma_f32_16x16x32_bf16 v[176:179], v[212:215], a[216:219], v[176:179]
    v_mfma_f32_16x16x32_bf16 v[184:187], v[124:127], v[220:223], v[184:187]
    v_mfma_f32_16x16x32_bf16 v[188:191], v[132:135], v[220:223], v[188:191]
    v_mfma_f32_16x16x32_bf16 v[184:187], v[128:131], v[216:219], v[184:187]
    s_nop 2
    v_mfma_f32_16x16x32_bf16 v[188:191], v[136:139], v[216:219], v[188:191]
    s_nop 2
    v_mfma_f32_16x16x32_bf16 v[192:195], v[140:143], v[220:223], v[192:195]
    v_cvt_pk_bf16_f32 v184, v184, v185
    v_cvt_pk_bf16_f32 v185, v186, v187
    v_mfma_f32_16x16x32_bf16 v[196:199], v[148:151], v[220:223], v[196:199]
    s_nop 0
    v_cvt_pk_bf16_f32 v186, v188, v189
    v_cvt_pk_bf16_f32 v187, v190, v191
    v_mfma_f32_16x16x32_bf16 v[192:195], v[144:147], v[216:219], v[192:195]
    buffer_store_dwordx4 v[184:187], v251, s[4:7], s78 offen offset:1024 sc1
    s_nop 4
    v_mfma_f32_16x16x32_bf16 v[196:199], v[152:155], v[216:219], v[196:199]
    s_nop 0
    v_cvt_pk_bf16_f32 v192, v192, v193
    v_cvt_pk_bf16_f32 v193, v194, v195
    v_mfma_f32_16x16x32_bf16 v[200:203], v[156:159], v[220:223], v[200:203]
    s_nop 2
    v_mfma_f32_16x16x32_bf16 v[200:203], v[160:163], v[216:219], v[200:203]
    v_cvt_pk_bf16_f32 v194, v196, v197
    v_cvt_pk_bf16_f32 v195, v198, v199
    s_waitcnt lgkmcnt(1)
    v_mfma_f32_16x16x32_bf16 v[180:183], v[64:67], v[204:207], v[180:183]
    ds_read_b128 v[212:215], v246 offset:36864
    v_mfma_f32_16x16x32_bf16 v[168:171], a[60:63], v[204:207], v[168:171]
    buffer_store_dwordx4 v[192:195], v251, s[4:7], s79 offen offset:1024 sc1
    s_nop 0
    v_cvt_pk_bf16_f32 v200, v200, v201
    v_cvt_pk_bf16_f32 v201, v202, v203
    v_mfma_f32_16x16x32_bf16 v[172:175], a[140:143], v[204:207], v[172:175]
    buffer_store_dwordx2 v[200:201], v252, s[4:7], s73 offen offset:1024 sc1
    ds_read_b128 v[188:191], v247 offset:5120
    ds_read_b128 v[184:187], v247 offset:6144
    v_mfma_f32_16x16x32_bf16 v[176:179], v[204:207], a[220:223], v[176:179]
    s_waitcnt lgkmcnt(3)
    v_mfma_f32_16x16x32_bf16 v[180:183], v[68:71], v[208:211], v[180:183]
    ds_read_b128 v[204:207], v245 offset:37888
    v_mfma_f32_16x16x32_bf16 v[168:171], a[64:67], v[208:211], v[168:171]
    v_mfma_f32_16x16x32_bf16 v[172:175], a[144:147], v[208:211], v[172:175]
    v_mfma_f32_16x16x32_bf16 v[176:179], v[208:211], a[224:227], v[176:179]
    s_waitcnt lgkmcnt(3)
    v_mfma_f32_16x16x32_bf16 v[180:183], v[72:75], v[212:215], v[180:183]
    ds_read_b128 v[208:211], v246 offset:37888
    v_mfma_f32_16x16x32_bf16 v[168:171], a[68:71], v[212:215], v[168:171]
    v_mfma_f32_16x16x32_bf16 v[172:175], a[148:151], v[212:215], v[172:175]
    v_mfma_f32_16x16x32_bf16 v[176:179], v[212:215], a[228:231], v[176:179]
    s_waitcnt lgkmcnt(1)
    v_mfma_f32_16x16x32_bf16 v[180:183], v[76:79], v[204:207], v[180:183]
    v_mfma_f32_16x16x32_bf16 v[168:171], a[72:75], v[204:207], v[168:171]
    v_mfma_f32_16x16x32_bf16 v[172:175], a[152:155], v[204:207], v[172:175]
    v_mfma_f32_16x16x32_bf16 v[176:179], v[204:207], a[232:235], v[176:179]
    s_waitcnt lgkmcnt(0)
    v_mfma_f32_16x16x32_bf16 v[180:183], v[80:83], v[208:211], v[180:183]
    s_nop 2
    v_mfma_f32_16x16x32_bf16 v[168:171], a[76:79], v[208:211], v[168:171]
    s_nop 2
    v_mfma_f32_16x16x32_bf16 v[172:175], a[156:159], v[208:211], v[172:175]
    s_nop 2
    v_mfma_f32_16x16x32_bf16 v[176:179], v[208:211], a[236:239], v[176:179]
    s_add_u32 s62, s62, 1
    s_mov_b32 s80, 1
    s_waitcnt vmcnt(6)
    s_branch L_Be1
L_Bi1:
    s_mov_b32 s75, 0
    ds_read_b128 v[204:207], v245 offset:8192
    ds_read_b128 v[208:211], v246 offset:8192
    v_max3_f32 v192, v184, v185, v186
    v_max3_f32 v193, v188, v189, v190
    v_max3_f32 v192, v192, v187, v191
    v_max_f32 v192, v192, v193
    s_waitcnt lgkmcnt(1)
    v_mfma_f32_16x16x32_bf16 v[180:183], v[4:7], v[204:207], 0
    ds_read_b128 v[212:215], v245 offset:9216
    v_mov_b32 v193, v192
    v_mfma_f32_16x16x32_bf16 v[168:171], a[0:3], v[204:207], 0
    s_nop 0
    v_permlane16_swap_b32 v192, v193
    v_mfma_f32_16x16x32_bf16 v[172:175], a[80:83], v[204:207], 0
    v_max_f32 v192, v192, v193
    v_mov_b32 v193, v192
    v_mfma_f32_16x16x32_bf16 v[176:179], v[204:207], a[160:163], 0
    s_waitcnt lgkmcnt(1)
    v_permlane32_swap_b32 v192, v193
    v_mfma_f32_16x16x32_bf16 v[180:183], v[8:11], v[208:211], v[180:183]
    ds_read_b128 v[204:207], v246 offset:9216
    v_max_f32 v192, v192, v193
    v_mfma_f32_16x16x32_bf16 v[168:171], a[4:7], v[208:211], v[168:171]
    v_mul_f32 v192, s77, v192
    v_fma_f32 v184, v184, s77, -v192
    v_mfma_f32_16x16x32_bf16 v[172:175], a[84:87], v[208:211], v[172:175]
    v_fma_f32 v185, v185, s77, -v192
    v_fma_f32 v186, v186, s77, -v192
    v_mfma_f32_16x16x32_bf16 v[176:179], v[208:211], a[164:167], v[176:179]
    s_waitcnt lgkmcnt(1)
    v_fma_f32 v187, v187, s77, -v192
    v_fma_f32 v188, v188, s77, -v192
    v_mfma_f32_16x16x32_bf16 v[180:183], v[12:15], v[212:215], v[180:183]
    ds_read_b128 v[208:211], v245 offset:10240
    v_fma_f32 v189, v189, s77, -v192
    v_mfma_f32_16x16x32_bf16 v[168:171], a[8:11], v[212:215], v[168:171]
    v_fma_f32 v190, v190, s77, -v192
    v_fma_f32 v191, v191, s77, -v192
    v_mfma_f32_16x16x32_bf16 v[172:175], a[88:91], v[212:215], v[172:175]
    v_exp_f32 v184, v184
    v_mfma_f32_16x16x32_bf16 v[176:179], v[212:215], a[168:171], v[176:179]
    v_exp_f32 v185, v185
    s_waitcnt vmcnt(0)
    s_cmp_eq_u32 s80, 0
    s_cbranch_scc1 Lowed_96
    s_waitcnt vmcnt(0)
    v_mov_b32 v2, s62
    s_mov_b64 exec, 1
    buffer_store_dword v2, off, s[4:7], s63 sc1
    buffer_store_dword v2, off, s[4:7], s3
    s_mov_b64 exec, -1
    s_mov_b32 s80, 0
Lowed_96:
    s_add_u32 s65, s62, s75
    s_add_u32 s65, s65, 3
    v_cmp_gt_u32 vcc, s65, v254
    s_cbranch_vccz Lpre_97
    s_waitcnt lgkmcnt(1)
    v_mfma_f32_16x16x32_bf16 v[180:183], v[16:19], v[204:207], v[180:183]
    ds_read_b128 v[212:215], v246 offset:10240
    v_mfma_f32_16x16x32_bf16 v[168:171], a[12:15], v[204:207], v[168:171]
    v_exp_f32 v186, v186
    v_mfma_f32_16x16x32_bf16 v[172:175], a[92:95], v[204:207], v[172:175]
    v_exp_f32 v187, v187
    v_mfma_f32_16x16x32_bf16 v[176:179], v[204:207], a[172:175], v[176:179]
    s_waitcnt lgkmcnt(1)
    v_exp_f32 v188, v188
    v_mfma_f32_16x16x32_bf16 v[180:183], v[20:23], v[208:211], v[180:183]
    ds_read_b128 v[204:207], v245 offset:11264
    v_mfma_f32_16x16x32_bf16 v[168:171], a[16:19], v[208:211], v[168:171]
    v_exp_f32 v189, v189
    v_mfma_f32_16x16x32_bf16 v[172:175], a[96:99], v[208:211], v[172:175]
    v_exp_f32 v190, v190
    v_mfma_f32_16x16x32_bf16 v[176:179], v[208:211], a[176:179], v[176:179]
    s_waitcnt lgkmcnt(1)
    v_exp_f32 v191, v191
    v_mfma_f32_16x16x32_bf16 v[180:183], v[24:27], v[212:215], v[180:183]
    ds_read_b128 v[208:211], v246 offset:11264
    v_cvt_pk_bf16_f32 v184, v184, v185
    v_mfma_f32_16x16x32_bf16 v[168:171], a[20:23], v[212:215], v[168:171]
    v_cvt_pk_bf16_f32 v185, v186, v187
    v_cvt_pk_bf16_f32 v186, v188, v189
    v_mfma_f32_16x16x32_bf16 v[172:175], a[100:103], v[212:215], v[172:175]
    v_cvt_pk_bf16_f32 v187, v190, v191
    s_nop 0
    v_mfma_f32_16x16x32_bf16 v[176:179], v[212:215], a[180:183], v[176:179]
    v_mfma_f32_16x16x32_bf16 v[200:203], v[236:239], v[184:187], 0
    s_nop 2
    v_mfma_f32_16x16x32_bf16 v[196:199], v[232:235], v[184:187], 0
Lback_98:
    s_waitcnt lgkmcnt(1)
    v_mfma_f32_16x16x32_bf16 v[180:183], v[28:31], v[204:207], v[180:183]
    ds_read_b128 v[212:215], v245 offset:12288
    v_mfma_f32_16x16x32_bf16 v[168:171], a[24:27], v[204:207], v[168:171]
    v_rcp_f32 v201, v201
    v_mfma_f32_16x16x32_bf16 v[172:175], a[104:107], v[204:207], v[172:175]
    v_mul_f32 v200, v200, v201
    s_nop 0
    v_mul_f32 v196, v196, v201
    v_mfma_f32_16x16x32_bf16 v[176:179], v[204:207], a[184:187], v[176:179]
    s_waitcnt lgkmcnt(1)
    v_mul_f32 v197, v197, v201
    v_mul_f32 v198, v198, v201
    v_mfma_f32_16x16x32_bf16 v[180:183], v[32:35], v[208:211], v[180:183]
    ds_read_b128 v[204:207], v246 offset:12288
    v_mul_f32 v199, v199, v201
    v_mfma_f32_16x16x32_bf16 v[168:171], a[28:31], v[208:211], v[168:171]
    v_cvt_pk_bf16_f32 v200, v200, v200
    v_cvt_pk_bf16_f32 v196, v196, v197
    v_mfma_f32_16x16x32_bf16 v[172:175], a[108:111], v[208:211], v[172:175]
    v_cvt_pk_bf16_f32 v197, v198, v199
    v_mfma_f32_16x16x32_bf16 v[176:179], v[208:211], a[188:191], v[176:179]
    s_waitcnt lgkmcnt(1)
    ds_write_b16 v250, v200 offset:2048
    v_mfma_f32_16x16x32_bf16 v[180:183], v[36:39], v[212:215], v[180:183]
    ds_read_b128 v[208:211], v245 offset:13312
    v_mfma_f32_16x16x32_bf16 v[168:171], a[32:35], v[212:215], v[168:171]
    ds_write_b64 v249, v[196:197] offset:0
    v_mfma_f32_16x16x32_bf16 v[172:175], a[112:115], v[212:215], v[172:175]
    v_mfma_f32_16x16x32_bf16 v[176:179], v[212:215], a[192:195], v[176:179]
    s_waitcnt lgkmcnt(3)
    v_mfma_f32_16x16x32_bf16 v[180:183], v[40:43], v[204:207], v[180:183]
    ds_read_b128 v[212:215], v246 offset:13312
    v_mfma_f32_16x16x32_bf16 v[168:171], a[36:39], v[204:207], v[168:171]
    v_mfma_f32_16x16x32_bf16 v[172:175], a[116:119], v[204:207], v[172:175]
    s_waitcnt lgkmcnt(1)
    s_barrier
    ds_read_b64 v[240:241], v255 offset:2048
    ds_read_b128 v[220:223], v247 offset:0
    v_mfma_f32_16x16x32_bf16 v[176:179], v[204:207], a[196:199], v[176:179]
    ds_read_b128 v[216:219], v247 offset:1024
    v_mfma_f32_16x16x32_bf16 v[180:183], v[44:47], v[208:211], v[180:183]
    ds_read_b128 v[204:207], v245 offset:14336
    v_mfma_f32_16x16x32_bf16 v[168:171], a[40:43], v[208:211], v[168:171]
    v_mfma_f32_16x16x32_bf16 v[172:175], a[120:123], v[208:211], v[172:175]
    v_mfma_f32_16x16x32_bf16 v[176:179], v[208:211], a[200:203], v[176:179]
    s_waitcnt lgkmcnt(3)
    v_mfma_f32_16x16x16_bf16 v[184:187], a[240:241], v[240:241], 0
    v_mfma_f32_16x16x16_bf16 v[188:191], a[242:243], v[240:241], 0
    v_mfma_f32_16x16x16_bf16 v[192:195], a[244:245], v[240:241], 0
    v_mfma_f32_16x16x16_bf16 v[196:199], a[246:247], v[240:241], 0
    v_mfma_f32_16x16x16_bf16 v[200:203], a[248:249], v[240:241], 0
    v_mfma_f32_16x16x32_bf16 v[180:183], v[48:51], v[212:215], v[180:183]
    ds_read_b128 v[208:211], v246 offset:14336
    v_mfma_f32_16x16x32_bf16 v[168:171], a[44:47], v[212:215], v[168:171]
    v_mfma_f32_16x16x32_bf16 v[172:175], a[124:127], v[212:215], v[172:175]
    v_mfma_f32_16x16x32_bf16 v[176:179], v[212:215], a[204:207], v[176:179]
    s_waitcnt lgkmcnt(3)
    v_mfma_f32_16x16x32_bf16 v[184:187], v[84:87], v[220:223], v[184:187]
    v_mfma_f32_16x16x32_bf16 v[188:191], v[92:95], v[220:223], v[188:191]
    s_waitcnt lgkmcnt(2)
    v_mfma_f32_16x16x32_bf16 v[184:187], v[88:91], v[216:219], v[184:187]
    s_nop 2
    v_mfma_f32_16x16x32_bf16 v[188:191], v[96:99], v[216:219], v[188:191]
    s_nop 2
    v_mfma_f32_16x16x32_bf16 v[192:195], v[100:103], v[220:223], v[192:195]
    v_cvt_pk_bf16_f32 v184, v184, v185
    v_cvt_pk_bf16_f32 v185, v186, v187
    v_mfma_f32_16x16x32_bf16 v[196:199], v[108:111], v[220:223], v[196:199]
    s_nop 0
    v_cvt_pk_bf16_f32 v186, v188, v189
    v_cvt_pk_bf16_f32 v187, v190, v191
    v_mfma_f32_16x16x32_bf16 v[192:195], v[104:107], v[216:219], v[192:195]
    buffer_store_dwordx4 v[184:187], v251, s[4:7], s78 offen offset:0 sc1
    s_nop 4
    v_mfma_f32_16x16x32_bf16 v[196:199], v[112:115], v[216:219], v[196:199]
    s_nop 0
    v_cvt_pk_bf16_f32 v192, v192, v193
    v_cvt_pk_bf16_f32 v193, v194, v195
    v_mfma_f32_16x16x32_bf16 v[200:203], v[116:119], v[220:223], v[200:203]
    s_nop 2
    v_mfma_f32_16x16x32_bf16 v[200:203], v[120:123], v[216:219], v[200:203]
    v_cvt_pk_bf16_f32 v194, v196, v197
    v_cvt_pk_bf16_f32 v195, v198, v199
    s_waitcnt lgkmcnt(1)
    v_mfma_f32_16x16x32_bf16 v[180:183], v[52:55], v[204:207], v[180:183]
    ds_read_b128 v[212:215], v245 offset:15360
    v_mfma_f32_16x16x32_bf16 v[168:171], a[48:51], v[204:207], v[168:171]
    buffer_store_dwordx4 v[192:195], v251, s[4:7], s79 offen offset:0 sc1
    s_nop 0
    v_cvt_pk_bf16_f32 v200, v200, v201
    v_cvt_pk_bf16_f32 v201, v202, v203
    v_mfma_f32_16x16x32_bf16 v[172:175], a[128:131], v[204:207], v[172:175]
    buffer_store_dwordx2 v[200:201], v252, s[4:7], s73 offen offset:512 sc1
    v_mfma_f32_16x16x32_bf16 v[176:179], v[204:207], a[208:211], v[176:179]
    s_waitcnt lgkmcnt(1)
    v_mfma_f32_16x16x32_bf16 v[180:183], v[56:59], v[208:211], v[180:183]
    ds_read_b128 v[204:207], v246 offset:15360
    v_mfma_f32_16x16x32_bf16 v[168:171], a[52:55], v[208:211], v[168:171]
    v_mfma_f32_16x16x32_bf16 v[172:175], a[132:135], v[208:211], v[172:175]
    v_mfma_f32_16x16x32_bf16 v[176:179], v[208:211], a[212:215], v[176:179]
    v_mfma_f32_16x16x16_bf16 v[184:187], a[250:251], v[240:241], 0
    v_mfma_f32_16x16x16_bf16 v[188:191], a[252:253], v[240:241], 0
    v_mfma_f32_16x16x16_bf16 v[192:195], a[254:255], v[240:241], 0
    v_mfma_f32_16x16x16_bf16 v[196:199], v[164:165], v[240:241], 0
    v_mfma_f32_16x16x16_bf16 v[200:203], v[166:167], v[240:241], 0
    s_waitcnt lgkmcnt(1)
    v_mfma_f32_16x16x32_bf16 v[180:183], v[60:63], v[212:215], v[180:183]
    ds_read_b128 v[208:211], v245 offset:16384
    v_mfma_f32_16x16x32_bf16 v[168:171], a[56:59], v[212:215], v[168:171]
    v_mfma_f32_16x16x32_bf16 v[172:175], a[136:139], v[212:215], v[172:175]
    v_mfma_f32_16x16x32_bf16 v[176:179], v[212:215], a[216:219], v[176:179]
    v_mfma_f32_16x16x32_bf16 v[184:187], v[124:127], v[220:223], v[184:187]
    v_mfma_f32_16x16x32_bf16 v[188:191], v[132:135], v[220:223], v[188:191]
    v_mfma_f32_16x16x32_bf16 v[184:187], v[128:131], v[216:219], v[184:187]
    s_nop 2
    v_mfma_f32_16x16x32_bf16 v[188:191], v[136:139], v[216:219], v[188:191]
    s_nop 2
    v_mfma_f32_16x16x32_bf16 v[192:195], v[140:143], v[220:223], v[192:195]
    v_cvt_pk_bf16_f32 v184, v184, v185
    v_cvt_pk_bf16_f32 v185, v186, v187
    v_mfma_f32_16x16x32_bf16 v[196:199], v[148:151], v[220:223], v[196:199]
    s_nop 0
    v_cvt_pk_bf16_f32 v186, v188, v189
    v_cvt_pk_bf16_f32 v187, v190, v191
    v_mfma_f32_16x16x32_bf16 v[192:195], v[144:147], v[216:219], v[192:195]
    buffer_store_dwordx4 v[184:187], v251, s[4:7], s78 offen offset:1024 sc1
    s_nop 4
    v_mfma_f32_16x16x32_bf16 v[196:199], v[152:155], v[216:219], v[196:199]
    s_nop 0
    v_cvt_pk_bf16_f32 v192, v192, v193
    v_cvt_pk_bf16_f32 v193, v194, v195
    v_mfma_f32_16x16x32_bf16 v[200:203], v[156:159], v[220:223], v[200:203]
    s_nop 2
    v_mfma_f32_16x16x32_bf16 v[200:203], v[160:163], v[216:219], v[200:203]
    v_cvt_pk_bf16_f32 v194, v196, v197
    v_cvt_pk_bf16_f32 v195, v198, v199
    s_waitcnt lgkmcnt(1)
    v_mfma_f32_16x16x32_bf16 v[180:183], v[64:67], v[204:207], v[180:183]
    ds_read_b128 v[212:215], v246 offset:16384
    v_mfma_f32_16x16x32_bf16 v[168:171], a[60:63], v[204:207], v[168:171]
    buffer_store_dwordx4 v[192:195], v251, s[4:7], s79 offen offset:1024 sc1
    s_nop 0
    v_cvt_pk_bf16_f32 v200, v200, v201
    v_cvt_pk_bf16_f32 v201, v202, v203
    v_mfma_f32_16x16x32_bf16 v[172:175], a[140:143], v[204:207], v[172:175]
    buffer_store_dwordx2 v[200:201], v252, s[4:7], s73 offen offset:1536 sc1
    ds_read_b128 v[184:187], v248 offset:5120
    ds_read_b128 v[188:191], v247 offset:6144
    v_mfma_f32_16x16x32_bf16 v[176:179], v[204:207], a[220:223], v[176:179]
    s_waitcnt lgkmcnt(3)
    v_mfma_f32_16x16x32_bf16 v[180:183], v[68:71], v[208:211], v[180:183]
    ds_read_b128 v[204:207], v245 offset:17408
    v_mfma_f32_16x16x32_bf16 v[168:171], a[64:67], v[208:211], v[168:171]
    v_mfma_f32_16x16x32_bf16 v[172:175], a[144:147], v[208:211], v[172:175]
    v_mfma_f32_16x16x32_bf16 v[176:179], v[208:211], a[224:227], v[176:179]
    s_waitcnt lgkmcnt(3)
    v_mfma_f32_16x16x32_bf16 v[180:183], v[72:75], v[212:215], v[180:183]
    ds_read_b128 v[208:211], v246 offset:17408
    v_mfma_f32_16x16x32_bf16 v[168:171], a[68:71], v[212:215], v[168:171]
    v_mfma_f32_16x16x32_bf16 v[172:175], a[148:151], v[212:215], v[172:175]
    v_mfma_f32_16x16x32_bf16 v[176:179], v[212:215], a[228:231], v[176:179]
    s_waitcnt lgkmcnt(1)
    v_mfma_f32_16x16x32_bf16 v[180:183], v[76:79], v[204:207], v[180:183]
    v_mfma_f32_16x16x32_bf16 v[168:171], a[72:75], v[204:207], v[168:171]
    v_mfma_f32_16x16x32_bf16 v[172:175], a[152:155], v[204:207], v[172:175]
    v_mfma_f32_16x16x32_bf16 v[176:179], v[204:207], a[232:235], v[176:179]
    s_waitcnt lgkmcnt(0)
    v_mfma_f32_16x16x32_bf16 v[180:183], v[80:83], v[208:211], v[180:183]
    s_nop 2
    v_mfma_f32_16x16x32_bf16 v[168:171], a[76:79], v[208:211], v[168:171]
    s_nop 2
    v_mfma_f32_16x16x32_bf16 v[172:175], a[156:159], v[208:211], v[172:175]
    s_nop 2
    v_mfma_f32_16x16x32_bf16 v[176:179], v[208:211], a[236:239], v[176:179]
    s_add_u32 s62, s62, 1
    s_mov_b32 s80, 1
    s_waitcnt vmcnt(6)
    s_branch L_Be0
Lgrty_71:
    s_sleep 16
    buffer_load_dword v2, off, s[8:11], 0 offset:132 sc1
    s_sub_u32 s61, s61, 1
    s_mov_b32 s67, 1
    s_cbranch_scc1 L_fail
    s_branch Lgchk_70
Lprty_74:
    s_sleep 16
    buffer_load_dword v2, off, s[8:11], 0 offset:140 sc1
    s_sub_u32 s61, s61, 1
    s_mov_b32 s67, 16
    s_cbranch_scc1 L_fail
    s_branch Lpchk_73
Lfrty_77:
    s_sleep 4
    buffer_load_dword v254, v253, s[4:7], 0 offen sc1
    s_sub_u32 s61, s61, 1
    s_mov_b32 s67, 30
    s_cbranch_scc1 L_fail
    s_waitcnt vmcnt(0)
    s_branch Lfchk_76
Lpre_79:
    s_waitcnt lgkmcnt(1)
    v_mfma_f32_16x16x32_bf16 v[180:183], v[44:47], v[208:211], v[180:183]
    s_movk_i32 s75, 1000
    s_add_u32 m0, s74, 28672
    s_add_u32 s64, s70, 36864
    ds_read_b128 v[204:207], v245 offset:14336
    ds_read_b128 v[184:187], v248 offset:5120
    v_mfma_f32_16x16x32_bf16 v[168:171], a[40:43], v[208:211], v[168:171]
    buffer_load_dwordx4 v244, s[4:7], s64 offen sc1 lds
    s_add_u32 m0, s74, 32768
    s_add_u32 s64, s70, 49152
    ds_read_b128 v[188:191], v247 offset:6144
    v_mfma_f32_16x16x32_bf16 v[172:175], a[120:123], v[208:211], v[172:175]
    buffer_load_dwordx4 v244, s[4:7], s64 offen sc1 lds
    s_add_u32 m0, s74, 36864
    s_add_u32 s64, s70, 53248
    v_mfma_f32_16x16x32_bf16 v[176:179], v[208:211], a[200:203], v[176:179]
    buffer_load_dwordx4 v244, s[4:7], s64 offen sc1 lds
    s_add_u32 m0, s74, 40960
    s_add_u32 s64, s70, 65536
    s_waitcnt lgkmcnt(3)
    v_mfma_f32_16x16x32_bf16 v[180:183], v[48:51], v[212:215], v[180:183]
    buffer_load_dwordx4 v244, s[4:7], s64 offen sc1 lds
    s_add_u32 m0, s74, 45056
    s_add_u32 s64, s70, 69632
    ds_read_b128 v[208:211], v246 offset:14336
    v_mfma_f32_16x16x32_bf16 v[168:171], a[44:47], v[212:215], v[168:171]
    buffer_load_dwordx4 v244, s[4:7], s64 offen sc1 lds
    s_add_u32 s71, s71, 131072
    s_lshr_b32 s70, s71, 8
    v_mfma_f32_16x16x32_bf16 v[172:175], a[124:127], v[212:215], v[172:175]
    s_xor_b32 s70, s70, s1
    s_and_b32 s70, s70, 0x2000
    s_or_b32 s70, s70, s71
    v_mfma_f32_16x16x32_bf16 v[176:179], v[212:215], a[204:207], v[176:179]
    s_waitcnt lgkmcnt(3)
    v_mfma_f32_16x16x32_bf16 v[180:183], v[52:55], v[204:207], v[180:183]
    ds_read_b128 v[212:215], v245 offset:15360
    v_mfma_f32_16x16x32_bf16 v[168:171], a[48:51], v[204:207], v[168:171]
    v_mfma_f32_16x16x32_bf16 v[172:175], a[128:131], v[204:207], v[172:175]
    v_mfma_f32_16x16x32_bf16 v[176:179], v[204:207], a[208:211], v[176:179]
    s_waitcnt lgkmcnt(1)
    v_mfma_f32_16x16x32_bf16 v[180:183], v[56:59], v[208:211], v[180:183]
    ds_read_b128 v[204:207], v246 offset:15360
    v_mfma_f32_16x16x32_bf16 v[168:171], a[52:55], v[208:211], v[168:171]
    v_mfma_f32_16x16x32_bf16 v[172:175], a[132:135], v[208:211], v[172:175]
    v_mfma_f32_16x16x32_bf16 v[176:179], v[208:211], a[212:215], v[176:179]
    s_waitcnt lgkmcnt(1)
    v_mfma_f32_16x16x32_bf16 v[180:183], v[60:63], v[212:215], v[180:183]
    ds_read_b128 v[208:211], v245 offset:16384
    v_mfma_f32_16x16x32_bf16 v[168:171], a[56:59], v[212:215], v[168:171]
    v_mfma_f32_16x16x32_bf16 v[172:175], a[136:139], v[212:215], v[172:175]
    v_mfma_f32_16x16x32_bf16 v[176:179], v[212:215], a[216:219], v[176:179]
    s_waitcnt lgkmcnt(1)
    v_mfma_f32_16x16x32_bf16 v[180:183], v[64:67], v[204:207], v[180:183]
    ds_read_b128 v[212:215], v246 offset:16384
    v_mfma_f32_16x16x32_bf16 v[168:171], a[60:63], v[204:207], v[168:171]
    v_mfma_f32_16x16x32_bf16 v[172:175], a[140:143], v[204:207], v[172:175]
    v_mfma_f32_16x16x32_bf16 v[176:179], v[204:207], a[220:223], v[176:179]
    s_waitcnt lgkmcnt(1)
    v_mfma_f32_16x16x32_bf16 v[180:183], v[68:71], v[208:211], v[180:183]
    ds_read_b128 v[204:207], v245 offset:17408
    v_mfma_f32_16x16x32_bf16 v[168:171], a[64:67], v[208:211], v[168:171]
    v_mfma_f32_16x16x32_bf16 v[172:175], a[144:147], v[208:211], v[172:175]
    v_mfma_f32_16x16x32_bf16 v[176:179], v[208:211], a[224:227], v[176:179]
    s_waitcnt lgkmcnt(1)
    v_mfma_f32_16x16x32_bf16 v[180:183], v[72:75], v[212:215], v[180:183]
    ds_read_b128 v[208:211], v246 offset:17408
    v_mfma_f32_16x16x32_bf16 v[168:171], a[68:71], v[212:215], v[168:171]
    v_mfma_f32_16x16x32_bf16 v[172:175], a[148:151], v[212:215], v[172:175]
    v_mfma_f32_16x16x32_bf16 v[176:179], v[212:215], a[228:231], v[176:179]
    s_waitcnt lgkmcnt(1)
    v_mfma_f32_16x16x32_bf16 v[180:183], v[76:79], v[204:207], v[180:183]
    v_mfma_f32_16x16x32_bf16 v[168:171], a[72:75], v[204:207], v[168:171]
    v_mfma_f32_16x16x32_bf16 v[172:175], a[152:155], v[204:207], v[172:175]
    v_mfma_f32_16x16x32_bf16 v[176:179], v[204:207], a[232:235], v[176:179]
    s_waitcnt lgkmcnt(0)
    v_mfma_f32_16x16x32_bf16 v[180:183], v[80:83], v[208:211], v[180:183]
    s_nop 2
    v_mfma_f32_16x16x32_bf16 v[168:171], a[76:79], v[208:211], v[168:171]
    s_nop 2
    v_mfma_f32_16x16x32_bf16 v[172:175], a[156:159], v[208:211], v[172:175]
    s_nop 2
    v_mfma_f32_16x16x32_bf16 v[176:179], v[208:211], a[236:239], v[176:179]
    s_branch Lback_80
Lpre_82:
    s_waitcnt lgkmcnt(2)
    v_mfma_f32_16x16x16_bf16 v[168:171], a[240:241], v[240:241], 0
    s_movk_i32 s75, 1000
    s_add_u32 m0, s74, 28672
    s_add_u32 s64, s70, 36864
    v_mfma_f32_16x16x16_bf16 v[172:175], a[242:243], v[240:241], 0
    buffer_load_dwordx4 v244, s[4:7], s64 offen sc1 lds
    s_add_u32 m0, s74, 32768
    s_add_u32 s64, s70, 49152
    v_mfma_f32_16x16x16_bf16 v[176:179], a[244:245], v[240:241], 0
    buffer_load_dwordx4 v244, s[4:7], s64 offen sc1 lds
    s_add_u32 m0, s74, 36864
    s_add_u32 s64, s70, 53248
    v_mfma_f32_16x16x16_bf16 v[180:183], a[246:247], v[240:241], 0
    buffer_load_dwordx4 v244, s[4:7], s64 offen sc1 lds
    s_add_u32 m0, s74, 40960
    s_add_u32 s64, s70, 65536
    v_mfma_f32_16x16x16_bf16 v[204:207], a[248:249], v[240:241], 0
    buffer_load_dwordx4 v244, s[4:7], s64 offen sc1 lds
    s_add_u32 m0, s74, 45056
    s_add_u32 s64, s70, 69632
    v_mfma_f32_16x16x16_bf16 v[184:187], a[250:251], v[240:241], 0
    buffer_load_dwordx4 v244, s[4:7], s64 offen sc1 lds
    s_add_u32 s71, s71, 131072
    s_lshr_b32 s70, s71, 8
    v_mfma_f32_16x16x16_bf16 v[188:191], a[252:253], v[240:241], 0
    s_xor_b32 s70, s70, s1
    s_and_b32 s70, s70, 0x2000
    s_or_b32 s70, s70, s71
    v_mfma_f32_16x16x16_bf16 v[192:195], a[254:255], v[240:241], 0
    v_mfma_f32_16x16x16_bf16 v[196:199], v[164:165], v[240:241], 0
    v_mfma_f32_16x16x16_bf16 v[200:203], v[166:167], v[240:241], 0
    s_branch Lback_83
Lfrty_86:
    s_sleep 4
    buffer_load_dword v254, v253, s[4:7], 0 offen sc1
    s_sub_u32 s61, s61, 1
    s_mov_b32 s67, 30
    s_cbranch_scc1 L_fail
    s_waitcnt vmcnt(0)
    s_branch Lfchk_85
Lpre_88:
    s_waitcnt lgkmcnt(1)
    v_mfma_f32_16x16x32_bf16 v[180:183], v[44:47], v[208:211], v[180:183]
    s_movk_i32 s75, 1000
    s_add_u32 m0, s74, 8192
    s_add_u32 s64, s70, 0
    ds_read_b128 v[204:207], v245 offset:34816
    ds_read_b128 v[188:191], v247 offset:5120
    v_mfma_f32_16x16x32_bf16 v[168:171], a[40:43], v[208:211], v[168:171]
    buffer_load_dwordx4 v244, s[4:7], s64 offen sc1 lds
    s_add_u32 m0, s74, 12288
    s_add_u32 s64, s70, 4096
    ds_read_b128 v[184:187], v247 offset:6144
    v_mfma_f32_16x16x32_bf16 v[172:175], a[120:123], v[208:211], v[172:175]
    buffer_load_dwordx4 v244, s[4:7], s64 offen sc1 lds
    s_add_u32 m0, s74, 16384
    s_add_u32 s64, s70, 16384
    v_mfma_f32_16x16x32_bf16 v[176:179], v[208:211], a[200:203], v[176:179]
    buffer_load_dwordx4 v244, s[4:7], s64 offen sc1 lds
    s_add_u32 m0, s74, 20480
    s_add_u32 s64, s70, 20480
    s_waitcnt lgkmcnt(3)
    v_mfma_f32_16x16x32_bf16 v[180:183], v[48:51], v[212:215], v[180:183]
    buffer_load_dwordx4 v244, s[4:7], s64 offen sc1 lds
    s_add_u32 m0, s74, 24576
    s_add_u32 s64, s70, 32768
    ds_read_b128 v[208:211], v246 offset:34816
    v_mfma_f32_16x16x32_bf16 v[168:171], a[44:47], v[212:215], v[168:171]
    buffer_load_dwordx4 v244, s[4:7], s64 offen sc1 lds
    v_mfma_f32_16x16x32_bf16 v[172:175], a[124:127], v[212:215], v[172:175]
    v_mfma_f32_16x16x32_bf16 v[176:179], v[212:215], a[204:207], v[176:179]
    s_waitcnt lgkmcnt(3)
    v_mfma_f32_16x16x32_bf16 v[180:183], v[52:55], v[204:207], v[180:183]
    ds_read_b128 v[212:215], v245 offset:35840
    v_mfma_f32_16x16x32_bf16 v[168:171], a[48:51], v[204:207], v[168:171]
    v_mfma_f32_16x16x32_bf16 v[172:175], a[128:131], v[204:207], v[172:175]
    v_mfma_f32_16x16x32_bf16 v[176:179], v[204:207], a[208:211], v[176:179]
    s_waitcnt lgkmcnt(1)
    v_mfma_f32_16x16x32_bf16 v[180:183], v[56:59], v[208:211], v[180:183]
    ds_read_b128 v[204:207], v246 offset:35840
    v_mfma_f32_16x16x32_bf16 v[168:171], a[52:55], v[208:211], v[168:171]
    v_mfma_f32_16x16x32_bf16 v[172:175], a[132:135], v[208:211], v[172:175]
    v_mfma_f32_16x16x32_bf16 v[176:179], v[208:211], a[212:215], v[176:179]
    s_waitcnt lgkmcnt(1)
    v_mfma_f32_16x16x32_bf16 v[180:183], v[60:63], v[212:215], v[180:183]
    ds_read_b128 v[208:211], v245 offset:36864
    v_mfma_f32_16x16x32_bf16 v[168:171], a[56:59], v[212:215], v[168:171]
    v_mfma_f32_16x16x32_bf16 v[172:175], a[136:139], v[212:215], v[172:175]
    v_mfma_f32_16x16x32_bf16 v[176:179], v[212:215], a[216:219], v[176:179]
    s_waitcnt lgkmcnt(1)
    v_mfma_f32_16x16x32_bf16 v[180:183], v[64:67], v[204:207], v[180:183]
    ds_read_b128 v[212:215], v246 offset:36864
    v_mfma_f32_16x16x32_bf16 v[168:171], a[60:63], v[204:207], v[168:171]
    v_mfma_f32_16x16x32_bf16 v[172:175], a[140:143], v[204:207], v[172:175]
    v_mfma_f32_16x16x32_bf16 v[176:179], v[204:207], a[220:223], v[176:179]
    s_waitcnt lgkmcnt(1)
    v_mfma_f32_16x16x32_bf16 v[180:183], v[68:71], v[208:211], v[180:183]
    ds_read_b128 v[204:207], v245 offset:37888
    v_mfma_f32_16x16x32_bf16 v[168:171], a[64:67], v[208:211], v[168:171]
    v_mfma_f32_16x16x32_bf16 v[172:175], a[144:147], v[208:211], v[172:175]
    v_mfma_f32_16x16x32_bf16 v[176:179], v[208:211], a[224:227], v[176:179]
    s_waitcnt lgkmcnt(1)
    v_mfma_f32_16x16x32_bf16 v[180:183], v[72:75], v[212:215], v[180:183]
    ds_read_b128 v[208:211], v246 offset:37888
    v_mfma_f32_16x16x32_bf16 v[168:171], a[68:71], v[212:215], v[168:171]
    v_mfma_f32_16x16x32_bf16 v[172:175], a[148:151], v[212:215], v[172:175]
    v_mfma_f32_16x16x32_bf16 v[176:179], v[212:215], a[228:231], v[176:179]
    s_waitcnt lgkmcnt(1)
    v_mfma_f32_16x16x32_bf16 v[180:183], v[76:79], v[204:207], v[180:183]
    v_mfma_f32_16x16x32_bf16 v[168:171], a[72:75], v[204:207], v[168:171]
    v_mfma_f32_16x16x32_bf16 v[172:175], a[152:155], v[204:207], v[172:175]
    v_mfma_f32_16x16x32_bf16 v[176:179], v[204:207], a[232:235], v[176:179]
    s_waitcnt lgkmcnt(0)
    v_mfma_f32_16x16x32_bf16 v[180:183], v[80:83], v[208:211], v[180:183]
    s_nop 2
    v_mfma_f32_16x16x32_bf16 v[168:171], a[76:79], v[208:211], v[168:171]
    s_nop 2
    v_mfma_f32_16x16x32_bf16 v[172:175], a[156:159], v[208:211], v[172:175]
    s_nop 2
    v_mfma_f32_16x16x32_bf16 v[176:179], v[208:211], a[236:239], v[176:179]
    s_branch Lback_89
Lpre_91:
    s_waitcnt lgkmcnt(2)
    v_mfma_f32_16x16x16_bf16 v[168:171], a[240:241], v[240:241], 0
    s_movk_i32 s75, 1000
    s_add_u32 m0, s74, 8192
    s_add_u32 s64, s70, 0
    v_mfma_f32_16x16x16_bf16 v[172:175], a[242:243], v[240:241], 0
    buffer_load_dwordx4 v244, s[4:7], s64 offen sc1 lds
    s_add_u32 m0, s74, 12288
    s_add_u32 s64, s70, 4096
    v_mfma_f32_16x16x16_bf16 v[176:179], a[244:245], v[240:241], 0
    buffer_load_dwordx4 v244, s[4:7], s64 offen sc1 lds
    s_add_u32 m0, s74, 16384
    s_add_u32 s64, s70, 16384
    v_mfma_f32_16x16x16_bf16 v[180:183], a[246:247], v[240:241], 0
    buffer_load_dwordx4 v244, s[4:7], s64 offen sc1 lds
    s_add_u32 m0, s74, 20480
    s_add_u32 s64, s70, 20480
    v_mfma_f32_16x16x16_bf16 v[204:207], a[248:249], v[240:241], 0
    buffer_load_dwordx4 v244, s[4:7], s64 offen sc1 lds
    s_add_u32 m0, s74, 24576
    s_add_u32 s64, s70, 32768
    v_mfma_f32_16x16x16_bf16 v[184:187], a[250:251], v[240:241], 0
    buffer_load_dwordx4 v244, s[4:7], s64 offen sc1 lds
    v_mfma_f32_16x16x16_bf16 v[188:191], a[252:253], v[240:241], 0
    v_mfma_f32_16x16x16_bf16 v[192:195], a[254:255], v[240:241], 0
    v_mfma_f32_16x16x16_bf16 v[196:199], v[164:165], v[240:241], 0
    v_mfma_f32_16x16x16_bf16 v[200:203], v[166:167], v[240:241], 0
    s_branch Lback_92
Lpre_94:
    s_waitcnt lgkmcnt(1)
    v_mfma_f32_16x16x32_bf16 v[180:183], v[16:19], v[204:207], v[180:183]
    s_movk_i32 s75, 1000
    s_add_u32 m0, s74, 8192
    s_add_u32 s64, s70, 0
    ds_read_b128 v[212:215], v246 offset:30720
    v_mfma_f32_16x16x32_bf16 v[168:171], a[12:15], v[204:207], v[168:171]
    buffer_load_dwordx4 v244, s[4:7], s64 offen sc1 lds
    s_add_u32 m0, s74, 12288
    s_add_u32 s64, s70, 4096
    v_exp_f32 v186, v186
    v_mfma_f32_16x16x32_bf16 v[172:175], a[92:95], v[204:207], v[172:175]
    buffer_load_dwordx4 v244, s[4:7], s64 offen sc1 lds
    s_add_u32 m0, s74, 16384
    s_add_u32 s64, s70, 16384
    v_exp_f32 v187, v187
    v_mfma_f32_16x16x32_bf16 v[176:179], v[204:207], a[172:175], v[176:179]
    buffer_load_dwordx4 v244, s[4:7], s64 offen sc1 lds
    s_add_u32 m0, s74, 20480
    s_add_u32 s64, s70, 20480
    s_waitcnt lgkmcnt(1)
    v_exp_f32 v188, v188
    v_mfma_f32_16x16x32_bf16 v[180:183], v[20:23], v[208:211], v[180:183]
    buffer_load_dwordx4 v244, s[4:7], s64 offen sc1 lds
    s_add_u32 m0, s74, 24576
    s_add_u32 s64, s70, 32768
    ds_read_b128 v[204:207], v245 offset:31744
    v_mfma_f32_16x16x32_bf16 v[168:171], a[16:19], v[208:211], v[168:171]
    buffer_load_dwordx4 v244, s[4:7], s64 offen sc1 lds
    v_exp_f32 v189, v189
    v_mfma_f32_16x16x32_bf16 v[172:175], a[96:99], v[208:211], v[172:175]
    v_exp_f32 v190, v190
    v_mfma_f32_16x16x32_bf16 v[176:179], v[208:211], a[176:179], v[176:179]
    s_waitcnt lgkmcnt(1)
    v_exp_f32 v191, v191
    v_mfma_f32_16x16x32_bf16 v[180:183], v[24:27], v[212:215], v[180:183]
    ds_read_b128 v[208:211], v246 offset:31744
    v_cvt_pk_bf16_f32 v184, v184, v185
    v_mfma_f32_16x16x32_bf16 v[168:171], a[20:23], v[212:215], v[168:171]
    v_cvt_pk_bf16_f32 v185, v186, v187
    v_cvt_pk_bf16_f32 v186, v188, v189
    v_mfma_f32_16x16x32_bf16 v[172:175], a[100:103], v[212:215], v[172:175]
    v_cvt_pk_bf16_f32 v187, v190, v191
    s_nop 0
    v_mfma_f32_16x16x32_bf16 v[176:179], v[212:215], a[180:183], v[176:179]
    v_mfma_f32_16x16x32_bf16 v[200:203], v[236:239], v[184:187], 0
    s_nop 2
    v_mfma_f32_16x16x32_bf16 v[196:199], v[232:235], v[184:187], 0
    s_branch Lback_95
Lpre_97:
    s_waitcnt lgkmcnt(1)
    v_mfma_f32_16x16x32_bf16 v[180:183], v[16:19], v[204:207], v[180:183]
    s_movk_i32 s75, 1000
    s_add_u32 m0, s74, 28672
    s_add_u32 s64, s70, 36864
    ds_read_b128 v[212:215], v246 offset:10240
    v_mfma_f32_16x16x32_bf16 v[168:171], a[12:15], v[204:207], v[168:171]
    buffer_load_dwordx4 v244, s[4:7], s64 offen sc1 lds
    s_add_u32 m0, s74, 32768
    s_add_u32 s64, s70, 49152
    v_exp_f32 v186, v186
    v_mfma_f32_16x16x32_bf16 v[172:175], a[92:95], v[204:207], v[172:175]
    buffer_load_dwordx4 v244, s[4:7], s64 offen sc1 lds
    s_add_u32 m0, s74, 36864
    s_add_u32 s64, s70, 53248
    v_exp_f32 v187, v187
    v_mfma_f32_16x16x32_bf16 v[176:179], v[204:207], a[172:175], v[176:179]
    buffer_load_dwordx4 v244, s[4:7], s64 offen sc1 lds
    s_add_u32 m0, s74, 40960
    s_add_u32 s64, s70, 65536
    s_waitcnt lgkmcnt(1)
    v_exp_f32 v188, v188
    v_mfma_f32_16x16x32_bf16 v[180:183], v[20:23], v[208:211], v[180:183]
    buffer_load_dwordx4 v244, s[4:7], s64 offen sc1 lds
    s_add_u32 m0, s74, 45056
    s_add_u32 s64, s70, 69632
    ds_read_b128 v[204:207], v245 offset:11264
    v_mfma_f32_16x16x32_bf16 v[168:171], a[16:19], v[208:211], v[168:171]
    buffer_load_dwordx4 v244, s[4:7], s64 offen sc1 lds
    s_add_u32 s71, s71, 131072
    s_lshr_b32 s70, s71, 8
    v_exp_f32 v189, v189
    v_mfma_f32_16x16x32_bf16 v[172:175], a[96:99], v[208:211], v[172:175]
    s_xor_b32 s70, s70, s1
    s_and_b32 s70, s70, 0x2000
    s_or_b32 s70, s70, s71
    v_exp_f32 v190, v190
    v_mfma_f32_16x16x32_bf16 v[176:179], v[208:211], a[176:179], v[176:179]
    s_waitcnt lgkmcnt(1)
    v_exp_f32 v191, v191
    v_mfma_f32_16x16x32_bf16 v[180:183], v[24:27], v[212:215], v[180:183]
    ds_read_b128 v[208:211], v246 offset:11264
    v_cvt_pk_bf16_f32 v184, v184, v185
    v_mfma_f32_16x16x32_bf16 v[168:171], a[20:23], v[212:215], v[168:171]
    v_cvt_pk_bf16_f32 v185, v186, v187
    v_cvt_pk_bf16_f32 v186, v188, v189
    v_mfma_f32_16x16x32_bf16 v[172:175], a[100:103], v[212:215], v[172:175]
    v_cvt_pk_bf16_f32 v187, v190, v191
    s_nop 0
    v_mfma_f32_16x16x32_bf16 v[176:179], v[212:215], a[180:183], v[176:179]
    v_mfma_f32_16x16x32_bf16 v[200:203], v[236:239], v[184:187], 0
    s_nop 2
    v_mfma_f32_16x16x32_bf16 v[196:199], v[232:235], v[184:187], 0
    s_branch Lback_98
L_roleR:
    s_cmp_lg_u32 s68, 0
    s_cbranch_scc1 Larr0_99
    s_waitcnt vmcnt(0)
    s_barrier
    s_cmp_lg_u32 s60, 0
    s_cbranch_scc1 Lcnt_100
    s_mov_b64 exec, 1
    v_mov_b32 v2, 1
    buffer_atomic_add v2, off, s[8:11], 0 offset:4 sc0
    v_mov_b32 v3, 0x80000000
    s_waitcnt vmcnt(0)
    v_cmp_ne_u32 vcc, 255, v2
    s_nop 1
    v_cndmask_b32 v3, 4, v3, vcc
    buffer_store_dword v2, v3, s[8:11], 0 offen offset:128 sc1
    s_mov_b64 exec, -1
Lcnt_100:
Larr0_99:
    s_and_b32 s64, s59, 1
    s_lshl_b32 s76, s68, 1
    s_add_u32 s76, s76, s64
    s_cmp_eq_u32 s76, 0
    s_cselect_b32 s16, s32, s56
    s_cselect_b32 s17, s33, s57
    s_cselect_b32 s18, 2621440, s6
    s_mov_b32 s19, 0x20000
    s_cmp_eq_u32 s76, 3
    s_cselect_b32 s20, s52, s56
    s_cselect_b32 s21, s53, s57
    s_cselect_b32 s22, 2621440, s6
    s_mov_b32 s23, 0x20000
    s_mov_b32 s72, 0
    s_mov_b32 s73, 50331648
    s_mov_b32 s74, 33554432
    s_cmp_eq_u32 s76, 1
    s_cselect_b32 s72, 50331648, s72
    s_cselect_b32 s73, 56623104, s73
    s_cselect_b32 s74, 25165824, s74
    s_cmp_eq_u32 s76, 2
    s_cselect_b32 s72, 56623104, s72
    s_cselect_b32 s73, 52953088, s73
    s_cselect_b32 s74, 41943040, s74
    s_cmp_eq_u32 s76, 3
    s_cselect_b32 s72, 52953088, s72
    s_cselect_b32 s73, 0, s73
    s_cselect_b32 s74, 0, s74
    s_cmp_eq_u32 s76, 1
    s_cselect_b32 s79, 0x2000, 0
    s_cmp_lg_u32 s60, 0
    s_cbranch_scc1 Lgskip_103
    buffer_load_dword v2, off, s[8:11], 0 offset:132 sc1
Lgchk_101:
    s_waitcnt vmcnt(0)
    v_cmp_eq_u32 vcc, 0, v2
    s_cbranch_vccnz Lgrty_102
Lgskip_103:
    s_waitcnt lgkmcnt(0)
    s_barrier
    buffer_load_dword v2, off, s[8:11], 0 offset:140 sc1
Lpchk_104:
    s_waitcnt vmcnt(0)
    v_cmp_eq_u32 vcc, 0, v2
    s_cbranch_vccnz Lprty_105
    v_readfirstlane_b32 s1, v2
    s_cmp_gt_u32 s1, 17
    s_cselect_b32 s1, 1, 0
    s_xor_b32 s1, s1, s68
    s_lshl_b32 s1, s1, 13
    s_lshl_b32 s63, s58, 18
    s_and_b32 s64, s3, 0xfff
    s_add_u32 s63, s63, s64
    s_add_u32 s63, s63, 14819328
    s_xor_b32 s63, s63, s1
    s_xor_b32 s63, s63, s79
    s_xor_b32 s79, s79, s1
    s_mov_b32 s71, 142606336
    s_bitcmp0_b32 s76, 0
    s_cselect_b32 s71, 75497472, s71
    s_cselect_b32 s65, 24, 28
    s_cselect_b32 s66, 15, 7
    v_and_b32 v92, s66, v0
    v_mov_b32 v71, s65
    v_lshl_add_u32 v92, v71, 2, v92
    v_lshlrev_b32 v92, 7, v92
    v_bfe_u32 v71, v0, 4, 2
    v_cmp_eq_u32 vcc, s69, v71
    s_xor_b32 s64, s1, 0x2000
    s_add_u32 s64, s64, 14798848
    v_lshl_add_u32 v71, v71, 18, s64
    s_lshl_b32 s64, s68, 20
    v_add_u32 v71, s64, v71
    s_lshl_b32 s64, s58, 14
    s_add_u32 s64, s64, 8388608
    v_mov_b32 v2, s64
    v_cndmask_b32 v71, v71, v2, vcc
    v_add_u32 v92, v92, v71
    v_and_b32 v70, 63, v0
    s_lshl_b32 s64, s69, 2
    s_add_u32 s64, s64, s60
    s_mul_i32 s65, s64, 1280
    v_lshl_add_u32 v86, v70, 4, s65
    v_lshl_add_u32 v87, v70, 2, s65
    v_bfe_u32 v71, v70, 2, 3
    v_lshlrev_b32 v82, 10, v71
    v_lshrrev_b32 v71, 5, v70
    v_lshl_add_u32 v82, v71, 15, v82
    v_and_b32 v71, 3, v70
    v_lshl_add_u32 v82, v71, 4, v82
    s_lshl_b32 s65, s64, 6
    v_add_u32 v82, s65, v82
    v_add_u32 v83, 16384, v82
    v_lshrrev_b32 v71, 3, v70
    v_lshlrev_b32 v84, 10, v71
    v_and_b32 v71, 7, v70
    v_lshl_add_u32 v84, v71, 2, v84
    s_lshl_b32 s65, s64, 5
    s_add_u32 s65, s65, 65536
    v_add_u32 v84, s65, v84
    v_add_u32 v85, 512, v84
    s_lshr_b32 s65, s64, 3
    s_mul_i32 s65, s65, 10
    s_and_b32 s64, s64, 7
    s_lshl_b32 s66, s64, 7
    v_lshrrev_b32 v71, 3, v70
    v_add3_u32 v88, v71, s65, 0
    v_lshrrev_b32 v71, 3, v88
    v_lshlrev_b32 v88, 10, v88
    v_lshl_add_u32 v88, v71, 13, v88
    v_and_b32 v71, 7, v70
    v_xor_b32 v71, s64, v71
    v_lshl_add_u32 v71, v71, 4, s66
    v_add_u32 v88, v88, v71
    v_lshrrev_b32 v71, 5, v70
    v_add3_u32 v90, v71, s65, 8
    v_lshrrev_b32 v71, 3, v90
    v_lshlrev_b32 v90, 10, v90
    v_lshl_add_u32 v90, v71, 13, v90
    v_bfe_u32 v71, v70, 2, 3
    v_xor_b32 v71, s64, v71
    v_lshl_add_u32 v71, v71, 4, s66
    v_and_b32 v72, 3, v70
    v_lshl_add_u32 v71, v72, 2, v71
    v_add_u32 v90, v90, v71
    v_lshrrev_b32 v71, 3, v70
    v_add3_u32 v89, v71, s65, 20
    v_lshrrev_b32 v71, 3, v89
    v_lshlrev_b32 v89, 10, v89
    v_lshl_add_u32 v89, v71, 13, v89
    v_and_b32 v71, 7, v70
    v_xor_b32 v71, s64, v71
    v_lshl_add_u32 v71, v71, 4, s66
    v_add_u32 v89, v89, v71
    v_lshrrev_b32 v71, 5, v70
    v_add3_u32 v91, v71, s65, 28
    v_lshrrev_b32 v71, 3, v91
    v_lshlrev_b32 v91, 10, v91
    v_lshl_add_u32 v91, v71, 13, v91
    v_bfe_u32 v71, v70, 2, 3
    v_xor_b32 v71, s64, v71
    v_lshl_add_u32 v71, v71, 4, s66
    v_and_b32 v72, 3, v70
    v_lshl_add_u32 v71, v72, 2, v71
    v_add_u32 v91, v91, v71
    s_mov_b32 s77, 0x3f80
    s_mov_b32 s78, 0x3f800000
L_Rseg:
    buffer_load_dword v93, v92, s[4:7], 0 offen sc1
    s_waitcnt vmcnt(0)
    v_mov_b32 v80, s62
    s_mov_b64 exec, 1
    buffer_store_dword v80, off, s[4:7], s63 sc1
    buffer_store_dword v80, off, s[4:7], s3
    s_mov_b64 exec, -1
    s_add_u32 s65, s62, 1
Lfchk_106:
    v_cmp_gt_u32 vcc, s65, v93
    s_cbranch_vccnz Lfrty_107
    s_lshr_b32 s70, s71, 8
    s_xor_b32 s70, s70, s1
    s_and_b32 s70, s70, 0x2000
    s_or_b32 s70, s70, s71
    buffer_load_dwordx4 v[4:7], v82, s[4:7], s70 offen sc1
    buffer_load_dword v8, v84, s[4:7], s70 offen sc1
    s_add_u32 s70, s70, 81920
    buffer_load_dwordx4 v[10:13], v82, s[4:7], s70 offen sc1
    buffer_load_dword v14, v84, s[4:7], s70 offen sc1
    s_add_u32 s70, s70, 81920
    buffer_load_dwordx4 v[16:19], v82, s[4:7], s70 offen sc1
    buffer_load_dword v20, v84, s[4:7], s70 offen sc1
    s_add_u32 s70, s70, 81920
    buffer_load_dwordx4 v[22:25], v82, s[4:7], s70 offen sc1
    buffer_load_dword v26, v84, s[4:7], s70 offen sc1
    s_add_u32 s70, s70, 81920
    buffer_load_dwordx4 v[28:31], v82, s[4:7], s70 offen sc1
    buffer_load_dword v32, v84, s[4:7], s70 offen sc1
    s_add_u32 s70, s70, 81920
    buffer_load_dwordx4 v[34:37], v82, s[4:7], s70 offen sc1
    buffer_load_dword v38, v84, s[4:7], s70 offen sc1
    s_add_u32 s70, s70, 81920
    buffer_load_dwordx4 v[40:43], v82, s[4:7], s70 offen sc1
    buffer_load_dword v44, v84, s[4:7], s70 offen sc1
    s_add_u32 s70, s70, 81920
    buffer_load_dwordx4 v[46:49], v82, s[4:7], s70 offen sc1
    buffer_load_dword v50, v84, s[4:7], s70 offen sc1
    s_add_u32 s70, s70, 81920
    buffer_load_dwordx4 v[52:55], v86, s[16:19], s72 offen sc1
    buffer_load_dword v56, v87, s[16:19], s72 offen offset:1024 sc1
    s_add_u32 s72, s72, 20480
    buffer_load_dword v93, v92, s[4:7], 0 offen sc1
    s_waitcnt vmcnt(18)
    v_lshlrev_b32 v70, 16, v4
    v_and_b32 v71, 0xffff0000, v4
    v_lshlrev_b32 v72, 16, v5
    v_and_b32 v73, 0xffff0000, v5
    v_lshlrev_b32 v74, 16, v6
    v_and_b32 v75, 0xffff0000, v6
    v_lshlrev_b32 v76, 16, v7
    v_and_b32 v77, 0xffff0000, v7
    s_waitcnt vmcnt(17)
    v_lshlrev_b32 v78, 16, v8
    v_and_b32 v79, 0xffff0000, v8
    s_waitcnt vmcnt(16)
    v_dot2_f32_bf16 v70, v10, s77, v70
    v_dot2_f32_bf16 v71, v10, s78, v71
    v_dot2_f32_bf16 v72, v11, s77, v72
    v_dot2_f32_bf16 v73, v11, s78, v73
    v_dot2_f32_bf16 v74, v12, s77, v74
    v_dot2_f32_bf16 v75, v12, s78, v75
    v_dot2_f32_bf16 v76, v13, s77, v76
    v_dot2_f32_bf16 v77, v13, s78, v77
    s_waitcnt vmcnt(15)
    v_dot2_f32_bf16 v78, v14, s77, v78
    v_dot2_f32_bf16 v79, v14, s78, v79
    s_waitcnt vmcnt(14)
    v_dot2_f32_bf16 v70, v16, s77, v70
    v_dot2_f32_bf16 v71, v16, s78, v71
    v_dot2_f32_bf16 v72, v17, s77, v72
    v_dot2_f32_bf16 v73, v17, s78, v73
    v_dot2_f32_bf16 v74, v18, s77, v74
    v_dot2_f32_bf16 v75, v18, s78, v75
    v_dot2_f32_bf16 v76, v19, s77, v76
    v_dot2_f32_bf16 v77, v19, s78, v77
    s_waitcnt vmcnt(13)
    v_dot2_f32_bf16 v78, v20, s77, v78
    v_dot2_f32_bf16 v79, v20, s78, v79
    s_waitcnt vmcnt(12)
    v_dot2_f32_bf16 v70, v22, s77, v70
    v_dot2_f32_bf16 v71, v22, s78, v71
    v_dot2_f32_bf16 v72, v23, s77, v72
    v_dot2_f32_bf16 v73, v23, s78, v73
    v_dot2_f32_bf16 v74, v24, s77, v74
    v_dot2_f32_bf16 v75, v24, s78, v75
    v_dot2_f32_bf16 v76, v25, s77, v76
    v_dot2_f32_bf16 v77, v25, s78, v77
    s_waitcnt vmcnt(11)
    v_dot2_f32_bf16 v78, v26, s77, v78
    v_dot2_f32_bf16 v79, v26, s78, v79
    s_waitcnt vmcnt(10)
    v_dot2_f32_bf16 v70, v28, s77, v70
    v_dot2_f32_bf16 v71, v28, s78, v71
    v_dot2_f32_bf16 v72, v29, s77, v72
    v_dot2_f32_bf16 v73, v29, s78, v73
    v_dot2_f32_bf16 v74, v30, s77, v74
    v_dot2_f32_bf16 v75, v30, s78, v75
    v_dot2_f32_bf16 v76, v31, s77, v76
    v_dot2_f32_bf16 v77, v31, s78, v77
    s_waitcnt vmcnt(9)
    v_dot2_f32_bf16 v78, v32, s77, v78
    v_dot2_f32_bf16 v79, v32, s78, v79
    s_waitcnt vmcnt(8)
    v_dot2_f32_bf16 v70, v34, s77, v70
    v_dot2_f32_bf16 v71, v34, s78, v71
    v_dot2_f32_bf16 v72, v35, s77, v72
    v_dot2_f32_bf16 v73, v35, s78, v73
    v_dot2_f32_bf16 v74, v36, s77, v74
    v_dot2_f32_bf16 v75, v36, s78, v75
    v_dot2_f32_bf16 v76, v37, s77, v76
    v_dot2_f32_bf16 v77, v37, s78, v77
    s_waitcnt vmcnt(7)
    v_dot2_f32_bf16 v78, v38, s77, v78
    v_dot2_f32_bf16 v79, v38, s78, v79
    s_waitcnt vmcnt(6)
    v_dot2_f32_bf16 v70, v40, s77, v70
    v_dot2_f32_bf16 v71, v40, s78, v71
    v_dot2_f32_bf16 v72, v41, s77, v72
    v_dot2_f32_bf16 v73, v41, s78, v73
    v_dot2_f32_bf16 v74, v42, s77, v74
    v_dot2_f32_bf16 v75, v42, s78, v75
    v_dot2_f32_bf16 v76, v43, s77, v76
    v_dot2_f32_bf16 v77, v43, s78, v77
    s_waitcnt vmcnt(5)
    v_dot2_f32_bf16 v78, v44, s77, v78
    v_dot2_f32_bf16 v79, v44, s78, v79
    s_waitcnt vmcnt(4)
    v_dot2_f32_bf16 v70, v46, s77, v70
    v_dot2_f32_bf16 v71, v46, s78, v71
    v_dot2_f32_bf16 v72, v47, s77, v72
    v_dot2_f32_bf16 v73, v47, s78, v73
    v_dot2_f32_bf16 v74, v48, s77, v74
    v_dot2_f32_bf16 v75, v48, s78, v75
    v_dot2_f32_bf16 v76, v49, s77, v76
    v_dot2_f32_bf16 v77, v49, s78, v77
    s_waitcnt vmcnt(3)
    v_dot2_f32_bf16 v78, v50, s77, v78
    v_dot2_f32_bf16 v79, v50, s78, v79
    s_waitcnt vmcnt(2)
    v_dot2_f32_bf16 v70, v52, s77, v70
    v_dot2_f32_bf16 v71, v52, s78, v71
    v_dot2_f32_bf16 v72, v53, s77, v72
    v_dot2_f32_bf16 v73, v53, s78, v73
    v_dot2_f32_bf16 v74, v54, s77, v74
    v_dot2_f32_bf16 v75, v54, s78, v75
    v_dot2_f32_bf16 v76, v55, s77, v76
    v_dot2_f32_bf16 v77, v55, s78, v77
    s_waitcnt vmcnt(1)
    v_dot2_f32_bf16 v78, v56, s77, v78
    v_dot2_f32_bf16 v79, v56, s78, v79
    v_cvt_pk_bf16_f32 v58, v70, v71
    v_cvt_pk_bf16_f32 v59, v72, v73
    v_cvt_pk_bf16_f32 v60, v74, v75
    v_cvt_pk_bf16_f32 v61, v76, v77
    v_cvt_pk_bf16_f32 v62, v78, v79
    s_waitcnt vmcnt(0)
L_Rsum0:
    s_add_u32 s65, s62, 2
    v_cmp_gt_u32 vcc, s65, v93
    s_cbranch_vccz L_Rpre0
    buffer_store_dwordx4 v[58:61], v86, s[20:23], s73 offen sc1
    buffer_store_dword v62, v87, s[20:23], s73 offen offset:1024 sc1
    s_add_u32 s73, s73, 20480
    s_cmp_eq_u32 s76, 3
    s_cbranch_scc1 Lnonorm_108
    s_lshr_b32 s75, s74, 8
    s_xor_b32 s75, s75, s79
    s_and_b32 s75, s75, 0x2000
    s_or_b32 s75, s75, s74
    v_lshlrev_b32 v70, 16, v58
    v_and_b32 v71, 0xffff0000, v58
    v_lshlrev_b32 v72, 16, v59
    v_and_b32 v73, 0xffff0000, v59
    v_lshlrev_b32 v74, 16, v60
    v_and_b32 v75, 0xffff0000, v60
    v_lshlrev_b32 v76, 16, v61
    v_and_b32 v77, 0xffff0000, v61
    v_lshlrev_b32 v78, 16, v62
    v_and_b32 v79, 0xffff0000, v62
    v_pk_add_f32 v[80:81], v[70:71], v[72:73]
    v_pk_add_f32 v[80:81], v[80:81], v[74:75]
    v_pk_add_f32 v[80:81], v[80:81], v[76:77]
    v_pk_add_f32 v[80:81], v[80:81], v[78:79]
    v_add_f32 v80, v80, v81
    s_nop 1
    v_add_f32_dpp v80, v80, v80 quad_perm:[1,0,3,2] row_mask:0xf bank_mask:0xf
    s_nop 1
    v_add_f32_dpp v80, v80, v80 quad_perm:[2,3,0,1] row_mask:0xf bank_mask:0xf
    s_nop 1
    v_add_f32_dpp v80, v80, v80 row_half_mirror row_mask:0xf bank_mask:0xf
    s_nop 1
    v_add_f32_dpp v80, v80, v80 row_mirror row_mask:0xf bank_mask:0xf
    v_mov_b32 v81, v80
    s_nop 1
    v_permlane16_swap_b32 v80, v81
    v_add_f32 v80, v80, v81
    v_mov_b32 v81, v80
    s_nop 1
    v_permlane32_swap_b32 v80, v81
    v_add_f32 v80, v80, v81
    v_mul_f32 v80, 0xbacccccd, v80
    v_pk_add_f32 v[70:71], v[70:71], v[80:81] op_sel_hi:[1,0]
    v_pk_add_f32 v[72:73], v[72:73], v[80:81] op_sel_hi:[1,0]
    v_pk_add_f32 v[74:75], v[74:75], v[80:81] op_sel_hi:[1,0]
    v_pk_add_f32 v[76:77], v[76:77], v[80:81] op_sel_hi:[1,0]
    v_pk_add_f32 v[78:79], v[78:79], v[80:81] op_sel_hi:[1,0]
    v_pk_mul_f32 v[80:81], v[70:71], v[70:71]
    v_pk_fma_f32 v[80:81], v[72:73], v[72:73], v[80:81]
    v_pk_fma_f32 v[80:81], v[74:75], v[74:75], v[80:81]
    v_pk_fma_f32 v[80:81], v[76:77], v[76:77], v[80:81]
    v_pk_fma_f32 v[80:81], v[78:79], v[78:79], v[80:81]
    v_add_f32 v80, v80, v81
    s_nop 1
    v_add_f32_dpp v80, v80, v80 quad_perm:[1,0,3,2] row_mask:0xf bank_mask:0xf
    s_nop 1
    v_add_f32_dpp v80, v80, v80 quad_perm:[2,3,0,1] row_mask:0xf bank_mask:0xf
    s_nop 1
    v_add_f32_dpp v80, v80, v80 row_half_mirror row_mask:0xf bank_mask:0xf
    s_nop 1
    v_add_f32_dpp v80, v80, v80 row_mirror row_mask:0xf bank_mask:0xf
    v_mov_b32 v81, v80
    s_nop 1
    v_permlane16_swap_b32 v80, v81
    v_add_f32 v80, v80, v81
    v_mov_b32 v81, v80
    s_nop 1
    v_permlane32_swap_b32 v80, v81
    v_add_f32 v80, v80, v81
    v_mov_b32 v81, 0x3727c5ac
    v_fmac_f32 v81, 0x3acccccd, v80
    v_rsq_f32 v80, v81
    s_nop 0
    v_pk_mul_f32 v[70:71], v[70:71], v[80:81] op_sel_hi:[1,0]
    v_pk_mul_f32 v[72:73], v[72:73], v[80:81] op_sel_hi:[1,0]
    v_pk_mul_f32 v[74:75], v[74:75], v[80:81] op_sel_hi:[1,0]
    v_pk_mul_f32 v[76:77], v[76:77], v[80:81] op_sel_hi:[1,0]
    v_pk_mul_f32 v[78:79], v[78:79], v[80:81] op_sel_hi:[1,0]
    v_cvt_pk_bf16_f32 v64, v70, v71
    v_cvt_pk_bf16_f32 v65, v72, v73
    v_cvt_pk_bf16_f32 v66, v74, v75
    v_cvt_pk_bf16_f32 v67, v76, v77
    v_cvt_pk_bf16_f32 v68, v78, v79
    buffer_store_dwordx4 v[64:67], v88, s[4:7], s75 offen sc1
    buffer_store_dword v68, v90, s[4:7], s75 offen sc1
Lnonorm_108:
    s_add_u32 s62, s62, 1
    buffer_load_dword v93, v92, s[4:7], 0 offen sc1
    s_waitcnt vmcnt(0)
    v_mov_b32 v80, s62
    s_mov_b64 exec, 1
    buffer_store_dword v80, off, s[4:7], s63 sc1
    buffer_store_dword v80, off, s[4:7], s3
    s_mov_b64 exec, -1
    s_add_u32 s65, s62, 1
Lfchk_109:
    v_cmp_gt_u32 vcc, s65, v93
    s_cbranch_vccnz Lfrty_110
    s_lshr_b32 s70, s71, 8
    s_xor_b32 s70, s70, s1
    s_and_b32 s70, s70, 0x2000
    s_or_b32 s70, s70, s71
    buffer_load_dwordx4 v[4:7], v83, s[4:7], s70 offen sc1
    buffer_load_dword v8, v85, s[4:7], s70 offen sc1
    s_add_u32 s70, s70, 81920
    buffer_load_dwordx4 v[10:13], v83, s[4:7], s70 offen sc1
    buffer_load_dword v14, v85, s[4:7], s70 offen sc1
    s_add_u32 s70, s70, 81920
    buffer_load_dwordx4 v[16:19], v83, s[4:7], s70 offen sc1
    buffer_load_dword v20, v85, s[4:7], s70 offen sc1
    s_add_u32 s70, s70, 81920
    buffer_load_dwordx4 v[22:25], v83, s[4:7], s70 offen sc1
    buffer_load_dword v26, v85, s[4:7], s70 offen sc1
    s_add_u32 s70, s70, 81920
    buffer_load_dwordx4 v[28:31], v83, s[4:7], s70 offen sc1
    buffer_load_dword v32, v85, s[4:7], s70 offen sc1
    s_add_u32 s70, s70, 81920
    buffer_load_dwordx4 v[34:37], v83, s[4:7], s70 offen sc1
    buffer_load_dword v38, v85, s[4:7], s70 offen sc1
    s_add_u32 s70, s70, 81920
    buffer_load_dwordx4 v[40:43], v83, s[4:7], s70 offen sc1
    buffer_load_dword v44, v85, s[4:7], s70 offen sc1
    s_add_u32 s70, s70, 81920
    buffer_load_dwordx4 v[46:49], v83, s[4:7], s70 offen sc1
    buffer_load_dword v50, v85, s[4:7], s70 offen sc1
    s_add_u32 s70, s70, 81920
    buffer_load_dwordx4 v[52:55], v86, s[16:19], s72 offen sc1
    buffer_load_dword v56, v87, s[16:19], s72 offen offset:1024 sc1
    s_add_u32 s72, s72, 20480
    s_add_u32 s71, s71, 1048576
    buffer_load_dword v93, v92, s[4:7], 0 offen sc1
    s_waitcnt vmcnt(18)
    v_lshlrev_b32 v70, 16, v4
    v_and_b32 v71, 0xffff0000, v4
    v_lshlrev_b32 v72, 16, v5
    v_and_b32 v73, 0xffff0000, v5
    v_lshlrev_b32 v74, 16, v6
    v_and_b32 v75, 0xffff0000, v6
    v_lshlrev_b32 v76, 16, v7
    v_and_b32 v77, 0xffff0000, v7
    s_waitcnt vmcnt(17)
    v_lshlrev_b32 v78, 16, v8
    v_and_b32 v79, 0xffff0000, v8
    s_waitcnt vmcnt(16)
    v_dot2_f32_bf16 v70, v10, s77, v70
    v_dot2_f32_bf16 v71, v10, s78, v71
    v_dot2_f32_bf16 v72, v11, s77, v72
    v_dot2_f32_bf16 v73, v11, s78, v73
    v_dot2_f32_bf16 v74, v12, s77, v74
    v_dot2_f32_bf16 v75, v12, s78, v75
    v_dot2_f32_bf16 v76, v13, s77, v76
    v_dot2_f32_bf16 v77, v13, s78, v77
    s_waitcnt vmcnt(15)
    v_dot2_f32_bf16 v78, v14, s77, v78
    v_dot2_f32_bf16 v79, v14, s78, v79
    s_waitcnt vmcnt(14)
    v_dot2_f32_bf16 v70, v16, s77, v70
    v_dot2_f32_bf16 v71, v16, s78, v71
    v_dot2_f32_bf16 v72, v17, s77, v72
    v_dot2_f32_bf16 v73, v17, s78, v73
    v_dot2_f32_bf16 v74, v18, s77, v74
    v_dot2_f32_bf16 v75, v18, s78, v75
    v_dot2_f32_bf16 v76, v19, s77, v76
    v_dot2_f32_bf16 v77, v19, s78, v77
    s_waitcnt vmcnt(13)
    v_dot2_f32_bf16 v78, v20, s77, v78
    v_dot2_f32_bf16 v79, v20, s78, v79
    s_waitcnt vmcnt(12)
    v_dot2_f32_bf16 v70, v22, s77, v70
    v_dot2_f32_bf16 v71, v22, s78, v71
    v_dot2_f32_bf16 v72, v23, s77, v72
    v_dot2_f32_bf16 v73, v23, s78, v73
    v_dot2_f32_bf16 v74, v24, s77, v74
    v_dot2_f32_bf16 v75, v24, s78, v75
    v_dot2_f32_bf16 v76, v25, s77, v76
    v_dot2_f32_bf16 v77, v25, s78, v77
    s_waitcnt vmcnt(11)
    v_dot2_f32_bf16 v78, v26, s77, v78
    v_dot2_f32_bf16 v79, v26, s78, v79
    s_waitcnt vmcnt(10)
    v_dot2_f32_bf16 v70, v28, s77, v70
    v_dot2_f32_bf16 v71, v28, s78, v71
    v_dot2_f32_bf16 v72, v29, s77, v72
    v_dot2_f32_bf16 v73, v29, s78, v73
    v_dot2_f32_bf16 v74, v30, s77, v74
    v_dot2_f32_bf16 v75, v30, s78, v75
    v_dot2_f32_bf16 v76, v31, s77, v76
    v_dot2_f32_bf16 v77, v31, s78, v77
    s_waitcnt vmcnt(9)
    v_dot2_f32_bf16 v78, v32, s77, v78
    v_dot2_f32_bf16 v79, v32, s78, v79
    s_waitcnt vmcnt(8)
    v_dot2_f32_bf16 v70, v34, s77, v70
    v_dot2_f32_bf16 v71, v34, s78, v71
    v_dot2_f32_bf16 v72, v35, s77, v72
    v_dot2_f32_bf16 v73, v35, s78, v73
    v_dot2_f32_bf16 v74, v36, s77, v74
    v_dot2_f32_bf16 v75, v36, s78, v75
    v_dot2_f32_bf16 v76, v37, s77, v76
    v_dot2_f32_bf16 v77, v37, s78, v77
    s_waitcnt vmcnt(7)
    v_dot2_f32_bf16 v78, v38, s77, v78
    v_dot2_f32_bf16 v79, v38, s78, v79
    s_waitcnt vmcnt(6)
    v_dot2_f32_bf16 v70, v40, s77, v70
    v_dot2_f32_bf16 v71, v40, s78, v71
    v_dot2_f32_bf16 v72, v41, s77, v72
    v_dot2_f32_bf16 v73, v41, s78, v73
    v_dot2_f32_bf16 v74, v42, s77, v74
    v_dot2_f32_bf16 v75, v42, s78, v75
    v_dot2_f32_bf16 v76, v43, s77, v76
    v_dot2_f32_bf16 v77, v43, s78, v77
    s_waitcnt vmcnt(5)
    v_dot2_f32_bf16 v78, v44, s77, v78
    v_dot2_f32_bf16 v79, v44, s78, v79
    s_waitcnt vmcnt(4)
    v_dot2_f32_bf16 v70, v46, s77, v70
    v_dot2_f32_bf16 v71, v46, s78, v71
    v_dot2_f32_bf16 v72, v47, s77, v72
    v_dot2_f32_bf16 v73, v47, s78, v73
    v_dot2_f32_bf16 v74, v48, s77, v74
    v_dot2_f32_bf16 v75, v48, s78, v75
    v_dot2_f32_bf16 v76, v49, s77, v76
    v_dot2_f32_bf16 v77, v49, s78, v77
    s_waitcnt vmcnt(3)
    v_dot2_f32_bf16 v78, v50, s77, v78
    v_dot2_f32_bf16 v79, v50, s78, v79
    s_waitcnt vmcnt(2)
    v_dot2_f32_bf16 v70, v52, s77, v70
    v_dot2_f32_bf16 v71, v52, s78, v71
    v_dot2_f32_bf16 v72, v53, s77, v72
    v_dot2_f32_bf16 v73, v53, s78, v73
    v_dot2_f32_bf16 v74, v54, s77, v74
    v_dot2_f32_bf16 v75, v54, s78, v75
    v_dot2_f32_bf16 v76, v55, s77, v76
    v_dot2_f32_bf16 v77, v55, s78, v77
    s_waitcnt vmcnt(1)
    v_dot2_f32_bf16 v78, v56, s77, v78
    v_dot2_f32_bf16 v79, v56, s78, v79
    v_cvt_pk_bf16_f32 v58, v70, v71
    v_cvt_pk_bf16_f32 v59, v72, v73
    v_cvt_pk_bf16_f32 v60, v74, v75
    v_cvt_pk_bf16_f32 v61, v76, v77
    v_cvt_pk_bf16_f32 v62, v78, v79
    s_waitcnt vmcnt(0)
L_Rsum1:
    s_add_u32 s65, s62, 2
    v_cmp_gt_u32 vcc, s65, v93
    s_cbranch_vccz L_Rpre1
    buffer_store_dwordx4 v[58:61], v86, s[20:23], s73 offen sc1
    buffer_store_dword v62, v87, s[20:23], s73 offen offset:1024 sc1
    s_add_u32 s73, s73, 20480
    s_cmp_eq_u32 s76, 3
    s_cbranch_scc1 Lnonorm_111
    s_lshr_b32 s75, s74, 8
    s_xor_b32 s75, s75, s79
    s_and_b32 s75, s75, 0x2000
    s_or_b32 s75, s75, s74
    v_lshlrev_b32 v70, 16, v58
    v_and_b32 v71, 0xffff0000, v58
    v_lshlrev_b32 v72, 16, v59
    v_and_b32 v73, 0xffff0000, v59
    v_lshlrev_b32 v74, 16, v60
    v_and_b32 v75, 0xffff0000, v60
    v_lshlrev_b32 v76, 16, v61
    v_and_b32 v77, 0xffff0000, v61
    v_lshlrev_b32 v78, 16, v62
    v_and_b32 v79, 0xffff0000, v62
    v_pk_add_f32 v[80:81], v[70:71], v[72:73]
    v_pk_add_f32 v[80:81], v[80:81], v[74:75]
    v_pk_add_f32 v[80:81], v[80:81], v[76:77]
    v_pk_add_f32 v[80:81], v[80:81], v[78:79]
    v_add_f32 v80, v80, v81
    s_nop 1
    v_add_f32_dpp v80, v80, v80 quad_perm:[1,0,3,2] row_mask:0xf bank_mask:0xf
    s_nop 1
    v_add_f32_dpp v80, v80, v80 quad_perm:[2,3,0,1] row_mask:0xf bank_mask:0xf
    s_nop 1
    v_add_f32_dpp v80, v80, v80 row_half_mirror row_mask:0xf bank_mask:0xf
    s_nop 1
    v_add_f32_dpp v80, v80, v80 row_mirror row_mask:0xf bank_mask:0xf
    v_mov_b32 v81, v80
    s_nop 1
    v_permlane16_swap_b32 v80, v81
    v_add_f32 v80, v80, v81
    v_mov_b32 v81, v80
    s_nop 1
    v_permlane32_swap_b32 v80, v81
    v_add_f32 v80, v80, v81
    v_mul_f32 v80, 0xbacccccd, v80
    v_pk_add_f32 v[70:71], v[70:71], v[80:81] op_sel_hi:[1,0]
    v_pk_add_f32 v[72:73], v[72:73], v[80:81] op_sel_hi:[1,0]
    v_pk_add_f32 v[74:75], v[74:75], v[80:81] op_sel_hi:[1,0]
    v_pk_add_f32 v[76:77], v[76:77], v[80:81] op_sel_hi:[1,0]
    v_pk_add_f32 v[78:79], v[78:79], v[80:81] op_sel_hi:[1,0]
    v_pk_mul_f32 v[80:81], v[70:71], v[70:71]
    v_pk_fma_f32 v[80:81], v[72:73], v[72:73], v[80:81]
    v_pk_fma_f32 v[80:81], v[74:75], v[74:75], v[80:81]
    v_pk_fma_f32 v[80:81], v[76:77], v[76:77], v[80:81]
    v_pk_fma_f32 v[80:81], v[78:79], v[78:79], v[80:81]
    v_add_f32 v80, v80, v81
    s_nop 1
    v_add_f32_dpp v80, v80, v80 quad_perm:[1,0,3,2] row_mask:0xf bank_mask:0xf
    s_nop 1
    v_add_f32_dpp v80, v80, v80 quad_perm:[2,3,0,1] row_mask:0xf bank_mask:0xf
    s_nop 1
    v_add_f32_dpp v80, v80, v80 row_half_mirror row_mask:0xf bank_mask:0xf
    s_nop 1
    v_add_f32_dpp v80, v80, v80 row_mirror row_mask:0xf bank_mask:0xf
    v_mov_b32 v81, v80
    s_nop 1
    v_permlane16_swap_b32 v80, v81
    v_add_f32 v80, v80, v81
    v_mov_b32 v81, v80
    s_nop 1
    v_permlane32_swap_b32 v80, v81
    v_add_f32 v80, v80, v81
    v_mov_b32 v81, 0x3727c5ac
    v_fmac_f32 v81, 0x3acccccd, v80
    v_rsq_f32 v80, v81
    s_nop 0
    v_pk_mul_f32 v[70:71], v[70:71], v[80:81] op_sel_hi:[1,0]
    v_pk_mul_f32 v[72:73], v[72:73], v[80:81] op_sel_hi:[1,0]
    v_pk_mul_f32 v[74:75], v[74:75], v[80:81] op_sel_hi:[1,0]
    v_pk_mul_f32 v[76:77], v[76:77], v[80:81] op_sel_hi:[1,0]
    v_pk_mul_f32 v[78:79], v[78:79], v[80:81] op_sel_hi:[1,0]
    v_cvt_pk_bf16_f32 v64, v70, v71
    v_cvt_pk_bf16_f32 v65, v72, v73
    v_cvt_pk_bf16_f32 v66, v74, v75
    v_cvt_pk_bf16_f32 v67, v76, v77
    v_cvt_pk_bf16_f32 v68, v78, v79
    buffer_store_dwordx4 v[64:67], v89, s[4:7], s75 offen sc1
    buffer_store_dword v68, v91, s[4:7], s75 offen sc1
Lnonorm_111:
    s_add_u32 s74, s74, 131072
    s_add_u32 s62, s62, 1
    s_cmp_lt_u32 s62, 128
    s_cbranch_scc1 L_Rseg
    s_waitcnt vmcnt(0)
    v_mov_b32 v80, s62
    s_mov_b64 exec, 1
    buffer_store_dword v80, off, s[4:7], s63 sc1
    buffer_store_dword v80, off, s[4:7], s3
    s_mov_b64 exec, -1
    s_endpgm
L_Rpre0:
    s_lshr_b32 s70, s71, 8
    s_xor_b32 s70, s70, s1
    s_and_b32 s70, s70, 0x2000
    s_or_b32 s70, s70, s71
    buffer_load_dwordx4 v[4:7], v83, s[4:7], s70 offen sc1
    buffer_load_dword v8, v85, s[4:7], s70 offen sc1
    s_add_u32 s70, s70, 81920
    buffer_load_dwordx4 v[10:13], v83, s[4:7], s70 offen sc1
    buffer_load_dword v14, v85, s[4:7], s70 offen sc1
    s_add_u32 s70, s70, 81920
    buffer_load_dwordx4 v[16:19], v83, s[4:7], s70 offen sc1
    buffer_load_dword v20, v85, s[4:7], s70 offen sc1
    s_add_u32 s70, s70, 81920
    buffer_load_dwordx4 v[22:25], v83, s[4:7], s70 offen sc1
    buffer_load_dword v26, v85, s[4:7], s70 offen sc1
    s_add_u32 s70, s70, 81920
    buffer_load_dwordx4 v[28:31], v83, s[4:7], s70 offen sc1
    buffer_load_dword v32, v85, s[4:7], s70 offen sc1
    s_add_u32 s70, s70, 81920
    buffer_load_dwordx4 v[34:37], v83, s[4:7], s70 offen sc1
    buffer_load_dword v38, v85, s[4:7], s70 offen sc1
    s_add_u32 s70, s70, 81920
    buffer_load_dwordx4 v[40:43], v83, s[4:7], s70 offen sc1
    buffer_load_dword v44, v85, s[4:7], s70 offen sc1
    s_add_u32 s70, s70, 81920
    buffer_load_dwordx4 v[46:49], v83, s[4:7], s70 offen sc1
    buffer_load_dword v50, v85, s[4:7], s70 offen sc1
    s_add_u32 s70, s70, 81920
    buffer_load_dwordx4 v[52:55], v86, s[16:19], s72 offen sc1
    buffer_load_dword v56, v87, s[16:19], s72 offen offset:1024 sc1
    s_add_u32 s72, s72, 20480
    s_add_u32 s71, s71, 1048576
    s_cmp_eq_u32 s76, 3
    s_cbranch_scc1 Lnonorm_112
    s_lshr_b32 s75, s74, 8
    s_xor_b32 s75, s75, s79
    s_and_b32 s75, s75, 0x2000
    s_or_b32 s75, s75, s74
    v_lshlrev_b32 v70, 16, v58
    v_and_b32 v71, 0xffff0000, v58
    v_lshlrev_b32 v72, 16, v59
    v_and_b32 v73, 0xffff0000, v59
    v_lshlrev_b32 v74, 16, v60
    v_and_b32 v75, 0xffff0000, v60
    v_lshlrev_b32 v76, 16, v61
    v_and_b32 v77, 0xffff0000, v61
    v_lshlrev_b32 v78, 16, v62
    v_and_b32 v79, 0xffff0000, v62
    v_pk_add_f32 v[80:81], v[70:71], v[72:73]
    v_pk_add_f32 v[80:81], v[80:81], v[74:75]
    v_pk_add_f32 v[80:81], v[80:81], v[76:77]
    v_pk_add_f32 v[80:81], v[80:81], v[78:79]
    v_add_f32 v80, v80, v81
    s_nop 1
    v_add_f32_dpp v80, v80, v80 quad_perm:[1,0,3,2] row_mask:0xf bank_mask:0xf
    s_nop 1
    v_add_f32_dpp v80, v80, v80 quad_perm:[2,3,0,1] row_mask:0xf bank_mask:0xf
    s_nop 1
    v_add_f32_dpp v80, v80, v80 row_half_mirror row_mask:0xf bank_mask:0xf
    s_nop 1
    v_add_f32_dpp v80, v80, v80 row_mirror row_mask:0xf bank_mask:0xf
    v_mov_b32 v81, v80
    s_nop 1
    v_permlane16_swap_b32 v80, v81
    v_add_f32 v80, v80, v81
    v_mov_b32 v81, v80
    s_nop 1
    v_permlane32_swap_b32 v80, v81
    v_add_f32 v80, v80, v81
    v_mul_f32 v80, 0xbacccccd, v80
    v_pk_add_f32 v[70:71], v[70:71], v[80:81] op_sel_hi:[1,0]
    v_pk_add_f32 v[72:73], v[72:73], v[80:81] op_sel_hi:[1,0]
    v_pk_add_f32 v[74:75], v[74:75], v[80:81] op_sel_hi:[1,0]
    v_pk_add_f32 v[76:77], v[76:77], v[80:81] op_sel_hi:[1,0]
    v_pk_add_f32 v[78:79], v[78:79], v[80:81] op_sel_hi:[1,0]
    v_pk_mul_f32 v[80:81], v[70:71], v[70:71]
    v_pk_fma_f32 v[80:81], v[72:73], v[72:73], v[80:81]
    v_pk_fma_f32 v[80:81], v[74:75], v[74:75], v[80:81]
    v_pk_fma_f32 v[80:81], v[76:77], v[76:77], v[80:81]
    v_pk_fma_f32 v[80:81], v[78:79], v[78:79], v[80:81]
    v_add_f32 v80, v80, v81
    s_nop 1
    v_add_f32_dpp v80, v80, v80 quad_perm:[1,0,3,2] row_mask:0xf bank_mask:0xf
    s_nop 1
    v_add_f32_dpp v80, v80, v80 quad_perm:[2,3,0,1] row_mask:0xf bank_mask:0xf
    s_nop 1
    v_add_f32_dpp v80, v80, v80 row_half_mirror row_mask:0xf bank_mask:0xf
    s_nop 1
    v_add_f32_dpp v80, v80, v80 row_mirror row_mask:0xf bank_mask:0xf
    v_mov_b32 v81, v80
    s_nop 1
    v_permlane16_swap_b32 v80, v81
    v_add_f32 v80, v80, v81
    v_mov_b32 v81, v80
    s_nop 1
    v_permlane32_swap_b32 v80, v81
    v_add_f32 v80, v80, v81
    v_mov_b32 v81, 0x3727c5ac
    v_fmac_f32 v81, 0x3acccccd, v80
    v_rsq_f32 v80, v81
    s_nop 0
    v_pk_mul_f32 v[70:71], v[70:71], v[80:81] op_sel_hi:[1,0]
    v_pk_mul_f32 v[72:73], v[72:73], v[80:81] op_sel_hi:[1,0]
    v_pk_mul_f32 v[74:75], v[74:75], v[80:81] op_sel_hi:[1,0]
    v_pk_mul_f32 v[76:77], v[76:77], v[80:81] op_sel_hi:[1,0]
    v_pk_mul_f32 v[78:79], v[78:79], v[80:81] op_sel_hi:[1,0]
    v_cvt_pk_bf16_f32 v64, v70, v71
    v_cvt_pk_bf16_f32 v65, v72, v73
    v_cvt_pk_bf16_f32 v66, v74, v75
    v_cvt_pk_bf16_f32 v67, v76, v77
    v_cvt_pk_bf16_f32 v68, v78, v79
    buffer_store_dwordx4 v[64:67], v88, s[4:7], s75 offen sc1
    buffer_store_dword v68, v90, s[4:7], s75 offen sc1
Lnonorm_112:
    buffer_store_dwordx4 v[58:61], v86, s[20:23], s73 offen sc1
    buffer_store_dword v62, v87, s[20:23], s73 offen offset:1024 sc1
    s_add_u32 s73, s73, 20480
    s_add_u32 s62, s62, 1
    buffer_load_dword v93, v92, s[4:7], 0 offen sc1
    s_waitcnt vmcnt(20)
    v_lshlrev_b32 v70, 16, v4
    v_and_b32 v71, 0xffff0000, v4
    v_lshlrev_b32 v72, 16, v5
    v_and_b32 v73, 0xffff0000, v5
    v_lshlrev_b32 v74, 16, v6
    v_and_b32 v75, 0xffff0000, v6
    v_lshlrev_b32 v76, 16, v7
    v_and_b32 v77, 0xffff0000, v7
    s_waitcnt vmcnt(19)
    v_lshlrev_b32 v78, 16, v8
    v_and_b32 v79, 0xffff0000, v8
    s_waitcnt vmcnt(18)
    v_dot2_f32_bf16 v70, v10, s77, v70
    v_dot2_f32_bf16 v71, v10, s78, v71
    v_dot2_f32_bf16 v72, v11, s77, v72
    v_dot2_f32_bf16 v73, v11, s78, v73
    v_dot2_f32_bf16 v74, v12, s77, v74
    v_dot2_f32_bf16 v75, v12, s78, v75
    v_dot2_f32_bf16 v76, v13, s77, v76
    v_dot2_f32_bf16 v77, v13, s78, v77
    s_waitcnt vmcnt(17)
    v_dot2_f32_bf16 v78, v14, s77, v78
    v_dot2_f32_bf16 v79, v14, s78, v79
    s_waitcnt vmcnt(16)
    v_dot2_f32_bf16 v70, v16, s77, v70
    v_dot2_f32_bf16 v71, v16, s78, v71
    v_dot2_f32_bf16 v72, v17, s77, v72
    v_dot2_f32_bf16 v73, v17, s78, v73
    v_dot2_f32_bf16 v74, v18, s77, v74
    v_dot2_f32_bf16 v75, v18, s78, v75
    v_dot2_f32_bf16 v76, v19, s77, v76
    v_dot2_f32_bf16 v77, v19, s78, v77
    s_waitcnt vmcnt(15)
    v_dot2_f32_bf16 v78, v20, s77, v78
    v_dot2_f32_bf16 v79, v20, s78, v79
    s_waitcnt vmcnt(14)
    v_dot2_f32_bf16 v70, v22, s77, v70
    v_dot2_f32_bf16 v71, v22, s78, v71
    v_dot2_f32_bf16 v72, v23, s77, v72
    v_dot2_f32_bf16 v73, v23, s78, v73
    v_dot2_f32_bf16 v74, v24, s77, v74
    v_dot2_f32_bf16 v75, v24, s78, v75
    v_dot2_f32_bf16 v76, v25, s77, v76
    v_dot2_f32_bf16 v77, v25, s78, v77
    s_waitcnt vmcnt(13)
    v_dot2_f32_bf16 v78, v26, s77, v78
    v_dot2_f32_bf16 v79, v26, s78, v79
    s_waitcnt vmcnt(12)
    v_dot2_f32_bf16 v70, v28, s77, v70
    v_dot2_f32_bf16 v71, v28, s78, v71
    v_dot2_f32_bf16 v72, v29, s77, v72
    v_dot2_f32_bf16 v73, v29, s78, v73
    v_dot2_f32_bf16 v74, v30, s77, v74
    v_dot2_f32_bf16 v75, v30, s78, v75
    v_dot2_f32_bf16 v76, v31, s77, v76
    v_dot2_f32_bf16 v77, v31, s78, v77
    s_waitcnt vmcnt(11)
    v_dot2_f32_bf16 v78, v32, s77, v78
    v_dot2_f32_bf16 v79, v32, s78, v79
    s_waitcnt vmcnt(10)
    v_dot2_f32_bf16 v70, v34, s77, v70
    v_dot2_f32_bf16 v71, v34, s78, v71
    v_dot2_f32_bf16 v72, v35, s77, v72
    v_dot2_f32_bf16 v73, v35, s78, v73
    v_dot2_f32_bf16 v74, v36, s77, v74
    v_dot2_f32_bf16 v75, v36, s78, v75
    v_dot2_f32_bf16 v76, v37, s77, v76
    v_dot2_f32_bf16 v77, v37, s78, v77
    s_waitcnt vmcnt(9)
    v_dot2_f32_bf16 v78, v38, s77, v78
    v_dot2_f32_bf16 v79, v38, s78, v79
    s_waitcnt vmcnt(8)
    v_dot2_f32_bf16 v70, v40, s77, v70
    v_dot2_f32_bf16 v71, v40, s78, v71
    v_dot2_f32_bf16 v72, v41, s77, v72
    v_dot2_f32_bf16 v73, v41, s78, v73
    v_dot2_f32_bf16 v74, v42, s77, v74
    v_dot2_f32_bf16 v75, v42, s78, v75
    v_dot2_f32_bf16 v76, v43, s77, v76
    v_dot2_f32_bf16 v77, v43, s78, v77
    s_waitcnt vmcnt(7)
    v_dot2_f32_bf16 v78, v44, s77, v78
    v_dot2_f32_bf16 v79, v44, s78, v79
    s_waitcnt vmcnt(6)
    v_dot2_f32_bf16 v70, v46, s77, v70
    v_dot2_f32_bf16 v71, v46, s78, v71
    v_dot2_f32_bf16 v72, v47, s77, v72
    v_dot2_f32_bf16 v73, v47, s78, v73
    v_dot2_f32_bf16 v74, v48, s77, v74
    v_dot2_f32_bf16 v75, v48, s78, v75
    v_dot2_f32_bf16 v76, v49, s77, v76
    v_dot2_f32_bf16 v77, v49, s78, v77
    s_waitcnt vmcnt(5)
    v_dot2_f32_bf16 v78, v50, s77, v78
    v_dot2_f32_bf16 v79, v50, s78, v79
    s_waitcnt vmcnt(4)
    v_dot2_f32_bf16 v70, v52, s77, v70
    v_dot2_f32_bf16 v71, v52, s78, v71
    v_dot2_f32_bf16 v72, v53, s77, v72
    v_dot2_f32_bf16 v73, v53, s78, v73
    v_dot2_f32_bf16 v74, v54, s77, v74
    v_dot2_f32_bf16 v75, v54, s78, v75
    v_dot2_f32_bf16 v76, v55, s77, v76
    v_dot2_f32_bf16 v77, v55, s78, v77
    s_waitcnt vmcnt(3)
    v_dot2_f32_bf16 v78, v56, s77, v78
    v_dot2_f32_bf16 v79, v56, s78, v79
    v_cvt_pk_bf16_f32 v58, v70, v71
    v_cvt_pk_bf16_f32 v59, v72, v73
    v_cvt_pk_bf16_f32 v60, v74, v75
    v_cvt_pk_bf16_f32 v61, v76, v77
    v_cvt_pk_bf16_f32 v62, v78, v79
    s_waitcnt vmcnt(0)
    v_mov_b32 v80, s62
    s_mov_b64 exec, 1
    buffer_store_dword v80, off, s[4:7], s63 sc1
    buffer_store_dword v80, off, s[4:7], s3
    s_mov_b64 exec, -1
    s_branch L_Rsum1
L_Rpre1:
    s_lshr_b32 s70, s71, 8
    s_xor_b32 s70, s70, s1
    s_and_b32 s70, s70, 0x2000
    s_or_b32 s70, s70, s71
    buffer_load_dwordx4 v[4:7], v82, s[4:7], s70 offen sc1
    buffer_load_dword v8, v84, s[4:7], s70 offen sc1
    s_add_u32 s70, s70, 81920
    buffer_load_dwordx4 v[10:13], v82, s[4:7], s70 offen sc1
    buffer_load_dword v14, v84, s[4:7], s70 offen sc1
    s_add_u32 s70, s70, 81920
    buffer_load_dwordx4 v[16:19], v82, s[4:7], s70 offen sc1
    buffer_load_dword v20, v84, s[4:7], s70 offen sc1
    s_add_u32 s70, s70, 81920
    buffer_load_dwordx4 v[22:25], v82, s[4:7], s70 offen sc1
    buffer_load_dword v26, v84, s[4:7], s70 offen sc1
    s_add_u32 s70, s70, 81920
    buffer_load_dwordx4 v[28:31], v82, s[4:7], s70 offen sc1
    buffer_load_dword v32, v84, s[4:7], s70 offen sc1
    s_add_u32 s70, s70, 81920
    buffer_load_dwordx4 v[34:37], v82, s[4:7], s70 offen sc1
    buffer_load_dword v38, v84, s[4:7], s70 offen sc1
    s_add_u32 s70, s70, 81920
    buffer_load_dwordx4 v[40:43], v82, s[4:7], s70 offen sc1
    buffer_load_dword v44, v84, s[4:7], s70 offen sc1
    s_add_u32 s70, s70, 81920
    buffer_load_dwordx4 v[46:49], v82, s[4:7], s70 offen sc1
    buffer_load_dword v50, v84, s[4:7], s70 offen sc1
    s_add_u32 s70, s70, 81920
    buffer_load_dwordx4 v[52:55], v86, s[16:19], s72 offen sc1
    buffer_load_dword v56, v87, s[16:19], s72 offen offset:1024 sc1
    s_add_u32 s72, s72, 20480
    s_cmp_eq_u32 s76, 3
    s_cbranch_scc1 Lnonorm_113
    s_lshr_b32 s75, s74, 8
    s_xor_b32 s75, s75, s79
    s_and_b32 s75, s75, 0x2000
    s_or_b32 s75, s75, s74
    v_lshlrev_b32 v70, 16, v58
    v_and_b32 v71, 0xffff0000, v58
    v_lshlrev_b32 v72, 16, v59
    v_and_b32 v73, 0xffff0000, v59
    v_lshlrev_b32 v74, 16, v60
    v_and_b32 v75, 0xffff0000, v60
    v_lshlrev_b32 v76, 16, v61
    v_and_b32 v77, 0xffff0000, v61
    v_lshlrev_b32 v78, 16, v62
    v_and_b32 v79, 0xffff0000, v62
    v_pk_add_f32 v[80:81], v[70:71], v[72:73]
    v_pk_add_f32 v[80:81], v[80:81], v[74:75]
    v_pk_add_f32 v[80:81], v[80:81], v[76:77]
    v_pk_add_f32 v[80:81], v[80:81], v[78:79]
    v_add_f32 v80, v80, v81
    s_nop 1
    v_add_f32_dpp v80, v80, v80 quad_perm:[1,0,3,2] row_mask:0xf bank_mask:0xf
    s_nop 1
    v_add_f32_dpp v80, v80, v80 quad_perm:[2,3,0,1] row_mask:0xf bank_mask:0xf
    s_nop 1
    v_add_f32_dpp v80, v80, v80 row_half_mirror row_mask:0xf bank_mask:0xf
    s_nop 1
    v_add_f32_dpp v80, v80, v80 row_mirror row_mask:0xf bank_mask:0xf
    v_mov_b32 v81, v80
    s_nop 1
    v_permlane16_swap_b32 v80, v81
    v_add_f32 v80, v80, v81
    v_mov_b32 v81, v80
    s_nop 1
    v_permlane32_swap_b32 v80, v81
    v_add_f32 v80, v80, v81
    v_mul_f32 v80, 0xbacccccd, v80
    v_pk_add_f32 v[70:71], v[70:71], v[80:81] op_sel_hi:[1,0]
    v_pk_add_f32 v[72:73], v[72:73], v[80:81] op_sel_hi:[1,0]
    v_pk_add_f32 v[74:75], v[74:75], v[80:81] op_sel_hi:[1,0]
    v_pk_add_f32 v[76:77], v[76:77], v[80:81] op_sel_hi:[1,0]
    v_pk_add_f32 v[78:79], v[78:79], v[80:81] op_sel_hi:[1,0]
    v_pk_mul_f32 v[80:81], v[70:71], v[70:71]
    v_pk_fma_f32 v[80:81], v[72:73], v[72:73], v[80:81]
    v_pk_fma_f32 v[80:81], v[74:75], v[74:75], v[80:81]
    v_pk_fma_f32 v[80:81], v[76:77], v[76:77], v[80:81]
    v_pk_fma_f32 v[80:81], v[78:79], v[78:79], v[80:81]
    v_add_f32 v80, v80, v81
    s_nop 1
    v_add_f32_dpp v80, v80, v80 quad_perm:[1,0,3,2] row_mask:0xf bank_mask:0xf
    s_nop 1
    v_add_f32_dpp v80, v80, v80 quad_perm:[2,3,0,1] row_mask:0xf bank_mask:0xf
    s_nop 1
    v_add_f32_dpp v80, v80, v80 row_half_mirror row_mask:0xf bank_mask:0xf
    s_nop 1
    v_add_f32_dpp v80, v80, v80 row_mirror row_mask:0xf bank_mask:0xf
    v_mov_b32 v81, v80
    s_nop 1
    v_permlane16_swap_b32 v80, v81
    v_add_f32 v80, v80, v81
    v_mov_b32 v81, v80
    s_nop 1
    v_permlane32_swap_b32 v80, v81
    v_add_f32 v80, v80, v81
    v_mov_b32 v81, 0x3727c5ac
    v_fmac_f32 v81, 0x3acccccd, v80
    v_rsq_f32 v80, v81
    s_nop 0
    v_pk_mul_f32 v[70:71], v[70:71], v[80:81] op_sel_hi:[1,0]
    v_pk_mul_f32 v[72:73], v[72:73], v[80:81] op_sel_hi:[1,0]
    v_pk_mul_f32 v[74:75], v[74:75], v[80:81] op_sel_hi:[1,0]
    v_pk_mul_f32 v[76:77], v[76:77], v[80:81] op_sel_hi:[1,0]
    v_pk_mul_f32 v[78:79], v[78:79], v[80:81] op_sel_hi:[1,0]
    v_cvt_pk_bf16_f32 v64, v70, v71
    v_cvt_pk_bf16_f32 v65, v72, v73
    v_cvt_pk_bf16_f32 v66, v74, v75
    v_cvt_pk_bf16_f32 v67, v76, v77
    v_cvt_pk_bf16_f32 v68, v78, v79
    buffer_store_dwordx4 v[64:67], v89, s[4:7], s75 offen sc1
    buffer_store_dword v68, v91, s[4:7], s75 offen sc1
Lnonorm_113:
    buffer_store_dwordx4 v[58:61], v86, s[20:23], s73 offen sc1
    buffer_store_dword v62, v87, s[20:23], s73 offen offset:1024 sc1
    s_add_u32 s73, s73, 20480
    s_add_u32 s74, s74, 131072
    s_add_u32 s62, s62, 1
    buffer_load_dword v93, v92, s[4:7], 0 offen sc1
    s_waitcnt vmcnt(20)
    v_lshlrev_b32 v70, 16, v4
    v_and_b32 v71, 0xffff0000, v4
    v_lshlrev_b32 v72, 16, v5
    v_and_b32 v73, 0xffff0000, v5
    v_lshlrev_b32 v74, 16, v6
    v_and_b32 v75, 0xffff0000, v6
    v_lshlrev_b32 v76, 16, v7
    v_and_b32 v77, 0xffff0000, v7
    s_waitcnt vmcnt(19)
    v_lshlrev_b32 v78, 16, v8
    v_and_b32 v79, 0xffff0000, v8
    s_waitcnt vmcnt(18)
    v_dot2_f32_bf16 v70, v10, s77, v70
    v_dot2_f32_bf16 v71, v10, s78, v71
    v_dot2_f32_bf16 v72, v11, s77, v72
    v_dot2_f32_bf16 v73, v11, s78, v73
    v_dot2_f32_bf16 v74, v12, s77, v74
    v_dot2_f32_bf16 v75, v12, s78, v75
    v_dot2_f32_bf16 v76, v13, s77, v76
    v_dot2_f32_bf16 v77, v13, s78, v77
    s_waitcnt vmcnt(17)
    v_dot2_f32_bf16 v78, v14, s77, v78
    v_dot2_f32_bf16 v79, v14, s78, v79
    s_waitcnt vmcnt(16)
    v_dot2_f32_bf16 v70, v16, s77, v70
    v_dot2_f32_bf16 v71, v16, s78, v71
    v_dot2_f32_bf16 v72, v17, s77, v72
    v_dot2_f32_bf16 v73, v17, s78, v73
    v_dot2_f32_bf16 v74, v18, s77, v74
    v_dot2_f32_bf16 v75, v18, s78, v75
    v_dot2_f32_bf16 v76, v19, s77, v76
    v_dot2_f32_bf16 v77, v19, s78, v77
    s_waitcnt vmcnt(15)
    v_dot2_f32_bf16 v78, v20, s77, v78
    v_dot2_f32_bf16 v79, v20, s78, v79
    s_waitcnt vmcnt(14)
    v_dot2_f32_bf16 v70, v22, s77, v70
    v_dot2_f32_bf16 v71, v22, s78, v71
    v_dot2_f32_bf16 v72, v23, s77, v72
    v_dot2_f32_bf16 v73, v23, s78, v73
    v_dot2_f32_bf16 v74, v24, s77, v74
    v_dot2_f32_bf16 v75, v24, s78, v75
    v_dot2_f32_bf16 v76, v25, s77, v76
    v_dot2_f32_bf16 v77, v25, s78, v77
    s_waitcnt vmcnt(13)
    v_dot2_f32_bf16 v78, v26, s77, v78
    v_dot2_f32_bf16 v79, v26, s78, v79
    s_waitcnt vmcnt(12)
    v_dot2_f32_bf16 v70, v28, s77, v70
    v_dot2_f32_bf16 v71, v28, s78, v71
    v_dot2_f32_bf16 v72, v29, s77, v72
    v_dot2_f32_bf16 v73, v29, s78, v73
    v_dot2_f32_bf16 v74, v30, s77, v74
    v_dot2_f32_bf16 v75, v30, s78, v75
    v_dot2_f32_bf16 v76, v31, s77, v76
    v_dot2_f32_bf16 v77, v31, s78, v77
    s_waitcnt vmcnt(11)
    v_dot2_f32_bf16 v78, v32, s77, v78
    v_dot2_f32_bf16 v79, v32, s78, v79
    s_waitcnt vmcnt(10)
    v_dot2_f32_bf16 v70, v34, s77, v70
    v_dot2_f32_bf16 v71, v34, s78, v71
    v_dot2_f32_bf16 v72, v35, s77, v72
    v_dot2_f32_bf16 v73, v35, s78, v73
    v_dot2_f32_bf16 v74, v36, s77, v74
    v_dot2_f32_bf16 v75, v36, s78, v75
    v_dot2_f32_bf16 v76, v37, s77, v76
    v_dot2_f32_bf16 v77, v37, s78, v77
    s_waitcnt vmcnt(9)
    v_dot2_f32_bf16 v78, v38, s77, v78
    v_dot2_f32_bf16 v79, v38, s78, v79
    s_waitcnt vmcnt(8)
    v_dot2_f32_bf16 v70, v40, s77, v70
    v_dot2_f32_bf16 v71, v40, s78, v71
    v_dot2_f32_bf16 v72, v41, s77, v72
    v_dot2_f32_bf16 v73, v41, s78, v73
    v_dot2_f32_bf16 v74, v42, s77, v74
    v_dot2_f32_bf16 v75, v42, s78, v75
    v_dot2_f32_bf16 v76, v43, s77, v76
    v_dot2_f32_bf16 v77, v43, s78, v77
    s_waitcnt vmcnt(7)
    v_dot2_f32_bf16 v78, v44, s77, v78
    v_dot2_f32_bf16 v79, v44, s78, v79
    s_waitcnt vmcnt(6)
    v_dot2_f32_bf16 v70, v46, s77, v70
    v_dot2_f32_bf16 v71, v46, s78, v71
    v_dot2_f32_bf16 v72, v47, s77, v72
    v_dot2_f32_bf16 v73, v47, s78, v73
    v_dot2_f32_bf16 v74, v48, s77, v74
    v_dot2_f32_bf16 v75, v48, s78, v75
    v_dot2_f32_bf16 v76, v49, s77, v76
    v_dot2_f32_bf16 v77, v49, s78, v77
    s_waitcnt vmcnt(5)
    v_dot2_f32_bf16 v78, v50, s77, v78
    v_dot2_f32_bf16 v79, v50, s78, v79
    s_waitcnt vmcnt(4)
    v_dot2_f32_bf16 v70, v52, s77, v70
    v_dot2_f32_bf16 v71, v52, s78, v71
    v_dot2_f32_bf16 v72, v53, s77, v72
    v_dot2_f32_bf16 v73, v53, s78, v73
    v_dot2_f32_bf16 v74, v54, s77, v74
    v_dot2_f32_bf16 v75, v54, s78, v75
    v_dot2_f32_bf16 v76, v55, s77, v76
    v_dot2_f32_bf16 v77, v55, s78, v77
    s_waitcnt vmcnt(3)
    v_dot2_f32_bf16 v78, v56, s77, v78
    v_dot2_f32_bf16 v79, v56, s78, v79
    v_cvt_pk_bf16_f32 v58, v70, v71
    v_cvt_pk_bf16_f32 v59, v72, v73
    v_cvt_pk_bf16_f32 v60, v74, v75
    v_cvt_pk_bf16_f32 v61, v76, v77
    v_cvt_pk_bf16_f32 v62, v78, v79
    s_waitcnt vmcnt(0)
    v_mov_b32 v80, s62
    s_mov_b64 exec, 1
    buffer_store_dword v80, off, s[4:7], s63 sc1
    buffer_store_dword v80, off, s[4:7], s3
    s_mov_b64 exec, -1
    s_branch L_Rsum0
Lgrty_102:
    s_sleep 16
    buffer_load_dword v2, off, s[8:11], 0 offset:132 sc1
    s_sub_u32 s61, s61, 1
    s_mov_b32 s67, 1
    s_cbranch_scc1 L_fail
    s_branch Lgchk_101
Lprty_105:
    s_sleep 16
    buffer_load_dword v2, off, s[8:11], 0 offset:140 sc1
    s_sub_u32 s61, s61, 1
    s_mov_b32 s67, 16
    s_cbranch_scc1 L_fail
    s_branch Lpchk_104
Lfrty_107:
    s_sleep 4
    buffer_load_dword v93, v92, s[4:7], 0 offen sc1
    s_sub_u32 s61, s61, 1
    s_mov_b32 s67, 40
    s_cbranch_scc1 L_fail
    s_waitcnt vmcnt(0)
    s_branch Lfchk_106
Lfrty_110:
    s_sleep 4
    buffer_load_dword v93, v92, s[4:7], 0 offen sc1
    s_sub_u32 s61, s61, 1
    s_mov_b32 s67, 40
    s_cbranch_scc1 L_fail
    s_waitcnt vmcnt(0)
    s_branch Lfchk_109
.section .rodata,"a"
.p2align 6
.amdhsa_kernel interleave_layers__memory_aug_recurrent_mem_tr__sliding_local_dilated__prompt_kernel
  .amdhsa_next_free_vgpr 512
  .amdhsa_next_free_sgpr 102
  .amdhsa_accum_offset 256
  .amdhsa_group_segment_fixed_size 0
  .amdhsa_kernarg_size 104
  .amdhsa_user_sgpr_count 2
  .amdhsa_user_sgpr_kernarg_segment_ptr 1
  .amdhsa_system_sgpr_workgroup_id_x 1
  .amdhsa_float_denorm_mode_32 3
.end_amdhsa_kernel
```

```asm
; @launch grid=(256,1,1) block=(256,1,1) lds=163840
.amdgcn_target "amdgcn-amd-amdhsa--gfx950"
.text
.globl interleave_layers__memory_aug_recurrent_mem_tr__sliding_local_dilated__prompt_kernel
.p2align 8
.type interleave_layers__memory_aug_recurrent_mem_tr__sliding_local_dilated__prompt_kernel,@function
interleave_layers__memory_aug_recurrent_mem_tr__sliding_local_dilated__prompt_kernel:
    s_cmp_ge_u32 s2, 256
    s_cbranch_scc1 L_end
    s_load_dwordx16 s[32:47], s[0:1], 0
    s_load_dwordx8 s[48:55], s[0:1], 64
    s_load_dwordx2 s[56:57], s[0:1], 96
    s_getreg_b32 s58, hwreg(HW_REG_XCC_ID)
    s_and_b32 s58, s58, 7
    v_lshrrev_b32 v1, 6, v0
    s_nop 0
    v_readfirstlane_b32 s60, v1
    s_mov_b32 s61, 0x100000
    s_waitcnt lgkmcnt(0)
    s_mov_b32 s4, s56
    s_mov_b32 s5, s57
    s_mov_b32 s6, 268435456
    s_mov_b32 s7, 0x20000
    s_mov_b32 s8, s54
    s_mov_b32 s9, s55
    s_mov_b32 s10, 256
    s_mov_b32 s11, 0x20000
    s_mov_b32 s12, s32
    s_mov_b32 s13, s33
    s_mov_b32 s14, 2621440
    s_mov_b32 s15, 0x20000
    s_cmp_lg_u32 s60, 0
    s_cbranch_scc1 L_notick
    s_mov_b64 exec, 1
    v_mov_b32 v2, 1
    s_lshl_b32 s64, s58, 5
    buffer_atomic_add v2, off, s[8:11], s64 sc0
    s_mov_b64 exec, -1
L_notick:
    v_lshrrev_b32 v4, 5, v0
    s_lshl_b32 s64, s2, 3
    v_add_u32 v4, s64, v4
    v_mul_u32_u24 v4, 1280, v4
    v_and_b32 v5, 31, v0
    v_lshl_add_u32 v6, v5, 3, v4
    v_lshl_add_u32 v5, v5, 4, v4
    buffer_load_dwordx4 v[8:11], v5, s[12:15], 0 offen
    buffer_load_dwordx4 v[12:15], v5, s[12:15], 0 offen offset:512
    buffer_load_dwordx2 v[16:17], v6, s[12:15], 0 offen offset:1024
    v_mov_b32 v44, -1
    v_mov_b32 v45, -1
    v_mov_b32 v46, -1
    v_mov_b32 v47, -1
    v_mov_b32 v48, 0
    v_lshlrev_b32 v7, 4, v0
    v_lshlrev_b32 v18, 2, v0
    s_lshr_b32 s64, s2, 5
    s_lshl_b32 s64, s64, 20
    s_bfe_u32 s65, s2, 0x10004
    s_lshl_b32 s65, s65, 18
    s_add_u32 s64, s64, s65
    s_and_b32 s65, s2, 15
    s_mul_i32 s65, s65, 11776
    s_add_u32 s64, s64, s65
    buffer_store_dwordx4 v[44:47], v7, s[4:7], s64 offen sc1
    s_add_u32 s64, s64, 4096
    buffer_store_dwordx4 v[44:47], v7, s[4:7], s64 offen sc1
    s_add_u32 s64, s64, 4096
    buffer_store_dwordx4 v[44:47], v7, s[4:7], s64 offen sc1
    s_add_u32 s64, s64, 4096
    s_lshr_b32 s64, s2, 5
    s_lshl_b32 s64, s64, 18
    s_and_b32 s65, s2, 31
    s_lshl_b32 s65, s65, 12
    s_add_u32 s64, s64, s65
    s_add_u32 s64, s64, 14680064
    buffer_store_dwordx4 v[44:47], v7, s[4:7], s64 offen sc1
    s_and_b32 s64, s2, 127
    s_lshl_b32 s64, s64, 10
    s_add_u32 s64, s64, 8388608
    s_bfe_u32 s65, s2, 0x30004
    s_lshl_b32 s65, s65, 18
    s_and_b32 s66, s2, 15
    s_lshl_b32 s66, s66, 10
    s_add_u32 s65, s65, s66
    s_add_u32 s65, s65, 14811136
    s_cmp_lt_u32 s2, 128
    s_cselect_b32 s64, s64, s65
    buffer_store_dword v48, v18, s[4:7], s64 offen sc1
    v_bfe_u32 v49, v0, 5, 3
    s_and_b32 s64, s2, 3
    s_mul_i32 s64, s64, 10
    v_bfe_u32 v50, v0, 3, 2
    v_add_u32 v50, s64, v50
    v_add_u32 v51, 4, v50
    v_bfe_u32 v52, v0, 4, 1
    v_add3_u32 v52, v52, s64, 8
    v_lshrrev_b32 v53, 3, v50
    v_lshlrev_b32 v50, 10, v50
    v_lshl_add_u32 v50, v53, 13, v50
    v_lshrrev_b32 v53, 3, v51
    v_lshlrev_b32 v51, 10, v51
    v_lshl_add_u32 v51, v53, 13, v51
    v_lshrrev_b32 v53, 3, v52
    v_lshlrev_b32 v52, 10, v52
    v_lshl_add_u32 v52, v53, 13, v52
    v_and_b32 v53, 7, v0
    v_xor_b32 v53, v53, v49
    v_lshlrev_b32 v53, 4, v53
    v_lshl_add_u32 v53, v49, 7, v53
    v_add_u32 v50, v50, v53
    v_add_u32 v51, v51, v53
    v_bfe_u32 v53, v0, 1, 3
    v_xor_b32 v53, v53, v49
    v_lshlrev_b32 v53, 4, v53
    v_lshl_add_u32 v53, v49, 7, v53
    v_and_b32 v54, 1, v0
    v_lshl_add_u32 v53, v54, 3, v53
    v_add_u32 v52, v52, v53
    s_cmp_lg_u32 s60, 0
    s_cbranch_scc1 L_notick2
    v_mov_b32 v3, 0
    s_mov_b64 exec, 1
    s_waitcnt vmcnt(8)
    ds_write_b32 v3, v2
    s_mov_b64 exec, -1
L_notick2:
    s_waitcnt lgkmcnt(0)
    s_barrier
    v_mov_b32 v3, 0
    s_waitcnt vmcnt(8)
    ds_read_b32 v2, v3
    s_waitcnt lgkmcnt(0)
    v_readfirstlane_b32 s59, v2
    s_waitcnt lgkmcnt(0)
    s_barrier
    s_waitcnt vmcnt(7)
    v_lshlrev_b32 v20, 16, v8
    v_and_b32 v21, 0xffff0000, v8
    v_lshlrev_b32 v22, 16, v9
    v_and_b32 v23, 0xffff0000, v9
    v_lshlrev_b32 v24, 16, v10
    v_and_b32 v25, 0xffff0000, v10
    v_lshlrev_b32 v26, 16, v11
    v_and_b32 v27, 0xffff0000, v11
    s_waitcnt vmcnt(6)
    v_lshlrev_b32 v28, 16, v12
    v_and_b32 v29, 0xffff0000, v12
    v_lshlrev_b32 v30, 16, v13
    v_and_b32 v31, 0xffff0000, v13
    v_lshlrev_b32 v32, 16, v14
    v_and_b32 v33, 0xffff0000, v14
    v_lshlrev_b32 v34, 16, v15
    v_and_b32 v35, 0xffff0000, v15
    s_waitcnt vmcnt(5)
    v_lshlrev_b32 v36, 16, v16
    v_and_b32 v37, 0xffff0000, v16
    v_lshlrev_b32 v38, 16, v17
    v_and_b32 v39, 0xffff0000, v17
    v_pk_add_f32 v[40:41], v[20:21], v[22:23]
    v_pk_add_f32 v[40:41], v[40:41], v[24:25]
    v_pk_add_f32 v[40:41], v[40:41], v[26:27]
    v_pk_add_f32 v[40:41], v[40:41], v[28:29]
    v_pk_add_f32 v[40:41], v[40:41], v[30:31]
    v_pk_add_f32 v[40:41], v[40:41], v[32:33]
    v_pk_add_f32 v[40:41], v[40:41], v[34:35]
    v_pk_add_f32 v[40:41], v[40:41], v[36:37]
    v_pk_add_f32 v[40:41], v[40:41], v[38:39]
    v_add_f32 v40, v40, v41
    s_nop 1
    v_add_f32_dpp v40, v40, v40 quad_perm:[1,0,3,2] row_mask:0xf bank_mask:0xf
    s_nop 1
    v_add_f32_dpp v40, v40, v40 quad_perm:[2,3,0,1] row_mask:0xf bank_mask:0xf
    s_nop 1
    v_add_f32_dpp v40, v40, v40 row_half_mirror row_mask:0xf bank_mask:0xf
    s_nop 1
    v_add_f32_dpp v40, v40, v40 row_mirror row_mask:0xf bank_mask:0xf
    v_mov_b32 v41, v40
    s_nop 1
    v_permlane16_swap_b32 v40, v41
    v_add_f32 v40, v40, v41
    v_mul_f32 v40, 0xbacccccd, v40
    v_pk_add_f32 v[20:21], v[20:21], v[40:41] op_sel_hi:[1,0]
    v_pk_add_f32 v[22:23], v[22:23], v[40:41] op_sel_hi:[1,0]
    v_pk_add_f32 v[24:25], v[24:25], v[40:41] op_sel_hi:[1,0]
    v_pk_add_f32 v[26:27], v[26:27], v[40:41] op_sel_hi:[1,0]
    v_pk_add_f32 v[28:29], v[28:29], v[40:41] op_sel_hi:[1,0]
    v_pk_add_f32 v[30:31], v[30:31], v[40:41] op_sel_hi:[1,0]
    v_pk_add_f32 v[32:33], v[32:33], v[40:41] op_sel_hi:[1,0]
    v_pk_add_f32 v[34:35], v[34:35], v[40:41] op_sel_hi:[1,0]
    v_pk_add_f32 v[36:37], v[36:37], v[40:41] op_sel_hi:[1,0]
    v_pk_add_f32 v[38:39], v[38:39], v[40:41] op_sel_hi:[1,0]
    v_pk_mul_f32 v[40:41], v[20:21], v[20:21]
    v_pk_fma_f32 v[40:41], v[22:23], v[22:23], v[40:41]
    v_pk_fma_f32 v[40:41], v[24:25], v[24:25], v[40:41]
    v_pk_fma_f32 v[40:41], v[26:27], v[26:27], v[40:41]
    v_pk_fma_f32 v[40:41], v[28:29], v[28:29], v[40:41]
    v_pk_fma_f32 v[40:41], v[30:31], v[30:31], v[40:41]
    v_pk_fma_f32 v[40:41], v[32:33], v[32:33], v[40:41]
    v_pk_fma_f32 v[40:41], v[34:35], v[34:35], v[40:41]
    v_pk_fma_f32 v[40:41], v[36:37], v[36:37], v[40:41]
    v_pk_fma_f32 v[40:41], v[38:39], v[38:39], v[40:41]
    v_add_f32 v40, v40, v41
    s_nop 1
    v_add_f32_dpp v40, v40, v40 quad_perm:[1,0,3,2] row_mask:0xf bank_mask:0xf
    s_nop 1
    v_add_f32_dpp v40, v40, v40 quad_perm:[2,3,0,1] row_mask:0xf bank_mask:0xf
    s_nop 1
    v_add_f32_dpp v40, v40, v40 row_half_mirror row_mask:0xf bank_mask:0xf
    s_nop 1
    v_add_f32_dpp v40, v40, v40 row_mirror row_mask:0xf bank_mask:0xf
    v_mov_b32 v41, v40
    s_nop 1
    v_permlane16_swap_b32 v40, v41
    v_add_f32 v40, v40, v41
    v_mov_b32 v41, 0x3727c5ac
    v_fmac_f32 v41, 0x3acccccd, v40
    v_rsq_f32 v40, v41
    s_nop 0
    v_pk_mul_f32 v[20:21], v[20:21], v[40:41] op_sel_hi:[1,0]
    v_pk_mul_f32 v[22:23], v[22:23], v[40:41] op_sel_hi:[1,0]
    v_pk_mul_f32 v[24:25], v[24:25], v[40:41] op_sel_hi:[1,0]
    v_pk_mul_f32 v[26:27], v[26:27], v[40:41] op_sel_hi:[1,0]
    v_pk_mul_f32 v[28:29], v[28:29], v[40:41] op_sel_hi:[1,0]
    v_pk_mul_f32 v[30:31], v[30:31], v[40:41] op_sel_hi:[1,0]
    v_pk_mul_f32 v[32:33], v[32:33], v[40:41] op_sel_hi:[1,0]
    v_pk_mul_f32 v[34:35], v[34:35], v[40:41] op_sel_hi:[1,0]
    v_pk_mul_f32 v[36:37], v[36:37], v[40:41] op_sel_hi:[1,0]
    v_pk_mul_f32 v[38:39], v[38:39], v[40:41] op_sel_hi:[1,0]
    v_cvt_pk_bf16_f32 v8, v20, v21
    v_cvt_pk_bf16_f32 v9, v22, v23
    v_cvt_pk_bf16_f32 v10, v24, v25
    v_cvt_pk_bf16_f32 v11, v26, v27
    v_cvt_pk_bf16_f32 v12, v28, v29
    v_cvt_pk_bf16_f32 v13, v30, v31
    v_cvt_pk_bf16_f32 v14, v32, v33
    v_cvt_pk_bf16_f32 v15, v34, v35
    v_cvt_pk_bf16_f32 v16, v36, v37
    v_cvt_pk_bf16_f32 v17, v38, v39
    s_lshr_b32 s64, s2, 2
    s_lshl_b32 s64, s64, 17
    s_add_u32 s64, s64, 16777216
    buffer_store_dwordx4 v[8:11], v50, s[4:7], s64 offen sc1
    buffer_store_dwordx4 v[12:15], v51, s[4:7], s64 offen sc1
    buffer_store_dwordx2 v[16:17], v52, s[4:7], s64 offen sc1
    s_lshr_b32 s68, s58, 2
    s_and_b32 s69, s58, 3
    s_lshl_b32 s63, s58, 5
    s_add_u32 s63, s63, s59
    s_lshl_b32 s63, s63, 2
    s_add_u32 s63, s63, s60
    s_lshl_b32 s63, s63, 7
    s_add_u32 s3, s63, 8388608
    s_mov_b32 s62, 0
    s_cmp_eq_u32 s68, 0
    s_cbranch_scc1 Lnowarm_1
    s_waitcnt vmcnt(0)
    s_barrier
    s_cmp_lg_u32 s60, 0
    s_cbranch_scc1 Lcnt_2
    s_mov_b64 exec, 1
    v_mov_b32 v2, 1
    buffer_atomic_add v2, off, s[8:11], 0 offset:4 sc0
    v_mov_b32 v3, 0x80000000
    s_waitcnt vmcnt(0)
    v_cmp_ne_u32 vcc, 255, v2
    s_nop 1
    v_cndmask_b32 v3, 4, v3, vcc
    buffer_store_dword v2, v3, s[8:11], 0 offen offset:128 sc1
    s_mov_b64 exec, -1
Lcnt_2:
    s_lshl_b32 s64, s60, 5
    s_add_u32 s64, s64, s59
    s_lshr_b32 s64, s64, 3
    s_cmp_lg_u32 s64, 3
    s_cbranch_scc1 Lnoprobe_4
    s_lshl_b32 s64, s69, 3
    s_and_b32 s65, s59, 7
    s_add_u32 s64, s64, s65
    s_lshl_b32 s64, s64, 7
    s_add_u32 s64, s64, 14860288
    s_add_u32 s66, s64, 131072
    v_lshlrev_b32 v3, 4, v0
    s_mov_b64 exec, 0xff
    s_mov_b32 s70, -1
    s_mov_b32 s71, -1
Lprobe_3:
    buffer_store_dwordx4 v[8:11], v3, s[4:7], s64 offen sc1
    s_mov_b32 s0, 0
Lprobe_3w:
    s_add_u32 s0, s0, 1
    s_sub_u32 s61, s61, 1
    s_cbranch_scc1 L_fail
    s_getreg_b32 s65, hwreg(HW_REG_IB_STS, 0, 4)
    s_cmp_lg_u32 s65, 0
    s_cbranch_scc1 Lprobe_3w
    s_waitcnt vmcnt(0)
    s_bitcmp1_b32 s64, 13
    s_cselect_b32 s65, -1, s0
    s_cselect_b32 s0, s0, -1
    s_min_u32 s70, s70, s65
    s_min_u32 s71, s71, s0
    s_add_u32 s64, s64, 0x1000
    s_or_b32 s64, s64, 0xc000
    s_cmp_lt_u32 s64, s66
    s_cbranch_scc1 Lprobe_3
    s_cmp_gt_u32 s70, s71
    s_cselect_b32 s65, 65, 64
    s_mov_b64 exec, 1
    v_mov_b32 v2, s65
    buffer_atomic_add v2, off, s[8:11], 0 offset:72 sc0
    s_waitcnt vmcnt(0)
    v_add_u32 v2, s65, v2
    v_subrev_u32 v2, 2047, v2
    v_mov_b32 v3, 0x80000000
    v_cmp_lt_i32 vcc, 0, v2
    s_nop 1
    v_cndmask_b32 v3, v3, 0, vcc
    buffer_store_dword v2, v3, s[8:11], 0 offen offset:140 sc1
    s_mov_b64 exec, -1
Lnoprobe_4:
    s_cmp_lg_u32 s60, 0
    s_cbranch_scc1 Lgskip_7
    buffer_load_dword v2, off, s[8:11], 0 offset:136 sc1
Lgchk_5:
    s_waitcnt vmcnt(0)
    v_cmp_eq_u32 vcc, 0, v2
    s_cbranch_vccnz Lgrty_6
Lgskip_7:
    s_waitcnt lgkmcnt(0)
    s_barrier
Lnowarm_1:
    s_cmp_lt_u32 s59, 24
    s_cbranch_scc1 L_roleC
    s_cmp_lt_u32 s59, 28
    s_cbranch_scc1 L_roleT
    s_cmp_lt_u32 s59, 30
    s_cbranch_scc1 L_roleB
    s_cmp_lt_u32 s59, 32
    s_cbranch_scc1 L_roleR
    s_mov_b32 s67, 2
L_fail:
    s_mov_b64 exec, 1
    s_lshl_b32 s67, s67, 8
    s_add_u32 s67, s67, s59
    s_lshl_b32 s67, s67, 8
    s_add_u32 s67, s67, s58
    s_lshl_b32 s67, s67, 8
    s_add_u32 s67, s67, s62
    s_waitcnt vmcnt(0)
    v_mov_b32 v2, s67
    buffer_store_dword v2, off, s[8:11], 0 offset:40
L_end:
    s_endpgm
L_roleC:
    s_mov_b32 s12, s36
    s_mov_b32 s13, s37
    s_mov_b32 s14, 7864320
    s_mov_b32 s15, 0x20000
    s_mov_b32 s16, s38
    s_mov_b32 s17, s39
    s_mov_b32 s18, 7864320
    s_mov_b32 s19, 0x20000
    s_mov_b32 s20, s40
    s_mov_b32 s21, s41
    s_mov_b32 s22, 7864320
    s_mov_b32 s23, 0x20000
    s_mov_b32 s24, s42
    s_mov_b32 s25, s43
    s_mov_b32 s26, 7864320
    s_mov_b32 s27, 0x20000
    s_mov_b32 s28, s34
    s_mov_b32 s29, s35
    s_mov_b32 s30, 10240
    s_mov_b32 s31, 0x20000
    v_and_b32 v1, 63, v0
    s_mul_i32 s64, s69, 3072
    s_lshl_b32 s65, s59, 7
    s_add_u32 s64, s64, s65
    s_mul_i32 s65, s60, 98304
    s_add_u32 s64, s64, s65
    v_lshrrev_b32 v194, 3, v1
    v_mul_u32_u24 v194, 12288, v194
    v_and_b32 v195, 7, v1
    v_lshl_add_u32 v194, v195, 4, v194
    v_add_u32 v194, s64, v194
    s_lshl_b32 s82, s60, 10
    s_lshl_b32 s64, s69, 2
    s_add_u32 s64, s64, s60
    s_mul_i32 s64, s64, 491520
    s_lshl_b32 s65, s59, 6
    s_add_u32 s64, s64, s65
    s_cmp_lt_u32 s59, 20
    s_cselect_b32 s64, s64, 0x80000000
    v_lshrrev_b32 v197, 2, v1
    v_mul_u32_u24 v197, 1280, v197
    v_and_b32 v198, 3, v1
    v_lshl_add_u32 v197, v198, 4, v197
    v_add_u32 v197, s64, v197
    s_lshl_b32 s83, s60, 12
    s_add_u32 m0, s83, 0
    s_mov_b32 s65, 0
    buffer_load_dwordx4 v197, s[24:27], s65 offen lds
    s_add_u32 m0, s83, 1024
    s_mov_b32 s65, 20480
    buffer_load_dwordx4 v197, s[24:27], s65 offen lds
    s_add_u32 m0, s83, 2048
    s_mov_b32 s65, 40960
    buffer_load_dwordx4 v197, s[24:27], s65 offen lds
    s_add_u32 m0, s83, 3072
    s_mov_b32 s65, 61440
    buffer_load_dwordx4 v197, s[24:27], s65 offen lds
    s_add_u32 m0, s83, 16384
    s_mov_b32 s65, 81920
    buffer_load_dwordx4 v197, s[24:27], s65 offen lds
    s_add_u32 m0, s83, 17408
    s_mov_b32 s65, 102400
    buffer_load_dwordx4 v197, s[24:27], s65 offen lds
    s_add_u32 m0, s83, 18432
    s_mov_b32 s65, 122880
    buffer_load_dwordx4 v197, s[24:27], s65 offen lds
    s_add_u32 m0, s83, 19456
    s_mov_b32 s65, 143360
    buffer_load_dwordx4 v197, s[24:27], s65 offen lds
    s_add_u32 m0, s83, 32768
    s_mov_b32 s65, 163840
    buffer_load_dwordx4 v197, s[24:27], s65 offen lds
    s_add_u32 m0, s83, 33792
    s_mov_b32 s65, 184320
    buffer_load_dwordx4 v197, s[24:27], s65 offen lds
    s_add_u32 m0, s83, 34816
    s_mov_b32 s65, 204800
    buffer_load_dwordx4 v197, s[24:27], s65 offen lds
    s_add_u32 m0, s83, 35840
    s_mov_b32 s65, 225280
    buffer_load_dwordx4 v197, s[24:27], s65 offen lds
    s_add_u32 m0, s83, 49152
    s_mov_b32 s65, 245760
    buffer_load_dwordx4 v197, s[24:27], s65 offen lds
    s_add_u32 m0, s83, 50176
    s_mov_b32 s65, 266240
    buffer_load_dwordx4 v197, s[24:27], s65 offen lds
    s_add_u32 m0, s83, 51200
    s_mov_b32 s65, 286720
    buffer_load_dwordx4 v197, s[24:27], s65 offen lds
    s_add_u32 m0, s83, 52224
    s_mov_b32 s65, 307200
    buffer_load_dwordx4 v197, s[24:27], s65 offen lds
    v_and_b32 v84, 7, v1
    v_bfe_u32 v85, v1, 3, 1
    v_lshrrev_b32 v86, 4, v1
    v_and_b32 v87, 15, v1
    v_lshlrev_b32 v234, 4, v0
    v_lshlrev_b32 v235, 3, v0
    v_add_u32 v235, 8192, v235
    v_lshlrev_b32 v236, 4, v1
    v_lshlrev_b32 v240, 3, v1
    v_lshlrev_b32 v237, 2, v1
    s_add_u32 s64, s60, 1
    s_mul_i32 s64, s64, 1280
    v_add_u32 v238, s64, v236
    v_add_u32 v239, s64, v237
    v_cmp_eq_u32 s[98:99], 1, v85
    v_cmp_lt_u32 s[100:101], 1, v86
    v_mov_b32 v88, 0x4444
    v_mov_b32 v89, 0xeeee
    v_cndmask_b32 v187, v88, v89, s[98:99]
    v_mov_b32 v88, 0xffff
    v_mov_b32 v89, 0xffff0000
    v_cndmask_b32 v231, v88, v89, s[98:99]
    v_mul_u32_u24 v232, 10240, v85
    v_lshl_add_u32 v232, v84, 7, v232
    v_xor_b32 v88, v86, v84
    v_lshl_add_u32 v232, v88, 4, v232
    v_add_u32 v232, 32768, v232
    v_xor_b32 v233, 64, v232
    v_lshrrev_b32 v88, 5, v1
    v_and_b32 v89, 1, v86
    v_lshlrev_b32 v90, 4, v87
    v_lshl_add_u32 v90, v89, 3, v90
    v_lshl_add_u32 v241, v88, 10, v90
    s_lshl_b32 s64, s60, 8
    v_add_u32 v241, s64, v241
    v_lshl_add_u32 v243, v88, 8, v90
    s_lshl_b32 s64, s60, 9
    v_add_u32 v243, s64, v243
    v_lshlrev_b32 v249, 9, v89
    v_lshl_add_u32 v249, v88, 6, v249
    v_bfe_u32 v90, v1, 1, 1
    v_lshl_add_u32 v249, v90, 5, v249
    v_bfe_u32 v90, v1, 2, 2
    v_lshl_add_u32 v249, v90, 3, v249
    v_and_b32 v89, 1, v1
    v_lshl_add_u32 v249, v89, 2, v249
    s_lshl_b32 s64, s60, 10
    s_add_u32 s64, s64, 18432
    v_add_u32 v249, s64, v249
    v_lshl_add_u32 v242, v86, 3, v90
    v_lshlrev_b32 v242, 4, v242
    v_lshl_add_u32 v242, v89, 3, v242
    v_bfe_u32 v88, v1, 1, 2
    v_lshlrev_b32 v250, 7, v88
    v_lshrrev_b32 v88, 3, v1
    v_lshl_add_u32 v250, v88, 4, v250
    v_lshl_add_u32 v250, v89, 3, v250
    s_lshl_b32 s64, s59, 9
    s_add_u32 s64, s64, 178176
    v_add_u32 v250, s64, v250
    s_lshl_b32 s66, s59, 10
    s_and_b32 s64, s66, 0x6000
    s_add_u32 s64, s64, s66
    s_lshl_b32 s65, s68, 20
    s_add_u32 s64, s64, s65
    s_add_u32 s64, s64, 14680064
    v_add_u32 v251, s64, v236
    s_and_b32 s64, s60, 1
    s_lshl_b32 s64, s64, 3
    s_lshr_b32 s65, s60, 1
    v_lshl_add_u32 v89, v86, 4, v84
    v_add_u32 v89, s64, v89
    s_lshl_b32 s64, s65, 11
    v_lshl_add_u32 v244, v89, 4, s64
    s_mul_i32 s64, s65, 1536
    v_lshlrev_b32 v246, 4, v89
    v_lshlrev_b32 v245, 3, v89
    v_add_u32 v245, 1024, v245
    v_cndmask_b32 v245, v246, v245, s[98:99]
    v_add_u32 v245, s64, v245
    v_lshl_add_u32 v246, v85, 1, v246
    v_add_u32 v246, s64, v246
    s_lshl_b32 s64, s60, 8
    s_add_u32 s64, s64, s66
    s_add_u32 s64, s64, 153600
    v_lshlrev_b32 v88, 5, v84
    v_lshl_add_u32 v247, v86, 3, v88
    v_add_u32 v247, s64, v247
    v_mov_b32 v89, 0x80000000
    v_cndmask_b32 v247, v247, v89, s[98:99]
    v_lshl_add_u32 v248, v86, 8, v88
    v_lshl_add_u32 v248, v85, 4, v248
    s_mul_i32 s64, s60, 6144
    s_add_u32 s64, s64, 153600
    v_add_u32 v248, s64, v248
    s_lshl_b32 s64, s59, 2
    s_add_u32 s64, s64, s60
    s_sub_u32 s64, s64, 80
    s_lshl_b32 s66, s64, 12
    s_and_b32 s65, s66, 0xe000
    s_add_u32 s66, s66, s65
    s_cmp_lt_u32 s64, 10
    s_cselect_b32 s64, s66, 0x80000000
    v_add_u32 v89, s64, v236
    s_cmp_lt_u32 s59, 20
    s_cselect_b64 vcc, -1, 0
    v_cndmask_b32 v248, v89, v248, vcc
    s_lshl_b32 s75, s59, 12
    s_mul_i32 s66, s69, 98304
    s_add_u32 s75, s75, s66
    s_mul_i32 s66, s68, 6291456
    s_add_u32 s75, s75, s66
    s_add_u32 s75, s75, 60817408
    v_lshlrev_b32 v88, 2, v86
    v_lshl_add_u32 v88, v85, 4, v88
    s_lshl_b32 s66, s60, 3
    v_add_u32 v89, s66, v84
    v_mov_b32 v90, 0xcf89a6aa
    v_cmp_gt_u32 vcc, v88, v89
    s_nop 1
    v_cndmask_b32 v188, 0, v90, vcc
    v_add_u32 v88, 1, v88
    v_cmp_gt_u32 vcc, v88, v89
    s_nop 1
    v_cndmask_b32 v189, 0, v90, vcc
    v_add_u32 v88, 1, v88
    v_cmp_gt_u32 vcc, v88, v89
    s_nop 1
    v_cndmask_b32 v190, 0, v90, vcc
    v_add_u32 v88, 1, v88
    v_cmp_gt_u32 vcc, v88, v89
    s_nop 1
    v_cndmask_b32 v191, 0, v90, vcc
    v_add_u32 v88, 1, v88
    v_mov_b32 v180, 0x3f803f80
    v_mov_b32 v181, 0x3f803f80
    v_mov_b32 v182, 0x3f803f80
    v_mov_b32 v183, 0
    v_mov_b32 v175, 0
    v_mov_b32 v179, 0
    s_mov_b32 s70, 0x3dd53b95
    s_cmp_lt_u32 s59, 20
    s_cselect_b32 s89, 4096, 0
    s_lshl_b32 s73, s60, 10
    s_add_u32 s73, s73, 32768
    s_lshl_b32 s91, s68, 23
    s_add_u32 s91, s91, 16777216
    s_mov_b32 s74, s91
    s_mul_i32 s64, s59, 43
    s_lshr_b32 s64, s64, 7
    s_mul_i32 s64, s64, 3
    s_add_u32 s65, s64, 3
    s_add_u32 s77, s59, 1
    s_cmp_eq_u32 s77, s65
    s_cselect_b32 s77, s64, s77
    s_add_u32 s78, s77, 1
    s_cmp_eq_u32 s78, s65
    s_cselect_b32 s78, s64, s78
    s_mul_i32 s76, s59, 6400
    s_mul_i32 s77, s77, 6400
    s_mul_i32 s78, s78, 6400
    s_cmp_lg_u32 s68, 0
    s_cbranch_scc1 Larr0_8
    s_waitcnt vmcnt(16)
    s_barrier
    s_cmp_lg_u32 s60, 0
    s_cbranch_scc1 Lcnt_9
    s_mov_b64 exec, 1
    v_mov_b32 v2, 1
    buffer_atomic_add v2, off, s[8:11], 0 offset:4 sc0
    s_mov_b64 exec, -1
Lcnt_9:
Larr0_8:
    s_add_u32 m0, s83, 65536
    s_mov_b32 s65, 327680
    buffer_load_dwordx4 v197, s[24:27], s65 offen lds
    s_add_u32 m0, s83, 66560
    s_mov_b32 s65, 348160
    buffer_load_dwordx4 v197, s[24:27], s65 offen lds
    s_add_u32 m0, s83, 67584
    s_mov_b32 s65, 368640
    buffer_load_dwordx4 v197, s[24:27], s65 offen lds
    s_add_u32 m0, s83, 68608
    s_mov_b32 s65, 389120
    buffer_load_dwordx4 v197, s[24:27], s65 offen lds
    s_add_u32 m0, s83, 81920
    s_mov_b32 s65, 409600
    buffer_load_dwordx4 v197, s[24:27], s65 offen lds
    s_add_u32 m0, s83, 82944
    s_mov_b32 s65, 430080
    buffer_load_dwordx4 v197, s[24:27], s65 offen lds
    s_add_u32 m0, s83, 83968
    s_mov_b32 s65, 450560
    buffer_load_dwordx4 v197, s[24:27], s65 offen lds
    s_add_u32 m0, s83, 84992
    s_mov_b32 s65, 471040
    buffer_load_dwordx4 v197, s[24:27], s65 offen lds
    s_add_u32 m0, s82, 98304
    s_mov_b32 s65, 0
    buffer_load_dwordx4 v194, s[12:15], s65 offen nt lds
    s_add_u32 m0, s82, 102400
    s_mov_b32 s65, 393216
    buffer_load_dwordx4 v194, s[12:15], s65 offen nt lds
    s_add_u32 m0, s82, 106496
    s_mov_b32 s65, 786432
    buffer_load_dwordx4 v194, s[12:15], s65 offen nt lds
    s_add_u32 m0, s82, 110592
    s_mov_b32 s65, 1179648
    buffer_load_dwordx4 v194, s[12:15], s65 offen nt lds
    s_add_u32 m0, s82, 114688
    s_mov_b32 s65, 1572864
    buffer_load_dwordx4 v194, s[12:15], s65 offen nt lds
    s_add_u32 m0, s82, 118784
    s_mov_b32 s65, 1966080
    buffer_load_dwordx4 v194, s[12:15], s65 offen nt lds
    s_add_u32 m0, s82, 122880
    s_mov_b32 s65, 2359296
    buffer_load_dwordx4 v194, s[12:15], s65 offen nt lds
    s_add_u32 m0, s82, 126976
    s_mov_b32 s65, 2752512
    buffer_load_dwordx4 v194, s[12:15], s65 offen nt lds
    s_add_u32 m0, s82, 131072
    s_mov_b32 s65, 3145728
    buffer_load_dwordx4 v194, s[12:15], s65 offen nt lds
    s_add_u32 m0, s82, 135168
    s_mov_b32 s65, 3538944
    buffer_load_dwordx4 v194, s[12:15], s65 offen nt lds
    s_add_u32 m0, s82, 139264
    s_mov_b32 s65, 3932160
    buffer_load_dwordx4 v194, s[12:15], s65 offen nt lds
    s_add_u32 m0, s82, 143360
    s_mov_b32 s65, 4325376
    buffer_load_dwordx4 v194, s[12:15], s65 offen nt lds
    v_bfe_u32 v196, v1, 2, 2
    v_lshl_add_u32 v195, v86, 3, v196
    v_lshlrev_b32 v195, 7, v195
    v_lshl_add_u32 v195, v198, 3, v195
    s_lshl_b32 s64, s60, 5
    v_add_u32 v195, s64, v195
    v_lshrrev_b32 v199, 5, v1
    v_lshlrev_b32 v199, 4, v199
    v_lshl_add_u32 v199, v85, 3, v199
    v_and_b32 v88, 1, v86
    v_lshl_add_u32 v199, v88, 2, v199
    v_bfe_u32 v88, v1, 2, 1
    v_add_u32 v199, v199, v88
    v_lshlrev_b32 v199, 6, v199
    v_lshl_add_u32 v199, v198, 3, v199
    v_add_u32 v199, s83, v199
    s_waitcnt vmcnt(32)
    s_waitcnt lgkmcnt(0)
    s_barrier
    s_add_u32 m0, s82, 147456
    s_mov_b32 s65, 4718592
    buffer_load_dwordx4 v194, s[12:15], s65 offen nt lds
    s_add_u32 m0, s82, 151552
    s_mov_b32 s65, 5111808
    buffer_load_dwordx4 v194, s[12:15], s65 offen nt lds
    s_add_u32 m0, s82, 155648
    s_mov_b32 s65, 5505024
    buffer_load_dwordx4 v194, s[12:15], s65 offen nt lds
    s_add_u32 m0, s82, 159744
    s_mov_b32 s65, 5898240
    buffer_load_dwordx4 v194, s[12:15], s65 offen nt lds
    v_add_u32 v196, 0, v199
    ds_read_b64_tr_b16 a[240:241], v196 offset:0
    ds_read_b64_tr_b16 a[242:243], v196 offset:128
    ds_read_b64_tr_b16 a[244:245], v196 offset:2048
    ds_read_b64_tr_b16 a[246:247], v196 offset:2176
    ds_read_b64_tr_b16 a[248:249], v196 offset:32
    ds_read_b64_tr_b16 a[250:251], v196 offset:160
    ds_read_b64_tr_b16 a[252:253], v196 offset:2080
    ds_read_b64_tr_b16 a[254:255], v196 offset:2208
    s_waitcnt vmcnt(32)
    s_waitcnt lgkmcnt(0)
    s_barrier
    s_add_u32 m0, s82, 0
    s_mov_b32 s65, 6291456
    buffer_load_dwordx4 v194, s[12:15], s65 offen nt lds
    s_add_u32 m0, s82, 4096
    s_mov_b32 s65, 6684672
    buffer_load_dwordx4 v194, s[12:15], s65 offen nt lds
    s_add_u32 m0, s82, 8192
    s_mov_b32 s65, 7077888
    buffer_load_dwordx4 v194, s[12:15], s65 offen nt lds
    s_add_u32 m0, s82, 12288
    s_mov_b32 s65, 7471104
    buffer_load_dwordx4 v194, s[12:15], s65 offen nt lds
    v_add_u32 v196, 16384, v199
    ds_read_b64_tr_b16 v[4:5], v196 offset:0
    ds_read_b64_tr_b16 v[6:7], v196 offset:128
    ds_read_b64_tr_b16 v[8:9], v196 offset:2048
    ds_read_b64_tr_b16 v[10:11], v196 offset:2176
    ds_read_b64_tr_b16 v[12:13], v196 offset:32
    ds_read_b64_tr_b16 v[14:15], v196 offset:160
    ds_read_b64_tr_b16 v[16:17], v196 offset:2080
    ds_read_b64_tr_b16 v[18:19], v196 offset:2208
    s_waitcnt vmcnt(32)
    s_waitcnt lgkmcnt(0)
    s_barrier
    s_add_u32 m0, s82, 16384
    s_mov_b32 s65, 0
    buffer_load_dwordx4 v194, s[16:19], s65 offen nt lds
    s_add_u32 m0, s82, 20480
    s_mov_b32 s65, 393216
    buffer_load_dwordx4 v194, s[16:19], s65 offen nt lds
    s_add_u32 m0, s82, 24576
    s_mov_b32 s65, 786432
    buffer_load_dwordx4 v194, s[16:19], s65 offen nt lds
    s_add_u32 m0, s82, 28672
    s_mov_b32 s65, 1179648
    buffer_load_dwordx4 v194, s[16:19], s65 offen nt lds
    v_add_u32 v196, 32768, v199
    ds_read_b64_tr_b16 v[20:21], v196 offset:0
    ds_read_b64_tr_b16 v[22:23], v196 offset:128
    ds_read_b64_tr_b16 v[24:25], v196 offset:2048
    ds_read_b64_tr_b16 v[26:27], v196 offset:2176
    ds_read_b64_tr_b16 v[28:29], v196 offset:32
    ds_read_b64_tr_b16 v[30:31], v196 offset:160
    ds_read_b64_tr_b16 v[32:33], v196 offset:2080
    ds_read_b64_tr_b16 v[34:35], v196 offset:2208
    s_waitcnt vmcnt(32)
    s_waitcnt lgkmcnt(0)
    s_barrier
    s_add_u32 m0, s82, 32768
    s_mov_b32 s65, 1572864
    buffer_load_dwordx4 v194, s[16:19], s65 offen nt lds
    s_add_u32 m0, s82, 36864
    s_mov_b32 s65, 1966080
    buffer_load_dwordx4 v194, s[16:19], s65 offen nt lds
    s_add_u32 m0, s82, 40960
    s_mov_b32 s65, 2359296
    buffer_load_dwordx4 v194, s[16:19], s65 offen nt lds
    s_add_u32 m0, s82, 45056
    s_mov_b32 s65, 2752512
    buffer_load_dwordx4 v194, s[16:19], s65 offen nt lds
    v_add_u32 v196, 49152, v199
    ds_read_b64_tr_b16 v[36:37], v196 offset:0
    ds_read_b64_tr_b16 v[38:39], v196 offset:128
    ds_read_b64_tr_b16 v[40:41], v196 offset:2048
    ds_read_b64_tr_b16 v[42:43], v196 offset:2176
    ds_read_b64_tr_b16 v[44:45], v196 offset:32
    ds_read_b64_tr_b16 v[46:47], v196 offset:160
    ds_read_b64_tr_b16 v[48:49], v196 offset:2080
    ds_read_b64_tr_b16 v[50:51], v196 offset:2208
    s_waitcnt vmcnt(32)
    s_waitcnt lgkmcnt(0)
    s_barrier
    s_add_u32 m0, s82, 49152
    s_mov_b32 s65, 3145728
    buffer_load_dwordx4 v194, s[16:19], s65 offen nt lds
    s_add_u32 m0, s82, 53248
    s_mov_b32 s65, 3538944
    buffer_load_dwordx4 v194, s[16:19], s65 offen nt lds
    s_add_u32 m0, s82, 57344
    s_mov_b32 s65, 3932160
    buffer_load_dwordx4 v194, s[16:19], s65 offen nt lds
    s_add_u32 m0, s82, 61440
    s_mov_b32 s65, 4325376
    buffer_load_dwordx4 v194, s[16:19], s65 offen nt lds
    s_cmp_lg_u32 s68, 0
    s_cbranch_scc1 Larr0_10
    s_cmp_lg_u32 s60, 0
    s_cbranch_scc1 Lcnt_11
    s_mov_b64 exec, 1
    v_mov_b32 v3, 0x80000000
    v_cmp_ne_u32 vcc, 255, v2
    s_nop 1
    v_cndmask_b32 v3, 4, v3, vcc
    buffer_store_dword v2, v3, s[8:11], 0 offen offset:128 sc1
    s_mov_b64 exec, -1
Lcnt_11:
Larr0_10:
    v_add_u32 v196, 65536, v199
    ds_read_b64_tr_b16 v[52:53], v196 offset:0
    ds_read_b64_tr_b16 v[54:55], v196 offset:128
    ds_read_b64_tr_b16 v[56:57], v196 offset:2048
    ds_read_b64_tr_b16 v[58:59], v196 offset:2176
    ds_read_b64_tr_b16 v[60:61], v196 offset:32
    ds_read_b64_tr_b16 v[62:63], v196 offset:160
    ds_read_b64_tr_b16 v[64:65], v196 offset:2080
    ds_read_b64_tr_b16 v[66:67], v196 offset:2208
    s_waitcnt vmcnt(32)
    s_waitcnt lgkmcnt(0)
    s_barrier
    s_add_u32 m0, s82, 65536
    s_mov_b32 s65, 4718592
    buffer_load_dwordx4 v194, s[16:19], s65 offen nt lds
    s_add_u32 m0, s82, 69632
    s_mov_b32 s65, 5111808
    buffer_load_dwordx4 v194, s[16:19], s65 offen nt lds
    s_add_u32 m0, s82, 73728
    s_mov_b32 s65, 5505024
    buffer_load_dwordx4 v194, s[16:19], s65 offen nt lds
    s_add_u32 m0, s82, 77824
    s_mov_b32 s65, 5898240
    buffer_load_dwordx4 v194, s[16:19], s65 offen nt lds
    v_add_u32 v196, 81920, v199
    ds_read_b64_tr_b16 v[68:69], v196 offset:0
    ds_read_b64_tr_b16 v[70:71], v196 offset:128
    ds_read_b64_tr_b16 v[72:73], v196 offset:2048
    ds_read_b64_tr_b16 v[74:75], v196 offset:2176
    ds_read_b64_tr_b16 v[76:77], v196 offset:32
    ds_read_b64_tr_b16 v[78:79], v196 offset:160
    ds_read_b64_tr_b16 v[80:81], v196 offset:2080
    ds_read_b64_tr_b16 v[82:83], v196 offset:2208
    s_waitcnt vmcnt(32)
    s_waitcnt lgkmcnt(0)
    s_barrier
    s_add_u32 m0, s82, 81920
    s_mov_b32 s65, 6291456
    buffer_load_dwordx4 v194, s[16:19], s65 offen nt lds
    s_add_u32 m0, s82, 86016
    s_mov_b32 s65, 6684672
    buffer_load_dwordx4 v194, s[16:19], s65 offen nt lds
    s_add_u32 m0, s82, 90112
    s_mov_b32 s65, 7077888
    buffer_load_dwordx4 v194, s[16:19], s65 offen nt lds
    s_add_u32 m0, s82, 94208
    s_mov_b32 s65, 7471104
    buffer_load_dwordx4 v194, s[16:19], s65 offen nt lds
    v_add_u32 v196, 98304, v195
    ds_read_b64_tr_b16 a[0:1], v196 offset:0
    ds_read_b64_tr_b16 a[2:3], v196 offset:512
    ds_read_b64_tr_b16 a[4:5], v196 offset:4096
    ds_read_b64_tr_b16 a[6:7], v196 offset:4608
    ds_read_b64_tr_b16 a[8:9], v196 offset:8192
    ds_read_b64_tr_b16 a[10:11], v196 offset:8704
    ds_read_b64_tr_b16 a[12:13], v196 offset:12288
    ds_read_b64_tr_b16 a[14:15], v196 offset:12800
    s_waitcnt vmcnt(32)
    s_waitcnt lgkmcnt(0)
    s_barrier
    s_add_u32 m0, s82, 98304
    s_mov_b32 s65, 0
    buffer_load_dwordx4 v194, s[20:23], s65 offen nt lds
    s_add_u32 m0, s82, 102400
    s_mov_b32 s65, 393216
    buffer_load_dwordx4 v194, s[20:23], s65 offen nt lds
    s_add_u32 m0, s82, 106496
    s_mov_b32 s65, 786432
    buffer_load_dwordx4 v194, s[20:23], s65 offen nt lds
    s_add_u32 m0, s82, 110592
    s_mov_b32 s65, 1179648
    buffer_load_dwordx4 v194, s[20:23], s65 offen nt lds
    buffer_load_dwordx3 v[216:218], off, s[8:11], 0 offset:132 sc1
    v_add_u32 v196, 114688, v195
    ds_read_b64_tr_b16 a[16:17], v196 offset:0
    ds_read_b64_tr_b16 a[18:19], v196 offset:512
    ds_read_b64_tr_b16 a[20:21], v196 offset:4096
    ds_read_b64_tr_b16 a[22:23], v196 offset:4608
    ds_read_b64_tr_b16 a[24:25], v196 offset:8192
    ds_read_b64_tr_b16 a[26:27], v196 offset:8704
    ds_read_b64_tr_b16 a[28:29], v196 offset:12288
    ds_read_b64_tr_b16 a[30:31], v196 offset:12800
    s_waitcnt vmcnt(32)
    s_waitcnt lgkmcnt(0)
    s_barrier
    s_add_u32 m0, s82, 114688
    s_mov_b32 s65, 1572864
    buffer_load_dwordx4 v194, s[20:23], s65 offen nt lds
    s_add_u32 m0, s82, 118784
    s_mov_b32 s65, 1966080
    buffer_load_dwordx4 v194, s[20:23], s65 offen nt lds
    s_add_u32 m0, s82, 122880
    s_mov_b32 s65, 2359296
    buffer_load_dwordx4 v194, s[20:23], s65 offen nt lds
    s_add_u32 m0, s82, 126976
    s_mov_b32 s65, 2752512
    buffer_load_dwordx4 v194, s[20:23], s65 offen nt lds
    v_add_u32 v196, 131072, v195
    ds_read_b64_tr_b16 a[32:33], v196 offset:0
    ds_read_b64_tr_b16 a[34:35], v196 offset:512
    ds_read_b64_tr_b16 a[36:37], v196 offset:4096
    ds_read_b64_tr_b16 a[38:39], v196 offset:4608
    ds_read_b64_tr_b16 a[40:41], v196 offset:8192
    ds_read_b64_tr_b16 a[42:43], v196 offset:8704
    ds_read_b64_tr_b16 a[44:45], v196 offset:12288
    ds_read_b64_tr_b16 a[46:47], v196 offset:12800
    s_waitcnt vmcnt(32)
    s_waitcnt lgkmcnt(0)
    s_barrier
    s_add_u32 m0, s82, 131072
    s_mov_b32 s65, 3145728
    buffer_load_dwordx4 v194, s[20:23], s65 offen nt lds
    s_add_u32 m0, s82, 135168
    s_mov_b32 s65, 3538944
    buffer_load_dwordx4 v194, s[20:23], s65 offen nt lds
    s_add_u32 m0, s82, 139264
    s_mov_b32 s65, 3932160
    buffer_load_dwordx4 v194, s[20:23], s65 offen nt lds
    s_add_u32 m0, s82, 143360
    s_mov_b32 s65, 4325376
    buffer_load_dwordx4 v194, s[20:23], s65 offen nt lds
    v_add_u32 v196, 147456, v195
    ds_read_b64_tr_b16 a[48:49], v196 offset:0
    ds_read_b64_tr_b16 a[50:51], v196 offset:512
    ds_read_b64_tr_b16 a[52:53], v196 offset:4096
    ds_read_b64_tr_b16 a[54:55], v196 offset:4608
    ds_read_b64_tr_b16 a[56:57], v196 offset:8192
    ds_read_b64_tr_b16 a[58:59], v196 offset:8704
    ds_read_b64_tr_b16 a[60:61], v196 offset:12288
    ds_read_b64_tr_b16 a[62:63], v196 offset:12800
    s_waitcnt vmcnt(32)
    s_waitcnt lgkmcnt(0)
    s_barrier
    s_add_u32 m0, s82, 147456
    s_mov_b32 s65, 4718592
    buffer_load_dwordx4 v194, s[20:23], s65 offen nt lds
    s_add_u32 m0, s82, 151552
    s_mov_b32 s65, 5111808
    buffer_load_dwordx4 v194, s[20:23], s65 offen nt lds
    s_add_u32 m0, s82, 155648
    s_mov_b32 s65, 5505024
    buffer_load_dwordx4 v194, s[20:23], s65 offen nt lds
    s_add_u32 m0, s82, 159744
    s_mov_b32 s65, 5898240
    buffer_load_dwordx4 v194, s[20:23], s65 offen nt lds
    v_add_u32 v196, 0, v195
    ds_read_b64_tr_b16 a[64:65], v196 offset:0
    ds_read_b64_tr_b16 a[66:67], v196 offset:512
    ds_read_b64_tr_b16 a[68:69], v196 offset:4096
    ds_read_b64_tr_b16 a[70:71], v196 offset:4608
    ds_read_b64_tr_b16 a[72:73], v196 offset:8192
    ds_read_b64_tr_b16 a[74:75], v196 offset:8704
    ds_read_b64_tr_b16 a[76:77], v196 offset:12288
    ds_read_b64_tr_b16 a[78:79], v196 offset:12800
    s_waitcnt vmcnt(32)
    s_waitcnt lgkmcnt(0)
    s_barrier
    s_add_u32 m0, s82, 0
    s_mov_b32 s65, 6291456
    buffer_load_dwordx4 v194, s[20:23], s65 offen nt lds
    s_add_u32 m0, s82, 4096
    s_mov_b32 s65, 6684672
    buffer_load_dwordx4 v194, s[20:23], s65 offen nt lds
    s_add_u32 m0, s82, 8192
    s_mov_b32 s65, 7077888
    buffer_load_dwordx4 v194, s[20:23], s65 offen nt lds
    s_add_u32 m0, s82, 12288
    s_mov_b32 s65, 7471104
    buffer_load_dwordx4 v194, s[20:23], s65 offen nt lds
    v_add_u32 v196, 16384, v195
    ds_read_b64_tr_b16 a[80:81], v196 offset:0
    ds_read_b64_tr_b16 a[82:83], v196 offset:512
    ds_read_b64_tr_b16 a[84:85], v196 offset:4096
    ds_read_b64_tr_b16 a[86:87], v196 offset:4608
    ds_read_b64_tr_b16 a[88:89], v196 offset:8192
    ds_read_b64_tr_b16 a[90:91], v196 offset:8704
    ds_read_b64_tr_b16 a[92:93], v196 offset:12288
    ds_read_b64_tr_b16 a[94:95], v196 offset:12800
    s_waitcnt vmcnt(32)
    s_waitcnt lgkmcnt(0)
    s_barrier
    v_add_u32 v196, 32768, v195
    ds_read_b64_tr_b16 a[96:97], v196 offset:0
    ds_read_b64_tr_b16 a[98:99], v196 offset:512
    ds_read_b64_tr_b16 a[100:101], v196 offset:4096
    ds_read_b64_tr_b16 a[102:103], v196 offset:4608
    ds_read_b64_tr_b16 a[104:105], v196 offset:8192
    ds_read_b64_tr_b16 a[106:107], v196 offset:8704
    ds_read_b64_tr_b16 a[108:109], v196 offset:12288
    ds_read_b64_tr_b16 a[110:111], v196 offset:12800
    s_waitcnt vmcnt(28)
    s_waitcnt lgkmcnt(0)
    s_barrier
    v_add_u32 v196, 49152, v195
    ds_read_b64_tr_b16 a[112:113], v196 offset:0
    ds_read_b64_tr_b16 a[114:115], v196 offset:512
    ds_read_b64_tr_b16 a[116:117], v196 offset:4096
    ds_read_b64_tr_b16 a[118:119], v196 offset:4608
    ds_read_b64_tr_b16 a[120:121], v196 offset:8192
    ds_read_b64_tr_b16 a[122:123], v196 offset:8704
    ds_read_b64_tr_b16 a[124:125], v196 offset:12288
    ds_read_b64_tr_b16 a[126:127], v196 offset:12800
    s_waitcnt vmcnt(24)
    s_waitcnt lgkmcnt(0)
    s_barrier
    v_add_u32 v196, 65536, v195
    ds_read_b64_tr_b16 a[128:129], v196 offset:0
    ds_read_b64_tr_b16 a[130:131], v196 offset:512
    ds_read_b64_tr_b16 a[132:133], v196 offset:4096
    ds_read_b64_tr_b16 a[134:135], v196 offset:4608
    ds_read_b64_tr_b16 a[136:137], v196 offset:8192
    ds_read_b64_tr_b16 a[138:139], v196 offset:8704
    ds_read_b64_tr_b16 a[140:141], v196 offset:12288
    ds_read_b64_tr_b16 a[142:143], v196 offset:12800
Lgchk_12:
    s_waitcnt vmcnt(16)
    v_min_u32 v214, v216, v218
    v_cmp_eq_u32 vcc, 0, v214
    s_cbranch_vccnz Lgrty_13
    s_waitcnt vmcnt(20)
    s_waitcnt lgkmcnt(0)
    s_barrier
    v_mul_u32_u24 v200, 1280, v84
    v_lshrrev_b32 v201, 4, v0
    v_lshl_add_u32 v200, v201, 5, v200
    v_lshl_add_u32 v200, v85, 2, v200
    buffer_load_dword v202, v200, s[28:31], 0 offen offset:0
    buffer_load_dword v203, v200, s[28:31], 0 offen offset:8
    buffer_load_dword v204, v200, s[28:31], 0 offen offset:16
    buffer_load_dword v205, v200, s[28:31], 0 offen offset:24
    buffer_load_dword v206, v200, s[28:31], 0 offen offset:512
    buffer_load_dword v207, v200, s[28:31], 0 offen offset:520
    buffer_load_dword v208, v200, s[28:31], 0 offen offset:528
    buffer_load_dword v209, v200, s[28:31], 0 offen offset:536
    buffer_load_dword v210, v200, s[28:31], 0 offen offset:1024
    buffer_load_dword v211, v200, s[28:31], 0 offen offset:1032
    buffer_load_dword v212, v200, s[28:31], 0 offen offset:1040
    buffer_load_dword v213, v200, s[28:31], 0 offen offset:1048
    s_cmp_eq_u32 s68, 0
    s_cbranch_scc1 Lt0_14
    s_waitcnt vmcnt(0)
    s_branch Lt0_15
Lt0_14:
    s_add_u32 m0, s73, 0
    s_add_u32 s94, s74, 0
    buffer_load_dwordx4 v234, s[4:7], s94 offen sc1 lds
    s_add_u32 m0, s73, 4096
    s_add_u32 s94, s74, 4096
    buffer_load_dwordx4 v234, s[4:7], s94 offen sc1 lds
    s_add_u32 m0, s73, 8192
    s_add_u32 s94, s74, 16384
    buffer_load_dwordx4 v234, s[4:7], s94 offen sc1 lds
    s_add_u32 m0, s73, 12288
    s_add_u32 s94, s74, 20480
    buffer_load_dwordx4 v234, s[4:7], s94 offen sc1 lds
    s_add_u32 m0, s73, 16384
    s_add_u32 s94, s74, 32768
    buffer_load_dwordx4 v234, s[4:7], s94 offen sc1 lds
    s_add_u32 m0, s73, 20480
    s_add_u32 s94, s74, 36864
    buffer_load_dwordx4 v234, s[4:7], s94 offen sc1 lds
    s_add_u32 m0, s73, 24576
    s_add_u32 s94, s74, 49152
    buffer_load_dwordx4 v234, s[4:7], s94 offen sc1 lds
    s_add_u32 m0, s73, 28672
    s_add_u32 s94, s74, 53248
    buffer_load_dwordx4 v234, s[4:7], s94 offen sc1 lds
    s_add_u32 m0, s73, 32768
    s_add_u32 s94, s74, 65536
    buffer_load_dwordx4 v234, s[4:7], s94 offen sc1 lds
    s_add_u32 m0, s73, 36864
    s_add_u32 s94, s74, 69632
    buffer_load_dwordx4 v234, s[4:7], s94 offen sc1 lds
Lt0_15:
    v_add_u32 v196, 81920, v195
    ds_read_b64_tr_b16 a[144:145], v196 offset:0
    ds_read_b64_tr_b16 a[146:147], v196 offset:512
    ds_read_b64_tr_b16 a[148:149], v196 offset:4096
    ds_read_b64_tr_b16 a[150:151], v196 offset:4608
    ds_read_b64_tr_b16 a[152:153], v196 offset:8192
    ds_read_b64_tr_b16 a[154:155], v196 offset:8704
    ds_read_b64_tr_b16 a[156:157], v196 offset:12288
    ds_read_b64_tr_b16 a[158:159], v196 offset:12800
    s_waitcnt vmcnt(38)
    s_waitcnt lgkmcnt(0)
    s_barrier
    v_add_u32 v196, 98304, v195
    ds_read_b64_tr_b16 a[160:161], v196 offset:0
    ds_read_b64_tr_b16 a[162:163], v196 offset:512
    ds_read_b64_tr_b16 a[164:165], v196 offset:4096
    ds_read_b64_tr_b16 a[166:167], v196 offset:4608
    ds_read_b64_tr_b16 a[168:169], v196 offset:8192
    ds_read_b64_tr_b16 a[170:171], v196 offset:8704
    ds_read_b64_tr_b16 a[172:173], v196 offset:12288
    ds_read_b64_tr_b16 a[174:175], v196 offset:12800
    s_waitcnt vmcnt(34)
    s_waitcnt lgkmcnt(0)
    s_barrier
    v_add_u32 v196, 114688, v195
    ds_read_b64_tr_b16 a[176:177], v196 offset:0
    ds_read_b64_tr_b16 a[178:179], v196 offset:512
    ds_read_b64_tr_b16 a[180:181], v196 offset:4096
    ds_read_b64_tr_b16 a[182:183], v196 offset:4608
    ds_read_b64_tr_b16 a[184:185], v196 offset:8192
    ds_read_b64_tr_b16 a[186:187], v196 offset:8704
    ds_read_b64_tr_b16 a[188:189], v196 offset:12288
    ds_read_b64_tr_b16 a[190:191], v196 offset:12800
    s_waitcnt vmcnt(30)
    s_waitcnt lgkmcnt(0)
    s_barrier
    v_add_u32 v196, 131072, v195
    ds_read_b64_tr_b16 a[192:193], v196 offset:0
    ds_read_b64_tr_b16 a[194:195], v196 offset:512
    ds_read_b64_tr_b16 a[196:197], v196 offset:4096
    ds_read_b64_tr_b16 a[198:199], v196 offset:4608
    ds_read_b64_tr_b16 a[200:201], v196 offset:8192
    ds_read_b64_tr_b16 a[202:203], v196 offset:8704
    ds_read_b64_tr_b16 a[204:205], v196 offset:12288
    ds_read_b64_tr_b16 a[206:207], v196 offset:12800
    s_waitcnt vmcnt(26)
    s_waitcnt lgkmcnt(0)
    s_barrier
    v_add_u32 v196, 147456, v195
    ds_read_b64_tr_b16 a[208:209], v196 offset:0
    ds_read_b64_tr_b16 a[210:211], v196 offset:512
    ds_read_b64_tr_b16 a[212:213], v196 offset:4096
    ds_read_b64_tr_b16 a[214:215], v196 offset:4608
    ds_read_b64_tr_b16 a[216:217], v196 offset:8192
    ds_read_b64_tr_b16 a[218:219], v196 offset:8704
    ds_read_b64_tr_b16 a[220:221], v196 offset:12288
    ds_read_b64_tr_b16 a[222:223], v196 offset:12800
    s_waitcnt vmcnt(22)
    s_waitcnt lgkmcnt(0)
    s_barrier
    v_add_u32 v196, 0, v195
    ds_read_b64_tr_b16 a[224:225], v196 offset:0
    ds_read_b64_tr_b16 a[226:227], v196 offset:512
    ds_read_b64_tr_b16 a[228:229], v196 offset:4096
    ds_read_b64_tr_b16 a[230:231], v196 offset:4608
    ds_read_b64_tr_b16 a[232:233], v196 offset:8192
    ds_read_b64_tr_b16 a[234:235], v196 offset:8704
    ds_read_b64_tr_b16 a[236:237], v196 offset:12288
    ds_read_b64_tr_b16 a[238:239], v196 offset:12800
    s_waitcnt lgkmcnt(0)
    s_barrier
    v_readfirstlane_b32 s1, v218
    s_cmp_gt_u32 s1, 17
    s_cselect_b32 s1, 1, 0
    s_xor_b32 s1, s1, s68
    s_lshl_b32 s1, s1, 13
    s_lshl_b32 s93, s68, 13
    s_xor_b32 s64, s1, 0x2000
    v_add_u32 v251, s64, v251
    s_lshr_b32 s74, s91, 8
    s_xor_b32 s74, s74, s1
    s_and_b32 s74, s74, s93
    s_or_b32 s74, s74, s91
    s_add_u32 s91, s91, 131072
    s_lshr_b32 s92, s91, 8
    s_xor_b32 s92, s92, s1
    s_and_b32 s92, s92, s93
    s_or_b32 s92, s92, s91
    v_and_b32 v252, 3, v0
    v_mov_b32 v88, 31
    v_lshl_add_u32 v252, v88, 2, v252
    v_lshlrev_b32 v252, 7, v252
    v_bfe_u32 v88, v0, 4, 2
    v_cmp_eq_u32 vcc, s69, v88
    s_xor_b32 s64, s1, 0x2000
    s_add_u32 s64, s64, 14798848
    v_lshl_add_u32 v88, v88, 18, s64
    v_add_u32 v252, v252, v88
    v_lshrrev_b32 v88, 2, v1
    v_and_b32 v88, 12, v88
    v_and_b32 v89, 3, v1
    v_add_u32 v88, v88, v89
    s_lshl_b32 s64, s58, 14
    s_add_u32 s64, s64, 8400896
    v_lshl_add_u32 v88, v88, 7, s64
    v_bfe_u32 v89, v1, 2, 1
    v_and_b32 v89, s68, v89
    v_cmp_eq_u32 vcc, 1, v89
    s_nop 1
    v_cndmask_b32 v252, v88, v252, vcc
    v_mov_b32 v88, -12
    v_cndmask_b32 v225, v88, 8, vcc
    v_mov_b32 v194, 0x80000000
    s_cmp_lt_u32 s59, 20
    s_cselect_b32 s87, -2, -1
    s_cselect_b64 vcc, -1, 0
    v_mov_b32 v192, -1
    v_cndmask_b32 v193, 0, 1, vcc
    v_cndmask_b32 v250, v194, v250, vcc
    v_cndmask_b32 v251, v194, v251, vcc
    s_cmp_eq_u32 s60, 2
    s_cselect_b64 vcc, -1, 0
    v_cndmask_b32 v252, v194, v252, vcc
    v_cmp_ne_u32 s[96:97], 0, v1
    s_nop 1
    v_cndmask_b32 v1, 0, v194, s[96:97]
    v_mov_b32 v194, -1000
    v_cndmask_b32 v225, v194, v225, vcc
    v_mov_b64 v[194:195], 0
    v_mov_b64 v[196:197], 0
    ds_write_b128 v234, v[194:197] offset:14336
    s_waitcnt vmcnt(18)
    ds_write_b128 v234, v[202:205] offset:0
    s_waitcnt vmcnt(14)
    ds_write_b128 v234, v[206:209] offset:4096
    s_waitcnt vmcnt(10)
    ds_write_b128 v234, v[210:213] offset:8192
    s_cmp_lg_u32 s60, 1
    s_cbranch_scc1 Lcnt_17
    s_mov_b64 exec, 1
    v_mov_b32 v216, 1
    buffer_atomic_add v216, off, s[8:11], 0 offset:68 sc0
    s_mov_b64 exec, -1
Lcnt_17:
    s_cmp_eq_u32 s68, 0
    s_cbranch_scc1 Lt0_16
    buffer_load_dword v2, v252, s[4:7], 0 offen sc1
    v_lshl_add_u32 v3, s62, 1, v225
    v_add_u32 v3, -6, v3
    v_min_i32 v3, 128, v3
Lfchk_18:
    s_waitcnt vmcnt(0)
    v_cmp_gt_i32 vcc, v3, v2
    s_cbranch_vccnz Lfrty_19
    s_waitcnt lgkmcnt(0)
    s_barrier
    s_add_u32 m0, s73, 0
    s_add_u32 s94, s74, 0
    buffer_load_dwordx4 v234, s[4:7], s94 offen sc1 lds
    s_add_u32 m0, s73, 4096
    s_add_u32 s94, s74, 4096
    buffer_load_dwordx4 v234, s[4:7], s94 offen sc1 lds
    s_add_u32 m0, s73, 8192
    s_add_u32 s94, s74, 16384
    buffer_load_dwordx4 v234, s[4:7], s94 offen sc1 lds
    s_add_u32 m0, s73, 12288
    s_add_u32 s94, s74, 20480
    buffer_load_dwordx4 v234, s[4:7], s94 offen sc1 lds
    s_add_u32 m0, s73, 16384
    s_add_u32 s94, s74, 32768
    buffer_load_dwordx4 v234, s[4:7], s94 offen sc1 lds
    s_add_u32 m0, s73, 20480
    s_add_u32 s94, s74, 36864
    buffer_load_dwordx4 v234, s[4:7], s94 offen sc1 lds
    s_add_u32 m0, s73, 24576
    s_add_u32 s94, s74, 49152
    buffer_load_dwordx4 v234, s[4:7], s94 offen sc1 lds
    s_add_u32 m0, s73, 28672
    s_add_u32 s94, s74, 53248
    buffer_load_dwordx4 v234, s[4:7], s94 offen sc1 lds
    s_add_u32 m0, s73, 32768
    s_add_u32 s94, s74, 65536
    buffer_load_dwordx4 v234, s[4:7], s94 offen sc1 lds
    s_add_u32 m0, s73, 36864
    s_add_u32 s94, s74, 69632
    buffer_load_dwordx4 v234, s[4:7], s94 offen sc1 lds
    buffer_load_dword v2, v252, s[4:7], 0 offen sc1
    s_waitcnt vmcnt(0)
    v_lshl_add_u32 v3, s62, 1, v225
    v_add_u32 v3, -4, v3
    v_min_i32 v3, 128, v3
Lfchk_20:
    v_cmp_gt_i32 vcc, v3, v2
    s_cbranch_vccnz Lfrty_21
Lt0_16:
    s_cmp_lg_u32 s60, 1
    s_cbranch_scc1 Lt0_16a
    s_waitcnt vmcnt(1)
    s_branch Lt0_16b
Lt0_16a:
    s_waitcnt vmcnt(0)
Lt0_16b:
    s_waitcnt lgkmcnt(0)
    s_barrier
    ds_read_b128 v[124:127], v232 offset:0
    ds_read_b128 v[128:131], v232 offset:20480
    ds_read_b128 v[132:135], v233 offset:0
    ds_read_b128 v[136:139], v233 offset:20480
    ds_read_b128 v[140:143], v232 offset:1024
    s_mov_b32 s74, s92
    s_xor_b32 s73, s73, 65536
    s_add_u32 s91, s91, 131072
    s_lshr_b32 s92, s91, 8
    s_xor_b32 s92, s92, s1
    s_and_b32 s92, s92, s93
    s_or_b32 s92, s92, s91
    s_waitcnt lgkmcnt(4)
    v_mfma_f32_16x16x32_bf16 v[148:151], a[0:3], v[124:127], 0
    ds_read_b128 v[144:147], v232 offset:21504
    v_mov_b64 v[194:195], 0
    v_mfma_f32_16x16x32_bf16 v[156:159], a[80:83], v[124:127], 0
    v_mov_b64 v[196:197], 0
    v_mov_b64 v[198:199], 0
    v_mfma_f32_16x16x32_bf16 v[164:167], v[124:127], a[160:163], 0
    s_waitcnt lgkmcnt(4)
    v_mov_b64 v[200:201], 0
    v_mov_b64 v[202:203], 0
    v_mfma_f32_16x16x32_bf16 v[152:155], a[0:3], v[128:131], 0
    ds_read_b128 v[124:127], v233 offset:1024
    v_mov_b64 v[204:205], 0
    v_mfma_f32_16x16x32_bf16 v[160:163], a[80:83], v[128:131], 0
    s_add_u32 m0, s73, 0
    s_add_u32 s94, s74, 0
    buffer_load_dwordx4 v234, s[4:7], s94 offen sc1 lds
    v_mfma_f32_16x16x32_bf16 v[168:171], v[128:131], a[160:163], 0
    s_waitcnt lgkmcnt(4)
    v_mfma_f32_16x16x32_bf16 v[148:151], a[4:7], v[132:135], v[148:151]
    ds_read_b128 v[128:131], v233 offset:21504
    v_mfma_f32_16x16x32_bf16 v[156:159], a[84:87], v[132:135], v[156:159]
    s_add_u32 m0, s73, 4096
    s_add_u32 s94, s74, 4096
    buffer_load_dwordx4 v234, s[4:7], s94 offen sc1 lds
    v_mfma_f32_16x16x32_bf16 v[164:167], v[132:135], a[164:167], v[164:167]
    s_waitcnt lgkmcnt(4)
    v_mfma_f32_16x16x32_bf16 v[152:155], a[4:7], v[136:139], v[152:155]
    ds_read_b128 v[132:135], v232 offset:2048
    v_mfma_f32_16x16x32_bf16 v[160:163], a[84:87], v[136:139], v[160:163]
    s_add_u32 m0, s73, 8192
    s_add_u32 s94, s74, 16384
    buffer_load_dwordx4 v234, s[4:7], s94 offen sc1 lds
    v_mfma_f32_16x16x32_bf16 v[168:171], v[136:139], a[164:167], v[168:171]
    s_waitcnt lgkmcnt(4)
    v_mfma_f32_16x16x32_bf16 v[148:151], a[8:11], v[140:143], v[148:151]
    ds_read_b128 v[136:139], v232 offset:22528
    v_mfma_f32_16x16x32_bf16 v[156:159], a[88:91], v[140:143], v[156:159]
    s_add_u32 m0, s73, 12288
    s_add_u32 s94, s74, 20480
    buffer_load_dwordx4 v234, s[4:7], s94 offen sc1 lds
    v_mfma_f32_16x16x32_bf16 v[164:167], v[140:143], a[168:171], v[164:167]
    s_waitcnt lgkmcnt(4)
    v_mfma_f32_16x16x32_bf16 v[152:155], a[8:11], v[144:147], v[152:155]
    ds_read_b128 v[140:143], v233 offset:2048
    v_mfma_f32_16x16x32_bf16 v[160:163], a[88:91], v[144:147], v[160:163]
    s_add_u32 m0, s73, 16384
    s_add_u32 s94, s74, 32768
    buffer_load_dwordx4 v234, s[4:7], s94 offen sc1 lds
    v_mfma_f32_16x16x32_bf16 v[168:171], v[144:147], a[168:171], v[168:171]
    s_waitcnt lgkmcnt(4)
    v_mfma_f32_16x16x32_bf16 v[148:151], a[12:15], v[124:127], v[148:151]
    ds_read_b128 v[144:147], v233 offset:22528
    v_mfma_f32_16x16x32_bf16 v[156:159], a[92:95], v[124:127], v[156:159]
    s_add_u32 m0, s73, 20480
    s_add_u32 s94, s74, 36864
    buffer_load_dwordx4 v234, s[4:7], s94 offen sc1 lds
    v_mfma_f32_16x16x32_bf16 v[164:167], v[124:127], a[172:175], v[164:167]
    s_waitcnt lgkmcnt(4)
    v_mfma_f32_16x16x32_bf16 v[152:155], a[12:15], v[128:131], v[152:155]
    ds_read_b128 v[124:127], v232 offset:3072
    v_mfma_f32_16x16x32_bf16 v[160:163], a[92:95], v[128:131], v[160:163]
    s_add_u32 m0, s73, 24576
    s_add_u32 s94, s74, 49152
    buffer_load_dwordx4 v234, s[4:7], s94 offen sc1 lds
    v_mfma_f32_16x16x32_bf16 v[168:171], v[128:131], a[172:175], v[168:171]
    s_waitcnt lgkmcnt(4)
    v_mfma_f32_16x16x32_bf16 v[148:151], a[16:19], v[132:135], v[148:151]
    ds_read_b128 v[128:131], v232 offset:23552
    v_mfma_f32_16x16x32_bf16 v[156:159], a[96:99], v[132:135], v[156:159]
    s_add_u32 m0, s73, 28672
    s_add_u32 s94, s74, 53248
    buffer_load_dwordx4 v234, s[4:7], s94 offen sc1 lds
    v_mfma_f32_16x16x32_bf16 v[164:167], v[132:135], a[176:179], v[164:167]
    s_waitcnt lgkmcnt(4)
    v_mfma_f32_16x16x32_bf16 v[152:155], a[16:19], v[136:139], v[152:155]
    ds_read_b128 v[132:135], v233 offset:3072
    v_mfma_f32_16x16x32_bf16 v[160:163], a[96:99], v[136:139], v[160:163]
    s_add_u32 m0, s73, 32768
    s_add_u32 s94, s74, 65536
    buffer_load_dwordx4 v234, s[4:7], s94 offen sc1 lds
    v_mfma_f32_16x16x32_bf16 v[168:171], v[136:139], a[176:179], v[168:171]
    s_waitcnt lgkmcnt(4)
    v_mfma_f32_16x16x32_bf16 v[148:151], a[20:23], v[140:143], v[148:151]
    ds_read_b128 v[136:139], v233 offset:23552
    v_mfma_f32_16x16x32_bf16 v[156:159], a[100:103], v[140:143], v[156:159]
    s_add_u32 m0, s73, 36864
    s_add_u32 s94, s74, 69632
    buffer_load_dwordx4 v234, s[4:7], s94 offen sc1 lds
    v_mfma_f32_16x16x32_bf16 v[164:167], v[140:143], a[180:183], v[164:167]
    s_waitcnt lgkmcnt(4)
    v_mfma_f32_16x16x32_bf16 v[152:155], a[20:23], v[144:147], v[152:155]
    ds_read_b128 v[140:143], v232 offset:4096
    v_mfma_f32_16x16x32_bf16 v[160:163], a[100:103], v[144:147], v[160:163]
    s_mov_b32 s74, s92
    s_xor_b32 s73, s73, 65536
    s_add_u32 s91, s91, 131072
    v_mfma_f32_16x16x32_bf16 v[168:171], v[144:147], a[180:183], v[168:171]
    s_waitcnt lgkmcnt(4)
    s_lshr_b32 s92, s91, 8
    s_xor_b32 s92, s92, s1
    v_mfma_f32_16x16x32_bf16 v[148:151], a[24:27], v[124:127], v[148:151]
    s_and_b32 s92, s92, s93
    ds_read_b128 v[144:147], v232 offset:24576
    s_or_b32 s92, s92, s91
    v_mfma_f32_16x16x32_bf16 v[156:159], a[104:107], v[124:127], v[156:159]
    v_mfma_f32_16x16x32_bf16 v[164:167], v[124:127], a[184:187], v[164:167]
    s_waitcnt lgkmcnt(4)
    v_mfma_f32_16x16x32_bf16 v[152:155], a[24:27], v[128:131], v[152:155]
    ds_read_b128 v[124:127], v233 offset:4096
    v_mfma_f32_16x16x32_bf16 v[160:163], a[104:107], v[128:131], v[160:163]
    v_mfma_f32_16x16x32_bf16 v[168:171], v[128:131], a[184:187], v[168:171]
    s_waitcnt lgkmcnt(4)
    v_mfma_f32_16x16x32_bf16 v[148:151], a[28:31], v[132:135], v[148:151]
    ds_read_b128 v[128:131], v233 offset:24576
    v_mfma_f32_16x16x32_bf16 v[156:159], a[108:111], v[132:135], v[156:159]
    v_mfma_f32_16x16x32_bf16 v[164:167], v[132:135], a[188:191], v[164:167]
    s_waitcnt lgkmcnt(4)
    v_mfma_f32_16x16x32_bf16 v[152:155], a[28:31], v[136:139], v[152:155]
    ds_read_b128 v[132:135], v232 offset:5120
    v_mfma_f32_16x16x32_bf16 v[160:163], a[108:111], v[136:139], v[160:163]
    v_mfma_f32_16x16x32_bf16 v[168:171], v[136:139], a[188:191], v[168:171]
    s_waitcnt lgkmcnt(4)
    v_mfma_f32_16x16x32_bf16 v[148:151], a[32:35], v[140:143], v[148:151]
    ds_read_b128 v[136:139], v232 offset:25600
    v_mfma_f32_16x16x32_bf16 v[156:159], a[112:115], v[140:143], v[156:159]
    v_mfma_f32_16x16x32_bf16 v[164:167], v[140:143], a[192:195], v[164:167]
    s_waitcnt lgkmcnt(4)
    v_mfma_f32_16x16x32_bf16 v[152:155], a[32:35], v[144:147], v[152:155]
    ds_read_b128 v[140:143], v233 offset:5120
    v_mfma_f32_16x16x32_bf16 v[160:163], a[112:115], v[144:147], v[160:163]
    v_mfma_f32_16x16x32_bf16 v[168:171], v[144:147], a[192:195], v[168:171]
    s_waitcnt lgkmcnt(4)
    v_mfma_f32_16x16x32_bf16 v[148:151], a[36:39], v[124:127], v[148:151]
    ds_read_b128 v[144:147], v233 offset:25600
    v_mfma_f32_16x16x32_bf16 v[156:159], a[116:119], v[124:127], v[156:159]
    v_mfma_f32_16x16x32_bf16 v[164:167], v[124:127], a[196:199], v[164:167]
    s_waitcnt lgkmcnt(4)
    v_mfma_f32_16x16x32_bf16 v[152:155], a[36:39], v[128:131], v[152:155]
    ds_read_b128 v[124:127], v232 offset:6144
    v_mfma_f32_16x16x32_bf16 v[160:163], a[116:119], v[128:131], v[160:163]
    v_mfma_f32_16x16x32_bf16 v[168:171], v[128:131], a[196:199], v[168:171]
    s_waitcnt lgkmcnt(4)
    v_mfma_f32_16x16x32_bf16 v[148:151], a[40:43], v[132:135], v[148:151]
    ds_read_b128 v[128:131], v232 offset:26624
    v_mfma_f32_16x16x32_bf16 v[156:159], a[120:123], v[132:135], v[156:159]
    v_mfma_f32_16x16x32_bf16 v[164:167], v[132:135], a[200:203], v[164:167]
    s_waitcnt lgkmcnt(4)
    v_mfma_f32_16x16x32_bf16 v[152:155], a[40:43], v[136:139], v[152:155]
    ds_read_b128 v[132:135], v233 offset:6144
    v_mfma_f32_16x16x32_bf16 v[160:163], a[120:123], v[136:139], v[160:163]
    v_mfma_f32_16x16x32_bf16 v[168:171], v[136:139], a[200:203], v[168:171]
    s_waitcnt lgkmcnt(4)
    v_mfma_f32_16x16x32_bf16 v[148:151], a[44:47], v[140:143], v[148:151]
    ds_read_b128 v[136:139], v233 offset:26624
    v_mfma_f32_16x16x32_bf16 v[156:159], a[124:127], v[140:143], v[156:159]
    v_mfma_f32_16x16x32_bf16 v[164:167], v[140:143], a[204:207], v[164:167]
    s_waitcnt lgkmcnt(4)
    v_mfma_f32_16x16x32_bf16 v[152:155], a[44:47], v[144:147], v[152:155]
    ds_read_b128 v[140:143], v232 offset:7168
    v_mfma_f32_16x16x32_bf16 v[160:163], a[124:127], v[144:147], v[160:163]
    v_mfma_f32_16x16x32_bf16 v[168:171], v[144:147], a[204:207], v[168:171]
    s_waitcnt lgkmcnt(4)
    v_mfma_f32_16x16x32_bf16 v[148:151], a[48:51], v[124:127], v[148:151]
    ds_read_b128 v[144:147], v232 offset:27648
    v_mfma_f32_16x16x32_bf16 v[156:159], a[128:131], v[124:127], v[156:159]
    v_mfma_f32_16x16x32_bf16 v[164:167], v[124:127], a[208:211], v[164:167]
    s_waitcnt lgkmcnt(4)
    v_mfma_f32_16x16x32_bf16 v[152:155], a[48:51], v[128:131], v[152:155]
    ds_read_b128 v[124:127], v233 offset:7168
    v_mfma_f32_16x16x32_bf16 v[160:163], a[128:131], v[128:131], v[160:163]
    v_mfma_f32_16x16x32_bf16 v[168:171], v[128:131], a[208:211], v[168:171]
    s_waitcnt lgkmcnt(4)
    v_mfma_f32_16x16x32_bf16 v[148:151], a[52:55], v[132:135], v[148:151]
    ds_read_b128 v[128:131], v233 offset:27648
    v_mfma_f32_16x16x32_bf16 v[156:159], a[132:135], v[132:135], v[156:159]
    v_mfma_f32_16x16x32_bf16 v[164:167], v[132:135], a[212:215], v[164:167]
    s_waitcnt lgkmcnt(4)
    v_mfma_f32_16x16x32_bf16 v[152:155], a[52:55], v[136:139], v[152:155]
    ds_read_b128 v[132:135], v232 offset:8192
    v_mfma_f32_16x16x32_bf16 v[160:163], a[132:135], v[136:139], v[160:163]
    v_mfma_f32_16x16x32_bf16 v[168:171], v[136:139], a[212:215], v[168:171]
    s_waitcnt lgkmcnt(4)
    v_mfma_f32_16x16x32_bf16 v[148:151], a[56:59], v[140:143], v[148:151]
    ds_read_b128 v[136:139], v232 offset:28672
    v_mfma_f32_16x16x32_bf16 v[156:159], a[136:139], v[140:143], v[156:159]
    v_mfma_f32_16x16x32_bf16 v[164:167], v[140:143], a[216:219], v[164:167]
    s_waitcnt lgkmcnt(4)
    v_mfma_f32_16x16x32_bf16 v[152:155], a[56:59], v[144:147], v[152:155]
    ds_read_b128 v[140:143], v233 offset:8192
    v_mfma_f32_16x16x32_bf16 v[160:163], a[136:139], v[144:147], v[160:163]
    v_mfma_f32_16x16x32_bf16 v[168:171], v[144:147], a[216:219], v[168:171]
    s_waitcnt lgkmcnt(4)
    v_mfma_f32_16x16x32_bf16 v[148:151], a[60:63], v[124:127], v[148:151]
    ds_read_b128 v[144:147], v233 offset:28672
    v_mfma_f32_16x16x32_bf16 v[156:159], a[140:143], v[124:127], v[156:159]
    v_mfma_f32_16x16x32_bf16 v[164:167], v[124:127], a[220:223], v[164:167]
    s_waitcnt lgkmcnt(4)
    v_mfma_f32_16x16x32_bf16 v[152:155], a[60:63], v[128:131], v[152:155]
    ds_read_b128 v[124:127], v232 offset:9216
    v_mfma_f32_16x16x32_bf16 v[160:163], a[140:143], v[128:131], v[160:163]
    v_mfma_f32_16x16x32_bf16 v[168:171], v[128:131], a[220:223], v[168:171]
    s_waitcnt lgkmcnt(4)
    v_mfma_f32_16x16x32_bf16 v[148:151], a[64:67], v[132:135], v[148:151]
    ds_read_b128 v[128:131], v232 offset:29696
    v_mfma_f32_16x16x32_bf16 v[156:159], a[144:147], v[132:135], v[156:159]
    v_mfma_f32_16x16x32_bf16 v[164:167], v[132:135], a[224:227], v[164:167]
    s_waitcnt lgkmcnt(4)
    v_mfma_f32_16x16x32_bf16 v[152:155], a[64:67], v[136:139], v[152:155]
    ds_read_b128 v[132:135], v233 offset:9216
    v_mfma_f32_16x16x32_bf16 v[160:163], a[144:147], v[136:139], v[160:163]
    v_mfma_f32_16x16x32_bf16 v[168:171], v[136:139], a[224:227], v[168:171]
    s_waitcnt lgkmcnt(4)
    v_mfma_f32_16x16x32_bf16 v[148:151], a[68:71], v[140:143], v[148:151]
    ds_read_b128 v[136:139], v233 offset:29696
    v_mfma_f32_16x16x32_bf16 v[156:159], a[148:151], v[140:143], v[156:159]
    v_mfma_f32_16x16x32_bf16 v[164:167], v[140:143], a[228:231], v[164:167]
    s_waitcnt lgkmcnt(4)
    v_mfma_f32_16x16x32_bf16 v[152:155], a[68:71], v[144:147], v[152:155]
    v_mfma_f32_16x16x32_bf16 v[160:163], a[148:151], v[144:147], v[160:163]
    v_mfma_f32_16x16x32_bf16 v[168:171], v[144:147], a[228:231], v[168:171]
    s_waitcnt lgkmcnt(3)
    v_mfma_f32_16x16x32_bf16 v[148:151], a[72:75], v[124:127], v[148:151]
    v_mfma_f32_16x16x32_bf16 v[156:159], a[152:155], v[124:127], v[156:159]
    v_mfma_f32_16x16x32_bf16 v[164:167], v[124:127], a[232:235], v[164:167]
    s_waitcnt lgkmcnt(2)
    v_mfma_f32_16x16x32_bf16 v[152:155], a[72:75], v[128:131], v[152:155]
    v_mfma_f32_16x16x32_bf16 v[160:163], a[152:155], v[128:131], v[160:163]
    v_mfma_f32_16x16x32_bf16 v[168:171], v[128:131], a[232:235], v[168:171]
    s_waitcnt lgkmcnt(1)
    v_mfma_f32_16x16x32_bf16 v[148:151], a[76:79], v[132:135], v[148:151]
    s_lshl_b32 s72, s58, 20
    buffer_load_dword v2, v252, s[4:7], 0 offen sc1
    s_waitcnt vmcnt(0) lgkmcnt(0)
    v_lshl_add_u32 v3, s62, 1, v225
    v_add_u32 v3, -2, v3
    v_min_i32 v3, 128, v3
Lfchk_22:
    v_cmp_gt_i32 vcc, v3, v2
    s_cbranch_vccnz Lfrty_23
    s_cmp_lg_u32 s60, 1
    s_cbranch_scc1 Lcnt_24
    s_mov_b64 exec, 1
    v_mov_b32 v217, 0x80000000
    v_cmp_ne_u32 vcc, 95, v216
    s_nop 1
    v_cndmask_b32 v217, 8, v217, vcc
    buffer_store_dword v216, v217, s[8:11], 0 offen offset:128 sc1
    s_mov_b64 exec, -1
Lcnt_24:
    s_cmp_eq_u32 s60, 3
    s_cbranch_scc1 L_Cin3
    s_branch L_Cin0
Lgrty_6:
    s_sleep 16
    buffer_load_dword v2, off, s[8:11], 0 offset:136 sc1
    s_sub_u32 s61, s61, 1
    s_mov_b32 s67, 4
    s_cbranch_scc1 L_fail
    s_branch Lgchk_5
Lgrty_13:
    s_sleep 8
    buffer_load_dwordx3 v[216:218], off, s[8:11], 0 offset:132 sc1
    s_sub_u32 s61, s61, 1
    s_mov_b32 s67, 1
    s_cbranch_scc1 L_fail
    s_waitcnt vmcnt(0)
    s_branch Lgchk_12
Lfrty_19:
    s_sleep 4
    buffer_load_dword v2, v252, s[4:7], 0 offen sc1
    s_sub_u32 s61, s61, 1
    s_mov_b32 s67, 10
    s_cbranch_scc1 L_fail
    s_waitcnt vmcnt(0)
    s_branch Lfchk_18
Lfrty_21:
    s_sleep 4
    buffer_load_dword v2, v252, s[4:7], 0 offen sc1
    s_sub_u32 s61, s61, 1
    s_mov_b32 s67, 10
    s_cbranch_scc1 L_fail
    s_waitcnt vmcnt(0)
    s_branch Lfchk_20
Lfrty_23:
    s_sleep 4
    buffer_load_dword v2, v252, s[4:7], 0 offen sc1
    s_sub_u32 s61, s61, 1
    s_mov_b32 s67, 10
    s_cbranch_scc1 L_fail
    s_waitcnt vmcnt(0)
    s_branch Lfchk_22
L_Ctop3:
    s_waitcnt vmcnt(5)
    ds_write_b128 v234, v[112:115] offset:0
    s_waitcnt vmcnt(4)
    ds_write_b128 v234, v[116:119] offset:4096
    s_waitcnt vmcnt(3)
    ds_write_b64 v235, v[120:121] offset:0
    v_max3_u32 v218, v112, v114, v116
    v_max3_u32 v218, v218, v118, v120
    v_cmp_eq_u32 vcc, -1, v218
    s_cbranch_vccnz Lrty_26
Lok_25:
    s_waitcnt lgkmcnt(5)
    v_mfma_f32_16x16x32_bf16 v[152:155], a[72:75], v[128:131], v[152:155]
    v_mfma_f32_16x16x32_bf16 v[160:163], a[152:155], v[128:131], v[160:163]
    v_mfma_f32_16x16x32_bf16 v[168:171], v[128:131], a[232:235], v[168:171]
    s_waitcnt lgkmcnt(4)
    v_mfma_f32_16x16x32_bf16 v[148:151], a[76:79], v[132:135], v[148:151]
L_Cin3:
    s_waitcnt lgkmcnt(0)
    s_barrier
    ds_read_b128 v[84:87], v236 offset:0
    ds_read_b128 v[88:91], v236 offset:1024
    v_mfma_f32_16x16x32_bf16 v[156:159], a[156:159], v[132:135], v[156:159]
    s_andn2_b32 s71, s72, 524288
    ds_read_b128 v[92:95], v236 offset:2048
    ds_read_b128 v[96:99], v236 offset:3072
    v_mfma_f32_16x16x32_bf16 v[164:167], v[132:135], a[236:239], v[164:167]
    s_waitcnt vmcnt(2)
    ds_read_b128 v[100:103], v236 offset:4096
    s_waitcnt vmcnt(1)
    ds_read_b128 v[104:107], v236 offset:5120
    v_mfma_f32_16x16x32_bf16 v[152:155], a[76:79], v[136:139], v[152:155]
    s_lshr_b32 s97, s62, 1
    s_waitcnt vmcnt(0)
    ds_read_b128 v[108:111], v236 offset:6144
    ds_read_b128 v[112:115], v236 offset:7168
    v_mfma_f32_16x16x32_bf16 v[160:163], a[156:159], v[136:139], v[160:163]
    s_add_u32 s79, s71, s76
    ds_read_b128 v[116:119], v236 offset:8192
    ds_read_b128 v[120:123], v236 offset:9216
    v_mfma_f32_16x16x32_bf16 v[168:171], v[136:139], a[236:239], v[168:171]
    s_add_u32 s80, s71, s77
    s_add_u32 s81, s71, s78
    s_waitcnt lgkmcnt(9)
    v_smfmac_f32_16x16x64_bf16 v[194:197], v[84:87], a[0:7], v187
    v_xor_b32 v232, 0x10000, v232
    v_smfmac_f32_16x16x64_bf16 v[198:201], v[84:87], a[80:87], v187
    s_waitcnt lgkmcnt(8)
    v_xor_b32 v233, 0x10000, v233
    v_smfmac_f32_16x16x64_bf16 v[194:197], v[88:91], a[8:15], v187
    v_cvt_pk_bf16_f32 v148, v148, v149
    v_smfmac_f32_16x16x64_bf16 v[198:201], v[88:91], a[88:95], v187
    s_waitcnt lgkmcnt(7)
    v_cvt_pk_bf16_f32 v149, v150, v151
    v_smfmac_f32_16x16x64_bf16 v[194:197], v[92:95], a[16:23], v187
    ds_write_b64 v243, v[148:149] offset:22528
    v_smfmac_f32_16x16x64_bf16 v[198:201], v[92:95], a[96:103], v187
    s_waitcnt lgkmcnt(7)
    v_cvt_pk_bf16_f32 v152, v152, v153
    v_smfmac_f32_16x16x64_bf16 v[194:197], v[96:99], a[24:31], v187
    v_cvt_pk_bf16_f32 v153, v154, v155
    v_smfmac_f32_16x16x64_bf16 v[198:201], v[96:99], a[104:111], v187
    s_waitcnt lgkmcnt(6)
    ds_write_b64 v243, v[152:153] offset:24576
    v_smfmac_f32_16x16x64_bf16 v[194:197], v[100:103], a[32:39], v187
    v_cvt_pk_bf16_f32 v156, v156, v157
    v_smfmac_f32_16x16x64_bf16 v[198:201], v[100:103], a[112:119], v187
    s_waitcnt lgkmcnt(6)
    v_cvt_pk_bf16_f32 v157, v158, v159
    v_smfmac_f32_16x16x64_bf16 v[194:197], v[104:107], a[40:47], v187
    ds_write_b64 v243, v[156:157] offset:26624
    v_smfmac_f32_16x16x64_bf16 v[198:201], v[104:107], a[120:127], v187
    s_waitcnt lgkmcnt(6)
    v_cvt_pk_bf16_f32 v160, v160, v161
    v_smfmac_f32_16x16x64_bf16 v[194:197], v[108:111], a[48:55], v187
    v_cvt_pk_bf16_f32 v161, v162, v163
    v_smfmac_f32_16x16x64_bf16 v[198:201], v[108:111], a[128:135], v187
    s_waitcnt lgkmcnt(5)
    ds_write_b64 v243, v[160:161] offset:28672
    v_smfmac_f32_16x16x64_bf16 v[194:197], v[112:115], a[56:63], v187
    v_cvt_pk_bf16_f32 v172, v164, v165
    v_smfmac_f32_16x16x64_bf16 v[198:201], v[112:115], a[136:143], v187
    s_waitcnt lgkmcnt(5)
    v_cvt_pk_bf16_f32 v173, v166, v167
    v_smfmac_f32_16x16x64_bf16 v[194:197], v[116:119], a[64:71], v187
    v_cvt_pk_bf16_f32 v176, v168, v169
    v_smfmac_f32_16x16x64_bf16 v[198:201], v[116:119], a[144:151], v187
    s_waitcnt lgkmcnt(4)
    v_cvt_pk_bf16_f32 v177, v170, v171
    v_smfmac_f32_16x16x64_bf16 v[194:197], v[120:123], a[72:79], v187
    s_cmp_lt_u32 s59, 20
    s_cselect_b32 s85, s72, s92
    s_add_u32 s86, s85, s89
    v_smfmac_f32_16x16x64_bf16 v[198:201], v[120:123], a[152:159], v187
    s_xor_b32 s96, s72, 524288
    s_lshr_b32 s88, s71, 2
    s_and_b32 s88, s88, 0xf0000
    v_smfmac_f32_16x16x64_bf16 v[202:205], v[84:87], a[160:167], v187
    s_xor_b32 s82, s88, 262144
    s_xor_b32 s83, s88, 524288
    s_xor_b32 s84, s88, 786432
    s_nop 0
    v_permlane32_swap_b32 v194, v198
    v_permlane32_swap_b32 v195, v199
    v_permlane32_swap_b32 v196, v200
    v_permlane32_swap_b32 v197, v201
    v_pk_add_f32 v[194:195], v[194:195], v[198:199]
    v_pk_add_f32 v[196:197], v[196:197], v[200:201]
    v_cvt_pk_bf16_f32 v194, v194, v195
    v_cvt_pk_bf16_f32 v195, v196, v197
    ds_write_b64 v241, v[194:195] offset:12288
    v_smfmac_f32_16x16x64_bf16 v[202:205], v[88:91], a[168:175], v187
    v_smfmac_f32_16x16x64_bf16 v[202:205], v[92:95], a[176:183], v187
    v_smfmac_f32_16x16x64_bf16 v[202:205], v[96:99], a[184:191], v187
    v_smfmac_f32_16x16x64_bf16 v[202:205], v[100:103], a[192:199], v187
    v_smfmac_f32_16x16x64_bf16 v[202:205], v[104:107], a[200:207], v187
    s_waitcnt lgkmcnt(0)
    s_barrier
    ds_read_b64_tr_b16 v[124:125], v242 offset:12288
    ds_read_b64_tr_b16 v[126:127], v242 offset:12352
    ds_read_b64_tr_b16 v[132:133], v242 offset:13312
    ds_read_b64_tr_b16 v[134:135], v242 offset:13376
    v_smfmac_f32_16x16x64_bf16 v[202:205], v[108:111], a[208:215], v187
    ds_read_b128 v[148:151], v236 offset:26624
    ds_read_b128 v[156:159], v236 offset:28672
    v_smfmac_f32_16x16x64_bf16 v[202:205], v[112:115], a[216:223], v187
    ds_read_b64_tr_b16 v[128:129], v242 offset:12800
    ds_read_b64_tr_b16 v[130:131], v242 offset:12864
    v_smfmac_f32_16x16x64_bf16 v[202:205], v[116:119], a[224:231], v187
    ds_read_b64_tr_b16 v[136:137], v242 offset:13824
    ds_read_b64_tr_b16 v[138:139], v242 offset:13888
    v_smfmac_f32_16x16x64_bf16 v[202:205], v[120:123], a[232:239], v187
    ds_read_b128 v[152:155], v236 offset:27648
    ds_read_b128 v[160:163], v236 offset:29696
    s_waitcnt lgkmcnt(8)
    v_mfma_f32_16x16x32_bf16 v[214:217], v[132:135], v[124:127], 0
    s_waitcnt lgkmcnt(7)
    v_mfma_f32_16x16x32_bf16 v[206:209], v[148:151], v[124:127], 0
    s_waitcnt lgkmcnt(6)
    v_mfma_f32_16x16x32_bf16 v[210:213], v[156:159], v[124:127], 0
    ds_read_b128 v[164:167], v244 offset:22528
    ds_read_b128 v[168:171], v244 offset:23552
    s_waitcnt lgkmcnt(4)
    v_mfma_f32_16x16x32_bf16 v[214:217], v[136:139], v[128:131], v[214:217]
    s_waitcnt lgkmcnt(3)
    v_mfma_f32_16x16x32_bf16 v[206:209], v[152:155], v[128:131], v[206:209]
    s_waitcnt lgkmcnt(2)
    v_mfma_f32_16x16x32_bf16 v[210:213], v[160:163], v[128:131], v[210:213]
    v_permlane32_swap_b32 v202, v204
    v_permlane32_swap_b32 v203, v205
    v_add_f32 v202, v202, v204
    v_add_f32 v203, v203, v205
    v_cndmask_b32 v214, v214, v215, s[98:99]
    v_cndmask_b32 v216, v216, v217, s[98:99]
    v_cndmask_b32 v224, v214, v216, s[100:101]
    v_bfi_b32 v224, 1, s97, v224
    buffer_store_dword v224, v237, s[4:7], s79 offen offset:1024
    v_cndmask_b32 v220, v206, v210, s[98:99]
    v_cndmask_b32 v221, v207, v211, s[98:99]
    v_cndmask_b32 v222, v208, v212, s[98:99]
    v_cndmask_b32 v223, v209, v213, s[98:99]
    v_bfi_b32 v220, 1, s97, v220
    buffer_store_dwordx4 v[220:223], v236, s[4:7], s79 offen
    v_cvt_pk_bf16_f32 v174, v202, v203
    v_cvt_pk_bf16_f32 v178, v202, v203
    ds_read_b128 v[124:127], v232 offset:0
    ds_read_b128 v[128:131], v232 offset:20480
    s_waitcnt lgkmcnt(3)
    v_mfma_f32_16x16x32_bf16 v[214:217], v[132:135], v[164:167], 0
    ds_read_b128 v[140:143], v232 offset:1024
    v_mfma_f32_16x16x32_bf16 v[206:209], v[148:151], v[164:167], v[188:191]
    v_mfma_f32_16x16x32_bf16 v[210:213], v[156:159], v[164:167], v[188:191]
    s_waitcnt lgkmcnt(3)
    v_mfma_f32_16x16x32_bf16 v[214:217], v[136:139], v[168:171], v[214:217]
    ds_read_b128 v[132:135], v233 offset:0
    v_mfma_f32_16x16x32_bf16 v[206:209], v[152:155], v[168:171], v[206:209]
    ds_read_b128 v[136:139], v233 offset:20480
    v_mfma_f32_16x16x32_bf16 v[210:213], v[160:163], v[168:171], v[210:213]
    s_waitcnt lgkmcnt(4)
    v_mfma_f32_16x16x32_bf16 v[148:151], a[0:3], v[124:127], 0
    ds_read_b128 v[144:147], v232 offset:21504
    s_nop 0
    v_cndmask_b32 v214, v214, v215, s[98:99]
    v_mfma_f32_16x16x32_bf16 v[156:159], a[80:83], v[124:127], 0
    v_cndmask_b32 v216, v216, v217, s[98:99]
    v_cndmask_b32 v230, v214, v216, s[100:101]
    v_mfma_f32_16x16x32_bf16 v[164:167], v[124:127], a[160:163], 0
    s_waitcnt lgkmcnt(4)
    v_bfi_b32 v230, 1, s97, v230
    v_cndmask_b32 v226, v206, v210, s[98:99]
    v_mfma_f32_16x16x32_bf16 v[152:155], a[0:3], v[128:131], 0
    ds_read_b128 v[124:127], v233 offset:1024
    v_cndmask_b32 v227, v207, v211, s[98:99]
    v_mfma_f32_16x16x32_bf16 v[160:163], a[80:83], v[128:131], 0
    v_cndmask_b32 v228, v208, v212, s[98:99]
    v_cndmask_b32 v229, v209, v213, s[98:99]
    v_mfma_f32_16x16x32_bf16 v[168:171], v[128:131], a[160:163], 0
    v_bfi_b32 v226, 1, s97, v226
    s_waitcnt lgkmcnt(3)
    v_mfma_f32_16x16x32_bf16 v[148:151], a[4:7], v[132:135], v[148:151]
    ds_read_b128 v[128:131], v233 offset:21504
    buffer_load_dwordx4 v[84:87], v236, s[4:7], s80 offen sc1
    v_mfma_f32_16x16x32_bf16 v[156:159], a[84:87], v[132:135], v[156:159]
    buffer_load_dwordx4 v[88:91], v236, s[4:7], s81 offen sc1
    buffer_load_dword v92, v237, s[4:7], s80 offen offset:1024 sc1
    v_mfma_f32_16x16x32_bf16 v[164:167], v[132:135], a[164:167], v[164:167]
    s_waitcnt lgkmcnt(3)
    buffer_load_dword v93, v237, s[4:7], s81 offen offset:1024 sc1
    v_mfma_f32_16x16x32_bf16 v[152:155], a[4:7], v[136:139], v[152:155]
    ds_read_b128 v[132:135], v232 offset:2048
    v_mfma_f32_16x16x32_bf16 v[160:163], a[84:87], v[136:139], v[160:163]
    v_mfma_f32_16x16x32_bf16 v[168:171], v[136:139], a[164:167], v[168:171]
    v_mfma_f32_16x16x32_bf16 v[148:151], a[8:11], v[140:143], v[148:151]
    ds_read_b128 v[136:139], v232 offset:22528
    v_mfma_f32_16x16x32_bf16 v[156:159], a[88:91], v[140:143], v[156:159]
    buffer_store_dwordx4 v[226:229], v238, s[4:7], s79 offen
    buffer_store_dword v230, v239, s[4:7], s79 offen offset:1024
    v_mfma_f32_16x16x32_bf16 v[164:167], v[140:143], a[168:171], v[164:167]
    s_waitcnt lgkmcnt(4)
    v_mfma_f32_16x16x32_bf16 v[152:155], a[8:11], v[144:147], v[152:155]
    ds_read_b128 v[140:143], v233 offset:2048
    v_mfma_f32_16x16x32_bf16 v[160:163], a[88:91], v[144:147], v[160:163]
    v_mfma_f32_16x16x32_bf16 v[168:171], v[144:147], a[168:171], v[168:171]
    s_waitcnt vmcnt(4)
    v_bitop3_b32 v218, v84, v88, s97 bitop3:0x7e
    s_waitcnt vmcnt(2)
    v_bitop3_b32 v219, v92, v93, s97 bitop3:0x7e
    v_bitop3_b32 v218, v218, v219, 1 bitop3:0xa8
    v_cmp_eq_u32 vcc, 1, v218
    s_cbranch_vccnz Lrty_29
    v_pk_add_f32 v[84:85], v[84:85], v[88:89]
    v_pk_add_f32 v[86:87], v[86:87], v[90:91]
    v_add_f32 v92, v92, v93
    v_pk_add_f32 v[220:221], v[220:221], v[84:85]
    v_pk_add_f32 v[222:223], v[222:223], v[86:87]
    v_add_f32 v224, v224, v92
Lok_28:
    v_max3_f32 v218, v220, v221, v222
    v_max3_f32 v218, v218, v223, v224
    buffer_load_dwordx4 v[108:111], v238, s[4:7], s80 offen sc1
    buffer_load_dwordx4 v[112:115], v238, s[4:7], s81 offen sc1
    v_max_f32_dpp v218, v218, v218 row_ror:8 row_mask:0xf bank_mask:0xf
    v_mov_b32 v219, v218
    buffer_load_dword v116, v239, s[4:7], s80 offen offset:1024 sc1
    buffer_load_dword v117, v239, s[4:7], s81 offen offset:1024 sc1
    v_permlane16_swap_b32 v218, v219
    v_max_f32 v218, v218, v219
    v_mov_b32 v219, v218
    s_add_u32 m0, s73, 0
    s_add_u32 s94, s74, 0
    buffer_load_dwordx4 v234, s[4:7], s94 offen sc1 lds
    v_permlane32_swap_b32 v218, v219
    v_max_f32 v218, v218, v219
    v_mul_f32 v218, s70, v218
    v_fma_f32 v224, v224, s70, -v218
    v_fma_f32 v220, v220, s70, -v218
    v_fma_f32 v221, v221, s70, -v218
    v_fma_f32 v222, v222, s70, -v218
    v_fma_f32 v223, v223, s70, -v218
    v_exp_f32 v224, v224
    v_exp_f32 v220, v220
    v_exp_f32 v221, v221
    v_exp_f32 v222, v222
    v_exp_f32 v223, v223
    v_cvt_pk_bf16_f32 v186, v224, v224
    v_cvt_pk_bf16_f32 v184, v220, v221
    v_and_b32 v186, v231, v186
    v_cvt_pk_bf16_f32 v185, v222, v223
    s_add_u32 m0, s73, 4096
    s_add_u32 s94, s74, 4096
    buffer_load_dwordx4 v234, s[4:7], s94 offen sc1 lds
    v_mfma_f32_16x16x32_bf16 v[202:205], v[180:183], v[184:187], 0
    s_nop 0
    v_mov_b64 v[206:207], 0
    v_mov_b64 v[208:209], 0
    v_mfma_f32_16x16x32_bf16 v[194:197], v[172:175], v[184:187], 0
    s_nop 0
    v_mov_b64 v[210:211], 0
    v_mov_b64 v[212:213], 0
    v_mfma_f32_16x16x32_bf16 v[198:201], v[176:179], v[184:187], 0
    s_nop 2
    s_waitcnt lgkmcnt(4)
    v_mfma_f32_16x16x32_bf16 v[148:151], a[12:15], v[124:127], v[148:151]
    s_nop 0
    ds_read_b128 v[144:147], v233 offset:22528
    v_add_f32_dpp v202, v202, v202 row_ror:8 row_mask:0xf bank_mask:0xf
    v_rcp_f32 v202, v202
    v_add_f32_dpp v194, v198, v194 row_ror:8 row_mask:0xf bank_mask:0xf
    v_add_f32_dpp v195, v199, v195 row_ror:8 row_mask:0xf bank_mask:0xf
    v_add_f32_dpp v196, v200, v196 row_ror:8 row_mask:0xf bank_mask:0xf
    v_add_f32_dpp v197, v201, v197 row_ror:8 row_mask:0xf bank_mask:0xf
    v_pk_mul_f32 v[194:195], v[194:195], v[202:203] op_sel_hi:[1,0]
    v_pk_mul_f32 v[196:197], v[196:197], v[202:203] op_sel_hi:[1,0]
    v_cvt_pk_bf16_f32 v194, v194, v195
    v_cvt_pk_bf16_f32 v195, v196, v197
    v_min_u32 v194, -2, v194
    buffer_store_dwordx2 v[194:195], v247, s[4:7], s72 offen
    v_mfma_f32_16x16x32_bf16 v[156:159], a[92:95], v[124:127], v[156:159]
    s_waitcnt vmcnt(5)
    v_bitop3_b32 v218, v108, v112, s97 bitop3:0x7e
    s_waitcnt vmcnt(3)
    v_bitop3_b32 v219, v116, v117, s97 bitop3:0x7e
    v_bitop3_b32 v218, v218, v219, 1 bitop3:0xa8
    v_cmp_eq_u32 vcc, 1, v218
    s_cbranch_vccnz Lrty_31
Lok_30:
    v_mfma_f32_16x16x32_bf16 v[164:167], v[124:127], a[172:175], v[164:167]
    s_waitcnt lgkmcnt(4)
    v_add_f32 v108, v108, v112
    v_add_f32 v109, v109, v113
    v_mfma_f32_16x16x32_bf16 v[152:155], a[12:15], v[128:131], v[152:155]
    ds_read_b128 v[124:127], v232 offset:3072
    v_add_f32 v110, v110, v114
    v_mfma_f32_16x16x32_bf16 v[160:163], a[92:95], v[128:131], v[160:163]
    v_add_f32 v111, v111, v115
    v_add_f32 v116, v116, v117
    v_mfma_f32_16x16x32_bf16 v[168:171], v[128:131], a[172:175], v[168:171]
    s_waitcnt lgkmcnt(4)
    v_add_f32 v226, v226, v108
    v_add_f32 v227, v227, v109
    v_mfma_f32_16x16x32_bf16 v[148:151], a[16:19], v[132:135], v[148:151]
    ds_read_b128 v[128:131], v232 offset:23552
    v_add_f32 v228, v228, v110
    v_mfma_f32_16x16x32_bf16 v[156:159], a[96:99], v[132:135], v[156:159]
    v_add_f32 v229, v229, v111
    v_add_f32 v230, v230, v116
    v_mfma_f32_16x16x32_bf16 v[164:167], v[132:135], a[176:179], v[164:167]
    s_waitcnt lgkmcnt(4)
    v_max3_f32 v218, v226, v227, v228
    v_max3_f32 v218, v218, v229, v230
    v_mfma_f32_16x16x32_bf16 v[152:155], a[16:19], v[136:139], v[152:155]
    ds_read_b128 v[132:135], v233 offset:3072
    v_max_f32_dpp v218, v218, v218 row_ror:8 row_mask:0xf bank_mask:0xf
    v_mfma_f32_16x16x32_bf16 v[160:163], a[96:99], v[136:139], v[160:163]
    v_mov_b32 v219, v218
    s_nop 0
    v_mfma_f32_16x16x32_bf16 v[168:171], v[136:139], a[176:179], v[168:171]
    s_waitcnt lgkmcnt(4)
    v_permlane16_swap_b32 v218, v219
    v_mfma_f32_16x16x32_bf16 v[148:151], a[20:23], v[140:143], v[148:151]
    ds_read_b128 v[136:139], v233 offset:23552
    v_max_f32 v218, v218, v219
    v_mfma_f32_16x16x32_bf16 v[156:159], a[100:103], v[140:143], v[156:159]
    buffer_load_dwordx4 v[84:87], v248, s[4:7], s85 offen offset:0 sc1
    v_mov_b32 v219, v218
    v_mfma_f32_16x16x32_bf16 v[164:167], v[140:143], a[180:183], v[164:167]
    s_waitcnt lgkmcnt(4)
    v_permlane32_swap_b32 v218, v219
    v_mfma_f32_16x16x32_bf16 v[152:155], a[20:23], v[144:147], v[152:155]
    ds_read_b128 v[140:143], v232 offset:4096
    buffer_load_dwordx4 v[88:91], v248, s[4:7], s85 offen offset:1024 sc1
    v_mfma_f32_16x16x32_bf16 v[160:163], a[100:103], v[144:147], v[160:163]
    v_max_f32 v218, v218, v219
    v_mul_f32 v218, s70, v218
    v_mfma_f32_16x16x32_bf16 v[168:171], v[144:147], a[180:183], v[168:171]
    s_waitcnt lgkmcnt(4)
    buffer_load_dwordx4 v[92:95], v248, s[4:7], s85 offen offset:2048 sc1
    v_fma_f32 v230, v230, s70, -v218
    v_mfma_f32_16x16x32_bf16 v[148:151], a[24:27], v[124:127], v[148:151]
    ds_read_b128 v[144:147], v232 offset:24576
    v_fma_f32 v226, v226, s70, -v218
    v_mfma_f32_16x16x32_bf16 v[156:159], a[104:107], v[124:127], v[156:159]
    buffer_load_dwordx4 v[96:99], v248, s[4:7], s85 offen offset:3072 sc1
    v_fma_f32 v227, v227, s70, -v218
    v_mfma_f32_16x16x32_bf16 v[164:167], v[124:127], a[184:187], v[164:167]
    v_fma_f32 v228, v228, s70, -v218
    v_fma_f32 v229, v229, s70, -v218
    buffer_load_dwordx4 v[100:103], v248, s[4:7], s86 offen offset:0 sc1
    buffer_load_dwordx4 v[104:107], v248, s[4:7], s86 offen offset:1024 sc1
Lwchk_32:
    s_waitcnt vmcnt(5)
    v_max_u32 v194, v84, v86
    s_waitcnt vmcnt(4)
    v_max3_u32 v194, v194, v88, v90
    v_cmp_lt_u32 vcc, s87, v194
    s_cbranch_vccnz Lwrty_33
    v_smfmac_f32_16x16x64_bf16 v[206:209], v[84:87], a[240:247], v187
    v_exp_f32 v230, v230
    v_smfmac_f32_16x16x64_bf16 v[210:213], v[84:87], a[248:255], v187
    v_exp_f32 v226, v226
    v_smfmac_f32_16x16x64_bf16 v[206:209], v[88:91], v[4:11], v187
    v_exp_f32 v227, v227
    v_smfmac_f32_16x16x64_bf16 v[210:213], v[88:91], v[12:19], v187
Lwchk_34:
    s_waitcnt vmcnt(3)
    v_max_u32 v194, v92, v94
    s_waitcnt vmcnt(2)
    v_max3_u32 v194, v194, v96, v98
    v_cmp_lt_u32 vcc, s87, v194
    s_cbranch_vccnz Lwrty_35
    v_smfmac_f32_16x16x64_bf16 v[206:209], v[92:95], v[20:27], v187
    v_exp_f32 v228, v228
    v_smfmac_f32_16x16x64_bf16 v[210:213], v[92:95], v[28:35], v187
    v_exp_f32 v229, v229
    v_smfmac_f32_16x16x64_bf16 v[206:209], v[96:99], v[36:43], v187
    v_cvt_pk_bf16_f32 v200, v230, v230
    v_smfmac_f32_16x16x64_bf16 v[210:213], v[96:99], v[44:51], v187
Lwchk_36:
    s_waitcnt vmcnt(1)
    v_max_u32 v194, v100, v102
    s_waitcnt vmcnt(0)
    v_max3_u32 v194, v194, v104, v106
    v_cmp_lt_u32 vcc, s87, v194
    s_cbranch_vccnz Lwrty_37
    v_smfmac_f32_16x16x64_bf16 v[206:209], v[100:103], v[52:59], v187
    v_cvt_pk_bf16_f32 v198, v226, v227
    v_smfmac_f32_16x16x64_bf16 v[210:213], v[100:103], v[60:67], v187
    v_cvt_pk_bf16_f32 v199, v228, v229
    v_smfmac_f32_16x16x64_bf16 v[206:209], v[104:107], v[68:75], v187
    ds_write_b16 v246, v200 offset:14344
    v_smfmac_f32_16x16x64_bf16 v[210:213], v[104:107], v[76:83], v187
    s_nop 0
    ds_write_b64 v245, v[198:199] offset:14336
    s_waitcnt lgkmcnt(6)
    v_mfma_f32_16x16x32_bf16 v[152:155], a[24:27], v[128:131], v[152:155]
    s_nop 0
    ds_read_b128 v[124:127], v233 offset:4096
    s_nop 0
    v_mfma_f32_16x16x32_bf16 v[160:163], a[104:107], v[128:131], v[160:163]
    v_permlane32_swap_b32 v206, v210
    v_permlane32_swap_b32 v207, v211
    v_permlane32_swap_b32 v208, v212
    v_permlane32_swap_b32 v209, v213
    v_pk_add_f32 v[206:207], v[206:207], v[210:211]
    v_pk_add_f32 v[208:209], v[208:209], v[212:213]
    ds_write2_b32 v249, v206, v207 offset0:0 offset1:32
    ds_write2_b32 v249, v208, v209 offset0:64 offset1:96
    v_mfma_f32_16x16x32_bf16 v[168:171], v[128:131], a[184:187], v[168:171]
    s_waitcnt lgkmcnt(8)
    v_mfma_f32_16x16x32_bf16 v[148:151], a[28:31], v[132:135], v[148:151]
    ds_read_b128 v[128:131], v233 offset:24576
    v_mfma_f32_16x16x32_bf16 v[156:159], a[108:111], v[132:135], v[156:159]
    v_mfma_f32_16x16x32_bf16 v[164:167], v[132:135], a[188:191], v[164:167]
    s_waitcnt lgkmcnt(1)
    s_barrier
    ds_read_b128 v[96:99], v236 offset:18432
    ds_read_b128 v[100:103], v236 offset:19456
    v_mfma_f32_16x16x32_bf16 v[152:155], a[28:31], v[136:139], v[152:155]
    ds_read_b128 v[132:135], v232 offset:5120
    ds_read_b128 v[104:107], v236 offset:20480
    v_mfma_f32_16x16x32_bf16 v[160:163], a[108:111], v[136:139], v[160:163]
    ds_read_b128 v[108:111], v236 offset:21504
    ds_read_b64 v[120:121], v240 offset:16896
    v_mfma_f32_16x16x32_bf16 v[168:171], v[136:139], a[188:191], v[168:171]
    ds_read_b128 v[112:115], v236 offset:14336
    ds_read_b128 v[116:119], v236 offset:15872
    v_mfma_f32_16x16x32_bf16 v[148:151], a[32:35], v[140:143], v[148:151]
    ds_read_b128 v[136:139], v232 offset:25600
    s_waitcnt lgkmcnt(7)
    v_pk_add_f32 v[96:97], v[96:97], v[100:101]
    v_pk_add_f32 v[98:99], v[98:99], v[102:103]
    s_waitcnt lgkmcnt(4)
    v_pk_add_f32 v[104:105], v[104:105], v[108:109]
    v_pk_add_f32 v[106:107], v[106:107], v[110:111]
    v_pk_add_f32 v[96:97], v[96:97], v[104:105]
    v_pk_add_f32 v[98:99], v[98:99], v[106:107]
    v_bfi_b32 v96, 1, s97, v96
    buffer_store_dwordx4 v[96:99], v251, s[4:7], s88 offen sc1
    s_waitcnt lgkmcnt(3)
    v_mfma_f32_16x16x16_bf16 v[206:209], v[180:181], v[120:121], 0
    v_mfma_f32_16x16x16_bf16 v[198:201], v[176:177], v[120:121], 0
    s_waitcnt lgkmcnt(2)
    v_mfma_f32_16x16x32_bf16 v[202:205], v[180:183], v[112:115], 0
    buffer_store_dword v192, v247, s[4:7], s96 offen
    v_mfma_f32_16x16x32_bf16 v[194:197], v[172:175], v[112:115], 0
    v_mfma_f32_16x16x32_bf16 v[156:159], a[112:115], v[140:143], v[156:159]
    v_mfma_f32_16x16x32_bf16 v[164:167], v[140:143], a[192:195], v[164:167]
    buffer_store_dword v192, v250, s[4:7], s96 offen
    v_mfma_f32_16x16x32_bf16 v[152:155], a[32:35], v[144:147], v[152:155]
    ds_read_b128 v[140:143], v233 offset:5120
    s_waitcnt lgkmcnt(2)
    v_mfma_f32_16x16x32_bf16 v[206:209], v[180:183], v[116:119], v[206:209]
    v_mfma_f32_16x16x32_bf16 v[198:201], v[172:175], v[116:119], v[198:201]
    v_mfma_f32_16x16x32_bf16 v[160:163], a[112:115], v[144:147], v[160:163]
    v_rcp_f32 v202, v202
    v_mfma_f32_16x16x32_bf16 v[168:171], v[144:147], a[192:195], v[168:171]
    v_mul_f32 v194, v194, v202
    v_mul_f32 v195, v195, v202
    v_mfma_f32_16x16x32_bf16 v[148:151], a[36:39], v[124:127], v[148:151]
    ds_read_b128 v[144:147], v233 offset:25600
    v_mul_f32 v196, v196, v202
    v_mfma_f32_16x16x32_bf16 v[156:159], a[116:119], v[124:127], v[156:159]
    v_mul_f32 v197, v197, v202
    v_cvt_pk_bf16_f32 v210, v194, v195
    v_mfma_f32_16x16x32_bf16 v[164:167], v[124:127], a[196:199], v[164:167]
    v_cvt_pk_bf16_f32 v211, v196, v197
    v_mfma_f32_16x16x32_bf16 v[152:155], a[36:39], v[128:131], v[152:155]
    ds_read_b128 v[124:127], v232 offset:6144
    v_mfma_f32_16x16x32_bf16 v[160:163], a[116:119], v[128:131], v[160:163]
    buffer_store_dwordx2 v[210:211], v243, s[4:7], s75 offen offset:0
    v_rcp_f32 v206, v206
    s_nop 0
    v_mfma_f32_16x16x32_bf16 v[168:171], v[128:131], a[196:199], v[168:171]
    v_mul_f32 v198, v198, v206
    v_mul_f32 v199, v199, v206
    v_mfma_f32_16x16x32_bf16 v[148:151], a[40:43], v[132:135], v[148:151]
    ds_read_b128 v[128:131], v232 offset:26624
    v_mul_f32 v200, v200, v206
    v_mfma_f32_16x16x32_bf16 v[156:159], a[120:123], v[132:135], v[156:159]
    v_mul_f32 v201, v201, v206
    v_cvt_pk_bf16_f32 v212, v198, v199
    v_mfma_f32_16x16x32_bf16 v[164:167], v[132:135], a[200:203], v[164:167]
    s_waitcnt lgkmcnt(4)
    v_cvt_pk_bf16_f32 v213, v200, v201
    v_mfma_f32_16x16x32_bf16 v[152:155], a[40:43], v[136:139], v[152:155]
    ds_read_b128 v[132:135], v233 offset:6144
    v_mfma_f32_16x16x32_bf16 v[160:163], a[120:123], v[136:139], v[160:163]
    s_add_u32 m0, s73, 8192
    buffer_load_dwordx4 v[100:103], v251, s[4:7], s82 offen sc1
    buffer_load_dwordx4 v[104:107], v251, s[4:7], s83 offen sc1
    v_mfma_f32_16x16x32_bf16 v[168:171], v[136:139], a[200:203], v[168:171]
    s_waitcnt lgkmcnt(4)
    buffer_load_dwordx4 v[108:111], v251, s[4:7], s84 offen sc1
    s_add_u32 s94, s74, 16384
    v_mfma_f32_16x16x32_bf16 v[148:151], a[44:47], v[140:143], v[148:151]
    ds_read_b128 v[136:139], v233 offset:26624
    buffer_load_dwordx4 v234, s[4:7], s94 offen sc1 lds
    v_mfma_f32_16x16x32_bf16 v[156:159], a[124:127], v[140:143], v[156:159]
    buffer_store_dwordx2 v[212:213], v243, s[4:7], s75 offen offset:2048
    s_cmp_eq_u32 s62, 63
    s_cbranch_scc1 L_Clast
    v_mfma_f32_16x16x32_bf16 v[164:167], v[140:143], a[204:207], v[164:167]
    s_waitcnt lgkmcnt(4)
    s_add_u32 s75, s75, 393216
    s_add_u32 s66, s62, 1
    v_mfma_f32_16x16x32_bf16 v[152:155], a[44:47], v[144:147], v[152:155]
    s_add_u32 m0, s73, 12288
    ds_read_b128 v[140:143], v232 offset:7168
    s_add_u32 s94, s74, 20480
    v_mfma_f32_16x16x32_bf16 v[160:163], a[124:127], v[144:147], v[160:163]
    buffer_load_dwordx4 v234, s[4:7], s94 offen sc1 lds
    v_mfma_f32_16x16x32_bf16 v[168:171], v[144:147], a[204:207], v[168:171]
    s_waitcnt lgkmcnt(4)
    s_and_b32 s66, s66, 7
    s_cselect_b32 s66, 0, 3145728
    v_mfma_f32_16x16x32_bf16 v[148:151], a[48:51], v[124:127], v[148:151]
    s_sub_u32 s75, s75, s66
    ds_read_b128 v[144:147], v232 offset:27648
    v_mov_b64 v[194:195], 0
    v_mfma_f32_16x16x32_bf16 v[156:159], a[128:131], v[124:127], v[156:159]
    s_add_u32 m0, s73, 16384
    s_add_u32 s94, s74, 32768
    buffer_load_dwordx4 v234, s[4:7], s94 offen sc1 lds
    v_mfma_f32_16x16x32_bf16 v[164:167], v[124:127], a[208:211], v[164:167]
    s_waitcnt lgkmcnt(4)
    buffer_load_dwordx4 v[84:87], v251, s[4:7], s82 offen sc1
    buffer_load_dwordx4 v[88:91], v251, s[4:7], s83 offen sc1
    v_mfma_f32_16x16x32_bf16 v[152:155], a[48:51], v[128:131], v[152:155]
    ds_read_b128 v[124:127], v233 offset:7168
    buffer_load_dwordx4 v[92:95], v251, s[4:7], s84 offen sc1
    v_mfma_f32_16x16x32_bf16 v[160:163], a[128:131], v[128:131], v[160:163]
    s_add_u32 m0, s73, 20480
    s_add_u32 s94, s74, 36864
    buffer_load_dwordx4 v234, s[4:7], s94 offen sc1 lds
    v_mfma_f32_16x16x32_bf16 v[168:171], v[128:131], a[208:211], v[168:171]
    s_waitcnt lgkmcnt(4)
    v_mov_b64 v[196:197], 0
    v_mov_b64 v[198:199], 0
    v_mfma_f32_16x16x32_bf16 v[148:151], a[52:55], v[132:135], v[148:151]
    ds_read_b128 v[128:131], v233 offset:27648
    v_mov_b64 v[200:201], 0
    v_mfma_f32_16x16x32_bf16 v[156:159], a[132:135], v[132:135], v[156:159]
    s_add_u32 m0, s73, 24576
    s_add_u32 s94, s74, 49152
    buffer_load_dwordx4 v234, s[4:7], s94 offen sc1 lds
    v_mfma_f32_16x16x32_bf16 v[164:167], v[132:135], a[212:215], v[164:167]
    s_waitcnt lgkmcnt(4)
    v_mov_b64 v[202:203], 0
    v_mov_b64 v[204:205], 0
    v_mfma_f32_16x16x32_bf16 v[152:155], a[52:55], v[136:139], v[152:155]
    ds_read_b128 v[132:135], v232 offset:8192
    v_mfma_f32_16x16x32_bf16 v[160:163], a[132:135], v[136:139], v[160:163]
    s_add_u32 m0, s73, 28672
    s_add_u32 s94, s74, 53248
    buffer_load_dwordx4 v234, s[4:7], s94 offen sc1 lds
    v_mfma_f32_16x16x32_bf16 v[168:171], v[136:139], a[212:215], v[168:171]
    s_waitcnt lgkmcnt(4)
    v_mfma_f32_16x16x32_bf16 v[148:151], a[56:59], v[140:143], v[148:151]
    ds_read_b128 v[136:139], v232 offset:28672
    v_mfma_f32_16x16x32_bf16 v[156:159], a[136:139], v[140:143], v[156:159]
    s_add_u32 m0, s73, 32768
    s_add_u32 s94, s74, 65536
    buffer_load_dwordx4 v234, s[4:7], s94 offen sc1 lds
    v_mfma_f32_16x16x32_bf16 v[164:167], v[140:143], a[216:219], v[164:167]
    s_waitcnt lgkmcnt(4)
    v_mfma_f32_16x16x32_bf16 v[152:155], a[56:59], v[144:147], v[152:155]
    ds_read_b128 v[140:143], v233 offset:8192
    s_waitcnt vmcnt(12)
    v_bitop3_b32 v218, v100, v104, s97 bitop3:0x7e
    s_waitcnt vmcnt(11)
    v_bitop3_b32 v218, v218, v108, s97 bitop3:0xf6
    v_and_b32 v218, v193, v218
    v_cmp_eq_u32 vcc, 1, v218
    s_cbranch_vccnz Lrty_39
    v_pk_add_f32 v[96:97], v[96:97], v[100:101]
    v_pk_add_f32 v[98:99], v[98:99], v[102:103]
    v_pk_add_f32 v[104:105], v[104:105], v[108:109]
    v_pk_add_f32 v[106:107], v[106:107], v[110:111]
    v_pk_add_f32 v[96:97], v[96:97], v[104:105]
    v_pk_add_f32 v[98:99], v[98:99], v[106:107]
Lok_38:
    v_cvt_pk_bf16_f32 v96, v96, v97
    v_cvt_pk_bf16_f32 v97, v98, v99
    v_min_u32 v96, -2, v96
    buffer_store_dwordx2 v[96:97], v250, s[4:7], s72 offen
    s_barrier
    v_mfma_f32_16x16x32_bf16 v[160:163], a[136:139], v[144:147], v[160:163]
    s_add_u32 s82, s72, 178176
    s_add_u32 s83, s72, 182272
    s_add_u32 m0, s73, 36864
    v_mfma_f32_16x16x32_bf16 v[168:171], v[144:147], a[216:219], v[168:171]
    s_waitcnt lgkmcnt(4)
    s_add_u32 s94, s74, 69632
    buffer_load_dwordx4 v234, s[4:7], s94 offen sc1 lds
    v_mfma_f32_16x16x32_bf16 v[148:151], a[60:63], v[124:127], v[148:151]
    ds_read_b128 v[144:147], v233 offset:28672
    v_add_u32_e64 v218, s62, 1
    v_mfma_f32_16x16x32_bf16 v[156:159], a[140:143], v[124:127], v[156:159]
    s_waitcnt vmcnt(11)
    buffer_store_dword v218, v1, s[4:7], s3 offen
    v_mfma_f32_16x16x32_bf16 v[164:167], v[124:127], a[220:223], v[164:167]
    s_waitcnt lgkmcnt(4)
    v_mfma_f32_16x16x32_bf16 v[152:155], a[60:63], v[128:131], v[152:155]
    ds_read_b128 v[124:127], v232 offset:9216
    v_mfma_f32_16x16x32_bf16 v[160:163], a[140:143], v[128:131], v[160:163]
    v_mfma_f32_16x16x32_bf16 v[168:171], v[128:131], a[220:223], v[168:171]
    s_waitcnt lgkmcnt(4)
    v_mfma_f32_16x16x32_bf16 v[148:151], a[64:67], v[132:135], v[148:151]
    ds_read_b128 v[128:131], v232 offset:29696
    v_mfma_f32_16x16x32_bf16 v[156:159], a[144:147], v[132:135], v[156:159]
    v_mfma_f32_16x16x32_bf16 v[164:167], v[132:135], a[224:227], v[164:167]
    s_waitcnt lgkmcnt(4)
    v_mfma_f32_16x16x32_bf16 v[152:155], a[64:67], v[136:139], v[152:155]
    s_add_u32 s86, s72, 262144
    ds_read_b128 v[132:135], v233 offset:9216
    buffer_load_dwordx4 v[112:115], v234, s[4:7], s82 offen sc1
    v_mfma_f32_16x16x32_bf16 v[160:163], a[144:147], v[136:139], v[160:163]
    s_and_b32 s86, s86, 786432
    buffer_load_dwordx4 v[116:119], v234, s[4:7], s83 offen sc1
    buffer_load_dwordx2 v[120:121], v235, s[4:7], s82 offen sc1
    v_mfma_f32_16x16x32_bf16 v[168:171], v[136:139], a[224:227], v[168:171]
    s_waitcnt lgkmcnt(4)
    s_andn2_b32 s72, s72, 786432
    s_or_b32 s72, s72, s86
    v_mfma_f32_16x16x32_bf16 v[148:151], a[68:71], v[140:143], v[148:151]
    s_mov_b32 s74, s92
    ds_read_b128 v[136:139], v233 offset:29696
    s_xor_b32 s73, s73, 65536
    v_mfma_f32_16x16x32_bf16 v[156:159], a[148:151], v[140:143], v[156:159]
    s_add_u32 s91, s91, 131072
    s_lshr_b32 s92, s91, 8
    s_xor_b32 s92, s92, s1
    v_mfma_f32_16x16x32_bf16 v[164:167], v[140:143], a[228:231], v[164:167]
    s_waitcnt lgkmcnt(4)
    s_and_b32 s92, s92, s93
    s_or_b32 s92, s92, s91
    v_mfma_f32_16x16x32_bf16 v[152:155], a[68:71], v[144:147], v[152:155]
    v_mfma_f32_16x16x32_bf16 v[160:163], a[148:151], v[144:147], v[160:163]
    buffer_load_dwordx4 v[100:103], v234, s[4:7], s82 offen sc1
    buffer_load_dwordx4 v[104:107], v234, s[4:7], s83 offen sc1
    v_mfma_f32_16x16x32_bf16 v[168:171], v[144:147], a[228:231], v[168:171]
    s_waitcnt lgkmcnt(3)
    buffer_load_dwordx2 v[108:109], v235, s[4:7], s82 offen sc1
    v_mfma_f32_16x16x32_bf16 v[148:151], a[72:75], v[124:127], v[148:151]
    v_mfma_f32_16x16x32_bf16 v[156:159], a[152:155], v[124:127], v[156:159]
    v_mfma_f32_16x16x32_bf16 v[164:167], v[124:127], a[232:235], v[164:167]
    s_add_u32 s62, s62, 1
    s_branch L_Ctop3
Lrty_26:
    buffer_load_dwordx4 v[112:115], v234, s[4:7], s82 offen sc1
    buffer_load_dwordx4 v[116:119], v234, s[4:7], s83 offen sc1
    buffer_load_dwordx2 v[120:121], v235, s[4:7], s82 offen sc1
    s_sub_u32 s61, s61, 1
    s_mov_b32 s67, 15
    s_cbranch_scc1 L_fail
    s_waitcnt vmcnt(4)
    v_max3_u32 v218, v100, v102, v104
    s_waitcnt vmcnt(3)
    v_max3_u32 v218, v218, v106, v108
    v_cmp_eq_u32 vcc, -1, v218
    s_cbranch_vccnz Lrty_27
    ds_write_b128 v234, v[100:103] offset:0
    ds_write_b128 v234, v[104:107] offset:4096
    ds_write_b64 v235, v[108:109] offset:0
    s_branch Lok_25
Lrty_27:
    buffer_load_dwordx4 v[100:103], v234, s[4:7], s82 offen sc1
    buffer_load_dwordx4 v[104:107], v234, s[4:7], s83 offen sc1
    buffer_load_dwordx2 v[108:109], v235, s[4:7], s82 offen sc1
    s_sub_u32 s61, s61, 1
    s_mov_b32 s67, 15
    s_cbranch_scc1 L_fail
    s_waitcnt vmcnt(4)
    v_max3_u32 v218, v112, v114, v116
    s_waitcnt vmcnt(3)
    v_max3_u32 v218, v218, v118, v120
    v_cmp_eq_u32 vcc, -1, v218
    s_cbranch_vccnz Lrty_26
    ds_write_b128 v234, v[112:115] offset:0
    ds_write_b128 v234, v[116:119] offset:4096
    ds_write_b64 v235, v[120:121] offset:0
    s_branch Lok_25
Lrty_29:
    buffer_load_dwordx4 v[84:87], v236, s[4:7], s80 offen sc1
    buffer_load_dwordx4 v[88:91], v236, s[4:7], s81 offen sc1
    buffer_load_dword v92, v237, s[4:7], s80 offen offset:1024 sc1
    buffer_load_dword v93, v237, s[4:7], s81 offen offset:1024 sc1
    s_sub_u32 s61, s61, 1
    s_mov_b32 s67, 11
    s_cbranch_scc1 L_fail
    s_waitcnt vmcnt(2)
    v_bitop3_b32 v218, v84, v88, s97 bitop3:0x7e
    s_waitcnt vmcnt(0)
    v_bitop3_b32 v219, v92, v93, s97 bitop3:0x7e
    v_bitop3_b32 v218, v218, v219, 1 bitop3:0xa8
    v_cmp_eq_u32 vcc, 1, v218
    s_cbranch_vccnz Lrty_29
    v_pk_add_f32 v[84:85], v[84:85], v[88:89]
    v_pk_add_f32 v[86:87], v[86:87], v[90:91]
    v_add_f32 v92, v92, v93
    v_pk_add_f32 v[220:221], v[220:221], v[84:85]
    v_pk_add_f32 v[222:223], v[222:223], v[86:87]
    v_add_f32 v224, v224, v92
    s_branch Lok_28
Lrty_31:
    buffer_load_dwordx4 v[108:111], v238, s[4:7], s80 offen sc1
    buffer_load_dwordx4 v[112:115], v238, s[4:7], s81 offen sc1
    buffer_load_dword v116, v239, s[4:7], s80 offen offset:1024 sc1
    buffer_load_dword v117, v239, s[4:7], s81 offen offset:1024 sc1
    s_sub_u32 s61, s61, 1
    s_mov_b32 s67, 12
    s_cbranch_scc1 L_fail
    s_waitcnt vmcnt(2)
    v_bitop3_b32 v218, v108, v112, s97 bitop3:0x7e
    s_waitcnt vmcnt(0)
    v_bitop3_b32 v219, v116, v117, s97 bitop3:0x7e
    v_bitop3_b32 v218, v218, v219, 1 bitop3:0xa8
    v_cmp_eq_u32 vcc, 1, v218
    s_cbranch_vccnz Lrty_31
    s_branch Lok_30
Lwrty_33:
    buffer_load_dwordx4 v[84:87], v248, s[4:7], s85 offen offset:0 sc1
    buffer_load_dwordx4 v[88:91], v248, s[4:7], s85 offen offset:1024 sc1
    buffer_load_dwordx4 v[92:95], v248, s[4:7], s85 offen offset:2048 sc1
    buffer_load_dwordx4 v[96:99], v248, s[4:7], s85 offen offset:3072 sc1
    buffer_load_dwordx4 v[100:103], v248, s[4:7], s86 offen offset:0 sc1
    buffer_load_dwordx4 v[104:107], v248, s[4:7], s86 offen offset:1024 sc1
    s_sub_u32 s61, s61, 1
    s_mov_b32 s67, 13
    s_cbranch_scc1 L_fail
    s_branch Lwchk_32
Lwrty_35:
    buffer_load_dwordx4 v[92:95], v248, s[4:7], s85 offen offset:2048 sc1
    buffer_load_dwordx4 v[96:99], v248, s[4:7], s85 offen offset:3072 sc1
    buffer_load_dwordx4 v[100:103], v248, s[4:7], s86 offen offset:0 sc1
    buffer_load_dwordx4 v[104:107], v248, s[4:7], s86 offen offset:1024 sc1
    s_sub_u32 s61, s61, 1
    s_mov_b32 s67, 13
    s_cbranch_scc1 L_fail
    s_branch Lwchk_34
Lwrty_37:
    buffer_load_dwordx4 v[100:103], v248, s[4:7], s86 offen offset:0 sc1
    buffer_load_dwordx4 v[104:107], v248, s[4:7], s86 offen offset:1024 sc1
    s_sub_u32 s61, s61, 1
    s_mov_b32 s67, 13
    s_cbranch_scc1 L_fail
    s_branch Lwchk_36
Lrty_39:
    buffer_load_dwordx4 v[100:103], v251, s[4:7], s82 offen sc1
    buffer_load_dwordx4 v[104:107], v251, s[4:7], s83 offen sc1
    buffer_load_dwordx4 v[108:111], v251, s[4:7], s84 offen sc1
    s_sub_u32 s61, s61, 1
    s_mov_b32 s67, 14
    s_cbranch_scc1 L_fail
    s_waitcnt vmcnt(4)
    v_bitop3_b32 v218, v84, v88, s97 bitop3:0x7e
    s_waitcnt vmcnt(3)
    v_bitop3_b32 v218, v218, v92, s97 bitop3:0xf6
    v_and_b32 v218, v193, v218
    v_cmp_eq_u32 vcc, 1, v218
    s_cbranch_vccnz Lrty_40
    v_pk_add_f32 v[96:97], v[96:97], v[84:85]
    v_pk_add_f32 v[98:99], v[98:99], v[86:87]
    v_pk_add_f32 v[88:89], v[88:89], v[92:93]
    v_pk_add_f32 v[90:91], v[90:91], v[94:95]
    v_pk_add_f32 v[96:97], v[96:97], v[88:89]
    v_pk_add_f32 v[98:99], v[98:99], v[90:91]
    s_branch Lok_38
Lrty_40:
    buffer_load_dwordx4 v[84:87], v251, s[4:7], s82 offen sc1
    buffer_load_dwordx4 v[88:91], v251, s[4:7], s83 offen sc1
    buffer_load_dwordx4 v[92:95], v251, s[4:7], s84 offen sc1
    s_sub_u32 s61, s61, 1
    s_mov_b32 s67, 14
    s_cbranch_scc1 L_fail
    s_waitcnt vmcnt(4)
    v_bitop3_b32 v218, v100, v104, s97 bitop3:0x7e
    s_waitcnt vmcnt(3)
    v_bitop3_b32 v218, v218, v108, s97 bitop3:0xf6
    v_and_b32 v218, v193, v218
    v_cmp_eq_u32 vcc, 1, v218
    s_cbranch_vccnz Lrty_39
    v_pk_add_f32 v[96:97], v[96:97], v[100:101]
    v_pk_add_f32 v[98:99], v[98:99], v[102:103]
    v_pk_add_f32 v[104:105], v[104:105], v[108:109]
    v_pk_add_f32 v[106:107], v[106:107], v[110:111]
    v_pk_add_f32 v[96:97], v[96:97], v[104:105]
    v_pk_add_f32 v[98:99], v[98:99], v[106:107]
    s_branch Lok_38
L_Ctop0:
    s_waitcnt vmcnt(5)
    ds_write_b128 v234, v[112:115] offset:0
    s_waitcnt vmcnt(4)
    ds_write_b128 v234, v[116:119] offset:4096
    s_waitcnt vmcnt(3)
    ds_write_b64 v235, v[120:121] offset:0
    v_max3_u32 v218, v112, v114, v116
    v_max3_u32 v218, v218, v118, v120
    v_cmp_eq_u32 vcc, -1, v218
    s_cbranch_vccnz Lrty_42
Lok_41:
    s_waitcnt lgkmcnt(5)
    v_mfma_f32_16x16x32_bf16 v[152:155], a[72:75], v[128:131], v[152:155]
    v_mfma_f32_16x16x32_bf16 v[160:163], a[152:155], v[128:131], v[160:163]
    v_mfma_f32_16x16x32_bf16 v[168:171], v[128:131], a[232:235], v[168:171]
    s_waitcnt lgkmcnt(4)
    v_mfma_f32_16x16x32_bf16 v[148:151], a[76:79], v[132:135], v[148:151]
L_Cin0:
    s_waitcnt lgkmcnt(0)
    s_barrier
    ds_read_b128 v[84:87], v236 offset:0
    ds_read_b128 v[88:91], v236 offset:1024
    v_mfma_f32_16x16x32_bf16 v[156:159], a[156:159], v[132:135], v[156:159]
    s_andn2_b32 s71, s72, 524288
    ds_read_b128 v[92:95], v236 offset:2048
    ds_read_b128 v[96:99], v236 offset:3072
    v_mfma_f32_16x16x32_bf16 v[164:167], v[132:135], a[236:239], v[164:167]
    s_waitcnt vmcnt(2)
    ds_read_b128 v[100:103], v236 offset:4096
    s_waitcnt vmcnt(1)
    ds_read_b128 v[104:107], v236 offset:5120
    v_mfma_f32_16x16x32_bf16 v[152:155], a[76:79], v[136:139], v[152:155]
    s_lshr_b32 s97, s62, 1
    s_waitcnt vmcnt(0)
    ds_read_b128 v[108:111], v236 offset:6144
    ds_read_b128 v[112:115], v236 offset:7168
    v_mfma_f32_16x16x32_bf16 v[160:163], a[156:159], v[136:139], v[160:163]
    s_add_u32 s79, s71, s76
    ds_read_b128 v[116:119], v236 offset:8192
    ds_read_b128 v[120:123], v236 offset:9216
    v_mfma_f32_16x16x32_bf16 v[168:171], v[136:139], a[236:239], v[168:171]
    s_add_u32 s80, s71, s77
    s_add_u32 s81, s71, s78
    s_waitcnt lgkmcnt(9)
    v_smfmac_f32_16x16x64_bf16 v[194:197], v[84:87], a[0:7], v187
    v_xor_b32 v232, 0x10000, v232
    v_smfmac_f32_16x16x64_bf16 v[198:201], v[84:87], a[80:87], v187
    s_waitcnt lgkmcnt(8)
    v_xor_b32 v233, 0x10000, v233
    v_smfmac_f32_16x16x64_bf16 v[194:197], v[88:91], a[8:15], v187
    v_cvt_pk_bf16_f32 v148, v148, v149
    v_smfmac_f32_16x16x64_bf16 v[198:201], v[88:91], a[88:95], v187
    s_waitcnt lgkmcnt(7)
    v_cvt_pk_bf16_f32 v149, v150, v151
    v_smfmac_f32_16x16x64_bf16 v[194:197], v[92:95], a[16:23], v187
    ds_write_b64 v243, v[148:149] offset:22528
    v_smfmac_f32_16x16x64_bf16 v[198:201], v[92:95], a[96:103], v187
    s_waitcnt lgkmcnt(7)
    v_cvt_pk_bf16_f32 v152, v152, v153
    v_smfmac_f32_16x16x64_bf16 v[194:197], v[96:99], a[24:31], v187
    v_cvt_pk_bf16_f32 v153, v154, v155
    v_smfmac_f32_16x16x64_bf16 v[198:201], v[96:99], a[104:111], v187
    s_waitcnt lgkmcnt(6)
    ds_write_b64 v243, v[152:153] offset:24576
    v_smfmac_f32_16x16x64_bf16 v[194:197], v[100:103], a[32:39], v187
    v_cvt_pk_bf16_f32 v156, v156, v157
    v_smfmac_f32_16x16x64_bf16 v[198:201], v[100:103], a[112:119], v187
    s_waitcnt lgkmcnt(6)
    v_cvt_pk_bf16_f32 v157, v158, v159
    v_smfmac_f32_16x16x64_bf16 v[194:197], v[104:107], a[40:47], v187
    ds_write_b64 v243, v[156:157] offset:26624
    v_smfmac_f32_16x16x64_bf16 v[198:201], v[104:107], a[120:127], v187
    s_waitcnt lgkmcnt(6)
    v_cvt_pk_bf16_f32 v160, v160, v161
    v_smfmac_f32_16x16x64_bf16 v[194:197], v[108:111], a[48:55], v187
    v_cvt_pk_bf16_f32 v161, v162, v163
    v_smfmac_f32_16x16x64_bf16 v[198:201], v[108:111], a[128:135], v187
    s_waitcnt lgkmcnt(5)
    ds_write_b64 v243, v[160:161] offset:28672
    v_smfmac_f32_16x16x64_bf16 v[194:197], v[112:115], a[56:63], v187
    v_cvt_pk_bf16_f32 v172, v164, v165
    v_smfmac_f32_16x16x64_bf16 v[198:201], v[112:115], a[136:143], v187
    s_waitcnt lgkmcnt(5)
    v_cvt_pk_bf16_f32 v173, v166, v167
    v_smfmac_f32_16x16x64_bf16 v[194:197], v[116:119], a[64:71], v187
    v_cvt_pk_bf16_f32 v176, v168, v169
    v_smfmac_f32_16x16x64_bf16 v[198:201], v[116:119], a[144:151], v187
    s_waitcnt lgkmcnt(4)
    v_cvt_pk_bf16_f32 v177, v170, v171
    v_smfmac_f32_16x16x64_bf16 v[194:197], v[120:123], a[72:79], v187
    s_cmp_lt_u32 s59, 20
    s_cselect_b32 s85, s72, s92
    s_add_u32 s86, s85, s89
    v_smfmac_f32_16x16x64_bf16 v[198:201], v[120:123], a[152:159], v187
    s_xor_b32 s96, s72, 524288
    s_nop 1
    v_smfmac_f32_16x16x64_bf16 v[202:205], v[84:87], a[160:167], v187
    s_nop 3
    v_permlane32_swap_b32 v194, v198
    v_permlane32_swap_b32 v195, v199
    v_permlane32_swap_b32 v196, v200
    v_permlane32_swap_b32 v197, v201
    v_pk_add_f32 v[194:195], v[194:195], v[198:199]
    v_pk_add_f32 v[196:197], v[196:197], v[200:201]
    v_cvt_pk_bf16_f32 v194, v194, v195
    v_cvt_pk_bf16_f32 v195, v196, v197
    ds_write_b64 v241, v[194:195] offset:12288
    v_smfmac_f32_16x16x64_bf16 v[202:205], v[88:91], a[168:175], v187
    v_smfmac_f32_16x16x64_bf16 v[202:205], v[92:95], a[176:183], v187
    v_smfmac_f32_16x16x64_bf16 v[202:205], v[96:99], a[184:191], v187
    v_smfmac_f32_16x16x64_bf16 v[202:205], v[100:103], a[192:199], v187
    v_smfmac_f32_16x16x64_bf16 v[202:205], v[104:107], a[200:207], v187
    s_waitcnt lgkmcnt(0)
    s_barrier
    ds_read_b64_tr_b16 v[124:125], v242 offset:12288
    ds_read_b64_tr_b16 v[126:127], v242 offset:12352
    ds_read_b64_tr_b16 v[132:133], v242 offset:13312
    ds_read_b64_tr_b16 v[134:135], v242 offset:13376
    v_smfmac_f32_16x16x64_bf16 v[202:205], v[108:111], a[208:215], v187
    ds_read_b128 v[148:151], v236 offset:26624
    ds_read_b128 v[156:159], v236 offset:28672
    v_smfmac_f32_16x16x64_bf16 v[202:205], v[112:115], a[216:223], v187
    ds_read_b64_tr_b16 v[128:129], v242 offset:12800
    ds_read_b64_tr_b16 v[130:131], v242 offset:12864
    v_smfmac_f32_16x16x64_bf16 v[202:205], v[116:119], a[224:231], v187
    ds_read_b64_tr_b16 v[136:137], v242 offset:13824
    ds_read_b64_tr_b16 v[138:139], v242 offset:13888
    v_smfmac_f32_16x16x64_bf16 v[202:205], v[120:123], a[232:239], v187
    ds_read_b128 v[152:155], v236 offset:27648
    ds_read_b128 v[160:163], v236 offset:29696
    s_waitcnt lgkmcnt(8)
    v_mfma_f32_16x16x32_bf16 v[214:217], v[132:135], v[124:127], 0
    s_waitcnt lgkmcnt(7)
    v_mfma_f32_16x16x32_bf16 v[206:209], v[148:151], v[124:127], 0
    s_waitcnt lgkmcnt(6)
    v_mfma_f32_16x16x32_bf16 v[210:213], v[156:159], v[124:127], 0
    ds_read_b128 v[164:167], v244 offset:22528
    ds_read_b128 v[168:171], v244 offset:23552
    s_waitcnt lgkmcnt(4)
    v_mfma_f32_16x16x32_bf16 v[214:217], v[136:139], v[128:131], v[214:217]
    s_waitcnt lgkmcnt(3)
    v_mfma_f32_16x16x32_bf16 v[206:209], v[152:155], v[128:131], v[206:209]
    s_waitcnt lgkmcnt(2)
    v_mfma_f32_16x16x32_bf16 v[210:213], v[160:163], v[128:131], v[210:213]
    v_permlane32_swap_b32 v202, v204
    v_permlane32_swap_b32 v203, v205
    v_add_f32 v202, v202, v204
    v_add_f32 v203, v203, v205
    v_cndmask_b32 v214, v214, v215, s[98:99]
    v_cndmask_b32 v216, v216, v217, s[98:99]
    v_cndmask_b32 v224, v214, v216, s[100:101]
    s_nop 0
    v_cndmask_b32 v220, v206, v210, s[98:99]
    v_cndmask_b32 v221, v207, v211, s[98:99]
    v_cndmask_b32 v222, v208, v212, s[98:99]
    v_cndmask_b32 v223, v209, v213, s[98:99]
    v_cvt_pk_bf16_f32 v174, v202, v203
    v_cvt_pk_bf16_f32 v178, v202, v203
    ds_read_b128 v[124:127], v232 offset:0
    ds_read_b128 v[128:131], v232 offset:20480
    s_waitcnt lgkmcnt(3)
    v_mfma_f32_16x16x32_bf16 v[214:217], v[132:135], v[164:167], 0
    ds_read_b128 v[140:143], v232 offset:1024
    v_mfma_f32_16x16x32_bf16 v[206:209], v[148:151], v[164:167], v[188:191]
    v_mfma_f32_16x16x32_bf16 v[210:213], v[156:159], v[164:167], v[188:191]
    s_waitcnt lgkmcnt(3)
    v_mfma_f32_16x16x32_bf16 v[214:217], v[136:139], v[168:171], v[214:217]
    ds_read_b128 v[132:135], v233 offset:0
    v_mfma_f32_16x16x32_bf16 v[206:209], v[152:155], v[168:171], v[206:209]
    ds_read_b128 v[136:139], v233 offset:20480
    v_mfma_f32_16x16x32_bf16 v[210:213], v[160:163], v[168:171], v[210:213]
    s_waitcnt lgkmcnt(4)
    v_mfma_f32_16x16x32_bf16 v[148:151], a[0:3], v[124:127], 0
    ds_read_b128 v[144:147], v232 offset:21504
    s_nop 0
    v_cndmask_b32 v214, v214, v215, s[98:99]
    v_mfma_f32_16x16x32_bf16 v[156:159], a[80:83], v[124:127], 0
    v_cndmask_b32 v216, v216, v217, s[98:99]
    v_cndmask_b32 v230, v214, v216, s[100:101]
    v_mfma_f32_16x16x32_bf16 v[164:167], v[124:127], a[160:163], 0
    s_waitcnt lgkmcnt(4)
    v_bfi_b32 v230, 1, s97, v230
    v_cndmask_b32 v226, v206, v210, s[98:99]
    v_mfma_f32_16x16x32_bf16 v[152:155], a[0:3], v[128:131], 0
    ds_read_b128 v[124:127], v233 offset:1024
    v_cndmask_b32 v227, v207, v211, s[98:99]
    v_mfma_f32_16x16x32_bf16 v[160:163], a[80:83], v[128:131], 0
    v_cndmask_b32 v228, v208, v212, s[98:99]
    v_cndmask_b32 v229, v209, v213, s[98:99]
    v_mfma_f32_16x16x32_bf16 v[168:171], v[128:131], a[160:163], 0
    v_bfi_b32 v226, 1, s97, v226
    s_waitcnt lgkmcnt(3)
    v_mfma_f32_16x16x32_bf16 v[148:151], a[4:7], v[132:135], v[148:151]
    ds_read_b128 v[128:131], v233 offset:21504
    buffer_load_dwordx4 v[84:87], v236, s[4:7], s80 offen sc1
    v_mfma_f32_16x16x32_bf16 v[156:159], a[84:87], v[132:135], v[156:159]
    buffer_load_dwordx4 v[88:91], v236, s[4:7], s81 offen sc1
    buffer_load_dword v92, v237, s[4:7], s80 offen offset:1024 sc1
    v_mfma_f32_16x16x32_bf16 v[164:167], v[132:135], a[164:167], v[164:167]
    s_waitcnt lgkmcnt(3)
    buffer_load_dword v93, v237, s[4:7], s81 offen offset:1024 sc1
    v_mfma_f32_16x16x32_bf16 v[152:155], a[4:7], v[136:139], v[152:155]
    ds_read_b128 v[132:135], v232 offset:2048
    v_mfma_f32_16x16x32_bf16 v[160:163], a[84:87], v[136:139], v[160:163]
    v_mfma_f32_16x16x32_bf16 v[168:171], v[136:139], a[164:167], v[168:171]
    v_mfma_f32_16x16x32_bf16 v[148:151], a[8:11], v[140:143], v[148:151]
    ds_read_b128 v[136:139], v232 offset:22528
    v_mfma_f32_16x16x32_bf16 v[156:159], a[88:91], v[140:143], v[156:159]
    buffer_store_dwordx4 v[226:229], v238, s[4:7], s79 offen
    buffer_store_dword v230, v239, s[4:7], s79 offen offset:1024
    v_mfma_f32_16x16x32_bf16 v[164:167], v[140:143], a[168:171], v[164:167]
    s_waitcnt lgkmcnt(4)
    v_mfma_f32_16x16x32_bf16 v[152:155], a[8:11], v[144:147], v[152:155]
    ds_read_b128 v[140:143], v233 offset:2048
    v_mfma_f32_16x16x32_bf16 v[160:163], a[88:91], v[144:147], v[160:163]
    v_mfma_f32_16x16x32_bf16 v[168:171], v[144:147], a[168:171], v[168:171]
    s_waitcnt vmcnt(4)
    v_bitop3_b32 v218, v84, v88, s97 bitop3:0x7e
    s_waitcnt vmcnt(2)
    v_bitop3_b32 v219, v92, v93, s97 bitop3:0x7e
    v_bitop3_b32 v218, v218, v219, 1 bitop3:0xa8
    v_cmp_eq_u32 vcc, 1, v218
    s_cbranch_vccnz Lrty_45
    v_pk_add_f32 v[84:85], v[84:85], v[88:89]
    v_pk_add_f32 v[86:87], v[86:87], v[90:91]
    v_add_f32 v92, v92, v93
    v_pk_add_f32 v[220:221], v[220:221], v[84:85]
    v_pk_add_f32 v[222:223], v[222:223], v[86:87]
    v_add_f32 v224, v224, v92
Lok_44:
    v_max3_f32 v218, v220, v221, v222
    v_max3_f32 v218, v218, v223, v224
    buffer_load_dwordx4 v[108:111], v238, s[4:7], s80 offen sc1
    buffer_load_dwordx4 v[112:115], v238, s[4:7], s81 offen sc1
    v_max_f32_dpp v218, v218, v218 row_ror:8 row_mask:0xf bank_mask:0xf
    v_mov_b32 v219, v218
    buffer_load_dword v116, v239, s[4:7], s80 offen offset:1024 sc1
    buffer_load_dword v117, v239, s[4:7], s81 offen offset:1024 sc1
    v_permlane16_swap_b32 v218, v219
    v_max_f32 v218, v218, v219
    v_mov_b32 v219, v218
    s_add_u32 m0, s73, 0
    s_add_u32 s94, s74, 0
    buffer_load_dwordx4 v234, s[4:7], s94 offen sc1 lds
    v_permlane32_swap_b32 v218, v219
    v_max_f32 v218, v218, v219
    v_mul_f32 v218, s70, v218
    v_fma_f32 v224, v224, s70, -v218
    v_fma_f32 v220, v220, s70, -v218
    v_fma_f32 v221, v221, s70, -v218
    v_fma_f32 v222, v222, s70, -v218
    v_fma_f32 v223, v223, s70, -v218
    v_exp_f32 v224, v224
    v_exp_f32 v220, v220
    v_exp_f32 v221, v221
    v_exp_f32 v222, v222
    v_exp_f32 v223, v223
    v_cvt_pk_bf16_f32 v186, v224, v224
    v_cvt_pk_bf16_f32 v184, v220, v221
    v_and_b32 v186, v231, v186
    v_cvt_pk_bf16_f32 v185, v222, v223
    s_add_u32 m0, s73, 4096
    s_add_u32 s94, s74, 4096
    buffer_load_dwordx4 v234, s[4:7], s94 offen sc1 lds
    v_mfma_f32_16x16x32_bf16 v[202:205], v[180:183], v[184:187], 0
    s_nop 0
    v_mov_b64 v[206:207], 0
    v_mov_b64 v[208:209], 0
    v_mfma_f32_16x16x32_bf16 v[194:197], v[172:175], v[184:187], 0
    s_nop 0
    v_mov_b64 v[210:211], 0
    v_mov_b64 v[212:213], 0
    v_mfma_f32_16x16x32_bf16 v[198:201], v[176:179], v[184:187], 0
    s_nop 2
    s_waitcnt lgkmcnt(4)
    v_mfma_f32_16x16x32_bf16 v[148:151], a[12:15], v[124:127], v[148:151]
    s_nop 0
    ds_read_b128 v[144:147], v233 offset:22528
    v_add_f32_dpp v202, v202, v202 row_ror:8 row_mask:0xf bank_mask:0xf
    v_rcp_f32 v202, v202
    v_add_f32_dpp v194, v198, v194 row_ror:8 row_mask:0xf bank_mask:0xf
    v_add_f32_dpp v195, v199, v195 row_ror:8 row_mask:0xf bank_mask:0xf
    v_add_f32_dpp v196, v200, v196 row_ror:8 row_mask:0xf bank_mask:0xf
    v_add_f32_dpp v197, v201, v197 row_ror:8 row_mask:0xf bank_mask:0xf
    v_pk_mul_f32 v[194:195], v[194:195], v[202:203] op_sel_hi:[1,0]
    v_pk_mul_f32 v[196:197], v[196:197], v[202:203] op_sel_hi:[1,0]
    v_cvt_pk_bf16_f32 v194, v194, v195
    v_cvt_pk_bf16_f32 v195, v196, v197
    v_min_u32 v194, -2, v194
    buffer_store_dwordx2 v[194:195], v247, s[4:7], s72 offen
    v_mfma_f32_16x16x32_bf16 v[156:159], a[92:95], v[124:127], v[156:159]
    s_waitcnt vmcnt(5)
    v_bitop3_b32 v218, v108, v112, s97 bitop3:0x7e
    s_waitcnt vmcnt(3)
    v_bitop3_b32 v219, v116, v117, s97 bitop3:0x7e
    v_bitop3_b32 v218, v218, v219, 1 bitop3:0xa8
    v_cmp_eq_u32 vcc, 1, v218
    s_cbranch_vccnz Lrty_47
Lok_46:
    v_mfma_f32_16x16x32_bf16 v[164:167], v[124:127], a[172:175], v[164:167]
    s_waitcnt lgkmcnt(4)
    v_add_f32 v108, v108, v112
    v_add_f32 v109, v109, v113
    v_mfma_f32_16x16x32_bf16 v[152:155], a[12:15], v[128:131], v[152:155]
    ds_read_b128 v[124:127], v232 offset:3072
    v_add_f32 v110, v110, v114
    v_mfma_f32_16x16x32_bf16 v[160:163], a[92:95], v[128:131], v[160:163]
    v_add_f32 v111, v111, v115
    v_add_f32 v116, v116, v117
    v_mfma_f32_16x16x32_bf16 v[168:171], v[128:131], a[172:175], v[168:171]
    s_waitcnt lgkmcnt(4)
    v_add_f32 v226, v226, v108
    v_add_f32 v227, v227, v109
    v_mfma_f32_16x16x32_bf16 v[148:151], a[16:19], v[132:135], v[148:151]
    ds_read_b128 v[128:131], v232 offset:23552
    v_add_f32 v228, v228, v110
    v_mfma_f32_16x16x32_bf16 v[156:159], a[96:99], v[132:135], v[156:159]
    v_add_f32 v229, v229, v111
    v_add_f32 v230, v230, v116
    v_mfma_f32_16x16x32_bf16 v[164:167], v[132:135], a[176:179], v[164:167]
    s_waitcnt lgkmcnt(4)
    v_max3_f32 v218, v226, v227, v228
    v_max3_f32 v218, v218, v229, v230
    v_mfma_f32_16x16x32_bf16 v[152:155], a[16:19], v[136:139], v[152:155]
    ds_read_b128 v[132:135], v233 offset:3072
    v_max_f32_dpp v218, v218, v218 row_ror:8 row_mask:0xf bank_mask:0xf
    v_mfma_f32_16x16x32_bf16 v[160:163], a[96:99], v[136:139], v[160:163]
    v_mov_b32 v219, v218
    s_nop 0
    v_mfma_f32_16x16x32_bf16 v[168:171], v[136:139], a[176:179], v[168:171]
    s_waitcnt lgkmcnt(4)
    v_permlane16_swap_b32 v218, v219
    v_mfma_f32_16x16x32_bf16 v[148:151], a[20:23], v[140:143], v[148:151]
    ds_read_b128 v[136:139], v233 offset:23552
    v_max_f32 v218, v218, v219
    v_mfma_f32_16x16x32_bf16 v[156:159], a[100:103], v[140:143], v[156:159]
    buffer_load_dwordx4 v[84:87], v248, s[4:7], s85 offen offset:0 sc1
    v_mov_b32 v219, v218
    v_mfma_f32_16x16x32_bf16 v[164:167], v[140:143], a[180:183], v[164:167]
    s_waitcnt lgkmcnt(4)
    v_permlane32_swap_b32 v218, v219
    v_mfma_f32_16x16x32_bf16 v[152:155], a[20:23], v[144:147], v[152:155]
    ds_read_b128 v[140:143], v232 offset:4096
    buffer_load_dwordx4 v[88:91], v248, s[4:7], s85 offen offset:1024 sc1
    v_mfma_f32_16x16x32_bf16 v[160:163], a[100:103], v[144:147], v[160:163]
    v_max_f32 v218, v218, v219
    v_mul_f32 v218, s70, v218
    v_mfma_f32_16x16x32_bf16 v[168:171], v[144:147], a[180:183], v[168:171]
    s_waitcnt lgkmcnt(4)
    buffer_load_dwordx4 v[92:95], v248, s[4:7], s85 offen offset:2048 sc1
    v_fma_f32 v230, v230, s70, -v218
    v_mfma_f32_16x16x32_bf16 v[148:151], a[24:27], v[124:127], v[148:151]
    ds_read_b128 v[144:147], v232 offset:24576
    v_fma_f32 v226, v226, s70, -v218
    v_mfma_f32_16x16x32_bf16 v[156:159], a[104:107], v[124:127], v[156:159]
    buffer_load_dwordx4 v[96:99], v248, s[4:7], s85 offen offset:3072 sc1
    v_fma_f32 v227, v227, s70, -v218
    v_mfma_f32_16x16x32_bf16 v[164:167], v[124:127], a[184:187], v[164:167]
    v_fma_f32 v228, v228, s70, -v218
    v_fma_f32 v229, v229, s70, -v218
    buffer_load_dwordx4 v[100:103], v248, s[4:7], s86 offen offset:0 sc1
    buffer_load_dwordx4 v[104:107], v248, s[4:7], s86 offen offset:1024 sc1
Lwchk_48:
    s_waitcnt vmcnt(5)
    v_max_u32 v194, v84, v86
    s_waitcnt vmcnt(4)
    v_max3_u32 v194, v194, v88, v90
    v_cmp_lt_u32 vcc, s87, v194
    s_cbranch_vccnz Lwrty_49
    v_smfmac_f32_16x16x64_bf16 v[206:209], v[84:87], a[240:247], v187
    v_exp_f32 v230, v230
    v_smfmac_f32_16x16x64_bf16 v[210:213], v[84:87], a[248:255], v187
    v_exp_f32 v226, v226
    v_smfmac_f32_16x16x64_bf16 v[206:209], v[88:91], v[4:11], v187
    v_exp_f32 v227, v227
    v_smfmac_f32_16x16x64_bf16 v[210:213], v[88:91], v[12:19], v187
Lwchk_50:
    s_waitcnt vmcnt(3)
    v_max_u32 v194, v92, v94
    s_waitcnt vmcnt(2)
    v_max3_u32 v194, v194, v96, v98
    v_cmp_lt_u32 vcc, s87, v194
    s_cbranch_vccnz Lwrty_51
    v_smfmac_f32_16x16x64_bf16 v[206:209], v[92:95], v[20:27], v187
    v_exp_f32 v228, v228
    v_smfmac_f32_16x16x64_bf16 v[210:213], v[92:95], v[28:35], v187
    v_exp_f32 v229, v229
    v_smfmac_f32_16x16x64_bf16 v[206:209], v[96:99], v[36:43], v187
    v_cvt_pk_bf16_f32 v200, v230, v230
    v_smfmac_f32_16x16x64_bf16 v[210:213], v[96:99], v[44:51], v187
Lwchk_52:
    s_waitcnt vmcnt(1)
    v_max_u32 v194, v100, v102
    s_waitcnt vmcnt(0)
    v_max3_u32 v194, v194, v104, v106
    v_cmp_lt_u32 vcc, s87, v194
    s_cbranch_vccnz Lwrty_53
    v_smfmac_f32_16x16x64_bf16 v[206:209], v[100:103], v[52:59], v187
    v_cvt_pk_bf16_f32 v198, v226, v227
    v_smfmac_f32_16x16x64_bf16 v[210:213], v[100:103], v[60:67], v187
    v_cvt_pk_bf16_f32 v199, v228, v229
    v_smfmac_f32_16x16x64_bf16 v[206:209], v[104:107], v[68:75], v187
    ds_write_b16 v246, v200 offset:14344
    v_smfmac_f32_16x16x64_bf16 v[210:213], v[104:107], v[76:83], v187
    s_nop 0
    ds_write_b64 v245, v[198:199] offset:14336
    s_waitcnt lgkmcnt(6)
    v_mfma_f32_16x16x32_bf16 v[152:155], a[24:27], v[128:131], v[152:155]
    s_nop 0
    ds_read_b128 v[124:127], v233 offset:4096
    s_nop 0
    v_mfma_f32_16x16x32_bf16 v[160:163], a[104:107], v[128:131], v[160:163]
    v_permlane32_swap_b32 v206, v210
    v_permlane32_swap_b32 v207, v211
    v_permlane32_swap_b32 v208, v212
    v_permlane32_swap_b32 v209, v213
    v_pk_add_f32 v[206:207], v[206:207], v[210:211]
    v_pk_add_f32 v[208:209], v[208:209], v[212:213]
    ds_write2_b32 v249, v206, v207 offset0:0 offset1:32
    ds_write2_b32 v249, v208, v209 offset0:64 offset1:96
    v_mfma_f32_16x16x32_bf16 v[168:171], v[128:131], a[184:187], v[168:171]
    s_waitcnt lgkmcnt(8)
    v_mfma_f32_16x16x32_bf16 v[148:151], a[28:31], v[132:135], v[148:151]
    ds_read_b128 v[128:131], v233 offset:24576
    v_mfma_f32_16x16x32_bf16 v[156:159], a[108:111], v[132:135], v[156:159]
    v_mfma_f32_16x16x32_bf16 v[164:167], v[132:135], a[188:191], v[164:167]
    s_waitcnt lgkmcnt(1)
    s_barrier
    buffer_load_dword v2, v252, s[4:7], 0 offen sc1
    ds_read_b64 v[120:121], v240 offset:16896
    v_mfma_f32_16x16x32_bf16 v[152:155], a[28:31], v[136:139], v[152:155]
    ds_read_b128 v[132:135], v232 offset:5120
    ds_read_b128 v[112:115], v236 offset:14336
    v_mfma_f32_16x16x32_bf16 v[160:163], a[108:111], v[136:139], v[160:163]
    ds_read_b128 v[116:119], v236 offset:15872
    v_mfma_f32_16x16x32_bf16 v[168:171], v[136:139], a[188:191], v[168:171]
    v_mfma_f32_16x16x32_bf16 v[148:151], a[32:35], v[140:143], v[148:151]
    ds_read_b128 v[136:139], v232 offset:25600
    s_waitcnt lgkmcnt(4)
    v_mfma_f32_16x16x16_bf16 v[206:209], v[180:181], v[120:121], 0
    v_mfma_f32_16x16x16_bf16 v[198:201], v[176:177], v[120:121], 0
    s_waitcnt lgkmcnt(2)
    v_mfma_f32_16x16x32_bf16 v[202:205], v[180:183], v[112:115], 0
    buffer_store_dword v192, v247, s[4:7], s96 offen
    v_mfma_f32_16x16x32_bf16 v[194:197], v[172:175], v[112:115], 0
    v_mfma_f32_16x16x32_bf16 v[156:159], a[112:115], v[140:143], v[156:159]
    v_mfma_f32_16x16x32_bf16 v[164:167], v[140:143], a[192:195], v[164:167]
    v_mfma_f32_16x16x32_bf16 v[152:155], a[32:35], v[144:147], v[152:155]
    ds_read_b128 v[140:143], v233 offset:5120
    s_waitcnt lgkmcnt(2)
    v_mfma_f32_16x16x32_bf16 v[206:209], v[180:183], v[116:119], v[206:209]
    v_mfma_f32_16x16x32_bf16 v[198:201], v[172:175], v[116:119], v[198:201]
    v_mfma_f32_16x16x32_bf16 v[160:163], a[112:115], v[144:147], v[160:163]
    v_rcp_f32 v202, v202
    v_mfma_f32_16x16x32_bf16 v[168:171], v[144:147], a[192:195], v[168:171]
    v_mul_f32 v194, v194, v202
    v_mul_f32 v195, v195, v202
    v_mfma_f32_16x16x32_bf16 v[148:151], a[36:39], v[124:127], v[148:151]
    ds_read_b128 v[144:147], v233 offset:25600
    v_mul_f32 v196, v196, v202
    v_mfma_f32_16x16x32_bf16 v[156:159], a[116:119], v[124:127], v[156:159]
    v_mul_f32 v197, v197, v202
    v_cvt_pk_bf16_f32 v210, v194, v195
    v_mfma_f32_16x16x32_bf16 v[164:167], v[124:127], a[196:199], v[164:167]
    v_cvt_pk_bf16_f32 v211, v196, v197
    v_mfma_f32_16x16x32_bf16 v[152:155], a[36:39], v[128:131], v[152:155]
    ds_read_b128 v[124:127], v232 offset:6144
    v_mfma_f32_16x16x32_bf16 v[160:163], a[116:119], v[128:131], v[160:163]
    buffer_store_dwordx2 v[210:211], v243, s[4:7], s75 offen offset:0
    v_rcp_f32 v206, v206
    s_nop 0
    v_mfma_f32_16x16x32_bf16 v[168:171], v[128:131], a[196:199], v[168:171]
    v_mul_f32 v198, v198, v206
    v_mul_f32 v199, v199, v206
    v_mfma_f32_16x16x32_bf16 v[148:151], a[40:43], v[132:135], v[148:151]
    ds_read_b128 v[128:131], v232 offset:26624
    v_mul_f32 v200, v200, v206
    v_mfma_f32_16x16x32_bf16 v[156:159], a[120:123], v[132:135], v[156:159]
    v_mul_f32 v201, v201, v206
    v_cvt_pk_bf16_f32 v212, v198, v199
    v_mfma_f32_16x16x32_bf16 v[164:167], v[132:135], a[200:203], v[164:167]
    s_waitcnt lgkmcnt(4)
    v_cvt_pk_bf16_f32 v213, v200, v201
    v_mfma_f32_16x16x32_bf16 v[152:155], a[40:43], v[136:139], v[152:155]
    ds_read_b128 v[132:135], v233 offset:6144
    v_mfma_f32_16x16x32_bf16 v[160:163], a[120:123], v[136:139], v[160:163]
    buffer_store_dwordx2 v[212:213], v243, s[4:7], s75 offen offset:2048
    s_cmp_eq_u32 s62, 63
    s_cbranch_scc1 L_Clast
    v_mfma_f32_16x16x32_bf16 v[168:171], v[136:139], a[200:203], v[168:171]
    s_waitcnt lgkmcnt(4)
    s_add_u32 s75, s75, 393216
    s_add_u32 s66, s62, 1
    v_mfma_f32_16x16x32_bf16 v[148:151], a[44:47], v[140:143], v[148:151]
    ds_read_b128 v[136:139], v233 offset:26624
    v_mfma_f32_16x16x32_bf16 v[156:159], a[124:127], v[140:143], v[156:159]
    s_and_b32 s66, s66, 7
    s_cselect_b32 s66, 0, 3145728
    s_sub_u32 s75, s75, s66
    v_mfma_f32_16x16x32_bf16 v[164:167], v[140:143], a[204:207], v[164:167]
    s_waitcnt lgkmcnt(4)
    v_mov_b64 v[194:195], 0
    v_mov_b64 v[196:197], 0
    v_mfma_f32_16x16x32_bf16 v[152:155], a[44:47], v[144:147], v[152:155]
    ds_read_b128 v[140:143], v232 offset:7168
    v_mov_b64 v[198:199], 0
    v_mfma_f32_16x16x32_bf16 v[160:163], a[124:127], v[144:147], v[160:163]
    v_mov_b64 v[200:201], 0
    v_mov_b64 v[202:203], 0
    v_mfma_f32_16x16x32_bf16 v[168:171], v[144:147], a[204:207], v[168:171]
    s_waitcnt lgkmcnt(4)
    v_mov_b64 v[204:205], 0
    v_mfma_f32_16x16x32_bf16 v[148:151], a[48:51], v[124:127], v[148:151]
    ds_read_b128 v[144:147], v232 offset:27648
    v_mfma_f32_16x16x32_bf16 v[156:159], a[128:131], v[124:127], v[156:159]
    v_mfma_f32_16x16x32_bf16 v[164:167], v[124:127], a[208:211], v[164:167]
    s_waitcnt lgkmcnt(4)
    v_mfma_f32_16x16x32_bf16 v[152:155], a[48:51], v[128:131], v[152:155]
    ds_read_b128 v[124:127], v233 offset:7168
    v_mfma_f32_16x16x32_bf16 v[160:163], a[128:131], v[128:131], v[160:163]
    v_mfma_f32_16x16x32_bf16 v[168:171], v[128:131], a[208:211], v[168:171]
    s_waitcnt lgkmcnt(4)
    v_mfma_f32_16x16x32_bf16 v[148:151], a[52:55], v[132:135], v[148:151]
    ds_read_b128 v[128:131], v233 offset:27648
    v_mfma_f32_16x16x32_bf16 v[156:159], a[132:135], v[132:135], v[156:159]
    v_add_u32_e64 v218, s62, 1
    v_mfma_f32_16x16x32_bf16 v[164:167], v[132:135], a[212:215], v[164:167]
    s_waitcnt lgkmcnt(4)
    s_waitcnt vmcnt(0)
    buffer_store_dword v218, v1, s[4:7], s3 offen
    v_lshl_add_u32 v3, s62, 1, v225
    v_mfma_f32_16x16x32_bf16 v[152:155], a[52:55], v[136:139], v[152:155]
    ds_read_b128 v[132:135], v232 offset:8192
    v_min_i32 v3, 128, v3
    v_mfma_f32_16x16x32_bf16 v[160:163], a[132:135], v[136:139], v[160:163]
Lfchk_54:
    v_cmp_gt_i32 vcc, v3, v2
    s_cbranch_vccnz Lfrty_55
    v_mfma_f32_16x16x32_bf16 v[168:171], v[136:139], a[212:215], v[168:171]
    s_waitcnt lgkmcnt(4)
    v_mfma_f32_16x16x32_bf16 v[148:151], a[56:59], v[140:143], v[148:151]
    s_add_u32 s82, s72, 178176
    ds_read_b128 v[136:139], v232 offset:28672
    s_add_u32 s83, s72, 182272
    v_mfma_f32_16x16x32_bf16 v[156:159], a[136:139], v[140:143], v[156:159]
    s_add_u32 m0, s73, 8192
    s_add_u32 s94, s74, 16384
    buffer_load_dwordx4 v234, s[4:7], s94 offen sc1 lds
    v_mfma_f32_16x16x32_bf16 v[164:167], v[140:143], a[216:219], v[164:167]
    s_waitcnt lgkmcnt(4)
    v_mfma_f32_16x16x32_bf16 v[152:155], a[56:59], v[144:147], v[152:155]
    ds_read_b128 v[140:143], v233 offset:8192
    s_add_u32 m0, s73, 12288
    s_add_u32 s94, s74, 20480
    buffer_load_dwordx4 v234, s[4:7], s94 offen sc1 lds
    s_add_u32 m0, s73, 16384
    s_add_u32 s94, s74, 32768
    buffer_load_dwordx4 v234, s[4:7], s94 offen sc1 lds
    s_add_u32 m0, s73, 20480
    s_add_u32 s94, s74, 36864
    buffer_load_dwordx4 v234, s[4:7], s94 offen sc1 lds
    s_add_u32 m0, s73, 24576
    s_add_u32 s94, s74, 49152
    buffer_load_dwordx4 v234, s[4:7], s94 offen sc1 lds
    s_add_u32 m0, s73, 28672
    s_add_u32 s94, s74, 53248
    buffer_load_dwordx4 v234, s[4:7], s94 offen sc1 lds
    s_add_u32 m0, s73, 32768
    s_add_u32 s94, s74, 65536
    buffer_load_dwordx4 v234, s[4:7], s94 offen sc1 lds
    s_add_u32 m0, s73, 36864
    s_add_u32 s94, s74, 69632
    buffer_load_dwordx4 v234, s[4:7], s94 offen sc1 lds
    s_barrier
    v_mfma_f32_16x16x32_bf16 v[160:163], a[136:139], v[144:147], v[160:163]
    v_mfma_f32_16x16x32_bf16 v[168:171], v[144:147], a[216:219], v[168:171]
    s_waitcnt lgkmcnt(4)
    v_mfma_f32_16x16x32_bf16 v[148:151], a[60:63], v[124:127], v[148:151]
    ds_read_b128 v[144:147], v233 offset:28672
    v_mfma_f32_16x16x32_bf16 v[156:159], a[140:143], v[124:127], v[156:159]
    v_mfma_f32_16x16x32_bf16 v[164:167], v[124:127], a[220:223], v[164:167]
    s_waitcnt lgkmcnt(4)
    v_mfma_f32_16x16x32_bf16 v[152:155], a[60:63], v[128:131], v[152:155]
    ds_read_b128 v[124:127], v232 offset:9216
    v_mfma_f32_16x16x32_bf16 v[160:163], a[140:143], v[128:131], v[160:163]
    v_mfma_f32_16x16x32_bf16 v[168:171], v[128:131], a[220:223], v[168:171]
    s_waitcnt lgkmcnt(4)
    v_mfma_f32_16x16x32_bf16 v[148:151], a[64:67], v[132:135], v[148:151]
    ds_read_b128 v[128:131], v232 offset:29696
    v_mfma_f32_16x16x32_bf16 v[156:159], a[144:147], v[132:135], v[156:159]
    v_mfma_f32_16x16x32_bf16 v[164:167], v[132:135], a[224:227], v[164:167]
    s_waitcnt lgkmcnt(4)
    v_mfma_f32_16x16x32_bf16 v[152:155], a[64:67], v[136:139], v[152:155]
    s_add_u32 s86, s72, 262144
    ds_read_b128 v[132:135], v233 offset:9216
    buffer_load_dwordx4 v[112:115], v234, s[4:7], s82 offen sc1
    v_mfma_f32_16x16x32_bf16 v[160:163], a[144:147], v[136:139], v[160:163]
    s_and_b32 s86, s86, 786432
    buffer_load_dwordx4 v[116:119], v234, s[4:7], s83 offen sc1
    buffer_load_dwordx2 v[120:121], v235, s[4:7], s82 offen sc1
    v_mfma_f32_16x16x32_bf16 v[168:171], v[136:139], a[224:227], v[168:171]
    s_waitcnt lgkmcnt(4)
    s_andn2_b32 s72, s72, 786432
    s_or_b32 s72, s72, s86
    v_mfma_f32_16x16x32_bf16 v[148:151], a[68:71], v[140:143], v[148:151]
    s_mov_b32 s74, s92
    ds_read_b128 v[136:139], v233 offset:29696
    s_xor_b32 s73, s73, 65536
    v_mfma_f32_16x16x32_bf16 v[156:159], a[148:151], v[140:143], v[156:159]
    s_add_u32 s91, s91, 131072
    s_lshr_b32 s92, s91, 8
    s_xor_b32 s92, s92, s1
    v_mfma_f32_16x16x32_bf16 v[164:167], v[140:143], a[228:231], v[164:167]
    s_waitcnt lgkmcnt(4)
    s_and_b32 s92, s92, s93
    s_or_b32 s92, s92, s91
    v_mfma_f32_16x16x32_bf16 v[152:155], a[68:71], v[144:147], v[152:155]
    v_mfma_f32_16x16x32_bf16 v[160:163], a[148:151], v[144:147], v[160:163]
    buffer_load_dwordx4 v[100:103], v234, s[4:7], s82 offen sc1
    buffer_load_dwordx4 v[104:107], v234, s[4:7], s83 offen sc1
    v_mfma_f32_16x16x32_bf16 v[168:171], v[144:147], a[228:231], v[168:171]
    s_waitcnt lgkmcnt(3)
    buffer_load_dwordx2 v[108:109], v235, s[4:7], s82 offen sc1
    v_mfma_f32_16x16x32_bf16 v[148:151], a[72:75], v[124:127], v[148:151]
    v_mfma_f32_16x16x32_bf16 v[156:159], a[152:155], v[124:127], v[156:159]
    v_mfma_f32_16x16x32_bf16 v[164:167], v[124:127], a[232:235], v[164:167]
    s_add_u32 s62, s62, 1
    s_branch L_Ctop0
Lrty_42:
    buffer_load_dwordx4 v[112:115], v234, s[4:7], s82 offen sc1
    buffer_load_dwordx4 v[116:119], v234, s[4:7], s83 offen sc1
    buffer_load_dwordx2 v[120:121], v235, s[4:7], s82 offen sc1
    s_sub_u32 s61, s61, 1
    s_mov_b32 s67, 15
    s_cbranch_scc1 L_fail
    s_waitcnt vmcnt(4)
    v_max3_u32 v218, v100, v102, v104
    s_waitcnt vmcnt(3)
    v_max3_u32 v218, v218, v106, v108
    v_cmp_eq_u32 vcc, -1, v218
    s_cbranch_vccnz Lrty_43
    ds_write_b128 v234, v[100:103] offset:0
    ds_write_b128 v234, v[104:107] offset:4096
    ds_write_b64 v235, v[108:109] offset:0
    s_branch Lok_41
Lrty_43:
    buffer_load_dwordx4 v[100:103], v234, s[4:7], s82 offen sc1
    buffer_load_dwordx4 v[104:107], v234, s[4:7], s83 offen sc1
    buffer_load_dwordx2 v[108:109], v235, s[4:7], s82 offen sc1
    s_sub_u32 s61, s61, 1
    s_mov_b32 s67, 15
    s_cbranch_scc1 L_fail
    s_waitcnt vmcnt(4)
    v_max3_u32 v218, v112, v114, v116
    s_waitcnt vmcnt(3)
    v_max3_u32 v218, v218, v118, v120
    v_cmp_eq_u32 vcc, -1, v218
    s_cbranch_vccnz Lrty_42
    ds_write_b128 v234, v[112:115] offset:0
    ds_write_b128 v234, v[116:119] offset:4096
    ds_write_b64 v235, v[120:121] offset:0
    s_branch Lok_41
Lrty_45:
    buffer_load_dwordx4 v[84:87], v236, s[4:7], s80 offen sc1
    buffer_load_dwordx4 v[88:91], v236, s[4:7], s81 offen sc1
    buffer_load_dword v92, v237, s[4:7], s80 offen offset:1024 sc1
    buffer_load_dword v93, v237, s[4:7], s81 offen offset:1024 sc1
    s_sub_u32 s61, s61, 1
    s_mov_b32 s67, 11
    s_cbranch_scc1 L_fail
    s_waitcnt vmcnt(2)
    v_bitop3_b32 v218, v84, v88, s97 bitop3:0x7e
    s_waitcnt vmcnt(0)
    v_bitop3_b32 v219, v92, v93, s97 bitop3:0x7e
    v_bitop3_b32 v218, v218, v219, 1 bitop3:0xa8
    v_cmp_eq_u32 vcc, 1, v218
    s_cbranch_vccnz Lrty_45
    v_pk_add_f32 v[84:85], v[84:85], v[88:89]
    v_pk_add_f32 v[86:87], v[86:87], v[90:91]
    v_add_f32 v92, v92, v93
    v_pk_add_f32 v[220:221], v[220:221], v[84:85]
    v_pk_add_f32 v[222:223], v[222:223], v[86:87]
    v_add_f32 v224, v224, v92
    s_branch Lok_44
Lrty_47:
    buffer_load_dwordx4 v[108:111], v238, s[4:7], s80 offen sc1
    buffer_load_dwordx4 v[112:115], v238, s[4:7], s81 offen sc1
    buffer_load_dword v116, v239, s[4:7], s80 offen offset:1024 sc1
    buffer_load_dword v117, v239, s[4:7], s81 offen offset:1024 sc1
    s_sub_u32 s61, s61, 1
    s_mov_b32 s67, 12
    s_cbranch_scc1 L_fail
    s_waitcnt vmcnt(2)
    v_bitop3_b32 v218, v108, v112, s97 bitop3:0x7e
    s_waitcnt vmcnt(0)
    v_bitop3_b32 v219, v116, v117, s97 bitop3:0x7e
    v_bitop3_b32 v218, v218, v219, 1 bitop3:0xa8
    v_cmp_eq_u32 vcc, 1, v218
    s_cbranch_vccnz Lrty_47
    s_branch Lok_46
Lwrty_49:
    buffer_load_dwordx4 v[84:87], v248, s[4:7], s85 offen offset:0 sc1
    buffer_load_dwordx4 v[88:91], v248, s[4:7], s85 offen offset:1024 sc1
    buffer_load_dwordx4 v[92:95], v248, s[4:7], s85 offen offset:2048 sc1
    buffer_load_dwordx4 v[96:99], v248, s[4:7], s85 offen offset:3072 sc1
    buffer_load_dwordx4 v[100:103], v248, s[4:7], s86 offen offset:0 sc1
    buffer_load_dwordx4 v[104:107], v248, s[4:7], s86 offen offset:1024 sc1
    s_sub_u32 s61, s61, 1
    s_mov_b32 s67, 13
    s_cbranch_scc1 L_fail
    s_branch Lwchk_48
Lwrty_51:
    buffer_load_dwordx4 v[92:95], v248, s[4:7], s85 offen offset:2048 sc1
    buffer_load_dwordx4 v[96:99], v248, s[4:7], s85 offen offset:3072 sc1
    buffer_load_dwordx4 v[100:103], v248, s[4:7], s86 offen offset:0 sc1
    buffer_load_dwordx4 v[104:107], v248, s[4:7], s86 offen offset:1024 sc1
    s_sub_u32 s61, s61, 1
    s_mov_b32 s67, 13
    s_cbranch_scc1 L_fail
    s_branch Lwchk_50
Lwrty_53:
    buffer_load_dwordx4 v[100:103], v248, s[4:7], s86 offen offset:0 sc1
    buffer_load_dwordx4 v[104:107], v248, s[4:7], s86 offen offset:1024 sc1
    s_sub_u32 s61, s61, 1
    s_mov_b32 s67, 13
    s_cbranch_scc1 L_fail
    s_branch Lwchk_52
Lfrty_55:
    s_sleep 4
    buffer_load_dword v2, v252, s[4:7], 0 offen sc1
    s_sub_u32 s61, s61, 1
    s_mov_b32 s67, 10
    s_cbranch_scc1 L_fail
    s_waitcnt vmcnt(0)
    s_branch Lfchk_54
L_Clast:
    s_waitcnt vmcnt(0)
    v_mov_b32 v194, 64
    s_mov_b64 exec, 1
    buffer_store_dword v194, off, s[4:7], s3
    s_mov_b64 exec, -1
    s_endpgm
L_roleT:
    s_mov_b32 s24, s42
    s_mov_b32 s25, s43
    s_mov_b32 s26, 7864320
    s_mov_b32 s27, 0x20000
    v_and_b32 v1, 63, v0
    s_and_b32 s75, s59, 1
    s_bfe_u32 s76, s59, 0x10001
    s_lshl_b32 s64, s69, 1
    s_add_u32 s76, s76, s64
    s_mul_i32 s64, s76, 983040
    s_mul_i32 s65, s60, 10240
    s_add_u32 s64, s64, s65
    s_lshl_b32 s65, s75, 8
    s_add_u32 s65, s65, s64
    v_lshrrev_b32 v164, 4, v1
    v_mul_u32_u24 v164, 1280, v164
    v_and_b32 v166, 15, v1
    v_lshl_add_u32 v164, v166, 4, v164
    v_add_u32 v164, s65, v164
    s_lshl_b32 s65, s75, 7
    s_add_u32 s65, s65, s64
    s_add_u32 s65, s65, 1024
    v_lshrrev_b32 v165, 3, v1
    v_mul_u32_u24 v165, 1280, v165
    v_and_b32 v166, 7, v1
    v_lshl_add_u32 v165, v166, 4, v165
    v_add_u32 v165, s65, v165
    v_lshrrev_b32 v166, 4, v1
    v_lshlrev_b32 v166, 3, v166
    v_bfe_u32 v167, v1, 2, 2
    v_add_u32 v166, v166, v167
    v_and_b32 v167, 3, v1
    v_lshlrev_b32 v168, 7, v166
    v_lshl_add_u32 v168, v167, 3, v168
    s_lshl_b32 s64, s60, 5
    v_add_u32 v168, s64, v168
    v_lshlrev_b32 v166, 1, v168
    v_add_u32 v167, 40960, v166
    v_add_u32 v169, 40960, v168
    v_lshlrev_b32 v238, 4, v0
    v_lshlrev_b32 v239, 4, v1
    s_lshl_b32 s64, s60, 14
    s_add_u32 s64, s64, 98304
    v_add_u32 v240, s64, v239
    s_lshl_b32 s70, s60, 11
    s_lshl_b32 s72, s60, 10
    s_mov_b32 s64, 0
    s_add_u32 m0, s70, 0
    s_nop 0
    buffer_load_dwordx4 v164, s[24:27], s64 offen lds
    s_mov_b32 s64, 5120
    s_add_u32 m0, s70, 1024
    s_nop 0
    buffer_load_dwordx4 v164, s[24:27], s64 offen lds
    s_mov_b32 s64, 512
    s_add_u32 m0, s70, 8192
    s_nop 0
    buffer_load_dwordx4 v164, s[24:27], s64 offen lds
    s_mov_b32 s64, 5632
    s_add_u32 m0, s70, 9216
    s_nop 0
    buffer_load_dwordx4 v164, s[24:27], s64 offen lds
    s_mov_b32 s64, 0
    s_add_u32 m0, s72, 16384
    s_nop 0
    buffer_load_dwordx4 v165, s[24:27], s64 offen lds
    s_mov_b32 s64, 40960
    s_add_u32 m0, s70, 20480
    s_nop 0
    buffer_load_dwordx4 v164, s[24:27], s64 offen lds
    s_mov_b32 s64, 46080
    s_add_u32 m0, s70, 21504
    s_nop 0
    buffer_load_dwordx4 v164, s[24:27], s64 offen lds
    s_mov_b32 s64, 41472
    s_add_u32 m0, s70, 28672
    s_nop 0
    buffer_load_dwordx4 v164, s[24:27], s64 offen lds
    s_mov_b32 s64, 46592
    s_add_u32 m0, s70, 29696
    s_nop 0
    buffer_load_dwordx4 v164, s[24:27], s64 offen lds
    s_mov_b32 s64, 40960
    s_add_u32 m0, s72, 36864
    s_nop 0
    buffer_load_dwordx4 v165, s[24:27], s64 offen lds
    s_mov_b32 s64, 81920
    s_add_u32 m0, s70, 40960
    s_nop 0
    buffer_load_dwordx4 v164, s[24:27], s64 offen lds
    s_mov_b32 s64, 87040
    s_add_u32 m0, s70, 41984
    s_nop 0
    buffer_load_dwordx4 v164, s[24:27], s64 offen lds
    s_mov_b32 s64, 82432
    s_add_u32 m0, s70, 49152
    s_nop 0
    buffer_load_dwordx4 v164, s[24:27], s64 offen lds
    s_mov_b32 s64, 87552
    s_add_u32 m0, s70, 50176
    s_nop 0
    buffer_load_dwordx4 v164, s[24:27], s64 offen lds
    s_mov_b32 s64, 81920
    s_add_u32 m0, s72, 57344
    s_nop 0
    buffer_load_dwordx4 v165, s[24:27], s64 offen lds
    s_cmp_lg_u32 s68, 0
    s_cbranch_scc1 Larr0_56
    s_waitcnt vmcnt(15)
    s_barrier
    s_cmp_lg_u32 s60, 0
    s_cbranch_scc1 Lcnt_57
    s_mov_b64 exec, 1
    v_mov_b32 v2, 1
    buffer_atomic_add v2, off, s[8:11], 0 offset:4 sc0
    s_mov_b64 exec, -1
Lcnt_57:
Larr0_56:
    s_waitcnt vmcnt(10)
    s_waitcnt lgkmcnt(0)
    s_barrier
    s_mov_b32 s64, 122880
    s_add_u32 m0, s70, 61440
    s_nop 0
    buffer_load_dwordx4 v164, s[24:27], s64 offen lds
    s_mov_b32 s64, 128000
    s_add_u32 m0, s70, 62464
    s_nop 0
    buffer_load_dwordx4 v164, s[24:27], s64 offen lds
    s_mov_b32 s64, 123392
    s_add_u32 m0, s70, 69632
    s_nop 0
    buffer_load_dwordx4 v164, s[24:27], s64 offen lds
    s_mov_b32 s64, 128512
    s_add_u32 m0, s70, 70656
    s_nop 0
    buffer_load_dwordx4 v164, s[24:27], s64 offen lds
    s_mov_b32 s64, 122880
    s_add_u32 m0, s72, 77824
    s_nop 0
    buffer_load_dwordx4 v165, s[24:27], s64 offen lds
    ds_read_b64_tr_b16 a[0:1], v166 offset:0
    ds_read_b64_tr_b16 a[2:3], v166 offset:1024
    ds_read_b64_tr_b16 a[4:5], v166 offset:8
    ds_read_b64_tr_b16 a[6:7], v166 offset:1032
    ds_read_b64_tr_b16 a[8:9], v166 offset:8192
    ds_read_b64_tr_b16 a[10:11], v166 offset:9216
    ds_read_b64_tr_b16 a[12:13], v166 offset:8200
    ds_read_b64_tr_b16 a[14:15], v166 offset:9224
    ds_read_b64_tr_b16 v[220:221], v168 offset:16384
    ds_read_b64_tr_b16 v[222:223], v168 offset:16896
    s_waitcnt lgkmcnt(0)
    ds_write_b128 v240, v[220:223] offset:0
    s_waitcnt vmcnt(10)
    s_waitcnt lgkmcnt(0)
    s_barrier
    s_mov_b32 s64, 163840
    s_add_u32 m0, s70, 0
    s_nop 0
    buffer_load_dwordx4 v164, s[24:27], s64 offen lds
    s_mov_b32 s64, 168960
    s_add_u32 m0, s70, 1024
    s_nop 0
    buffer_load_dwordx4 v164, s[24:27], s64 offen lds
    s_mov_b32 s64, 164352
    s_add_u32 m0, s70, 8192
    s_nop 0
    buffer_load_dwordx4 v164, s[24:27], s64 offen lds
    s_mov_b32 s64, 169472
    s_add_u32 m0, s70, 9216
    s_nop 0
    buffer_load_dwordx4 v164, s[24:27], s64 offen lds
    s_mov_b32 s64, 163840
    s_add_u32 m0, s72, 16384
    s_nop 0
    buffer_load_dwordx4 v165, s[24:27], s64 offen lds
    ds_read_b64_tr_b16 a[16:17], v166 offset:20480
    ds_read_b64_tr_b16 a[18:19], v166 offset:21504
    ds_read_b64_tr_b16 a[20:21], v166 offset:20488
    ds_read_b64_tr_b16 a[22:23], v166 offset:21512
    ds_read_b64_tr_b16 a[24:25], v166 offset:28672
    ds_read_b64_tr_b16 a[26:27], v166 offset:29696
    ds_read_b64_tr_b16 a[28:29], v166 offset:28680
    ds_read_b64_tr_b16 a[30:31], v166 offset:29704
    ds_read_b64_tr_b16 v[224:225], v168 offset:36864
    ds_read_b64_tr_b16 v[226:227], v168 offset:37376
    s_waitcnt lgkmcnt(0)
    ds_write_b128 v240, v[224:227] offset:1024
    s_waitcnt vmcnt(10)
    s_waitcnt lgkmcnt(0)
    s_barrier
    s_mov_b32 s64, 204800
    s_add_u32 m0, s70, 20480
    s_nop 0
    buffer_load_dwordx4 v164, s[24:27], s64 offen lds
    s_mov_b32 s64, 209920
    s_add_u32 m0, s70, 21504
    s_nop 0
    buffer_load_dwordx4 v164, s[24:27], s64 offen lds
    s_mov_b32 s64, 205312
    s_add_u32 m0, s70, 28672
    s_nop 0
    buffer_load_dwordx4 v164, s[24:27], s64 offen lds
    s_mov_b32 s64, 210432
    s_add_u32 m0, s70, 29696
    s_nop 0
    buffer_load_dwordx4 v164, s[24:27], s64 offen lds
    s_mov_b32 s64, 204800
    s_add_u32 m0, s72, 36864
    s_nop 0
    buffer_load_dwordx4 v165, s[24:27], s64 offen lds
    s_cmp_lg_u32 s68, 0
    s_cbranch_scc1 Larr0_58
    s_cmp_lg_u32 s60, 0
    s_cbranch_scc1 Lcnt_59
    s_mov_b64 exec, 1
    v_mov_b32 v3, 0x80000000
    v_cmp_ne_u32 vcc, 255, v2
    s_nop 1
    v_cndmask_b32 v3, 4, v3, vcc
    buffer_store_dword v2, v3, s[8:11], 0 offen offset:128 sc1
    s_mov_b64 exec, -1
Lcnt_59:
Larr0_58:
    ds_read_b64_tr_b16 a[32:33], v167 offset:0
    ds_read_b64_tr_b16 a[34:35], v167 offset:1024
    ds_read_b64_tr_b16 a[36:37], v167 offset:8
    ds_read_b64_tr_b16 a[38:39], v167 offset:1032
    ds_read_b64_tr_b16 a[40:41], v167 offset:8192
    ds_read_b64_tr_b16 a[42:43], v167 offset:9216
    ds_read_b64_tr_b16 a[44:45], v167 offset:8200
    ds_read_b64_tr_b16 a[46:47], v167 offset:9224
    ds_read_b64_tr_b16 v[228:229], v169 offset:16384
    ds_read_b64_tr_b16 v[230:231], v169 offset:16896
    s_waitcnt lgkmcnt(0)
    ds_write_b128 v240, v[228:231] offset:2048
    s_waitcnt vmcnt(10)
    s_waitcnt lgkmcnt(0)
    s_barrier
    s_mov_b32 s64, 245760
    s_add_u32 m0, s70, 40960
    s_nop 0
    buffer_load_dwordx4 v164, s[24:27], s64 offen lds
    s_mov_b32 s64, 250880
    s_add_u32 m0, s70, 41984
    s_nop 0
    buffer_load_dwordx4 v164, s[24:27], s64 offen lds
    s_mov_b32 s64, 246272
    s_add_u32 m0, s70, 49152
    s_nop 0
    buffer_load_dwordx4 v164, s[24:27], s64 offen lds
    s_mov_b32 s64, 251392
    s_add_u32 m0, s70, 50176
    s_nop 0
    buffer_load_dwordx4 v164, s[24:27], s64 offen lds
    s_mov_b32 s64, 245760
    s_add_u32 m0, s72, 57344
    s_nop 0
    buffer_load_dwordx4 v165, s[24:27], s64 offen lds
    ds_read_b64_tr_b16 a[48:49], v167 offset:20480
    ds_read_b64_tr_b16 a[50:51], v167 offset:21504
    ds_read_b64_tr_b16 a[52:53], v167 offset:20488
    ds_read_b64_tr_b16 a[54:55], v167 offset:21512
    ds_read_b64_tr_b16 a[56:57], v167 offset:28672
    ds_read_b64_tr_b16 a[58:59], v167 offset:29696
    ds_read_b64_tr_b16 a[60:61], v167 offset:28680
    ds_read_b64_tr_b16 a[62:63], v167 offset:29704
    ds_read_b64_tr_b16 v[232:233], v169 offset:36864
    ds_read_b64_tr_b16 v[234:235], v169 offset:37376
    s_waitcnt lgkmcnt(0)
    ds_write_b128 v240, v[232:235] offset:3072
    s_waitcnt vmcnt(10)
    s_waitcnt lgkmcnt(0)
    s_barrier
    s_mov_b32 s64, 286720
    s_add_u32 m0, s70, 61440
    s_nop 0
    buffer_load_dwordx4 v164, s[24:27], s64 offen lds
    s_mov_b32 s64, 291840
    s_add_u32 m0, s70, 62464
    s_nop 0
    buffer_load_dwordx4 v164, s[24:27], s64 offen lds
    s_mov_b32 s64, 287232
    s_add_u32 m0, s70, 69632
    s_nop 0
    buffer_load_dwordx4 v164, s[24:27], s64 offen lds
    s_mov_b32 s64, 292352
    s_add_u32 m0, s70, 70656
    s_nop 0
    buffer_load_dwordx4 v164, s[24:27], s64 offen lds
    s_mov_b32 s64, 286720
    s_add_u32 m0, s72, 77824
    s_nop 0
    buffer_load_dwordx4 v165, s[24:27], s64 offen lds
    ds_read_b64_tr_b16 a[64:65], v166 offset:0
    ds_read_b64_tr_b16 a[66:67], v166 offset:1024
    ds_read_b64_tr_b16 a[68:69], v166 offset:8
    ds_read_b64_tr_b16 a[70:71], v166 offset:1032
    ds_read_b64_tr_b16 a[72:73], v166 offset:8192
    ds_read_b64_tr_b16 a[74:75], v166 offset:9216
    ds_read_b64_tr_b16 a[76:77], v166 offset:8200
    ds_read_b64_tr_b16 a[78:79], v166 offset:9224
    ds_read_b64_tr_b16 v[220:221], v168 offset:16384
    ds_read_b64_tr_b16 v[222:223], v168 offset:16896
    s_waitcnt lgkmcnt(0)
    ds_write_b128 v240, v[220:223] offset:4096
    s_waitcnt vmcnt(10)
    s_waitcnt lgkmcnt(0)
    s_barrier
    s_mov_b32 s64, 327680
    s_add_u32 m0, s70, 0
    s_nop 0
    buffer_load_dwordx4 v164, s[24:27], s64 offen lds
    s_mov_b32 s64, 332800
    s_add_u32 m0, s70, 1024
    s_nop 0
    buffer_load_dwordx4 v164, s[24:27], s64 offen lds
    s_mov_b32 s64, 328192
    s_add_u32 m0, s70, 8192
    s_nop 0
    buffer_load_dwordx4 v164, s[24:27], s64 offen lds
    s_mov_b32 s64, 333312
    s_add_u32 m0, s70, 9216
    s_nop 0
    buffer_load_dwordx4 v164, s[24:27], s64 offen lds
    s_mov_b32 s64, 327680
    s_add_u32 m0, s72, 16384
    s_nop 0
    buffer_load_dwordx4 v165, s[24:27], s64 offen lds
    ds_read_b64_tr_b16 a[80:81], v166 offset:20480
    ds_read_b64_tr_b16 a[82:83], v166 offset:21504
    ds_read_b64_tr_b16 a[84:85], v166 offset:20488
    ds_read_b64_tr_b16 a[86:87], v166 offset:21512
    ds_read_b64_tr_b16 a[88:89], v166 offset:28672
    ds_read_b64_tr_b16 a[90:91], v166 offset:29696
    ds_read_b64_tr_b16 a[92:93], v166 offset:28680
    ds_read_b64_tr_b16 a[94:95], v166 offset:29704
    ds_read_b64_tr_b16 v[224:225], v168 offset:36864
    ds_read_b64_tr_b16 v[226:227], v168 offset:37376
    s_waitcnt lgkmcnt(0)
    ds_write_b128 v240, v[224:227] offset:5120
    s_waitcnt vmcnt(10)
    s_waitcnt lgkmcnt(0)
    s_barrier
    s_mov_b32 s64, 368640
    s_add_u32 m0, s70, 20480
    s_nop 0
    buffer_load_dwordx4 v164, s[24:27], s64 offen lds
    s_mov_b32 s64, 373760
    s_add_u32 m0, s70, 21504
    s_nop 0
    buffer_load_dwordx4 v164, s[24:27], s64 offen lds
    s_mov_b32 s64, 369152
    s_add_u32 m0, s70, 28672
    s_nop 0
    buffer_load_dwordx4 v164, s[24:27], s64 offen lds
    s_mov_b32 s64, 374272
    s_add_u32 m0, s70, 29696
    s_nop 0
    buffer_load_dwordx4 v164, s[24:27], s64 offen lds
    s_mov_b32 s64, 368640
    s_add_u32 m0, s72, 36864
    s_nop 0
    buffer_load_dwordx4 v165, s[24:27], s64 offen lds
    ds_read_b64_tr_b16 a[96:97], v167 offset:0
    ds_read_b64_tr_b16 a[98:99], v167 offset:1024
    ds_read_b64_tr_b16 a[100:101], v167 offset:8
    ds_read_b64_tr_b16 a[102:103], v167 offset:1032
    ds_read_b64_tr_b16 a[104:105], v167 offset:8192
    ds_read_b64_tr_b16 a[106:107], v167 offset:9216
    ds_read_b64_tr_b16 a[108:109], v167 offset:8200
    ds_read_b64_tr_b16 a[110:111], v167 offset:9224
    ds_read_b64_tr_b16 v[228:229], v169 offset:16384
    ds_read_b64_tr_b16 v[230:231], v169 offset:16896
    s_waitcnt lgkmcnt(0)
    ds_write_b128 v240, v[228:231] offset:6144
    s_waitcnt vmcnt(10)
    s_waitcnt lgkmcnt(0)
    s_barrier
    s_mov_b32 s64, 409600
    s_add_u32 m0, s70, 40960
    s_nop 0
    buffer_load_dwordx4 v164, s[24:27], s64 offen lds
    s_mov_b32 s64, 414720
    s_add_u32 m0, s70, 41984
    s_nop 0
    buffer_load_dwordx4 v164, s[24:27], s64 offen lds
    s_mov_b32 s64, 410112
    s_add_u32 m0, s70, 49152
    s_nop 0
    buffer_load_dwordx4 v164, s[24:27], s64 offen lds
    s_mov_b32 s64, 415232
    s_add_u32 m0, s70, 50176
    s_nop 0
    buffer_load_dwordx4 v164, s[24:27], s64 offen lds
    s_mov_b32 s64, 409600
    s_add_u32 m0, s72, 57344
    s_nop 0
    buffer_load_dwordx4 v165, s[24:27], s64 offen lds
    ds_read_b64_tr_b16 a[112:113], v167 offset:20480
    ds_read_b64_tr_b16 a[114:115], v167 offset:21504
    ds_read_b64_tr_b16 a[116:117], v167 offset:20488
    ds_read_b64_tr_b16 a[118:119], v167 offset:21512
    ds_read_b64_tr_b16 a[120:121], v167 offset:28672
    ds_read_b64_tr_b16 a[122:123], v167 offset:29696
    ds_read_b64_tr_b16 a[124:125], v167 offset:28680
    ds_read_b64_tr_b16 a[126:127], v167 offset:29704
    ds_read_b64_tr_b16 v[232:233], v169 offset:36864
    ds_read_b64_tr_b16 v[234:235], v169 offset:37376
    s_waitcnt lgkmcnt(0)
    ds_write_b128 v240, v[232:235] offset:7168
    s_waitcnt vmcnt(10)
    s_waitcnt lgkmcnt(0)
    s_barrier
    s_mov_b32 s64, 450560
    s_add_u32 m0, s70, 61440
    s_nop 0
    buffer_load_dwordx4 v164, s[24:27], s64 offen lds
    s_mov_b32 s64, 455680
    s_add_u32 m0, s70, 62464
    s_nop 0
    buffer_load_dwordx4 v164, s[24:27], s64 offen lds
    s_mov_b32 s64, 451072
    s_add_u32 m0, s70, 69632
    s_nop 0
    buffer_load_dwordx4 v164, s[24:27], s64 offen lds
    s_mov_b32 s64, 456192
    s_add_u32 m0, s70, 70656
    s_nop 0
    buffer_load_dwordx4 v164, s[24:27], s64 offen lds
    s_mov_b32 s64, 450560
    s_add_u32 m0, s72, 77824
    s_nop 0
    buffer_load_dwordx4 v165, s[24:27], s64 offen lds
    ds_read_b64_tr_b16 a[128:129], v166 offset:0
    ds_read_b64_tr_b16 a[130:131], v166 offset:1024
    ds_read_b64_tr_b16 a[132:133], v166 offset:8
    ds_read_b64_tr_b16 a[134:135], v166 offset:1032
    ds_read_b64_tr_b16 a[136:137], v166 offset:8192
    ds_read_b64_tr_b16 a[138:139], v166 offset:9216
    ds_read_b64_tr_b16 a[140:141], v166 offset:8200
    ds_read_b64_tr_b16 a[142:143], v166 offset:9224
    ds_read_b64_tr_b16 v[220:221], v168 offset:16384
    ds_read_b64_tr_b16 v[222:223], v168 offset:16896
    s_waitcnt lgkmcnt(0)
    ds_write_b128 v240, v[220:223] offset:8192
    s_waitcnt vmcnt(10)
    s_waitcnt lgkmcnt(0)
    s_barrier
    s_mov_b32 s64, 491520
    s_add_u32 m0, s70, 0
    s_nop 0
    buffer_load_dwordx4 v164, s[24:27], s64 offen lds
    s_mov_b32 s64, 496640
    s_add_u32 m0, s70, 1024
    s_nop 0
    buffer_load_dwordx4 v164, s[24:27], s64 offen lds
    s_mov_b32 s64, 492032
    s_add_u32 m0, s70, 8192
    s_nop 0
    buffer_load_dwordx4 v164, s[24:27], s64 offen lds
    s_mov_b32 s64, 497152
    s_add_u32 m0, s70, 9216
    s_nop 0
    buffer_load_dwordx4 v164, s[24:27], s64 offen lds
    s_mov_b32 s64, 491520
    s_add_u32 m0, s72, 16384
    s_nop 0
    buffer_load_dwordx4 v165, s[24:27], s64 offen lds
    ds_read_b64_tr_b16 a[144:145], v166 offset:20480
    ds_read_b64_tr_b16 a[146:147], v166 offset:21504
    ds_read_b64_tr_b16 a[148:149], v166 offset:20488
    ds_read_b64_tr_b16 a[150:151], v166 offset:21512
    ds_read_b64_tr_b16 a[152:153], v166 offset:28672
    ds_read_b64_tr_b16 a[154:155], v166 offset:29696
    ds_read_b64_tr_b16 a[156:157], v166 offset:28680
    ds_read_b64_tr_b16 a[158:159], v166 offset:29704
    ds_read_b64_tr_b16 v[224:225], v168 offset:36864
    ds_read_b64_tr_b16 v[226:227], v168 offset:37376
    s_waitcnt lgkmcnt(0)
    ds_write_b128 v240, v[224:227] offset:9216
    s_waitcnt vmcnt(10)
    s_waitcnt lgkmcnt(0)
    s_barrier
    s_mov_b32 s64, 532480
    s_add_u32 m0, s70, 20480
    s_nop 0
    buffer_load_dwordx4 v164, s[24:27], s64 offen lds
    s_mov_b32 s64, 537600
    s_add_u32 m0, s70, 21504
    s_nop 0
    buffer_load_dwordx4 v164, s[24:27], s64 offen lds
    s_mov_b32 s64, 532992
    s_add_u32 m0, s70, 28672
    s_nop 0
    buffer_load_dwordx4 v164, s[24:27], s64 offen lds
    s_mov_b32 s64, 538112
    s_add_u32 m0, s70, 29696
    s_nop 0
    buffer_load_dwordx4 v164, s[24:27], s64 offen lds
    s_mov_b32 s64, 532480
    s_add_u32 m0, s72, 36864
    s_nop 0
    buffer_load_dwordx4 v165, s[24:27], s64 offen lds
    ds_read_b64_tr_b16 a[160:161], v167 offset:0
    ds_read_b64_tr_b16 a[162:163], v167 offset:1024
    ds_read_b64_tr_b16 a[164:165], v167 offset:8
    ds_read_b64_tr_b16 a[166:167], v167 offset:1032
    ds_read_b64_tr_b16 a[168:169], v167 offset:8192
    ds_read_b64_tr_b16 a[170:171], v167 offset:9216
    ds_read_b64_tr_b16 a[172:173], v167 offset:8200
    ds_read_b64_tr_b16 a[174:175], v167 offset:9224
    ds_read_b64_tr_b16 v[228:229], v169 offset:16384
    ds_read_b64_tr_b16 v[230:231], v169 offset:16896
    s_waitcnt lgkmcnt(0)
    ds_write_b128 v240, v[228:231] offset:10240
    s_waitcnt vmcnt(10)
    s_waitcnt lgkmcnt(0)
    s_barrier
    s_mov_b32 s64, 573440
    s_add_u32 m0, s70, 40960
    s_nop 0
    buffer_load_dwordx4 v164, s[24:27], s64 offen lds
    s_mov_b32 s64, 578560
    s_add_u32 m0, s70, 41984
    s_nop 0
    buffer_load_dwordx4 v164, s[24:27], s64 offen lds
    s_mov_b32 s64, 573952
    s_add_u32 m0, s70, 49152
    s_nop 0
    buffer_load_dwordx4 v164, s[24:27], s64 offen lds
    s_mov_b32 s64, 579072
    s_add_u32 m0, s70, 50176
    s_nop 0
    buffer_load_dwordx4 v164, s[24:27], s64 offen lds
    s_mov_b32 s64, 573440
    s_add_u32 m0, s72, 57344
    s_nop 0
    buffer_load_dwordx4 v165, s[24:27], s64 offen lds
    ds_read_b64_tr_b16 a[176:177], v167 offset:20480
    ds_read_b64_tr_b16 a[178:179], v167 offset:21504
    ds_read_b64_tr_b16 a[180:181], v167 offset:20488
    ds_read_b64_tr_b16 a[182:183], v167 offset:21512
    ds_read_b64_tr_b16 a[184:185], v167 offset:28672
    ds_read_b64_tr_b16 a[186:187], v167 offset:29696
    ds_read_b64_tr_b16 a[188:189], v167 offset:28680
    ds_read_b64_tr_b16 a[190:191], v167 offset:29704
    ds_read_b64_tr_b16 v[232:233], v169 offset:36864
    ds_read_b64_tr_b16 v[234:235], v169 offset:37376
    s_waitcnt lgkmcnt(0)
    ds_write_b128 v240, v[232:235] offset:11264
    s_waitcnt vmcnt(10)
    s_waitcnt lgkmcnt(0)
    s_barrier
    s_mov_b32 s64, 614400
    s_add_u32 m0, s70, 61440
    s_nop 0
    buffer_load_dwordx4 v164, s[24:27], s64 offen lds
    s_mov_b32 s64, 619520
    s_add_u32 m0, s70, 62464
    s_nop 0
    buffer_load_dwordx4 v164, s[24:27], s64 offen lds
    s_mov_b32 s64, 614912
    s_add_u32 m0, s70, 69632
    s_nop 0
    buffer_load_dwordx4 v164, s[24:27], s64 offen lds
    s_mov_b32 s64, 620032
    s_add_u32 m0, s70, 70656
    s_nop 0
    buffer_load_dwordx4 v164, s[24:27], s64 offen lds
    s_mov_b32 s64, 614400
    s_add_u32 m0, s72, 77824
    s_nop 0
    buffer_load_dwordx4 v165, s[24:27], s64 offen lds
    ds_read_b64_tr_b16 a[192:193], v166 offset:0
    ds_read_b64_tr_b16 a[194:195], v166 offset:1024
    ds_read_b64_tr_b16 a[196:197], v166 offset:8
    ds_read_b64_tr_b16 a[198:199], v166 offset:1032
    ds_read_b64_tr_b16 a[200:201], v166 offset:8192
    ds_read_b64_tr_b16 a[202:203], v166 offset:9216
    ds_read_b64_tr_b16 a[204:205], v166 offset:8200
    ds_read_b64_tr_b16 a[206:207], v166 offset:9224
    ds_read_b64_tr_b16 v[220:221], v168 offset:16384
    ds_read_b64_tr_b16 v[222:223], v168 offset:16896
    s_waitcnt lgkmcnt(0)
    ds_write_b128 v240, v[220:223] offset:12288
    s_waitcnt vmcnt(10)
    s_waitcnt lgkmcnt(0)
    s_barrier
    s_mov_b32 s64, 655360
    s_add_u32 m0, s70, 0
    s_nop 0
    buffer_load_dwordx4 v164, s[24:27], s64 offen lds
    s_mov_b32 s64, 660480
    s_add_u32 m0, s70, 1024
    s_nop 0
    buffer_load_dwordx4 v164, s[24:27], s64 offen lds
    s_mov_b32 s64, 655872
    s_add_u32 m0, s70, 8192
    s_nop 0
    buffer_load_dwordx4 v164, s[24:27], s64 offen lds
    s_mov_b32 s64, 660992
    s_add_u32 m0, s70, 9216
    s_nop 0
    buffer_load_dwordx4 v164, s[24:27], s64 offen lds
    s_mov_b32 s64, 655360
    s_add_u32 m0, s72, 16384
    s_nop 0
    buffer_load_dwordx4 v165, s[24:27], s64 offen lds
    ds_read_b64_tr_b16 a[208:209], v166 offset:20480
    ds_read_b64_tr_b16 a[210:211], v166 offset:21504
    ds_read_b64_tr_b16 a[212:213], v166 offset:20488
    ds_read_b64_tr_b16 a[214:215], v166 offset:21512
    ds_read_b64_tr_b16 a[216:217], v166 offset:28672
    ds_read_b64_tr_b16 a[218:219], v166 offset:29696
    ds_read_b64_tr_b16 a[220:221], v166 offset:28680
    ds_read_b64_tr_b16 a[222:223], v166 offset:29704
    ds_read_b64_tr_b16 v[224:225], v168 offset:36864
    ds_read_b64_tr_b16 v[226:227], v168 offset:37376
    s_waitcnt lgkmcnt(0)
    ds_write_b128 v240, v[224:227] offset:13312
    s_waitcnt vmcnt(10)
    s_waitcnt lgkmcnt(0)
    s_barrier
    s_mov_b32 s64, 696320
    s_add_u32 m0, s70, 20480
    s_nop 0
    buffer_load_dwordx4 v164, s[24:27], s64 offen lds
    s_mov_b32 s64, 701440
    s_add_u32 m0, s70, 21504
    s_nop 0
    buffer_load_dwordx4 v164, s[24:27], s64 offen lds
    s_mov_b32 s64, 696832
    s_add_u32 m0, s70, 28672
    s_nop 0
    buffer_load_dwordx4 v164, s[24:27], s64 offen lds
    s_mov_b32 s64, 701952
    s_add_u32 m0, s70, 29696
    s_nop 0
    buffer_load_dwordx4 v164, s[24:27], s64 offen lds
    s_mov_b32 s64, 696320
    s_add_u32 m0, s72, 36864
    s_nop 0
    buffer_load_dwordx4 v165, s[24:27], s64 offen lds
    ds_read_b64_tr_b16 a[224:225], v167 offset:0
    ds_read_b64_tr_b16 a[226:227], v167 offset:1024
    ds_read_b64_tr_b16 a[228:229], v167 offset:8
    ds_read_b64_tr_b16 a[230:231], v167 offset:1032
    ds_read_b64_tr_b16 a[232:233], v167 offset:8192
    ds_read_b64_tr_b16 a[234:235], v167 offset:9216
    ds_read_b64_tr_b16 a[236:237], v167 offset:8200
    ds_read_b64_tr_b16 a[238:239], v167 offset:9224
    ds_read_b64_tr_b16 v[228:229], v169 offset:16384
    ds_read_b64_tr_b16 v[230:231], v169 offset:16896
    s_waitcnt lgkmcnt(0)
    ds_write_b128 v240, v[228:231] offset:14336
    s_waitcnt vmcnt(10)
    s_waitcnt lgkmcnt(0)
    s_barrier
    s_mov_b32 s64, 737280
    s_add_u32 m0, s70, 40960
    s_nop 0
    buffer_load_dwordx4 v164, s[24:27], s64 offen lds
    s_mov_b32 s64, 742400
    s_add_u32 m0, s70, 41984
    s_nop 0
    buffer_load_dwordx4 v164, s[24:27], s64 offen lds
    s_mov_b32 s64, 737792
    s_add_u32 m0, s70, 49152
    s_nop 0
    buffer_load_dwordx4 v164, s[24:27], s64 offen lds
    s_mov_b32 s64, 742912
    s_add_u32 m0, s70, 50176
    s_nop 0
    buffer_load_dwordx4 v164, s[24:27], s64 offen lds
    s_mov_b32 s64, 737280
    s_add_u32 m0, s72, 57344
    s_nop 0
    buffer_load_dwordx4 v165, s[24:27], s64 offen lds
    ds_read_b64_tr_b16 a[240:241], v167 offset:20480
    ds_read_b64_tr_b16 a[242:243], v167 offset:21504
    ds_read_b64_tr_b16 a[244:245], v167 offset:20488
    ds_read_b64_tr_b16 a[246:247], v167 offset:21512
    ds_read_b64_tr_b16 a[248:249], v167 offset:28672
    ds_read_b64_tr_b16 a[250:251], v167 offset:29696
    ds_read_b64_tr_b16 a[252:253], v167 offset:28680
    ds_read_b64_tr_b16 a[254:255], v167 offset:29704
    ds_read_b64_tr_b16 v[232:233], v169 offset:36864
    ds_read_b64_tr_b16 v[234:235], v169 offset:37376
    s_waitcnt lgkmcnt(0)
    ds_write_b128 v240, v[232:235] offset:15360
    s_waitcnt vmcnt(10)
    s_waitcnt lgkmcnt(0)
    s_barrier
    s_mov_b32 s64, 778240
    s_add_u32 m0, s70, 61440
    s_nop 0
    buffer_load_dwordx4 v164, s[24:27], s64 offen lds
    s_mov_b32 s64, 783360
    s_add_u32 m0, s70, 62464
    s_nop 0
    buffer_load_dwordx4 v164, s[24:27], s64 offen lds
    s_mov_b32 s64, 778752
    s_add_u32 m0, s70, 69632
    s_nop 0
    buffer_load_dwordx4 v164, s[24:27], s64 offen lds
    s_mov_b32 s64, 783872
    s_add_u32 m0, s70, 70656
    s_nop 0
    buffer_load_dwordx4 v164, s[24:27], s64 offen lds
    s_mov_b32 s64, 778240
    s_add_u32 m0, s72, 77824
    s_nop 0
    buffer_load_dwordx4 v165, s[24:27], s64 offen lds
    ds_read_b64_tr_b16 v[4:5], v166 offset:0
    ds_read_b64_tr_b16 v[6:7], v166 offset:1024
    ds_read_b64_tr_b16 v[8:9], v166 offset:8
    ds_read_b64_tr_b16 v[10:11], v166 offset:1032
    ds_read_b64_tr_b16 v[12:13], v166 offset:8192
    ds_read_b64_tr_b16 v[14:15], v166 offset:9216
    ds_read_b64_tr_b16 v[16:17], v166 offset:8200
    ds_read_b64_tr_b16 v[18:19], v166 offset:9224
    ds_read_b64_tr_b16 v[132:133], v168 offset:16384
    ds_read_b64_tr_b16 v[134:135], v168 offset:16896
    s_waitcnt vmcnt(10)
    s_waitcnt lgkmcnt(0)
    s_barrier
    s_mov_b32 s64, 819200
    s_add_u32 m0, s70, 0
    s_nop 0
    buffer_load_dwordx4 v164, s[24:27], s64 offen lds
    s_mov_b32 s64, 824320
    s_add_u32 m0, s70, 1024
    s_nop 0
    buffer_load_dwordx4 v164, s[24:27], s64 offen lds
    s_mov_b32 s64, 819712
    s_add_u32 m0, s70, 8192
    s_nop 0
    buffer_load_dwordx4 v164, s[24:27], s64 offen lds
    s_mov_b32 s64, 824832
    s_add_u32 m0, s70, 9216
    s_nop 0
    buffer_load_dwordx4 v164, s[24:27], s64 offen lds
    s_mov_b32 s64, 819200
    s_add_u32 m0, s72, 16384
    s_nop 0
    buffer_load_dwordx4 v165, s[24:27], s64 offen lds
    ds_read_b64_tr_b16 v[20:21], v166 offset:20480
    ds_read_b64_tr_b16 v[22:23], v166 offset:21504
    ds_read_b64_tr_b16 v[24:25], v166 offset:20488
    ds_read_b64_tr_b16 v[26:27], v166 offset:21512
    ds_read_b64_tr_b16 v[28:29], v166 offset:28672
    ds_read_b64_tr_b16 v[30:31], v166 offset:29696
    ds_read_b64_tr_b16 v[32:33], v166 offset:28680
    ds_read_b64_tr_b16 v[34:35], v166 offset:29704
    ds_read_b64_tr_b16 v[136:137], v168 offset:36864
    ds_read_b64_tr_b16 v[138:139], v168 offset:37376
    s_waitcnt vmcnt(10)
    s_waitcnt lgkmcnt(0)
    s_barrier
    s_mov_b32 s64, 860160
    s_add_u32 m0, s70, 20480
    s_nop 0
    buffer_load_dwordx4 v164, s[24:27], s64 offen lds
    s_mov_b32 s64, 865280
    s_add_u32 m0, s70, 21504
    s_nop 0
    buffer_load_dwordx4 v164, s[24:27], s64 offen lds
    s_mov_b32 s64, 860672
    s_add_u32 m0, s70, 28672
    s_nop 0
    buffer_load_dwordx4 v164, s[24:27], s64 offen lds
    s_mov_b32 s64, 865792
    s_add_u32 m0, s70, 29696
    s_nop 0
    buffer_load_dwordx4 v164, s[24:27], s64 offen lds
    s_mov_b32 s64, 860160
    s_add_u32 m0, s72, 36864
    s_nop 0
    buffer_load_dwordx4 v165, s[24:27], s64 offen lds
    ds_read_b64_tr_b16 v[36:37], v167 offset:0
    ds_read_b64_tr_b16 v[38:39], v167 offset:1024
    ds_read_b64_tr_b16 v[40:41], v167 offset:8
    ds_read_b64_tr_b16 v[42:43], v167 offset:1032
    ds_read_b64_tr_b16 v[44:45], v167 offset:8192
    ds_read_b64_tr_b16 v[46:47], v167 offset:9216
    ds_read_b64_tr_b16 v[48:49], v167 offset:8200
    ds_read_b64_tr_b16 v[50:51], v167 offset:9224
    ds_read_b64_tr_b16 v[140:141], v169 offset:16384
    ds_read_b64_tr_b16 v[142:143], v169 offset:16896
    s_waitcnt vmcnt(10)
    s_waitcnt lgkmcnt(0)
    s_barrier
    s_mov_b32 s64, 901120
    s_add_u32 m0, s70, 40960
    s_nop 0
    buffer_load_dwordx4 v164, s[24:27], s64 offen lds
    s_mov_b32 s64, 906240
    s_add_u32 m0, s70, 41984
    s_nop 0
    buffer_load_dwordx4 v164, s[24:27], s64 offen lds
    s_mov_b32 s64, 901632
    s_add_u32 m0, s70, 49152
    s_nop 0
    buffer_load_dwordx4 v164, s[24:27], s64 offen lds
    s_mov_b32 s64, 906752
    s_add_u32 m0, s70, 50176
    s_nop 0
    buffer_load_dwordx4 v164, s[24:27], s64 offen lds
    s_mov_b32 s64, 901120
    s_add_u32 m0, s72, 57344
    s_nop 0
    buffer_load_dwordx4 v165, s[24:27], s64 offen lds
    ds_read_b64_tr_b16 v[52:53], v167 offset:20480
    ds_read_b64_tr_b16 v[54:55], v167 offset:21504
    ds_read_b64_tr_b16 v[56:57], v167 offset:20488
    ds_read_b64_tr_b16 v[58:59], v167 offset:21512
    ds_read_b64_tr_b16 v[60:61], v167 offset:28672
    ds_read_b64_tr_b16 v[62:63], v167 offset:29696
    ds_read_b64_tr_b16 v[64:65], v167 offset:28680
    ds_read_b64_tr_b16 v[66:67], v167 offset:29704
    ds_read_b64_tr_b16 v[144:145], v169 offset:36864
    ds_read_b64_tr_b16 v[146:147], v169 offset:37376
    s_waitcnt vmcnt(10)
    s_waitcnt lgkmcnt(0)
    s_barrier
    s_mov_b32 s64, 942080
    s_add_u32 m0, s70, 61440
    s_nop 0
    buffer_load_dwordx4 v164, s[24:27], s64 offen lds
    s_mov_b32 s64, 947200
    s_add_u32 m0, s70, 62464
    s_nop 0
    buffer_load_dwordx4 v164, s[24:27], s64 offen lds
    s_mov_b32 s64, 942592
    s_add_u32 m0, s70, 69632
    s_nop 0
    buffer_load_dwordx4 v164, s[24:27], s64 offen lds
    s_mov_b32 s64, 947712
    s_add_u32 m0, s70, 70656
    s_nop 0
    buffer_load_dwordx4 v164, s[24:27], s64 offen lds
    s_mov_b32 s64, 942080
    s_add_u32 m0, s72, 77824
    s_nop 0
    buffer_load_dwordx4 v165, s[24:27], s64 offen lds
    ds_read_b64_tr_b16 v[68:69], v166 offset:0
    ds_read_b64_tr_b16 v[70:71], v166 offset:1024
    ds_read_b64_tr_b16 v[72:73], v166 offset:8
    ds_read_b64_tr_b16 v[74:75], v166 offset:1032
    ds_read_b64_tr_b16 v[76:77], v166 offset:8192
    ds_read_b64_tr_b16 v[78:79], v166 offset:9216
    ds_read_b64_tr_b16 v[80:81], v166 offset:8200
    ds_read_b64_tr_b16 v[82:83], v166 offset:9224
    ds_read_b64_tr_b16 v[148:149], v168 offset:16384
    ds_read_b64_tr_b16 v[150:151], v168 offset:16896
    s_waitcnt vmcnt(10)
    s_waitcnt lgkmcnt(0)
    s_barrier
    ds_read_b64_tr_b16 v[84:85], v166 offset:20480
    ds_read_b64_tr_b16 v[86:87], v166 offset:21504
    ds_read_b64_tr_b16 v[88:89], v166 offset:20488
    ds_read_b64_tr_b16 v[90:91], v166 offset:21512
    ds_read_b64_tr_b16 v[92:93], v166 offset:28672
    ds_read_b64_tr_b16 v[94:95], v166 offset:29696
    ds_read_b64_tr_b16 v[96:97], v166 offset:28680
    ds_read_b64_tr_b16 v[98:99], v166 offset:29704
    ds_read_b64_tr_b16 v[152:153], v168 offset:36864
    ds_read_b64_tr_b16 v[154:155], v168 offset:37376
    s_waitcnt vmcnt(5)
    s_waitcnt lgkmcnt(0)
    s_barrier
    ds_read_b64_tr_b16 v[100:101], v167 offset:0
    ds_read_b64_tr_b16 v[102:103], v167 offset:1024
    ds_read_b64_tr_b16 v[104:105], v167 offset:8
    ds_read_b64_tr_b16 v[106:107], v167 offset:1032
    ds_read_b64_tr_b16 v[108:109], v167 offset:8192
    ds_read_b64_tr_b16 v[110:111], v167 offset:9216
    ds_read_b64_tr_b16 v[112:113], v167 offset:8200
    ds_read_b64_tr_b16 v[114:115], v167 offset:9224
    ds_read_b64_tr_b16 v[156:157], v169 offset:16384
    ds_read_b64_tr_b16 v[158:159], v169 offset:16896
    s_waitcnt vmcnt(0)
    s_waitcnt lgkmcnt(0)
    s_barrier
    ds_read_b64_tr_b16 v[116:117], v167 offset:20480
    ds_read_b64_tr_b16 v[118:119], v167 offset:21504
    ds_read_b64_tr_b16 v[120:121], v167 offset:20488
    ds_read_b64_tr_b16 v[122:123], v167 offset:21512
    ds_read_b64_tr_b16 v[124:125], v167 offset:28672
    ds_read_b64_tr_b16 v[126:127], v167 offset:29696
    ds_read_b64_tr_b16 v[128:129], v167 offset:28680
    ds_read_b64_tr_b16 v[130:131], v167 offset:29704
    ds_read_b64_tr_b16 v[160:161], v169 offset:36864
    ds_read_b64_tr_b16 v[162:163], v169 offset:37376
    v_and_b32 v164, 15, v1
    v_lshrrev_b32 v165, 4, v1
    v_lshlrev_b32 v242, 5, v164
    v_lshl_add_u32 v242, v165, 3, v242
    v_lshlrev_b32 v241, 1, v242
    s_lshl_b32 s64, s75, 2
    s_add_u32 s64, s64, s60
    s_lshl_b32 s64, s64, 10
    v_add_u32 v241, s64, v241
    s_add_u32 s64, s64, 65536
    v_add_u32 v242, s64, v242
    v_min_u32 v243, 47, v1
    s_and_b32 s64, s76, 1
    s_mul_i32 s64, s64, 48
    s_lshl_b32 s65, s58, 7
    s_add_u32 s64, s64, s65
    v_add_u32 v243, s64, v243
    v_lshlrev_b32 v243, 7, v243
    v_add_u32 v243, 8388608, v243
    s_mul_i32 s70, s76, 49152
    s_mul_i32 s64, s68, 6291456
    s_add_u32 s70, s70, s64
    s_add_u32 s70, s70, 60817408
    s_mul_i32 s71, s76, 81920
    s_add_u32 s71, s71, 75497472
    s_lshr_b32 s73, s60, 1
    s_lshl_b32 s73, s73, 12
    s_and_b32 s64, s60, 1
    s_lshl_b32 s64, s64, 10
    s_add_u32 s73, s73, s64
    v_add_u32 v238, s73, v239
    s_mov_b32 s74, 0
    s_cmp_lg_u32 s60, 0
    s_cbranch_scc1 Lgskip_62
    buffer_load_dword v2, off, s[8:11], 0 offset:132 sc1
Lgchk_60:
    s_waitcnt vmcnt(0)
    v_cmp_eq_u32 vcc, 0, v2
    s_cbranch_vccnz Lgrty_61
Lgskip_62:
    s_waitcnt lgkmcnt(0)
    s_barrier
    buffer_load_dword v2, off, s[8:11], 0 offset:140 sc1
Lpchk_63:
    s_waitcnt vmcnt(0)
    v_cmp_eq_u32 vcc, 0, v2
    s_cbranch_vccnz Lprty_64
    v_readfirstlane_b32 s1, v2
    s_cmp_gt_u32 s1, 17
    s_cselect_b32 s1, 1, 0
    s_xor_b32 s1, s1, s68
    s_lshl_b32 s1, s1, 13
    s_lshl_b32 s63, s58, 18
    s_and_b32 s64, s3, 0xfff
    s_add_u32 s63, s63, s64
    s_add_u32 s63, s63, 14819328
    s_xor_b32 s63, s63, s1
L_Tseg:
    s_cmp_lg_u32 s74, 0
    s_cbranch_scc1 L_Thave
    buffer_load_dword v244, v243, s[4:7], 0 offen sc1
    s_lshl_b32 s65, s62, 1
    s_add_u32 s65, s65, 0
    s_waitcnt vmcnt(0)
    v_mov_b32 v236, s65
    s_mov_b64 exec, 1
    buffer_store_dword v236, off, s[4:7], s63 sc1
    buffer_store_dword v236, off, s[4:7], s3
    s_mov_b64 exec, -1
    s_add_u32 s65, s62, 1
Lfchk_65:
    v_cmp_gt_u32 vcc, s65, v244
    s_cbranch_vccnz Lfrty_66
    s_add_u32 m0, s73, 0
    s_add_u32 s64, s70, 0
    buffer_load_dwordx4 v238, s[4:7], s64 offen sc1 lds
    s_add_u32 m0, s73, 8192
    s_add_u32 s64, s70, 8192
    buffer_load_dwordx4 v238, s[4:7], s64 offen sc1 lds
    s_add_u32 m0, s73, 16384
    s_add_u32 s64, s70, 16384
    buffer_load_dwordx4 v238, s[4:7], s64 offen sc1 lds
    s_add_u32 m0, s73, 24576
    s_add_u32 s64, s70, 24576
    buffer_load_dwordx4 v238, s[4:7], s64 offen sc1 lds
    s_add_u32 m0, s73, 32768
    s_add_u32 s64, s70, 32768
    buffer_load_dwordx4 v238, s[4:7], s64 offen sc1 lds
    s_add_u32 m0, s73, 40960
    s_add_u32 s64, s70, 40960
    buffer_load_dwordx4 v238, s[4:7], s64 offen sc1 lds
    s_add_u32 m0, s73, 2048
    s_add_u32 s64, s70, 2048
    buffer_load_dwordx4 v238, s[4:7], s64 offen sc1 lds
    s_add_u32 m0, s73, 10240
    s_add_u32 s64, s70, 10240
    buffer_load_dwordx4 v238, s[4:7], s64 offen sc1 lds
    s_add_u32 m0, s73, 18432
    s_add_u32 s64, s70, 18432
    buffer_load_dwordx4 v238, s[4:7], s64 offen sc1 lds
    s_add_u32 m0, s73, 26624
    s_add_u32 s64, s70, 26624
    buffer_load_dwordx4 v238, s[4:7], s64 offen sc1 lds
    s_add_u32 m0, s73, 34816
    s_add_u32 s64, s70, 34816
    buffer_load_dwordx4 v238, s[4:7], s64 offen sc1 lds
    s_add_u32 m0, s73, 43008
    s_add_u32 s64, s70, 43008
    buffer_load_dwordx4 v238, s[4:7], s64 offen sc1 lds
    s_add_u32 s70, s70, 393216
    s_add_u32 s66, s62, 1
    s_and_b32 s66, s66, 7
    s_cselect_b32 s66, 0, 3145728
    s_sub_u32 s70, s70, s66
    s_xor_b32 s73, s73, 49152
    s_waitcnt vmcnt(10)
L_Thave:
    s_waitcnt vmcnt(13)
    s_barrier
    ds_read_b128 v[204:207], v239 offset:0
    ds_read_b128 v[220:223], v240 offset:0
    ds_read_b128 v[208:211], v239 offset:1024
    ds_read_b128 v[224:227], v240 offset:1024
    ds_read_b128 v[212:215], v239 offset:4096
    ds_read_b128 v[228:231], v240 offset:2048
    s_waitcnt lgkmcnt(5)
    v_mfma_f32_16x16x32_bf16 v[164:167], a[0:3], v[204:207], 0
    s_lshr_b32 s72, s71, 8
    ds_read_b128 v[216:219], v239 offset:5120
    s_xor_b32 s72, s72, s1
    v_mfma_f32_16x16x32_bf16 v[168:171], a[4:7], v[204:207], 0
    s_and_b32 s72, s72, 0x2000
    ds_read_b128 v[232:235], v240 offset:3072
    s_or_b32 s72, s72, s71
    v_mfma_f32_16x16x32_bf16 v[172:175], a[8:11], v[204:207], 0
    s_add_u32 s71, s71, 1048576
    v_mfma_f32_16x16x32_bf16 v[176:179], a[12:15], v[204:207], 0
    s_waitcnt lgkmcnt(6)
    v_mfma_f32_16x16x32_bf16 v[180:183], v[220:223], v[204:207], 0
    s_waitcnt lgkmcnt(4)
    v_mfma_f32_16x16x32_bf16 v[164:167], a[16:19], v[208:211], v[164:167]
    ds_read_b128 v[204:207], v239 offset:8192
    v_mfma_f32_16x16x32_bf16 v[168:171], a[20:23], v[208:211], v[168:171]
    ds_read_b128 v[220:223], v240 offset:4096
    v_mfma_f32_16x16x32_bf16 v[172:175], a[24:27], v[208:211], v[172:175]
    v_mfma_f32_16x16x32_bf16 v[176:179], a[28:31], v[208:211], v[176:179]
    v_mfma_f32_16x16x32_bf16 v[180:183], v[224:227], v[208:211], v[180:183]
    s_waitcnt lgkmcnt(4)
    v_mfma_f32_16x16x32_bf16 v[164:167], a[32:35], v[212:215], v[164:167]
    ds_read_b128 v[208:211], v239 offset:9216
    v_mfma_f32_16x16x32_bf16 v[168:171], a[36:39], v[212:215], v[168:171]
    ds_read_b128 v[224:227], v240 offset:5120
    v_mfma_f32_16x16x32_bf16 v[172:175], a[40:43], v[212:215], v[172:175]
    v_mfma_f32_16x16x32_bf16 v[176:179], a[44:47], v[212:215], v[176:179]
    v_mfma_f32_16x16x32_bf16 v[180:183], v[228:231], v[212:215], v[180:183]
    s_waitcnt lgkmcnt(4)
    v_mfma_f32_16x16x32_bf16 v[164:167], a[48:51], v[216:219], v[164:167]
    ds_read_b128 v[212:215], v239 offset:12288
    v_mfma_f32_16x16x32_bf16 v[168:171], a[52:55], v[216:219], v[168:171]
    ds_read_b128 v[228:231], v240 offset:6144
    v_mfma_f32_16x16x32_bf16 v[172:175], a[56:59], v[216:219], v[172:175]
    v_mfma_f32_16x16x32_bf16 v[176:179], a[60:63], v[216:219], v[176:179]
    v_mfma_f32_16x16x32_bf16 v[180:183], v[232:235], v[216:219], v[180:183]
    s_waitcnt lgkmcnt(4)
    v_mfma_f32_16x16x32_bf16 v[164:167], a[64:67], v[204:207], v[164:167]
    ds_read_b128 v[216:219], v239 offset:13312
    v_mfma_f32_16x16x32_bf16 v[168:171], a[68:71], v[204:207], v[168:171]
    ds_read_b128 v[232:235], v240 offset:7168
    v_mfma_f32_16x16x32_bf16 v[172:175], a[72:75], v[204:207], v[172:175]
    v_mfma_f32_16x16x32_bf16 v[176:179], a[76:79], v[204:207], v[176:179]
    v_mfma_f32_16x16x32_bf16 v[180:183], v[220:223], v[204:207], v[180:183]
    s_waitcnt vmcnt(6)
    s_barrier
    s_waitcnt lgkmcnt(5)
    v_mfma_f32_16x16x32_bf16 v[164:167], a[80:83], v[208:211], v[164:167]
    ds_read_b128 v[204:207], v239 offset:16384
    v_mfma_f32_16x16x32_bf16 v[168:171], a[84:87], v[208:211], v[168:171]
    ds_read_b128 v[220:223], v240 offset:8192
    v_mfma_f32_16x16x32_bf16 v[172:175], a[88:91], v[208:211], v[172:175]
    v_mfma_f32_16x16x32_bf16 v[176:179], a[92:95], v[208:211], v[176:179]
    s_waitcnt lgkmcnt(6)
    v_mfma_f32_16x16x32_bf16 v[180:183], v[224:227], v[208:211], v[180:183]
    s_waitcnt lgkmcnt(4)
    v_mfma_f32_16x16x32_bf16 v[164:167], a[96:99], v[212:215], v[164:167]
    ds_read_b128 v[208:211], v239 offset:17408
    v_mfma_f32_16x16x32_bf16 v[168:171], a[100:103], v[212:215], v[168:171]
    ds_read_b128 v[224:227], v240 offset:9216
    v_mfma_f32_16x16x32_bf16 v[172:175], a[104:107], v[212:215], v[172:175]
    v_mfma_f32_16x16x32_bf16 v[176:179], a[108:111], v[212:215], v[176:179]
    v_mfma_f32_16x16x32_bf16 v[180:183], v[228:231], v[212:215], v[180:183]
    s_waitcnt lgkmcnt(4)
    v_mfma_f32_16x16x32_bf16 v[164:167], a[112:115], v[216:219], v[164:167]
    ds_read_b128 v[212:215], v239 offset:20480
    v_mfma_f32_16x16x32_bf16 v[168:171], a[116:119], v[216:219], v[168:171]
    ds_read_b128 v[228:231], v240 offset:10240
    v_mfma_f32_16x16x32_bf16 v[172:175], a[120:123], v[216:219], v[172:175]
    v_mfma_f32_16x16x32_bf16 v[176:179], a[124:127], v[216:219], v[176:179]
    v_mfma_f32_16x16x32_bf16 v[180:183], v[232:235], v[216:219], v[180:183]
    s_cmp_eq_u32 s74, 0
    s_cbranch_scc1 L_Tnofl
    s_lshl_b32 s65, s62, 1
    s_add_u32 s65, s65, 0
    s_waitcnt vmcnt(0)
    v_mov_b32 v236, s65
    s_mov_b64 exec, 1
    buffer_store_dword v236, off, s[4:7], s63 sc1
    buffer_store_dword v236, off, s[4:7], s3
    s_mov_b64 exec, -1
L_Tnofl:
    s_waitcnt lgkmcnt(5)
    v_mfma_f32_16x16x32_bf16 v[164:167], a[128:131], v[204:207], v[164:167]
    ds_read_b128 v[216:219], v239 offset:21504
    v_mfma_f32_16x16x32_bf16 v[168:171], a[132:135], v[204:207], v[168:171]
    ds_read_b128 v[232:235], v240 offset:11264
    v_mfma_f32_16x16x32_bf16 v[172:175], a[136:139], v[204:207], v[172:175]
    v_mfma_f32_16x16x32_bf16 v[176:179], a[140:143], v[204:207], v[176:179]
    s_waitcnt lgkmcnt(6)
    v_mfma_f32_16x16x32_bf16 v[180:183], v[220:223], v[204:207], v[180:183]
    s_waitcnt lgkmcnt(4)
    v_mfma_f32_16x16x32_bf16 v[164:167], a[144:147], v[208:211], v[164:167]
    ds_read_b128 v[204:207], v239 offset:24576
    v_mfma_f32_16x16x32_bf16 v[168:171], a[148:151], v[208:211], v[168:171]
    ds_read_b128 v[220:223], v240 offset:12288
    v_mfma_f32_16x16x32_bf16 v[172:175], a[152:155], v[208:211], v[172:175]
    v_mfma_f32_16x16x32_bf16 v[176:179], a[156:159], v[208:211], v[176:179]
    v_mfma_f32_16x16x32_bf16 v[180:183], v[224:227], v[208:211], v[180:183]
    s_waitcnt lgkmcnt(4)
    v_mfma_f32_16x16x32_bf16 v[164:167], a[160:163], v[212:215], v[164:167]
    ds_read_b128 v[208:211], v239 offset:25600
    v_mfma_f32_16x16x32_bf16 v[168:171], a[164:167], v[212:215], v[168:171]
    ds_read_b128 v[224:227], v240 offset:13312
    v_mfma_f32_16x16x32_bf16 v[172:175], a[168:171], v[212:215], v[172:175]
    v_mfma_f32_16x16x32_bf16 v[176:179], a[172:175], v[212:215], v[176:179]
    v_mfma_f32_16x16x32_bf16 v[180:183], v[228:231], v[212:215], v[180:183]
    s_waitcnt lgkmcnt(4)
    v_mfma_f32_16x16x32_bf16 v[164:167], a[176:179], v[216:219], v[164:167]
    ds_read_b128 v[212:215], v239 offset:28672
    v_mfma_f32_16x16x32_bf16 v[168:171], a[180:183], v[216:219], v[168:171]
    ds_read_b128 v[228:231], v240 offset:14336
    v_mfma_f32_16x16x32_bf16 v[172:175], a[184:187], v[216:219], v[172:175]
    v_mfma_f32_16x16x32_bf16 v[176:179], a[188:191], v[216:219], v[176:179]
    v_mfma_f32_16x16x32_bf16 v[180:183], v[232:235], v[216:219], v[180:183]
    s_waitcnt lgkmcnt(4)
    v_mfma_f32_16x16x32_bf16 v[164:167], a[192:195], v[204:207], v[164:167]
    ds_read_b128 v[216:219], v239 offset:29696
    v_mfma_f32_16x16x32_bf16 v[168:171], a[196:199], v[204:207], v[168:171]
    ds_read_b128 v[232:235], v240 offset:15360
    v_mfma_f32_16x16x32_bf16 v[172:175], a[200:203], v[204:207], v[172:175]
    v_mfma_f32_16x16x32_bf16 v[176:179], a[204:207], v[204:207], v[176:179]
    v_mfma_f32_16x16x32_bf16 v[180:183], v[220:223], v[204:207], v[180:183]
    s_waitcnt lgkmcnt(4)
    v_mfma_f32_16x16x32_bf16 v[164:167], a[208:211], v[208:211], v[164:167]
    ds_read_b128 v[204:207], v239 offset:32768
    v_mfma_f32_16x16x32_bf16 v[168:171], a[212:215], v[208:211], v[168:171]
    v_mfma_f32_16x16x32_bf16 v[172:175], a[216:219], v[208:211], v[172:175]
    v_mfma_f32_16x16x32_bf16 v[176:179], a[220:223], v[208:211], v[176:179]
    v_mfma_f32_16x16x32_bf16 v[180:183], v[224:227], v[208:211], v[180:183]
    s_waitcnt lgkmcnt(3)
    v_mfma_f32_16x16x32_bf16 v[164:167], a[224:227], v[212:215], v[164:167]
    ds_read_b128 v[208:211], v239 offset:33792
    v_mfma_f32_16x16x32_bf16 v[168:171], a[228:231], v[212:215], v[168:171]
    v_mfma_f32_16x16x32_bf16 v[172:175], a[232:235], v[212:215], v[172:175]
    v_mfma_f32_16x16x32_bf16 v[176:179], a[236:239], v[212:215], v[176:179]
    v_mfma_f32_16x16x32_bf16 v[180:183], v[228:231], v[212:215], v[180:183]
    s_waitcnt lgkmcnt(2)
    v_mfma_f32_16x16x32_bf16 v[164:167], a[240:243], v[216:219], v[164:167]
    ds_read_b128 v[212:215], v239 offset:36864
    v_mfma_f32_16x16x32_bf16 v[168:171], a[244:247], v[216:219], v[168:171]
    v_mfma_f32_16x16x32_bf16 v[172:175], a[248:251], v[216:219], v[172:175]
    v_mfma_f32_16x16x32_bf16 v[176:179], a[252:255], v[216:219], v[176:179]
    v_mfma_f32_16x16x32_bf16 v[180:183], v[232:235], v[216:219], v[180:183]
    s_waitcnt lgkmcnt(2)
    v_mfma_f32_16x16x32_bf16 v[164:167], v[4:7], v[204:207], v[164:167]
    ds_read_b128 v[216:219], v239 offset:37888
    v_mfma_f32_16x16x32_bf16 v[168:171], v[8:11], v[204:207], v[168:171]
    v_mfma_f32_16x16x32_bf16 v[172:175], v[12:15], v[204:207], v[172:175]
    v_mfma_f32_16x16x32_bf16 v[176:179], v[16:19], v[204:207], v[176:179]
    v_mfma_f32_16x16x32_bf16 v[180:183], v[132:135], v[204:207], v[180:183]
    s_waitcnt lgkmcnt(2)
    v_mfma_f32_16x16x32_bf16 v[164:167], v[20:23], v[208:211], v[164:167]
    ds_read_b128 v[204:207], v239 offset:40960
    v_mfma_f32_16x16x32_bf16 v[168:171], v[24:27], v[208:211], v[168:171]
    v_mfma_f32_16x16x32_bf16 v[172:175], v[28:31], v[208:211], v[172:175]
    v_mfma_f32_16x16x32_bf16 v[176:179], v[32:35], v[208:211], v[176:179]
    v_mfma_f32_16x16x32_bf16 v[180:183], v[136:139], v[208:211], v[180:183]
    s_waitcnt lgkmcnt(2)
    v_mfma_f32_16x16x32_bf16 v[164:167], v[36:39], v[212:215], v[164:167]
    ds_read_b128 v[208:211], v239 offset:41984
    v_mfma_f32_16x16x32_bf16 v[168:171], v[40:43], v[212:215], v[168:171]
    v_mfma_f32_16x16x32_bf16 v[172:175], v[44:47], v[212:215], v[172:175]
    v_mfma_f32_16x16x32_bf16 v[176:179], v[48:51], v[212:215], v[176:179]
    v_mfma_f32_16x16x32_bf16 v[180:183], v[140:143], v[212:215], v[180:183]
    s_waitcnt lgkmcnt(2)
    v_mfma_f32_16x16x32_bf16 v[164:167], v[52:55], v[216:219], v[164:167]
    ds_read_b128 v[212:215], v239 offset:45056
    v_mfma_f32_16x16x32_bf16 v[168:171], v[56:59], v[216:219], v[168:171]
    v_mfma_f32_16x16x32_bf16 v[172:175], v[60:63], v[216:219], v[172:175]
    v_mfma_f32_16x16x32_bf16 v[176:179], v[64:67], v[216:219], v[176:179]
    v_mfma_f32_16x16x32_bf16 v[180:183], v[144:147], v[216:219], v[180:183]
    s_waitcnt lgkmcnt(2)
    v_mfma_f32_16x16x32_bf16 v[164:167], v[68:71], v[204:207], v[164:167]
    ds_read_b128 v[216:219], v239 offset:46080
    v_mfma_f32_16x16x32_bf16 v[168:171], v[72:75], v[204:207], v[168:171]
    v_mfma_f32_16x16x32_bf16 v[172:175], v[76:79], v[204:207], v[172:175]
    v_mfma_f32_16x16x32_bf16 v[176:179], v[80:83], v[204:207], v[176:179]
    v_mfma_f32_16x16x32_bf16 v[180:183], v[148:151], v[204:207], v[180:183]
    s_waitcnt vmcnt(0)
    s_barrier
    s_waitcnt lgkmcnt(2)
    v_mfma_f32_16x16x32_bf16 v[164:167], v[84:87], v[208:211], v[164:167]
    ds_read_b128 v[204:207], v239 offset:2048
    v_mfma_f32_16x16x32_bf16 v[168:171], v[88:91], v[208:211], v[168:171]
    ds_read_b128 v[220:223], v240 offset:0
    v_mfma_f32_16x16x32_bf16 v[172:175], v[92:95], v[208:211], v[172:175]
    v_mfma_f32_16x16x32_bf16 v[176:179], v[96:99], v[208:211], v[176:179]
    v_mfma_f32_16x16x32_bf16 v[180:183], v[152:155], v[208:211], v[180:183]
    s_waitcnt lgkmcnt(3)
    v_mfma_f32_16x16x32_bf16 v[164:167], v[100:103], v[212:215], v[164:167]
    ds_read_b128 v[208:211], v239 offset:3072
    v_mfma_f32_16x16x32_bf16 v[168:171], v[104:107], v[212:215], v[168:171]
    ds_read_b128 v[224:227], v240 offset:1024
    v_mfma_f32_16x16x32_bf16 v[172:175], v[108:111], v[212:215], v[172:175]
    v_mfma_f32_16x16x32_bf16 v[176:179], v[112:115], v[212:215], v[176:179]
    v_mfma_f32_16x16x32_bf16 v[180:183], v[156:159], v[212:215], v[180:183]
    s_waitcnt lgkmcnt(4)
    v_mfma_f32_16x16x32_bf16 v[164:167], v[116:119], v[216:219], v[164:167]
    ds_read_b128 v[212:215], v239 offset:6144
    v_mfma_f32_16x16x32_bf16 v[168:171], v[120:123], v[216:219], v[168:171]
    ds_read_b128 v[228:231], v240 offset:2048
    v_mfma_f32_16x16x32_bf16 v[172:175], v[124:127], v[216:219], v[172:175]
    v_mfma_f32_16x16x32_bf16 v[176:179], v[128:131], v[216:219], v[176:179]
    v_mfma_f32_16x16x32_bf16 v[180:183], v[160:163], v[216:219], v[180:183]
    s_waitcnt lgkmcnt(4)
    v_mfma_f32_16x16x32_bf16 v[184:187], a[0:3], v[204:207], 0
    ds_read_b128 v[216:219], v239 offset:7168
    v_mfma_f32_16x16x32_bf16 v[188:191], a[4:7], v[204:207], 0
    ds_read_b128 v[232:235], v240 offset:3072
    v_mfma_f32_16x16x32_bf16 v[192:195], a[8:11], v[204:207], 0
    v_mfma_f32_16x16x32_bf16 v[196:199], a[12:15], v[204:207], 0
    v_mfma_f32_16x16x32_bf16 v[200:203], v[220:223], v[204:207], 0
    s_waitcnt lgkmcnt(5)
    v_mfma_f32_16x16x32_bf16 v[184:187], a[16:19], v[208:211], v[184:187]
    s_add_u32 s77, s72, 0
    ds_read_b128 v[204:207], v239 offset:10240
    s_add_u32 s78, s72, 32768
    v_mfma_f32_16x16x32_bf16 v[188:191], a[20:23], v[208:211], v[188:191]
    ds_read_b128 v[220:223], v240 offset:4096
    v_cvt_pk_bf16_f32 v164, v164, v165
    v_mfma_f32_16x16x32_bf16 v[192:195], a[24:27], v[208:211], v[192:195]
    v_cvt_pk_bf16_f32 v165, v166, v167
    v_cvt_pk_bf16_f32 v166, v168, v169
    v_mfma_f32_16x16x32_bf16 v[196:199], a[28:31], v[208:211], v[196:199]
    v_cvt_pk_bf16_f32 v167, v170, v171
    s_waitcnt lgkmcnt(6)
    v_mfma_f32_16x16x32_bf16 v[200:203], v[224:227], v[208:211], v[200:203]
    s_waitcnt lgkmcnt(4)
    buffer_store_dwordx4 v[164:167], v241, s[4:7], s77 offen sc1
    v_cvt_pk_bf16_f32 v168, v172, v173
    v_cvt_pk_bf16_f32 v169, v174, v175
    v_cvt_pk_bf16_f32 v170, v176, v177
    v_cvt_pk_bf16_f32 v171, v178, v179
    v_mfma_f32_16x16x32_bf16 v[184:187], a[32:35], v[212:215], v[184:187]
    ds_read_b128 v[208:211], v239 offset:11264
    v_mfma_f32_16x16x32_bf16 v[188:191], a[36:39], v[212:215], v[188:191]
    ds_read_b128 v[224:227], v240 offset:5120
    v_mfma_f32_16x16x32_bf16 v[192:195], a[40:43], v[212:215], v[192:195]
    buffer_store_dwordx4 v[168:171], v241, s[4:7], s78 offen sc1
    v_cvt_pk_bf16_f32 v172, v180, v181
    v_cvt_pk_bf16_f32 v173, v182, v183
    v_mfma_f32_16x16x32_bf16 v[196:199], a[44:47], v[212:215], v[196:199]
    buffer_store_dwordx2 v[172:173], v242, s[4:7], s72 offen offset:0 sc1
    v_mfma_f32_16x16x32_bf16 v[200:203], v[228:231], v[212:215], v[200:203]
    s_waitcnt lgkmcnt(4)
    v_mfma_f32_16x16x32_bf16 v[184:187], a[48:51], v[216:219], v[184:187]
    ds_read_b128 v[212:215], v239 offset:14336
    v_mfma_f32_16x16x32_bf16 v[188:191], a[52:55], v[216:219], v[188:191]
    ds_read_b128 v[228:231], v240 offset:6144
    v_mfma_f32_16x16x32_bf16 v[192:195], a[56:59], v[216:219], v[192:195]
    v_mfma_f32_16x16x32_bf16 v[196:199], a[60:63], v[216:219], v[196:199]
    v_mfma_f32_16x16x32_bf16 v[200:203], v[232:235], v[216:219], v[200:203]
    s_waitcnt lgkmcnt(4)
    v_mfma_f32_16x16x32_bf16 v[184:187], a[64:67], v[204:207], v[184:187]
    ds_read_b128 v[216:219], v239 offset:15360
    v_mfma_f32_16x16x32_bf16 v[188:191], a[68:71], v[204:207], v[188:191]
    ds_read_b128 v[232:235], v240 offset:7168
    v_mfma_f32_16x16x32_bf16 v[192:195], a[72:75], v[204:207], v[192:195]
    v_mfma_f32_16x16x32_bf16 v[196:199], a[76:79], v[204:207], v[196:199]
    v_mfma_f32_16x16x32_bf16 v[200:203], v[220:223], v[204:207], v[200:203]
    s_waitcnt lgkmcnt(4)
    v_mfma_f32_16x16x32_bf16 v[184:187], a[80:83], v[208:211], v[184:187]
    ds_read_b128 v[204:207], v239 offset:18432
    v_mfma_f32_16x16x32_bf16 v[188:191], a[84:87], v[208:211], v[188:191]
    ds_read_b128 v[220:223], v240 offset:8192
    v_mfma_f32_16x16x32_bf16 v[192:195], a[88:91], v[208:211], v[192:195]
    v_mfma_f32_16x16x32_bf16 v[196:199], a[92:95], v[208:211], v[196:199]
    v_mfma_f32_16x16x32_bf16 v[200:203], v[224:227], v[208:211], v[200:203]
    s_waitcnt lgkmcnt(4)
    v_mfma_f32_16x16x32_bf16 v[184:187], a[96:99], v[212:215], v[184:187]
    ds_read_b128 v[208:211], v239 offset:19456
    v_mfma_f32_16x16x32_bf16 v[188:191], a[100:103], v[212:215], v[188:191]
    ds_read_b128 v[224:227], v240 offset:9216
    v_mfma_f32_16x16x32_bf16 v[192:195], a[104:107], v[212:215], v[192:195]
    v_mfma_f32_16x16x32_bf16 v[196:199], a[108:111], v[212:215], v[196:199]
    v_mfma_f32_16x16x32_bf16 v[200:203], v[228:231], v[212:215], v[200:203]
    s_waitcnt lgkmcnt(4)
    v_mfma_f32_16x16x32_bf16 v[184:187], a[112:115], v[216:219], v[184:187]
    ds_read_b128 v[212:215], v239 offset:22528
    v_mfma_f32_16x16x32_bf16 v[188:191], a[116:119], v[216:219], v[188:191]
    ds_read_b128 v[228:231], v240 offset:10240
    v_mfma_f32_16x16x32_bf16 v[192:195], a[120:123], v[216:219], v[192:195]
    v_mfma_f32_16x16x32_bf16 v[196:199], a[124:127], v[216:219], v[196:199]
    v_mfma_f32_16x16x32_bf16 v[200:203], v[232:235], v[216:219], v[200:203]
    s_waitcnt lgkmcnt(4)
    v_mfma_f32_16x16x32_bf16 v[184:187], a[128:131], v[204:207], v[184:187]
    ds_read_b128 v[216:219], v239 offset:23552
    v_mfma_f32_16x16x32_bf16 v[188:191], a[132:135], v[204:207], v[188:191]
    ds_read_b128 v[232:235], v240 offset:11264
    v_mfma_f32_16x16x32_bf16 v[192:195], a[136:139], v[204:207], v[192:195]
    v_mfma_f32_16x16x32_bf16 v[196:199], a[140:143], v[204:207], v[196:199]
    v_mfma_f32_16x16x32_bf16 v[200:203], v[220:223], v[204:207], v[200:203]
    s_waitcnt lgkmcnt(4)
    v_mfma_f32_16x16x32_bf16 v[184:187], a[144:147], v[208:211], v[184:187]
    ds_read_b128 v[204:207], v239 offset:26624
    v_mfma_f32_16x16x32_bf16 v[188:191], a[148:151], v[208:211], v[188:191]
    ds_read_b128 v[220:223], v240 offset:12288
    v_mfma_f32_16x16x32_bf16 v[192:195], a[152:155], v[208:211], v[192:195]
    v_mfma_f32_16x16x32_bf16 v[196:199], a[156:159], v[208:211], v[196:199]
    v_mfma_f32_16x16x32_bf16 v[200:203], v[224:227], v[208:211], v[200:203]
    s_waitcnt lgkmcnt(4)
    v_mfma_f32_16x16x32_bf16 v[184:187], a[160:163], v[212:215], v[184:187]
    ds_read_b128 v[208:211], v239 offset:27648
    v_mfma_f32_16x16x32_bf16 v[188:191], a[164:167], v[212:215], v[188:191]
    ds_read_b128 v[224:227], v240 offset:13312
    v_mfma_f32_16x16x32_bf16 v[192:195], a[168:171], v[212:215], v[192:195]
    v_mfma_f32_16x16x32_bf16 v[196:199], a[172:175], v[212:215], v[196:199]
    v_mfma_f32_16x16x32_bf16 v[200:203], v[228:231], v[212:215], v[200:203]
    s_lshl_b32 s65, s62, 1
    s_add_u32 s65, s65, 1
    s_waitcnt vmcnt(0)
    v_mov_b32 v236, s65
    s_mov_b64 exec, 1
    buffer_store_dword v236, off, s[4:7], s63 sc1
    buffer_store_dword v236, off, s[4:7], s3
    s_mov_b64 exec, -1
    s_waitcnt lgkmcnt(5)
    v_mfma_f32_16x16x32_bf16 v[184:187], a[176:179], v[216:219], v[184:187]
    ds_read_b128 v[212:215], v239 offset:30720
    v_mfma_f32_16x16x32_bf16 v[188:191], a[180:183], v[216:219], v[188:191]
    ds_read_b128 v[228:231], v240 offset:14336
    v_mfma_f32_16x16x32_bf16 v[192:195], a[184:187], v[216:219], v[192:195]
    v_mfma_f32_16x16x32_bf16 v[196:199], a[188:191], v[216:219], v[196:199]
    s_waitcnt lgkmcnt(6)
    v_mfma_f32_16x16x32_bf16 v[200:203], v[232:235], v[216:219], v[200:203]
    s_waitcnt lgkmcnt(4)
    v_mfma_f32_16x16x32_bf16 v[184:187], a[192:195], v[204:207], v[184:187]
    ds_read_b128 v[216:219], v239 offset:31744
    v_mfma_f32_16x16x32_bf16 v[188:191], a[196:199], v[204:207], v[188:191]
    ds_read_b128 v[232:235], v240 offset:15360
    v_mfma_f32_16x16x32_bf16 v[192:195], a[200:203], v[204:207], v[192:195]
    v_mfma_f32_16x16x32_bf16 v[196:199], a[204:207], v[204:207], v[196:199]
    v_mfma_f32_16x16x32_bf16 v[200:203], v[220:223], v[204:207], v[200:203]
    s_waitcnt lgkmcnt(4)
    v_mfma_f32_16x16x32_bf16 v[184:187], a[208:211], v[208:211], v[184:187]
    ds_read_b128 v[204:207], v239 offset:34816
    v_mfma_f32_16x16x32_bf16 v[188:191], a[212:215], v[208:211], v[188:191]
    v_mfma_f32_16x16x32_bf16 v[192:195], a[216:219], v[208:211], v[192:195]
    v_mfma_f32_16x16x32_bf16 v[196:199], a[220:223], v[208:211], v[196:199]
    v_mfma_f32_16x16x32_bf16 v[200:203], v[224:227], v[208:211], v[200:203]
    s_waitcnt lgkmcnt(3)
    v_mfma_f32_16x16x32_bf16 v[184:187], a[224:227], v[212:215], v[184:187]
    ds_read_b128 v[208:211], v239 offset:35840
    v_mfma_f32_16x16x32_bf16 v[188:191], a[228:231], v[212:215], v[188:191]
    v_mfma_f32_16x16x32_bf16 v[192:195], a[232:235], v[212:215], v[192:195]
    v_mfma_f32_16x16x32_bf16 v[196:199], a[236:239], v[212:215], v[196:199]
    v_mfma_f32_16x16x32_bf16 v[200:203], v[228:231], v[212:215], v[200:203]
    s_waitcnt lgkmcnt(2)
    v_mfma_f32_16x16x32_bf16 v[184:187], a[240:243], v[216:219], v[184:187]
    ds_read_b128 v[212:215], v239 offset:38912
    buffer_load_dword v244, v243, s[4:7], 0 offen sc1
    v_mfma_f32_16x16x32_bf16 v[188:191], a[244:247], v[216:219], v[188:191]
    v_mfma_f32_16x16x32_bf16 v[192:195], a[248:251], v[216:219], v[192:195]
    v_mfma_f32_16x16x32_bf16 v[196:199], a[252:255], v[216:219], v[196:199]
    v_mfma_f32_16x16x32_bf16 v[200:203], v[232:235], v[216:219], v[200:203]
    s_waitcnt lgkmcnt(2)
    v_mfma_f32_16x16x32_bf16 v[184:187], v[4:7], v[204:207], v[184:187]
    ds_read_b128 v[216:219], v239 offset:39936
    v_mfma_f32_16x16x32_bf16 v[188:191], v[8:11], v[204:207], v[188:191]
    v_mfma_f32_16x16x32_bf16 v[192:195], v[12:15], v[204:207], v[192:195]
    v_mfma_f32_16x16x32_bf16 v[196:199], v[16:19], v[204:207], v[196:199]
    v_mfma_f32_16x16x32_bf16 v[200:203], v[132:135], v[204:207], v[200:203]
    s_waitcnt lgkmcnt(2)
    v_mfma_f32_16x16x32_bf16 v[184:187], v[20:23], v[208:211], v[184:187]
    ds_read_b128 v[204:207], v239 offset:43008
    v_mfma_f32_16x16x32_bf16 v[188:191], v[24:27], v[208:211], v[188:191]
    v_mfma_f32_16x16x32_bf16 v[192:195], v[28:31], v[208:211], v[192:195]
    v_mfma_f32_16x16x32_bf16 v[196:199], v[32:35], v[208:211], v[196:199]
    v_mfma_f32_16x16x32_bf16 v[200:203], v[136:139], v[208:211], v[200:203]
    s_waitcnt lgkmcnt(2)
    v_mfma_f32_16x16x32_bf16 v[184:187], v[36:39], v[212:215], v[184:187]
    ds_read_b128 v[208:211], v239 offset:44032
    v_mfma_f32_16x16x32_bf16 v[188:191], v[40:43], v[212:215], v[188:191]
    v_mfma_f32_16x16x32_bf16 v[192:195], v[44:47], v[212:215], v[192:195]
    v_mfma_f32_16x16x32_bf16 v[196:199], v[48:51], v[212:215], v[196:199]
    v_mfma_f32_16x16x32_bf16 v[200:203], v[140:143], v[212:215], v[200:203]
    s_add_u32 s65, s62, 2
    s_waitcnt vmcnt(0)
    v_cmp_gt_u32 vcc, s65, v244
    s_mov_b32 s74, 0
    s_cbranch_vccz L_Tpre
    s_waitcnt lgkmcnt(2)
    v_mfma_f32_16x16x32_bf16 v[184:187], v[52:55], v[216:219], v[184:187]
    ds_read_b128 v[212:215], v239 offset:47104
    v_mfma_f32_16x16x32_bf16 v[188:191], v[56:59], v[216:219], v[188:191]
    v_mfma_f32_16x16x32_bf16 v[192:195], v[60:63], v[216:219], v[192:195]
    v_mfma_f32_16x16x32_bf16 v[196:199], v[64:67], v[216:219], v[196:199]
    v_mfma_f32_16x16x32_bf16 v[200:203], v[144:147], v[216:219], v[200:203]
    s_waitcnt lgkmcnt(2)
    v_mfma_f32_16x16x32_bf16 v[184:187], v[68:71], v[204:207], v[184:187]
    ds_read_b128 v[216:219], v239 offset:48128
    v_mfma_f32_16x16x32_bf16 v[188:191], v[72:75], v[204:207], v[188:191]
    v_mfma_f32_16x16x32_bf16 v[192:195], v[76:79], v[204:207], v[192:195]
    v_mfma_f32_16x16x32_bf16 v[196:199], v[80:83], v[204:207], v[196:199]
    v_mfma_f32_16x16x32_bf16 v[200:203], v[148:151], v[204:207], v[200:203]
    s_waitcnt lgkmcnt(2)
    v_mfma_f32_16x16x32_bf16 v[184:187], v[84:87], v[208:211], v[184:187]
    v_mfma_f32_16x16x32_bf16 v[188:191], v[88:91], v[208:211], v[188:191]
    v_mfma_f32_16x16x32_bf16 v[192:195], v[92:95], v[208:211], v[192:195]
    v_mfma_f32_16x16x32_bf16 v[196:199], v[96:99], v[208:211], v[196:199]
    v_mfma_f32_16x16x32_bf16 v[200:203], v[152:155], v[208:211], v[200:203]
    s_waitcnt lgkmcnt(1)
    v_mfma_f32_16x16x32_bf16 v[184:187], v[100:103], v[212:215], v[184:187]
    v_mfma_f32_16x16x32_bf16 v[188:191], v[104:107], v[212:215], v[188:191]
    v_mfma_f32_16x16x32_bf16 v[192:195], v[108:111], v[212:215], v[192:195]
    v_mfma_f32_16x16x32_bf16 v[196:199], v[112:115], v[212:215], v[196:199]
    v_mfma_f32_16x16x32_bf16 v[200:203], v[156:159], v[212:215], v[200:203]
    s_waitcnt lgkmcnt(0)
    v_mfma_f32_16x16x32_bf16 v[184:187], v[116:119], v[216:219], v[184:187]
    v_mfma_f32_16x16x32_bf16 v[188:191], v[120:123], v[216:219], v[188:191]
    v_mfma_f32_16x16x32_bf16 v[192:195], v[124:127], v[216:219], v[192:195]
    v_mfma_f32_16x16x32_bf16 v[196:199], v[128:131], v[216:219], v[196:199]
    v_mfma_f32_16x16x32_bf16 v[200:203], v[160:163], v[216:219], v[200:203]
L_Tend:
    v_xor_b32 v239, 49152, v239
    s_add_u32 s77, s72, 16384
    s_add_u32 s78, s72, 49152
    s_nop 0
    v_cvt_pk_bf16_f32 v184, v184, v185
    v_cvt_pk_bf16_f32 v185, v186, v187
    v_cvt_pk_bf16_f32 v186, v188, v189
    v_cvt_pk_bf16_f32 v187, v190, v191
    buffer_store_dwordx4 v[184:187], v241, s[4:7], s77 offen sc1
    v_cvt_pk_bf16_f32 v188, v192, v193
    v_cvt_pk_bf16_f32 v189, v194, v195
    v_cvt_pk_bf16_f32 v190, v196, v197
    v_cvt_pk_bf16_f32 v191, v198, v199
    buffer_store_dwordx4 v[188:191], v241, s[4:7], s78 offen sc1
    v_cvt_pk_bf16_f32 v192, v200, v201
    v_cvt_pk_bf16_f32 v193, v202, v203
    buffer_store_dwordx2 v[192:193], v242, s[4:7], s72 offen offset:512 sc1
    s_add_u32 s62, s62, 1
    s_cmp_lt_u32 s62, 64
    s_cbranch_scc1 L_Tseg
    s_lshl_b32 s65, s62, 1
    s_add_u32 s65, s65, 0
    s_waitcnt vmcnt(0)
    v_mov_b32 v236, s65
    s_mov_b64 exec, 1
    buffer_store_dword v236, off, s[4:7], s63 sc1
    buffer_store_dword v236, off, s[4:7], s3
    s_mov_b64 exec, -1
    s_endpgm
L_Tpre:
    s_mov_b32 s74, 1
    s_waitcnt lgkmcnt(2)
    v_mfma_f32_16x16x32_bf16 v[184:187], v[52:55], v[216:219], v[184:187]
    s_add_u32 m0, s73, 0
    ds_read_b128 v[212:215], v239 offset:47104
    s_add_u32 s64, s70, 0
    v_mfma_f32_16x16x32_bf16 v[188:191], v[56:59], v[216:219], v[188:191]
    buffer_load_dwordx4 v238, s[4:7], s64 offen sc1 lds
    s_add_u32 m0, s73, 8192
    v_mfma_f32_16x16x32_bf16 v[192:195], v[60:63], v[216:219], v[192:195]
    s_add_u32 s64, s70, 8192
    buffer_load_dwordx4 v238, s[4:7], s64 offen sc1 lds
    s_add_u32 m0, s73, 16384
    v_mfma_f32_16x16x32_bf16 v[196:199], v[64:67], v[216:219], v[196:199]
    s_add_u32 s64, s70, 16384
    buffer_load_dwordx4 v238, s[4:7], s64 offen sc1 lds
    s_add_u32 m0, s73, 24576
    v_mfma_f32_16x16x32_bf16 v[200:203], v[144:147], v[216:219], v[200:203]
    s_waitcnt lgkmcnt(2)
    s_add_u32 s64, s70, 24576
    buffer_load_dwordx4 v238, s[4:7], s64 offen sc1 lds
    v_mfma_f32_16x16x32_bf16 v[184:187], v[68:71], v[204:207], v[184:187]
    s_add_u32 m0, s73, 32768
    ds_read_b128 v[216:219], v239 offset:48128
    s_add_u32 s64, s70, 32768
    v_mfma_f32_16x16x32_bf16 v[188:191], v[72:75], v[204:207], v[188:191]
    buffer_load_dwordx4 v238, s[4:7], s64 offen sc1 lds
    s_add_u32 m0, s73, 40960
    v_mfma_f32_16x16x32_bf16 v[192:195], v[76:79], v[204:207], v[192:195]
    s_add_u32 s64, s70, 40960
    buffer_load_dwordx4 v238, s[4:7], s64 offen sc1 lds
    s_add_u32 m0, s73, 2048
    v_mfma_f32_16x16x32_bf16 v[196:199], v[80:83], v[204:207], v[196:199]
    s_add_u32 s64, s70, 2048
    buffer_load_dwordx4 v238, s[4:7], s64 offen sc1 lds
    s_add_u32 m0, s73, 10240
    v_mfma_f32_16x16x32_bf16 v[200:203], v[148:151], v[204:207], v[200:203]
    s_waitcnt lgkmcnt(2)
    s_add_u32 s64, s70, 10240
    buffer_load_dwordx4 v238, s[4:7], s64 offen sc1 lds
    v_mfma_f32_16x16x32_bf16 v[184:187], v[84:87], v[208:211], v[184:187]
    s_add_u32 m0, s73, 18432
    s_add_u32 s64, s70, 18432
    buffer_load_dwordx4 v238, s[4:7], s64 offen sc1 lds
    v_mfma_f32_16x16x32_bf16 v[188:191], v[88:91], v[208:211], v[188:191]
    s_add_u32 m0, s73, 26624
    s_add_u32 s64, s70, 26624
    buffer_load_dwordx4 v238, s[4:7], s64 offen sc1 lds
    v_mfma_f32_16x16x32_bf16 v[192:195], v[92:95], v[208:211], v[192:195]
    s_add_u32 m0, s73, 34816
    s_add_u32 s64, s70, 34816
    buffer_load_dwordx4 v238, s[4:7], s64 offen sc1 lds
    v_mfma_f32_16x16x32_bf16 v[196:199], v[96:99], v[208:211], v[196:199]
    s_add_u32 m0, s73, 43008
    s_add_u32 s64, s70, 43008
    buffer_load_dwordx4 v238, s[4:7], s64 offen sc1 lds
    v_mfma_f32_16x16x32_bf16 v[200:203], v[152:155], v[208:211], v[200:203]
    s_waitcnt lgkmcnt(1)
    s_add_u32 s70, s70, 393216
    s_add_u32 s66, s62, 2
    v_mfma_f32_16x16x32_bf16 v[184:187], v[100:103], v[212:215], v[184:187]
    s_and_b32 s66, s66, 7
    s_cselect_b32 s66, 0, 3145728
    s_sub_u32 s70, s70, s66
    v_mfma_f32_16x16x32_bf16 v[188:191], v[104:107], v[212:215], v[188:191]
    s_xor_b32 s73, s73, 49152
    v_mfma_f32_16x16x32_bf16 v[192:195], v[108:111], v[212:215], v[192:195]
    v_mfma_f32_16x16x32_bf16 v[196:199], v[112:115], v[212:215], v[196:199]
    v_mfma_f32_16x16x32_bf16 v[200:203], v[156:159], v[212:215], v[200:203]
    s_waitcnt lgkmcnt(0)
    v_mfma_f32_16x16x32_bf16 v[184:187], v[116:119], v[216:219], v[184:187]
    v_mfma_f32_16x16x32_bf16 v[188:191], v[120:123], v[216:219], v[188:191]
    v_mfma_f32_16x16x32_bf16 v[192:195], v[124:127], v[216:219], v[192:195]
    v_mfma_f32_16x16x32_bf16 v[196:199], v[128:131], v[216:219], v[196:199]
    v_mfma_f32_16x16x32_bf16 v[200:203], v[160:163], v[216:219], v[200:203]
    s_branch L_Tend
Lgrty_61:
    s_sleep 16
    buffer_load_dword v2, off, s[8:11], 0 offset:132 sc1
    s_sub_u32 s61, s61, 1
    s_mov_b32 s67, 1
    s_cbranch_scc1 L_fail
    s_branch Lgchk_60
Lprty_64:
    s_sleep 16
    buffer_load_dword v2, off, s[8:11], 0 offset:140 sc1
    s_sub_u32 s61, s61, 1
    s_mov_b32 s67, 16
    s_cbranch_scc1 L_fail
    s_branch Lpchk_63
Lfrty_66:
    s_sleep 4
    buffer_load_dword v244, v243, s[4:7], 0 offen sc1
    s_sub_u32 s61, s61, 1
    s_mov_b32 s67, 20
    s_cbranch_scc1 L_fail
    s_waitcnt vmcnt(0)
    s_branch Lfchk_65
L_roleB:
    s_mov_b32 s20, s48
    s_mov_b32 s21, s49
    s_mov_b32 s22, 2457600
    s_mov_b32 s23, 0x20000
    s_mov_b32 s24, s50
    s_mov_b32 s25, s51
    s_mov_b32 s26, 819200
    s_mov_b32 s27, 0x20000
    v_and_b32 v1, 63, v0
    s_lshl_b32 s76, s69, 1
    s_and_b32 s64, s59, 1
    s_add_u32 s76, s76, s64
    v_lshrrev_b32 v176, 4, v1
    v_bfe_u32 v177, v1, 2, 2
    v_and_b32 v178, 3, v1
    v_lshlrev_b32 v247, 4, v1
    v_and_b32 v169, 31, v1
    v_mul_u32_u24 v170, 26, v169
    v_lshrrev_b32 v170, 8, v170
    v_mul_u32_u24 v168, 1120, v170
    v_lshl_add_u32 v168, v169, 4, v168
    v_lshrrev_b32 v170, 5, v0
    v_mul_u32_u24 v170, 3840, v170
    s_mul_i32 s64, s76, 160
    v_add3_u32 v168, v168, v170, s64
    v_mov_b32 v170, 0x80000000
    v_cmp_gt_u32 vcc, 30, v169
    s_nop 1
    v_cndmask_b32 v168, v170, v168, vcc
    v_lshl_add_u32 v169, v176, 3, v177
    v_lshlrev_b32 v169, 9, v169
    s_mul_i32 s64, s60, 40
    v_mul_u32_u24 v171, 160, v178
    s_add_u32 s65, s64, 32
    v_mov_b32 v172, s65
    v_cmp_gt_u32 vcc, 3, v178
    s_nop 1
    v_cndmask_b32 v172, 0, v172, vcc
    v_add3_u32 v171, v171, v172, v169
    v_lshl_add_u32 v169, v178, 3, v169
    v_add_u32 v169, s64, v169
    v_add_u32 v170, 65536, v169
    v_add_u32 v172, 65536, v171
    v_lshl_add_u32 v173, v178, 2, v177
    v_lshl_add_u32 v173, v176, 4, v173
    v_lshlrev_b32 v173, 2, v173
    s_lshl_b32 s70, s60, 10
    s_cmp_lg_u32 s68, 0
    s_cbranch_scc1 Larr0_67
    s_waitcnt vmcnt(0)
    s_barrier
    s_cmp_lg_u32 s60, 0
    s_cbranch_scc1 Lcnt_68
    s_mov_b64 exec, 1
    v_mov_b32 v2, 1
    buffer_atomic_add v2, off, s[8:11], 0 offset:4 sc0
    v_mov_b32 v3, 0x80000000
    s_waitcnt vmcnt(0)
    v_cmp_ne_u32 vcc, 255, v2
    s_nop 1
    v_cndmask_b32 v3, 4, v3, vcc
    buffer_store_dword v2, v3, s[8:11], 0 offen offset:128 sc1
    s_mov_b64 exec, -1
Lcnt_68:
Larr0_67:
    s_mov_b32 s64, 0
    s_add_u32 m0, s70, 0
    s_nop 0
    buffer_load_dwordx4 v168, s[20:23], s64 offen nt lds
    s_mov_b32 s64, 30720
    s_add_u32 m0, s70, 4096
    s_nop 0
    buffer_load_dwordx4 v168, s[20:23], s64 offen nt lds
    s_mov_b32 s64, 61440
    s_add_u32 m0, s70, 8192
    s_nop 0
    buffer_load_dwordx4 v168, s[20:23], s64 offen nt lds
    s_mov_b32 s64, 92160
    s_add_u32 m0, s70, 12288
    s_nop 0
    buffer_load_dwordx4 v168, s[20:23], s64 offen nt lds
    s_mov_b32 s64, 122880
    s_add_u32 m0, s70, 16384
    s_nop 0
    buffer_load_dwordx4 v168, s[20:23], s64 offen nt lds
    s_mov_b32 s64, 153600
    s_add_u32 m0, s70, 20480
    s_nop 0
    buffer_load_dwordx4 v168, s[20:23], s64 offen nt lds
    s_mov_b32 s64, 184320
    s_add_u32 m0, s70, 24576
    s_nop 0
    buffer_load_dwordx4 v168, s[20:23], s64 offen nt lds
    s_mov_b32 s64, 215040
    s_add_u32 m0, s70, 28672
    s_nop 0
    buffer_load_dwordx4 v168, s[20:23], s64 offen nt lds
    s_mov_b32 s64, 245760
    s_add_u32 m0, s70, 32768
    s_nop 0
    buffer_load_dwordx4 v168, s[20:23], s64 offen nt lds
    s_mov_b32 s64, 276480
    s_add_u32 m0, s70, 36864
    s_nop 0
    buffer_load_dwordx4 v168, s[20:23], s64 offen nt lds
    s_mov_b32 s64, 307200
    s_add_u32 m0, s70, 40960
    s_nop 0
    buffer_load_dwordx4 v168, s[20:23], s64 offen nt lds
    s_mov_b32 s64, 337920
    s_add_u32 m0, s70, 45056
    s_nop 0
    buffer_load_dwordx4 v168, s[20:23], s64 offen nt lds
    s_mov_b32 s64, 368640
    s_add_u32 m0, s70, 49152
    s_nop 0
    buffer_load_dwordx4 v168, s[20:23], s64 offen nt lds
    s_mov_b32 s64, 399360
    s_add_u32 m0, s70, 53248
    s_nop 0
    buffer_load_dwordx4 v168, s[20:23], s64 offen nt lds
    s_mov_b32 s64, 430080
    s_add_u32 m0, s70, 57344
    s_nop 0
    buffer_load_dwordx4 v168, s[20:23], s64 offen nt lds
    s_mov_b32 s64, 460800
    s_add_u32 m0, s70, 61440
    s_nop 0
    buffer_load_dwordx4 v168, s[20:23], s64 offen nt lds
    s_mov_b32 s64, 491520
    s_add_u32 m0, s70, 65536
    s_nop 0
    buffer_load_dwordx4 v168, s[20:23], s64 offen nt lds
    s_mov_b32 s64, 522240
    s_add_u32 m0, s70, 69632
    s_nop 0
    buffer_load_dwordx4 v168, s[20:23], s64 offen nt lds
    s_mov_b32 s64, 552960
    s_add_u32 m0, s70, 73728
    s_nop 0
    buffer_load_dwordx4 v168, s[20:23], s64 offen nt lds
    s_mov_b32 s64, 583680
    s_add_u32 m0, s70, 77824
    s_nop 0
    buffer_load_dwordx4 v168, s[20:23], s64 offen nt lds
    s_mov_b32 s64, 614400
    s_add_u32 m0, s70, 81920
    s_nop 0
    buffer_load_dwordx4 v168, s[20:23], s64 offen nt lds
    s_mov_b32 s64, 645120
    s_add_u32 m0, s70, 86016
    s_nop 0
    buffer_load_dwordx4 v168, s[20:23], s64 offen nt lds
    s_mov_b32 s64, 675840
    s_add_u32 m0, s70, 90112
    s_nop 0
    buffer_load_dwordx4 v168, s[20:23], s64 offen nt lds
    s_mov_b32 s64, 706560
    s_add_u32 m0, s70, 94208
    s_nop 0
    buffer_load_dwordx4 v168, s[20:23], s64 offen nt lds
    s_mov_b32 s64, 737280
    s_add_u32 m0, s70, 98304
    s_nop 0
    buffer_load_dwordx4 v168, s[20:23], s64 offen nt lds
    s_mov_b32 s64, 768000
    s_add_u32 m0, s70, 102400
    s_nop 0
    buffer_load_dwordx4 v168, s[20:23], s64 offen nt lds
    s_mov_b32 s64, 798720
    s_add_u32 m0, s70, 106496
    s_nop 0
    buffer_load_dwordx4 v168, s[20:23], s64 offen nt lds
    s_mov_b32 s64, 829440
    s_add_u32 m0, s70, 110592
    s_nop 0
    buffer_load_dwordx4 v168, s[20:23], s64 offen nt lds
    s_waitcnt vmcnt(24)
    s_waitcnt lgkmcnt(0)
    s_barrier
    s_mov_b32 s64, 860160
    s_add_u32 m0, s70, 114688
    s_nop 0
    buffer_load_dwordx4 v168, s[20:23], s64 offen nt lds
    s_mov_b32 s64, 890880
    s_add_u32 m0, s70, 118784
    s_nop 0
    buffer_load_dwordx4 v168, s[20:23], s64 offen nt lds
    s_mov_b32 s64, 921600
    s_add_u32 m0, s70, 122880
    s_nop 0
    buffer_load_dwordx4 v168, s[20:23], s64 offen nt lds
    s_mov_b32 s64, 952320
    s_add_u32 m0, s70, 126976
    s_nop 0
    buffer_load_dwordx4 v168, s[20:23], s64 offen nt lds
    ds_read_b64_tr_b16 v[204:205], v171 offset:0
    ds_read_b64_tr_b16 v[206:207], v171 offset:2048
    ds_read_b64_tr_b16 a[0:1], v169 offset:0
    ds_read_b64_tr_b16 a[2:3], v169 offset:2048
    ds_read_b64_tr_b16 a[80:81], v169 offset:160
    ds_read_b64_tr_b16 a[82:83], v169 offset:2208
    ds_read_b64_tr_b16 a[160:161], v169 offset:320
    ds_read_b64_tr_b16 a[162:163], v169 offset:2368
    s_waitcnt lgkmcnt(7)
    ds_bpermute_b32 v4, v173, v204
    ds_bpermute_b32 v5, v173, v205
    s_waitcnt lgkmcnt(8)
    ds_bpermute_b32 v6, v173, v206
    ds_bpermute_b32 v7, v173, v207
    s_waitcnt vmcnt(24)
    s_waitcnt lgkmcnt(0)
    s_barrier
    s_mov_b32 s64, 983040
    s_add_u32 m0, s70, 0
    s_nop 0
    buffer_load_dwordx4 v168, s[20:23], s64 offen nt lds
    s_mov_b32 s64, 1013760
    s_add_u32 m0, s70, 4096
    s_nop 0
    buffer_load_dwordx4 v168, s[20:23], s64 offen nt lds
    s_mov_b32 s64, 1044480
    s_add_u32 m0, s70, 8192
    s_nop 0
    buffer_load_dwordx4 v168, s[20:23], s64 offen nt lds
    s_mov_b32 s64, 1075200
    s_add_u32 m0, s70, 12288
    s_nop 0
    buffer_load_dwordx4 v168, s[20:23], s64 offen nt lds
    ds_read_b64_tr_b16 v[204:205], v171 offset:16384
    ds_read_b64_tr_b16 v[206:207], v171 offset:18432
    ds_read_b64_tr_b16 a[4:5], v169 offset:16384
    ds_read_b64_tr_b16 a[6:7], v169 offset:18432
    ds_read_b64_tr_b16 a[84:85], v169 offset:16544
    ds_read_b64_tr_b16 a[86:87], v169 offset:18592
    ds_read_b64_tr_b16 a[164:165], v169 offset:16704
    ds_read_b64_tr_b16 a[166:167], v169 offset:18752
    s_waitcnt lgkmcnt(7)
    ds_bpermute_b32 v8, v173, v204
    ds_bpermute_b32 v9, v173, v205
    s_waitcnt lgkmcnt(8)
    ds_bpermute_b32 v10, v173, v206
    ds_bpermute_b32 v11, v173, v207
    s_waitcnt vmcnt(24)
    s_waitcnt lgkmcnt(0)
    s_barrier
    s_mov_b32 s64, 1105920
    s_add_u32 m0, s70, 16384
    s_nop 0
    buffer_load_dwordx4 v168, s[20:23], s64 offen nt lds
    s_mov_b32 s64, 1136640
    s_add_u32 m0, s70, 20480
    s_nop 0
    buffer_load_dwordx4 v168, s[20:23], s64 offen nt lds
    s_mov_b32 s64, 1167360
    s_add_u32 m0, s70, 24576
    s_nop 0
    buffer_load_dwordx4 v168, s[20:23], s64 offen nt lds
    s_mov_b32 s64, 1198080
    s_add_u32 m0, s70, 28672
    s_nop 0
    buffer_load_dwordx4 v168, s[20:23], s64 offen nt lds
    ds_read_b64_tr_b16 v[204:205], v171 offset:32768
    ds_read_b64_tr_b16 v[206:207], v171 offset:34816
    ds_read_b64_tr_b16 a[8:9], v169 offset:32768
    ds_read_b64_tr_b16 a[10:11], v169 offset:34816
    ds_read_b64_tr_b16 a[88:89], v169 offset:32928
    ds_read_b64_tr_b16 a[90:91], v169 offset:34976
    ds_read_b64_tr_b16 a[168:169], v169 offset:33088
    ds_read_b64_tr_b16 a[170:171], v169 offset:35136
    s_waitcnt lgkmcnt(7)
    ds_bpermute_b32 v12, v173, v204
    ds_bpermute_b32 v13, v173, v205
    s_waitcnt lgkmcnt(8)
    ds_bpermute_b32 v14, v173, v206
    ds_bpermute_b32 v15, v173, v207
    s_waitcnt vmcnt(24)
    s_waitcnt lgkmcnt(0)
    s_barrier
    s_mov_b32 s64, 1228800
    s_add_u32 m0, s70, 32768
    s_nop 0
    buffer_load_dwordx4 v168, s[20:23], s64 offen nt lds
    s_mov_b32 s64, 1259520
    s_add_u32 m0, s70, 36864
    s_nop 0
    buffer_load_dwordx4 v168, s[20:23], s64 offen nt lds
    s_mov_b32 s64, 1290240
    s_add_u32 m0, s70, 40960
    s_nop 0
    buffer_load_dwordx4 v168, s[20:23], s64 offen nt lds
    s_mov_b32 s64, 1320960
    s_add_u32 m0, s70, 45056
    s_nop 0
    buffer_load_dwordx4 v168, s[20:23], s64 offen nt lds
    ds_read_b64_tr_b16 v[204:205], v171 offset:49152
    ds_read_b64_tr_b16 v[206:207], v171 offset:51200
    ds_read_b64_tr_b16 a[12:13], v169 offset:49152
    ds_read_b64_tr_b16 a[14:15], v169 offset:51200
    ds_read_b64_tr_b16 a[92:93], v169 offset:49312
    ds_read_b64_tr_b16 a[94:95], v169 offset:51360
    ds_read_b64_tr_b16 a[172:173], v169 offset:49472
    ds_read_b64_tr_b16 a[174:175], v169 offset:51520
    s_waitcnt lgkmcnt(7)
    ds_bpermute_b32 v16, v173, v204
    ds_bpermute_b32 v17, v173, v205
    s_waitcnt lgkmcnt(8)
    ds_bpermute_b32 v18, v173, v206
    ds_bpermute_b32 v19, v173, v207
    s_waitcnt vmcnt(24)
    s_waitcnt lgkmcnt(0)
    s_barrier
    s_mov_b32 s64, 1351680
    s_add_u32 m0, s70, 49152
    s_nop 0
    buffer_load_dwordx4 v168, s[20:23], s64 offen nt lds
    s_mov_b32 s64, 1382400
    s_add_u32 m0, s70, 53248
    s_nop 0
    buffer_load_dwordx4 v168, s[20:23], s64 offen nt lds
    s_mov_b32 s64, 1413120
    s_add_u32 m0, s70, 57344
    s_nop 0
    buffer_load_dwordx4 v168, s[20:23], s64 offen nt lds
    s_mov_b32 s64, 1443840
    s_add_u32 m0, s70, 61440
    s_nop 0
    buffer_load_dwordx4 v168, s[20:23], s64 offen nt lds
    ds_read_b64_tr_b16 v[204:205], v172 offset:0
    ds_read_b64_tr_b16 v[206:207], v172 offset:2048
    ds_read_b64_tr_b16 a[16:17], v170 offset:0
    ds_read_b64_tr_b16 a[18:19], v170 offset:2048
    ds_read_b64_tr_b16 a[96:97], v170 offset:160
    ds_read_b64_tr_b16 a[98:99], v170 offset:2208
    ds_read_b64_tr_b16 a[176:177], v170 offset:320
    ds_read_b64_tr_b16 a[178:179], v170 offset:2368
    s_waitcnt lgkmcnt(7)
    ds_bpermute_b32 v20, v173, v204
    ds_bpermute_b32 v21, v173, v205
    s_waitcnt lgkmcnt(8)
    ds_bpermute_b32 v22, v173, v206
    ds_bpermute_b32 v23, v173, v207
    s_waitcnt vmcnt(24)
    s_waitcnt lgkmcnt(0)
    s_barrier
    s_mov_b32 s64, 1474560
    s_add_u32 m0, s70, 65536
    s_nop 0
    buffer_load_dwordx4 v168, s[20:23], s64 offen nt lds
    s_mov_b32 s64, 1505280
    s_add_u32 m0, s70, 69632
    s_nop 0
    buffer_load_dwordx4 v168, s[20:23], s64 offen nt lds
    s_mov_b32 s64, 1536000
    s_add_u32 m0, s70, 73728
    s_nop 0
    buffer_load_dwordx4 v168, s[20:23], s64 offen nt lds
    s_mov_b32 s64, 1566720
    s_add_u32 m0, s70, 77824
    s_nop 0
    buffer_load_dwordx4 v168, s[20:23], s64 offen nt lds
    ds_read_b64_tr_b16 v[204:205], v172 offset:16384
    ds_read_b64_tr_b16 v[206:207], v172 offset:18432
    ds_read_b64_tr_b16 a[20:21], v170 offset:16384
    ds_read_b64_tr_b16 a[22:23], v170 offset:18432
    ds_read_b64_tr_b16 a[100:101], v170 offset:16544
    ds_read_b64_tr_b16 a[102:103], v170 offset:18592
    ds_read_b64_tr_b16 a[180:181], v170 offset:16704
    ds_read_b64_tr_b16 a[182:183], v170 offset:18752
    s_waitcnt lgkmcnt(7)
    ds_bpermute_b32 v24, v173, v204
    ds_bpermute_b32 v25, v173, v205
    s_waitcnt lgkmcnt(8)
    ds_bpermute_b32 v26, v173, v206
    ds_bpermute_b32 v27, v173, v207
    s_waitcnt vmcnt(24)
    s_waitcnt lgkmcnt(0)
    s_barrier
    s_mov_b32 s64, 1597440
    s_add_u32 m0, s70, 81920
    s_nop 0
    buffer_load_dwordx4 v168, s[20:23], s64 offen nt lds
    s_mov_b32 s64, 1628160
    s_add_u32 m0, s70, 86016
    s_nop 0
    buffer_load_dwordx4 v168, s[20:23], s64 offen nt lds
    s_mov_b32 s64, 1658880
    s_add_u32 m0, s70, 90112
    s_nop 0
    buffer_load_dwordx4 v168, s[20:23], s64 offen nt lds
    s_mov_b32 s64, 1689600
    s_add_u32 m0, s70, 94208
    s_nop 0
    buffer_load_dwordx4 v168, s[20:23], s64 offen nt lds
    ds_read_b64_tr_b16 v[204:205], v172 offset:32768
    ds_read_b64_tr_b16 v[206:207], v172 offset:34816
    ds_read_b64_tr_b16 a[24:25], v170 offset:32768
    ds_read_b64_tr_b16 a[26:27], v170 offset:34816
    ds_read_b64_tr_b16 a[104:105], v170 offset:32928
    ds_read_b64_tr_b16 a[106:107], v170 offset:34976
    ds_read_b64_tr_b16 a[184:185], v170 offset:33088
    ds_read_b64_tr_b16 a[186:187], v170 offset:35136
    s_waitcnt lgkmcnt(7)
    ds_bpermute_b32 v28, v173, v204
    ds_bpermute_b32 v29, v173, v205
    s_waitcnt lgkmcnt(8)
    ds_bpermute_b32 v30, v173, v206
    ds_bpermute_b32 v31, v173, v207
    s_waitcnt vmcnt(24)
    s_waitcnt lgkmcnt(0)
    s_barrier
    s_mov_b32 s64, 1720320
    s_add_u32 m0, s70, 98304
    s_nop 0
    buffer_load_dwordx4 v168, s[20:23], s64 offen nt lds
    s_mov_b32 s64, 1751040
    s_add_u32 m0, s70, 102400
    s_nop 0
    buffer_load_dwordx4 v168, s[20:23], s64 offen nt lds
    s_mov_b32 s64, 1781760
    s_add_u32 m0, s70, 106496
    s_nop 0
    buffer_load_dwordx4 v168, s[20:23], s64 offen nt lds
    s_mov_b32 s64, 1812480
    s_add_u32 m0, s70, 110592
    s_nop 0
    buffer_load_dwordx4 v168, s[20:23], s64 offen nt lds
    ds_read_b64_tr_b16 v[204:205], v172 offset:49152
    ds_read_b64_tr_b16 v[206:207], v172 offset:51200
    ds_read_b64_tr_b16 a[28:29], v170 offset:49152
    ds_read_b64_tr_b16 a[30:31], v170 offset:51200
    ds_read_b64_tr_b16 a[108:109], v170 offset:49312
    ds_read_b64_tr_b16 a[110:111], v170 offset:51360
    ds_read_b64_tr_b16 a[188:189], v170 offset:49472
    ds_read_b64_tr_b16 a[190:191], v170 offset:51520
    s_waitcnt lgkmcnt(7)
    ds_bpermute_b32 v32, v173, v204
    ds_bpermute_b32 v33, v173, v205
    s_waitcnt lgkmcnt(8)
    ds_bpermute_b32 v34, v173, v206
    ds_bpermute_b32 v35, v173, v207
    s_waitcnt vmcnt(24)
    s_waitcnt lgkmcnt(0)
    s_barrier
    s_mov_b32 s64, 1843200
    s_add_u32 m0, s70, 114688
    s_nop 0
    buffer_load_dwordx4 v168, s[20:23], s64 offen nt lds
    s_mov_b32 s64, 1873920
    s_add_u32 m0, s70, 118784
    s_nop 0
    buffer_load_dwordx4 v168, s[20:23], s64 offen nt lds
    s_mov_b32 s64, 1904640
    s_add_u32 m0, s70, 122880
    s_nop 0
    buffer_load_dwordx4 v168, s[20:23], s64 offen nt lds
    s_mov_b32 s64, 1935360
    s_add_u32 m0, s70, 126976
    s_nop 0
    buffer_load_dwordx4 v168, s[20:23], s64 offen nt lds
    ds_read_b64_tr_b16 v[204:205], v171 offset:0
    ds_read_b64_tr_b16 v[206:207], v171 offset:2048
    ds_read_b64_tr_b16 a[32:33], v169 offset:0
    ds_read_b64_tr_b16 a[34:35], v169 offset:2048
    ds_read_b64_tr_b16 a[112:113], v169 offset:160
    ds_read_b64_tr_b16 a[114:115], v169 offset:2208
    ds_read_b64_tr_b16 a[192:193], v169 offset:320
    ds_read_b64_tr_b16 a[194:195], v169 offset:2368
    s_waitcnt lgkmcnt(7)
    ds_bpermute_b32 v36, v173, v204
    ds_bpermute_b32 v37, v173, v205
    s_waitcnt lgkmcnt(8)
    ds_bpermute_b32 v38, v173, v206
    ds_bpermute_b32 v39, v173, v207
    s_waitcnt vmcnt(24)
    s_waitcnt lgkmcnt(0)
    s_barrier
    s_mov_b32 s64, 1966080
    s_add_u32 m0, s70, 0
    s_nop 0
    buffer_load_dwordx4 v168, s[20:23], s64 offen nt lds
    s_mov_b32 s64, 1996800
    s_add_u32 m0, s70, 4096
    s_nop 0
    buffer_load_dwordx4 v168, s[20:23], s64 offen nt lds
    s_mov_b32 s64, 2027520
    s_add_u32 m0, s70, 8192
    s_nop 0
    buffer_load_dwordx4 v168, s[20:23], s64 offen nt lds
    s_mov_b32 s64, 2058240
    s_add_u32 m0, s70, 12288
    s_nop 0
    buffer_load_dwordx4 v168, s[20:23], s64 offen nt lds
    ds_read_b64_tr_b16 v[204:205], v171 offset:16384
    ds_read_b64_tr_b16 v[206:207], v171 offset:18432
    ds_read_b64_tr_b16 a[36:37], v169 offset:16384
    ds_read_b64_tr_b16 a[38:39], v169 offset:18432
    ds_read_b64_tr_b16 a[116:117], v169 offset:16544
    ds_read_b64_tr_b16 a[118:119], v169 offset:18592
    ds_read_b64_tr_b16 a[196:197], v169 offset:16704
    ds_read_b64_tr_b16 a[198:199], v169 offset:18752
    s_waitcnt lgkmcnt(7)
    ds_bpermute_b32 v40, v173, v204
    ds_bpermute_b32 v41, v173, v205
    s_waitcnt lgkmcnt(8)
    ds_bpermute_b32 v42, v173, v206
    ds_bpermute_b32 v43, v173, v207
    s_waitcnt vmcnt(24)
    s_waitcnt lgkmcnt(0)
    s_barrier
    s_mov_b32 s64, 2088960
    s_add_u32 m0, s70, 16384
    s_nop 0
    buffer_load_dwordx4 v168, s[20:23], s64 offen nt lds
    s_mov_b32 s64, 2119680
    s_add_u32 m0, s70, 20480
    s_nop 0
    buffer_load_dwordx4 v168, s[20:23], s64 offen nt lds
    s_mov_b32 s64, 2150400
    s_add_u32 m0, s70, 24576
    s_nop 0
    buffer_load_dwordx4 v168, s[20:23], s64 offen nt lds
    s_mov_b32 s64, 2181120
    s_add_u32 m0, s70, 28672
    s_nop 0
    buffer_load_dwordx4 v168, s[20:23], s64 offen nt lds
    ds_read_b64_tr_b16 v[204:205], v171 offset:32768
    ds_read_b64_tr_b16 v[206:207], v171 offset:34816
    ds_read_b64_tr_b16 a[40:41], v169 offset:32768
    ds_read_b64_tr_b16 a[42:43], v169 offset:34816
    ds_read_b64_tr_b16 a[120:121], v169 offset:32928
    ds_read_b64_tr_b16 a[122:123], v169 offset:34976
    ds_read_b64_tr_b16 a[200:201], v169 offset:33088
    ds_read_b64_tr_b16 a[202:203], v169 offset:35136
    s_waitcnt lgkmcnt(7)
    ds_bpermute_b32 v44, v173, v204
    ds_bpermute_b32 v45, v173, v205
    s_waitcnt lgkmcnt(8)
    ds_bpermute_b32 v46, v173, v206
    ds_bpermute_b32 v47, v173, v207
    s_waitcnt vmcnt(24)
    s_waitcnt lgkmcnt(0)
    s_barrier
    s_mov_b32 s64, 2211840
    s_add_u32 m0, s70, 32768
    s_nop 0
    buffer_load_dwordx4 v168, s[20:23], s64 offen nt lds
    s_mov_b32 s64, 2242560
    s_add_u32 m0, s70, 36864
    s_nop 0
    buffer_load_dwordx4 v168, s[20:23], s64 offen nt lds
    s_mov_b32 s64, 2273280
    s_add_u32 m0, s70, 40960
    s_nop 0
    buffer_load_dwordx4 v168, s[20:23], s64 offen nt lds
    s_mov_b32 s64, 2304000
    s_add_u32 m0, s70, 45056
    s_nop 0
    buffer_load_dwordx4 v168, s[20:23], s64 offen nt lds
    ds_read_b64_tr_b16 v[204:205], v171 offset:49152
    ds_read_b64_tr_b16 v[206:207], v171 offset:51200
    ds_read_b64_tr_b16 a[44:45], v169 offset:49152
    ds_read_b64_tr_b16 a[46:47], v169 offset:51200
    ds_read_b64_tr_b16 a[124:125], v169 offset:49312
    ds_read_b64_tr_b16 a[126:127], v169 offset:51360
    ds_read_b64_tr_b16 a[204:205], v169 offset:49472
    ds_read_b64_tr_b16 a[206:207], v169 offset:51520
    s_waitcnt lgkmcnt(7)
    ds_bpermute_b32 v48, v173, v204
    ds_bpermute_b32 v49, v173, v205
    s_waitcnt lgkmcnt(8)
    ds_bpermute_b32 v50, v173, v206
    ds_bpermute_b32 v51, v173, v207
    s_waitcnt vmcnt(24)
    s_waitcnt lgkmcnt(0)
    s_barrier
    s_mov_b32 s64, 2334720
    s_add_u32 m0, s70, 49152
    s_nop 0
    buffer_load_dwordx4 v168, s[20:23], s64 offen nt lds
    s_mov_b32 s64, 2365440
    s_add_u32 m0, s70, 53248
    s_nop 0
    buffer_load_dwordx4 v168, s[20:23], s64 offen nt lds
    s_mov_b32 s64, 2396160
    s_add_u32 m0, s70, 57344
    s_nop 0
    buffer_load_dwordx4 v168, s[20:23], s64 offen nt lds
    s_mov_b32 s64, 2426880
    s_add_u32 m0, s70, 61440
    s_nop 0
    buffer_load_dwordx4 v168, s[20:23], s64 offen nt lds
    ds_read_b64_tr_b16 v[204:205], v172 offset:0
    ds_read_b64_tr_b16 v[206:207], v172 offset:2048
    ds_read_b64_tr_b16 a[48:49], v170 offset:0
    ds_read_b64_tr_b16 a[50:51], v170 offset:2048
    ds_read_b64_tr_b16 a[128:129], v170 offset:160
    ds_read_b64_tr_b16 a[130:131], v170 offset:2208
    ds_read_b64_tr_b16 a[208:209], v170 offset:320
    ds_read_b64_tr_b16 a[210:211], v170 offset:2368
    s_waitcnt lgkmcnt(7)
    ds_bpermute_b32 v52, v173, v204
    ds_bpermute_b32 v53, v173, v205
    s_waitcnt lgkmcnt(8)
    ds_bpermute_b32 v54, v173, v206
    ds_bpermute_b32 v55, v173, v207
    s_waitcnt vmcnt(24)
    s_waitcnt lgkmcnt(0)
    s_barrier
    ds_read_b64_tr_b16 v[204:205], v172 offset:16384
    ds_read_b64_tr_b16 v[206:207], v172 offset:18432
    ds_read_b64_tr_b16 a[52:53], v170 offset:16384
    ds_read_b64_tr_b16 a[54:55], v170 offset:18432
    ds_read_b64_tr_b16 a[132:133], v170 offset:16544
    ds_read_b64_tr_b16 a[134:135], v170 offset:18592
    ds_read_b64_tr_b16 a[212:213], v170 offset:16704
    ds_read_b64_tr_b16 a[214:215], v170 offset:18752
    s_waitcnt lgkmcnt(7)
    ds_bpermute_b32 v56, v173, v204
    ds_bpermute_b32 v57, v173, v205
    s_waitcnt lgkmcnt(8)
    ds_bpermute_b32 v58, v173, v206
    ds_bpermute_b32 v59, v173, v207
    s_waitcnt vmcnt(20)
    s_waitcnt lgkmcnt(0)
    s_barrier
    ds_read_b64_tr_b16 v[204:205], v172 offset:32768
    ds_read_b64_tr_b16 v[206:207], v172 offset:34816
    ds_read_b64_tr_b16 a[56:57], v170 offset:32768
    ds_read_b64_tr_b16 a[58:59], v170 offset:34816
    ds_read_b64_tr_b16 a[136:137], v170 offset:32928
    ds_read_b64_tr_b16 a[138:139], v170 offset:34976
    ds_read_b64_tr_b16 a[216:217], v170 offset:33088
    ds_read_b64_tr_b16 a[218:219], v170 offset:35136
    s_waitcnt lgkmcnt(7)
    ds_bpermute_b32 v60, v173, v204
    ds_bpermute_b32 v61, v173, v205
    s_waitcnt lgkmcnt(8)
    ds_bpermute_b32 v62, v173, v206
    ds_bpermute_b32 v63, v173, v207
    s_waitcnt vmcnt(16)
    s_waitcnt lgkmcnt(0)
    s_barrier
    ds_read_b64_tr_b16 v[204:205], v172 offset:49152
    ds_read_b64_tr_b16 v[206:207], v172 offset:51200
    ds_read_b64_tr_b16 a[60:61], v170 offset:49152
    ds_read_b64_tr_b16 a[62:63], v170 offset:51200
    ds_read_b64_tr_b16 a[140:141], v170 offset:49312
    ds_read_b64_tr_b16 a[142:143], v170 offset:51360
    ds_read_b64_tr_b16 a[220:221], v170 offset:49472
    ds_read_b64_tr_b16 a[222:223], v170 offset:51520
    s_waitcnt lgkmcnt(7)
    ds_bpermute_b32 v64, v173, v204
    ds_bpermute_b32 v65, v173, v205
    s_waitcnt lgkmcnt(8)
    ds_bpermute_b32 v66, v173, v206
    ds_bpermute_b32 v67, v173, v207
    s_waitcnt vmcnt(12)
    s_waitcnt lgkmcnt(0)
    s_barrier
    ds_read_b64_tr_b16 v[204:205], v171 offset:0
    ds_read_b64_tr_b16 v[206:207], v171 offset:2048
    ds_read_b64_tr_b16 a[64:65], v169 offset:0
    ds_read_b64_tr_b16 a[66:67], v169 offset:2048
    ds_read_b64_tr_b16 a[144:145], v169 offset:160
    ds_read_b64_tr_b16 a[146:147], v169 offset:2208
    ds_read_b64_tr_b16 a[224:225], v169 offset:320
    ds_read_b64_tr_b16 a[226:227], v169 offset:2368
    s_waitcnt lgkmcnt(7)
    ds_bpermute_b32 v68, v173, v204
    ds_bpermute_b32 v69, v173, v205
    s_waitcnt lgkmcnt(8)
    ds_bpermute_b32 v70, v173, v206
    ds_bpermute_b32 v71, v173, v207
    s_waitcnt vmcnt(8)
    s_waitcnt lgkmcnt(0)
    s_barrier
    ds_read_b64_tr_b16 v[204:205], v171 offset:16384
    ds_read_b64_tr_b16 v[206:207], v171 offset:18432
    ds_read_b64_tr_b16 a[68:69], v169 offset:16384
    ds_read_b64_tr_b16 a[70:71], v169 offset:18432
    ds_read_b64_tr_b16 a[148:149], v169 offset:16544
    ds_read_b64_tr_b16 a[150:151], v169 offset:18592
    ds_read_b64_tr_b16 a[228:229], v169 offset:16704
    ds_read_b64_tr_b16 a[230:231], v169 offset:18752
    s_waitcnt lgkmcnt(7)
    ds_bpermute_b32 v72, v173, v204
    ds_bpermute_b32 v73, v173, v205
    s_waitcnt lgkmcnt(8)
    ds_bpermute_b32 v74, v173, v206
    ds_bpermute_b32 v75, v173, v207
    s_waitcnt vmcnt(4)
    s_waitcnt lgkmcnt(0)
    s_barrier
    ds_read_b64_tr_b16 v[204:205], v171 offset:32768
    ds_read_b64_tr_b16 v[206:207], v171 offset:34816
    ds_read_b64_tr_b16 a[72:73], v169 offset:32768
    ds_read_b64_tr_b16 a[74:75], v169 offset:34816
    ds_read_b64_tr_b16 a[152:153], v169 offset:32928
    ds_read_b64_tr_b16 a[154:155], v169 offset:34976
    ds_read_b64_tr_b16 a[232:233], v169 offset:33088
    ds_read_b64_tr_b16 a[234:235], v169 offset:35136
    s_waitcnt lgkmcnt(7)
    ds_bpermute_b32 v76, v173, v204
    ds_bpermute_b32 v77, v173, v205
    s_waitcnt lgkmcnt(8)
    ds_bpermute_b32 v78, v173, v206
    ds_bpermute_b32 v79, v173, v207
    s_waitcnt vmcnt(0)
    s_waitcnt lgkmcnt(0)
    s_barrier
    ds_read_b64_tr_b16 v[204:205], v171 offset:49152
    ds_read_b64_tr_b16 v[206:207], v171 offset:51200
    ds_read_b64_tr_b16 a[76:77], v169 offset:49152
    ds_read_b64_tr_b16 a[78:79], v169 offset:51200
    ds_read_b64_tr_b16 a[156:157], v169 offset:49312
    ds_read_b64_tr_b16 a[158:159], v169 offset:51360
    ds_read_b64_tr_b16 a[236:237], v169 offset:49472
    ds_read_b64_tr_b16 a[238:239], v169 offset:51520
    s_waitcnt lgkmcnt(7)
    ds_bpermute_b32 v80, v173, v204
    ds_bpermute_b32 v81, v173, v205
    s_waitcnt lgkmcnt(8)
    ds_bpermute_b32 v82, v173, v206
    ds_bpermute_b32 v83, v173, v207
    s_waitcnt lgkmcnt(0)
    s_barrier
    v_lshlrev_b32 v168, 4, v0
    s_mul_i32 s64, s76, 102400
    s_add_u32 s65, s64, 102400
    s_mov_b32 m0, s70
Lstgb_69:
    s_nop 0
    buffer_load_dwordx4 v168, s[24:27], s64 offen nt lds
    s_add_u32 m0, m0, 4096
    s_add_u32 s64, s64, 4096
    s_cmp_lt_u32 s64, s65
    s_cbranch_scc1 Lstgb_69
    v_lshl_add_u32 v169, v176, 2, v177
    v_mul_u32_u24 v169, 1280, v169
    v_mul_u32_u24 v171, 20, v177
    v_add3_u32 v171, v171, v176, 16
    v_mul_u32_u24 v171, 1280, v171
    s_lshl_b32 s64, s60, 6
    v_lshl_add_u32 v173, v178, 3, s64
    v_add_u32 v170, v169, v173
    v_add_u32 v172, v171, v173
    v_lshl_add_u32 v169, v173, 1, v169
    v_lshl_add_u32 v171, v173, 1, v171
    v_add_u32 v174, 51200, v169
    v_add_u32 v175, 51200, v170
    s_waitcnt vmcnt(0)
    s_barrier
    ds_read_b64_tr_b16 v[84:85], v169 offset:0
    ds_read_b64_tr_b16 v[86:87], v169 offset:25600
    ds_read_b64_tr_b16 v[88:89], v174 offset:0
    ds_read_b64_tr_b16 v[90:91], v174 offset:25600
    ds_read_b64_tr_b16 a[240:241], v171 offset:0
    ds_read_b64_tr_b16 v[92:93], v169 offset:8
    ds_read_b64_tr_b16 v[94:95], v169 offset:25608
    ds_read_b64_tr_b16 v[96:97], v174 offset:8
    ds_read_b64_tr_b16 v[98:99], v174 offset:25608
    ds_read_b64_tr_b16 a[242:243], v171 offset:8
    ds_read_b64_tr_b16 v[100:101], v169 offset:512
    ds_read_b64_tr_b16 v[102:103], v169 offset:26112
    ds_read_b64_tr_b16 v[104:105], v174 offset:512
    ds_read_b64_tr_b16 v[106:107], v174 offset:26112
    ds_read_b64_tr_b16 a[244:245], v171 offset:512
    ds_read_b64_tr_b16 v[108:109], v169 offset:520
    ds_read_b64_tr_b16 v[110:111], v169 offset:26120
    ds_read_b64_tr_b16 v[112:113], v174 offset:520
    ds_read_b64_tr_b16 v[114:115], v174 offset:26120
    ds_read_b64_tr_b16 a[246:247], v171 offset:520
    ds_read_b64_tr_b16 v[116:117], v170 offset:1024
    ds_read_b64_tr_b16 v[118:119], v170 offset:26624
    ds_read_b64_tr_b16 v[120:121], v175 offset:1024
    ds_read_b64_tr_b16 v[122:123], v175 offset:26624
    ds_read_b64_tr_b16 a[248:249], v172 offset:1024
    ds_read_b64_tr_b16 v[124:125], v169 offset:64
    ds_read_b64_tr_b16 v[126:127], v169 offset:25664
    ds_read_b64_tr_b16 v[128:129], v174 offset:64
    ds_read_b64_tr_b16 v[130:131], v174 offset:25664
    ds_read_b64_tr_b16 a[250:251], v171 offset:64
    ds_read_b64_tr_b16 v[132:133], v169 offset:72
    ds_read_b64_tr_b16 v[134:135], v169 offset:25672
    ds_read_b64_tr_b16 v[136:137], v174 offset:72
    ds_read_b64_tr_b16 v[138:139], v174 offset:25672
    ds_read_b64_tr_b16 a[252:253], v171 offset:72
    ds_read_b64_tr_b16 v[140:141], v169 offset:576
    ds_read_b64_tr_b16 v[142:143], v169 offset:26176
    ds_read_b64_tr_b16 v[144:145], v174 offset:576
    ds_read_b64_tr_b16 v[146:147], v174 offset:26176
    ds_read_b64_tr_b16 a[254:255], v171 offset:576
    ds_read_b64_tr_b16 v[148:149], v169 offset:584
    ds_read_b64_tr_b16 v[150:151], v169 offset:26184
    ds_read_b64_tr_b16 v[152:153], v174 offset:584
    ds_read_b64_tr_b16 v[154:155], v174 offset:26184
    ds_read_b64_tr_b16 v[164:165], v171 offset:584
    ds_read_b64_tr_b16 v[156:157], v170 offset:1056
    ds_read_b64_tr_b16 v[158:159], v170 offset:26656
    ds_read_b64_tr_b16 v[160:161], v175 offset:1056
    ds_read_b64_tr_b16 v[162:163], v175 offset:26656
    ds_read_b64_tr_b16 v[166:167], v172 offset:1056
    s_waitcnt lgkmcnt(0)
    s_barrier
    v_and_b32 v179, 7, v1
    v_bfe_u32 v180, v1, 3, 1
    v_lshlrev_b32 v244, 4, v0
    v_lshlrev_b32 v255, 3, v1
    v_mul_u32_u24 v245, 10240, v180
    v_lshl_add_u32 v245, v179, 7, v245
    v_xor_b32 v181, v176, v179
    v_lshl_add_u32 v245, v181, 4, v245
    v_xor_b32 v246, 64, v245
    v_and_b32 v168, 15, v1
    v_lshlrev_b32 v181, 2, v176
    v_cmp_eq_u32 vcc, v168, v181
    s_nop 1
    v_cndmask_b32 v242, 0, 1.0, vcc
    v_mov_b32 v182, 0x3f803f80
    v_cmp_eq_u32 vcc, 1, v178
    s_nop 1
    v_cndmask_b32 v243, 0, v182, vcc
    v_sub_u32 v181, v168, v181
    v_mov_b32 v182, 0xff800000
    v_add_u32 v169, 16, v181
    v_and_b32 v169, 0xfffffff1, v169
    v_cmp_eq_u32 vcc, 0, v169
    s_nop 1
    v_cndmask_b32 v204, v182, 0, vcc
    v_add_u32 v169, 15, v181
    v_and_b32 v169, 0xfffffff1, v169
    v_cmp_eq_u32 vcc, 0, v169
    s_nop 1
    v_cndmask_b32 v205, v182, 0, vcc
    v_add_u32 v169, 14, v181
    v_and_b32 v169, 0xfffffff1, v169
    v_cmp_eq_u32 vcc, 0, v169
    s_nop 1
    v_cndmask_b32 v206, v182, 0, vcc
    v_add_u32 v169, 13, v181
    v_and_b32 v169, 0xfffffff1, v169
    v_cmp_eq_u32 vcc, 0, v169
    s_nop 1
    v_cndmask_b32 v207, v182, 0, vcc
    v_add_u32 v169, 0, v181
    v_and_b32 v169, 0xfffffff1, v169
    v_cmp_eq_u32 vcc, 0, v169
    s_nop 1
    v_cndmask_b32 v208, v182, 0, vcc
    v_add_u32 v169, -1, v181
    v_and_b32 v169, 0xfffffff1, v169
    v_cmp_eq_u32 vcc, 0, v169
    s_nop 1
    v_cndmask_b32 v209, v182, 0, vcc
    v_add_u32 v169, -2, v181
    v_and_b32 v169, 0xfffffff1, v169
    v_cmp_eq_u32 vcc, 0, v169
    s_nop 1
    v_cndmask_b32 v210, v182, 0, vcc
    v_add_u32 v169, -3, v181
    v_and_b32 v169, 0xfffffff1, v169
    v_cmp_eq_u32 vcc, 0, v169
    s_nop 1
    v_cndmask_b32 v211, v182, 0, vcc
    v_mov_b32 v212, v182
    v_mov_b32 v213, v182
    v_mov_b32 v214, v182
    v_mov_b32 v215, v182
    v_mov_b32 v220, 0
    v_mov_b32 v221, 0
    v_mov_b32 v222, 0
    v_mov_b32 v223, 0
    v_mov_b32 v224, 0
    v_mov_b32 v225, 0
    v_mov_b32 v226, 0
    v_mov_b32 v227, 0
    v_mov_b32 v228, 0
    v_mov_b32 v229, 0
    v_mov_b32 v230, 0
    v_mov_b32 v231, 0
    v_mov_b32 v232, 0
    v_mov_b32 v233, 0
    v_mov_b32 v234, 0
    v_mov_b32 v235, 0
    v_mov_b32 v236, 0
    v_mov_b32 v237, 0
    v_mov_b32 v238, 0
    v_mov_b32 v239, 0
    ds_write_b128 v247, v[204:207] offset:5120
    ds_write_b128 v247, v[208:211] offset:6144
    ds_write_b128 v247, v[212:215] offset:7168
    v_add_u32 v248, 2048, v247
    s_lshr_b32 s64, s60, 1
    s_lshl_b32 s64, s64, 10
    s_and_b32 s65, s60, 1
    s_lshl_b32 s65, s65, 3
    s_add_u32 s64, s64, s65
    v_add_u32 v249, s64, v247
    s_lshl_b32 s64, s60, 1
    v_lshl_add_u32 v250, v1, 3, s64
    v_lshlrev_b32 v252, 5, v168
    v_lshl_add_u32 v252, v176, 3, v252
    v_lshlrev_b32 v251, 1, v252
    s_lshl_b32 s64, s60, 11
    v_add_u32 v251, s64, v251
    s_add_u32 s64, s64, 65536
    v_add_u32 v252, s64, v252
    s_lshl_b32 s71, s68, 23
    s_add_u32 s71, s71, 33554432
    s_mul_i32 s72, s76, 81920
    s_add_u32 s72, s72, 142606336
    s_lshl_b32 s74, s60, 10
    s_mov_b32 s77, 0x3ea52b5c
    s_mov_b32 s75, 0
    s_cmp_lg_u32 s60, 0
    s_cbranch_scc1 Lgskip_72
    buffer_load_dword v2, off, s[8:11], 0 offset:132 sc1
Lgchk_70:
    s_waitcnt vmcnt(0)
    v_cmp_eq_u32 vcc, 0, v2
    s_cbranch_vccnz Lgrty_71
Lgskip_72:
    s_waitcnt lgkmcnt(0)
    s_barrier
    buffer_load_dword v2, off, s[8:11], 0 offset:140 sc1
Lpchk_73:
    s_waitcnt vmcnt(0)
    v_cmp_eq_u32 vcc, 0, v2
    s_cbranch_vccnz Lprty_74
    v_readfirstlane_b32 s1, v2
    s_cmp_gt_u32 s1, 17
    s_cselect_b32 s1, 1, 0
    s_xor_b32 s1, s1, s68
    s_lshl_b32 s1, s1, 13
    s_lshl_b32 s63, s58, 18
    s_and_b32 s64, s3, 0xfff
    s_add_u32 s63, s63, s64
    s_add_u32 s63, s63, 14819328
    s_xor_b32 s63, s63, s1
    v_and_b32 v253, 3, v0
    v_mov_b32 v181, 30
    v_lshl_add_u32 v253, v181, 2, v253
    v_lshlrev_b32 v253, 7, v253
    v_bfe_u32 v181, v0, 4, 2
    v_cmp_eq_u32 vcc, s69, v181
    s_xor_b32 s64, s1, 0x2000
    s_add_u32 s64, s64, 14798848
    v_lshl_add_u32 v181, v181, 18, s64
    s_lshl_b32 s64, s68, 20
    v_add_u32 v181, s64, v181
    s_lshl_b32 s64, s58, 14
    s_add_u32 s64, s64, 8388608
    v_mov_b32 v2, s64
    v_cndmask_b32 v181, v181, v2, vcc
    v_add_u32 v253, v253, v181
    s_lshr_b32 s70, s71, 8
    s_xor_b32 s70, s70, s1
    s_and_b32 s70, s70, 0x2000
    s_or_b32 s70, s70, s71
    s_mov_b32 s80, 0
    s_lshl_b32 s64, s60, 2
    v_mov_b32 v3, s64
    v_and_b32 v1, 12, v1
L_Bh0:
    s_cmp_lg_u32 s75, 0
    s_cbranch_scc1 L_Bhave0
    buffer_load_dword v254, v253, s[4:7], 0 offen sc1
    s_waitcnt vmcnt(0)
    s_cmp_eq_u32 s80, 0
    s_cbranch_scc1 Lowed_75
    s_waitcnt vmcnt(0)
    v_mov_b32 v2, s62
    s_mov_b64 exec, 1
    buffer_store_dword v2, off, s[4:7], s63 sc1
    buffer_store_dword v2, off, s[4:7], s3
    s_mov_b64 exec, -1
    s_mov_b32 s80, 0
Lowed_75:
    s_add_u32 s65, s62, 1
Lfchk_76:
    v_cmp_gt_u32 vcc, s65, v254
    s_cbranch_vccnz Lfrty_77
    s_add_u32 m0, s74, 8192
    s_add_u32 s64, s70, 0
    buffer_load_dwordx4 v244, s[4:7], s64 offen sc1 lds
    s_add_u32 m0, s74, 12288
    s_add_u32 s64, s70, 4096
    buffer_load_dwordx4 v244, s[4:7], s64 offen sc1 lds
    s_add_u32 m0, s74, 16384
    s_add_u32 s64, s70, 16384
    buffer_load_dwordx4 v244, s[4:7], s64 offen sc1 lds
    s_add_u32 m0, s74, 20480
    s_add_u32 s64, s70, 20480
    buffer_load_dwordx4 v244, s[4:7], s64 offen sc1 lds
    s_add_u32 m0, s74, 24576
    s_add_u32 s64, s70, 32768
    buffer_load_dwordx4 v244, s[4:7], s64 offen sc1 lds
    s_waitcnt vmcnt(0)
L_Bhave0:
    s_waitcnt vmcnt(6) lgkmcnt(0)
    s_barrier
    s_mov_b32 s75, 0
    ds_read_b128 v[204:207], v245 offset:8192
    ds_read_b128 v[208:211], v246 offset:8192
    s_waitcnt lgkmcnt(1)
    v_mfma_f32_16x16x32_bf16 v[180:183], v[4:7], v[204:207], 0
    ds_read_b128 v[212:215], v245 offset:9216
    v_mfma_f32_16x16x32_bf16 v[168:171], a[0:3], v[204:207], 0
    v_mfma_f32_16x16x32_bf16 v[172:175], a[80:83], v[204:207], 0
    v_mfma_f32_16x16x32_bf16 v[176:179], v[204:207], a[160:163], 0
    s_waitcnt lgkmcnt(1)
    v_mfma_f32_16x16x32_bf16 v[180:183], v[8:11], v[208:211], v[180:183]
    ds_read_b128 v[204:207], v246 offset:9216
    v_mfma_f32_16x16x32_bf16 v[168:171], a[4:7], v[208:211], v[168:171]
    v_mfma_f32_16x16x32_bf16 v[172:175], a[84:87], v[208:211], v[172:175]
    v_mfma_f32_16x16x32_bf16 v[176:179], v[208:211], a[164:167], v[176:179]
    s_waitcnt lgkmcnt(1)
    v_mfma_f32_16x16x32_bf16 v[180:183], v[12:15], v[212:215], v[180:183]
    ds_read_b128 v[208:211], v245 offset:10240
    buffer_load_dword v254, v253, s[4:7], 0 offen sc1
    v_mfma_f32_16x16x32_bf16 v[168:171], a[8:11], v[212:215], v[168:171]
    v_mfma_f32_16x16x32_bf16 v[172:175], a[88:91], v[212:215], v[172:175]
    v_mfma_f32_16x16x32_bf16 v[176:179], v[212:215], a[168:171], v[176:179]
    s_waitcnt lgkmcnt(1)
    v_mfma_f32_16x16x32_bf16 v[180:183], v[16:19], v[204:207], v[180:183]
    ds_read_b128 v[212:215], v246 offset:10240
    v_mfma_f32_16x16x32_bf16 v[168:171], a[12:15], v[204:207], v[168:171]
    v_mfma_f32_16x16x32_bf16 v[172:175], a[92:95], v[204:207], v[172:175]
    v_mfma_f32_16x16x32_bf16 v[176:179], v[204:207], a[172:175], v[176:179]
    s_waitcnt lgkmcnt(1)
    v_mfma_f32_16x16x32_bf16 v[180:183], v[20:23], v[208:211], v[180:183]
    ds_read_b128 v[204:207], v245 offset:11264
    v_mfma_f32_16x16x32_bf16 v[168:171], a[16:19], v[208:211], v[168:171]
    v_mfma_f32_16x16x32_bf16 v[172:175], a[96:99], v[208:211], v[172:175]
    v_mfma_f32_16x16x32_bf16 v[176:179], v[208:211], a[176:179], v[176:179]
    s_waitcnt lgkmcnt(1)
    v_mfma_f32_16x16x32_bf16 v[180:183], v[24:27], v[212:215], v[180:183]
    ds_read_b128 v[208:211], v246 offset:11264
    v_mfma_f32_16x16x32_bf16 v[168:171], a[20:23], v[212:215], v[168:171]
    v_mfma_f32_16x16x32_bf16 v[172:175], a[100:103], v[212:215], v[172:175]
    v_mfma_f32_16x16x32_bf16 v[176:179], v[212:215], a[180:183], v[176:179]
    s_waitcnt lgkmcnt(1)
    v_mfma_f32_16x16x32_bf16 v[180:183], v[28:31], v[204:207], v[180:183]
    ds_read_b128 v[212:215], v245 offset:12288
    v_mfma_f32_16x16x32_bf16 v[168:171], a[24:27], v[204:207], v[168:171]
    v_mfma_f32_16x16x32_bf16 v[172:175], a[104:107], v[204:207], v[172:175]
    v_mfma_f32_16x16x32_bf16 v[176:179], v[204:207], a[184:187], v[176:179]
    s_waitcnt lgkmcnt(1)
    v_mfma_f32_16x16x32_bf16 v[180:183], v[32:35], v[208:211], v[180:183]
    ds_read_b128 v[204:207], v246 offset:12288
    v_mfma_f32_16x16x32_bf16 v[168:171], a[28:31], v[208:211], v[168:171]
    v_mfma_f32_16x16x32_bf16 v[172:175], a[108:111], v[208:211], v[172:175]
    v_mfma_f32_16x16x32_bf16 v[176:179], v[208:211], a[188:191], v[176:179]
    s_waitcnt lgkmcnt(1)
    v_mfma_f32_16x16x32_bf16 v[180:183], v[36:39], v[212:215], v[180:183]
    ds_read_b128 v[208:211], v245 offset:13312
    v_mfma_f32_16x16x32_bf16 v[168:171], a[32:35], v[212:215], v[168:171]
    v_mfma_f32_16x16x32_bf16 v[172:175], a[112:115], v[212:215], v[172:175]
    v_mfma_f32_16x16x32_bf16 v[176:179], v[212:215], a[192:195], v[176:179]
    s_waitcnt lgkmcnt(1)
    v_mfma_f32_16x16x32_bf16 v[180:183], v[40:43], v[204:207], v[180:183]
    ds_read_b128 v[212:215], v246 offset:13312
    v_mfma_f32_16x16x32_bf16 v[168:171], a[36:39], v[204:207], v[168:171]
    v_mfma_f32_16x16x32_bf16 v[172:175], a[116:119], v[204:207], v[172:175]
    v_mfma_f32_16x16x32_bf16 v[176:179], v[204:207], a[196:199], v[176:179]
    s_waitcnt vmcnt(0)
    s_cmp_eq_u32 s80, 0
    s_cbranch_scc1 Lowed_78
    s_waitcnt vmcnt(0)
    v_mov_b32 v2, s62
    s_mov_b64 exec, 1
    buffer_store_dword v2, off, s[4:7], s63 sc1
    buffer_store_dword v2, off, s[4:7], s3
    s_mov_b64 exec, -1
    s_mov_b32 s80, 0
Lowed_78:
    s_add_u32 s65, s62, s75
    s_add_u32 s65, s65, 2
    v_cmp_gt_u32 vcc, s65, v254
    s_cbranch_vccz Lpre_79
    s_waitcnt lgkmcnt(1)
    v_mfma_f32_16x16x32_bf16 v[180:183], v[44:47], v[208:211], v[180:183]
    ds_read_b128 v[204:207], v245 offset:14336
    ds_read_b128 v[184:187], v248 offset:5120
    v_mfma_f32_16x16x32_bf16 v[168:171], a[40:43], v[208:211], v[168:171]
    ds_read_b128 v[188:191], v247 offset:6144
    v_mfma_f32_16x16x32_bf16 v[172:175], a[120:123], v[208:211], v[172:175]
    v_mfma_f32_16x16x32_bf16 v[176:179], v[208:211], a[200:203], v[176:179]
    s_waitcnt lgkmcnt(3)
    v_mfma_f32_16x16x32_bf16 v[180:183], v[48:51], v[212:215], v[180:183]
    ds_read_b128 v[208:211], v246 offset:14336
    v_mfma_f32_16x16x32_bf16 v[168:171], a[44:47], v[212:215], v[168:171]
    v_mfma_f32_16x16x32_bf16 v[172:175], a[124:127], v[212:215], v[172:175]
    v_mfma_f32_16x16x32_bf16 v[176:179], v[212:215], a[204:207], v[176:179]
    s_waitcnt lgkmcnt(3)
    v_mfma_f32_16x16x32_bf16 v[180:183], v[52:55], v[204:207], v[180:183]
    ds_read_b128 v[212:215], v245 offset:15360
    v_mfma_f32_16x16x32_bf16 v[168:171], a[48:51], v[204:207], v[168:171]
    v_mfma_f32_16x16x32_bf16 v[172:175], a[128:131], v[204:207], v[172:175]
    v_mfma_f32_16x16x32_bf16 v[176:179], v[204:207], a[208:211], v[176:179]
    s_waitcnt lgkmcnt(1)
    v_mfma_f32_16x16x32_bf16 v[180:183], v[56:59], v[208:211], v[180:183]
    ds_read_b128 v[204:207], v246 offset:15360
    v_mfma_f32_16x16x32_bf16 v[168:171], a[52:55], v[208:211], v[168:171]
    v_mfma_f32_16x16x32_bf16 v[172:175], a[132:135], v[208:211], v[172:175]
    v_mfma_f32_16x16x32_bf16 v[176:179], v[208:211], a[212:215], v[176:179]
    s_waitcnt lgkmcnt(1)
    v_mfma_f32_16x16x32_bf16 v[180:183], v[60:63], v[212:215], v[180:183]
    ds_read_b128 v[208:211], v245 offset:16384
    v_mfma_f32_16x16x32_bf16 v[168:171], a[56:59], v[212:215], v[168:171]
    v_mfma_f32_16x16x32_bf16 v[172:175], a[136:139], v[212:215], v[172:175]
    v_mfma_f32_16x16x32_bf16 v[176:179], v[212:215], a[216:219], v[176:179]
    s_waitcnt lgkmcnt(1)
    v_mfma_f32_16x16x32_bf16 v[180:183], v[64:67], v[204:207], v[180:183]
    ds_read_b128 v[212:215], v246 offset:16384
    v_mfma_f32_16x16x32_bf16 v[168:171], a[60:63], v[204:207], v[168:171]
    v_mfma_f32_16x16x32_bf16 v[172:175], a[140:143], v[204:207], v[172:175]
    v_mfma_f32_16x16x32_bf16 v[176:179], v[204:207], a[220:223], v[176:179]
    s_waitcnt lgkmcnt(1)
    v_mfma_f32_16x16x32_bf16 v[180:183], v[68:71], v[208:211], v[180:183]
    ds_read_b128 v[204:207], v245 offset:17408
    v_mfma_f32_16x16x32_bf16 v[168:171], a[64:67], v[208:211], v[168:171]
    v_mfma_f32_16x16x32_bf16 v[172:175], a[144:147], v[208:211], v[172:175]
    v_mfma_f32_16x16x32_bf16 v[176:179], v[208:211], a[224:227], v[176:179]
    s_waitcnt lgkmcnt(1)
    v_mfma_f32_16x16x32_bf16 v[180:183], v[72:75], v[212:215], v[180:183]
    ds_read_b128 v[208:211], v246 offset:17408
    v_mfma_f32_16x16x32_bf16 v[168:171], a[68:71], v[212:215], v[168:171]
    v_mfma_f32_16x16x32_bf16 v[172:175], a[148:151], v[212:215], v[172:175]
    v_mfma_f32_16x16x32_bf16 v[176:179], v[212:215], a[228:231], v[176:179]
    s_waitcnt lgkmcnt(1)
    v_mfma_f32_16x16x32_bf16 v[180:183], v[76:79], v[204:207], v[180:183]
    v_mfma_f32_16x16x32_bf16 v[168:171], a[72:75], v[204:207], v[168:171]
    v_mfma_f32_16x16x32_bf16 v[172:175], a[152:155], v[204:207], v[172:175]
    v_mfma_f32_16x16x32_bf16 v[176:179], v[204:207], a[232:235], v[176:179]
    s_waitcnt lgkmcnt(0)
    v_mfma_f32_16x16x32_bf16 v[180:183], v[80:83], v[208:211], v[180:183]
    s_nop 2
    v_mfma_f32_16x16x32_bf16 v[168:171], a[76:79], v[208:211], v[168:171]
    s_nop 2
    v_mfma_f32_16x16x32_bf16 v[172:175], a[156:159], v[208:211], v[172:175]
    s_nop 2
    v_mfma_f32_16x16x32_bf16 v[176:179], v[208:211], a[236:239], v[176:179]
Lback_80:
    s_waitcnt vmcnt(0)
L_Be0:
    v_mov_b32 v2, s75
    ds_write_b32 v3, v2 offset:2560
    buffer_load_dword v254, v253, s[4:7], 0 offen sc1
    v_mfma_f32_16x16x4_f32 v[192:195], v182, v242, 0
    v_cvt_pk_bf16_f32 v222, v180, 0
    v_cvt_pk_bf16_f32 v226, v181, 0
    v_cvt_pk_bf16_f32 v220, v168, v169
    v_cvt_pk_bf16_f32 v221, v170, v171
    v_mov_b32 v223, 0
    v_cvt_pk_bf16_f32 v224, v172, v173
    v_cvt_pk_bf16_f32 v225, v174, v175
    s_waitcnt lgkmcnt(0)
    s_barrier
    ds_read_b32 v2, v1 offset:2560
    v_mfma_f32_16x16x32_bf16 v[184:187], v[228:231], v[220:223], v[184:187]
    v_cvt_pk_bf16_f32 v234, v176, v177
    v_cvt_pk_bf16_f32 v235, v178, v179
    v_mfma_f32_16x16x32_bf16 v[188:191], v[224:227], v[220:223], v[188:191]
    s_lshr_b32 s73, s72, 8
    s_xor_b32 s73, s73, s1
    s_and_b32 s73, s73, 0x2000
    s_or_b32 s73, s73, s72
    s_add_u32 s72, s72, 1048576
    s_add_u32 s78, s73, 0
    s_add_u32 s79, s73, 32768
    v_mov_b32 v248, v247
    v_cvt_pk_bf16_f32 v238, v192, v193
    v_cvt_pk_bf16_f32 v239, v194, v195
    v_or_b32 v238, v243, v238
    v_or_b32 v239, v243, v239
    s_waitcnt lgkmcnt(0)
    v_cmp_eq_u32 vcc, 0, v2
    s_cbranch_vccz L_Bi0
    v_max3_f32 v192, v184, v185, v186
    v_max3_f32 v193, v188, v189, v190
    v_max3_f32 v192, v192, v187, v191
    v_max_f32 v192, v192, v193
    v_mov_b32 v193, v192
    s_nop 1
    v_permlane16_swap_b32 v192, v193
    v_max_f32 v192, v192, v193
    v_mov_b32 v193, v192
    s_nop 1
    v_permlane32_swap_b32 v192, v193
    v_max_f32 v192, v192, v193
    v_mul_f32 v192, s77, v192
    v_fma_f32 v184, v184, s77, -v192
    v_fma_f32 v185, v185, s77, -v192
    v_fma_f32 v186, v186, s77, -v192
    v_fma_f32 v187, v187, s77, -v192
    v_fma_f32 v188, v188, s77, -v192
    v_fma_f32 v189, v189, s77, -v192
    v_fma_f32 v190, v190, s77, -v192
    v_fma_f32 v191, v191, s77, -v192
    v_exp_f32 v184, v184
    v_exp_f32 v185, v185
    v_exp_f32 v186, v186
    v_exp_f32 v187, v187
    v_exp_f32 v188, v188
    v_exp_f32 v189, v189
    v_exp_f32 v190, v190
    v_exp_f32 v191, v191
    v_cvt_pk_bf16_f32 v184, v184, v185
    v_cvt_pk_bf16_f32 v185, v186, v187
    v_cvt_pk_bf16_f32 v186, v188, v189
    v_cvt_pk_bf16_f32 v187, v190, v191
    s_nop 1
    v_mfma_f32_16x16x32_bf16 v[200:203], v[236:239], v[184:187], 0
    s_nop 2
    v_mfma_f32_16x16x32_bf16 v[196:199], v[232:235], v[184:187], 0
    s_nop 3
    v_rcp_f32 v201, v201
    s_nop 0
    v_mul_f32 v200, v200, v201
    s_nop 0
    v_mul_f32 v196, v196, v201
    v_mul_f32 v197, v197, v201
    v_mul_f32 v198, v198, v201
    v_mul_f32 v199, v199, v201
    v_cvt_pk_bf16_f32 v200, v200, v200
    v_cvt_pk_bf16_f32 v196, v196, v197
    v_cvt_pk_bf16_f32 v197, v198, v199
    ds_write_b16 v250, v200 offset:2048
    ds_write_b64 v249, v[196:197] offset:0
    s_waitcnt lgkmcnt(0)
    s_barrier
    ds_read_b64 v[240:241], v255 offset:2048
    ds_read_b128 v[220:223], v247 offset:0
    ds_read_b128 v[216:219], v247 offset:1024
    s_waitcnt vmcnt(0)
    s_cmp_eq_u32 s80, 0
    s_cbranch_scc1 Lowed_81
    s_waitcnt vmcnt(0)
    v_mov_b32 v2, s62
    s_mov_b64 exec, 1
    buffer_store_dword v2, off, s[4:7], s63 sc1
    buffer_store_dword v2, off, s[4:7], s3
    s_mov_b64 exec, -1
    s_mov_b32 s80, 0
Lowed_81:
    s_add_u32 s65, s62, s75
    s_add_u32 s65, s65, 2
    v_cmp_gt_u32 vcc, s65, v254
    s_cbranch_vccz Lpre_82
    s_waitcnt lgkmcnt(2)
    v_mfma_f32_16x16x16_bf16 v[168:171], a[240:241], v[240:241], 0
    v_mfma_f32_16x16x16_bf16 v[172:175], a[242:243], v[240:241], 0
    v_mfma_f32_16x16x16_bf16 v[176:179], a[244:245], v[240:241], 0
    v_mfma_f32_16x16x16_bf16 v[180:183], a[246:247], v[240:241], 0
    v_mfma_f32_16x16x16_bf16 v[204:207], a[248:249], v[240:241], 0
    v_mfma_f32_16x16x16_bf16 v[184:187], a[250:251], v[240:241], 0
    v_mfma_f32_16x16x16_bf16 v[188:191], a[252:253], v[240:241], 0
    v_mfma_f32_16x16x16_bf16 v[192:195], a[254:255], v[240:241], 0
    v_mfma_f32_16x16x16_bf16 v[196:199], v[164:165], v[240:241], 0
    v_mfma_f32_16x16x16_bf16 v[200:203], v[166:167], v[240:241], 0
Lback_83:
    s_waitcnt lgkmcnt(1)
    v_mfma_f32_16x16x32_bf16 v[168:171], v[84:87], v[220:223], v[168:171]
    v_mfma_f32_16x16x32_bf16 v[172:175], v[92:95], v[220:223], v[172:175]
    s_waitcnt lgkmcnt(0)
    v_mfma_f32_16x16x32_bf16 v[168:171], v[88:91], v[216:219], v[168:171]
    s_nop 2
    v_mfma_f32_16x16x32_bf16 v[172:175], v[96:99], v[216:219], v[172:175]
    s_nop 2
    v_mfma_f32_16x16x32_bf16 v[176:179], v[100:103], v[220:223], v[176:179]
    v_cvt_pk_bf16_f32 v168, v168, v169
    v_cvt_pk_bf16_f32 v169, v170, v171
    v_mfma_f32_16x16x32_bf16 v[180:183], v[108:111], v[220:223], v[180:183]
    s_nop 0
    v_cvt_pk_bf16_f32 v170, v172, v173
    v_cvt_pk_bf16_f32 v171, v174, v175
    v_mfma_f32_16x16x32_bf16 v[176:179], v[104:107], v[216:219], v[176:179]
    buffer_store_dwordx4 v[168:171], v251, s[4:7], s78 offen offset:0 sc1
    s_nop 4
    v_mfma_f32_16x16x32_bf16 v[180:183], v[112:115], v[216:219], v[180:183]
    s_nop 0
    v_cvt_pk_bf16_f32 v176, v176, v177
    v_cvt_pk_bf16_f32 v177, v178, v179
    v_mfma_f32_16x16x32_bf16 v[204:207], v[116:119], v[220:223], v[204:207]
    s_nop 2
    v_mfma_f32_16x16x32_bf16 v[204:207], v[120:123], v[216:219], v[204:207]
    v_cvt_pk_bf16_f32 v178, v180, v181
    v_cvt_pk_bf16_f32 v179, v182, v183
    v_mfma_f32_16x16x32_bf16 v[184:187], v[124:127], v[220:223], v[184:187]
    buffer_store_dwordx4 v[176:179], v251, s[4:7], s79 offen offset:0 sc1
    s_nop 3
    v_cvt_pk_bf16_f32 v204, v204, v205
    v_mfma_f32_16x16x32_bf16 v[188:191], v[132:135], v[220:223], v[188:191]
    v_cvt_pk_bf16_f32 v205, v206, v207
    v_mfma_f32_16x16x32_bf16 v[184:187], v[128:131], v[216:219], v[184:187]
    buffer_store_dwordx2 v[204:205], v252, s[4:7], s73 offen offset:0 sc1
    s_nop 2
    v_mfma_f32_16x16x32_bf16 v[188:191], v[136:139], v[216:219], v[188:191]
    s_nop 2
    v_mfma_f32_16x16x32_bf16 v[192:195], v[140:143], v[220:223], v[192:195]
    v_cvt_pk_bf16_f32 v184, v184, v185
    v_cvt_pk_bf16_f32 v185, v186, v187
    v_mfma_f32_16x16x32_bf16 v[196:199], v[148:151], v[220:223], v[196:199]
    s_nop 0
    v_cvt_pk_bf16_f32 v186, v188, v189
    v_cvt_pk_bf16_f32 v187, v190, v191
    v_mfma_f32_16x16x32_bf16 v[192:195], v[144:147], v[216:219], v[192:195]
    buffer_store_dwordx4 v[184:187], v251, s[4:7], s78 offen offset:1024 sc1
    s_nop 4
    v_mfma_f32_16x16x32_bf16 v[196:199], v[152:155], v[216:219], v[196:199]
    s_nop 0
    v_cvt_pk_bf16_f32 v192, v192, v193
    v_cvt_pk_bf16_f32 v193, v194, v195
    v_mfma_f32_16x16x32_bf16 v[200:203], v[156:159], v[220:223], v[200:203]
    s_nop 2
    v_mfma_f32_16x16x32_bf16 v[200:203], v[160:163], v[216:219], v[200:203]
    v_cvt_pk_bf16_f32 v194, v196, v197
    v_cvt_pk_bf16_f32 v195, v198, v199
    buffer_store_dwordx4 v[192:195], v251, s[4:7], s79 offen offset:1024 sc1
    s_nop 4
    v_cvt_pk_bf16_f32 v200, v200, v201
    v_cvt_pk_bf16_f32 v201, v202, v203
    buffer_store_dwordx2 v[200:201], v252, s[4:7], s73 offen offset:1024 sc1
    s_add_u32 s62, s62, 1
    s_mov_b32 s80, 1
L_Bh1:
    s_cmp_lg_u32 s75, 0
    s_cbranch_scc1 L_Bhave1
    buffer_load_dword v254, v253, s[4:7], 0 offen sc1
    s_waitcnt vmcnt(0)
    s_cmp_eq_u32 s80, 0
    s_cbranch_scc1 Lowed_84
    s_waitcnt vmcnt(0)
    v_mov_b32 v2, s62
    s_mov_b64 exec, 1
    buffer_store_dword v2, off, s[4:7], s63 sc1
    buffer_store_dword v2, off, s[4:7], s3
    s_mov_b64 exec, -1
    s_mov_b32 s80, 0
Lowed_84:
    s_add_u32 s65, s62, 1
Lfchk_85:
    v_cmp_gt_u32 vcc, s65, v254
    s_cbranch_vccnz Lfrty_86
    s_add_u32 m0, s74, 28672
    s_add_u32 s64, s70, 36864
    buffer_load_dwordx4 v244, s[4:7], s64 offen sc1 lds
    s_add_u32 m0, s74, 32768
    s_add_u32 s64, s70, 49152
    buffer_load_dwordx4 v244, s[4:7], s64 offen sc1 lds
    s_add_u32 m0, s74, 36864
    s_add_u32 s64, s70, 53248
    buffer_load_dwordx4 v244, s[4:7], s64 offen sc1 lds
    s_add_u32 m0, s74, 40960
    s_add_u32 s64, s70, 65536
    buffer_load_dwordx4 v244, s[4:7], s64 offen sc1 lds
    s_add_u32 m0, s74, 45056
    s_add_u32 s64, s70, 69632
    buffer_load_dwordx4 v244, s[4:7], s64 offen sc1 lds
    s_add_u32 s71, s71, 131072
    s_lshr_b32 s70, s71, 8
    s_xor_b32 s70, s70, s1
    s_and_b32 s70, s70, 0x2000
    s_or_b32 s70, s70, s71
    s_waitcnt vmcnt(0)
L_Bhave1:
    s_waitcnt vmcnt(6) lgkmcnt(0)
    s_barrier
    s_mov_b32 s75, 0
    ds_read_b128 v[204:207], v245 offset:28672
    ds_read_b128 v[208:211], v246 offset:28672
    s_waitcnt lgkmcnt(1)
    v_mfma_f32_16x16x32_bf16 v[180:183], v[4:7], v[204:207], 0
    ds_read_b128 v[212:215], v245 offset:29696
    v_mfma_f32_16x16x32_bf16 v[168:171], a[0:3], v[204:207], 0
    v_mfma_f32_16x16x32_bf16 v[172:175], a[80:83], v[204:207], 0
    v_mfma_f32_16x16x32_bf16 v[176:179], v[204:207], a[160:163], 0
    s_waitcnt lgkmcnt(1)
    v_mfma_f32_16x16x32_bf16 v[180:183], v[8:11], v[208:211], v[180:183]
    ds_read_b128 v[204:207], v246 offset:29696
    v_mfma_f32_16x16x32_bf16 v[168:171], a[4:7], v[208:211], v[168:171]
    v_mfma_f32_16x16x32_bf16 v[172:175], a[84:87], v[208:211], v[172:175]
    v_mfma_f32_16x16x32_bf16 v[176:179], v[208:211], a[164:167], v[176:179]
    s_waitcnt lgkmcnt(1)
    v_mfma_f32_16x16x32_bf16 v[180:183], v[12:15], v[212:215], v[180:183]
    ds_read_b128 v[208:211], v245 offset:30720
    buffer_load_dword v254, v253, s[4:7], 0 offen sc1
    v_mfma_f32_16x16x32_bf16 v[168:171], a[8:11], v[212:215], v[168:171]
    v_mfma_f32_16x16x32_bf16 v[172:175], a[88:91], v[212:215], v[172:175]
    v_mfma_f32_16x16x32_bf16 v[176:179], v[212:215], a[168:171], v[176:179]
    s_waitcnt lgkmcnt(1)
    v_mfma_f32_16x16x32_bf16 v[180:183], v[16:19], v[204:207], v[180:183]
    ds_read_b128 v[212:215], v246 offset:30720
    v_mfma_f32_16x16x32_bf16 v[168:171], a[12:15], v[204:207], v[168:171]
    v_mfma_f32_16x16x32_bf16 v[172:175], a[92:95], v[204:207], v[172:175]
    v_mfma_f32_16x16x32_bf16 v[176:179], v[204:207], a[172:175], v[176:179]
    s_waitcnt lgkmcnt(1)
    v_mfma_f32_16x16x32_bf16 v[180:183], v[20:23], v[208:211], v[180:183]
    ds_read_b128 v[204:207], v245 offset:31744
    v_mfma_f32_16x16x32_bf16 v[168:171], a[16:19], v[208:211], v[168:171]
    v_mfma_f32_16x16x32_bf16 v[172:175], a[96:99], v[208:211], v[172:175]
    v_mfma_f32_16x16x32_bf16 v[176:179], v[208:211], a[176:179], v[176:179]
    s_waitcnt lgkmcnt(1)
    v_mfma_f32_16x16x32_bf16 v[180:183], v[24:27], v[212:215], v[180:183]
    ds_read_b128 v[208:211], v246 offset:31744
    v_mfma_f32_16x16x32_bf16 v[168:171], a[20:23], v[212:215], v[168:171]
    v_mfma_f32_16x16x32_bf16 v[172:175], a[100:103], v[212:215], v[172:175]
    v_mfma_f32_16x16x32_bf16 v[176:179], v[212:215], a[180:183], v[176:179]
    s_waitcnt lgkmcnt(1)
    v_mfma_f32_16x16x32_bf16 v[180:183], v[28:31], v[204:207], v[180:183]
    ds_read_b128 v[212:215], v245 offset:32768
    v_mfma_f32_16x16x32_bf16 v[168:171], a[24:27], v[204:207], v[168:171]
    v_mfma_f32_16x16x32_bf16 v[172:175], a[104:107], v[204:207], v[172:175]
    v_mfma_f32_16x16x32_bf16 v[176:179], v[204:207], a[184:187], v[176:179]
    s_waitcnt lgkmcnt(1)
    v_mfma_f32_16x16x32_bf16 v[180:183], v[32:35], v[208:211], v[180:183]
    ds_read_b128 v[204:207], v246 offset:32768
    v_mfma_f32_16x16x32_bf16 v[168:171], a[28:31], v[208:211], v[168:171]
    v_mfma_f32_16x16x32_bf16 v[172:175], a[108:111], v[208:211], v[172:175]
    v_mfma_f32_16x16x32_bf16 v[176:179], v[208:211], a[188:191], v[176:179]
    s_waitcnt lgkmcnt(1)
    v_mfma_f32_16x16x32_bf16 v[180:183], v[36:39], v[212:215], v[180:183]
    ds_read_b128 v[208:211], v245 offset:33792
    v_mfma_f32_16x16x32_bf16 v[168:171], a[32:35], v[212:215], v[168:171]
    v_mfma_f32_16x16x32_bf16 v[172:175], a[112:115], v[212:215], v[172:175]
    v_mfma_f32_16x16x32_bf16 v[176:179], v[212:215], a[192:195], v[176:179]
    s_waitcnt lgkmcnt(1)
    v_mfma_f32_16x16x32_bf16 v[180:183], v[40:43], v[204:207], v[180:183]
    ds_read_b128 v[212:215], v246 offset:33792
    v_mfma_f32_16x16x32_bf16 v[168:171], a[36:39], v[204:207], v[168:171]
    v_mfma_f32_16x16x32_bf16 v[172:175], a[116:119], v[204:207], v[172:175]
    v_mfma_f32_16x16x32_bf16 v[176:179], v[204:207], a[196:199], v[176:179]
    s_waitcnt vmcnt(0)
    s_cmp_eq_u32 s80, 0
    s_cbranch_scc1 Lowed_87
    s_waitcnt vmcnt(0)
    v_mov_b32 v2, s62
    s_mov_b64 exec, 1
    buffer_store_dword v2, off, s[4:7], s63 sc1
    buffer_store_dword v2, off, s[4:7], s3
    s_mov_b64 exec, -1
    s_mov_b32 s80, 0
Lowed_87:
    s_add_u32 s65, s62, s75
    s_add_u32 s65, s65, 2
    v_cmp_gt_u32 vcc, s65, v254
    s_cbranch_vccz Lpre_88
    s_waitcnt lgkmcnt(1)
    v_mfma_f32_16x16x32_bf16 v[180:183], v[44:47], v[208:211], v[180:183]
    ds_read_b128 v[204:207], v245 offset:34816
    ds_read_b128 v[188:191], v247 offset:5120
    v_mfma_f32_16x16x32_bf16 v[168:171], a[40:43], v[208:211], v[168:171]
    ds_read_b128 v[184:187], v247 offset:6144
    v_mfma_f32_16x16x32_bf16 v[172:175], a[120:123], v[208:211], v[172:175]
    v_mfma_f32_16x16x32_bf16 v[176:179], v[208:211], a[200:203], v[176:179]
    s_waitcnt lgkmcnt(3)
    v_mfma_f32_16x16x32_bf16 v[180:183], v[48:51], v[212:215], v[180:183]
    ds_read_b128 v[208:211], v246 offset:34816
    v_mfma_f32_16x16x32_bf16 v[168:171], a[44:47], v[212:215], v[168:171]
    v_mfma_f32_16x16x32_bf16 v[172:175], a[124:127], v[212:215], v[172:175]
    v_mfma_f32_16x16x32_bf16 v[176:179], v[212:215], a[204:207], v[176:179]
    s_waitcnt lgkmcnt(3)
    v_mfma_f32_16x16x32_bf16 v[180:183], v[52:55], v[204:207], v[180:183]
    ds_read_b128 v[212:215], v245 offset:35840
    v_mfma_f32_16x16x32_bf16 v[168:171], a[48:51], v[204:207], v[168:171]
    v_mfma_f32_16x16x32_bf16 v[172:175], a[128:131], v[204:207], v[172:175]
    v_mfma_f32_16x16x32_bf16 v[176:179], v[204:207], a[208:211], v[176:179]
    s_waitcnt lgkmcnt(1)
    v_mfma_f32_16x16x32_bf16 v[180:183], v[56:59], v[208:211], v[180:183]
    ds_read_b128 v[204:207], v246 offset:35840
    v_mfma_f32_16x16x32_bf16 v[168:171], a[52:55], v[208:211], v[168:171]
    v_mfma_f32_16x16x32_bf16 v[172:175], a[132:135], v[208:211], v[172:175]
    v_mfma_f32_16x16x32_bf16 v[176:179], v[208:211], a[212:215], v[176:179]
    s_waitcnt lgkmcnt(1)
    v_mfma_f32_16x16x32_bf16 v[180:183], v[60:63], v[212:215], v[180:183]
    ds_read_b128 v[208:211], v245 offset:36864
    v_mfma_f32_16x16x32_bf16 v[168:171], a[56:59], v[212:215], v[168:171]
    v_mfma_f32_16x16x32_bf16 v[172:175], a[136:139], v[212:215], v[172:175]
    v_mfma_f32_16x16x32_bf16 v[176:179], v[212:215], a[216:219], v[176:179]
    s_waitcnt lgkmcnt(1)
    v_mfma_f32_16x16x32_bf16 v[180:183], v[64:67], v[204:207], v[180:183]
    ds_read_b128 v[212:215], v246 offset:36864
    v_mfma_f32_16x16x32_bf16 v[168:171], a[60:63], v[204:207], v[168:171]
    v_mfma_f32_16x16x32_bf16 v[172:175], a[140:143], v[204:207], v[172:175]
    v_mfma_f32_16x16x32_bf16 v[176:179], v[204:207], a[220:223], v[176:179]
    s_waitcnt lgkmcnt(1)
    v_mfma_f32_16x16x32_bf16 v[180:183], v[68:71], v[208:211], v[180:183]
    ds_read_b128 v[204:207], v245 offset:37888
    v_mfma_f32_16x16x32_bf16 v[168:171], a[64:67], v[208:211], v[168:171]
    v_mfma_f32_16x16x32_bf16 v[172:175], a[144:147], v[208:211], v[172:175]
    v_mfma_f32_16x16x32_bf16 v[176:179], v[208:211], a[224:227], v[176:179]
    s_waitcnt lgkmcnt(1)
    v_mfma_f32_16x16x32_bf16 v[180:183], v[72:75], v[212:215], v[180:183]
    ds_read_b128 v[208:211], v246 offset:37888
    v_mfma_f32_16x16x32_bf16 v[168:171], a[68:71], v[212:215], v[168:171]
    v_mfma_f32_16x16x32_bf16 v[172:175], a[148:151], v[212:215], v[172:175]
    v_mfma_f32_16x16x32_bf16 v[176:179], v[212:215], a[228:231], v[176:179]
    s_waitcnt lgkmcnt(1)
    v_mfma_f32_16x16x32_bf16 v[180:183], v[76:79], v[204:207], v[180:183]
    v_mfma_f32_16x16x32_bf16 v[168:171], a[72:75], v[204:207], v[168:171]
    v_mfma_f32_16x16x32_bf16 v[172:175], a[152:155], v[204:207], v[172:175]
    v_mfma_f32_16x16x32_bf16 v[176:179], v[204:207], a[232:235], v[176:179]
    s_waitcnt lgkmcnt(0)
    v_mfma_f32_16x16x32_bf16 v[180:183], v[80:83], v[208:211], v[180:183]
    s_nop 2
    v_mfma_f32_16x16x32_bf16 v[168:171], a[76:79], v[208:211], v[168:171]
    s_nop 2
    v_mfma_f32_16x16x32_bf16 v[172:175], a[156:159], v[208:211], v[172:175]
    s_nop 2
    v_mfma_f32_16x16x32_bf16 v[176:179], v[208:211], a[236:239], v[176:179]
Lback_89:
    s_waitcnt vmcnt(0)
L_Be1:
    v_mov_b32 v2, s75
    ds_write_b32 v3, v2 offset:2560
    buffer_load_dword v254, v253, s[4:7], 0 offen sc1
    v_mfma_f32_16x16x4_f32 v[192:195], v182, v242, 0
    v_cvt_pk_bf16_f32 v222, v180, 0
    v_cvt_pk_bf16_f32 v230, v181, 0
    v_cvt_pk_bf16_f32 v220, v168, v169
    v_cvt_pk_bf16_f32 v221, v170, v171
    v_mov_b32 v223, 0
    v_cvt_pk_bf16_f32 v228, v172, v173
    v_cvt_pk_bf16_f32 v229, v174, v175
    s_waitcnt lgkmcnt(0)
    s_barrier
    ds_read_b32 v2, v1 offset:2560
    v_mfma_f32_16x16x32_bf16 v[188:191], v[224:227], v[220:223], v[188:191]
    v_cvt_pk_bf16_f32 v232, v176, v177
    v_cvt_pk_bf16_f32 v233, v178, v179
    v_mfma_f32_16x16x32_bf16 v[184:187], v[228:231], v[220:223], v[184:187]
    s_add_u32 s78, s73, 16384
    s_add_u32 s79, s73, 49152
    v_mov_b32 v248, v247
    v_cvt_pk_bf16_f32 v236, v192, v193
    v_cvt_pk_bf16_f32 v237, v194, v195
    v_or_b32 v236, v243, v236
    v_or_b32 v237, v243, v237
    s_waitcnt lgkmcnt(0)
    v_cmp_eq_u32 vcc, 0, v2
    s_cbranch_vccz L_Bi1
    v_max3_f32 v192, v184, v185, v186
    v_max3_f32 v193, v188, v189, v190
    v_max3_f32 v192, v192, v187, v191
    v_max_f32 v192, v192, v193
    v_mov_b32 v193, v192
    s_nop 1
    v_permlane16_swap_b32 v192, v193
    v_max_f32 v192, v192, v193
    v_mov_b32 v193, v192
    s_nop 1
    v_permlane32_swap_b32 v192, v193
    v_max_f32 v192, v192, v193
    v_mul_f32 v192, s77, v192
    v_fma_f32 v184, v184, s77, -v192
    v_fma_f32 v185, v185, s77, -v192
    v_fma_f32 v186, v186, s77, -v192
    v_fma_f32 v187, v187, s77, -v192
    v_fma_f32 v188, v188, s77, -v192
    v_fma_f32 v189, v189, s77, -v192
    v_fma_f32 v190, v190, s77, -v192
    v_fma_f32 v191, v191, s77, -v192
    v_exp_f32 v184, v184
    v_exp_f32 v185, v185
    v_exp_f32 v186, v186
    v_exp_f32 v187, v187
    v_exp_f32 v188, v188
    v_exp_f32 v189, v189
    v_exp_f32 v190, v190
    v_exp_f32 v191, v191
    v_cvt_pk_bf16_f32 v184, v184, v185
    v_cvt_pk_bf16_f32 v185, v186, v187
    v_cvt_pk_bf16_f32 v186, v188, v189
    v_cvt_pk_bf16_f32 v187, v190, v191
    s_nop 1
    v_mfma_f32_16x16x32_bf16 v[200:203], v[236:239], v[184:187], 0
    s_nop 2
    v_mfma_f32_16x16x32_bf16 v[196:199], v[232:235], v[184:187], 0
    s_nop 3
    v_rcp_f32 v201, v201
    s_nop 0
    v_mul_f32 v200, v200, v201
    s_nop 0
    v_mul_f32 v196, v196, v201
    v_mul_f32 v197, v197, v201
    v_mul_f32 v198, v198, v201
    v_mul_f32 v199, v199, v201
    v_cvt_pk_bf16_f32 v200, v200, v200
    v_cvt_pk_bf16_f32 v196, v196, v197
    v_cvt_pk_bf16_f32 v197, v198, v199
    ds_write_b16 v250, v200 offset:2048
    ds_write_b64 v249, v[196:197] offset:0
    s_waitcnt lgkmcnt(0)
    s_barrier
    ds_read_b64 v[240:241], v255 offset:2048
    ds_read_b128 v[220:223], v247 offset:0
    ds_read_b128 v[216:219], v247 offset:1024
    s_waitcnt vmcnt(0)
    s_cmp_eq_u32 s80, 0
    s_cbranch_scc1 Lowed_90
    s_waitcnt vmcnt(0)
    v_mov_b32 v2, s62
    s_mov_b64 exec, 1
    buffer_store_dword v2, off, s[4:7], s63 sc1
    buffer_store_dword v2, off, s[4:7], s3
    s_mov_b64 exec, -1
    s_mov_b32 s80, 0
Lowed_90:
    s_add_u32 s65, s62, s75
    s_add_u32 s65, s65, 2
    v_cmp_gt_u32 vcc, s65, v254
    s_cbranch_vccz Lpre_91
    s_waitcnt lgkmcnt(2)
    v_mfma_f32_16x16x16_bf16 v[168:171], a[240:241], v[240:241], 0
    v_mfma_f32_16x16x16_bf16 v[172:175], a[242:243], v[240:241], 0
    v_mfma_f32_16x16x16_bf16 v[176:179], a[244:245], v[240:241], 0
    v_mfma_f32_16x16x16_bf16 v[180:183], a[246:247], v[240:241], 0
    v_mfma_f32_16x16x16_bf16 v[204:207], a[248:249], v[240:241], 0
    v_mfma_f32_16x16x16_bf16 v[184:187], a[250:251], v[240:241], 0
    v_mfma_f32_16x16x16_bf16 v[188:191], a[252:253], v[240:241], 0
    v_mfma_f32_16x16x16_bf16 v[192:195], a[254:255], v[240:241], 0
    v_mfma_f32_16x16x16_bf16 v[196:199], v[164:165], v[240:241], 0
    v_mfma_f32_16x16x16_bf16 v[200:203], v[166:167], v[240:241], 0
Lback_92:
    s_waitcnt lgkmcnt(1)
    v_mfma_f32_16x16x32_bf16 v[168:171], v[84:87], v[220:223], v[168:171]
    v_mfma_f32_16x16x32_bf16 v[172:175], v[92:95], v[220:223], v[172:175]
    s_waitcnt lgkmcnt(0)
    v_mfma_f32_16x16x32_bf16 v[168:171], v[88:91], v[216:219], v[168:171]
    s_nop 2
    v_mfma_f32_16x16x32_bf16 v[172:175], v[96:99], v[216:219], v[172:175]
    s_nop 2
    v_mfma_f32_16x16x32_bf16 v[176:179], v[100:103], v[220:223], v[176:179]
    v_cvt_pk_bf16_f32 v168, v168, v169
    v_cvt_pk_bf16_f32 v169, v170, v171
    v_mfma_f32_16x16x32_bf16 v[180:183], v[108:111], v[220:223], v[180:183]
    s_nop 0
    v_cvt_pk_bf16_f32 v170, v172, v173
    v_cvt_pk_bf16_f32 v171, v174, v175
    v_mfma_f32_16x16x32_bf16 v[176:179], v[104:107], v[216:219], v[176:179]
    buffer_store_dwordx4 v[168:171], v251, s[4:7], s78 offen offset:0 sc1
    s_nop 4
    v_mfma_f32_16x16x32_bf16 v[180:183], v[112:115], v[216:219], v[180:183]
    s_nop 0
    v_cvt_pk_bf16_f32 v176, v176, v177
    v_cvt_pk_bf16_f32 v177, v178, v179
    v_mfma_f32_16x16x32_bf16 v[204:207], v[116:119], v[220:223], v[204:207]
    s_nop 2
    v_mfma_f32_16x16x32_bf16 v[204:207], v[120:123], v[216:219], v[204:207]
    v_cvt_pk_bf16_f32 v178, v180, v181
    v_cvt_pk_bf16_f32 v179, v182, v183
    v_mfma_f32_16x16x32_bf16 v[184:187], v[124:127], v[220:223], v[184:187]
    buffer_store_dwordx4 v[176:179], v251, s[4:7], s79 offen offset:0 sc1
    s_nop 3
    v_cvt_pk_bf16_f32 v204, v204, v205
    v_mfma_f32_16x16x32_bf16 v[188:191], v[132:135], v[220:223], v[188:191]
    v_cvt_pk_bf16_f32 v205, v206, v207
    v_mfma_f32_16x16x32_bf16 v[184:187], v[128:131], v[216:219], v[184:187]
    buffer_store_dwordx2 v[204:205], v252, s[4:7], s73 offen offset:512 sc1
    s_nop 2
    v_mfma_f32_16x16x32_bf16 v[188:191], v[136:139], v[216:219], v[188:191]
    s_nop 2
    v_mfma_f32_16x16x32_bf16 v[192:195], v[140:143], v[220:223], v[192:195]
    v_cvt_pk_bf16_f32 v184, v184, v185
    v_cvt_pk_bf16_f32 v185, v186, v187
    v_mfma_f32_16x16x32_bf16 v[196:199], v[148:151], v[220:223], v[196:199]
    s_nop 0
    v_cvt_pk_bf16_f32 v186, v188, v189
    v_cvt_pk_bf16_f32 v187, v190, v191
    v_mfma_f32_16x16x32_bf16 v[192:195], v[144:147], v[216:219], v[192:195]
    buffer_store_dwordx4 v[184:187], v251, s[4:7], s78 offen offset:1024 sc1
    s_nop 4
    v_mfma_f32_16x16x32_bf16 v[196:199], v[152:155], v[216:219], v[196:199]
    s_nop 0
    v_cvt_pk_bf16_f32 v192, v192, v193
    v_cvt_pk_bf16_f32 v193, v194, v195
    v_mfma_f32_16x16x32_bf16 v[200:203], v[156:159], v[220:223], v[200:203]
    s_nop 2
    v_mfma_f32_16x16x32_bf16 v[200:203], v[160:163], v[216:219], v[200:203]
    v_cvt_pk_bf16_f32 v194, v196, v197
    v_cvt_pk_bf16_f32 v195, v198, v199
    buffer_store_dwordx4 v[192:195], v251, s[4:7], s79 offen offset:1024 sc1
    s_nop 4
    v_cvt_pk_bf16_f32 v200, v200, v201
    v_cvt_pk_bf16_f32 v201, v202, v203
    buffer_store_dwordx2 v[200:201], v252, s[4:7], s73 offen offset:1536 sc1
    s_add_u32 s62, s62, 1
    s_mov_b32 s80, 1
    s_cmp_lt_u32 s62, 128
    s_cbranch_scc1 L_Bh0
    s_waitcnt vmcnt(0)
    v_mov_b32 v2, s62
    s_mov_b64 exec, 1
    buffer_store_dword v2, off, s[4:7], s63 sc1
    buffer_store_dword v2, off, s[4:7], s3
    s_mov_b64 exec, -1
    s_endpgm
L_Bi0:
    s_mov_b32 s75, 0
    ds_read_b128 v[204:207], v245 offset:28672
    ds_read_b128 v[208:211], v246 offset:28672
    v_max3_f32 v192, v184, v185, v186
    v_max3_f32 v193, v188, v189, v190
    v_max3_f32 v192, v192, v187, v191
    v_max_f32 v192, v192, v193
    s_waitcnt lgkmcnt(1)
    v_mfma_f32_16x16x32_bf16 v[180:183], v[4:7], v[204:207], 0
    ds_read_b128 v[212:215], v245 offset:29696
    v_mov_b32 v193, v192
    v_mfma_f32_16x16x32_bf16 v[168:171], a[0:3], v[204:207], 0
    s_nop 0
    v_permlane16_swap_b32 v192, v193
    v_mfma_f32_16x16x32_bf16 v[172:175], a[80:83], v[204:207], 0
    v_max_f32 v192, v192, v193
    v_mov_b32 v193, v192
    v_mfma_f32_16x16x32_bf16 v[176:179], v[204:207], a[160:163], 0
    s_waitcnt lgkmcnt(1)
    v_permlane32_swap_b32 v192, v193
    v_mfma_f32_16x16x32_bf16 v[180:183], v[8:11], v[208:211], v[180:183]
    ds_read_b128 v[204:207], v246 offset:29696
    v_max_f32 v192, v192, v193
    v_mfma_f32_16x16x32_bf16 v[168:171], a[4:7], v[208:211], v[168:171]
    v_mul_f32 v192, s77, v192
    v_fma_f32 v184, v184, s77, -v192
    v_mfma_f32_16x16x32_bf16 v[172:175], a[84:87], v[208:211], v[172:175]
    v_fma_f32 v185, v185, s77, -v192
    v_fma_f32 v186, v186, s77, -v192
    v_mfma_f32_16x16x32_bf16 v[176:179], v[208:211], a[164:167], v[176:179]
    s_waitcnt lgkmcnt(1)
    v_fma_f32 v187, v187, s77, -v192
    v_fma_f32 v188, v188, s77, -v192
    v_mfma_f32_16x16x32_bf16 v[180:183], v[12:15], v[212:215], v[180:183]
    ds_read_b128 v[208:211], v245 offset:30720
    v_fma_f32 v189, v189, s77, -v192
    v_mfma_f32_16x16x32_bf16 v[168:171], a[8:11], v[212:215], v[168:171]
    v_fma_f32 v190, v190, s77, -v192
    v_fma_f32 v191, v191, s77, -v192
    v_mfma_f32_16x16x32_bf16 v[172:175], a[88:91], v[212:215], v[172:175]
    v_exp_f32 v184, v184
    v_mfma_f32_16x16x32_bf16 v[176:179], v[212:215], a[168:171], v[176:179]
    s_waitcnt lgkmcnt(1)
    v_exp_f32 v185, v185
    v_mfma_f32_16x16x32_bf16 v[180:183], v[16:19], v[204:207], v[180:183]
    ds_read_b128 v[212:215], v246 offset:30720
    v_mfma_f32_16x16x32_bf16 v[168:171], a[12:15], v[204:207], v[168:171]
    v_exp_f32 v186, v186
    v_mfma_f32_16x16x32_bf16 v[172:175], a[92:95], v[204:207], v[172:175]
    v_exp_f32 v187, v187
    v_mfma_f32_16x16x32_bf16 v[176:179], v[204:207], a[172:175], v[176:179]
    s_waitcnt lgkmcnt(1)
    v_exp_f32 v188, v188
    v_mfma_f32_16x16x32_bf16 v[180:183], v[20:23], v[208:211], v[180:183]
    ds_read_b128 v[204:207], v245 offset:31744
    v_mfma_f32_16x16x32_bf16 v[168:171], a[16:19], v[208:211], v[168:171]
    v_exp_f32 v189, v189
    v_mfma_f32_16x16x32_bf16 v[172:175], a[96:99], v[208:211], v[172:175]
    v_exp_f32 v190, v190
    v_mfma_f32_16x16x32_bf16 v[176:179], v[208:211], a[176:179], v[176:179]
    s_waitcnt lgkmcnt(1)
    v_exp_f32 v191, v191
    v_mfma_f32_16x16x32_bf16 v[180:183], v[24:27], v[212:215], v[180:183]
    ds_read_b128 v[208:211], v246 offset:31744
    v_cvt_pk_bf16_f32 v184, v184, v185
    v_mfma_f32_16x16x32_bf16 v[168:171], a[20:23], v[212:215], v[168:171]
    v_cvt_pk_bf16_f32 v185, v186, v187
    v_cvt_pk_bf16_f32 v186, v188, v189
    v_mfma_f32_16x16x32_bf16 v[172:175], a[100:103], v[212:215], v[172:175]
    v_cvt_pk_bf16_f32 v187, v190, v191
    s_nop 0
    v_mfma_f32_16x16x32_bf16 v[176:179], v[212:215], a[180:183], v[176:179]
    v_mfma_f32_16x16x32_bf16 v[200:203], v[236:239], v[184:187], 0
    s_nop 2
    v_mfma_f32_16x16x32_bf16 v[196:199], v[232:235], v[184:187], 0
    s_waitcnt vmcnt(0)
    s_cmp_eq_u32 s80, 0
    s_cbranch_scc1 Lowed_93
    s_waitcnt vmcnt(0)
    v_mov_b32 v2, s62
    s_mov_b64 exec, 1
    buffer_store_dword v2, off, s[4:7], s63 sc1
    buffer_store_dword v2, off, s[4:7], s3
    s_mov_b64 exec, -1
    s_mov_b32 s80, 0
Lowed_93:
    s_add_u32 s65, s62, s75
    s_add_u32 s65, s65, 3
    v_cmp_gt_u32 vcc, s65, v254
    s_cbranch_vccz Lpre_94
    s_waitcnt lgkmcnt(1)
    v_mfma_f32_16x16x32_bf16 v[180:183], v[28:31], v[204:207], v[180:183]
    ds_read_b128 v[212:215], v245 offset:32768
    v_mfma_f32_16x16x32_bf16 v[168:171], a[24:27], v[204:207], v[168:171]
    v_rcp_f32 v201, v201
    v_mfma_f32_16x16x32_bf16 v[172:175], a[104:107], v[204:207], v[172:175]
    v_mul_f32 v200, v200, v201
    v_mul_f32 v196, v196, v201
    v_mfma_f32_16x16x32_bf16 v[176:179], v[204:207], a[184:187], v[176:179]
    s_waitcnt lgkmcnt(1)
    v_mul_f32 v197, v197, v201
    v_mul_f32 v198, v198, v201
    v_mfma_f32_16x16x32_bf16 v[180:183], v[32:35], v[208:211], v[180:183]
    ds_read_b128 v[204:207], v246 offset:32768
    v_mul_f32 v199, v199, v201
    v_mfma_f32_16x16x32_bf16 v[168:171], a[28:31], v[208:211], v[168:171]
    v_cvt_pk_bf16_f32 v200, v200, v200
    v_cvt_pk_bf16_f32 v196, v196, v197
    v_mfma_f32_16x16x32_bf16 v[172:175], a[108:111], v[208:211], v[172:175]
    v_cvt_pk_bf16_f32 v197, v198, v199
    v_mfma_f32_16x16x32_bf16 v[176:179], v[208:211], a[188:191], v[176:179]
    ds_write_b16 v250, v200 offset:2048
Lback_95:
    s_waitcnt lgkmcnt(2)
    v_mfma_f32_16x16x32_bf16 v[180:183], v[36:39], v[212:215], v[180:183]
    ds_read_b128 v[208:211], v245 offset:33792
    v_mfma_f32_16x16x32_bf16 v[168:171], a[32:35], v[212:215], v[168:171]
    ds_write_b64 v249, v[196:197] offset:0
    v_mfma_f32_16x16x32_bf16 v[172:175], a[112:115], v[212:215], v[172:175]
    v_mfma_f32_16x16x32_bf16 v[176:179], v[212:215], a[192:195], v[176:179]
    s_waitcnt lgkmcnt(3)
    v_mfma_f32_16x16x32_bf16 v[180:183], v[40:43], v[204:207], v[180:183]
    ds_read_b128 v[212:215], v246 offset:33792
    v_mfma_f32_16x16x32_bf16 v[168:171], a[36:39], v[204:207], v[168:171]
    v_mfma_f32_16x16x32_bf16 v[172:175], a[116:119], v[204:207], v[172:175]
    s_waitcnt lgkmcnt(1)
    s_barrier
    ds_read_b64 v[240:241], v255 offset:2048
    ds_read_b128 v[220:223], v247 offset:0
    v_mfma_f32_16x16x32_bf16 v[176:179], v[204:207], a[196:199], v[176:179]
    ds_read_b128 v[216:219], v247 offset:1024
    v_mfma_f32_16x16x32_bf16 v[180:183], v[44:47], v[208:211], v[180:183]
    ds_read_b128 v[204:207], v245 offset:34816
    v_mfma_f32_16x16x32_bf16 v[168:171], a[40:43], v[208:211], v[168:171]
    v_mfma_f32_16x16x32_bf16 v[172:175], a[120:123], v[208:211], v[172:175]
    v_mfma_f32_16x16x32_bf16 v[176:179], v[208:211], a[200:203], v[176:179]
    s_waitcnt lgkmcnt(3)
    v_mfma_f32_16x16x16_bf16 v[184:187], a[240:241], v[240:241], 0
    v_mfma_f32_16x16x16_bf16 v[188:191], a[242:243], v[240:241], 0
    v_mfma_f32_16x16x16_bf16 v[192:195], a[244:245], v[240:241], 0
    v_mfma_f32_16x16x16_bf16 v[196:199], a[246:247], v[240:241], 0
    v_mfma_f32_16x16x16_bf16 v[200:203], a[248:249], v[240:241], 0
    v_mfma_f32_16x16x32_bf16 v[180:183], v[48:51], v[212:215], v[180:183]
    ds_read_b128 v[208:211], v246 offset:34816
    v_mfma_f32_16x16x32_bf16 v[168:171], a[44:47], v[212:215], v[168:171]
    v_mfma_f32_16x16x32_bf16 v[172:175], a[124:127], v[212:215], v[172:175]
    v_mfma_f32_16x16x32_bf16 v[176:179], v[212:215], a[204:207], v[176:179]
    s_waitcnt lgkmcnt(3)
    v_mfma_f32_16x16x32_bf16 v[184:187], v[84:87], v[220:223], v[184:187]
    v_mfma_f32_16x16x32_bf16 v[188:191], v[92:95], v[220:223], v[188:191]
    s_waitcnt lgkmcnt(2)
    v_mfma_f32_16x16x32_bf16 v[184:187], v[88:91], v[216:219], v[184:187]
    s_nop 2
    v_mfma_f32_16x16x32_bf16 v[188:191], v[96:99], v[216:219], v[188:191]
    s_nop 2
    v_mfma_f32_16x16x32_bf16 v[192:195], v[100:103], v[220:223], v[192:195]
    v_cvt_pk_bf16_f32 v184, v184, v185
    v_cvt_pk_bf16_f32 v185, v186, v187
    v_mfma_f32_16x16x32_bf16 v[196:199], v[108:111], v[220:223], v[196:199]
    s_nop 0
    v_cvt_pk_bf16_f32 v186, v188, v189
    v_cvt_pk_bf16_f32 v187, v190, v191
    v_mfma_f32_16x16x32_bf16 v[192:195], v[104:107], v[216:219], v[192:195]
    buffer_store_dwordx4 v[184:187], v251, s[4:7], s78 offen offset:0 sc1
    s_nop 4
    v_mfma_f32_16x16x32_bf16 v[196:199], v[112:115], v[216:219], v[196:199]
    s_nop 0
    v_cvt_pk_bf16_f32 v192, v192, v193
    v_cvt_pk_bf16_f32 v193, v194, v195
    v_mfma_f32_16x16x32_bf16 v[200:203], v[116:119], v[220:223], v[200:203]
    s_nop 2
    v_mfma_f32_16x16x32_bf16 v[200:203], v[120:123], v[216:219], v[200:203]
    v_cvt_pk_bf16_f32 v194, v196, v197
    v_cvt_pk_bf16_f32 v195, v198, v199
    s_waitcnt lgkmcnt(1)
    v_mfma_f32_16x16x32_bf16 v[180:183], v[52:55], v[204:207], v[180:183]
    ds_read_b128 v[212:215], v245 offset:35840
    v_mfma_f32_16x16x32_bf16 v[168:171], a[48:51], v[204:207], v[168:171]
    buffer_store_dwordx4 v[192:195], v251, s[4:7], s79 offen offset:0 sc1
    s_nop 0
    v_cvt_pk_bf16_f32 v200, v200, v201
    v_cvt_pk_bf16_f32 v201, v202, v203
    v_mfma_f32_16x16x32_bf16 v[172:175], a[128:131], v[204:207], v[172:175]
    buffer_store_dwordx2 v[200:201], v252, s[4:7], s73 offen offset:0 sc1
    v_mfma_f32_16x16x32_bf16 v[176:179], v[204:207], a[208:211], v[176:179]
    s_waitcnt lgkmcnt(1)
    v_mfma_f32_16x16x32_bf16 v[180:183], v[56:59], v[208:211], v[180:183]
    ds_read_b128 v[204:207], v246 offset:35840
    v_mfma_f32_16x16x32_bf16 v[168:171], a[52:55], v[208:211], v[168:171]
    v_mfma_f32_16x16x32_bf16 v[172:175], a[132:135], v[208:211], v[172:175]
    v_mfma_f32_16x16x32_bf16 v[176:179], v[208:211], a[212:215], v[176:179]
    v_mfma_f32_16x16x16_bf16 v[184:187], a[250:251], v[240:241], 0
    v_mfma_f32_16x16x16_bf16 v[188:191], a[252:253], v[240:241], 0
    v_mfma_f32_16x16x16_bf16 v[192:195], a[254:255], v[240:241], 0
    v_mfma_f32_16x16x16_bf16 v[196:199], v[164:165], v[240:241], 0
    v_mfma_f32_16x16x16_bf16 v[200:203], v[166:167], v[240:241], 0
    s_waitcnt lgkmcnt(1)
    v_mfma_f32_16x16x32_bf16 v[180:183], v[60:63], v[212:215], v[180:183]
    ds_read_b128 v[208:211], v245 offset:36864
    v_mfma_f32_16x16x32_bf16 v[168:171], a[56:59], v[212:215], v[168:171]
    v_mfma_f32_16x16x32_bf16 v[172:175], a[136:139], v[212:215], v[172:175]
    v_mfma_f32_16x16x32_bf16 v[176:179], v[212:215], a[216:219], v[176:179]
    v_mfma_f32_16x16x32_bf16 v[184:187], v[124:127], v[220:223], v[184:187]
    v_mfma_f32_16x16x32_bf16 v[188:191], v[132:135], v[220:223], v[188:191]
    v_mfma_f32_16x16x32_bf16 v[184:187], v[128:131], v[216:219], v[184:187]
    s_nop 2
    v_mfma_f32_16x16x32_bf16 v[188:191], v[136:139], v[216:219], v[188:191]
    s_nop 2
    v_mfma_f32_16x16x32_bf16 v[192:195], v[140:143], v[220:223], v[192:195]
    v_cvt_pk_bf16_f32 v184, v184, v185
    v_cvt_pk_bf16_f32 v185, v186, v187
    v_mfma_f32_16x16x32_bf16 v[196:199], v[148:151], v[220:223], v[196:199]
    s_nop 0
    v_cvt_pk_bf16_f32 v186, v188, v189
    v_cvt_pk_bf16_f32 v187, v190, v191
    v_mfma_f32_16x16x32_bf16 v[192:195], v[144:147], v[216:219], v[192:195]
    buffer_store_dwordx4 v[184:187], v251, s[4:7], s78 offen offset:1024 sc1
    s_nop 4
    v_mfma_f32_16x16x32_bf16 v[196:199], v[152:155], v[216:219], v[196:199]
    s_nop 0
    v_cvt_pk_bf16_f32 v192, v192, v193
    v_cvt_pk_bf16_f32 v193, v194, v195
    v_mfma_f32_16x16x32_bf16 v[200:203], v[156:159], v[220:223], v[200:203]
    s_nop 2
    v_mfma_f32_16x16x32_bf16 v[200:203], v[160:163], v[216:219], v[200:203]
    v_cvt_pk_bf16_f32 v194, v196, v197
    v_cvt_pk_bf16_f32 v195, v198, v199
    s_waitcnt lgkmcnt(1)
    v_mfma_f32_16x16x32_bf16 v[180:183], v[64:67], v[204:207], v[180:183]
    ds_read_b128 v[212:215], v246 offset:36864
    v_mfma_f32_16x16x32_bf16 v[168:171], a[60:63], v[204:207], v[168:171]
    buffer_store_dwordx4 v[192:195], v251, s[4:7], s79 offen offset:1024 sc1
    s_nop 0
    v_cvt_pk_bf16_f32 v200, v200, v201
    v_cvt_pk_bf16_f32 v201, v202, v203
    v_mfma_f32_16x16x32_bf16 v[172:175], a[140:143], v[204:207], v[172:175]
    buffer_store_dwordx2 v[200:201], v252, s[4:7], s73 offen offset:1024 sc1
    ds_read_b128 v[188:191], v247 offset:5120
    ds_read_b128 v[184:187], v247 offset:6144
    v_mfma_f32_16x16x32_bf16 v[176:179], v[204:207], a[220:223], v[176:179]
    s_waitcnt lgkmcnt(3)
    v_mfma_f32_16x16x32_bf16 v[180:183], v[68:71], v[208:211], v[180:183]
    ds_read_b128 v[204:207], v245 offset:37888
    v_mfma_f32_16x16x32_bf16 v[168:171], a[64:67], v[208:211], v[168:171]
    v_mfma_f32_16x16x32_bf16 v[172:175], a[144:147], v[208:211], v[172:175]
    v_mfma_f32_16x16x32_bf16 v[176:179], v[208:211], a[224:227], v[176:179]
    s_waitcnt lgkmcnt(3)
    v_mfma_f32_16x16x32_bf16 v[180:183], v[72:75], v[212:215], v[180:183]
    ds_read_b128 v[208:211], v246 offset:37888
    v_mfma_f32_16x16x32_bf16 v[168:171], a[68:71], v[212:215], v[168:171]
    v_mfma_f32_16x16x32_bf16 v[172:175], a[148:151], v[212:215], v[172:175]
    v_mfma_f32_16x16x32_bf16 v[176:179], v[212:215], a[228:231], v[176:179]
    s_waitcnt lgkmcnt(1)
    v_mfma_f32_16x16x32_bf16 v[180:183], v[76:79], v[204:207], v[180:183]
    v_mfma_f32_16x16x32_bf16 v[168:171], a[72:75], v[204:207], v[168:171]
    v_mfma_f32_16x16x32_bf16 v[172:175], a[152:155], v[204:207], v[172:175]
    v_mfma_f32_16x16x32_bf16 v[176:179], v[204:207], a[232:235], v[176:179]
    s_waitcnt lgkmcnt(0)
    v_mfma_f32_16x16x32_bf16 v[180:183], v[80:83], v[208:211], v[180:183]
    s_nop 2
    v_mfma_f32_16x16x32_bf16 v[168:171], a[76:79], v[208:211], v[168:171]
    s_nop 2
    v_mfma_f32_16x16x32_bf16 v[172:175], a[156:159], v[208:211], v[172:175]
    s_nop 2
    v_mfma_f32_16x16x32_bf16 v[176:179], v[208:211], a[236:239], v[176:179]
    s_add_u32 s62, s62, 1
    s_mov_b32 s80, 1
    s_waitcnt vmcnt(6)
    s_branch L_Be1
L_Bi1:
    s_mov_b32 s75, 0
    ds_read_b128 v[204:207], v245 offset:8192
    ds_read_b128 v[208:211], v246 offset:8192
    v_max3_f32 v192, v184, v185, v186
    v_max3_f32 v193, v188, v189, v190
    v_max3_f32 v192, v192, v187, v191
    v_max_f32 v192, v192, v193
    s_waitcnt lgkmcnt(1)
    v_mfma_f32_16x16x32_bf16 v[180:183], v[4:7], v[204:207], 0
    ds_read_b128 v[212:215], v245 offset:9216
    v_mov_b32 v193, v192
    v_mfma_f32_16x16x32_bf16 v[168:171], a[0:3], v[204:207], 0
    s_nop 0
    v_permlane16_swap_b32 v192, v193
    v_mfma_f32_16x16x32_bf16 v[172:175], a[80:83], v[204:207], 0
    v_max_f32 v192, v192, v193
    v_mov_b32 v193, v192
    v_mfma_f32_16x16x32_bf16 v[176:179], v[204:207], a[160:163], 0
    s_waitcnt lgkmcnt(1)
    v_permlane32_swap_b32 v192, v193
    v_mfma_f32_16x16x32_bf16 v[180:183], v[8:11], v[208:211], v[180:183]
    ds_read_b128 v[204:207], v246 offset:9216
    v_max_f32 v192, v192, v193
    v_mfma_f32_16x16x32_bf16 v[168:171], a[4:7], v[208:211], v[168:171]
    v_mul_f32 v192, s77, v192
    v_fma_f32 v184, v184, s77, -v192
    v_mfma_f32_16x16x32_bf16 v[172:175], a[84:87], v[208:211], v[172:175]
    v_fma_f32 v185, v185, s77, -v192
    v_fma_f32 v186, v186, s77, -v192
    v_mfma_f32_16x16x32_bf16 v[176:179], v[208:211], a[164:167], v[176:179]
    s_waitcnt lgkmcnt(1)
    v_fma_f32 v187, v187, s77, -v192
    v_fma_f32 v188, v188, s77, -v192
    v_mfma_f32_16x16x32_bf16 v[180:183], v[12:15], v[212:215], v[180:183]
    ds_read_b128 v[208:211], v245 offset:10240
    v_fma_f32 v189, v189, s77, -v192
    v_mfma_f32_16x16x32_bf16 v[168:171], a[8:11], v[212:215], v[168:171]
    v_fma_f32 v190, v190, s77, -v192
    v_fma_f32 v191, v191, s77, -v192
    v_mfma_f32_16x16x32_bf16 v[172:175], a[88:91], v[212:215], v[172:175]
    v_exp_f32 v184, v184
    v_mfma_f32_16x16x32_bf16 v[176:179], v[212:215], a[168:171], v[176:179]
    s_waitcnt lgkmcnt(1)
    v_exp_f32 v185, v185
    v_mfma_f32_16x16x32_bf16 v[180:183], v[16:19], v[204:207], v[180:183]
    ds_read_b128 v[212:215], v246 offset:10240
    v_mfma_f32_16x16x32_bf16 v[168:171], a[12:15], v[204:207], v[168:171]
    v_exp_f32 v186, v186
    v_mfma_f32_16x16x32_bf16 v[172:175], a[92:95], v[204:207], v[172:175]
    v_exp_f32 v187, v187
    v_mfma_f32_16x16x32_bf16 v[176:179], v[204:207], a[172:175], v[176:179]
    s_waitcnt lgkmcnt(1)
    v_exp_f32 v188, v188
    v_mfma_f32_16x16x32_bf16 v[180:183], v[20:23], v[208:211], v[180:183]
    ds_read_b128 v[204:207], v245 offset:11264
    v_mfma_f32_16x16x32_bf16 v[168:171], a[16:19], v[208:211], v[168:171]
    v_exp_f32 v189, v189
    v_mfma_f32_16x16x32_bf16 v[172:175], a[96:99], v[208:211], v[172:175]
    v_exp_f32 v190, v190
    v_mfma_f32_16x16x32_bf16 v[176:179], v[208:211], a[176:179], v[176:179]
    s_waitcnt lgkmcnt(1)
    v_exp_f32 v191, v191
    v_mfma_f32_16x16x32_bf16 v[180:183], v[24:27], v[212:215], v[180:183]
    ds_read_b128 v[208:211], v246 offset:11264
    v_cvt_pk_bf16_f32 v184, v184, v185
    v_mfma_f32_16x16x32_bf16 v[168:171], a[20:23], v[212:215], v[168:171]
    v_cvt_pk_bf16_f32 v185, v186, v187
    v_cvt_pk_bf16_f32 v186, v188, v189
    v_mfma_f32_16x16x32_bf16 v[172:175], a[100:103], v[212:215], v[172:175]
    v_cvt_pk_bf16_f32 v187, v190, v191
    s_nop 0
    v_mfma_f32_16x16x32_bf16 v[176:179], v[212:215], a[180:183], v[176:179]
    v_mfma_f32_16x16x32_bf16 v[200:203], v[236:239], v[184:187], 0
    s_nop 2
    v_mfma_f32_16x16x32_bf16 v[196:199], v[232:235], v[184:187], 0
    s_waitcnt vmcnt(0)
    s_cmp_eq_u32 s80, 0
    s_cbranch_scc1 Lowed_96
    s_waitcnt vmcnt(0)
    v_mov_b32 v2, s62
    s_mov_b64 exec, 1
    buffer_store_dword v2, off, s[4:7], s63 sc1
    buffer_store_dword v2, off, s[4:7], s3
    s_mov_b64 exec, -1
    s_mov_b32 s80, 0
Lowed_96:
    s_add_u32 s65, s62, s75
    s_add_u32 s65, s65, 3
    v_cmp_gt_u32 vcc, s65, v254
    s_cbranch_vccz Lpre_97
    s_waitcnt lgkmcnt(1)
    v_mfma_f32_16x16x32_bf16 v[180:183], v[28:31], v[204:207], v[180:183]
    ds_read_b128 v[212:215], v245 offset:12288
    v_mfma_f32_16x16x32_bf16 v[168:171], a[24:27], v[204:207], v[168:171]
    v_rcp_f32 v201, v201
    v_mfma_f32_16x16x32_bf16 v[172:175], a[104:107], v[204:207], v[172:175]
    v_mul_f32 v200, v200, v201
    v_mul_f32 v196, v196, v201
    v_mfma_f32_16x16x32_bf16 v[176:179], v[204:207], a[184:187], v[176:179]
    s_waitcnt lgkmcnt(1)
    v_mul_f32 v197, v197, v201
    v_mul_f32 v198, v198, v201
    v_mfma_f32_16x16x32_bf16 v[180:183], v[32:35], v[208:211], v[180:183]
    ds_read_b128 v[204:207], v246 offset:12288
    v_mul_f32 v199, v199, v201
    v_mfma_f32_16x16x32_bf16 v[168:171], a[28:31], v[208:211], v[168:171]
    v_cvt_pk_bf16_f32 v200, v200, v200
    v_cvt_pk_bf16_f32 v196, v196, v197
    v_mfma_f32_16x16x32_bf16 v[172:175], a[108:111], v[208:211], v[172:175]
    v_cvt_pk_bf16_f32 v197, v198, v199
    v_mfma_f32_16x16x32_bf16 v[176:179], v[208:211], a[188:191], v[176:179]
    ds_write_b16 v250, v200 offset:2048
Lback_98:
    s_waitcnt lgkmcnt(2)
    v_mfma_f32_16x16x32_bf16 v[180:183], v[36:39], v[212:215], v[180:183]
    ds_read_b128 v[208:211], v245 offset:13312
    v_mfma_f32_16x16x32_bf16 v[168:171], a[32:35], v[212:215], v[168:171]
    ds_write_b64 v249, v[196:197] offset:0
    v_mfma_f32_16x16x32_bf16 v[172:175], a[112:115], v[212:215], v[172:175]
    v_mfma_f32_16x16x32_bf16 v[176:179], v[212:215], a[192:195], v[176:179]
    s_waitcnt lgkmcnt(3)
    v_mfma_f32_16x16x32_bf16 v[180:183], v[40:43], v[204:207], v[180:183]
    ds_read_b128 v[212:215], v246 offset:13312
    v_mfma_f32_16x16x32_bf16 v[168:171], a[36:39], v[204:207], v[168:171]
    v_mfma_f32_16x16x32_bf16 v[172:175], a[116:119], v[204:207], v[172:175]
    s_waitcnt lgkmcnt(1)
    s_barrier
    ds_read_b64 v[240:241], v255 offset:2048
    ds_read_b128 v[220:223], v247 offset:0
    v_mfma_f32_16x16x32_bf16 v[176:179], v[204:207], a[196:199], v[176:179]
    ds_read_b128 v[216:219], v247 offset:1024
    v_mfma_f32_16x16x32_bf16 v[180:183], v[44:47], v[208:211], v[180:183]
    ds_read_b128 v[204:207], v245 offset:14336
    v_mfma_f32_16x16x32_bf16 v[168:171], a[40:43], v[208:211], v[168:171]
    v_mfma_f32_16x16x32_bf16 v[172:175], a[120:123], v[208:211], v[172:175]
    v_mfma_f32_16x16x32_bf16 v[176:179], v[208:211], a[200:203], v[176:179]
    s_waitcnt lgkmcnt(3)
    v_mfma_f32_16x16x16_bf16 v[184:187], a[240:241], v[240:241], 0
    v_mfma_f32_16x16x16_bf16 v[188:191], a[242:243], v[240:241], 0
    v_mfma_f32_16x16x16_bf16 v[192:195], a[244:245], v[240:241], 0
    v_mfma_f32_16x16x16_bf16 v[196:199], a[246:247], v[240:241], 0
    v_mfma_f32_16x16x16_bf16 v[200:203], a[248:249], v[240:241], 0
    v_mfma_f32_16x16x32_bf16 v[180:183], v[48:51], v[212:215], v[180:183]
    ds_read_b128 v[208:211], v246 offset:14336
    v_mfma_f32_16x16x32_bf16 v[168:171], a[44:47], v[212:215], v[168:171]
    v_mfma_f32_16x16x32_bf16 v[172:175], a[124:127], v[212:215], v[172:175]
    v_mfma_f32_16x16x32_bf16 v[176:179], v[212:215], a[204:207], v[176:179]
    s_waitcnt lgkmcnt(3)
    v_mfma_f32_16x16x32_bf16 v[184:187], v[84:87], v[220:223], v[184:187]
    v_mfma_f32_16x16x32_bf16 v[188:191], v[92:95], v[220:223], v[188:191]
    s_waitcnt lgkmcnt(2)
    v_mfma_f32_16x16x32_bf16 v[184:187], v[88:91], v[216:219], v[184:187]
    s_nop 2
    v_mfma_f32_16x16x32_bf16 v[188:191], v[96:99], v[216:219], v[188:191]
    s_nop 2
    v_mfma_f32_16x16x32_bf16 v[192:195], v[100:103], v[220:223], v[192:195]
    v_cvt_pk_bf16_f32 v184, v184, v185
    v_cvt_pk_bf16_f32 v185, v186, v187
    v_mfma_f32_16x16x32_bf16 v[196:199], v[108:111], v[220:223], v[196:199]
    s_nop 0
    v_cvt_pk_bf16_f32 v186, v188, v189
    v_cvt_pk_bf16_f32 v187, v190, v191
    v_mfma_f32_16x16x32_bf16 v[192:195], v[104:107], v[216:219], v[192:195]
    buffer_store_dwordx4 v[184:187], v251, s[4:7], s78 offen offset:0 sc1
    s_nop 4
    v_mfma_f32_16x16x32_bf16 v[196:199], v[112:115], v[216:219], v[196:199]
    s_nop 0
    v_cvt_pk_bf16_f32 v192, v192, v193
    v_cvt_pk_bf16_f32 v193, v194, v195
    v_mfma_f32_16x16x32_bf16 v[200:203], v[116:119], v[220:223], v[200:203]
    s_nop 2
    v_mfma_f32_16x16x32_bf16 v[200:203], v[120:123], v[216:219], v[200:203]
    v_cvt_pk_bf16_f32 v194, v196, v197
    v_cvt_pk_bf16_f32 v195, v198, v199
    s_waitcnt lgkmcnt(1)
    v_mfma_f32_16x16x32_bf16 v[180:183], v[52:55], v[204:207], v[180:183]
    ds_read_b128 v[212:215], v245 offset:15360
    v_mfma_f32_16x16x32_bf16 v[168:171], a[48:51], v[204:207], v[168:171]
    buffer_store_dwordx4 v[192:195], v251, s[4:7], s79 offen offset:0 sc1
    s_nop 0
    v_cvt_pk_bf16_f32 v200, v200, v201
    v_cvt_pk_bf16_f32 v201, v202, v203
    v_mfma_f32_16x16x32_bf16 v[172:175], a[128:131], v[204:207], v[172:175]
    buffer_store_dwordx2 v[200:201], v252, s[4:7], s73 offen offset:512 sc1
    v_mfma_f32_16x16x32_bf16 v[176:179], v[204:207], a[208:211], v[176:179]
    s_waitcnt lgkmcnt(1)
    v_mfma_f32_16x16x32_bf16 v[180:183], v[56:59], v[208:211], v[180:183]
    ds_read_b128 v[204:207], v246 offset:15360
    v_mfma_f32_16x16x32_bf16 v[168:171], a[52:55], v[208:211], v[168:171]
    v_mfma_f32_16x16x32_bf16 v[172:175], a[132:135], v[208:211], v[172:175]
    v_mfma_f32_16x16x32_bf16 v[176:179], v[208:211], a[212:215], v[176:179]
    v_mfma_f32_16x16x16_bf16 v[184:187], a[250:251], v[240:241], 0
    v_mfma_f32_16x16x16_bf16 v[188:191], a[252:253], v[240:241], 0
    v_mfma_f32_16x16x16_bf16 v[192:195], a[254:255], v[240:241], 0
    v_mfma_f32_16x16x16_bf16 v[196:199], v[164:165], v[240:241], 0
    v_mfma_f32_16x16x16_bf16 v[200:203], v[166:167], v[240:241], 0
    s_waitcnt lgkmcnt(1)
    v_mfma_f32_16x16x32_bf16 v[180:183], v[60:63], v[212:215], v[180:183]
    ds_read_b128 v[208:211], v245 offset:16384
    v_mfma_f32_16x16x32_bf16 v[168:171], a[56:59], v[212:215], v[168:171]
    v_mfma_f32_16x16x32_bf16 v[172:175], a[136:139], v[212:215], v[172:175]
    v_mfma_f32_16x16x32_bf16 v[176:179], v[212:215], a[216:219], v[176:179]
    v_mfma_f32_16x16x32_bf16 v[184:187], v[124:127], v[220:223], v[184:187]
    v_mfma_f32_16x16x32_bf16 v[188:191], v[132:135], v[220:223], v[188:191]
    v_mfma_f32_16x16x32_bf16 v[184:187], v[128:131], v[216:219], v[184:187]
    s_nop 2
    v_mfma_f32_16x16x32_bf16 v[188:191], v[136:139], v[216:219], v[188:191]
    s_nop 2
    v_mfma_f32_16x16x32_bf16 v[192:195], v[140:143], v[220:223], v[192:195]
    v_cvt_pk_bf16_f32 v184, v184, v185
    v_cvt_pk_bf16_f32 v185, v186, v187
    v_mfma_f32_16x16x32_bf16 v[196:199], v[148:151], v[220:223], v[196:199]
    s_nop 0
    v_cvt_pk_bf16_f32 v186, v188, v189
    v_cvt_pk_bf16_f32 v187, v190, v191
    v_mfma_f32_16x16x32_bf16 v[192:195], v[144:147], v[216:219], v[192:195]
    buffer_store_dwordx4 v[184:187], v251, s[4:7], s78 offen offset:1024 sc1
    s_nop 4
    v_mfma_f32_16x16x32_bf16 v[196:199], v[152:155], v[216:219], v[196:199]
    s_nop 0
    v_cvt_pk_bf16_f32 v192, v192, v193
    v_cvt_pk_bf16_f32 v193, v194, v195
    v_mfma_f32_16x16x32_bf16 v[200:203], v[156:159], v[220:223], v[200:203]
    s_nop 2
    v_mfma_f32_16x16x32_bf16 v[200:203], v[160:163], v[216:219], v[200:203]
    v_cvt_pk_bf16_f32 v194, v196, v197
    v_cvt_pk_bf16_f32 v195, v198, v199
    s_waitcnt lgkmcnt(1)
    v_mfma_f32_16x16x32_bf16 v[180:183], v[64:67], v[204:207], v[180:183]
    ds_read_b128 v[212:215], v246 offset:16384
    v_mfma_f32_16x16x32_bf16 v[168:171], a[60:63], v[204:207], v[168:171]
    buffer_store_dwordx4 v[192:195], v251, s[4:7], s79 offen offset:1024 sc1
    s_nop 0
    v_cvt_pk_bf16_f32 v200, v200, v201
    v_cvt_pk_bf16_f32 v201, v202, v203
    v_mfma_f32_16x16x32_bf16 v[172:175], a[140:143], v[204:207], v[172:175]
    buffer_store_dwordx2 v[200:201], v252, s[4:7], s73 offen offset:1536 sc1
    ds_read_b128 v[184:187], v248 offset:5120
    ds_read_b128 v[188:191], v247 offset:6144
    v_mfma_f32_16x16x32_bf16 v[176:179], v[204:207], a[220:223], v[176:179]
    s_waitcnt lgkmcnt(3)
    v_mfma_f32_16x16x32_bf16 v[180:183], v[68:71], v[208:211], v[180:183]
    ds_read_b128 v[204:207], v245 offset:17408
    v_mfma_f32_16x16x32_bf16 v[168:171], a[64:67], v[208:211], v[168:171]
    v_mfma_f32_16x16x32_bf16 v[172:175], a[144:147], v[208:211], v[172:175]
    v_mfma_f32_16x16x32_bf16 v[176:179], v[208:211], a[224:227], v[176:179]
    s_waitcnt lgkmcnt(3)
    v_mfma_f32_16x16x32_bf16 v[180:183], v[72:75], v[212:215], v[180:183]
    ds_read_b128 v[208:211], v246 offset:17408
    v_mfma_f32_16x16x32_bf16 v[168:171], a[68:71], v[212:215], v[168:171]
    v_mfma_f32_16x16x32_bf16 v[172:175], a[148:151], v[212:215], v[172:175]
    v_mfma_f32_16x16x32_bf16 v[176:179], v[212:215], a[228:231], v[176:179]
    s_waitcnt lgkmcnt(1)
    v_mfma_f32_16x16x32_bf16 v[180:183], v[76:79], v[204:207], v[180:183]
    v_mfma_f32_16x16x32_bf16 v[168:171], a[72:75], v[204:207], v[168:171]
    v_mfma_f32_16x16x32_bf16 v[172:175], a[152:155], v[204:207], v[172:175]
    v_mfma_f32_16x16x32_bf16 v[176:179], v[204:207], a[232:235], v[176:179]
    s_waitcnt lgkmcnt(0)
    v_mfma_f32_16x16x32_bf16 v[180:183], v[80:83], v[208:211], v[180:183]
    s_nop 2
    v_mfma_f32_16x16x32_bf16 v[168:171], a[76:79], v[208:211], v[168:171]
    s_nop 2
    v_mfma_f32_16x16x32_bf16 v[172:175], a[156:159], v[208:211], v[172:175]
    s_nop 2
    v_mfma_f32_16x16x32_bf16 v[176:179], v[208:211], a[236:239], v[176:179]
    s_add_u32 s62, s62, 1
    s_mov_b32 s80, 1
    s_waitcnt vmcnt(6)
    s_branch L_Be0
Lgrty_71:
    s_sleep 16
    buffer_load_dword v2, off, s[8:11], 0 offset:132 sc1
    s_sub_u32 s61, s61, 1
    s_mov_b32 s67, 1
    s_cbranch_scc1 L_fail
    s_branch Lgchk_70
Lprty_74:
    s_sleep 16
    buffer_load_dword v2, off, s[8:11], 0 offset:140 sc1
    s_sub_u32 s61, s61, 1
    s_mov_b32 s67, 16
    s_cbranch_scc1 L_fail
    s_branch Lpchk_73
Lfrty_77:
    s_sleep 4
    buffer_load_dword v254, v253, s[4:7], 0 offen sc1
    s_sub_u32 s61, s61, 1
    s_mov_b32 s67, 30
    s_cbranch_scc1 L_fail
    s_waitcnt vmcnt(0)
    s_branch Lfchk_76
Lpre_79:
    s_waitcnt lgkmcnt(1)
    v_mfma_f32_16x16x32_bf16 v[180:183], v[44:47], v[208:211], v[180:183]
    s_movk_i32 s75, 1000
    s_add_u32 m0, s74, 28672
    s_add_u32 s64, s70, 36864
    ds_read_b128 v[204:207], v245 offset:14336
    ds_read_b128 v[184:187], v248 offset:5120
    v_mfma_f32_16x16x32_bf16 v[168:171], a[40:43], v[208:211], v[168:171]
    buffer_load_dwordx4 v244, s[4:7], s64 offen sc1 lds
    s_add_u32 m0, s74, 32768
    s_add_u32 s64, s70, 49152
    ds_read_b128 v[188:191], v247 offset:6144
    v_mfma_f32_16x16x32_bf16 v[172:175], a[120:123], v[208:211], v[172:175]
    buffer_load_dwordx4 v244, s[4:7], s64 offen sc1 lds
    s_add_u32 m0, s74, 36864
    s_add_u32 s64, s70, 53248
    v_mfma_f32_16x16x32_bf16 v[176:179], v[208:211], a[200:203], v[176:179]
    buffer_load_dwordx4 v244, s[4:7], s64 offen sc1 lds
    s_add_u32 m0, s74, 40960
    s_add_u32 s64, s70, 65536
    s_waitcnt lgkmcnt(3)
    v_mfma_f32_16x16x32_bf16 v[180:183], v[48:51], v[212:215], v[180:183]
    buffer_load_dwordx4 v244, s[4:7], s64 offen sc1 lds
    s_add_u32 m0, s74, 45056
    s_add_u32 s64, s70, 69632
    ds_read_b128 v[208:211], v246 offset:14336
    v_mfma_f32_16x16x32_bf16 v[168:171], a[44:47], v[212:215], v[168:171]
    buffer_load_dwordx4 v244, s[4:7], s64 offen sc1 lds
    s_add_u32 s71, s71, 131072
    s_lshr_b32 s70, s71, 8
    v_mfma_f32_16x16x32_bf16 v[172:175], a[124:127], v[212:215], v[172:175]
    s_xor_b32 s70, s70, s1
    s_and_b32 s70, s70, 0x2000
    s_or_b32 s70, s70, s71
    v_mfma_f32_16x16x32_bf16 v[176:179], v[212:215], a[204:207], v[176:179]
    s_waitcnt lgkmcnt(3)
    v_mfma_f32_16x16x32_bf16 v[180:183], v[52:55], v[204:207], v[180:183]
    ds_read_b128 v[212:215], v245 offset:15360
    v_mfma_f32_16x16x32_bf16 v[168:171], a[48:51], v[204:207], v[168:171]
    v_mfma_f32_16x16x32_bf16 v[172:175], a[128:131], v[204:207], v[172:175]
    v_mfma_f32_16x16x32_bf16 v[176:179], v[204:207], a[208:211], v[176:179]
    s_waitcnt lgkmcnt(1)
    v_mfma_f32_16x16x32_bf16 v[180:183], v[56:59], v[208:211], v[180:183]
    ds_read_b128 v[204:207], v246 offset:15360
    v_mfma_f32_16x16x32_bf16 v[168:171], a[52:55], v[208:211], v[168:171]
    v_mfma_f32_16x16x32_bf16 v[172:175], a[132:135], v[208:211], v[172:175]
    v_mfma_f32_16x16x32_bf16 v[176:179], v[208:211], a[212:215], v[176:179]
    s_waitcnt lgkmcnt(1)
    v_mfma_f32_16x16x32_bf16 v[180:183], v[60:63], v[212:215], v[180:183]
    ds_read_b128 v[208:211], v245 offset:16384
    v_mfma_f32_16x16x32_bf16 v[168:171], a[56:59], v[212:215], v[168:171]
    v_mfma_f32_16x16x32_bf16 v[172:175], a[136:139], v[212:215], v[172:175]
    v_mfma_f32_16x16x32_bf16 v[176:179], v[212:215], a[216:219], v[176:179]
    s_waitcnt lgkmcnt(1)
    v_mfma_f32_16x16x32_bf16 v[180:183], v[64:67], v[204:207], v[180:183]
    ds_read_b128 v[212:215], v246 offset:16384
    v_mfma_f32_16x16x32_bf16 v[168:171], a[60:63], v[204:207], v[168:171]
    v_mfma_f32_16x16x32_bf16 v[172:175], a[140:143], v[204:207], v[172:175]
    v_mfma_f32_16x16x32_bf16 v[176:179], v[204:207], a[220:223], v[176:179]
    s_waitcnt lgkmcnt(1)
    v_mfma_f32_16x16x32_bf16 v[180:183], v[68:71], v[208:211], v[180:183]
    ds_read_b128 v[204:207], v245 offset:17408
    v_mfma_f32_16x16x32_bf16 v[168:171], a[64:67], v[208:211], v[168:171]
    v_mfma_f32_16x16x32_bf16 v[172:175], a[144:147], v[208:211], v[172:175]
    v_mfma_f32_16x16x32_bf16 v[176:179], v[208:211], a[224:227], v[176:179]
    s_waitcnt lgkmcnt(1)
    v_mfma_f32_16x16x32_bf16 v[180:183], v[72:75], v[212:215], v[180:183]
    ds_read_b128 v[208:211], v246 offset:17408
    v_mfma_f32_16x16x32_bf16 v[168:171], a[68:71], v[212:215], v[168:171]
    v_mfma_f32_16x16x32_bf16 v[172:175], a[148:151], v[212:215], v[172:175]
    v_mfma_f32_16x16x32_bf16 v[176:179], v[212:215], a[228:231], v[176:179]
    s_waitcnt lgkmcnt(1)
    v_mfma_f32_16x16x32_bf16 v[180:183], v[76:79], v[204:207], v[180:183]
    v_mfma_f32_16x16x32_bf16 v[168:171], a[72:75], v[204:207], v[168:171]
    v_mfma_f32_16x16x32_bf16 v[172:175], a[152:155], v[204:207], v[172:175]
    v_mfma_f32_16x16x32_bf16 v[176:179], v[204:207], a[232:235], v[176:179]
    s_waitcnt lgkmcnt(0)
    v_mfma_f32_16x16x32_bf16 v[180:183], v[80:83], v[208:211], v[180:183]
    s_nop 2
    v_mfma_f32_16x16x32_bf16 v[168:171], a[76:79], v[208:211], v[168:171]
    s_nop 2
    v_mfma_f32_16x16x32_bf16 v[172:175], a[156:159], v[208:211], v[172:175]
    s_nop 2
    v_mfma_f32_16x16x32_bf16 v[176:179], v[208:211], a[236:239], v[176:179]
    s_branch Lback_80
Lpre_82:
    s_waitcnt lgkmcnt(2)
    v_mfma_f32_16x16x16_bf16 v[168:171], a[240:241], v[240:241], 0
    s_movk_i32 s75, 1000
    s_add_u32 m0, s74, 28672
    s_add_u32 s64, s70, 36864
    v_mfma_f32_16x16x16_bf16 v[172:175], a[242:243], v[240:241], 0
    buffer_load_dwordx4 v244, s[4:7], s64 offen sc1 lds
    s_add_u32 m0, s74, 32768
    s_add_u32 s64, s70, 49152
    v_mfma_f32_16x16x16_bf16 v[176:179], a[244:245], v[240:241], 0
    buffer_load_dwordx4 v244, s[4:7], s64 offen sc1 lds
    s_add_u32 m0, s74, 36864
    s_add_u32 s64, s70, 53248
    v_mfma_f32_16x16x16_bf16 v[180:183], a[246:247], v[240:241], 0
    buffer_load_dwordx4 v244, s[4:7], s64 offen sc1 lds
    s_add_u32 m0, s74, 40960
    s_add_u32 s64, s70, 65536
    v_mfma_f32_16x16x16_bf16 v[204:207], a[248:249], v[240:241], 0
    buffer_load_dwordx4 v244, s[4:7], s64 offen sc1 lds
    s_add_u32 m0, s74, 45056
    s_add_u32 s64, s70, 69632
    v_mfma_f32_16x16x16_bf16 v[184:187], a[250:251], v[240:241], 0
    buffer_load_dwordx4 v244, s[4:7], s64 offen sc1 lds
    s_add_u32 s71, s71, 131072
    s_lshr_b32 s70, s71, 8
    v_mfma_f32_16x16x16_bf16 v[188:191], a[252:253], v[240:241], 0
    s_xor_b32 s70, s70, s1
    s_and_b32 s70, s70, 0x2000
    s_or_b32 s70, s70, s71
    v_mfma_f32_16x16x16_bf16 v[192:195], a[254:255], v[240:241], 0
    v_mfma_f32_16x16x16_bf16 v[196:199], v[164:165], v[240:241], 0
    v_mfma_f32_16x16x16_bf16 v[200:203], v[166:167], v[240:241], 0
    s_branch Lback_83
Lfrty_86:
    s_sleep 4
    buffer_load_dword v254, v253, s[4:7], 0 offen sc1
    s_sub_u32 s61, s61, 1
    s_mov_b32 s67, 30
    s_cbranch_scc1 L_fail
    s_waitcnt vmcnt(0)
    s_branch Lfchk_85
Lpre_88:
    s_waitcnt lgkmcnt(1)
    v_mfma_f32_16x16x32_bf16 v[180:183], v[44:47], v[208:211], v[180:183]
    s_movk_i32 s75, 1000
    s_add_u32 m0, s74, 8192
    s_add_u32 s64, s70, 0
    ds_read_b128 v[204:207], v245 offset:34816
    ds_read_b128 v[188:191], v247 offset:5120
    v_mfma_f32_16x16x32_bf16 v[168:171], a[40:43], v[208:211], v[168:171]
    buffer_load_dwordx4 v244, s[4:7], s64 offen sc1 lds
    s_add_u32 m0, s74, 12288
    s_add_u32 s64, s70, 4096
    ds_read_b128 v[184:187], v247 offset:6144
    v_mfma_f32_16x16x32_bf16 v[172:175], a[120:123], v[208:211], v[172:175]
    buffer_load_dwordx4 v244, s[4:7], s64 offen sc1 lds
    s_add_u32 m0, s74, 16384
    s_add_u32 s64, s70, 16384
    v_mfma_f32_16x16x32_bf16 v[176:179], v[208:211], a[200:203], v[176:179]
    buffer_load_dwordx4 v244, s[4:7], s64 offen sc1 lds
    s_add_u32 m0, s74, 20480
    s_add_u32 s64, s70, 20480
    s_waitcnt lgkmcnt(3)
    v_mfma_f32_16x16x32_bf16 v[180:183], v[48:51], v[212:215], v[180:183]
    buffer_load_dwordx4 v244, s[4:7], s64 offen sc1 lds
    s_add_u32 m0, s74, 24576
    s_add_u32 s64, s70, 32768
    ds_read_b128 v[208:211], v246 offset:34816
    v_mfma_f32_16x16x32_bf16 v[168:171], a[44:47], v[212:215], v[168:171]
    buffer_load_dwordx4 v244, s[4:7], s64 offen sc1 lds
    v_mfma_f32_16x16x32_bf16 v[172:175], a[124:127], v[212:215], v[172:175]
    v_mfma_f32_16x16x32_bf16 v[176:179], v[212:215], a[204:207], v[176:179]
    s_waitcnt lgkmcnt(3)
    v_mfma_f32_16x16x32_bf16 v[180:183], v[52:55], v[204:207], v[180:183]
    ds_read_b128 v[212:215], v245 offset:35840
    v_mfma_f32_16x16x32_bf16 v[168:171], a[48:51], v[204:207], v[168:171]
    v_mfma_f32_16x16x32_bf16 v[172:175], a[128:131], v[204:207], v[172:175]
    v_mfma_f32_16x16x32_bf16 v[176:179], v[204:207], a[208:211], v[176:179]
    s_waitcnt lgkmcnt(1)
    v_mfma_f32_16x16x32_bf16 v[180:183], v[56:59], v[208:211], v[180:183]
    ds_read_b128 v[204:207], v246 offset:35840
    v_mfma_f32_16x16x32_bf16 v[168:171], a[52:55], v[208:211], v[168:171]
    v_mfma_f32_16x16x32_bf16 v[172:175], a[132:135], v[208:211], v[172:175]
    v_mfma_f32_16x16x32_bf16 v[176:179], v[208:211], a[212:215], v[176:179]
    s_waitcnt lgkmcnt(1)
    v_mfma_f32_16x16x32_bf16 v[180:183], v[60:63], v[212:215], v[180:183]
    ds_read_b128 v[208:211], v245 offset:36864
    v_mfma_f32_16x16x32_bf16 v[168:171], a[56:59], v[212:215], v[168:171]
    v_mfma_f32_16x16x32_bf16 v[172:175], a[136:139], v[212:215], v[172:175]
    v_mfma_f32_16x16x32_bf16 v[176:179], v[212:215], a[216:219], v[176:179]
    s_waitcnt lgkmcnt(1)
    v_mfma_f32_16x16x32_bf16 v[180:183], v[64:67], v[204:207], v[180:183]
    ds_read_b128 v[212:215], v246 offset:36864
    v_mfma_f32_16x16x32_bf16 v[168:171], a[60:63], v[204:207], v[168:171]
    v_mfma_f32_16x16x32_bf16 v[172:175], a[140:143], v[204:207], v[172:175]
    v_mfma_f32_16x16x32_bf16 v[176:179], v[204:207], a[220:223], v[176:179]
    s_waitcnt lgkmcnt(1)
    v_mfma_f32_16x16x32_bf16 v[180:183], v[68:71], v[208:211], v[180:183]
    ds_read_b128 v[204:207], v245 offset:37888
    v_mfma_f32_16x16x32_bf16 v[168:171], a[64:67], v[208:211], v[168:171]
    v_mfma_f32_16x16x32_bf16 v[172:175], a[144:147], v[208:211], v[172:175]
    v_mfma_f32_16x16x32_bf16 v[176:179], v[208:211], a[224:227], v[176:179]
    s_waitcnt lgkmcnt(1)
    v_mfma_f32_16x16x32_bf16 v[180:183], v[72:75], v[212:215], v[180:183]
    ds_read_b128 v[208:211], v246 offset:37888
    v_mfma_f32_16x16x32_bf16 v[168:171], a[68:71], v[212:215], v[168:171]
    v_mfma_f32_16x16x32_bf16 v[172:175], a[148:151], v[212:215], v[172:175]
    v_mfma_f32_16x16x32_bf16 v[176:179], v[212:215], a[228:231], v[176:179]
    s_waitcnt lgkmcnt(1)
    v_mfma_f32_16x16x32_bf16 v[180:183], v[76:79], v[204:207], v[180:183]
    v_mfma_f32_16x16x32_bf16 v[168:171], a[72:75], v[204:207], v[168:171]
    v_mfma_f32_16x16x32_bf16 v[172:175], a[152:155], v[204:207], v[172:175]
    v_mfma_f32_16x16x32_bf16 v[176:179], v[204:207], a[232:235], v[176:179]
    s_waitcnt lgkmcnt(0)
    v_mfma_f32_16x16x32_bf16 v[180:183], v[80:83], v[208:211], v[180:183]
    s_nop 2
    v_mfma_f32_16x16x32_bf16 v[168:171], a[76:79], v[208:211], v[168:171]
    s_nop 2
    v_mfma_f32_16x16x32_bf16 v[172:175], a[156:159], v[208:211], v[172:175]
    s_nop 2
    v_mfma_f32_16x16x32_bf16 v[176:179], v[208:211], a[236:239], v[176:179]
    s_branch Lback_89
Lpre_91:
    s_waitcnt lgkmcnt(2)
    v_mfma_f32_16x16x16_bf16 v[168:171], a[240:241], v[240:241], 0
    s_movk_i32 s75, 1000
    s_add_u32 m0, s74, 8192
    s_add_u32 s64, s70, 0
    v_mfma_f32_16x16x16_bf16 v[172:175], a[242:243], v[240:241], 0
    buffer_load_dwordx4 v244, s[4:7], s64 offen sc1 lds
    s_add_u32 m0, s74, 12288
    s_add_u32 s64, s70, 4096
    v_mfma_f32_16x16x16_bf16 v[176:179], a[244:245], v[240:241], 0
    buffer_load_dwordx4 v244, s[4:7], s64 offen sc1 lds
    s_add_u32 m0, s74, 16384
    s_add_u32 s64, s70, 16384
    v_mfma_f32_16x16x16_bf16 v[180:183], a[246:247], v[240:241], 0
    buffer_load_dwordx4 v244, s[4:7], s64 offen sc1 lds
    s_add_u32 m0, s74, 20480
    s_add_u32 s64, s70, 20480
    v_mfma_f32_16x16x16_bf16 v[204:207], a[248:249], v[240:241], 0
    buffer_load_dwordx4 v244, s[4:7], s64 offen sc1 lds
    s_add_u32 m0, s74, 24576
    s_add_u32 s64, s70, 32768
    v_mfma_f32_16x16x16_bf16 v[184:187], a[250:251], v[240:241], 0
    buffer_load_dwordx4 v244, s[4:7], s64 offen sc1 lds
    v_mfma_f32_16x16x16_bf16 v[188:191], a[252:253], v[240:241], 0
    v_mfma_f32_16x16x16_bf16 v[192:195], a[254:255], v[240:241], 0
    v_mfma_f32_16x16x16_bf16 v[196:199], v[164:165], v[240:241], 0
    v_mfma_f32_16x16x16_bf16 v[200:203], v[166:167], v[240:241], 0
    s_branch Lback_92
Lpre_94:
    s_waitcnt lgkmcnt(1)
    v_mfma_f32_16x16x32_bf16 v[180:183], v[28:31], v[204:207], v[180:183]
    s_movk_i32 s75, 1000
    s_add_u32 m0, s74, 8192
    s_add_u32 s64, s70, 0
    ds_read_b128 v[212:215], v245 offset:32768
    v_mfma_f32_16x16x32_bf16 v[168:171], a[24:27], v[204:207], v[168:171]
    buffer_load_dwordx4 v244, s[4:7], s64 offen sc1 lds
    s_add_u32 m0, s74, 12288
    s_add_u32 s64, s70, 4096
    v_rcp_f32 v201, v201
    v_mfma_f32_16x16x32_bf16 v[172:175], a[104:107], v[204:207], v[172:175]
    buffer_load_dwordx4 v244, s[4:7], s64 offen sc1 lds
    s_add_u32 m0, s74, 16384
    s_add_u32 s64, s70, 16384
    v_mul_f32 v200, v200, v201
    v_mul_f32 v196, v196, v201
    v_mfma_f32_16x16x32_bf16 v[176:179], v[204:207], a[184:187], v[176:179]
    buffer_load_dwordx4 v244, s[4:7], s64 offen sc1 lds
    s_add_u32 m0, s74, 20480
    s_add_u32 s64, s70, 20480
    s_waitcnt lgkmcnt(1)
    v_mul_f32 v197, v197, v201
    v_mul_f32 v198, v198, v201
    v_mfma_f32_16x16x32_bf16 v[180:183], v[32:35], v[208:211], v[180:183]
    buffer_load_dwordx4 v244, s[4:7], s64 offen sc1 lds
    s_add_u32 m0, s74, 24576
    s_add_u32 s64, s70, 32768
    ds_read_b128 v[204:207], v246 offset:32768
    v_mul_f32 v199, v199, v201
    v_mfma_f32_16x16x32_bf16 v[168:171], a[28:31], v[208:211], v[168:171]
    buffer_load_dwordx4 v244, s[4:7], s64 offen sc1 lds
    v_cvt_pk_bf16_f32 v200, v200, v200
    v_cvt_pk_bf16_f32 v196, v196, v197
    v_mfma_f32_16x16x32_bf16 v[172:175], a[108:111], v[208:211], v[172:175]
    v_cvt_pk_bf16_f32 v197, v198, v199
    v_mfma_f32_16x16x32_bf16 v[176:179], v[208:211], a[188:191], v[176:179]
    ds_write_b16 v250, v200 offset:2048
    s_branch Lback_95
Lpre_97:
    s_waitcnt lgkmcnt(1)
    v_mfma_f32_16x16x32_bf16 v[180:183], v[28:31], v[204:207], v[180:183]
    s_movk_i32 s75, 1000
    s_add_u32 m0, s74, 28672
    s_add_u32 s64, s70, 36864
    ds_read_b128 v[212:215], v245 offset:12288
    v_mfma_f32_16x16x32_bf16 v[168:171], a[24:27], v[204:207], v[168:171]
    buffer_load_dwordx4 v244, s[4:7], s64 offen sc1 lds
    s_add_u32 m0, s74, 32768
    s_add_u32 s64, s70, 49152
    v_rcp_f32 v201, v201
    v_mfma_f32_16x16x32_bf16 v[172:175], a[104:107], v[204:207], v[172:175]
    buffer_load_dwordx4 v244, s[4:7], s64 offen sc1 lds
    s_add_u32 m0, s74, 36864
    s_add_u32 s64, s70, 53248
    v_mul_f32 v200, v200, v201
    v_mul_f32 v196, v196, v201
    v_mfma_f32_16x16x32_bf16 v[176:179], v[204:207], a[184:187], v[176:179]
    buffer_load_dwordx4 v244, s[4:7], s64 offen sc1 lds
    s_add_u32 m0, s74, 40960
    s_add_u32 s64, s70, 65536
    s_waitcnt lgkmcnt(1)
    v_mul_f32 v197, v197, v201
    v_mul_f32 v198, v198, v201
    v_mfma_f32_16x16x32_bf16 v[180:183], v[32:35], v[208:211], v[180:183]
    buffer_load_dwordx4 v244, s[4:7], s64 offen sc1 lds
    s_add_u32 m0, s74, 45056
    s_add_u32 s64, s70, 69632
    ds_read_b128 v[204:207], v246 offset:12288
    v_mul_f32 v199, v199, v201
    v_mfma_f32_16x16x32_bf16 v[168:171], a[28:31], v[208:211], v[168:171]
    buffer_load_dwordx4 v244, s[4:7], s64 offen sc1 lds
    s_add_u32 s71, s71, 131072
    s_lshr_b32 s70, s71, 8
    v_cvt_pk_bf16_f32 v200, v200, v200
    v_cvt_pk_bf16_f32 v196, v196, v197
    v_mfma_f32_16x16x32_bf16 v[172:175], a[108:111], v[208:211], v[172:175]
    s_xor_b32 s70, s70, s1
    s_and_b32 s70, s70, 0x2000
    s_or_b32 s70, s70, s71
    v_cvt_pk_bf16_f32 v197, v198, v199
    v_mfma_f32_16x16x32_bf16 v[176:179], v[208:211], a[188:191], v[176:179]
    ds_write_b16 v250, v200 offset:2048
    s_branch Lback_98
L_roleR:
    s_cmp_lg_u32 s68, 0
    s_cbranch_scc1 Larr0_99
    s_waitcnt vmcnt(0)
    s_barrier
    s_cmp_lg_u32 s60, 0
    s_cbranch_scc1 Lcnt_100
    s_mov_b64 exec, 1
    v_mov_b32 v2, 1
    buffer_atomic_add v2, off, s[8:11], 0 offset:4 sc0
    v_mov_b32 v3, 0x80000000
    s_waitcnt vmcnt(0)
    v_cmp_ne_u32 vcc, 255, v2
    s_nop 1
    v_cndmask_b32 v3, 4, v3, vcc
    buffer_store_dword v2, v3, s[8:11], 0 offen offset:128 sc1
    s_mov_b64 exec, -1
Lcnt_100:
Larr0_99:
    s_and_b32 s64, s59, 1
    s_lshl_b32 s76, s68, 1
    s_add_u32 s76, s76, s64
    s_cmp_eq_u32 s76, 0
    s_cselect_b32 s16, s32, s56
    s_cselect_b32 s17, s33, s57
    s_cselect_b32 s18, 2621440, s6
    s_mov_b32 s19, 0x20000
    s_cmp_eq_u32 s76, 3
    s_cselect_b32 s20, s52, s56
    s_cselect_b32 s21, s53, s57
    s_cselect_b32 s22, 2621440, s6
    s_mov_b32 s23, 0x20000
    s_mov_b32 s72, 0
    s_mov_b32 s73, 50331648
    s_mov_b32 s74, 33554432
    s_cmp_eq_u32 s76, 1
    s_cselect_b32 s72, 50331648, s72
    s_cselect_b32 s73, 56623104, s73
    s_cselect_b32 s74, 25165824, s74
    s_cmp_eq_u32 s76, 2
    s_cselect_b32 s72, 56623104, s72
    s_cselect_b32 s73, 52953088, s73
    s_cselect_b32 s74, 41943040, s74
    s_cmp_eq_u32 s76, 3
    s_cselect_b32 s72, 52953088, s72
    s_cselect_b32 s73, 0, s73
    s_cselect_b32 s74, 0, s74
    s_cmp_eq_u32 s76, 1
    s_cselect_b32 s79, 0x2000, 0
    s_cmp_lg_u32 s60, 0
    s_cbranch_scc1 Lgskip_103
    buffer_load_dword v2, off, s[8:11], 0 offset:132 sc1
Lgchk_101:
    s_waitcnt vmcnt(0)
    v_cmp_eq_u32 vcc, 0, v2
    s_cbranch_vccnz Lgrty_102
Lgskip_103:
    s_waitcnt lgkmcnt(0)
    s_barrier
    buffer_load_dword v2, off, s[8:11], 0 offset:140 sc1
Lpchk_104:
    s_waitcnt vmcnt(0)
    v_cmp_eq_u32 vcc, 0, v2
    s_cbranch_vccnz Lprty_105
    v_readfirstlane_b32 s1, v2
    s_cmp_gt_u32 s1, 17
    s_cselect_b32 s1, 1, 0
    s_xor_b32 s1, s1, s68
    s_lshl_b32 s1, s1, 13
    s_lshl_b32 s63, s58, 18
    s_and_b32 s64, s3, 0xfff
    s_add_u32 s63, s63, s64
    s_add_u32 s63, s63, 14819328
    s_xor_b32 s63, s63, s1
    s_xor_b32 s63, s63, s79
    s_xor_b32 s79, s79, s1
    s_mov_b32 s71, 142606336
    s_bitcmp0_b32 s76, 0
    s_cselect_b32 s71, 75497472, s71
    s_cselect_b32 s65, 24, 28
    s_cselect_b32 s66, 15, 7
    v_and_b32 v100, s66, v0
    v_mov_b32 v65, s65
    v_lshl_add_u32 v100, v65, 2, v100
    v_lshlrev_b32 v100, 7, v100
    v_bfe_u32 v65, v0, 4, 2
    v_cmp_eq_u32 vcc, s69, v65
    s_xor_b32 s64, s1, 0x2000
    s_add_u32 s64, s64, 14798848
    v_lshl_add_u32 v65, v65, 18, s64
    s_lshl_b32 s64, s68, 20
    v_add_u32 v65, s64, v65
    s_lshl_b32 s64, s58, 14
    s_add_u32 s64, s64, 8388608
    v_mov_b32 v2, s64
    v_cndmask_b32 v65, v65, v2, vcc
    v_add_u32 v100, v100, v65
    v_and_b32 v64, 63, v0
    s_lshl_b32 s64, s69, 2
    s_add_u32 s64, s64, s60
    s_mul_i32 s65, s64, 1280
    v_lshl_add_u32 v94, v64, 4, s65
    v_lshl_add_u32 v95, v64, 2, s65
    v_bfe_u32 v65, v64, 2, 3
    v_lshlrev_b32 v90, 10, v65
    v_lshrrev_b32 v65, 5, v64
    v_lshl_add_u32 v90, v65, 15, v90
    v_and_b32 v65, 3, v64
    v_lshl_add_u32 v90, v65, 4, v90
    s_lshl_b32 s65, s64, 6
    v_add_u32 v90, s65, v90
    v_add_u32 v91, 16384, v90
    v_lshrrev_b32 v65, 3, v64
    v_lshlrev_b32 v92, 10, v65
    v_and_b32 v65, 7, v64
    v_lshl_add_u32 v92, v65, 2, v92
    s_lshl_b32 s65, s64, 5
    s_add_u32 s65, s65, 65536
    v_add_u32 v92, s65, v92
    v_add_u32 v93, 512, v92
    s_lshr_b32 s65, s64, 3
    s_mul_i32 s65, s65, 10
    s_and_b32 s64, s64, 7
    s_lshl_b32 s66, s64, 7
    v_lshrrev_b32 v65, 3, v64
    v_add3_u32 v96, v65, s65, 0
    v_lshrrev_b32 v65, 3, v96
    v_lshlrev_b32 v96, 10, v96
    v_lshl_add_u32 v96, v65, 13, v96
    v_and_b32 v65, 7, v64
    v_xor_b32 v65, s64, v65
    v_lshl_add_u32 v65, v65, 4, s66
    v_add_u32 v96, v96, v65
    v_lshrrev_b32 v65, 5, v64
    v_add3_u32 v98, v65, s65, 8
    v_lshrrev_b32 v65, 3, v98
    v_lshlrev_b32 v98, 10, v98
    v_lshl_add_u32 v98, v65, 13, v98
    v_bfe_u32 v65, v64, 2, 3
    v_xor_b32 v65, s64, v65
    v_lshl_add_u32 v65, v65, 4, s66
    v_and_b32 v66, 3, v64
    v_lshl_add_u32 v65, v66, 2, v65
    v_add_u32 v98, v98, v65
    v_lshrrev_b32 v65, 3, v64
    v_add3_u32 v97, v65, s65, 20
    v_lshrrev_b32 v65, 3, v97
    v_lshlrev_b32 v97, 10, v97
    v_lshl_add_u32 v97, v65, 13, v97
    v_and_b32 v65, 7, v64
    v_xor_b32 v65, s64, v65
    v_lshl_add_u32 v65, v65, 4, s66
    v_add_u32 v97, v97, v65
    v_lshrrev_b32 v65, 5, v64
    v_add3_u32 v99, v65, s65, 28
    v_lshrrev_b32 v65, 3, v99
    v_lshlrev_b32 v99, 10, v99
    v_lshl_add_u32 v99, v65, 13, v99
    v_bfe_u32 v65, v64, 2, 3
    v_xor_b32 v65, s64, v65
    v_lshl_add_u32 v65, v65, 4, s66
    v_and_b32 v66, 3, v64
    v_lshl_add_u32 v65, v66, 2, v65
    v_add_u32 v99, v99, v65
    v_bfe_u32 v65, v64, 2, 2
    v_lshrrev_b32 v66, 4, v64
    v_cmp_eq_u32 vcc, v65, v66
    v_and_b32 v65, 1, v64
    v_lshlrev_b32 v65, 4, v65
    v_mov_b32 v66, 0x3f80
    v_lshlrev_b32 v66, v65, v66
    v_cndmask_b32 v66, 0, v66, vcc
    v_and_b32 v65, 2, v64
    v_cmp_eq_u32 vcc, 0, v65
    s_nop 1
    v_cndmask_b32 v52, 0, v66, vcc
    v_xor_b32 v53, v52, v66
    v_mov_b32 v58, v52
    v_mov_b32 v59, v53
    v_mov_b32 v101, 0
    v_mov_b32 v54, 0
    v_mov_b32 v55, 0
    v_mov_b32 v56, 0
    v_mov_b32 v57, 0
    v_mov_b32 v49, 0
    v_mov_b32 v50, 0
    v_mov_b32 v51, 0
    v_mov_b32 v60, v52
    v_mov_b32 v61, v52
    v_mov_b32 v62, v52
    v_mov_b32 v63, v52
L_Rseg:
    s_add_u32 s65, s62, 1
    v_cmp_gt_u32 vcc, s65, v101
    s_cbranch_vccz L_Rpre0
    buffer_load_dword v101, v100, s[4:7], 0 offen sc1
    s_waitcnt vmcnt(0)
    v_mov_b32 v88, s62
    s_mov_b64 exec, 1
    buffer_store_dword v88, off, s[4:7], s63 sc1
    buffer_store_dword v88, off, s[4:7], s3
    s_mov_b64 exec, -1
Lfchk_106:
    v_cmp_gt_u32 vcc, s65, v101
    s_cbranch_vccnz Lfrty_107
    s_lshr_b32 s70, s71, 8
    s_xor_b32 s70, s70, s1
    s_and_b32 s70, s70, 0x2000
    s_or_b32 s70, s70, s71
    buffer_load_dwordx4 v[4:7], v90, s[4:7], s70 offen sc1
    buffer_load_dword v40, v92, s[4:7], s70 offen sc1
    s_add_u32 s70, s70, 81920
    buffer_load_dwordx4 v[8:11], v90, s[4:7], s70 offen sc1
    buffer_load_dword v41, v92, s[4:7], s70 offen sc1
    s_add_u32 s70, s70, 81920
    buffer_load_dwordx4 v[12:15], v90, s[4:7], s70 offen sc1
    buffer_load_dword v42, v92, s[4:7], s70 offen sc1
    s_add_u32 s70, s70, 81920
    buffer_load_dwordx4 v[16:19], v90, s[4:7], s70 offen sc1
    buffer_load_dword v43, v92, s[4:7], s70 offen sc1
    s_add_u32 s70, s70, 81920
    buffer_load_dwordx4 v[20:23], v90, s[4:7], s70 offen sc1
    buffer_load_dword v44, v92, s[4:7], s70 offen sc1
    s_add_u32 s70, s70, 81920
    buffer_load_dwordx4 v[24:27], v90, s[4:7], s70 offen sc1
    buffer_load_dword v45, v92, s[4:7], s70 offen sc1
    s_add_u32 s70, s70, 81920
    buffer_load_dwordx4 v[28:31], v90, s[4:7], s70 offen sc1
    buffer_load_dword v46, v92, s[4:7], s70 offen sc1
    s_add_u32 s70, s70, 81920
    buffer_load_dwordx4 v[32:35], v90, s[4:7], s70 offen sc1
    buffer_load_dword v47, v92, s[4:7], s70 offen sc1
    s_add_u32 s70, s70, 81920
    buffer_load_dwordx4 v[36:39], v94, s[16:19], s72 offen sc1
    buffer_load_dword v48, v95, s[16:19], s72 offen offset:1024 sc1
    s_add_u32 s72, s72, 20480
    s_waitcnt vmcnt(17)
    v_mfma_f32_16x16x32_bf16 v[64:67], v[52:55], v[4:7], 0
    v_mfma_f32_16x16x32_bf16 v[68:71], v[56:59], v[4:7], 0
    s_waitcnt vmcnt(15)
    v_mfma_f32_16x16x32_bf16 v[64:67], v[52:55], v[8:11], v[64:67]
    v_mfma_f32_16x16x32_bf16 v[68:71], v[56:59], v[8:11], v[68:71]
    s_waitcnt vmcnt(13)
    v_mfma_f32_16x16x32_bf16 v[64:67], v[52:55], v[12:15], v[64:67]
    v_mfma_f32_16x16x32_bf16 v[68:71], v[56:59], v[12:15], v[68:71]
    s_waitcnt vmcnt(11)
    v_mfma_f32_16x16x32_bf16 v[64:67], v[52:55], v[16:19], v[64:67]
    v_mfma_f32_16x16x32_bf16 v[68:71], v[56:59], v[16:19], v[68:71]
    s_waitcnt vmcnt(10)
    v_mfma_f32_16x16x32_bf16 v[72:75], v[60:63], v[40:43], 0
    s_waitcnt vmcnt(9)
    v_mfma_f32_16x16x32_bf16 v[64:67], v[52:55], v[20:23], v[64:67]
    v_mfma_f32_16x16x32_bf16 v[68:71], v[56:59], v[20:23], v[68:71]
    s_waitcnt vmcnt(7)
    v_mfma_f32_16x16x32_bf16 v[64:67], v[52:55], v[24:27], v[64:67]
    v_mfma_f32_16x16x32_bf16 v[68:71], v[56:59], v[24:27], v[68:71]
    s_waitcnt vmcnt(5)
    v_mfma_f32_16x16x32_bf16 v[64:67], v[52:55], v[28:31], v[64:67]
    v_mfma_f32_16x16x32_bf16 v[68:71], v[56:59], v[28:31], v[68:71]
    s_waitcnt vmcnt(3)
    v_mfma_f32_16x16x32_bf16 v[64:67], v[52:55], v[32:35], v[64:67]
    v_mfma_f32_16x16x32_bf16 v[68:71], v[56:59], v[32:35], v[68:71]
    s_waitcnt vmcnt(2)
    v_mfma_f32_16x16x32_bf16 v[72:75], v[60:63], v[44:47], v[72:75]
    s_waitcnt vmcnt(1)
    v_mfma_f32_16x16x32_bf16 v[64:67], v[52:55], v[36:39], v[64:67]
    v_mfma_f32_16x16x32_bf16 v[68:71], v[56:59], v[36:39], v[68:71]
    s_waitcnt vmcnt(0)
    v_mfma_f32_16x16x32_bf16 v[72:75], v[60:63], v[48:51], v[72:75]
L_Rsum0:
    buffer_load_dword v101, v100, s[4:7], 0 offen sc1
    s_lshr_b32 s75, s74, 8
    s_xor_b32 s75, s75, s79
    s_and_b32 s75, s75, 0x2000
    s_or_b32 s75, s75, s74
    v_cvt_pk_bf16_f32 v76, v64, v65
    v_cvt_pk_bf16_f32 v77, v66, v67
    v_cvt_pk_bf16_f32 v78, v68, v69
    v_cvt_pk_bf16_f32 v79, v70, v71
    v_cvt_pk_bf16_f32 v80, v72, v73
    buffer_store_dwordx4 v[76:79], v94, s[20:23], s73 offen sc1
    buffer_store_dword v80, v95, s[20:23], s73 offen offset:1024 sc1
    s_add_u32 s73, s73, 20480
    s_cmp_eq_u32 s76, 3
    s_cbranch_scc1 L_Rlast0
    v_lshlrev_b32 v64, 16, v76
    v_and_b32 v65, 0xffff0000, v76
    v_lshlrev_b32 v66, 16, v77
    v_and_b32 v67, 0xffff0000, v77
    v_lshlrev_b32 v68, 16, v78
    v_and_b32 v69, 0xffff0000, v78
    v_lshlrev_b32 v70, 16, v79
    v_and_b32 v71, 0xffff0000, v79
    v_lshlrev_b32 v72, 16, v80
    v_and_b32 v73, 0xffff0000, v80
    v_pk_add_f32 v[88:89], v[64:65], v[66:67]
    v_pk_add_f32 v[88:89], v[88:89], v[68:69]
    v_pk_add_f32 v[88:89], v[88:89], v[70:71]
    v_pk_add_f32 v[88:89], v[88:89], v[72:73]
    v_add_f32 v88, v88, v89
    s_nop 1
    v_add_f32_dpp v88, v88, v88 quad_perm:[1,0,3,2] row_mask:0xf bank_mask:0xf
    s_nop 1
    v_add_f32_dpp v88, v88, v88 quad_perm:[2,3,0,1] row_mask:0xf bank_mask:0xf
    s_nop 1
    v_add_f32_dpp v88, v88, v88 row_half_mirror row_mask:0xf bank_mask:0xf
    s_nop 1
    v_add_f32_dpp v88, v88, v88 row_mirror row_mask:0xf bank_mask:0xf
    v_mov_b32 v89, v88
    s_nop 1
    v_permlane16_swap_b32 v88, v89
    v_add_f32 v88, v88, v89
    v_mov_b32 v89, v88
    s_nop 1
    v_permlane32_swap_b32 v88, v89
    v_add_f32 v88, v88, v89
    v_mul_f32 v88, 0xbacccccd, v88
    v_pk_add_f32 v[64:65], v[64:65], v[88:89] op_sel_hi:[1,0]
    v_pk_add_f32 v[66:67], v[66:67], v[88:89] op_sel_hi:[1,0]
    v_pk_add_f32 v[68:69], v[68:69], v[88:89] op_sel_hi:[1,0]
    v_pk_add_f32 v[70:71], v[70:71], v[88:89] op_sel_hi:[1,0]
    v_pk_add_f32 v[72:73], v[72:73], v[88:89] op_sel_hi:[1,0]
    v_pk_mul_f32 v[88:89], v[64:65], v[64:65]
    v_pk_fma_f32 v[88:89], v[66:67], v[66:67], v[88:89]
    v_pk_fma_f32 v[88:89], v[68:69], v[68:69], v[88:89]
    v_pk_fma_f32 v[88:89], v[70:71], v[70:71], v[88:89]
    v_pk_fma_f32 v[88:89], v[72:73], v[72:73], v[88:89]
    v_add_f32 v88, v88, v89
    s_nop 1
    v_add_f32_dpp v88, v88, v88 quad_perm:[1,0,3,2] row_mask:0xf bank_mask:0xf
    s_nop 1
    v_add_f32_dpp v88, v88, v88 quad_perm:[2,3,0,1] row_mask:0xf bank_mask:0xf
    s_nop 1
    v_add_f32_dpp v88, v88, v88 row_half_mirror row_mask:0xf bank_mask:0xf
    s_nop 1
    v_add_f32_dpp v88, v88, v88 row_mirror row_mask:0xf bank_mask:0xf
    v_mov_b32 v89, v88
    s_nop 1
    v_permlane16_swap_b32 v88, v89
    v_add_f32 v88, v88, v89
    v_mov_b32 v89, v88
    s_nop 1
    v_permlane32_swap_b32 v88, v89
    v_add_f32 v88, v88, v89
    v_mov_b32 v89, 0x3727c5ac
    v_fmac_f32 v89, 0x3acccccd, v88
    v_rsq_f32 v88, v89
    s_nop 0
    v_pk_mul_f32 v[64:65], v[64:65], v[88:89] op_sel_hi:[1,0]
    v_pk_mul_f32 v[66:67], v[66:67], v[88:89] op_sel_hi:[1,0]
    v_pk_mul_f32 v[68:69], v[68:69], v[88:89] op_sel_hi:[1,0]
    v_pk_mul_f32 v[70:71], v[70:71], v[88:89] op_sel_hi:[1,0]
    v_pk_mul_f32 v[72:73], v[72:73], v[88:89] op_sel_hi:[1,0]
    v_cvt_pk_bf16_f32 v82, v64, v65
    v_cvt_pk_bf16_f32 v83, v66, v67
    v_cvt_pk_bf16_f32 v84, v68, v69
    v_cvt_pk_bf16_f32 v85, v70, v71
    v_cvt_pk_bf16_f32 v86, v72, v73
    s_waitcnt vmcnt(2)
    buffer_store_dwordx4 v[82:85], v96, s[4:7], s75 offen sc1
    buffer_store_dword v86, v98, s[4:7], s75 offen sc1
L_Rnext0:
    s_add_u32 s62, s62, 1
    s_add_u32 s65, s62, 1
    v_cmp_gt_u32 vcc, s65, v101
    s_cbranch_vccz L_Rpre1
    buffer_load_dword v101, v100, s[4:7], 0 offen sc1
    s_waitcnt vmcnt(0)
    v_mov_b32 v88, s62
    s_mov_b64 exec, 1
    buffer_store_dword v88, off, s[4:7], s63 sc1
    buffer_store_dword v88, off, s[4:7], s3
    s_mov_b64 exec, -1
Lfchk_108:
    v_cmp_gt_u32 vcc, s65, v101
    s_cbranch_vccnz Lfrty_109
    s_lshr_b32 s70, s71, 8
    s_xor_b32 s70, s70, s1
    s_and_b32 s70, s70, 0x2000
    s_or_b32 s70, s70, s71
    buffer_load_dwordx4 v[4:7], v91, s[4:7], s70 offen sc1
    buffer_load_dword v40, v93, s[4:7], s70 offen sc1
    s_add_u32 s70, s70, 81920
    buffer_load_dwordx4 v[8:11], v91, s[4:7], s70 offen sc1
    buffer_load_dword v41, v93, s[4:7], s70 offen sc1
    s_add_u32 s70, s70, 81920
    buffer_load_dwordx4 v[12:15], v91, s[4:7], s70 offen sc1
    buffer_load_dword v42, v93, s[4:7], s70 offen sc1
    s_add_u32 s70, s70, 81920
    buffer_load_dwordx4 v[16:19], v91, s[4:7], s70 offen sc1
    buffer_load_dword v43, v93, s[4:7], s70 offen sc1
    s_add_u32 s70, s70, 81920
    buffer_load_dwordx4 v[20:23], v91, s[4:7], s70 offen sc1
    buffer_load_dword v44, v93, s[4:7], s70 offen sc1
    s_add_u32 s70, s70, 81920
    buffer_load_dwordx4 v[24:27], v91, s[4:7], s70 offen sc1
    buffer_load_dword v45, v93, s[4:7], s70 offen sc1
    s_add_u32 s70, s70, 81920
    buffer_load_dwordx4 v[28:31], v91, s[4:7], s70 offen sc1
    buffer_load_dword v46, v93, s[4:7], s70 offen sc1
    s_add_u32 s70, s70, 81920
    buffer_load_dwordx4 v[32:35], v91, s[4:7], s70 offen sc1
    buffer_load_dword v47, v93, s[4:7], s70 offen sc1
    s_add_u32 s70, s70, 81920
    buffer_load_dwordx4 v[36:39], v94, s[16:19], s72 offen sc1
    buffer_load_dword v48, v95, s[16:19], s72 offen offset:1024 sc1
    s_add_u32 s72, s72, 20480
    s_add_u32 s71, s71, 1048576
    s_waitcnt vmcnt(17)
    v_mfma_f32_16x16x32_bf16 v[64:67], v[52:55], v[4:7], 0
    v_mfma_f32_16x16x32_bf16 v[68:71], v[56:59], v[4:7], 0
    s_waitcnt vmcnt(15)
    v_mfma_f32_16x16x32_bf16 v[64:67], v[52:55], v[8:11], v[64:67]
    v_mfma_f32_16x16x32_bf16 v[68:71], v[56:59], v[8:11], v[68:71]
    s_waitcnt vmcnt(13)
    v_mfma_f32_16x16x32_bf16 v[64:67], v[52:55], v[12:15], v[64:67]
    v_mfma_f32_16x16x32_bf16 v[68:71], v[56:59], v[12:15], v[68:71]
    s_waitcnt vmcnt(11)
    v_mfma_f32_16x16x32_bf16 v[64:67], v[52:55], v[16:19], v[64:67]
    v_mfma_f32_16x16x32_bf16 v[68:71], v[56:59], v[16:19], v[68:71]
    s_waitcnt vmcnt(10)
    v_mfma_f32_16x16x32_bf16 v[72:75], v[60:63], v[40:43], 0
    s_waitcnt vmcnt(9)
    v_mfma_f32_16x16x32_bf16 v[64:67], v[52:55], v[20:23], v[64:67]
    v_mfma_f32_16x16x32_bf16 v[68:71], v[56:59], v[20:23], v[68:71]
    s_waitcnt vmcnt(7)
    v_mfma_f32_16x16x32_bf16 v[64:67], v[52:55], v[24:27], v[64:67]
    v_mfma_f32_16x16x32_bf16 v[68:71], v[56:59], v[24:27], v[68:71]
    s_waitcnt vmcnt(5)
    v_mfma_f32_16x16x32_bf16 v[64:67], v[52:55], v[28:31], v[64:67]
    v_mfma_f32_16x16x32_bf16 v[68:71], v[56:59], v[28:31], v[68:71]
    s_waitcnt vmcnt(3)
    v_mfma_f32_16x16x32_bf16 v[64:67], v[52:55], v[32:35], v[64:67]
    v_mfma_f32_16x16x32_bf16 v[68:71], v[56:59], v[32:35], v[68:71]
    s_waitcnt vmcnt(2)
    v_mfma_f32_16x16x32_bf16 v[72:75], v[60:63], v[44:47], v[72:75]
    s_waitcnt vmcnt(1)
    v_mfma_f32_16x16x32_bf16 v[64:67], v[52:55], v[36:39], v[64:67]
    v_mfma_f32_16x16x32_bf16 v[68:71], v[56:59], v[36:39], v[68:71]
    s_waitcnt vmcnt(0)
    v_mfma_f32_16x16x32_bf16 v[72:75], v[60:63], v[48:51], v[72:75]
L_Rsum1:
    buffer_load_dword v101, v100, s[4:7], 0 offen sc1
    s_lshr_b32 s75, s74, 8
    s_xor_b32 s75, s75, s79
    s_and_b32 s75, s75, 0x2000
    s_or_b32 s75, s75, s74
    v_cvt_pk_bf16_f32 v76, v64, v65
    v_cvt_pk_bf16_f32 v77, v66, v67
    v_cvt_pk_bf16_f32 v78, v68, v69
    v_cvt_pk_bf16_f32 v79, v70, v71
    v_cvt_pk_bf16_f32 v80, v72, v73
    buffer_store_dwordx4 v[76:79], v94, s[20:23], s73 offen sc1
    buffer_store_dword v80, v95, s[20:23], s73 offen offset:1024 sc1
    s_add_u32 s73, s73, 20480
    s_cmp_eq_u32 s76, 3
    s_cbranch_scc1 L_Rlast1
    v_lshlrev_b32 v64, 16, v76
    v_and_b32 v65, 0xffff0000, v76
    v_lshlrev_b32 v66, 16, v77
    v_and_b32 v67, 0xffff0000, v77
    v_lshlrev_b32 v68, 16, v78
    v_and_b32 v69, 0xffff0000, v78
    v_lshlrev_b32 v70, 16, v79
    v_and_b32 v71, 0xffff0000, v79
    v_lshlrev_b32 v72, 16, v80
    v_and_b32 v73, 0xffff0000, v80
    v_pk_add_f32 v[88:89], v[64:65], v[66:67]
    v_pk_add_f32 v[88:89], v[88:89], v[68:69]
    v_pk_add_f32 v[88:89], v[88:89], v[70:71]
    v_pk_add_f32 v[88:89], v[88:89], v[72:73]
    v_add_f32 v88, v88, v89
    s_nop 1
    v_add_f32_dpp v88, v88, v88 quad_perm:[1,0,3,2] row_mask:0xf bank_mask:0xf
    s_nop 1
    v_add_f32_dpp v88, v88, v88 quad_perm:[2,3,0,1] row_mask:0xf bank_mask:0xf
    s_nop 1
    v_add_f32_dpp v88, v88, v88 row_half_mirror row_mask:0xf bank_mask:0xf
    s_nop 1
    v_add_f32_dpp v88, v88, v88 row_mirror row_mask:0xf bank_mask:0xf
    v_mov_b32 v89, v88
    s_nop 1
    v_permlane16_swap_b32 v88, v89
    v_add_f32 v88, v88, v89
    v_mov_b32 v89, v88
    s_nop 1
    v_permlane32_swap_b32 v88, v89
    v_add_f32 v88, v88, v89
    v_mul_f32 v88, 0xbacccccd, v88
    v_pk_add_f32 v[64:65], v[64:65], v[88:89] op_sel_hi:[1,0]
    v_pk_add_f32 v[66:67], v[66:67], v[88:89] op_sel_hi:[1,0]
    v_pk_add_f32 v[68:69], v[68:69], v[88:89] op_sel_hi:[1,0]
    v_pk_add_f32 v[70:71], v[70:71], v[88:89] op_sel_hi:[1,0]
    v_pk_add_f32 v[72:73], v[72:73], v[88:89] op_sel_hi:[1,0]
    v_pk_mul_f32 v[88:89], v[64:65], v[64:65]
    v_pk_fma_f32 v[88:89], v[66:67], v[66:67], v[88:89]
    v_pk_fma_f32 v[88:89], v[68:69], v[68:69], v[88:89]
    v_pk_fma_f32 v[88:89], v[70:71], v[70:71], v[88:89]
    v_pk_fma_f32 v[88:89], v[72:73], v[72:73], v[88:89]
    v_add_f32 v88, v88, v89
    s_nop 1
    v_add_f32_dpp v88, v88, v88 quad_perm:[1,0,3,2] row_mask:0xf bank_mask:0xf
    s_nop 1
    v_add_f32_dpp v88, v88, v88 quad_perm:[2,3,0,1] row_mask:0xf bank_mask:0xf
    s_nop 1
    v_add_f32_dpp v88, v88, v88 row_half_mirror row_mask:0xf bank_mask:0xf
    s_nop 1
    v_add_f32_dpp v88, v88, v88 row_mirror row_mask:0xf bank_mask:0xf
    v_mov_b32 v89, v88
    s_nop 1
    v_permlane16_swap_b32 v88, v89
    v_add_f32 v88, v88, v89
    v_mov_b32 v89, v88
    s_nop 1
    v_permlane32_swap_b32 v88, v89
    v_add_f32 v88, v88, v89
    v_mov_b32 v89, 0x3727c5ac
    v_fmac_f32 v89, 0x3acccccd, v88
    v_rsq_f32 v88, v89
    s_nop 0
    v_pk_mul_f32 v[64:65], v[64:65], v[88:89] op_sel_hi:[1,0]
    v_pk_mul_f32 v[66:67], v[66:67], v[88:89] op_sel_hi:[1,0]
    v_pk_mul_f32 v[68:69], v[68:69], v[88:89] op_sel_hi:[1,0]
    v_pk_mul_f32 v[70:71], v[70:71], v[88:89] op_sel_hi:[1,0]
    v_pk_mul_f32 v[72:73], v[72:73], v[88:89] op_sel_hi:[1,0]
    v_cvt_pk_bf16_f32 v82, v64, v65
    v_cvt_pk_bf16_f32 v83, v66, v67
    v_cvt_pk_bf16_f32 v84, v68, v69
    v_cvt_pk_bf16_f32 v85, v70, v71
    v_cvt_pk_bf16_f32 v86, v72, v73
    s_waitcnt vmcnt(2)
    buffer_store_dwordx4 v[82:85], v97, s[4:7], s75 offen sc1
    buffer_store_dword v86, v99, s[4:7], s75 offen sc1
L_Rnext1:
    s_add_u32 s62, s62, 1
    s_add_u32 s74, s74, 131072
    s_cmp_lt_u32 s62, 128
    s_cbranch_scc1 L_Rseg
    s_waitcnt vmcnt(0)
    v_mov_b32 v88, s62
    s_mov_b64 exec, 1
    buffer_store_dword v88, off, s[4:7], s63 sc1
    buffer_store_dword v88, off, s[4:7], s3
    s_mov_b64 exec, -1
    s_endpgm
Lgrty_102:
    s_sleep 16
    buffer_load_dword v2, off, s[8:11], 0 offset:132 sc1
    s_sub_u32 s61, s61, 1
    s_mov_b32 s67, 1
    s_cbranch_scc1 L_fail
    s_branch Lgchk_101
Lprty_105:
    s_sleep 16
    buffer_load_dword v2, off, s[8:11], 0 offset:140 sc1
    s_sub_u32 s61, s61, 1
    s_mov_b32 s67, 16
    s_cbranch_scc1 L_fail
    s_branch Lpchk_104
Lfrty_107:
    s_sleep 4
    buffer_load_dword v101, v100, s[4:7], 0 offen sc1
    s_sub_u32 s61, s61, 1
    s_mov_b32 s67, 40
    s_cbranch_scc1 L_fail
    s_waitcnt vmcnt(0)
    s_branch Lfchk_106
L_Rpre0:
    s_lshr_b32 s70, s71, 8
    s_xor_b32 s70, s70, s1
    s_and_b32 s70, s70, 0x2000
    s_or_b32 s70, s70, s71
    buffer_load_dwordx4 v[4:7], v90, s[4:7], s70 offen sc1
    buffer_load_dword v40, v92, s[4:7], s70 offen sc1
    s_add_u32 s70, s70, 81920
    buffer_load_dwordx4 v[8:11], v90, s[4:7], s70 offen sc1
    buffer_load_dword v41, v92, s[4:7], s70 offen sc1
    s_add_u32 s70, s70, 81920
    buffer_load_dwordx4 v[12:15], v90, s[4:7], s70 offen sc1
    buffer_load_dword v42, v92, s[4:7], s70 offen sc1
    s_add_u32 s70, s70, 81920
    buffer_load_dwordx4 v[16:19], v90, s[4:7], s70 offen sc1
    buffer_load_dword v43, v92, s[4:7], s70 offen sc1
    s_add_u32 s70, s70, 81920
    buffer_load_dwordx4 v[20:23], v90, s[4:7], s70 offen sc1
    buffer_load_dword v44, v92, s[4:7], s70 offen sc1
    s_add_u32 s70, s70, 81920
    buffer_load_dwordx4 v[24:27], v90, s[4:7], s70 offen sc1
    buffer_load_dword v45, v92, s[4:7], s70 offen sc1
    s_add_u32 s70, s70, 81920
    buffer_load_dwordx4 v[28:31], v90, s[4:7], s70 offen sc1
    buffer_load_dword v46, v92, s[4:7], s70 offen sc1
    s_add_u32 s70, s70, 81920
    buffer_load_dwordx4 v[32:35], v90, s[4:7], s70 offen sc1
    buffer_load_dword v47, v92, s[4:7], s70 offen sc1
    s_add_u32 s70, s70, 81920
    buffer_load_dwordx4 v[36:39], v94, s[16:19], s72 offen sc1
    buffer_load_dword v48, v95, s[16:19], s72 offen offset:1024 sc1
    s_add_u32 s72, s72, 20480
    s_waitcnt vmcnt(18)
    v_mov_b32 v88, s62
    s_mov_b64 exec, 1
    buffer_store_dword v88, off, s[4:7], s63 sc1
    buffer_store_dword v88, off, s[4:7], s3
    s_mov_b64 exec, -1
    s_waitcnt vmcnt(19)
    v_mfma_f32_16x16x32_bf16 v[64:67], v[52:55], v[4:7], 0
    v_mfma_f32_16x16x32_bf16 v[68:71], v[56:59], v[4:7], 0
    s_waitcnt vmcnt(17)
    v_mfma_f32_16x16x32_bf16 v[64:67], v[52:55], v[8:11], v[64:67]
    v_mfma_f32_16x16x32_bf16 v[68:71], v[56:59], v[8:11], v[68:71]
    s_waitcnt vmcnt(15)
    v_mfma_f32_16x16x32_bf16 v[64:67], v[52:55], v[12:15], v[64:67]
    v_mfma_f32_16x16x32_bf16 v[68:71], v[56:59], v[12:15], v[68:71]
    s_waitcnt vmcnt(13)
    v_mfma_f32_16x16x32_bf16 v[64:67], v[52:55], v[16:19], v[64:67]
    v_mfma_f32_16x16x32_bf16 v[68:71], v[56:59], v[16:19], v[68:71]
    s_waitcnt vmcnt(12)
    v_mfma_f32_16x16x32_bf16 v[72:75], v[60:63], v[40:43], 0
    s_waitcnt vmcnt(11)
    v_mfma_f32_16x16x32_bf16 v[64:67], v[52:55], v[20:23], v[64:67]
    v_mfma_f32_16x16x32_bf16 v[68:71], v[56:59], v[20:23], v[68:71]
    s_waitcnt vmcnt(9)
    v_mfma_f32_16x16x32_bf16 v[64:67], v[52:55], v[24:27], v[64:67]
    v_mfma_f32_16x16x32_bf16 v[68:71], v[56:59], v[24:27], v[68:71]
    s_waitcnt vmcnt(7)
    v_mfma_f32_16x16x32_bf16 v[64:67], v[52:55], v[28:31], v[64:67]
    v_mfma_f32_16x16x32_bf16 v[68:71], v[56:59], v[28:31], v[68:71]
    s_waitcnt vmcnt(5)
    v_mfma_f32_16x16x32_bf16 v[64:67], v[52:55], v[32:35], v[64:67]
    v_mfma_f32_16x16x32_bf16 v[68:71], v[56:59], v[32:35], v[68:71]
    s_waitcnt vmcnt(4)
    v_mfma_f32_16x16x32_bf16 v[72:75], v[60:63], v[44:47], v[72:75]
    s_waitcnt vmcnt(3)
    v_mfma_f32_16x16x32_bf16 v[64:67], v[52:55], v[36:39], v[64:67]
    v_mfma_f32_16x16x32_bf16 v[68:71], v[56:59], v[36:39], v[68:71]
    s_waitcnt vmcnt(2)
    v_mfma_f32_16x16x32_bf16 v[72:75], v[60:63], v[48:51], v[72:75]
    s_branch L_Rsum0
L_Rlast0:
    s_waitcnt vmcnt(2)
    s_branch L_Rnext0
Lfrty_109:
    s_sleep 4
    buffer_load_dword v101, v100, s[4:7], 0 offen sc1
    s_sub_u32 s61, s61, 1
    s_mov_b32 s67, 40
    s_cbranch_scc1 L_fail
    s_waitcnt vmcnt(0)
    s_branch Lfchk_108
L_Rpre1:
    s_lshr_b32 s70, s71, 8
    s_xor_b32 s70, s70, s1
    s_and_b32 s70, s70, 0x2000
    s_or_b32 s70, s70, s71
    buffer_load_dwordx4 v[4:7], v91, s[4:7], s70 offen sc1
    buffer_load_dword v40, v93, s[4:7], s70 offen sc1
    s_add_u32 s70, s70, 81920
    buffer_load_dwordx4 v[8:11], v91, s[4:7], s70 offen sc1
    buffer_load_dword v41, v93, s[4:7], s70 offen sc1
    s_add_u32 s70, s70, 81920
    buffer_load_dwordx4 v[12:15], v91, s[4:7], s70 offen sc1
    buffer_load_dword v42, v93, s[4:7], s70 offen sc1
    s_add_u32 s70, s70, 81920
    buffer_load_dwordx4 v[16:19], v91, s[4:7], s70 offen sc1
    buffer_load_dword v43, v93, s[4:7], s70 offen sc1
    s_add_u32 s70, s70, 81920
    buffer_load_dwordx4 v[20:23], v91, s[4:7], s70 offen sc1
    buffer_load_dword v44, v93, s[4:7], s70 offen sc1
    s_add_u32 s70, s70, 81920
    buffer_load_dwordx4 v[24:27], v91, s[4:7], s70 offen sc1
    buffer_load_dword v45, v93, s[4:7], s70 offen sc1
    s_add_u32 s70, s70, 81920
    buffer_load_dwordx4 v[28:31], v91, s[4:7], s70 offen sc1
    buffer_load_dword v46, v93, s[4:7], s70 offen sc1
    s_add_u32 s70, s70, 81920
    buffer_load_dwordx4 v[32:35], v91, s[4:7], s70 offen sc1
    buffer_load_dword v47, v93, s[4:7], s70 offen sc1
    s_add_u32 s70, s70, 81920
    buffer_load_dwordx4 v[36:39], v94, s[16:19], s72 offen sc1
    buffer_load_dword v48, v95, s[16:19], s72 offen offset:1024 sc1
    s_add_u32 s72, s72, 20480
    s_add_u32 s71, s71, 1048576
    s_waitcnt vmcnt(18)
    v_mov_b32 v88, s62
    s_mov_b64 exec, 1
    buffer_store_dword v88, off, s[4:7], s63 sc1
    buffer_store_dword v88, off, s[4:7], s3
    s_mov_b64 exec, -1
    s_waitcnt vmcnt(19)
    v_mfma_f32_16x16x32_bf16 v[64:67], v[52:55], v[4:7], 0
    v_mfma_f32_16x16x32_bf16 v[68:71], v[56:59], v[4:7], 0
    s_waitcnt vmcnt(17)
    v_mfma_f32_16x16x32_bf16 v[64:67], v[52:55], v[8:11], v[64:67]
    v_mfma_f32_16x16x32_bf16 v[68:71], v[56:59], v[8:11], v[68:71]
    s_waitcnt vmcnt(15)
    v_mfma_f32_16x16x32_bf16 v[64:67], v[52:55], v[12:15], v[64:67]
    v_mfma_f32_16x16x32_bf16 v[68:71], v[56:59], v[12:15], v[68:71]
    s_waitcnt vmcnt(13)
    v_mfma_f32_16x16x32_bf16 v[64:67], v[52:55], v[16:19], v[64:67]
    v_mfma_f32_16x16x32_bf16 v[68:71], v[56:59], v[16:19], v[68:71]
    s_waitcnt vmcnt(12)
    v_mfma_f32_16x16x32_bf16 v[72:75], v[60:63], v[40:43], 0
    s_waitcnt vmcnt(11)
    v_mfma_f32_16x16x32_bf16 v[64:67], v[52:55], v[20:23], v[64:67]
    v_mfma_f32_16x16x32_bf16 v[68:71], v[56:59], v[20:23], v[68:71]
    s_waitcnt vmcnt(9)
    v_mfma_f32_16x16x32_bf16 v[64:67], v[52:55], v[24:27], v[64:67]
    v_mfma_f32_16x16x32_bf16 v[68:71], v[56:59], v[24:27], v[68:71]
    s_waitcnt vmcnt(7)
    v_mfma_f32_16x16x32_bf16 v[64:67], v[52:55], v[28:31], v[64:67]
    v_mfma_f32_16x16x32_bf16 v[68:71], v[56:59], v[28:31], v[68:71]
    s_waitcnt vmcnt(5)
    v_mfma_f32_16x16x32_bf16 v[64:67], v[52:55], v[32:35], v[64:67]
    v_mfma_f32_16x16x32_bf16 v[68:71], v[56:59], v[32:35], v[68:71]
    s_waitcnt vmcnt(4)
    v_mfma_f32_16x16x32_bf16 v[72:75], v[60:63], v[44:47], v[72:75]
    s_waitcnt vmcnt(3)
    v_mfma_f32_16x16x32_bf16 v[64:67], v[52:55], v[36:39], v[64:67]
    v_mfma_f32_16x16x32_bf16 v[68:71], v[56:59], v[36:39], v[68:71]
    s_waitcnt vmcnt(2)
    v_mfma_f32_16x16x32_bf16 v[72:75], v[60:63], v[48:51], v[72:75]
    s_branch L_Rsum1
L_Rlast1:
    s_waitcnt vmcnt(2)
    s_branch L_Rnext1
.section .rodata,"a"
.p2align 6
.amdhsa_kernel interleave_layers__memory_aug_recurrent_mem_tr__sliding_local_dilated__prompt_kernel
  .amdhsa_next_free_vgpr 512
  .amdhsa_next_free_sgpr 102
  .amdhsa_accum_offset 256
  .amdhsa_group_segment_fixed_size 0
  .amdhsa_kernarg_size 104
  .amdhsa_user_sgpr_count 2
  .amdhsa_user_sgpr_kernarg_segment_ptr 1
  .amdhsa_system_sgpr_workgroup_id_x 1
  .amdhsa_float_denorm_mode_32 3
.end_amdhsa_kernel
```

```asm
; @launch grid=(256,1,1) block=(256,1,1) lds=163840
.amdgcn_target "amdgcn-amd-amdhsa--gfx950"
.text
.globl interleave_layers__memory_aug_recurrent_mem_tr__sliding_local_dilated__prompt_kernel
.p2align 8
.type interleave_layers__memory_aug_recurrent_mem_tr__sliding_local_dilated__prompt_kernel,@function
interleave_layers__memory_aug_recurrent_mem_tr__sliding_local_dilated__prompt_kernel:
    s_cmp_ge_u32 s2, 256
    s_cbranch_scc1 L_end
    s_load_dwordx16 s[32:47], s[0:1], 0
    s_load_dwordx8 s[48:55], s[0:1], 64
    s_load_dwordx2 s[56:57], s[0:1], 96
    s_getreg_b32 s58, hwreg(HW_REG_XCC_ID)
    s_and_b32 s58, s58, 7
    v_lshrrev_b32 v1, 6, v0
    s_nop 0
    v_readfirstlane_b32 s60, v1
    s_mov_b32 s61, 0x100000
    s_waitcnt lgkmcnt(0)
    s_mov_b32 s4, s56
    s_mov_b32 s5, s57
    s_mov_b32 s6, 268435456
    s_mov_b32 s7, 0x20000
    s_mov_b32 s8, s54
    s_mov_b32 s9, s55
    s_mov_b32 s10, 256
    s_mov_b32 s11, 0x20000
    s_mov_b32 s12, s32
    s_mov_b32 s13, s33
    s_mov_b32 s14, 2621440
    s_mov_b32 s15, 0x20000
    s_cmp_lg_u32 s60, 0
    s_cbranch_scc1 L_notick
    s_mov_b64 exec, 1
    v_mov_b32 v2, 1
    s_lshl_b32 s64, s58, 5
    buffer_atomic_add v2, off, s[8:11], s64 sc0
    s_mov_b64 exec, -1
L_notick:
    v_lshrrev_b32 v4, 5, v0
    s_lshl_b32 s64, s2, 3
    v_add_u32 v4, s64, v4
    v_mul_u32_u24 v4, 1280, v4
    v_and_b32 v5, 31, v0
    v_lshl_add_u32 v6, v5, 3, v4
    v_lshl_add_u32 v5, v5, 4, v4
    buffer_load_dwordx4 v[8:11], v5, s[12:15], 0 offen
    buffer_load_dwordx4 v[12:15], v5, s[12:15], 0 offen offset:512
    buffer_load_dwordx2 v[16:17], v6, s[12:15], 0 offen offset:1024
    v_mov_b32 v44, -1
    v_mov_b32 v45, -1
    v_mov_b32 v46, -1
    v_mov_b32 v47, -1
    v_mov_b32 v48, 0
    v_lshlrev_b32 v7, 4, v0
    v_lshlrev_b32 v18, 2, v0
    s_lshr_b32 s64, s2, 5
    s_lshl_b32 s64, s64, 20
    s_bfe_u32 s65, s2, 0x10004
    s_lshl_b32 s65, s65, 18
    s_add_u32 s64, s64, s65
    s_and_b32 s65, s2, 15
    s_mul_i32 s65, s65, 11776
    s_add_u32 s64, s64, s65
    buffer_store_dwordx4 v[44:47], v7, s[4:7], s64 offen sc1
    s_add_u32 s64, s64, 4096
    buffer_store_dwordx4 v[44:47], v7, s[4:7], s64 offen sc1
    s_add_u32 s64, s64, 4096
    buffer_store_dwordx4 v[44:47], v7, s[4:7], s64 offen sc1
    s_add_u32 s64, s64, 4096
    s_lshr_b32 s64, s2, 5
    s_lshl_b32 s64, s64, 18
    s_and_b32 s65, s2, 31
    s_lshl_b32 s65, s65, 12
    s_add_u32 s64, s64, s65
    s_add_u32 s64, s64, 14680064
    buffer_store_dwordx4 v[44:47], v7, s[4:7], s64 offen sc1
    s_and_b32 s64, s2, 127
    s_lshl_b32 s64, s64, 10
    s_add_u32 s64, s64, 8388608
    s_bfe_u32 s65, s2, 0x30004
    s_lshl_b32 s65, s65, 18
    s_and_b32 s66, s2, 15
    s_lshl_b32 s66, s66, 10
    s_add_u32 s65, s65, s66
    s_add_u32 s65, s65, 14811136
    s_cmp_lt_u32 s2, 128
    s_cselect_b32 s64, s64, s65
    buffer_store_dword v48, v18, s[4:7], s64 offen sc1
    v_bfe_u32 v49, v0, 5, 3
    s_and_b32 s64, s2, 3
    s_mul_i32 s64, s64, 10
    v_bfe_u32 v50, v0, 3, 2
    v_add_u32 v50, s64, v50
    v_add_u32 v51, 4, v50
    v_bfe_u32 v52, v0, 4, 1
    v_add3_u32 v52, v52, s64, 8
    v_lshrrev_b32 v53, 3, v50
    v_lshlrev_b32 v50, 10, v50
    v_lshl_add_u32 v50, v53, 13, v50
    v_lshrrev_b32 v53, 3, v51
    v_lshlrev_b32 v51, 10, v51
    v_lshl_add_u32 v51, v53, 13, v51
    v_lshrrev_b32 v53, 3, v52
    v_lshlrev_b32 v52, 10, v52
    v_lshl_add_u32 v52, v53, 13, v52
    v_and_b32 v53, 7, v0
    v_xor_b32 v53, v53, v49
    v_lshlrev_b32 v53, 4, v53
    v_lshl_add_u32 v53, v49, 7, v53
    v_add_u32 v50, v50, v53
    v_add_u32 v51, v51, v53
    v_bfe_u32 v53, v0, 1, 3
    v_xor_b32 v53, v53, v49
    v_lshlrev_b32 v53, 4, v53
    v_lshl_add_u32 v53, v49, 7, v53
    v_and_b32 v54, 1, v0
    v_lshl_add_u32 v53, v54, 3, v53
    v_add_u32 v52, v52, v53
    s_cmp_lg_u32 s60, 0
    s_cbranch_scc1 L_notick2
    v_mov_b32 v3, 0
    s_mov_b64 exec, 1
    s_waitcnt vmcnt(8)
    ds_write_b32 v3, v2
    s_mov_b64 exec, -1
L_notick2:
    s_waitcnt lgkmcnt(0)
    s_barrier
    v_mov_b32 v3, 0
    s_waitcnt vmcnt(8)
    ds_read_b32 v2, v3
    s_waitcnt lgkmcnt(0)
    v_readfirstlane_b32 s59, v2
    s_waitcnt lgkmcnt(0)
    s_barrier
    s_waitcnt vmcnt(7)
    v_lshlrev_b32 v20, 16, v8
    v_and_b32 v21, 0xffff0000, v8
    v_lshlrev_b32 v22, 16, v9
    v_and_b32 v23, 0xffff0000, v9
    v_lshlrev_b32 v24, 16, v10
    v_and_b32 v25, 0xffff0000, v10
    v_lshlrev_b32 v26, 16, v11
    v_and_b32 v27, 0xffff0000, v11
    s_waitcnt vmcnt(6)
    v_lshlrev_b32 v28, 16, v12
    v_and_b32 v29, 0xffff0000, v12
    v_lshlrev_b32 v30, 16, v13
    v_and_b32 v31, 0xffff0000, v13
    v_lshlrev_b32 v32, 16, v14
    v_and_b32 v33, 0xffff0000, v14
    v_lshlrev_b32 v34, 16, v15
    v_and_b32 v35, 0xffff0000, v15
    s_waitcnt vmcnt(5)
    v_lshlrev_b32 v36, 16, v16
    v_and_b32 v37, 0xffff0000, v16
    v_lshlrev_b32 v38, 16, v17
    v_and_b32 v39, 0xffff0000, v17
    v_pk_add_f32 v[40:41], v[20:21], v[22:23]
    v_pk_add_f32 v[40:41], v[40:41], v[24:25]
    v_pk_add_f32 v[40:41], v[40:41], v[26:27]
    v_pk_add_f32 v[40:41], v[40:41], v[28:29]
    v_pk_add_f32 v[40:41], v[40:41], v[30:31]
    v_pk_add_f32 v[40:41], v[40:41], v[32:33]
    v_pk_add_f32 v[40:41], v[40:41], v[34:35]
    v_pk_add_f32 v[40:41], v[40:41], v[36:37]
    v_pk_add_f32 v[40:41], v[40:41], v[38:39]
    v_add_f32 v40, v40, v41
    s_nop 1
    v_add_f32_dpp v40, v40, v40 quad_perm:[1,0,3,2] row_mask:0xf bank_mask:0xf
    s_nop 1
    v_add_f32_dpp v40, v40, v40 quad_perm:[2,3,0,1] row_mask:0xf bank_mask:0xf
    s_nop 1
    v_add_f32_dpp v40, v40, v40 row_half_mirror row_mask:0xf bank_mask:0xf
    s_nop 1
    v_add_f32_dpp v40, v40, v40 row_mirror row_mask:0xf bank_mask:0xf
    v_mov_b32 v41, v40
    s_nop 1
    v_permlane16_swap_b32 v40, v41
    v_add_f32 v40, v40, v41
    v_mul_f32 v40, 0xbacccccd, v40
    v_pk_add_f32 v[20:21], v[20:21], v[40:41] op_sel_hi:[1,0]
    v_pk_add_f32 v[22:23], v[22:23], v[40:41] op_sel_hi:[1,0]
    v_pk_add_f32 v[24:25], v[24:25], v[40:41] op_sel_hi:[1,0]
    v_pk_add_f32 v[26:27], v[26:27], v[40:41] op_sel_hi:[1,0]
    v_pk_add_f32 v[28:29], v[28:29], v[40:41] op_sel_hi:[1,0]
    v_pk_add_f32 v[30:31], v[30:31], v[40:41] op_sel_hi:[1,0]
    v_pk_add_f32 v[32:33], v[32:33], v[40:41] op_sel_hi:[1,0]
    v_pk_add_f32 v[34:35], v[34:35], v[40:41] op_sel_hi:[1,0]
    v_pk_add_f32 v[36:37], v[36:37], v[40:41] op_sel_hi:[1,0]
    v_pk_add_f32 v[38:39], v[38:39], v[40:41] op_sel_hi:[1,0]
    v_pk_mul_f32 v[40:41], v[20:21], v[20:21]
    v_pk_fma_f32 v[40:41], v[22:23], v[22:23], v[40:41]
    v_pk_fma_f32 v[40:41], v[24:25], v[24:25], v[40:41]
    v_pk_fma_f32 v[40:41], v[26:27], v[26:27], v[40:41]
    v_pk_fma_f32 v[40:41], v[28:29], v[28:29], v[40:41]
    v_pk_fma_f32 v[40:41], v[30:31], v[30:31], v[40:41]
    v_pk_fma_f32 v[40:41], v[32:33], v[32:33], v[40:41]
    v_pk_fma_f32 v[40:41], v[34:35], v[34:35], v[40:41]
    v_pk_fma_f32 v[40:41], v[36:37], v[36:37], v[40:41]
    v_pk_fma_f32 v[40:41], v[38:39], v[38:39], v[40:41]
    v_add_f32 v40, v40, v41
    s_nop 1
    v_add_f32_dpp v40, v40, v40 quad_perm:[1,0,3,2] row_mask:0xf bank_mask:0xf
    s_nop 1
    v_add_f32_dpp v40, v40, v40 quad_perm:[2,3,0,1] row_mask:0xf bank_mask:0xf
    s_nop 1
    v_add_f32_dpp v40, v40, v40 row_half_mirror row_mask:0xf bank_mask:0xf
    s_nop 1
    v_add_f32_dpp v40, v40, v40 row_mirror row_mask:0xf bank_mask:0xf
    v_mov_b32 v41, v40
    s_nop 1
    v_permlane16_swap_b32 v40, v41
    v_add_f32 v40, v40, v41
    v_mov_b32 v41, 0x3727c5ac
    v_fmac_f32 v41, 0x3acccccd, v40
    v_rsq_f32 v40, v41
    s_nop 0
    v_pk_mul_f32 v[20:21], v[20:21], v[40:41] op_sel_hi:[1,0]
    v_pk_mul_f32 v[22:23], v[22:23], v[40:41] op_sel_hi:[1,0]
    v_pk_mul_f32 v[24:25], v[24:25], v[40:41] op_sel_hi:[1,0]
    v_pk_mul_f32 v[26:27], v[26:27], v[40:41] op_sel_hi:[1,0]
    v_pk_mul_f32 v[28:29], v[28:29], v[40:41] op_sel_hi:[1,0]
    v_pk_mul_f32 v[30:31], v[30:31], v[40:41] op_sel_hi:[1,0]
    v_pk_mul_f32 v[32:33], v[32:33], v[40:41] op_sel_hi:[1,0]
    v_pk_mul_f32 v[34:35], v[34:35], v[40:41] op_sel_hi:[1,0]
    v_pk_mul_f32 v[36:37], v[36:37], v[40:41] op_sel_hi:[1,0]
    v_pk_mul_f32 v[38:39], v[38:39], v[40:41] op_sel_hi:[1,0]
    v_cvt_pk_bf16_f32 v8, v20, v21
    v_cvt_pk_bf16_f32 v9, v22, v23
    v_cvt_pk_bf16_f32 v10, v24, v25
    v_cvt_pk_bf16_f32 v11, v26, v27
    v_cvt_pk_bf16_f32 v12, v28, v29
    v_cvt_pk_bf16_f32 v13, v30, v31
    v_cvt_pk_bf16_f32 v14, v32, v33
    v_cvt_pk_bf16_f32 v15, v34, v35
    v_cvt_pk_bf16_f32 v16, v36, v37
    v_cvt_pk_bf16_f32 v17, v38, v39
    s_lshr_b32 s64, s2, 2
    s_lshl_b32 s64, s64, 17
    s_add_u32 s64, s64, 16777216
    buffer_store_dwordx4 v[8:11], v50, s[4:7], s64 offen sc1
    buffer_store_dwordx4 v[12:15], v51, s[4:7], s64 offen sc1
    buffer_store_dwordx2 v[16:17], v52, s[4:7], s64 offen sc1
    s_lshr_b32 s68, s58, 2
    s_and_b32 s69, s58, 3
    s_lshl_b32 s63, s58, 5
    s_add_u32 s63, s63, s59
    s_lshl_b32 s63, s63, 2
    s_add_u32 s63, s63, s60
    s_lshl_b32 s63, s63, 7
    s_add_u32 s3, s63, 8388608
    s_mov_b32 s62, 0
    s_cmp_eq_u32 s68, 0
    s_cbranch_scc1 Lnowarm_1
    s_waitcnt vmcnt(0)
    s_barrier
    s_cmp_lg_u32 s60, 0
    s_cbranch_scc1 Lcnt_2
    s_mov_b64 exec, 1
    v_mov_b32 v2, 1
    buffer_atomic_add v2, off, s[8:11], 0 offset:4 sc0
    v_mov_b32 v3, 0x80000000
    s_waitcnt vmcnt(0)
    v_cmp_ne_u32 vcc, 255, v2
    s_nop 1
    v_cndmask_b32 v3, 4, v3, vcc
    buffer_store_dword v2, v3, s[8:11], 0 offen offset:128 sc1
    s_mov_b64 exec, -1
Lcnt_2:
    s_lshl_b32 s64, s60, 5
    s_add_u32 s64, s64, s59
    s_lshr_b32 s64, s64, 3
    s_cmp_lg_u32 s64, 3
    s_cbranch_scc1 Lnoprobe_4
    s_lshl_b32 s64, s69, 3
    s_and_b32 s65, s59, 7
    s_add_u32 s64, s64, s65
    s_lshl_b32 s64, s64, 7
    s_add_u32 s64, s64, 14860288
    s_add_u32 s66, s64, 131072
    v_lshlrev_b32 v3, 4, v0
    s_mov_b64 exec, 0xff
    s_mov_b32 s70, -1
    s_mov_b32 s71, -1
Lprobe_3:
    buffer_store_dwordx4 v[8:11], v3, s[4:7], s64 offen sc1
    s_mov_b32 s0, 0
Lprobe_3w:
    s_add_u32 s0, s0, 1
    s_sub_u32 s61, s61, 1
    s_cbranch_scc1 L_fail
    s_getreg_b32 s65, hwreg(HW_REG_IB_STS, 0, 4)
    s_cmp_lg_u32 s65, 0
    s_cbranch_scc1 Lprobe_3w
    s_waitcnt vmcnt(0)
    s_bitcmp1_b32 s64, 13
    s_cselect_b32 s65, -1, s0
    s_cselect_b32 s0, s0, -1
    s_min_u32 s70, s70, s65
    s_min_u32 s71, s71, s0
    s_add_u32 s64, s64, 0x1000
    s_or_b32 s64, s64, 0xc000
    s_cmp_lt_u32 s64, s66
    s_cbranch_scc1 Lprobe_3
    s_cmp_gt_u32 s70, s71
    s_cselect_b32 s65, 65, 64
    s_mov_b64 exec, 1
    v_mov_b32 v2, s65
    buffer_atomic_add v2, off, s[8:11], 0 offset:72 sc0
    s_waitcnt vmcnt(0)
    v_add_u32 v2, s65, v2
    v_subrev_u32 v2, 2047, v2
    v_mov_b32 v3, 0x80000000
    v_cmp_lt_i32 vcc, 0, v2
    s_nop 1
    v_cndmask_b32 v3, v3, 0, vcc
    buffer_store_dword v2, v3, s[8:11], 0 offen offset:140 sc1
    s_mov_b64 exec, -1
Lnoprobe_4:
    s_cmp_lg_u32 s60, 0
    s_cbranch_scc1 Lgskip_7
    buffer_load_dword v2, off, s[8:11], 0 offset:136 sc1
Lgchk_5:
    s_waitcnt vmcnt(0)
    v_cmp_eq_u32 vcc, 0, v2
    s_cbranch_vccnz Lgrty_6
Lgskip_7:
    s_waitcnt lgkmcnt(0)
    s_barrier
Lnowarm_1:
    s_cmp_lt_u32 s59, 24
    s_cbranch_scc1 L_roleC
    s_cmp_lt_u32 s59, 28
    s_cbranch_scc1 L_roleT
    s_cmp_lt_u32 s59, 30
    s_cbranch_scc1 L_roleB
    s_cmp_lt_u32 s59, 32
    s_cbranch_scc1 L_roleR
    s_mov_b32 s67, 2
L_fail:
    s_mov_b64 exec, 1
    s_lshl_b32 s67, s67, 8
    s_add_u32 s67, s67, s59
    s_lshl_b32 s67, s67, 8
    s_add_u32 s67, s67, s58
    s_lshl_b32 s67, s67, 8
    s_add_u32 s67, s67, s62
    s_waitcnt vmcnt(0)
    v_mov_b32 v2, s67
    buffer_store_dword v2, off, s[8:11], 0 offset:40
L_end:
    s_endpgm
L_roleC:
    s_mov_b32 s12, s36
    s_mov_b32 s13, s37
    s_mov_b32 s14, 7864320
    s_mov_b32 s15, 0x20000
    s_mov_b32 s16, s38
    s_mov_b32 s17, s39
    s_mov_b32 s18, 7864320
    s_mov_b32 s19, 0x20000
    s_mov_b32 s20, s40
    s_mov_b32 s21, s41
    s_mov_b32 s22, 7864320
    s_mov_b32 s23, 0x20000
    s_mov_b32 s24, s42
    s_mov_b32 s25, s43
    s_mov_b32 s26, 7864320
    s_mov_b32 s27, 0x20000
    s_mov_b32 s28, s34
    s_mov_b32 s29, s35
    s_mov_b32 s30, 10240
    s_mov_b32 s31, 0x20000
    v_and_b32 v1, 63, v0
    s_mul_i32 s64, s69, 3072
    s_lshl_b32 s65, s59, 7
    s_add_u32 s64, s64, s65
    s_mul_i32 s65, s60, 98304
    s_add_u32 s64, s64, s65
    v_lshrrev_b32 v194, 3, v1
    v_mul_u32_u24 v194, 12288, v194
    v_and_b32 v195, 7, v1
    v_lshl_add_u32 v194, v195, 4, v194
    v_add_u32 v194, s64, v194
    s_lshl_b32 s82, s60, 10
    s_lshl_b32 s64, s69, 2
    s_add_u32 s64, s64, s60
    s_mul_i32 s64, s64, 491520
    s_lshl_b32 s65, s59, 6
    s_add_u32 s64, s64, s65
    s_cmp_lt_u32 s59, 20
    s_cselect_b32 s64, s64, 0x80000000
    v_lshrrev_b32 v197, 2, v1
    v_mul_u32_u24 v197, 1280, v197
    v_and_b32 v198, 3, v1
    v_lshl_add_u32 v197, v198, 4, v197
    v_add_u32 v197, s64, v197
    s_lshl_b32 s83, s60, 12
    s_add_u32 m0, s83, 0
    s_mov_b32 s65, 0
    buffer_load_dwordx4 v197, s[24:27], s65 offen lds
    s_add_u32 m0, s83, 1024
    s_mov_b32 s65, 20480
    buffer_load_dwordx4 v197, s[24:27], s65 offen lds
    s_add_u32 m0, s83, 2048
    s_mov_b32 s65, 40960
    buffer_load_dwordx4 v197, s[24:27], s65 offen lds
    s_add_u32 m0, s83, 3072
    s_mov_b32 s65, 61440
    buffer_load_dwordx4 v197, s[24:27], s65 offen lds
    s_add_u32 m0, s83, 16384
    s_mov_b32 s65, 81920
    buffer_load_dwordx4 v197, s[24:27], s65 offen lds
    s_add_u32 m0, s83, 17408
    s_mov_b32 s65, 102400
    buffer_load_dwordx4 v197, s[24:27], s65 offen lds
    s_add_u32 m0, s83, 18432
    s_mov_b32 s65, 122880
    buffer_load_dwordx4 v197, s[24:27], s65 offen lds
    s_add_u32 m0, s83, 19456
    s_mov_b32 s65, 143360
    buffer_load_dwordx4 v197, s[24:27], s65 offen lds
    s_add_u32 m0, s83, 32768
    s_mov_b32 s65, 163840
    buffer_load_dwordx4 v197, s[24:27], s65 offen lds
    s_add_u32 m0, s83, 33792
    s_mov_b32 s65, 184320
    buffer_load_dwordx4 v197, s[24:27], s65 offen lds
    s_add_u32 m0, s83, 34816
    s_mov_b32 s65, 204800
    buffer_load_dwordx4 v197, s[24:27], s65 offen lds
    s_add_u32 m0, s83, 35840
    s_mov_b32 s65, 225280
    buffer_load_dwordx4 v197, s[24:27], s65 offen lds
    s_add_u32 m0, s83, 49152
    s_mov_b32 s65, 245760
    buffer_load_dwordx4 v197, s[24:27], s65 offen lds
    s_add_u32 m0, s83, 50176
    s_mov_b32 s65, 266240
    buffer_load_dwordx4 v197, s[24:27], s65 offen lds
    s_add_u32 m0, s83, 51200
    s_mov_b32 s65, 286720
    buffer_load_dwordx4 v197, s[24:27], s65 offen lds
    s_add_u32 m0, s83, 52224
    s_mov_b32 s65, 307200
    buffer_load_dwordx4 v197, s[24:27], s65 offen lds
    v_and_b32 v84, 7, v1
    v_bfe_u32 v85, v1, 3, 1
    v_lshrrev_b32 v86, 4, v1
    v_and_b32 v87, 15, v1
    v_lshlrev_b32 v234, 4, v0
    v_lshlrev_b32 v235, 3, v0
    v_add_u32 v235, 8192, v235
    v_lshlrev_b32 v236, 4, v1
    v_lshlrev_b32 v240, 3, v1
    v_lshlrev_b32 v237, 2, v1
    s_add_u32 s64, s60, 1
    s_mul_i32 s64, s64, 1280
    v_add_u32 v238, s64, v236
    v_add_u32 v239, s64, v237
    v_cmp_eq_u32 s[98:99], 1, v85
    v_cmp_lt_u32 s[100:101], 1, v86
    v_mov_b32 v88, 0x4444
    v_mov_b32 v89, 0xeeee
    v_cndmask_b32 v187, v88, v89, s[98:99]
    v_mov_b32 v88, 0xffff
    v_mov_b32 v89, 0xffff0000
    v_cndmask_b32 v231, v88, v89, s[98:99]
    v_mul_u32_u24 v232, 10240, v85
    v_lshl_add_u32 v232, v84, 7, v232
    v_xor_b32 v88, v86, v84
    v_lshl_add_u32 v232, v88, 4, v232
    v_add_u32 v232, 32768, v232
    v_xor_b32 v233, 64, v232
    v_lshrrev_b32 v88, 5, v1
    v_and_b32 v89, 1, v86
    v_lshlrev_b32 v90, 4, v87
    v_lshl_add_u32 v90, v89, 3, v90
    v_lshl_add_u32 v241, v88, 10, v90
    s_lshl_b32 s64, s60, 8
    v_add_u32 v241, s64, v241
    v_lshl_add_u32 v243, v88, 8, v90
    s_lshl_b32 s64, s60, 9
    v_add_u32 v243, s64, v243
    v_lshlrev_b32 v249, 9, v89
    v_lshl_add_u32 v249, v88, 6, v249
    v_bfe_u32 v90, v1, 1, 1
    v_lshl_add_u32 v249, v90, 5, v249
    v_bfe_u32 v90, v1, 2, 2
    v_lshl_add_u32 v249, v90, 3, v249
    v_and_b32 v89, 1, v1
    v_lshl_add_u32 v249, v89, 2, v249
    s_lshl_b32 s64, s60, 10
    s_add_u32 s64, s64, 18432
    v_add_u32 v249, s64, v249
    v_lshl_add_u32 v242, v86, 3, v90
    v_lshlrev_b32 v242, 4, v242
    v_lshl_add_u32 v242, v89, 3, v242
    v_bfe_u32 v88, v1, 1, 2
    v_lshlrev_b32 v250, 7, v88
    v_lshrrev_b32 v88, 3, v1
    v_lshl_add_u32 v250, v88, 4, v250
    v_lshl_add_u32 v250, v89, 3, v250
    s_lshl_b32 s64, s59, 9
    s_add_u32 s64, s64, 178176
    v_add_u32 v250, s64, v250
    s_lshl_b32 s66, s59, 10
    s_and_b32 s64, s66, 0x6000
    s_add_u32 s64, s64, s66
    s_lshl_b32 s65, s68, 20
    s_add_u32 s64, s64, s65
    s_add_u32 s64, s64, 14680064
    v_add_u32 v251, s64, v236
    s_and_b32 s64, s60, 1
    s_lshl_b32 s64, s64, 3
    s_lshr_b32 s65, s60, 1
    v_lshl_add_u32 v89, v86, 4, v84
    v_add_u32 v89, s64, v89
    s_lshl_b32 s64, s65, 11
    v_lshl_add_u32 v244, v89, 4, s64
    s_mul_i32 s64, s65, 1536
    v_lshlrev_b32 v246, 4, v89
    v_lshlrev_b32 v245, 3, v89
    v_add_u32 v245, 1024, v245
    v_cndmask_b32 v245, v246, v245, s[98:99]
    v_add_u32 v245, s64, v245
    v_lshl_add_u32 v246, v85, 1, v246
    v_add_u32 v246, s64, v246
    s_lshl_b32 s64, s60, 8
    s_add_u32 s64, s64, s66
    s_add_u32 s64, s64, 153600
    v_lshlrev_b32 v88, 5, v84
    v_lshl_add_u32 v247, v86, 3, v88
    v_add_u32 v247, s64, v247
    v_mov_b32 v89, 0x80000000
    v_cndmask_b32 v247, v247, v89, s[98:99]
    v_lshl_add_u32 v248, v86, 8, v88
    v_lshl_add_u32 v248, v85, 4, v248
    s_mul_i32 s64, s60, 6144
    s_add_u32 s64, s64, 153600
    v_add_u32 v248, s64, v248
    s_lshl_b32 s64, s59, 2
    s_add_u32 s64, s64, s60
    s_sub_u32 s64, s64, 80
    s_lshl_b32 s66, s64, 12
    s_and_b32 s65, s66, 0xe000
    s_add_u32 s66, s66, s65
    s_cmp_lt_u32 s64, 10
    s_cselect_b32 s64, s66, 0x80000000
    v_add_u32 v89, s64, v236
    s_cmp_lt_u32 s59, 20
    s_cselect_b64 vcc, -1, 0
    v_cndmask_b32 v248, v89, v248, vcc
    s_lshl_b32 s75, s59, 12
    s_mul_i32 s66, s69, 98304
    s_add_u32 s75, s75, s66
    s_mul_i32 s66, s68, 6291456
    s_add_u32 s75, s75, s66
    s_add_u32 s75, s75, 60817408
    v_lshlrev_b32 v88, 2, v86
    v_lshl_add_u32 v88, v85, 4, v88
    s_lshl_b32 s66, s60, 3
    v_add_u32 v89, s66, v84
    v_mov_b32 v90, 0xcf89a6aa
    v_cmp_gt_u32 vcc, v88, v89
    s_nop 1
    v_cndmask_b32 v188, 0, v90, vcc
    v_add_u32 v88, 1, v88
    v_cmp_gt_u32 vcc, v88, v89
    s_nop 1
    v_cndmask_b32 v189, 0, v90, vcc
    v_add_u32 v88, 1, v88
    v_cmp_gt_u32 vcc, v88, v89
    s_nop 1
    v_cndmask_b32 v190, 0, v90, vcc
    v_add_u32 v88, 1, v88
    v_cmp_gt_u32 vcc, v88, v89
    s_nop 1
    v_cndmask_b32 v191, 0, v90, vcc
    v_add_u32 v88, 1, v88
    v_mov_b32 v180, 0x3f803f80
    v_mov_b32 v181, 0x3f803f80
    v_mov_b32 v182, 0x3f803f80
    v_mov_b32 v183, 0
    v_mov_b32 v175, 0
    v_mov_b32 v179, 0
    s_mov_b32 s70, 0x3dd53b95
    s_cmp_lt_u32 s59, 20
    s_cselect_b32 s89, 4096, 0
    s_lshl_b32 s73, s60, 10
    s_add_u32 s73, s73, 32768
    s_lshl_b32 s91, s68, 23
    s_add_u32 s91, s91, 16777216
    s_mov_b32 s74, s91
    s_mul_i32 s64, s59, 43
    s_lshr_b32 s64, s64, 7
    s_mul_i32 s64, s64, 3
    s_add_u32 s65, s64, 3
    s_add_u32 s77, s59, 1
    s_cmp_eq_u32 s77, s65
    s_cselect_b32 s77, s64, s77
    s_add_u32 s78, s77, 1
    s_cmp_eq_u32 s78, s65
    s_cselect_b32 s78, s64, s78
    s_mul_i32 s76, s59, 6400
    s_mul_i32 s77, s77, 6400
    s_mul_i32 s78, s78, 6400
    s_cmp_lg_u32 s68, 0
    s_cbranch_scc1 Larr0_8
    s_waitcnt vmcnt(16)
    s_barrier
    s_cmp_lg_u32 s60, 0
    s_cbranch_scc1 Lcnt_9
    s_mov_b64 exec, 1
    v_mov_b32 v2, 1
    buffer_atomic_add v2, off, s[8:11], 0 offset:4 sc0
    s_mov_b64 exec, -1
Lcnt_9:
Larr0_8:
    s_add_u32 m0, s83, 65536
    s_mov_b32 s65, 327680
    buffer_load_dwordx4 v197, s[24:27], s65 offen lds
    s_add_u32 m0, s83, 66560
    s_mov_b32 s65, 348160
    buffer_load_dwordx4 v197, s[24:27], s65 offen lds
    s_add_u32 m0, s83, 67584
    s_mov_b32 s65, 368640
    buffer_load_dwordx4 v197, s[24:27], s65 offen lds
    s_add_u32 m0, s83, 68608
    s_mov_b32 s65, 389120
    buffer_load_dwordx4 v197, s[24:27], s65 offen lds
    s_add_u32 m0, s83, 81920
    s_mov_b32 s65, 409600
    buffer_load_dwordx4 v197, s[24:27], s65 offen lds
    s_add_u32 m0, s83, 82944
    s_mov_b32 s65, 430080
    buffer_load_dwordx4 v197, s[24:27], s65 offen lds
    s_add_u32 m0, s83, 83968
    s_mov_b32 s65, 450560
    buffer_load_dwordx4 v197, s[24:27], s65 offen lds
    s_add_u32 m0, s83, 84992
    s_mov_b32 s65, 471040
    buffer_load_dwordx4 v197, s[24:27], s65 offen lds
    s_add_u32 m0, s82, 98304
    s_mov_b32 s65, 0
    buffer_load_dwordx4 v194, s[12:15], s65 offen nt lds
    s_add_u32 m0, s82, 102400
    s_mov_b32 s65, 393216
    buffer_load_dwordx4 v194, s[12:15], s65 offen nt lds
    s_add_u32 m0, s82, 106496
    s_mov_b32 s65, 786432
    buffer_load_dwordx4 v194, s[12:15], s65 offen nt lds
    s_add_u32 m0, s82, 110592
    s_mov_b32 s65, 1179648
    buffer_load_dwordx4 v194, s[12:15], s65 offen nt lds
    s_add_u32 m0, s82, 114688
    s_mov_b32 s65, 1572864
    buffer_load_dwordx4 v194, s[12:15], s65 offen nt lds
    s_add_u32 m0, s82, 118784
    s_mov_b32 s65, 1966080
    buffer_load_dwordx4 v194, s[12:15], s65 offen nt lds
    s_add_u32 m0, s82, 122880
    s_mov_b32 s65, 2359296
    buffer_load_dwordx4 v194, s[12:15], s65 offen nt lds
    s_add_u32 m0, s82, 126976
    s_mov_b32 s65, 2752512
    buffer_load_dwordx4 v194, s[12:15], s65 offen nt lds
    s_add_u32 m0, s82, 131072
    s_mov_b32 s65, 3145728
    buffer_load_dwordx4 v194, s[12:15], s65 offen nt lds
    s_add_u32 m0, s82, 135168
    s_mov_b32 s65, 3538944
    buffer_load_dwordx4 v194, s[12:15], s65 offen nt lds
    s_add_u32 m0, s82, 139264
    s_mov_b32 s65, 3932160
    buffer_load_dwordx4 v194, s[12:15], s65 offen nt lds
    s_add_u32 m0, s82, 143360
    s_mov_b32 s65, 4325376
    buffer_load_dwordx4 v194, s[12:15], s65 offen nt lds
    v_bfe_u32 v196, v1, 2, 2
    v_lshl_add_u32 v195, v86, 3, v196
    v_lshlrev_b32 v195, 7, v195
    v_lshl_add_u32 v195, v198, 3, v195
    s_lshl_b32 s64, s60, 5
    v_add_u32 v195, s64, v195
    v_lshrrev_b32 v199, 5, v1
    v_lshlrev_b32 v199, 4, v199
    v_lshl_add_u32 v199, v85, 3, v199
    v_and_b32 v88, 1, v86
    v_lshl_add_u32 v199, v88, 2, v199
    v_bfe_u32 v88, v1, 2, 1
    v_add_u32 v199, v199, v88
    v_lshlrev_b32 v199, 6, v199
    v_lshl_add_u32 v199, v198, 3, v199
    v_add_u32 v199, s83, v199
    s_waitcnt vmcnt(32)
    s_waitcnt lgkmcnt(0)
    s_barrier
    s_add_u32 m0, s82, 147456
    s_mov_b32 s65, 4718592
    buffer_load_dwordx4 v194, s[12:15], s65 offen nt lds
    s_add_u32 m0, s82, 151552
    s_mov_b32 s65, 5111808
    buffer_load_dwordx4 v194, s[12:15], s65 offen nt lds
    s_add_u32 m0, s82, 155648
    s_mov_b32 s65, 5505024
    buffer_load_dwordx4 v194, s[12:15], s65 offen nt lds
    s_add_u32 m0, s82, 159744
    s_mov_b32 s65, 5898240
    buffer_load_dwordx4 v194, s[12:15], s65 offen nt lds
    v_add_u32 v196, 0, v199
    ds_read_b64_tr_b16 a[240:241], v196 offset:0
    ds_read_b64_tr_b16 a[242:243], v196 offset:128
    ds_read_b64_tr_b16 a[244:245], v196 offset:2048
    ds_read_b64_tr_b16 a[246:247], v196 offset:2176
    ds_read_b64_tr_b16 a[248:249], v196 offset:32
    ds_read_b64_tr_b16 a[250:251], v196 offset:160
    ds_read_b64_tr_b16 a[252:253], v196 offset:2080
    ds_read_b64_tr_b16 a[254:255], v196 offset:2208
    s_waitcnt vmcnt(32)
    s_waitcnt lgkmcnt(0)
    s_barrier
    s_add_u32 m0, s82, 0
    s_mov_b32 s65, 6291456
    buffer_load_dwordx4 v194, s[12:15], s65 offen nt lds
    s_add_u32 m0, s82, 4096
    s_mov_b32 s65, 6684672
    buffer_load_dwordx4 v194, s[12:15], s65 offen nt lds
    s_add_u32 m0, s82, 8192
    s_mov_b32 s65, 7077888
    buffer_load_dwordx4 v194, s[12:15], s65 offen nt lds
    s_add_u32 m0, s82, 12288
    s_mov_b32 s65, 7471104
    buffer_load_dwordx4 v194, s[12:15], s65 offen nt lds
    v_add_u32 v196, 16384, v199
    ds_read_b64_tr_b16 v[4:5], v196 offset:0
    ds_read_b64_tr_b16 v[6:7], v196 offset:128
    ds_read_b64_tr_b16 v[8:9], v196 offset:2048
    ds_read_b64_tr_b16 v[10:11], v196 offset:2176
    ds_read_b64_tr_b16 v[12:13], v196 offset:32
    ds_read_b64_tr_b16 v[14:15], v196 offset:160
    ds_read_b64_tr_b16 v[16:17], v196 offset:2080
    ds_read_b64_tr_b16 v[18:19], v196 offset:2208
    s_waitcnt vmcnt(32)
    s_waitcnt lgkmcnt(0)
    s_barrier
    s_add_u32 m0, s82, 16384
    s_mov_b32 s65, 0
    buffer_load_dwordx4 v194, s[16:19], s65 offen nt lds
    s_add_u32 m0, s82, 20480
    s_mov_b32 s65, 393216
    buffer_load_dwordx4 v194, s[16:19], s65 offen nt lds
    s_add_u32 m0, s82, 24576
    s_mov_b32 s65, 786432
    buffer_load_dwordx4 v194, s[16:19], s65 offen nt lds
    s_add_u32 m0, s82, 28672
    s_mov_b32 s65, 1179648
    buffer_load_dwordx4 v194, s[16:19], s65 offen nt lds
    v_add_u32 v196, 32768, v199
    ds_read_b64_tr_b16 v[20:21], v196 offset:0
    ds_read_b64_tr_b16 v[22:23], v196 offset:128
    ds_read_b64_tr_b16 v[24:25], v196 offset:2048
    ds_read_b64_tr_b16 v[26:27], v196 offset:2176
    ds_read_b64_tr_b16 v[28:29], v196 offset:32
    ds_read_b64_tr_b16 v[30:31], v196 offset:160
    ds_read_b64_tr_b16 v[32:33], v196 offset:2080
    ds_read_b64_tr_b16 v[34:35], v196 offset:2208
    s_waitcnt vmcnt(32)
    s_waitcnt lgkmcnt(0)
    s_barrier
    s_add_u32 m0, s82, 32768
    s_mov_b32 s65, 1572864
    buffer_load_dwordx4 v194, s[16:19], s65 offen nt lds
    s_add_u32 m0, s82, 36864
    s_mov_b32 s65, 1966080
    buffer_load_dwordx4 v194, s[16:19], s65 offen nt lds
    s_add_u32 m0, s82, 40960
    s_mov_b32 s65, 2359296
    buffer_load_dwordx4 v194, s[16:19], s65 offen nt lds
    s_add_u32 m0, s82, 45056
    s_mov_b32 s65, 2752512
    buffer_load_dwordx4 v194, s[16:19], s65 offen nt lds
    v_add_u32 v196, 49152, v199
    ds_read_b64_tr_b16 v[36:37], v196 offset:0
    ds_read_b64_tr_b16 v[38:39], v196 offset:128
    ds_read_b64_tr_b16 v[40:41], v196 offset:2048
    ds_read_b64_tr_b16 v[42:43], v196 offset:2176
    ds_read_b64_tr_b16 v[44:45], v196 offset:32
    ds_read_b64_tr_b16 v[46:47], v196 offset:160
    ds_read_b64_tr_b16 v[48:49], v196 offset:2080
    ds_read_b64_tr_b16 v[50:51], v196 offset:2208
    s_waitcnt vmcnt(32)
    s_waitcnt lgkmcnt(0)
    s_barrier
    s_add_u32 m0, s82, 49152
    s_mov_b32 s65, 3145728
    buffer_load_dwordx4 v194, s[16:19], s65 offen nt lds
    s_add_u32 m0, s82, 53248
    s_mov_b32 s65, 3538944
    buffer_load_dwordx4 v194, s[16:19], s65 offen nt lds
    s_add_u32 m0, s82, 57344
    s_mov_b32 s65, 3932160
    buffer_load_dwordx4 v194, s[16:19], s65 offen nt lds
    s_add_u32 m0, s82, 61440
    s_mov_b32 s65, 4325376
    buffer_load_dwordx4 v194, s[16:19], s65 offen nt lds
    s_cmp_lg_u32 s68, 0
    s_cbranch_scc1 Larr0_10
    s_cmp_lg_u32 s60, 0
    s_cbranch_scc1 Lcnt_11
    s_mov_b64 exec, 1
    v_mov_b32 v3, 0x80000000
    v_cmp_ne_u32 vcc, 255, v2
    s_nop 1
    v_cndmask_b32 v3, 4, v3, vcc
    buffer_store_dword v2, v3, s[8:11], 0 offen offset:128 sc1
    s_mov_b64 exec, -1
Lcnt_11:
Larr0_10:
    v_add_u32 v196, 65536, v199
    ds_read_b64_tr_b16 v[52:53], v196 offset:0
    ds_read_b64_tr_b16 v[54:55], v196 offset:128
    ds_read_b64_tr_b16 v[56:57], v196 offset:2048
    ds_read_b64_tr_b16 v[58:59], v196 offset:2176
    ds_read_b64_tr_b16 v[60:61], v196 offset:32
    ds_read_b64_tr_b16 v[62:63], v196 offset:160
    ds_read_b64_tr_b16 v[64:65], v196 offset:2080
    ds_read_b64_tr_b16 v[66:67], v196 offset:2208
    s_waitcnt vmcnt(32)
    s_waitcnt lgkmcnt(0)
    s_barrier
    s_add_u32 m0, s82, 65536
    s_mov_b32 s65, 4718592
    buffer_load_dwordx4 v194, s[16:19], s65 offen nt lds
    s_add_u32 m0, s82, 69632
    s_mov_b32 s65, 5111808
    buffer_load_dwordx4 v194, s[16:19], s65 offen nt lds
    s_add_u32 m0, s82, 73728
    s_mov_b32 s65, 5505024
    buffer_load_dwordx4 v194, s[16:19], s65 offen nt lds
    s_add_u32 m0, s82, 77824
    s_mov_b32 s65, 5898240
    buffer_load_dwordx4 v194, s[16:19], s65 offen nt lds
    v_add_u32 v196, 81920, v199
    ds_read_b64_tr_b16 v[68:69], v196 offset:0
    ds_read_b64_tr_b16 v[70:71], v196 offset:128
    ds_read_b64_tr_b16 v[72:73], v196 offset:2048
    ds_read_b64_tr_b16 v[74:75], v196 offset:2176
    ds_read_b64_tr_b16 v[76:77], v196 offset:32
    ds_read_b64_tr_b16 v[78:79], v196 offset:160
    ds_read_b64_tr_b16 v[80:81], v196 offset:2080
    ds_read_b64_tr_b16 v[82:83], v196 offset:2208
    s_waitcnt vmcnt(32)
    s_waitcnt lgkmcnt(0)
    s_barrier
    s_add_u32 m0, s82, 81920
    s_mov_b32 s65, 6291456
    buffer_load_dwordx4 v194, s[16:19], s65 offen nt lds
    s_add_u32 m0, s82, 86016
    s_mov_b32 s65, 6684672
    buffer_load_dwordx4 v194, s[16:19], s65 offen nt lds
    s_add_u32 m0, s82, 90112
    s_mov_b32 s65, 7077888
    buffer_load_dwordx4 v194, s[16:19], s65 offen nt lds
    s_add_u32 m0, s82, 94208
    s_mov_b32 s65, 7471104
    buffer_load_dwordx4 v194, s[16:19], s65 offen nt lds
    v_add_u32 v196, 98304, v195
    ds_read_b64_tr_b16 a[0:1], v196 offset:0
    ds_read_b64_tr_b16 a[2:3], v196 offset:512
    ds_read_b64_tr_b16 a[4:5], v196 offset:4096
    ds_read_b64_tr_b16 a[6:7], v196 offset:4608
    ds_read_b64_tr_b16 a[8:9], v196 offset:8192
    ds_read_b64_tr_b16 a[10:11], v196 offset:8704
    ds_read_b64_tr_b16 a[12:13], v196 offset:12288
    ds_read_b64_tr_b16 a[14:15], v196 offset:12800
    s_waitcnt vmcnt(32)
    s_waitcnt lgkmcnt(0)
    s_barrier
    s_add_u32 m0, s82, 98304
    s_mov_b32 s65, 0
    buffer_load_dwordx4 v194, s[20:23], s65 offen nt lds
    s_add_u32 m0, s82, 102400
    s_mov_b32 s65, 393216
    buffer_load_dwordx4 v194, s[20:23], s65 offen nt lds
    s_add_u32 m0, s82, 106496
    s_mov_b32 s65, 786432
    buffer_load_dwordx4 v194, s[20:23], s65 offen nt lds
    s_add_u32 m0, s82, 110592
    s_mov_b32 s65, 1179648
    buffer_load_dwordx4 v194, s[20:23], s65 offen nt lds
    buffer_load_dwordx3 v[216:218], off, s[8:11], 0 offset:132 sc1
    v_add_u32 v196, 114688, v195
    ds_read_b64_tr_b16 a[16:17], v196 offset:0
    ds_read_b64_tr_b16 a[18:19], v196 offset:512
    ds_read_b64_tr_b16 a[20:21], v196 offset:4096
    ds_read_b64_tr_b16 a[22:23], v196 offset:4608
    ds_read_b64_tr_b16 a[24:25], v196 offset:8192
    ds_read_b64_tr_b16 a[26:27], v196 offset:8704
    ds_read_b64_tr_b16 a[28:29], v196 offset:12288
    ds_read_b64_tr_b16 a[30:31], v196 offset:12800
    s_waitcnt vmcnt(32)
    s_waitcnt lgkmcnt(0)
    s_barrier
    s_add_u32 m0, s82, 114688
    s_mov_b32 s65, 1572864
    buffer_load_dwordx4 v194, s[20:23], s65 offen nt lds
    s_add_u32 m0, s82, 118784
    s_mov_b32 s65, 1966080
    buffer_load_dwordx4 v194, s[20:23], s65 offen nt lds
    s_add_u32 m0, s82, 122880
    s_mov_b32 s65, 2359296
    buffer_load_dwordx4 v194, s[20:23], s65 offen nt lds
    s_add_u32 m0, s82, 126976
    s_mov_b32 s65, 2752512
    buffer_load_dwordx4 v194, s[20:23], s65 offen nt lds
    v_add_u32 v196, 131072, v195
    ds_read_b64_tr_b16 a[32:33], v196 offset:0
    ds_read_b64_tr_b16 a[34:35], v196 offset:512
    ds_read_b64_tr_b16 a[36:37], v196 offset:4096
    ds_read_b64_tr_b16 a[38:39], v196 offset:4608
    ds_read_b64_tr_b16 a[40:41], v196 offset:8192
    ds_read_b64_tr_b16 a[42:43], v196 offset:8704
    ds_read_b64_tr_b16 a[44:45], v196 offset:12288
    ds_read_b64_tr_b16 a[46:47], v196 offset:12800
    s_waitcnt vmcnt(32)
    s_waitcnt lgkmcnt(0)
    s_barrier
    s_add_u32 m0, s82, 131072
    s_mov_b32 s65, 3145728
    buffer_load_dwordx4 v194, s[20:23], s65 offen nt lds
    s_add_u32 m0, s82, 135168
    s_mov_b32 s65, 3538944
    buffer_load_dwordx4 v194, s[20:23], s65 offen nt lds
    s_add_u32 m0, s82, 139264
    s_mov_b32 s65, 3932160
    buffer_load_dwordx4 v194, s[20:23], s65 offen nt lds
    s_add_u32 m0, s82, 143360
    s_mov_b32 s65, 4325376
    buffer_load_dwordx4 v194, s[20:23], s65 offen nt lds
    v_add_u32 v196, 147456, v195
    ds_read_b64_tr_b16 a[48:49], v196 offset:0
    ds_read_b64_tr_b16 a[50:51], v196 offset:512
    ds_read_b64_tr_b16 a[52:53], v196 offset:4096
    ds_read_b64_tr_b16 a[54:55], v196 offset:4608
    ds_read_b64_tr_b16 a[56:57], v196 offset:8192
    ds_read_b64_tr_b16 a[58:59], v196 offset:8704
    ds_read_b64_tr_b16 a[60:61], v196 offset:12288
    ds_read_b64_tr_b16 a[62:63], v196 offset:12800
    s_waitcnt vmcnt(32)
    s_waitcnt lgkmcnt(0)
    s_barrier
    s_add_u32 m0, s82, 147456
    s_mov_b32 s65, 4718592
    buffer_load_dwordx4 v194, s[20:23], s65 offen nt lds
    s_add_u32 m0, s82, 151552
    s_mov_b32 s65, 5111808
    buffer_load_dwordx4 v194, s[20:23], s65 offen nt lds
    s_add_u32 m0, s82, 155648
    s_mov_b32 s65, 5505024
    buffer_load_dwordx4 v194, s[20:23], s65 offen nt lds
    s_add_u32 m0, s82, 159744
    s_mov_b32 s65, 5898240
    buffer_load_dwordx4 v194, s[20:23], s65 offen nt lds
    v_add_u32 v196, 0, v195
    ds_read_b64_tr_b16 a[64:65], v196 offset:0
    ds_read_b64_tr_b16 a[66:67], v196 offset:512
    ds_read_b64_tr_b16 a[68:69], v196 offset:4096
    ds_read_b64_tr_b16 a[70:71], v196 offset:4608
    ds_read_b64_tr_b16 a[72:73], v196 offset:8192
    ds_read_b64_tr_b16 a[74:75], v196 offset:8704
    ds_read_b64_tr_b16 a[76:77], v196 offset:12288
    ds_read_b64_tr_b16 a[78:79], v196 offset:12800
    s_waitcnt vmcnt(32)
    s_waitcnt lgkmcnt(0)
    s_barrier
    s_add_u32 m0, s82, 0
    s_mov_b32 s65, 6291456
    buffer_load_dwordx4 v194, s[20:23], s65 offen nt lds
    s_add_u32 m0, s82, 4096
    s_mov_b32 s65, 6684672
    buffer_load_dwordx4 v194, s[20:23], s65 offen nt lds
    s_add_u32 m0, s82, 8192
    s_mov_b32 s65, 7077888
    buffer_load_dwordx4 v194, s[20:23], s65 offen nt lds
    s_add_u32 m0, s82, 12288
    s_mov_b32 s65, 7471104
    buffer_load_dwordx4 v194, s[20:23], s65 offen nt lds
    v_add_u32 v196, 16384, v195
    ds_read_b64_tr_b16 a[80:81], v196 offset:0
    ds_read_b64_tr_b16 a[82:83], v196 offset:512
    ds_read_b64_tr_b16 a[84:85], v196 offset:4096
    ds_read_b64_tr_b16 a[86:87], v196 offset:4608
    ds_read_b64_tr_b16 a[88:89], v196 offset:8192
    ds_read_b64_tr_b16 a[90:91], v196 offset:8704
    ds_read_b64_tr_b16 a[92:93], v196 offset:12288
    ds_read_b64_tr_b16 a[94:95], v196 offset:12800
    s_waitcnt vmcnt(32)
    s_waitcnt lgkmcnt(0)
    s_barrier
    v_add_u32 v196, 32768, v195
    ds_read_b64_tr_b16 a[96:97], v196 offset:0
    ds_read_b64_tr_b16 a[98:99], v196 offset:512
    ds_read_b64_tr_b16 a[100:101], v196 offset:4096
    ds_read_b64_tr_b16 a[102:103], v196 offset:4608
    ds_read_b64_tr_b16 a[104:105], v196 offset:8192
    ds_read_b64_tr_b16 a[106:107], v196 offset:8704
    ds_read_b64_tr_b16 a[108:109], v196 offset:12288
    ds_read_b64_tr_b16 a[110:111], v196 offset:12800
    s_waitcnt vmcnt(28)
    s_waitcnt lgkmcnt(0)
    s_barrier
    v_add_u32 v196, 49152, v195
    ds_read_b64_tr_b16 a[112:113], v196 offset:0
    ds_read_b64_tr_b16 a[114:115], v196 offset:512
    ds_read_b64_tr_b16 a[116:117], v196 offset:4096
    ds_read_b64_tr_b16 a[118:119], v196 offset:4608
    ds_read_b64_tr_b16 a[120:121], v196 offset:8192
    ds_read_b64_tr_b16 a[122:123], v196 offset:8704
    ds_read_b64_tr_b16 a[124:125], v196 offset:12288
    ds_read_b64_tr_b16 a[126:127], v196 offset:12800
    s_waitcnt vmcnt(24)
    s_waitcnt lgkmcnt(0)
    s_barrier
    v_add_u32 v196, 65536, v195
    ds_read_b64_tr_b16 a[128:129], v196 offset:0
    ds_read_b64_tr_b16 a[130:131], v196 offset:512
    ds_read_b64_tr_b16 a[132:133], v196 offset:4096
    ds_read_b64_tr_b16 a[134:135], v196 offset:4608
    ds_read_b64_tr_b16 a[136:137], v196 offset:8192
    ds_read_b64_tr_b16 a[138:139], v196 offset:8704
    ds_read_b64_tr_b16 a[140:141], v196 offset:12288
    ds_read_b64_tr_b16 a[142:143], v196 offset:12800
Lgchk_12:
    s_waitcnt vmcnt(16)
    v_min_u32 v214, v216, v218
    v_cmp_eq_u32 vcc, 0, v214
    s_cbranch_vccnz Lgrty_13
    s_waitcnt vmcnt(20)
    s_waitcnt lgkmcnt(0)
    s_barrier
    v_mul_u32_u24 v200, 1280, v84
    v_lshrrev_b32 v201, 4, v0
    v_lshl_add_u32 v200, v201, 5, v200
    v_lshl_add_u32 v200, v85, 2, v200
    buffer_load_dword v202, v200, s[28:31], 0 offen offset:0
    buffer_load_dword v203, v200, s[28:31], 0 offen offset:8
    buffer_load_dword v204, v200, s[28:31], 0 offen offset:16
    buffer_load_dword v205, v200, s[28:31], 0 offen offset:24
    buffer_load_dword v206, v200, s[28:31], 0 offen offset:512
    buffer_load_dword v207, v200, s[28:31], 0 offen offset:520
    buffer_load_dword v208, v200, s[28:31], 0 offen offset:528
    buffer_load_dword v209, v200, s[28:31], 0 offen offset:536
    buffer_load_dword v210, v200, s[28:31], 0 offen offset:1024
    buffer_load_dword v211, v200, s[28:31], 0 offen offset:1032
    buffer_load_dword v212, v200, s[28:31], 0 offen offset:1040
    buffer_load_dword v213, v200, s[28:31], 0 offen offset:1048
    s_cmp_eq_u32 s68, 0
    s_cbranch_scc1 Lt0_14
    s_waitcnt vmcnt(0)
    s_branch Lt0_15
Lt0_14:
    s_add_u32 m0, s73, 0
    s_add_u32 s94, s74, 0
    buffer_load_dwordx4 v234, s[4:7], s94 offen sc1 lds
    s_add_u32 m0, s73, 4096
    s_add_u32 s94, s74, 4096
    buffer_load_dwordx4 v234, s[4:7], s94 offen sc1 lds
    s_add_u32 m0, s73, 8192
    s_add_u32 s94, s74, 16384
    buffer_load_dwordx4 v234, s[4:7], s94 offen sc1 lds
    s_add_u32 m0, s73, 12288
    s_add_u32 s94, s74, 20480
    buffer_load_dwordx4 v234, s[4:7], s94 offen sc1 lds
    s_add_u32 m0, s73, 16384
    s_add_u32 s94, s74, 32768
    buffer_load_dwordx4 v234, s[4:7], s94 offen sc1 lds
    s_add_u32 m0, s73, 20480
    s_add_u32 s94, s74, 36864
    buffer_load_dwordx4 v234, s[4:7], s94 offen sc1 lds
    s_add_u32 m0, s73, 24576
    s_add_u32 s94, s74, 49152
    buffer_load_dwordx4 v234, s[4:7], s94 offen sc1 lds
    s_add_u32 m0, s73, 28672
    s_add_u32 s94, s74, 53248
    buffer_load_dwordx4 v234, s[4:7], s94 offen sc1 lds
    s_add_u32 m0, s73, 32768
    s_add_u32 s94, s74, 65536
    buffer_load_dwordx4 v234, s[4:7], s94 offen sc1 lds
    s_add_u32 m0, s73, 36864
    s_add_u32 s94, s74, 69632
    buffer_load_dwordx4 v234, s[4:7], s94 offen sc1 lds
Lt0_15:
    v_add_u32 v196, 81920, v195
    ds_read_b64_tr_b16 a[144:145], v196 offset:0
    ds_read_b64_tr_b16 a[146:147], v196 offset:512
    ds_read_b64_tr_b16 a[148:149], v196 offset:4096
    ds_read_b64_tr_b16 a[150:151], v196 offset:4608
    ds_read_b64_tr_b16 a[152:153], v196 offset:8192
    ds_read_b64_tr_b16 a[154:155], v196 offset:8704
    ds_read_b64_tr_b16 a[156:157], v196 offset:12288
    ds_read_b64_tr_b16 a[158:159], v196 offset:12800
    s_waitcnt vmcnt(38)
    s_waitcnt lgkmcnt(0)
    s_barrier
    v_add_u32 v196, 98304, v195
    ds_read_b64_tr_b16 a[160:161], v196 offset:0
    ds_read_b64_tr_b16 a[162:163], v196 offset:512
    ds_read_b64_tr_b16 a[164:165], v196 offset:4096
    ds_read_b64_tr_b16 a[166:167], v196 offset:4608
    ds_read_b64_tr_b16 a[168:169], v196 offset:8192
    ds_read_b64_tr_b16 a[170:171], v196 offset:8704
    ds_read_b64_tr_b16 a[172:173], v196 offset:12288
    ds_read_b64_tr_b16 a[174:175], v196 offset:12800
    s_waitcnt vmcnt(34)
    s_waitcnt lgkmcnt(0)
    s_barrier
    v_add_u32 v196, 114688, v195
    ds_read_b64_tr_b16 a[176:177], v196 offset:0
    ds_read_b64_tr_b16 a[178:179], v196 offset:512
    ds_read_b64_tr_b16 a[180:181], v196 offset:4096
    ds_read_b64_tr_b16 a[182:183], v196 offset:4608
    ds_read_b64_tr_b16 a[184:185], v196 offset:8192
    ds_read_b64_tr_b16 a[186:187], v196 offset:8704
    ds_read_b64_tr_b16 a[188:189], v196 offset:12288
    ds_read_b64_tr_b16 a[190:191], v196 offset:12800
    s_waitcnt vmcnt(30)
    s_waitcnt lgkmcnt(0)
    s_barrier
    v_add_u32 v196, 131072, v195
    ds_read_b64_tr_b16 a[192:193], v196 offset:0
    ds_read_b64_tr_b16 a[194:195], v196 offset:512
    ds_read_b64_tr_b16 a[196:197], v196 offset:4096
    ds_read_b64_tr_b16 a[198:199], v196 offset:4608
    ds_read_b64_tr_b16 a[200:201], v196 offset:8192
    ds_read_b64_tr_b16 a[202:203], v196 offset:8704
    ds_read_b64_tr_b16 a[204:205], v196 offset:12288
    ds_read_b64_tr_b16 a[206:207], v196 offset:12800
    s_waitcnt vmcnt(26)
    s_waitcnt lgkmcnt(0)
    s_barrier
    v_add_u32 v196, 147456, v195
    ds_read_b64_tr_b16 a[208:209], v196 offset:0
    ds_read_b64_tr_b16 a[210:211], v196 offset:512
    ds_read_b64_tr_b16 a[212:213], v196 offset:4096
    ds_read_b64_tr_b16 a[214:215], v196 offset:4608
    ds_read_b64_tr_b16 a[216:217], v196 offset:8192
    ds_read_b64_tr_b16 a[218:219], v196 offset:8704
    ds_read_b64_tr_b16 a[220:221], v196 offset:12288
    ds_read_b64_tr_b16 a[222:223], v196 offset:12800
    s_waitcnt vmcnt(22)
    s_waitcnt lgkmcnt(0)
    s_barrier
    v_add_u32 v196, 0, v195
    ds_read_b64_tr_b16 a[224:225], v196 offset:0
    ds_read_b64_tr_b16 a[226:227], v196 offset:512
    ds_read_b64_tr_b16 a[228:229], v196 offset:4096
    ds_read_b64_tr_b16 a[230:231], v196 offset:4608
    ds_read_b64_tr_b16 a[232:233], v196 offset:8192
    ds_read_b64_tr_b16 a[234:235], v196 offset:8704
    ds_read_b64_tr_b16 a[236:237], v196 offset:12288
    ds_read_b64_tr_b16 a[238:239], v196 offset:12800
    s_waitcnt lgkmcnt(0)
    s_barrier
    v_readfirstlane_b32 s1, v218
    s_cmp_gt_u32 s1, 17
    s_cselect_b32 s1, 1, 0
    s_xor_b32 s1, s1, s68
    s_lshl_b32 s1, s1, 13
    s_lshl_b32 s93, s68, 13
    s_xor_b32 s64, s1, 0x2000
    v_add_u32 v251, s64, v251
    s_lshr_b32 s74, s91, 8
    s_xor_b32 s74, s74, s1
    s_and_b32 s74, s74, s93
    s_or_b32 s74, s74, s91
    s_add_u32 s91, s91, 131072
    s_lshr_b32 s92, s91, 8
    s_xor_b32 s92, s92, s1
    s_and_b32 s92, s92, s93
    s_or_b32 s92, s92, s91
    v_and_b32 v252, 3, v0
    v_mov_b32 v88, 31
    v_lshl_add_u32 v252, v88, 2, v252
    v_lshlrev_b32 v252, 7, v252
    v_bfe_u32 v88, v0, 4, 2
    v_cmp_eq_u32 vcc, s69, v88
    s_xor_b32 s64, s1, 0x2000
    s_add_u32 s64, s64, 14798848
    v_lshl_add_u32 v88, v88, 18, s64
    v_add_u32 v252, v252, v88
    v_lshrrev_b32 v88, 2, v1
    v_and_b32 v88, 12, v88
    v_and_b32 v89, 3, v1
    v_add_u32 v88, v88, v89
    s_lshl_b32 s64, s58, 14
    s_add_u32 s64, s64, 8400896
    v_lshl_add_u32 v88, v88, 7, s64
    v_bfe_u32 v89, v1, 2, 1
    v_and_b32 v89, s68, v89
    v_cmp_eq_u32 vcc, 1, v89
    s_nop 1
    v_cndmask_b32 v252, v88, v252, vcc
    v_mov_b32 v88, -12
    v_cndmask_b32 v225, v88, 8, vcc
    v_mov_b32 v194, 0x80000000
    s_cmp_lt_u32 s59, 20
    s_cselect_b32 s87, -2, -1
    s_cselect_b64 vcc, -1, 0
    v_mov_b32 v192, -1
    v_cndmask_b32 v193, 0, 1, vcc
    v_cndmask_b32 v250, v194, v250, vcc
    v_cndmask_b32 v251, v194, v251, vcc
    s_cmp_eq_u32 s60, 2
    s_cselect_b64 vcc, -1, 0
    v_cndmask_b32 v252, v194, v252, vcc
    v_cmp_ne_u32 s[96:97], 0, v1
    s_nop 1
    v_cndmask_b32 v1, 0, v194, s[96:97]
    v_mov_b32 v194, -1000
    v_cndmask_b32 v225, v194, v225, vcc
    v_mov_b64 v[194:195], 0
    v_mov_b64 v[196:197], 0
    ds_write_b128 v234, v[194:197] offset:14336
    s_waitcnt vmcnt(18)
    ds_write_b128 v234, v[202:205] offset:0
    s_waitcnt vmcnt(14)
    ds_write_b128 v234, v[206:209] offset:4096
    s_waitcnt vmcnt(10)
    ds_write_b128 v234, v[210:213] offset:8192
    s_cmp_lg_u32 s60, 1
    s_cbranch_scc1 Lcnt_17
    s_mov_b64 exec, 1
    v_mov_b32 v216, 1
    buffer_atomic_add v216, off, s[8:11], 0 offset:68 sc0
    s_mov_b64 exec, -1
Lcnt_17:
    s_cmp_eq_u32 s68, 0
    s_cbranch_scc1 Lt0_16
    buffer_load_dword v2, v252, s[4:7], 0 offen sc1
    v_lshl_add_u32 v3, s62, 1, v225
    v_add_u32 v3, -6, v3
    v_min_i32 v3, 128, v3
Lfchk_18:
    s_waitcnt vmcnt(0)
    v_cmp_gt_i32 vcc, v3, v2
    s_cbranch_vccnz Lfrty_19
    s_waitcnt lgkmcnt(0)
    s_barrier
    s_add_u32 m0, s73, 0
    s_add_u32 s94, s74, 0
    buffer_load_dwordx4 v234, s[4:7], s94 offen sc1 lds
    s_add_u32 m0, s73, 4096
    s_add_u32 s94, s74, 4096
    buffer_load_dwordx4 v234, s[4:7], s94 offen sc1 lds
    s_add_u32 m0, s73, 8192
    s_add_u32 s94, s74, 16384
    buffer_load_dwordx4 v234, s[4:7], s94 offen sc1 lds
    s_add_u32 m0, s73, 12288
    s_add_u32 s94, s74, 20480
    buffer_load_dwordx4 v234, s[4:7], s94 offen sc1 lds
    s_add_u32 m0, s73, 16384
    s_add_u32 s94, s74, 32768
    buffer_load_dwordx4 v234, s[4:7], s94 offen sc1 lds
    s_add_u32 m0, s73, 20480
    s_add_u32 s94, s74, 36864
    buffer_load_dwordx4 v234, s[4:7], s94 offen sc1 lds
    s_add_u32 m0, s73, 24576
    s_add_u32 s94, s74, 49152
    buffer_load_dwordx4 v234, s[4:7], s94 offen sc1 lds
    s_add_u32 m0, s73, 28672
    s_add_u32 s94, s74, 53248
    buffer_load_dwordx4 v234, s[4:7], s94 offen sc1 lds
    s_add_u32 m0, s73, 32768
    s_add_u32 s94, s74, 65536
    buffer_load_dwordx4 v234, s[4:7], s94 offen sc1 lds
    s_add_u32 m0, s73, 36864
    s_add_u32 s94, s74, 69632
    buffer_load_dwordx4 v234, s[4:7], s94 offen sc1 lds
    s_waitcnt vmcnt(0)
Lt0_16:
    s_cmp_lg_u32 s60, 1
    s_cbranch_scc1 Lt0_16a
    s_waitcnt vmcnt(1)
    s_branch Lt0_16b
Lt0_16a:
    s_waitcnt vmcnt(0)
Lt0_16b:
    s_waitcnt lgkmcnt(0)
    s_barrier
    ds_read_b128 v[124:127], v232 offset:0
    ds_read_b128 v[128:131], v232 offset:20480
    ds_read_b128 v[132:135], v233 offset:0
    ds_read_b128 v[136:139], v233 offset:20480
    ds_read_b128 v[140:143], v232 offset:1024
    s_mov_b32 s74, s92
    s_xor_b32 s73, s73, 65536
    s_add_u32 s91, s91, 131072
    s_lshr_b32 s92, s91, 8
    s_xor_b32 s92, s92, s1
    s_and_b32 s92, s92, s93
    s_or_b32 s92, s92, s91
    s_cmp_lg_u32 s68, 0
    s_cbranch_scc1 Lt0_16c
    s_add_u32 m0, s73, 0
    s_add_u32 s94, s74, 0
    buffer_load_dwordx4 v234, s[4:7], s94 offen sc1 lds
    s_add_u32 m0, s73, 4096
    s_add_u32 s94, s74, 4096
    buffer_load_dwordx4 v234, s[4:7], s94 offen sc1 lds
    s_add_u32 m0, s73, 8192
    s_add_u32 s94, s74, 16384
    buffer_load_dwordx4 v234, s[4:7], s94 offen sc1 lds
    s_add_u32 m0, s73, 12288
    s_add_u32 s94, s74, 20480
    buffer_load_dwordx4 v234, s[4:7], s94 offen sc1 lds
    s_add_u32 m0, s73, 16384
    s_add_u32 s94, s74, 32768
    buffer_load_dwordx4 v234, s[4:7], s94 offen sc1 lds
    s_add_u32 m0, s73, 20480
    s_add_u32 s94, s74, 36864
    buffer_load_dwordx4 v234, s[4:7], s94 offen sc1 lds
    s_add_u32 m0, s73, 24576
    s_add_u32 s94, s74, 49152
    buffer_load_dwordx4 v234, s[4:7], s94 offen sc1 lds
    s_add_u32 m0, s73, 28672
    s_add_u32 s94, s74, 53248
    buffer_load_dwordx4 v234, s[4:7], s94 offen sc1 lds
    s_add_u32 m0, s73, 32768
    s_add_u32 s94, s74, 65536
    buffer_load_dwordx4 v234, s[4:7], s94 offen sc1 lds
    s_add_u32 m0, s73, 36864
    s_add_u32 s94, s74, 69632
    buffer_load_dwordx4 v234, s[4:7], s94 offen sc1 lds
Lt0_16c:
    s_waitcnt lgkmcnt(4)
    v_mfma_f32_16x16x32_bf16 v[148:151], a[0:3], v[124:127], 0
    ds_read_b128 v[144:147], v232 offset:21504
    v_mov_b64 v[194:195], 0
    v_mfma_f32_16x16x32_bf16 v[156:159], a[80:83], v[124:127], 0
    v_mov_b64 v[196:197], 0
    v_mov_b64 v[198:199], 0
    v_mfma_f32_16x16x32_bf16 v[164:167], v[124:127], a[160:163], 0
    s_waitcnt lgkmcnt(4)
    v_mov_b64 v[200:201], 0
    v_mov_b64 v[202:203], 0
    v_mfma_f32_16x16x32_bf16 v[152:155], a[0:3], v[128:131], 0
    ds_read_b128 v[124:127], v233 offset:1024
    v_mov_b64 v[204:205], 0
    v_mfma_f32_16x16x32_bf16 v[160:163], a[80:83], v[128:131], 0
    v_mfma_f32_16x16x32_bf16 v[168:171], v[128:131], a[160:163], 0
    s_waitcnt lgkmcnt(4)
    v_mfma_f32_16x16x32_bf16 v[148:151], a[4:7], v[132:135], v[148:151]
    ds_read_b128 v[128:131], v233 offset:21504
    v_mfma_f32_16x16x32_bf16 v[156:159], a[84:87], v[132:135], v[156:159]
    v_mfma_f32_16x16x32_bf16 v[164:167], v[132:135], a[164:167], v[164:167]
    s_waitcnt lgkmcnt(4)
    v_mfma_f32_16x16x32_bf16 v[152:155], a[4:7], v[136:139], v[152:155]
    ds_read_b128 v[132:135], v232 offset:2048
    v_mfma_f32_16x16x32_bf16 v[160:163], a[84:87], v[136:139], v[160:163]
    v_mfma_f32_16x16x32_bf16 v[168:171], v[136:139], a[164:167], v[168:171]
    s_waitcnt lgkmcnt(4)
    v_mfma_f32_16x16x32_bf16 v[148:151], a[8:11], v[140:143], v[148:151]
    ds_read_b128 v[136:139], v232 offset:22528
    v_mfma_f32_16x16x32_bf16 v[156:159], a[88:91], v[140:143], v[156:159]
    v_mfma_f32_16x16x32_bf16 v[164:167], v[140:143], a[168:171], v[164:167]
    s_waitcnt lgkmcnt(4)
    v_mfma_f32_16x16x32_bf16 v[152:155], a[8:11], v[144:147], v[152:155]
    ds_read_b128 v[140:143], v233 offset:2048
    v_mfma_f32_16x16x32_bf16 v[160:163], a[88:91], v[144:147], v[160:163]
    v_mfma_f32_16x16x32_bf16 v[168:171], v[144:147], a[168:171], v[168:171]
    s_waitcnt lgkmcnt(4)
    v_mfma_f32_16x16x32_bf16 v[148:151], a[12:15], v[124:127], v[148:151]
    ds_read_b128 v[144:147], v233 offset:22528
    v_mfma_f32_16x16x32_bf16 v[156:159], a[92:95], v[124:127], v[156:159]
    v_mfma_f32_16x16x32_bf16 v[164:167], v[124:127], a[172:175], v[164:167]
    s_waitcnt lgkmcnt(4)
    v_mfma_f32_16x16x32_bf16 v[152:155], a[12:15], v[128:131], v[152:155]
    ds_read_b128 v[124:127], v232 offset:3072
    v_mfma_f32_16x16x32_bf16 v[160:163], a[92:95], v[128:131], v[160:163]
    v_mfma_f32_16x16x32_bf16 v[168:171], v[128:131], a[172:175], v[168:171]
    s_waitcnt lgkmcnt(4)
    v_mfma_f32_16x16x32_bf16 v[148:151], a[16:19], v[132:135], v[148:151]
    ds_read_b128 v[128:131], v232 offset:23552
    v_mfma_f32_16x16x32_bf16 v[156:159], a[96:99], v[132:135], v[156:159]
    v_mfma_f32_16x16x32_bf16 v[164:167], v[132:135], a[176:179], v[164:167]
    s_waitcnt lgkmcnt(4)
    v_mfma_f32_16x16x32_bf16 v[152:155], a[16:19], v[136:139], v[152:155]
    ds_read_b128 v[132:135], v233 offset:3072
    v_mfma_f32_16x16x32_bf16 v[160:163], a[96:99], v[136:139], v[160:163]
    v_mfma_f32_16x16x32_bf16 v[168:171], v[136:139], a[176:179], v[168:171]
    s_waitcnt lgkmcnt(4)
    v_mfma_f32_16x16x32_bf16 v[148:151], a[20:23], v[140:143], v[148:151]
    ds_read_b128 v[136:139], v233 offset:23552
    v_mfma_f32_16x16x32_bf16 v[156:159], a[100:103], v[140:143], v[156:159]
    v_mfma_f32_16x16x32_bf16 v[164:167], v[140:143], a[180:183], v[164:167]
    s_waitcnt lgkmcnt(4)
    v_mfma_f32_16x16x32_bf16 v[152:155], a[20:23], v[144:147], v[152:155]
    ds_read_b128 v[140:143], v232 offset:4096
    v_mfma_f32_16x16x32_bf16 v[160:163], a[100:103], v[144:147], v[160:163]
    v_mfma_f32_16x16x32_bf16 v[168:171], v[144:147], a[180:183], v[168:171]
    s_waitcnt lgkmcnt(4)
    v_mfma_f32_16x16x32_bf16 v[148:151], a[24:27], v[124:127], v[148:151]
    ds_read_b128 v[144:147], v232 offset:24576
    v_mfma_f32_16x16x32_bf16 v[156:159], a[104:107], v[124:127], v[156:159]
    v_mfma_f32_16x16x32_bf16 v[164:167], v[124:127], a[184:187], v[164:167]
    s_waitcnt lgkmcnt(4)
    v_mfma_f32_16x16x32_bf16 v[152:155], a[24:27], v[128:131], v[152:155]
    ds_read_b128 v[124:127], v233 offset:4096
    v_mfma_f32_16x16x32_bf16 v[160:163], a[104:107], v[128:131], v[160:163]
    v_mfma_f32_16x16x32_bf16 v[168:171], v[128:131], a[184:187], v[168:171]
    s_waitcnt lgkmcnt(4)
    v_mfma_f32_16x16x32_bf16 v[148:151], a[28:31], v[132:135], v[148:151]
    ds_read_b128 v[128:131], v233 offset:24576
    v_mfma_f32_16x16x32_bf16 v[156:159], a[108:111], v[132:135], v[156:159]
    v_mfma_f32_16x16x32_bf16 v[164:167], v[132:135], a[188:191], v[164:167]
    s_waitcnt lgkmcnt(4)
    v_mfma_f32_16x16x32_bf16 v[152:155], a[28:31], v[136:139], v[152:155]
    ds_read_b128 v[132:135], v232 offset:5120
    v_mfma_f32_16x16x32_bf16 v[160:163], a[108:111], v[136:139], v[160:163]
    v_mfma_f32_16x16x32_bf16 v[168:171], v[136:139], a[188:191], v[168:171]
    s_waitcnt lgkmcnt(4)
    v_mfma_f32_16x16x32_bf16 v[148:151], a[32:35], v[140:143], v[148:151]
    ds_read_b128 v[136:139], v232 offset:25600
    v_mfma_f32_16x16x32_bf16 v[156:159], a[112:115], v[140:143], v[156:159]
    v_mfma_f32_16x16x32_bf16 v[164:167], v[140:143], a[192:195], v[164:167]
    s_waitcnt lgkmcnt(4)
    v_mfma_f32_16x16x32_bf16 v[152:155], a[32:35], v[144:147], v[152:155]
    ds_read_b128 v[140:143], v233 offset:5120
    v_mfma_f32_16x16x32_bf16 v[160:163], a[112:115], v[144:147], v[160:163]
    v_mfma_f32_16x16x32_bf16 v[168:171], v[144:147], a[192:195], v[168:171]
    s_waitcnt lgkmcnt(4)
    v_mfma_f32_16x16x32_bf16 v[148:151], a[36:39], v[124:127], v[148:151]
    ds_read_b128 v[144:147], v233 offset:25600
    v_mfma_f32_16x16x32_bf16 v[156:159], a[116:119], v[124:127], v[156:159]
    v_mfma_f32_16x16x32_bf16 v[164:167], v[124:127], a[196:199], v[164:167]
    s_waitcnt lgkmcnt(4)
    v_mfma_f32_16x16x32_bf16 v[152:155], a[36:39], v[128:131], v[152:155]
    ds_read_b128 v[124:127], v232 offset:6144
    v_mfma_f32_16x16x32_bf16 v[160:163], a[116:119], v[128:131], v[160:163]
    v_mfma_f32_16x16x32_bf16 v[168:171], v[128:131], a[196:199], v[168:171]
    s_waitcnt lgkmcnt(4)
    v_mfma_f32_16x16x32_bf16 v[148:151], a[40:43], v[132:135], v[148:151]
    ds_read_b128 v[128:131], v232 offset:26624
    v_mfma_f32_16x16x32_bf16 v[156:159], a[120:123], v[132:135], v[156:159]
    v_mfma_f32_16x16x32_bf16 v[164:167], v[132:135], a[200:203], v[164:167]
    s_waitcnt lgkmcnt(4)
    v_mfma_f32_16x16x32_bf16 v[152:155], a[40:43], v[136:139], v[152:155]
    ds_read_b128 v[132:135], v233 offset:6144
    v_mfma_f32_16x16x32_bf16 v[160:163], a[120:123], v[136:139], v[160:163]
    v_mfma_f32_16x16x32_bf16 v[168:171], v[136:139], a[200:203], v[168:171]
    s_waitcnt lgkmcnt(4)
    v_mfma_f32_16x16x32_bf16 v[148:151], a[44:47], v[140:143], v[148:151]
    ds_read_b128 v[136:139], v233 offset:26624
    v_mfma_f32_16x16x32_bf16 v[156:159], a[124:127], v[140:143], v[156:159]
    v_mfma_f32_16x16x32_bf16 v[164:167], v[140:143], a[204:207], v[164:167]
    s_waitcnt lgkmcnt(4)
    v_mfma_f32_16x16x32_bf16 v[152:155], a[44:47], v[144:147], v[152:155]
    ds_read_b128 v[140:143], v232 offset:7168
    v_mfma_f32_16x16x32_bf16 v[160:163], a[124:127], v[144:147], v[160:163]
    v_mfma_f32_16x16x32_bf16 v[168:171], v[144:147], a[204:207], v[168:171]
    s_waitcnt lgkmcnt(4)
    v_mfma_f32_16x16x32_bf16 v[148:151], a[48:51], v[124:127], v[148:151]
    ds_read_b128 v[144:147], v232 offset:27648
    v_mfma_f32_16x16x32_bf16 v[156:159], a[128:131], v[124:127], v[156:159]
    v_mfma_f32_16x16x32_bf16 v[164:167], v[124:127], a[208:211], v[164:167]
    s_waitcnt lgkmcnt(4)
    v_mfma_f32_16x16x32_bf16 v[152:155], a[48:51], v[128:131], v[152:155]
    ds_read_b128 v[124:127], v233 offset:7168
    v_mfma_f32_16x16x32_bf16 v[160:163], a[128:131], v[128:131], v[160:163]
    v_mfma_f32_16x16x32_bf16 v[168:171], v[128:131], a[208:211], v[168:171]
    s_waitcnt lgkmcnt(4)
    v_mfma_f32_16x16x32_bf16 v[148:151], a[52:55], v[132:135], v[148:151]
    ds_read_b128 v[128:131], v233 offset:27648
    v_mfma_f32_16x16x32_bf16 v[156:159], a[132:135], v[132:135], v[156:159]
    v_mfma_f32_16x16x32_bf16 v[164:167], v[132:135], a[212:215], v[164:167]
    s_waitcnt lgkmcnt(4)
    v_mfma_f32_16x16x32_bf16 v[152:155], a[52:55], v[136:139], v[152:155]
    ds_read_b128 v[132:135], v232 offset:8192
    v_mfma_f32_16x16x32_bf16 v[160:163], a[132:135], v[136:139], v[160:163]
    v_mfma_f32_16x16x32_bf16 v[168:171], v[136:139], a[212:215], v[168:171]
    s_waitcnt lgkmcnt(4)
    v_mfma_f32_16x16x32_bf16 v[148:151], a[56:59], v[140:143], v[148:151]
    ds_read_b128 v[136:139], v232 offset:28672
    v_mfma_f32_16x16x32_bf16 v[156:159], a[136:139], v[140:143], v[156:159]
    v_mfma_f32_16x16x32_bf16 v[164:167], v[140:143], a[216:219], v[164:167]
    s_waitcnt lgkmcnt(4)
    v_mfma_f32_16x16x32_bf16 v[152:155], a[56:59], v[144:147], v[152:155]
    ds_read_b128 v[140:143], v233 offset:8192
    v_mfma_f32_16x16x32_bf16 v[160:163], a[136:139], v[144:147], v[160:163]
    v_mfma_f32_16x16x32_bf16 v[168:171], v[144:147], a[216:219], v[168:171]
    s_waitcnt lgkmcnt(4)
    v_mfma_f32_16x16x32_bf16 v[148:151], a[60:63], v[124:127], v[148:151]
    ds_read_b128 v[144:147], v233 offset:28672
    v_mfma_f32_16x16x32_bf16 v[156:159], a[140:143], v[124:127], v[156:159]
    v_mfma_f32_16x16x32_bf16 v[164:167], v[124:127], a[220:223], v[164:167]
    s_waitcnt lgkmcnt(4)
    v_mfma_f32_16x16x32_bf16 v[152:155], a[60:63], v[128:131], v[152:155]
    ds_read_b128 v[124:127], v232 offset:9216
    v_mfma_f32_16x16x32_bf16 v[160:163], a[140:143], v[128:131], v[160:163]
    v_mfma_f32_16x16x32_bf16 v[168:171], v[128:131], a[220:223], v[168:171]
    s_waitcnt lgkmcnt(4)
    v_mfma_f32_16x16x32_bf16 v[148:151], a[64:67], v[132:135], v[148:151]
    ds_read_b128 v[128:131], v232 offset:29696
    v_mfma_f32_16x16x32_bf16 v[156:159], a[144:147], v[132:135], v[156:159]
    v_mfma_f32_16x16x32_bf16 v[164:167], v[132:135], a[224:227], v[164:167]
    s_waitcnt lgkmcnt(4)
    v_mfma_f32_16x16x32_bf16 v[152:155], a[64:67], v[136:139], v[152:155]
    ds_read_b128 v[132:135], v233 offset:9216
    v_mfma_f32_16x16x32_bf16 v[160:163], a[144:147], v[136:139], v[160:163]
    v_mfma_f32_16x16x32_bf16 v[168:171], v[136:139], a[224:227], v[168:171]
    s_waitcnt lgkmcnt(4)
    v_mfma_f32_16x16x32_bf16 v[148:151], a[68:71], v[140:143], v[148:151]
    ds_read_b128 v[136:139], v233 offset:29696
    v_mfma_f32_16x16x32_bf16 v[156:159], a[148:151], v[140:143], v[156:159]
    v_mfma_f32_16x16x32_bf16 v[164:167], v[140:143], a[228:231], v[164:167]
    s_waitcnt lgkmcnt(4)
    v_mfma_f32_16x16x32_bf16 v[152:155], a[68:71], v[144:147], v[152:155]
    v_mfma_f32_16x16x32_bf16 v[160:163], a[148:151], v[144:147], v[160:163]
    v_mfma_f32_16x16x32_bf16 v[168:171], v[144:147], a[228:231], v[168:171]
    s_waitcnt lgkmcnt(3)
    v_mfma_f32_16x16x32_bf16 v[148:151], a[72:75], v[124:127], v[148:151]
    v_mfma_f32_16x16x32_bf16 v[156:159], a[152:155], v[124:127], v[156:159]
    v_mfma_f32_16x16x32_bf16 v[164:167], v[124:127], a[232:235], v[164:167]
    s_waitcnt lgkmcnt(2)
    v_mfma_f32_16x16x32_bf16 v[152:155], a[72:75], v[128:131], v[152:155]
    v_mfma_f32_16x16x32_bf16 v[160:163], a[152:155], v[128:131], v[160:163]
    v_mfma_f32_16x16x32_bf16 v[168:171], v[128:131], a[232:235], v[168:171]
    s_waitcnt lgkmcnt(1)
    v_mfma_f32_16x16x32_bf16 v[148:151], a[76:79], v[132:135], v[148:151]
    v_mfma_f32_16x16x32_bf16 v[156:159], a[156:159], v[132:135], v[156:159]
    v_mfma_f32_16x16x32_bf16 v[164:167], v[132:135], a[236:239], v[164:167]
    s_waitcnt lgkmcnt(0)
    v_mfma_f32_16x16x32_bf16 v[152:155], a[76:79], v[136:139], v[152:155]
    v_mfma_f32_16x16x32_bf16 v[160:163], a[156:159], v[136:139], v[160:163]
    v_mfma_f32_16x16x32_bf16 v[168:171], v[136:139], a[236:239], v[168:171]
    v_xor_b32 v232, 0x10000, v232
    v_xor_b32 v233, 0x10000, v233
    v_cvt_pk_bf16_f32 v148, v148, v149
    v_cvt_pk_bf16_f32 v149, v150, v151
    ds_write_b64 v243, v[148:149] offset:22528
    s_nop 0
    v_cvt_pk_bf16_f32 v152, v152, v153
    v_cvt_pk_bf16_f32 v153, v154, v155
    ds_write_b64 v243, v[152:153] offset:24576
    v_cvt_pk_bf16_f32 v156, v156, v157
    v_cvt_pk_bf16_f32 v157, v158, v159
    ds_write_b64 v243, v[156:157] offset:26624
    v_cvt_pk_bf16_f32 v160, v160, v161
    v_cvt_pk_bf16_f32 v161, v162, v163
    ds_write_b64 v243, v[160:161] offset:28672
    v_cvt_pk_bf16_f32 v172, v164, v165
    v_cvt_pk_bf16_f32 v173, v166, v167
    v_cvt_pk_bf16_f32 v176, v168, v169
    v_cvt_pk_bf16_f32 v177, v170, v171
    s_cmp_eq_u32 s68, 0
    s_cbranch_scc1 Lt0_16d
    buffer_load_dword v2, v252, s[4:7], 0 offen sc1
    v_lshl_add_u32 v3, s62, 1, v225
    v_add_u32 v3, -4, v3
    v_min_i32 v3, 128, v3
Lfchk_20:
    s_waitcnt vmcnt(0)
    v_cmp_gt_i32 vcc, v3, v2
    s_cbranch_vccnz Lfrty_21
    s_waitcnt lgkmcnt(0)
    s_barrier
    s_add_u32 m0, s73, 0
    s_add_u32 s94, s74, 0
    buffer_load_dwordx4 v234, s[4:7], s94 offen sc1 lds
    s_add_u32 m0, s73, 4096
    s_add_u32 s94, s74, 4096
    buffer_load_dwordx4 v234, s[4:7], s94 offen sc1 lds
    s_add_u32 m0, s73, 8192
    s_add_u32 s94, s74, 16384
    buffer_load_dwordx4 v234, s[4:7], s94 offen sc1 lds
    s_add_u32 m0, s73, 12288
    s_add_u32 s94, s74, 20480
    buffer_load_dwordx4 v234, s[4:7], s94 offen sc1 lds
    s_add_u32 m0, s73, 16384
    s_add_u32 s94, s74, 32768
    buffer_load_dwordx4 v234, s[4:7], s94 offen sc1 lds
    s_add_u32 m0, s73, 20480
    s_add_u32 s94, s74, 36864
    buffer_load_dwordx4 v234, s[4:7], s94 offen sc1 lds
    s_add_u32 m0, s73, 24576
    s_add_u32 s94, s74, 49152
    buffer_load_dwordx4 v234, s[4:7], s94 offen sc1 lds
    s_add_u32 m0, s73, 28672
    s_add_u32 s94, s74, 53248
    buffer_load_dwordx4 v234, s[4:7], s94 offen sc1 lds
    s_add_u32 m0, s73, 32768
    s_add_u32 s94, s74, 65536
    buffer_load_dwordx4 v234, s[4:7], s94 offen sc1 lds
    s_add_u32 m0, s73, 36864
    s_add_u32 s94, s74, 69632
    buffer_load_dwordx4 v234, s[4:7], s94 offen sc1 lds
Lt0_16d:
    s_mov_b32 s74, s92
    s_xor_b32 s73, s73, 65536
    s_add_u32 s91, s91, 131072
    s_lshr_b32 s92, s91, 8
    s_xor_b32 s92, s92, s1
    s_and_b32 s92, s92, s93
    s_or_b32 s92, s92, s91
    s_lshl_b32 s72, s58, 20
    buffer_load_dword v2, v252, s[4:7], 0 offen sc1
    s_waitcnt vmcnt(0) lgkmcnt(0)
    v_lshl_add_u32 v3, s62, 1, v225
    v_add_u32 v3, -2, v3
    v_min_i32 v3, 128, v3
Lfchk_22:
    v_cmp_gt_i32 vcc, v3, v2
    s_cbranch_vccnz Lfrty_23
    s_cmp_lg_u32 s60, 1
    s_cbranch_scc1 Lcnt_24
    s_mov_b64 exec, 1
    v_mov_b32 v217, 0x80000000
    v_cmp_ne_u32 vcc, 95, v216
    s_nop 1
    v_cndmask_b32 v217, 8, v217, vcc
    buffer_store_dword v216, v217, s[8:11], 0 offen offset:128 sc1
    s_mov_b64 exec, -1
Lcnt_24:
    s_add_u32 s64, s60, 0
    s_lshl_b32 s24, s64, 12
    s_and_b32 s64, s24, 0xe000
    s_add_u32 s24, s24, s64
    s_add_u32 s64, s60, 3
    s_lshl_b32 s25, s64, 12
    s_and_b32 s64, s25, 0xe000
    s_add_u32 s25, s25, s64
    s_add_u32 s64, s60, 6
    s_lshl_b32 s26, s64, 12
    s_and_b32 s64, s26, 0xe000
    s_add_u32 s26, s26, s64
    s_mul_i32 s27, s60, 3072
    s_add_u32 s27, s27, s73
    s_cmp_eq_u32 s60, 3
    s_cbranch_scc1 L_Cin3
    s_branch L_Cin0
Lgrty_6:
    s_sleep 16
    buffer_load_dword v2, off, s[8:11], 0 offset:136 sc1
    s_sub_u32 s61, s61, 1
    s_mov_b32 s67, 4
    s_cbranch_scc1 L_fail
    s_branch Lgchk_5
Lgrty_13:
    s_sleep 8
    buffer_load_dwordx3 v[216:218], off, s[8:11], 0 offset:132 sc1
    s_sub_u32 s61, s61, 1
    s_mov_b32 s67, 1
    s_cbranch_scc1 L_fail
    s_waitcnt vmcnt(0)
    s_branch Lgchk_12
Lfrty_19:
    s_sleep 2
    buffer_load_dword v2, v252, s[4:7], 0 offen sc1
    s_sub_u32 s61, s61, 1
    s_mov_b32 s67, 10
    s_cbranch_scc1 L_fail
    s_waitcnt vmcnt(0)
    s_branch Lfchk_18
Lfrty_21:
    s_sleep 2
    buffer_load_dword v2, v252, s[4:7], 0 offen sc1
    s_sub_u32 s61, s61, 1
    s_mov_b32 s67, 10
    s_cbranch_scc1 L_fail
    s_waitcnt vmcnt(0)
    s_branch Lfchk_20
Lfrty_23:
    s_sleep 2
    buffer_load_dword v2, v252, s[4:7], 0 offen sc1
    s_sub_u32 s61, s61, 1
    s_mov_b32 s67, 10
    s_cbranch_scc1 L_fail
    s_waitcnt vmcnt(0)
    s_branch Lfchk_22
L_Ctop3:
    s_waitcnt vmcnt(1)
    v_max3_u32 v218, v206, v208, v214
    s_waitcnt vmcnt(0)
    v_max3_u32 v218, v218, v216, v210
    v_cmp_lt_u32 vcc, -2, v218
    s_cbranch_vccnz Lrty_26
    ds_write_b128 v234, v[206:209] offset:0
    ds_write_b128 v234, v[214:217] offset:4096
    ds_write_b64 v235, v[210:211] offset:0
Lok_25:
L_Cin3:
    s_waitcnt lgkmcnt(0)
    s_barrier
    ds_read_b128 v[84:87], v236 offset:0
    ds_read_b128 v[88:91], v236 offset:1024
    ds_read_b128 v[92:95], v236 offset:2048
    ds_read_b128 v[96:99], v236 offset:3072
    s_waitcnt lgkmcnt(3)
    v_smfmac_f32_16x16x64_bf16 v[194:197], v[84:87], a[0:7], v187
    s_add_u32 m0, s73, 0
    ds_read_b128 v[100:103], v236 offset:4096
    s_add_u32 s94, s74, 0
    v_smfmac_f32_16x16x64_bf16 v[198:201], v[84:87], a[80:87], v187
    s_waitcnt lgkmcnt(3)
    ds_read_b128 v[104:107], v236 offset:5120
    buffer_load_dwordx4 v234, s[4:7], s94 offen sc1 lds
    v_smfmac_f32_16x16x64_bf16 v[194:197], v[88:91], a[8:15], v187
    s_andn2_b32 s71, s72, 524288
    ds_read_b128 v[108:111], v236 offset:6144
    s_lshr_b32 s97, s62, 1
    v_smfmac_f32_16x16x64_bf16 v[198:201], v[88:91], a[88:95], v187
    s_waitcnt lgkmcnt(4)
    ds_read_b128 v[112:115], v236 offset:7168
    s_add_u32 m0, s73, 4096
    v_smfmac_f32_16x16x64_bf16 v[194:197], v[92:95], a[16:23], v187
    s_add_u32 s94, s74, 4096
    ds_read_b128 v[116:119], v236 offset:8192
    buffer_load_dwordx4 v234, s[4:7], s94 offen sc1 lds
    v_smfmac_f32_16x16x64_bf16 v[198:201], v[92:95], a[96:103], v187
    s_waitcnt lgkmcnt(5)
    ds_read_b128 v[120:123], v236 offset:9216
    s_add_u32 s79, s71, s76
    v_smfmac_f32_16x16x64_bf16 v[194:197], v[96:99], a[24:31], v187
    s_add_u32 m0, s73, 8192
    s_add_u32 s94, s74, 16384
    buffer_load_dwordx4 v234, s[4:7], s94 offen sc1 lds
    v_smfmac_f32_16x16x64_bf16 v[198:201], v[96:99], a[104:111], v187
    s_waitcnt lgkmcnt(5)
    s_add_u32 s80, s71, s77
    s_add_u32 s81, s71, s78
    v_smfmac_f32_16x16x64_bf16 v[194:197], v[100:103], a[32:39], v187
    s_cmp_lt_u32 s59, 20
    s_cselect_b32 s85, s72, s92
    s_add_u32 s86, s85, s89
    v_smfmac_f32_16x16x64_bf16 v[198:201], v[100:103], a[112:119], v187
    s_waitcnt lgkmcnt(4)
    s_xor_b32 s96, s72, 524288
    s_lshr_b32 s88, s71, 2
    v_smfmac_f32_16x16x64_bf16 v[194:197], v[104:107], a[40:47], v187
    s_and_b32 s88, s88, 0xf0000
    s_xor_b32 s82, s88, 262144
    s_xor_b32 s83, s88, 524288
    v_smfmac_f32_16x16x64_bf16 v[198:201], v[104:107], a[120:127], v187
    s_waitcnt lgkmcnt(3)
    s_xor_b32 s84, s88, 786432
    v_smfmac_f32_16x16x64_bf16 v[194:197], v[108:111], a[48:55], v187
    v_smfmac_f32_16x16x64_bf16 v[198:201], v[108:111], a[128:135], v187
    s_waitcnt lgkmcnt(2)
    v_smfmac_f32_16x16x64_bf16 v[194:197], v[112:115], a[56:63], v187
    v_smfmac_f32_16x16x64_bf16 v[198:201], v[112:115], a[136:143], v187
    s_waitcnt lgkmcnt(1)
    v_smfmac_f32_16x16x64_bf16 v[194:197], v[116:119], a[64:71], v187
    v_smfmac_f32_16x16x64_bf16 v[198:201], v[116:119], a[144:151], v187
    s_waitcnt lgkmcnt(0)
    v_smfmac_f32_16x16x64_bf16 v[194:197], v[120:123], a[72:79], v187
    v_smfmac_f32_16x16x64_bf16 v[198:201], v[120:123], a[152:159], v187
    s_nop 2
    v_smfmac_f32_16x16x64_bf16 v[202:205], v[84:87], a[160:167], v187
    s_nop 3
    v_permlane32_swap_b32 v194, v198
    v_permlane32_swap_b32 v195, v199
    v_permlane32_swap_b32 v196, v200
    v_permlane32_swap_b32 v197, v201
    v_pk_add_f32 v[194:195], v[194:195], v[198:199]
    v_pk_add_f32 v[196:197], v[196:197], v[200:201]
    v_cvt_pk_bf16_f32 v194, v194, v195
    v_cvt_pk_bf16_f32 v195, v196, v197
    ds_write_b64 v241, v[194:195] offset:12288
    v_smfmac_f32_16x16x64_bf16 v[202:205], v[88:91], a[168:175], v187
    s_add_u32 m0, s73, 12288
    s_add_u32 s94, s74, 20480
    buffer_load_dwordx4 v234, s[4:7], s94 offen sc1 lds
    v_smfmac_f32_16x16x64_bf16 v[202:205], v[92:95], a[176:183], v187
    v_smfmac_f32_16x16x64_bf16 v[202:205], v[96:99], a[184:191], v187
    s_add_u32 m0, s73, 16384
    s_add_u32 s94, s74, 32768
    buffer_load_dwordx4 v234, s[4:7], s94 offen sc1 lds
    v_smfmac_f32_16x16x64_bf16 v[202:205], v[100:103], a[192:199], v187
    v_smfmac_f32_16x16x64_bf16 v[202:205], v[104:107], a[200:207], v187
    s_add_u32 m0, s73, 20480
    s_add_u32 s94, s74, 36864
    buffer_load_dwordx4 v234, s[4:7], s94 offen sc1 lds
    s_waitcnt lgkmcnt(0)
    s_barrier
    ds_read_b64_tr_b16 v[124:125], v242 offset:12288
    ds_read_b64_tr_b16 v[126:127], v242 offset:12352
    ds_read_b64_tr_b16 v[132:133], v242 offset:13312
    ds_read_b64_tr_b16 v[134:135], v242 offset:13376
    v_smfmac_f32_16x16x64_bf16 v[202:205], v[108:111], a[208:215], v187
    ds_read_b128 v[148:151], v236 offset:26624
    ds_read_b128 v[156:159], v236 offset:28672
    v_smfmac_f32_16x16x64_bf16 v[202:205], v[112:115], a[216:223], v187
    ds_read_b64_tr_b16 v[128:129], v242 offset:12800
    ds_read_b64_tr_b16 v[130:131], v242 offset:12864
    v_smfmac_f32_16x16x64_bf16 v[202:205], v[116:119], a[224:231], v187
    ds_read_b64_tr_b16 v[136:137], v242 offset:13824
    ds_read_b64_tr_b16 v[138:139], v242 offset:13888
    v_smfmac_f32_16x16x64_bf16 v[202:205], v[120:123], a[232:239], v187
    ds_read_b128 v[152:155], v236 offset:27648
    ds_read_b128 v[160:163], v236 offset:29696
    s_waitcnt lgkmcnt(8)
    v_mfma_f32_16x16x32_bf16 v[214:217], v[132:135], v[124:127], 0
    s_waitcnt lgkmcnt(7)
    ds_read_b128 v[164:167], v244 offset:22528
    v_mfma_f32_16x16x32_bf16 v[206:209], v[148:151], v[124:127], 0
    s_waitcnt lgkmcnt(7)
    ds_read_b128 v[168:171], v244 offset:23552
    s_add_u32 m0, s73, 24576
    v_mfma_f32_16x16x32_bf16 v[210:213], v[156:159], v[124:127], 0
    s_waitcnt lgkmcnt(4)
    s_add_u32 s94, s74, 49152
    buffer_load_dwordx4 v234, s[4:7], s94 offen sc1 lds
    v_mfma_f32_16x16x32_bf16 v[214:217], v[136:139], v[128:131], v[214:217]
    s_waitcnt lgkmcnt(3)
    v_mfma_f32_16x16x32_bf16 v[206:209], v[152:155], v[128:131], v[206:209]
    s_waitcnt lgkmcnt(2)
    v_mfma_f32_16x16x32_bf16 v[210:213], v[160:163], v[128:131], v[210:213]
    v_permlane32_swap_b32 v202, v204
    v_permlane32_swap_b32 v203, v205
    v_add_f32 v202, v202, v204
    v_add_f32 v203, v203, v205
    v_cndmask_b32 v214, v214, v215, s[98:99]
    v_cndmask_b32 v216, v216, v217, s[98:99]
    v_cndmask_b32 v224, v214, v216, s[100:101]
    v_bfi_b32 v224, 1, s97, v224
    buffer_store_dword v224, v237, s[4:7], s79 offen offset:1024
    v_cndmask_b32 v220, v206, v210, s[98:99]
    v_cndmask_b32 v221, v207, v211, s[98:99]
    v_cndmask_b32 v222, v208, v212, s[98:99]
    v_cndmask_b32 v223, v209, v213, s[98:99]
    v_bfi_b32 v220, 1, s97, v220
    buffer_store_dwordx4 v[220:223], v236, s[4:7], s79 offen
    v_cvt_pk_bf16_f32 v174, v202, v203
    v_cvt_pk_bf16_f32 v178, v202, v203
    ds_read_b128 v[124:127], v232 offset:0
    ds_read_b128 v[128:131], v232 offset:20480
    s_waitcnt lgkmcnt(3)
    v_mfma_f32_16x16x32_bf16 v[214:217], v[132:135], v[164:167], 0
    ds_read_b128 v[140:143], v232 offset:1024
    v_mfma_f32_16x16x32_bf16 v[206:209], v[148:151], v[164:167], v[188:191]
    v_mfma_f32_16x16x32_bf16 v[210:213], v[156:159], v[164:167], v[188:191]
    s_waitcnt lgkmcnt(3)
    v_mfma_f32_16x16x32_bf16 v[214:217], v[136:139], v[168:171], v[214:217]
    ds_read_b128 v[132:135], v233 offset:0
    v_mfma_f32_16x16x32_bf16 v[206:209], v[152:155], v[168:171], v[206:209]
    ds_read_b128 v[136:139], v233 offset:20480
    v_mfma_f32_16x16x32_bf16 v[210:213], v[160:163], v[168:171], v[210:213]
    s_waitcnt lgkmcnt(4)
    v_mfma_f32_16x16x32_bf16 v[148:151], a[0:3], v[124:127], 0
    ds_read_b128 v[144:147], v232 offset:21504
    s_nop 0
    v_cndmask_b32 v214, v214, v215, s[98:99]
    v_mfma_f32_16x16x32_bf16 v[156:159], a[80:83], v[124:127], 0
    v_cndmask_b32 v216, v216, v217, s[98:99]
    v_cndmask_b32 v230, v214, v216, s[100:101]
    v_mfma_f32_16x16x32_bf16 v[164:167], v[124:127], a[160:163], 0
    s_waitcnt lgkmcnt(4)
    v_bfi_b32 v230, 1, s97, v230
    v_cndmask_b32 v226, v206, v210, s[98:99]
    v_mfma_f32_16x16x32_bf16 v[152:155], a[0:3], v[128:131], 0
    ds_read_b128 v[124:127], v233 offset:1024
    v_cndmask_b32 v227, v207, v211, s[98:99]
    v_mfma_f32_16x16x32_bf16 v[160:163], a[80:83], v[128:131], 0
    v_cndmask_b32 v228, v208, v212, s[98:99]
    v_cndmask_b32 v229, v209, v213, s[98:99]
    v_mfma_f32_16x16x32_bf16 v[168:171], v[128:131], a[160:163], 0
    v_bfi_b32 v226, 1, s97, v226
    s_waitcnt lgkmcnt(3)
    v_mfma_f32_16x16x32_bf16 v[148:151], a[4:7], v[132:135], v[148:151]
    ds_read_b128 v[128:131], v233 offset:21504
    buffer_load_dwordx4 v[84:87], v236, s[4:7], s80 offen sc1
    v_mfma_f32_16x16x32_bf16 v[156:159], a[84:87], v[132:135], v[156:159]
    buffer_load_dwordx4 v[88:91], v236, s[4:7], s81 offen sc1
    buffer_load_dword v92, v237, s[4:7], s80 offen offset:1024 sc1
    v_mfma_f32_16x16x32_bf16 v[164:167], v[132:135], a[164:167], v[164:167]
    s_waitcnt lgkmcnt(3)
    buffer_load_dword v93, v237, s[4:7], s81 offen offset:1024 sc1
    v_mfma_f32_16x16x32_bf16 v[152:155], a[4:7], v[136:139], v[152:155]
    ds_read_b128 v[132:135], v232 offset:2048
    v_mfma_f32_16x16x32_bf16 v[160:163], a[84:87], v[136:139], v[160:163]
    v_mfma_f32_16x16x32_bf16 v[168:171], v[136:139], a[164:167], v[168:171]
    v_mfma_f32_16x16x32_bf16 v[148:151], a[8:11], v[140:143], v[148:151]
    ds_read_b128 v[136:139], v232 offset:22528
    v_mfma_f32_16x16x32_bf16 v[156:159], a[88:91], v[140:143], v[156:159]
    buffer_store_dwordx4 v[226:229], v238, s[4:7], s79 offen
    buffer_store_dword v230, v239, s[4:7], s79 offen offset:1024
    v_mfma_f32_16x16x32_bf16 v[164:167], v[140:143], a[168:171], v[164:167]
    s_waitcnt lgkmcnt(4)
    v_mfma_f32_16x16x32_bf16 v[152:155], a[8:11], v[144:147], v[152:155]
    ds_read_b128 v[140:143], v233 offset:2048
    v_mfma_f32_16x16x32_bf16 v[160:163], a[88:91], v[144:147], v[160:163]
    v_mfma_f32_16x16x32_bf16 v[168:171], v[144:147], a[168:171], v[168:171]
    s_waitcnt lgkmcnt(4)
    v_mfma_f32_16x16x32_bf16 v[148:151], a[12:15], v[124:127], v[148:151]
    ds_read_b128 v[144:147], v233 offset:22528
    v_mfma_f32_16x16x32_bf16 v[156:159], a[92:95], v[124:127], v[156:159]
    v_mfma_f32_16x16x32_bf16 v[164:167], v[124:127], a[172:175], v[164:167]
    s_waitcnt lgkmcnt(4)
    v_mfma_f32_16x16x32_bf16 v[152:155], a[12:15], v[128:131], v[152:155]
    ds_read_b128 v[124:127], v232 offset:3072
    v_mfma_f32_16x16x32_bf16 v[160:163], a[92:95], v[128:131], v[160:163]
    v_mfma_f32_16x16x32_bf16 v[168:171], v[128:131], a[172:175], v[168:171]
    s_waitcnt lgkmcnt(4)
    v_mfma_f32_16x16x32_bf16 v[148:151], a[16:19], v[132:135], v[148:151]
    ds_read_b128 v[128:131], v232 offset:23552
    v_mfma_f32_16x16x32_bf16 v[156:159], a[96:99], v[132:135], v[156:159]
    v_mfma_f32_16x16x32_bf16 v[164:167], v[132:135], a[176:179], v[164:167]
    s_waitcnt vmcnt(4)
    v_bitop3_b32 v218, v84, v88, s97 bitop3:0x7e
    s_waitcnt vmcnt(2)
    v_bitop3_b32 v219, v92, v93, s97 bitop3:0x7e
    v_bitop3_b32 v218, v218, v219, 1 bitop3:0xa8
    v_cmp_eq_u32 vcc, 1, v218
    s_cbranch_vccnz Lrty_28
    v_pk_add_f32 v[84:85], v[84:85], v[88:89]
    v_pk_add_f32 v[86:87], v[86:87], v[90:91]
    v_add_f32 v92, v92, v93
    v_pk_add_f32 v[220:221], v[220:221], v[84:85]
    v_pk_add_f32 v[222:223], v[222:223], v[86:87]
    v_add_f32 v224, v224, v92
Lok_27:
    v_max3_f32 v218, v220, v221, v222
    v_max3_f32 v218, v218, v223, v224
    buffer_load_dwordx4 v[108:111], v238, s[4:7], s80 offen sc1
    buffer_load_dwordx4 v[112:115], v238, s[4:7], s81 offen sc1
    v_max_f32_dpp v218, v218, v218 row_ror:8 row_mask:0xf bank_mask:0xf
    v_mov_b32 v219, v218
    buffer_load_dword v116, v239, s[4:7], s80 offen offset:1024 sc1
    buffer_load_dword v117, v239, s[4:7], s81 offen offset:1024 sc1
    v_permlane16_swap_b32 v218, v219
    v_max_f32 v218, v218, v219
    v_mov_b32 v219, v218
    v_mov_b64 v[206:207], 0
    v_mov_b64 v[208:209], 0
    v_permlane32_swap_b32 v218, v219
    v_max_f32 v218, v218, v219
    v_mul_f32 v218, s70, v218
    v_fma_f32 v224, v224, s70, -v218
    v_fma_f32 v220, v220, s70, -v218
    v_fma_f32 v221, v221, s70, -v218
    v_fma_f32 v222, v222, s70, -v218
    v_fma_f32 v223, v223, s70, -v218
    v_exp_f32 v224, v224
    v_exp_f32 v220, v220
    v_exp_f32 v221, v221
    v_exp_f32 v222, v222
    v_exp_f32 v223, v223
    v_cvt_pk_bf16_f32 v186, v224, v224
    v_cvt_pk_bf16_f32 v184, v220, v221
    v_and_b32 v186, v231, v186
    v_cvt_pk_bf16_f32 v185, v222, v223
    v_mov_b64 v[210:211], 0
    v_mov_b64 v[212:213], 0
    v_mfma_f32_16x16x32_bf16 v[202:205], v[180:183], v[184:187], 0
    s_nop 2
    v_mfma_f32_16x16x32_bf16 v[194:197], v[172:175], v[184:187], 0
    s_nop 2
    v_mfma_f32_16x16x32_bf16 v[198:201], v[176:179], v[184:187], 0
    s_nop 2
    s_waitcnt lgkmcnt(4)
    v_mfma_f32_16x16x32_bf16 v[152:155], a[16:19], v[136:139], v[152:155]
    s_nop 0
    ds_read_b128 v[132:135], v233 offset:3072
    v_add_f32_dpp v202, v202, v202 row_ror:8 row_mask:0xf bank_mask:0xf
    v_rcp_f32 v202, v202
    v_add_f32_dpp v194, v198, v194 row_ror:8 row_mask:0xf bank_mask:0xf
    v_add_f32_dpp v195, v199, v195 row_ror:8 row_mask:0xf bank_mask:0xf
    v_add_f32_dpp v196, v200, v196 row_ror:8 row_mask:0xf bank_mask:0xf
    v_add_f32_dpp v197, v201, v197 row_ror:8 row_mask:0xf bank_mask:0xf
    v_pk_mul_f32 v[194:195], v[194:195], v[202:203] op_sel_hi:[1,0]
    v_pk_mul_f32 v[196:197], v[196:197], v[202:203] op_sel_hi:[1,0]
    v_cvt_pk_bf16_f32 v194, v194, v195
    v_cvt_pk_bf16_f32 v195, v196, v197
    v_min_u32 v194, -2, v194
    buffer_store_dwordx2 v[194:195], v247, s[4:7], s72 offen
    v_mfma_f32_16x16x32_bf16 v[160:163], a[96:99], v[136:139], v[160:163]
    s_waitcnt vmcnt(3)
    v_bitop3_b32 v218, v108, v112, s97 bitop3:0x7e
    s_waitcnt vmcnt(1)
    v_bitop3_b32 v219, v116, v117, s97 bitop3:0x7e
    v_bitop3_b32 v218, v218, v219, 1 bitop3:0xa8
    v_cmp_eq_u32 vcc, 1, v218
    s_cbranch_vccnz Lrty_30
Lok_29:
    v_mfma_f32_16x16x32_bf16 v[168:171], v[136:139], a[176:179], v[168:171]
    s_waitcnt lgkmcnt(4)
    v_add_f32 v108, v108, v112
    v_add_f32 v109, v109, v113
    v_mfma_f32_16x16x32_bf16 v[148:151], a[20:23], v[140:143], v[148:151]
    ds_read_b128 v[136:139], v233 offset:23552
    v_add_f32 v110, v110, v114
    v_mfma_f32_16x16x32_bf16 v[156:159], a[100:103], v[140:143], v[156:159]
    v_add_f32 v111, v111, v115
    v_add_f32 v116, v116, v117
    v_mfma_f32_16x16x32_bf16 v[164:167], v[140:143], a[180:183], v[164:167]
    s_waitcnt lgkmcnt(4)
    v_add_f32 v226, v226, v108
    v_add_f32 v227, v227, v109
    v_mfma_f32_16x16x32_bf16 v[152:155], a[20:23], v[144:147], v[152:155]
    ds_read_b128 v[140:143], v232 offset:4096
    v_add_f32 v228, v228, v110
    v_mfma_f32_16x16x32_bf16 v[160:163], a[100:103], v[144:147], v[160:163]
    v_add_f32 v229, v229, v111
    v_add_f32 v230, v230, v116
    v_mfma_f32_16x16x32_bf16 v[168:171], v[144:147], a[180:183], v[168:171]
    s_waitcnt lgkmcnt(4)
    v_max3_f32 v218, v226, v227, v228
    v_max3_f32 v218, v218, v229, v230
    v_mfma_f32_16x16x32_bf16 v[148:151], a[24:27], v[124:127], v[148:151]
    ds_read_b128 v[144:147], v232 offset:24576
    v_max_f32_dpp v218, v218, v218 row_ror:8 row_mask:0xf bank_mask:0xf
    v_mfma_f32_16x16x32_bf16 v[156:159], a[104:107], v[124:127], v[156:159]
    v_mov_b32 v219, v218
    s_nop 0
    v_mfma_f32_16x16x32_bf16 v[164:167], v[124:127], a[184:187], v[164:167]
    s_waitcnt lgkmcnt(4)
    v_permlane16_swap_b32 v218, v219
    v_mfma_f32_16x16x32_bf16 v[152:155], a[24:27], v[128:131], v[152:155]
    ds_read_b128 v[124:127], v233 offset:4096
    v_max_f32 v218, v218, v219
    v_mfma_f32_16x16x32_bf16 v[160:163], a[104:107], v[128:131], v[160:163]
    buffer_load_dwordx4 v[84:87], v248, s[4:7], s85 offen offset:0 sc1
    v_mov_b32 v219, v218
    v_mfma_f32_16x16x32_bf16 v[168:171], v[128:131], a[184:187], v[168:171]
    s_waitcnt lgkmcnt(4)
    v_permlane32_swap_b32 v218, v219
    v_mfma_f32_16x16x32_bf16 v[148:151], a[28:31], v[132:135], v[148:151]
    ds_read_b128 v[128:131], v233 offset:24576
    buffer_load_dwordx4 v[88:91], v248, s[4:7], s85 offen offset:1024 sc1
    v_mfma_f32_16x16x32_bf16 v[156:159], a[108:111], v[132:135], v[156:159]
    v_max_f32 v218, v218, v219
    v_mul_f32 v218, s70, v218
    v_mfma_f32_16x16x32_bf16 v[164:167], v[132:135], a[188:191], v[164:167]
    s_waitcnt lgkmcnt(4)
    buffer_load_dwordx4 v[92:95], v248, s[4:7], s85 offen offset:2048 sc1
    v_fma_f32 v230, v230, s70, -v218
    v_mfma_f32_16x16x32_bf16 v[152:155], a[28:31], v[136:139], v[152:155]
    ds_read_b128 v[132:135], v232 offset:5120
    v_fma_f32 v226, v226, s70, -v218
    v_mfma_f32_16x16x32_bf16 v[160:163], a[108:111], v[136:139], v[160:163]
    buffer_load_dwordx4 v[96:99], v248, s[4:7], s85 offen offset:3072 sc1
    v_fma_f32 v227, v227, s70, -v218
    v_mfma_f32_16x16x32_bf16 v[168:171], v[136:139], a[188:191], v[168:171]
    s_waitcnt lgkmcnt(4)
    v_fma_f32 v228, v228, s70, -v218
    v_fma_f32 v229, v229, s70, -v218
    v_mfma_f32_16x16x32_bf16 v[148:151], a[32:35], v[140:143], v[148:151]
    ds_read_b128 v[136:139], v232 offset:25600
    buffer_load_dwordx4 v[100:103], v248, s[4:7], s86 offen offset:0 sc1
    v_mfma_f32_16x16x32_bf16 v[156:159], a[112:115], v[140:143], v[156:159]
    v_exp_f32 v230, v230
    v_mfma_f32_16x16x32_bf16 v[164:167], v[140:143], a[192:195], v[164:167]
    s_waitcnt lgkmcnt(4)
    buffer_load_dwordx4 v[104:107], v248, s[4:7], s86 offen offset:1024 sc1
    v_mfma_f32_16x16x32_bf16 v[152:155], a[32:35], v[144:147], v[152:155]
    ds_read_b128 v[140:143], v233 offset:5120
    v_mfma_f32_16x16x32_bf16 v[160:163], a[112:115], v[144:147], v[160:163]
    v_exp_f32 v226, v226
    v_mfma_f32_16x16x32_bf16 v[168:171], v[144:147], a[192:195], v[168:171]
    v_exp_f32 v227, v227
Lwchk_31:
    s_waitcnt vmcnt(5)
    v_max_u32 v194, v84, v86
    s_waitcnt vmcnt(4)
    v_max3_u32 v194, v194, v88, v90
    v_cmp_lt_u32 vcc, s87, v194
    s_cbranch_vccnz Lwrty_32
    v_smfmac_f32_16x16x64_bf16 v[206:209], v[84:87], a[240:247], v187
    v_exp_f32 v228, v228
    v_smfmac_f32_16x16x64_bf16 v[210:213], v[84:87], a[248:255], v187
    v_exp_f32 v229, v229
    v_smfmac_f32_16x16x64_bf16 v[206:209], v[88:91], v[4:11], v187
    v_cvt_pk_bf16_f32 v200, v230, v230
    v_smfmac_f32_16x16x64_bf16 v[210:213], v[88:91], v[12:19], v187
Lwchk_33:
    s_waitcnt vmcnt(3)
    v_max_u32 v194, v92, v94
    s_waitcnt vmcnt(2)
    v_max3_u32 v194, v194, v96, v98
    v_cmp_lt_u32 vcc, s87, v194
    s_cbranch_vccnz Lwrty_34
    v_smfmac_f32_16x16x64_bf16 v[206:209], v[92:95], v[20:27], v187
    v_cvt_pk_bf16_f32 v198, v226, v227
    v_smfmac_f32_16x16x64_bf16 v[210:213], v[92:95], v[28:35], v187
    v_cvt_pk_bf16_f32 v199, v228, v229
    v_smfmac_f32_16x16x64_bf16 v[206:209], v[96:99], v[36:43], v187
    ds_write_b16 v246, v200 offset:14344
    v_smfmac_f32_16x16x64_bf16 v[210:213], v[96:99], v[44:51], v187
Lwchk_35:
    s_waitcnt vmcnt(1)
    v_max_u32 v194, v100, v102
    s_waitcnt vmcnt(0)
    v_max3_u32 v194, v194, v104, v106
    v_cmp_lt_u32 vcc, s87, v194
    s_cbranch_vccnz Lwrty_36
    v_smfmac_f32_16x16x64_bf16 v[206:209], v[100:103], v[52:59], v187
    ds_write_b64 v245, v[198:199] offset:14336
    v_smfmac_f32_16x16x64_bf16 v[210:213], v[100:103], v[60:67], v187
    v_smfmac_f32_16x16x64_bf16 v[206:209], v[104:107], v[68:75], v187
    v_smfmac_f32_16x16x64_bf16 v[210:213], v[104:107], v[76:83], v187
    s_nop 2
    s_waitcnt lgkmcnt(6)
    v_mfma_f32_16x16x32_bf16 v[148:151], a[36:39], v[124:127], v[148:151]
    s_nop 0
    ds_read_b128 v[144:147], v233 offset:25600
    s_nop 0
    v_mfma_f32_16x16x32_bf16 v[156:159], a[116:119], v[124:127], v[156:159]
    v_permlane32_swap_b32 v206, v210
    v_permlane32_swap_b32 v207, v211
    v_permlane32_swap_b32 v208, v212
    v_permlane32_swap_b32 v209, v213
    v_pk_add_f32 v[206:207], v[206:207], v[210:211]
    v_pk_add_f32 v[208:209], v[208:209], v[212:213]
    ds_write2_b32 v249, v206, v207 offset0:0 offset1:32
    ds_write2_b32 v249, v208, v209 offset0:64 offset1:96
    v_mfma_f32_16x16x32_bf16 v[164:167], v[124:127], a[196:199], v[164:167]
    s_waitcnt lgkmcnt(8)
    v_mfma_f32_16x16x32_bf16 v[152:155], a[36:39], v[128:131], v[152:155]
    ds_read_b128 v[124:127], v232 offset:6144
    v_mfma_f32_16x16x32_bf16 v[160:163], a[116:119], v[128:131], v[160:163]
    v_mfma_f32_16x16x32_bf16 v[168:171], v[128:131], a[196:199], v[168:171]
    s_waitcnt lgkmcnt(1)
    s_barrier
    ds_read_b128 v[96:99], v236 offset:18432
    ds_read_b128 v[100:103], v236 offset:19456
    v_mfma_f32_16x16x32_bf16 v[148:151], a[40:43], v[132:135], v[148:151]
    ds_read_b128 v[128:131], v232 offset:26624
    ds_read_b128 v[104:107], v236 offset:20480
    v_mfma_f32_16x16x32_bf16 v[156:159], a[120:123], v[132:135], v[156:159]
    ds_read_b128 v[108:111], v236 offset:21504
    ds_read_b64 v[120:121], v240 offset:16896
    v_mfma_f32_16x16x32_bf16 v[164:167], v[132:135], a[200:203], v[164:167]
    ds_read_b128 v[112:115], v236 offset:14336
    ds_read_b128 v[116:119], v236 offset:15872
    v_mfma_f32_16x16x32_bf16 v[152:155], a[40:43], v[136:139], v[152:155]
    ds_read_b128 v[132:135], v233 offset:6144
    s_waitcnt lgkmcnt(7)
    v_pk_add_f32 v[96:97], v[96:97], v[100:101]
    v_pk_add_f32 v[98:99], v[98:99], v[102:103]
    s_waitcnt lgkmcnt(4)
    v_pk_add_f32 v[104:105], v[104:105], v[108:109]
    v_pk_add_f32 v[106:107], v[106:107], v[110:111]
    v_pk_add_f32 v[96:97], v[96:97], v[104:105]
    v_pk_add_f32 v[98:99], v[98:99], v[106:107]
    v_bfi_b32 v96, 1, s97, v96
    buffer_store_dwordx4 v[96:99], v251, s[4:7], s88 offen sc1
    s_waitcnt lgkmcnt(3)
    v_mfma_f32_16x16x16_bf16 v[206:209], v[180:181], v[120:121], 0
    v_mfma_f32_16x16x16_bf16 v[198:201], v[176:177], v[120:121], 0
    s_waitcnt lgkmcnt(2)
    v_mfma_f32_16x16x32_bf16 v[202:205], v[180:183], v[112:115], 0
    buffer_store_dword v192, v247, s[4:7], s96 offen
    v_mfma_f32_16x16x32_bf16 v[194:197], v[172:175], v[112:115], 0
    v_mfma_f32_16x16x32_bf16 v[160:163], a[120:123], v[136:139], v[160:163]
    v_mfma_f32_16x16x32_bf16 v[168:171], v[136:139], a[200:203], v[168:171]
    buffer_store_dword v192, v250, s[4:7], s96 offen
    v_mfma_f32_16x16x32_bf16 v[148:151], a[44:47], v[140:143], v[148:151]
    ds_read_b128 v[136:139], v233 offset:26624
    s_waitcnt lgkmcnt(2)
    v_mfma_f32_16x16x32_bf16 v[206:209], v[180:183], v[116:119], v[206:209]
    v_mfma_f32_16x16x32_bf16 v[198:201], v[172:175], v[116:119], v[198:201]
    v_mfma_f32_16x16x32_bf16 v[156:159], a[124:127], v[140:143], v[156:159]
    v_rcp_f32 v202, v202
    v_mfma_f32_16x16x32_bf16 v[164:167], v[140:143], a[204:207], v[164:167]
    v_mul_f32 v194, v194, v202
    v_mul_f32 v195, v195, v202
    v_mfma_f32_16x16x32_bf16 v[152:155], a[44:47], v[144:147], v[152:155]
    ds_read_b128 v[140:143], v232 offset:7168
    v_mul_f32 v196, v196, v202
    v_mfma_f32_16x16x32_bf16 v[160:163], a[124:127], v[144:147], v[160:163]
    v_mul_f32 v197, v197, v202
    v_cvt_pk_bf16_f32 v210, v194, v195
    v_mfma_f32_16x16x32_bf16 v[168:171], v[144:147], a[204:207], v[168:171]
    v_cvt_pk_bf16_f32 v211, v196, v197
    v_mfma_f32_16x16x32_bf16 v[148:151], a[48:51], v[124:127], v[148:151]
    ds_read_b128 v[144:147], v232 offset:27648
    v_mfma_f32_16x16x32_bf16 v[156:159], a[128:131], v[124:127], v[156:159]
    buffer_store_dwordx2 v[210:211], v243, s[4:7], s75 offen offset:0
    v_rcp_f32 v206, v206
    s_nop 0
    v_mfma_f32_16x16x32_bf16 v[164:167], v[124:127], a[208:211], v[164:167]
    v_mul_f32 v198, v198, v206
    v_mul_f32 v199, v199, v206
    v_mfma_f32_16x16x32_bf16 v[152:155], a[48:51], v[128:131], v[152:155]
    ds_read_b128 v[124:127], v233 offset:7168
    v_mul_f32 v200, v200, v206
    v_mfma_f32_16x16x32_bf16 v[160:163], a[128:131], v[128:131], v[160:163]
    buffer_load_dwordx4 v[100:103], v251, s[4:7], s82 offen sc1
    buffer_load_dwordx4 v[104:107], v251, s[4:7], s83 offen sc1
    v_mfma_f32_16x16x32_bf16 v[168:171], v[128:131], a[208:211], v[168:171]
    s_waitcnt lgkmcnt(4)
    buffer_load_dwordx4 v[108:111], v251, s[4:7], s84 offen sc1
    v_mul_f32 v201, v201, v206
    v_mfma_f32_16x16x32_bf16 v[148:151], a[52:55], v[132:135], v[148:151]
    ds_read_b128 v[128:131], v233 offset:27648
    v_cvt_pk_bf16_f32 v212, v198, v199
    v_mfma_f32_16x16x32_bf16 v[156:159], a[132:135], v[132:135], v[156:159]
    v_cvt_pk_bf16_f32 v213, v200, v201
    v_mfma_f32_16x16x32_bf16 v[164:167], v[132:135], a[212:215], v[164:167]
    s_waitcnt lgkmcnt(4)
    buffer_store_dwordx2 v[212:213], v243, s[4:7], s75 offen offset:2048
    s_cmp_eq_u32 s62, 63
    s_cbranch_scc1 L_Clast
    v_mfma_f32_16x16x32_bf16 v[152:155], a[52:55], v[136:139], v[152:155]
    s_add_u32 s75, s75, 393216
    ds_read_b128 v[132:135], v232 offset:8192
    s_add_u32 s66, s62, 1
    v_mfma_f32_16x16x32_bf16 v[160:163], a[132:135], v[136:139], v[160:163]
    s_and_b32 s66, s66, 7
    s_cselect_b32 s66, 0, 3145728
    s_sub_u32 s75, s75, s66
    v_mfma_f32_16x16x32_bf16 v[168:171], v[136:139], a[212:215], v[168:171]
    s_waitcnt lgkmcnt(4)
    v_mov_b64 v[194:195], 0
    v_mov_b64 v[196:197], 0
    v_mfma_f32_16x16x32_bf16 v[148:151], a[56:59], v[140:143], v[148:151]
    ds_read_b128 v[136:139], v232 offset:28672
    v_mov_b64 v[198:199], 0
    v_mfma_f32_16x16x32_bf16 v[156:159], a[136:139], v[140:143], v[156:159]
    v_mov_b64 v[200:201], 0
    v_mov_b64 v[202:203], 0
    v_mfma_f32_16x16x32_bf16 v[164:167], v[140:143], a[216:219], v[164:167]
    s_waitcnt lgkmcnt(4)
    v_mov_b64 v[204:205], 0
    v_mfma_f32_16x16x32_bf16 v[152:155], a[56:59], v[144:147], v[152:155]
    ds_read_b128 v[140:143], v233 offset:8192
    v_mfma_f32_16x16x32_bf16 v[160:163], a[136:139], v[144:147], v[160:163]
    v_mfma_f32_16x16x32_bf16 v[168:171], v[144:147], a[216:219], v[168:171]
    buffer_load_dwordx4 v[84:87], v251, s[4:7], s82 offen sc1
    buffer_load_dwordx4 v[88:91], v251, s[4:7], s83 offen sc1
    buffer_load_dwordx4 v[92:95], v251, s[4:7], s84 offen sc1
    s_waitcnt vmcnt(5)
    v_bitop3_b32 v218, v100, v104, s97 bitop3:0x7e
    s_waitcnt vmcnt(4)
    v_bitop3_b32 v218, v218, v108, s97 bitop3:0xf6
    v_and_b32 v218, v193, v218
    v_cmp_eq_u32 vcc, 1, v218
    s_cbranch_vccnz Lrty_38
    v_pk_add_f32 v[96:97], v[96:97], v[100:101]
    v_pk_add_f32 v[98:99], v[98:99], v[102:103]
    v_pk_add_f32 v[104:105], v[104:105], v[108:109]
    v_pk_add_f32 v[106:107], v[106:107], v[110:111]
    v_pk_add_f32 v[96:97], v[96:97], v[104:105]
    v_pk_add_f32 v[98:99], v[98:99], v[106:107]
Lok_37:
    v_cvt_pk_bf16_f32 v96, v96, v97
    v_cvt_pk_bf16_f32 v97, v98, v99
    v_min_u32 v96, -2, v96
    buffer_store_dwordx2 v[96:97], v250, s[4:7], s72 offen
    s_barrier
L_C3c:
    s_waitcnt lgkmcnt(4)
    v_mfma_f32_16x16x32_bf16 v[148:151], a[60:63], v[124:127], v[148:151]
    s_add_u32 s82, s72, 178176
    ds_read_b128 v[144:147], v233 offset:28672
    s_add_u32 s83, s72, 182272
    v_mfma_f32_16x16x32_bf16 v[156:159], a[140:143], v[124:127], v[156:159]
    s_add_u32 m0, s73, 28672
    s_add_u32 s94, s74, 53248
    buffer_load_dwordx4 v234, s[4:7], s94 offen sc1 lds
    v_mfma_f32_16x16x32_bf16 v[164:167], v[124:127], a[220:223], v[164:167]
    s_waitcnt lgkmcnt(4)
    v_add_u32_e64 v218, s62, 1
    v_mfma_f32_16x16x32_bf16 v[152:155], a[60:63], v[128:131], v[152:155]
    s_add_u32 m0, s73, 32768
    ds_read_b128 v[124:127], v232 offset:9216
    s_add_u32 s94, s74, 65536
    v_mfma_f32_16x16x32_bf16 v[160:163], a[140:143], v[128:131], v[160:163]
    buffer_load_dwordx4 v234, s[4:7], s94 offen sc1 lds
    v_mfma_f32_16x16x32_bf16 v[168:171], v[128:131], a[220:223], v[168:171]
    s_waitcnt lgkmcnt(4)
    s_waitcnt vmcnt(6)
    buffer_store_dword v218, v1, s[4:7], s3 offen
    v_mfma_f32_16x16x32_bf16 v[148:151], a[64:67], v[132:135], v[148:151]
    s_add_u32 m0, s73, 36864
    ds_read_b128 v[128:131], v232 offset:29696
    s_add_u32 s94, s74, 69632
    v_mfma_f32_16x16x32_bf16 v[156:159], a[144:147], v[132:135], v[156:159]
    buffer_load_dwordx4 v234, s[4:7], s94 offen sc1 lds
    v_mfma_f32_16x16x32_bf16 v[164:167], v[132:135], a[224:227], v[164:167]
    s_waitcnt lgkmcnt(4)
    v_mfma_f32_16x16x32_bf16 v[152:155], a[64:67], v[136:139], v[152:155]
    ds_read_b128 v[132:135], v233 offset:9216
    v_mfma_f32_16x16x32_bf16 v[160:163], a[144:147], v[136:139], v[160:163]
    v_mfma_f32_16x16x32_bf16 v[168:171], v[136:139], a[224:227], v[168:171]
    s_waitcnt lgkmcnt(4)
    v_mfma_f32_16x16x32_bf16 v[148:151], a[68:71], v[140:143], v[148:151]
    ds_read_b128 v[136:139], v233 offset:29696
    v_mfma_f32_16x16x32_bf16 v[156:159], a[148:151], v[140:143], v[156:159]
    v_mfma_f32_16x16x32_bf16 v[164:167], v[140:143], a[228:231], v[164:167]
    s_waitcnt lgkmcnt(4)
    v_mfma_f32_16x16x32_bf16 v[152:155], a[68:71], v[144:147], v[152:155]
    v_mfma_f32_16x16x32_bf16 v[160:163], a[148:151], v[144:147], v[160:163]
    v_mfma_f32_16x16x32_bf16 v[168:171], v[144:147], a[228:231], v[168:171]
    s_waitcnt lgkmcnt(3)
    v_mfma_f32_16x16x32_bf16 v[148:151], a[72:75], v[124:127], v[148:151]
    s_add_u32 s86, s72, 262144
    buffer_load_dwordx4 v[206:209], v234, s[4:7], s82 offen sc1
    buffer_load_dwordx4 v[214:217], v234, s[4:7], s83 offen sc1
    v_mfma_f32_16x16x32_bf16 v[156:159], a[152:155], v[124:127], v[156:159]
    s_and_b32 s86, s86, 786432
    buffer_load_dwordx2 v[210:211], v235, s[4:7], s82 offen sc1
    s_andn2_b32 s72, s72, 786432
    v_mfma_f32_16x16x32_bf16 v[164:167], v[124:127], a[232:235], v[164:167]
    s_waitcnt lgkmcnt(2)
    s_or_b32 s72, s72, s86
    s_mov_b32 s74, s92
    v_mfma_f32_16x16x32_bf16 v[152:155], a[72:75], v[128:131], v[152:155]
    s_xor_b32 s73, s73, 65536
    s_add_u32 s91, s91, 131072
    s_lshr_b32 s92, s91, 8
    v_mfma_f32_16x16x32_bf16 v[160:163], a[152:155], v[128:131], v[160:163]
    s_xor_b32 s92, s92, s1
    s_and_b32 s92, s92, s93
    s_or_b32 s92, s92, s91
    v_mfma_f32_16x16x32_bf16 v[168:171], v[128:131], a[232:235], v[168:171]
    s_waitcnt lgkmcnt(1)
    s_xor_b32 s27, s27, 65536
    v_mfma_f32_16x16x32_bf16 v[148:151], a[76:79], v[132:135], v[148:151]
    v_mfma_f32_16x16x32_bf16 v[156:159], a[156:159], v[132:135], v[156:159]
    v_mfma_f32_16x16x32_bf16 v[164:167], v[132:135], a[236:239], v[164:167]
    s_waitcnt lgkmcnt(0)
    v_mfma_f32_16x16x32_bf16 v[152:155], a[76:79], v[136:139], v[152:155]
    v_mfma_f32_16x16x32_bf16 v[160:163], a[156:159], v[136:139], v[160:163]
    v_mfma_f32_16x16x32_bf16 v[168:171], v[136:139], a[236:239], v[168:171]
    v_xor_b32 v232, 0x10000, v232
    v_xor_b32 v233, 0x10000, v233
    v_cvt_pk_bf16_f32 v148, v148, v149
    v_cvt_pk_bf16_f32 v149, v150, v151
    ds_write_b64 v243, v[148:149] offset:22528
    s_nop 0
    v_cvt_pk_bf16_f32 v152, v152, v153
    v_cvt_pk_bf16_f32 v153, v154, v155
    ds_write_b64 v243, v[152:153] offset:24576
    v_cvt_pk_bf16_f32 v156, v156, v157
    v_cvt_pk_bf16_f32 v157, v158, v159
    ds_write_b64 v243, v[156:157] offset:26624
    v_cvt_pk_bf16_f32 v160, v160, v161
    v_cvt_pk_bf16_f32 v161, v162, v163
    ds_write_b64 v243, v[160:161] offset:28672
    v_cvt_pk_bf16_f32 v172, v164, v165
    v_cvt_pk_bf16_f32 v173, v166, v167
    v_cvt_pk_bf16_f32 v176, v168, v169
    v_cvt_pk_bf16_f32 v177, v170, v171
    s_add_u32 s62, s62, 1
    s_branch L_Ctop3
Lrty_26:
    v_max_u32 v218, v206, v208
    v_cmp_lt_u32 s[12:13], -2, v218
    v_max_u32 v218, v214, v216
    v_cmp_lt_u32 s[14:15], -2, v218
    v_cmp_lt_u32 s[16:17], -2, v210
    s_mov_b64 exec, s[12:13]
    buffer_load_dwordx4 v[206:209], v234, s[4:7], s82 offen sc1
    s_mov_b64 exec, s[14:15]
    buffer_load_dwordx4 v[214:217], v234, s[4:7], s83 offen sc1
    s_mov_b64 exec, s[16:17]
    buffer_load_dwordx2 v[210:211], v235, s[4:7], s82 offen sc1
    s_mov_b64 exec, -1
    s_sub_u32 s61, s61, 1
    s_mov_b32 s67, 15
    s_cbranch_scc1 L_fail
    s_waitcnt vmcnt(0)
    v_max3_u32 v218, v206, v208, v214
    v_max3_u32 v218, v218, v216, v210
    v_cmp_lt_u32 vcc, -2, v218
    s_cbranch_vccnz Lrty_26
    ds_write_b128 v234, v[206:209] offset:0
    ds_write_b128 v234, v[214:217] offset:4096
    ds_write_b64 v235, v[210:211] offset:0
    s_branch Lok_25
Lrty_28:
    buffer_load_dwordx4 v[84:87], v236, s[4:7], s80 offen sc1
    buffer_load_dwordx4 v[88:91], v236, s[4:7], s81 offen sc1
    buffer_load_dword v92, v237, s[4:7], s80 offen offset:1024 sc1
    buffer_load_dword v93, v237, s[4:7], s81 offen offset:1024 sc1
    s_sub_u32 s61, s61, 1
    s_mov_b32 s67, 11
    s_cbranch_scc1 L_fail
    s_waitcnt vmcnt(2)
    v_bitop3_b32 v218, v84, v88, s97 bitop3:0x7e
    s_waitcnt vmcnt(0)
    v_bitop3_b32 v219, v92, v93, s97 bitop3:0x7e
    v_bitop3_b32 v218, v218, v219, 1 bitop3:0xa8
    v_cmp_eq_u32 vcc, 1, v218
    s_cbranch_vccnz Lrty_28
    v_pk_add_f32 v[84:85], v[84:85], v[88:89]
    v_pk_add_f32 v[86:87], v[86:87], v[90:91]
    v_add_f32 v92, v92, v93
    v_pk_add_f32 v[220:221], v[220:221], v[84:85]
    v_pk_add_f32 v[222:223], v[222:223], v[86:87]
    v_add_f32 v224, v224, v92
    s_branch Lok_27
Lrty_30:
    buffer_load_dwordx4 v[108:111], v238, s[4:7], s80 offen sc1
    buffer_load_dwordx4 v[112:115], v238, s[4:7], s81 offen sc1
    buffer_load_dword v116, v239, s[4:7], s80 offen offset:1024 sc1
    buffer_load_dword v117, v239, s[4:7], s81 offen offset:1024 sc1
    s_sub_u32 s61, s61, 1
    s_mov_b32 s67, 12
    s_cbranch_scc1 L_fail
    s_waitcnt vmcnt(2)
    v_bitop3_b32 v218, v108, v112, s97 bitop3:0x7e
    s_waitcnt vmcnt(0)
    v_bitop3_b32 v219, v116, v117, s97 bitop3:0x7e
    v_bitop3_b32 v218, v218, v219, 1 bitop3:0xa8
    v_cmp_eq_u32 vcc, 1, v218
    s_cbranch_vccnz Lrty_30
    s_branch Lok_29
Lwrty_32:
    buffer_load_dwordx4 v[84:87], v248, s[4:7], s85 offen offset:0 sc1
    buffer_load_dwordx4 v[88:91], v248, s[4:7], s85 offen offset:1024 sc1
    buffer_load_dwordx4 v[92:95], v248, s[4:7], s85 offen offset:2048 sc1
    buffer_load_dwordx4 v[96:99], v248, s[4:7], s85 offen offset:3072 sc1
    buffer_load_dwordx4 v[100:103], v248, s[4:7], s86 offen offset:0 sc1
    buffer_load_dwordx4 v[104:107], v248, s[4:7], s86 offen offset:1024 sc1
    s_sub_u32 s61, s61, 1
    s_mov_b32 s67, 13
    s_cbranch_scc1 L_fail
    s_branch Lwchk_31
Lwrty_34:
    buffer_load_dwordx4 v[92:95], v248, s[4:7], s85 offen offset:2048 sc1
    buffer_load_dwordx4 v[96:99], v248, s[4:7], s85 offen offset:3072 sc1
    buffer_load_dwordx4 v[100:103], v248, s[4:7], s86 offen offset:0 sc1
    buffer_load_dwordx4 v[104:107], v248, s[4:7], s86 offen offset:1024 sc1
    s_sub_u32 s61, s61, 1
    s_mov_b32 s67, 13
    s_cbranch_scc1 L_fail
    s_branch Lwchk_33
Lwrty_36:
    buffer_load_dwordx4 v[100:103], v248, s[4:7], s86 offen offset:0 sc1
    buffer_load_dwordx4 v[104:107], v248, s[4:7], s86 offen offset:1024 sc1
    s_sub_u32 s61, s61, 1
    s_mov_b32 s67, 13
    s_cbranch_scc1 L_fail
    s_branch Lwchk_35
Lrty_38:
    buffer_load_dwordx4 v[100:103], v251, s[4:7], s82 offen sc1
    buffer_load_dwordx4 v[104:107], v251, s[4:7], s83 offen sc1
    buffer_load_dwordx4 v[108:111], v251, s[4:7], s84 offen sc1
    s_sub_u32 s61, s61, 1
    s_mov_b32 s67, 14
    s_cbranch_scc1 L_fail
    s_waitcnt vmcnt(4)
    v_bitop3_b32 v218, v84, v88, s97 bitop3:0x7e
    s_waitcnt vmcnt(3)
    v_bitop3_b32 v218, v218, v92, s97 bitop3:0xf6
    v_and_b32 v218, v193, v218
    v_cmp_eq_u32 vcc, 1, v218
    s_cbranch_vccnz Lrty_39
    v_pk_add_f32 v[96:97], v[96:97], v[84:85]
    v_pk_add_f32 v[98:99], v[98:99], v[86:87]
    v_pk_add_f32 v[88:89], v[88:89], v[92:93]
    v_pk_add_f32 v[90:91], v[90:91], v[94:95]
    v_pk_add_f32 v[96:97], v[96:97], v[88:89]
    v_pk_add_f32 v[98:99], v[98:99], v[90:91]
    s_branch Lok_37
Lrty_39:
    buffer_load_dwordx4 v[84:87], v251, s[4:7], s82 offen sc1
    buffer_load_dwordx4 v[88:91], v251, s[4:7], s83 offen sc1
    buffer_load_dwordx4 v[92:95], v251, s[4:7], s84 offen sc1
    s_sub_u32 s61, s61, 1
    s_mov_b32 s67, 14
    s_cbranch_scc1 L_fail
    s_waitcnt vmcnt(4)
    v_bitop3_b32 v218, v100, v104, s97 bitop3:0x7e
    s_waitcnt vmcnt(3)
    v_bitop3_b32 v218, v218, v108, s97 bitop3:0xf6
    v_and_b32 v218, v193, v218
    v_cmp_eq_u32 vcc, 1, v218
    s_cbranch_vccnz Lrty_38
    v_pk_add_f32 v[96:97], v[96:97], v[100:101]
    v_pk_add_f32 v[98:99], v[98:99], v[102:103]
    v_pk_add_f32 v[104:105], v[104:105], v[108:109]
    v_pk_add_f32 v[106:107], v[106:107], v[110:111]
    v_pk_add_f32 v[96:97], v[96:97], v[104:105]
    v_pk_add_f32 v[98:99], v[98:99], v[106:107]
    s_branch Lok_37
L_Ctop0:
    s_waitcnt vmcnt(1)
    v_max3_u32 v218, v206, v208, v214
    s_waitcnt vmcnt(0)
    v_max3_u32 v218, v218, v216, v210
    v_cmp_lt_u32 vcc, -2, v218
    s_cbranch_vccnz Lrty_41
    ds_write_b128 v234, v[206:209] offset:0
    ds_write_b128 v234, v[214:217] offset:4096
    ds_write_b64 v235, v[210:211] offset:0
Lok_40:
L_Cin0:
    s_waitcnt lgkmcnt(0)
    s_barrier
    ds_read_b128 v[84:87], v236 offset:0
    ds_read_b128 v[88:91], v236 offset:1024
    ds_read_b128 v[92:95], v236 offset:2048
    ds_read_b128 v[96:99], v236 offset:3072
    s_waitcnt lgkmcnt(3)
    v_smfmac_f32_16x16x64_bf16 v[194:197], v[84:87], a[0:7], v187
    s_add_u32 m0, s73, 0
    ds_read_b128 v[100:103], v236 offset:4096
    s_add_u32 s94, s74, 0
    v_smfmac_f32_16x16x64_bf16 v[198:201], v[84:87], a[80:87], v187
    s_waitcnt lgkmcnt(3)
    ds_read_b128 v[104:107], v236 offset:5120
    buffer_load_dwordx4 v234, s[4:7], s94 offen sc1 lds
    v_smfmac_f32_16x16x64_bf16 v[194:197], v[88:91], a[8:15], v187
    s_andn2_b32 s71, s72, 524288
    ds_read_b128 v[108:111], v236 offset:6144
    s_lshr_b32 s97, s62, 1
    v_smfmac_f32_16x16x64_bf16 v[198:201], v[88:91], a[88:95], v187
    s_waitcnt lgkmcnt(4)
    ds_read_b128 v[112:115], v236 offset:7168
    s_add_u32 m0, s73, 4096
    v_smfmac_f32_16x16x64_bf16 v[194:197], v[92:95], a[16:23], v187
    s_add_u32 s94, s74, 4096
    ds_read_b128 v[116:119], v236 offset:8192
    buffer_load_dwordx4 v234, s[4:7], s94 offen sc1 lds
    v_smfmac_f32_16x16x64_bf16 v[198:201], v[92:95], a[96:103], v187
    s_waitcnt lgkmcnt(5)
    ds_read_b128 v[120:123], v236 offset:9216
    s_add_u32 s79, s71, s76
    v_smfmac_f32_16x16x64_bf16 v[194:197], v[96:99], a[24:31], v187
    s_add_u32 m0, s73, 8192
    s_add_u32 s94, s74, 16384
    buffer_load_dwordx4 v234, s[4:7], s94 offen sc1 lds
    v_smfmac_f32_16x16x64_bf16 v[198:201], v[96:99], a[104:111], v187
    s_waitcnt lgkmcnt(5)
    s_add_u32 s80, s71, s77
    s_add_u32 s81, s71, s78
    v_smfmac_f32_16x16x64_bf16 v[194:197], v[100:103], a[32:39], v187
    s_cmp_lt_u32 s59, 20
    s_cselect_b32 s85, s72, s92
    s_add_u32 s86, s85, s89
    v_smfmac_f32_16x16x64_bf16 v[198:201], v[100:103], a[112:119], v187
    s_waitcnt lgkmcnt(4)
    s_xor_b32 s96, s72, 524288
    v_smfmac_f32_16x16x64_bf16 v[194:197], v[104:107], a[40:47], v187
    v_smfmac_f32_16x16x64_bf16 v[198:201], v[104:107], a[120:127], v187
    s_waitcnt lgkmcnt(3)
    v_smfmac_f32_16x16x64_bf16 v[194:197], v[108:111], a[48:55], v187
    v_smfmac_f32_16x16x64_bf16 v[198:201], v[108:111], a[128:135], v187
    s_waitcnt lgkmcnt(2)
    v_smfmac_f32_16x16x64_bf16 v[194:197], v[112:115], a[56:63], v187
    v_smfmac_f32_16x16x64_bf16 v[198:201], v[112:115], a[136:143], v187
    s_waitcnt lgkmcnt(1)
    v_smfmac_f32_16x16x64_bf16 v[194:197], v[116:119], a[64:71], v187
    v_smfmac_f32_16x16x64_bf16 v[198:201], v[116:119], a[144:151], v187
    s_waitcnt lgkmcnt(0)
    v_smfmac_f32_16x16x64_bf16 v[194:197], v[120:123], a[72:79], v187
    v_smfmac_f32_16x16x64_bf16 v[198:201], v[120:123], a[152:159], v187
    s_nop 2
    v_smfmac_f32_16x16x64_bf16 v[202:205], v[84:87], a[160:167], v187
    s_nop 3
    v_permlane32_swap_b32 v194, v198
    v_permlane32_swap_b32 v195, v199
    v_permlane32_swap_b32 v196, v200
    v_permlane32_swap_b32 v197, v201
    v_pk_add_f32 v[194:195], v[194:195], v[198:199]
    v_pk_add_f32 v[196:197], v[196:197], v[200:201]
    v_cvt_pk_bf16_f32 v194, v194, v195
    v_cvt_pk_bf16_f32 v195, v196, v197
    ds_write_b64 v241, v[194:195] offset:12288
    v_smfmac_f32_16x16x64_bf16 v[202:205], v[88:91], a[168:175], v187
    s_add_u32 m0, s73, 12288
    s_add_u32 s94, s74, 20480
    buffer_load_dwordx4 v234, s[4:7], s94 offen sc1 lds
    v_smfmac_f32_16x16x64_bf16 v[202:205], v[92:95], a[176:183], v187
    v_smfmac_f32_16x16x64_bf16 v[202:205], v[96:99], a[184:191], v187
    s_add_u32 m0, s73, 16384
    s_add_u32 s94, s74, 32768
    buffer_load_dwordx4 v234, s[4:7], s94 offen sc1 lds
    v_smfmac_f32_16x16x64_bf16 v[202:205], v[100:103], a[192:199], v187
    v_smfmac_f32_16x16x64_bf16 v[202:205], v[104:107], a[200:207], v187
    s_add_u32 m0, s73, 20480
    s_add_u32 s94, s74, 36864
    buffer_load_dwordx4 v234, s[4:7], s94 offen sc1 lds
    s_waitcnt lgkmcnt(0)
    s_barrier
    ds_read_b64_tr_b16 v[124:125], v242 offset:12288
    ds_read_b64_tr_b16 v[126:127], v242 offset:12352
    ds_read_b64_tr_b16 v[132:133], v242 offset:13312
    ds_read_b64_tr_b16 v[134:135], v242 offset:13376
    v_smfmac_f32_16x16x64_bf16 v[202:205], v[108:111], a[208:215], v187
    ds_read_b128 v[148:151], v236 offset:26624
    ds_read_b128 v[156:159], v236 offset:28672
    v_smfmac_f32_16x16x64_bf16 v[202:205], v[112:115], a[216:223], v187
    ds_read_b64_tr_b16 v[128:129], v242 offset:12800
    ds_read_b64_tr_b16 v[130:131], v242 offset:12864
    v_smfmac_f32_16x16x64_bf16 v[202:205], v[116:119], a[224:231], v187
    ds_read_b64_tr_b16 v[136:137], v242 offset:13824
    ds_read_b64_tr_b16 v[138:139], v242 offset:13888
    v_smfmac_f32_16x16x64_bf16 v[202:205], v[120:123], a[232:239], v187
    ds_read_b128 v[152:155], v236 offset:27648
    ds_read_b128 v[160:163], v236 offset:29696
    s_waitcnt lgkmcnt(8)
    v_mfma_f32_16x16x32_bf16 v[214:217], v[132:135], v[124:127], 0
    s_waitcnt lgkmcnt(7)
    ds_read_b128 v[164:167], v244 offset:22528
    v_mfma_f32_16x16x32_bf16 v[206:209], v[148:151], v[124:127], 0
    s_waitcnt lgkmcnt(7)
    ds_read_b128 v[168:171], v244 offset:23552
    s_add_u32 m0, s73, 24576
    v_mfma_f32_16x16x32_bf16 v[210:213], v[156:159], v[124:127], 0
    s_waitcnt lgkmcnt(4)
    s_add_u32 s94, s74, 49152
    buffer_load_dwordx4 v234, s[4:7], s94 offen sc1 lds
    v_mfma_f32_16x16x32_bf16 v[214:217], v[136:139], v[128:131], v[214:217]
    s_waitcnt lgkmcnt(3)
    v_mfma_f32_16x16x32_bf16 v[206:209], v[152:155], v[128:131], v[206:209]
    s_waitcnt lgkmcnt(2)
    v_mfma_f32_16x16x32_bf16 v[210:213], v[160:163], v[128:131], v[210:213]
    v_permlane32_swap_b32 v202, v204
    v_permlane32_swap_b32 v203, v205
    v_add_f32 v202, v202, v204
    v_add_f32 v203, v203, v205
    v_cndmask_b32 v214, v214, v215, s[98:99]
    v_cndmask_b32 v216, v216, v217, s[98:99]
    v_cndmask_b32 v224, v214, v216, s[100:101]
    s_nop 0
    v_cndmask_b32 v220, v206, v210, s[98:99]
    v_cndmask_b32 v221, v207, v211, s[98:99]
    v_cndmask_b32 v222, v208, v212, s[98:99]
    v_cndmask_b32 v223, v209, v213, s[98:99]
    v_cvt_pk_bf16_f32 v174, v202, v203
    v_cvt_pk_bf16_f32 v178, v202, v203
    ds_read_b128 v[124:127], v232 offset:0
    ds_read_b128 v[128:131], v232 offset:20480
    s_waitcnt lgkmcnt(3)
    v_mfma_f32_16x16x32_bf16 v[214:217], v[132:135], v[164:167], 0
    ds_read_b128 v[140:143], v232 offset:1024
    v_mfma_f32_16x16x32_bf16 v[206:209], v[148:151], v[164:167], v[188:191]
    v_mfma_f32_16x16x32_bf16 v[210:213], v[156:159], v[164:167], v[188:191]
    s_waitcnt lgkmcnt(3)
    v_mfma_f32_16x16x32_bf16 v[214:217], v[136:139], v[168:171], v[214:217]
    ds_read_b128 v[132:135], v233 offset:0
    v_mfma_f32_16x16x32_bf16 v[206:209], v[152:155], v[168:171], v[206:209]
    ds_read_b128 v[136:139], v233 offset:20480
    v_mfma_f32_16x16x32_bf16 v[210:213], v[160:163], v[168:171], v[210:213]
    s_waitcnt lgkmcnt(4)
    v_mfma_f32_16x16x32_bf16 v[148:151], a[0:3], v[124:127], 0
    ds_read_b128 v[144:147], v232 offset:21504
    s_nop 0
    v_cndmask_b32 v214, v214, v215, s[98:99]
    v_mfma_f32_16x16x32_bf16 v[156:159], a[80:83], v[124:127], 0
    v_cndmask_b32 v216, v216, v217, s[98:99]
    v_cndmask_b32 v230, v214, v216, s[100:101]
    v_mfma_f32_16x16x32_bf16 v[164:167], v[124:127], a[160:163], 0
    s_waitcnt lgkmcnt(4)
    v_bfi_b32 v230, 1, s97, v230
    v_cndmask_b32 v226, v206, v210, s[98:99]
    v_mfma_f32_16x16x32_bf16 v[152:155], a[0:3], v[128:131], 0
    ds_read_b128 v[124:127], v233 offset:1024
    v_cndmask_b32 v227, v207, v211, s[98:99]
    v_mfma_f32_16x16x32_bf16 v[160:163], a[80:83], v[128:131], 0
    v_cndmask_b32 v228, v208, v212, s[98:99]
    v_cndmask_b32 v229, v209, v213, s[98:99]
    v_mfma_f32_16x16x32_bf16 v[168:171], v[128:131], a[160:163], 0
    v_bfi_b32 v226, 1, s97, v226
    s_waitcnt lgkmcnt(3)
    v_mfma_f32_16x16x32_bf16 v[148:151], a[4:7], v[132:135], v[148:151]
    ds_read_b128 v[128:131], v233 offset:21504
    buffer_load_dwordx4 v[84:87], v236, s[4:7], s80 offen sc1
    v_mfma_f32_16x16x32_bf16 v[156:159], a[84:87], v[132:135], v[156:159]
    buffer_load_dwordx4 v[88:91], v236, s[4:7], s81 offen sc1
    buffer_load_dword v92, v237, s[4:7], s80 offen offset:1024 sc1
    v_mfma_f32_16x16x32_bf16 v[164:167], v[132:135], a[164:167], v[164:167]
    s_waitcnt lgkmcnt(3)
    buffer_load_dword v93, v237, s[4:7], s81 offen offset:1024 sc1
    v_mfma_f32_16x16x32_bf16 v[152:155], a[4:7], v[136:139], v[152:155]
    ds_read_b128 v[132:135], v232 offset:2048
    v_mfma_f32_16x16x32_bf16 v[160:163], a[84:87], v[136:139], v[160:163]
    v_mfma_f32_16x16x32_bf16 v[168:171], v[136:139], a[164:167], v[168:171]
    v_mfma_f32_16x16x32_bf16 v[148:151], a[8:11], v[140:143], v[148:151]
    ds_read_b128 v[136:139], v232 offset:22528
    v_mfma_f32_16x16x32_bf16 v[156:159], a[88:91], v[140:143], v[156:159]
    buffer_store_dwordx4 v[226:229], v238, s[4:7], s79 offen
    buffer_store_dword v230, v239, s[4:7], s79 offen offset:1024
    v_mfma_f32_16x16x32_bf16 v[164:167], v[140:143], a[168:171], v[164:167]
    s_waitcnt lgkmcnt(4)
    v_mfma_f32_16x16x32_bf16 v[152:155], a[8:11], v[144:147], v[152:155]
    ds_read_b128 v[140:143], v233 offset:2048
    v_mfma_f32_16x16x32_bf16 v[160:163], a[88:91], v[144:147], v[160:163]
    v_mfma_f32_16x16x32_bf16 v[168:171], v[144:147], a[168:171], v[168:171]
    s_waitcnt lgkmcnt(4)
    v_mfma_f32_16x16x32_bf16 v[148:151], a[12:15], v[124:127], v[148:151]
    ds_read_b128 v[144:147], v233 offset:22528
    v_mfma_f32_16x16x32_bf16 v[156:159], a[92:95], v[124:127], v[156:159]
    v_mfma_f32_16x16x32_bf16 v[164:167], v[124:127], a[172:175], v[164:167]
    s_waitcnt lgkmcnt(4)
    v_mfma_f32_16x16x32_bf16 v[152:155], a[12:15], v[128:131], v[152:155]
    ds_read_b128 v[124:127], v232 offset:3072
    v_mfma_f32_16x16x32_bf16 v[160:163], a[92:95], v[128:131], v[160:163]
    v_mfma_f32_16x16x32_bf16 v[168:171], v[128:131], a[172:175], v[168:171]
    s_waitcnt lgkmcnt(4)
    v_mfma_f32_16x16x32_bf16 v[148:151], a[16:19], v[132:135], v[148:151]
    ds_read_b128 v[128:131], v232 offset:23552
    v_mfma_f32_16x16x32_bf16 v[156:159], a[96:99], v[132:135], v[156:159]
    v_mfma_f32_16x16x32_bf16 v[164:167], v[132:135], a[176:179], v[164:167]
    s_waitcnt vmcnt(4)
    v_bitop3_b32 v218, v84, v88, s97 bitop3:0x7e
    s_waitcnt vmcnt(2)
    v_bitop3_b32 v219, v92, v93, s97 bitop3:0x7e
    v_bitop3_b32 v218, v218, v219, 1 bitop3:0xa8
    v_cmp_eq_u32 vcc, 1, v218
    s_cbranch_vccnz Lrty_43
    v_pk_add_f32 v[84:85], v[84:85], v[88:89]
    v_pk_add_f32 v[86:87], v[86:87], v[90:91]
    v_add_f32 v92, v92, v93
    v_pk_add_f32 v[220:221], v[220:221], v[84:85]
    v_pk_add_f32 v[222:223], v[222:223], v[86:87]
    v_add_f32 v224, v224, v92
Lok_42:
    v_max3_f32 v218, v220, v221, v222
    v_max3_f32 v218, v218, v223, v224
    buffer_load_dwordx4 v[108:111], v238, s[4:7], s80 offen sc1
    buffer_load_dwordx4 v[112:115], v238, s[4:7], s81 offen sc1
    v_max_f32_dpp v218, v218, v218 row_ror:8 row_mask:0xf bank_mask:0xf
    v_mov_b32 v219, v218
    buffer_load_dword v116, v239, s[4:7], s80 offen offset:1024 sc1
    buffer_load_dword v117, v239, s[4:7], s81 offen offset:1024 sc1
    v_permlane16_swap_b32 v218, v219
    v_max_f32 v218, v218, v219
    v_mov_b32 v219, v218
    v_mov_b64 v[206:207], 0
    v_mov_b64 v[208:209], 0
    v_permlane32_swap_b32 v218, v219
    v_max_f32 v218, v218, v219
    v_mul_f32 v218, s70, v218
    v_fma_f32 v224, v224, s70, -v218
    v_fma_f32 v220, v220, s70, -v218
    v_fma_f32 v221, v221, s70, -v218
    v_fma_f32 v222, v222, s70, -v218
    v_fma_f32 v223, v223, s70, -v218
    v_exp_f32 v224, v224
    v_exp_f32 v220, v220
    v_exp_f32 v221, v221
    v_exp_f32 v222, v222
    v_exp_f32 v223, v223
    v_cvt_pk_bf16_f32 v186, v224, v224
    v_cvt_pk_bf16_f32 v184, v220, v221
    v_and_b32 v186, v231, v186
    v_cvt_pk_bf16_f32 v185, v222, v223
    v_mov_b64 v[210:211], 0
    v_mov_b64 v[212:213], 0
    v_mfma_f32_16x16x32_bf16 v[202:205], v[180:183], v[184:187], 0
    s_nop 2
    v_mfma_f32_16x16x32_bf16 v[194:197], v[172:175], v[184:187], 0
    s_nop 2
    v_mfma_f32_16x16x32_bf16 v[198:201], v[176:179], v[184:187], 0
    s_nop 2
    s_waitcnt lgkmcnt(4)
    v_mfma_f32_16x16x32_bf16 v[152:155], a[16:19], v[136:139], v[152:155]
    s_nop 0
    ds_read_b128 v[132:135], v233 offset:3072
    v_add_f32_dpp v202, v202, v202 row_ror:8 row_mask:0xf bank_mask:0xf
    v_rcp_f32 v202, v202
    v_add_f32_dpp v194, v198, v194 row_ror:8 row_mask:0xf bank_mask:0xf
    v_add_f32_dpp v195, v199, v195 row_ror:8 row_mask:0xf bank_mask:0xf
    v_add_f32_dpp v196, v200, v196 row_ror:8 row_mask:0xf bank_mask:0xf
    v_add_f32_dpp v197, v201, v197 row_ror:8 row_mask:0xf bank_mask:0xf
    v_pk_mul_f32 v[194:195], v[194:195], v[202:203] op_sel_hi:[1,0]
    v_pk_mul_f32 v[196:197], v[196:197], v[202:203] op_sel_hi:[1,0]
    v_cvt_pk_bf16_f32 v194, v194, v195
    v_cvt_pk_bf16_f32 v195, v196, v197
    v_min_u32 v194, -2, v194
    buffer_store_dwordx2 v[194:195], v247, s[4:7], s72 offen
    v_mfma_f32_16x16x32_bf16 v[160:163], a[96:99], v[136:139], v[160:163]
    s_waitcnt vmcnt(3)
    v_bitop3_b32 v218, v108, v112, s97 bitop3:0x7e
    s_waitcnt vmcnt(1)
    v_bitop3_b32 v219, v116, v117, s97 bitop3:0x7e
    v_bitop3_b32 v218, v218, v219, 1 bitop3:0xa8
    v_cmp_eq_u32 vcc, 1, v218
    s_cbranch_vccnz Lrty_45
Lok_44:
    v_mfma_f32_16x16x32_bf16 v[168:171], v[136:139], a[176:179], v[168:171]
    s_waitcnt lgkmcnt(4)
    v_add_f32 v108, v108, v112
    v_add_f32 v109, v109, v113
    v_mfma_f32_16x16x32_bf16 v[148:151], a[20:23], v[140:143], v[148:151]
    ds_read_b128 v[136:139], v233 offset:23552
    v_add_f32 v110, v110, v114
    v_mfma_f32_16x16x32_bf16 v[156:159], a[100:103], v[140:143], v[156:159]
    v_add_f32 v111, v111, v115
    v_add_f32 v116, v116, v117
    v_mfma_f32_16x16x32_bf16 v[164:167], v[140:143], a[180:183], v[164:167]
    s_waitcnt lgkmcnt(4)
    v_add_f32 v226, v226, v108
    v_add_f32 v227, v227, v109
    v_mfma_f32_16x16x32_bf16 v[152:155], a[20:23], v[144:147], v[152:155]
    ds_read_b128 v[140:143], v232 offset:4096
    v_add_f32 v228, v228, v110
    v_mfma_f32_16x16x32_bf16 v[160:163], a[100:103], v[144:147], v[160:163]
    v_add_f32 v229, v229, v111
    v_add_f32 v230, v230, v116
    v_mfma_f32_16x16x32_bf16 v[168:171], v[144:147], a[180:183], v[168:171]
    s_waitcnt lgkmcnt(4)
    v_max3_f32 v218, v226, v227, v228
    v_max3_f32 v218, v218, v229, v230
    v_mfma_f32_16x16x32_bf16 v[148:151], a[24:27], v[124:127], v[148:151]
    ds_read_b128 v[144:147], v232 offset:24576
    v_max_f32_dpp v218, v218, v218 row_ror:8 row_mask:0xf bank_mask:0xf
    v_mfma_f32_16x16x32_bf16 v[156:159], a[104:107], v[124:127], v[156:159]
    v_mov_b32 v219, v218
    s_nop 0
    v_mfma_f32_16x16x32_bf16 v[164:167], v[124:127], a[184:187], v[164:167]
    s_waitcnt lgkmcnt(4)
    v_permlane16_swap_b32 v218, v219
    v_mfma_f32_16x16x32_bf16 v[152:155], a[24:27], v[128:131], v[152:155]
    ds_read_b128 v[124:127], v233 offset:4096
    v_max_f32 v218, v218, v219
    v_mfma_f32_16x16x32_bf16 v[160:163], a[104:107], v[128:131], v[160:163]
    buffer_load_dwordx4 v[84:87], v248, s[4:7], s85 offen offset:0 sc1
    v_mov_b32 v219, v218
    v_mfma_f32_16x16x32_bf16 v[168:171], v[128:131], a[184:187], v[168:171]
    s_waitcnt lgkmcnt(4)
    v_permlane32_swap_b32 v218, v219
    v_mfma_f32_16x16x32_bf16 v[148:151], a[28:31], v[132:135], v[148:151]
    ds_read_b128 v[128:131], v233 offset:24576
    buffer_load_dwordx4 v[88:91], v248, s[4:7], s85 offen offset:1024 sc1
    v_mfma_f32_16x16x32_bf16 v[156:159], a[108:111], v[132:135], v[156:159]
    v_max_f32 v218, v218, v219
    v_mul_f32 v218, s70, v218
    v_mfma_f32_16x16x32_bf16 v[164:167], v[132:135], a[188:191], v[164:167]
    s_waitcnt lgkmcnt(4)
    buffer_load_dwordx4 v[92:95], v248, s[4:7], s85 offen offset:2048 sc1
    v_fma_f32 v230, v230, s70, -v218
    v_mfma_f32_16x16x32_bf16 v[152:155], a[28:31], v[136:139], v[152:155]
    ds_read_b128 v[132:135], v232 offset:5120
    v_fma_f32 v226, v226, s70, -v218
    v_mfma_f32_16x16x32_bf16 v[160:163], a[108:111], v[136:139], v[160:163]
    buffer_load_dwordx4 v[96:99], v248, s[4:7], s85 offen offset:3072 sc1
    v_fma_f32 v227, v227, s70, -v218
    v_mfma_f32_16x16x32_bf16 v[168:171], v[136:139], a[188:191], v[168:171]
    s_waitcnt lgkmcnt(4)
    v_fma_f32 v228, v228, s70, -v218
    v_fma_f32 v229, v229, s70, -v218
    v_mfma_f32_16x16x32_bf16 v[148:151], a[32:35], v[140:143], v[148:151]
    ds_read_b128 v[136:139], v232 offset:25600
    buffer_load_dwordx4 v[100:103], v248, s[4:7], s86 offen offset:0 sc1
    v_mfma_f32_16x16x32_bf16 v[156:159], a[112:115], v[140:143], v[156:159]
    v_exp_f32 v230, v230
    v_mfma_f32_16x16x32_bf16 v[164:167], v[140:143], a[192:195], v[164:167]
    s_waitcnt lgkmcnt(4)
    buffer_load_dwordx4 v[104:107], v248, s[4:7], s86 offen offset:1024 sc1
    v_mfma_f32_16x16x32_bf16 v[152:155], a[32:35], v[144:147], v[152:155]
    ds_read_b128 v[140:143], v233 offset:5120
    v_mfma_f32_16x16x32_bf16 v[160:163], a[112:115], v[144:147], v[160:163]
    v_exp_f32 v226, v226
    v_mfma_f32_16x16x32_bf16 v[168:171], v[144:147], a[192:195], v[168:171]
    v_exp_f32 v227, v227
Lwchk_46:
    s_waitcnt vmcnt(5)
    v_max_u32 v194, v84, v86
    s_waitcnt vmcnt(4)
    v_max3_u32 v194, v194, v88, v90
    v_cmp_lt_u32 vcc, s87, v194
    s_cbranch_vccnz Lwrty_47
    v_smfmac_f32_16x16x64_bf16 v[206:209], v[84:87], a[240:247], v187
    v_exp_f32 v228, v228
    v_smfmac_f32_16x16x64_bf16 v[210:213], v[84:87], a[248:255], v187
    v_exp_f32 v229, v229
    v_smfmac_f32_16x16x64_bf16 v[206:209], v[88:91], v[4:11], v187
    v_cvt_pk_bf16_f32 v200, v230, v230
    v_smfmac_f32_16x16x64_bf16 v[210:213], v[88:91], v[12:19], v187
Lwchk_48:
    s_waitcnt vmcnt(3)
    v_max_u32 v194, v92, v94
    s_waitcnt vmcnt(2)
    v_max3_u32 v194, v194, v96, v98
    v_cmp_lt_u32 vcc, s87, v194
    s_cbranch_vccnz Lwrty_49
    v_smfmac_f32_16x16x64_bf16 v[206:209], v[92:95], v[20:27], v187
    v_cvt_pk_bf16_f32 v198, v226, v227
    v_smfmac_f32_16x16x64_bf16 v[210:213], v[92:95], v[28:35], v187
    v_cvt_pk_bf16_f32 v199, v228, v229
    v_smfmac_f32_16x16x64_bf16 v[206:209], v[96:99], v[36:43], v187
    ds_write_b16 v246, v200 offset:14344
    v_smfmac_f32_16x16x64_bf16 v[210:213], v[96:99], v[44:51], v187
Lwchk_50:
    s_waitcnt vmcnt(1)
    v_max_u32 v194, v100, v102
    s_waitcnt vmcnt(0)
    v_max3_u32 v194, v194, v104, v106
    v_cmp_lt_u32 vcc, s87, v194
    s_cbranch_vccnz Lwrty_51
    v_smfmac_f32_16x16x64_bf16 v[206:209], v[100:103], v[52:59], v187
    ds_write_b64 v245, v[198:199] offset:14336
    v_smfmac_f32_16x16x64_bf16 v[210:213], v[100:103], v[60:67], v187
    v_smfmac_f32_16x16x64_bf16 v[206:209], v[104:107], v[68:75], v187
    v_smfmac_f32_16x16x64_bf16 v[210:213], v[104:107], v[76:83], v187
    s_nop 2
    s_waitcnt lgkmcnt(6)
    v_mfma_f32_16x16x32_bf16 v[148:151], a[36:39], v[124:127], v[148:151]
    s_nop 0
    ds_read_b128 v[144:147], v233 offset:25600
    s_nop 0
    v_mfma_f32_16x16x32_bf16 v[156:159], a[116:119], v[124:127], v[156:159]
    v_permlane32_swap_b32 v206, v210
    v_permlane32_swap_b32 v207, v211
    v_permlane32_swap_b32 v208, v212
    v_permlane32_swap_b32 v209, v213
    v_pk_add_f32 v[206:207], v[206:207], v[210:211]
    v_pk_add_f32 v[208:209], v[208:209], v[212:213]
    ds_write2_b32 v249, v206, v207 offset0:0 offset1:32
    ds_write2_b32 v249, v208, v209 offset0:64 offset1:96
    v_mfma_f32_16x16x32_bf16 v[164:167], v[124:127], a[196:199], v[164:167]
    s_waitcnt lgkmcnt(8)
    v_mfma_f32_16x16x32_bf16 v[152:155], a[36:39], v[128:131], v[152:155]
    ds_read_b128 v[124:127], v232 offset:6144
    v_mfma_f32_16x16x32_bf16 v[160:163], a[116:119], v[128:131], v[160:163]
    v_mfma_f32_16x16x32_bf16 v[168:171], v[128:131], a[196:199], v[168:171]
    s_waitcnt lgkmcnt(1)
    s_barrier
    buffer_load_dword v2, v252, s[4:7], 0 offen sc1
    ds_read_b64 v[120:121], v240 offset:16896
    v_mfma_f32_16x16x32_bf16 v[148:151], a[40:43], v[132:135], v[148:151]
    ds_read_b128 v[128:131], v232 offset:26624
    ds_read_b128 v[112:115], v236 offset:14336
    v_mfma_f32_16x16x32_bf16 v[156:159], a[120:123], v[132:135], v[156:159]
    ds_read_b128 v[116:119], v236 offset:15872
    v_mfma_f32_16x16x32_bf16 v[164:167], v[132:135], a[200:203], v[164:167]
    v_mfma_f32_16x16x32_bf16 v[152:155], a[40:43], v[136:139], v[152:155]
    ds_read_b128 v[132:135], v233 offset:6144
    s_waitcnt lgkmcnt(4)
    v_mfma_f32_16x16x16_bf16 v[206:209], v[180:181], v[120:121], 0
    v_mfma_f32_16x16x16_bf16 v[198:201], v[176:177], v[120:121], 0
    s_waitcnt lgkmcnt(2)
    v_mfma_f32_16x16x32_bf16 v[202:205], v[180:183], v[112:115], 0
    buffer_store_dword v192, v247, s[4:7], s96 offen
    v_mfma_f32_16x16x32_bf16 v[194:197], v[172:175], v[112:115], 0
    v_mfma_f32_16x16x32_bf16 v[160:163], a[120:123], v[136:139], v[160:163]
    v_mfma_f32_16x16x32_bf16 v[168:171], v[136:139], a[200:203], v[168:171]
    v_mfma_f32_16x16x32_bf16 v[148:151], a[44:47], v[140:143], v[148:151]
    ds_read_b128 v[136:139], v233 offset:26624
    s_waitcnt lgkmcnt(2)
    v_mfma_f32_16x16x32_bf16 v[206:209], v[180:183], v[116:119], v[206:209]
    v_mfma_f32_16x16x32_bf16 v[198:201], v[172:175], v[116:119], v[198:201]
    v_mfma_f32_16x16x32_bf16 v[156:159], a[124:127], v[140:143], v[156:159]
    v_rcp_f32 v202, v202
    v_mfma_f32_16x16x32_bf16 v[164:167], v[140:143], a[204:207], v[164:167]
    v_mul_f32 v194, v194, v202
    v_mul_f32 v195, v195, v202
    v_mfma_f32_16x16x32_bf16 v[152:155], a[44:47], v[144:147], v[152:155]
    ds_read_b128 v[140:143], v232 offset:7168
    v_mul_f32 v196, v196, v202
    v_mfma_f32_16x16x32_bf16 v[160:163], a[124:127], v[144:147], v[160:163]
    v_mul_f32 v197, v197, v202
    v_cvt_pk_bf16_f32 v210, v194, v195
    v_mfma_f32_16x16x32_bf16 v[168:171], v[144:147], a[204:207], v[168:171]
    v_cvt_pk_bf16_f32 v211, v196, v197
    v_mfma_f32_16x16x32_bf16 v[148:151], a[48:51], v[124:127], v[148:151]
    ds_read_b128 v[144:147], v232 offset:27648
    v_mfma_f32_16x16x32_bf16 v[156:159], a[128:131], v[124:127], v[156:159]
    buffer_store_dwordx2 v[210:211], v243, s[4:7], s75 offen offset:0
    v_rcp_f32 v206, v206
    s_nop 0
    v_mfma_f32_16x16x32_bf16 v[164:167], v[124:127], a[208:211], v[164:167]
    v_mul_f32 v198, v198, v206
    v_mul_f32 v199, v199, v206
    v_mfma_f32_16x16x32_bf16 v[152:155], a[48:51], v[128:131], v[152:155]
    ds_read_b128 v[124:127], v233 offset:7168
    v_mul_f32 v200, v200, v206
    v_mfma_f32_16x16x32_bf16 v[160:163], a[128:131], v[128:131], v[160:163]
    v_mul_f32 v201, v201, v206
    v_cvt_pk_bf16_f32 v212, v198, v199
    v_mfma_f32_16x16x32_bf16 v[168:171], v[128:131], a[208:211], v[168:171]
    s_waitcnt lgkmcnt(4)
    v_cvt_pk_bf16_f32 v213, v200, v201
    v_mfma_f32_16x16x32_bf16 v[148:151], a[52:55], v[132:135], v[148:151]
    ds_read_b128 v[128:131], v233 offset:27648
    v_mfma_f32_16x16x32_bf16 v[156:159], a[132:135], v[132:135], v[156:159]
    buffer_store_dwordx2 v[212:213], v243, s[4:7], s75 offen offset:2048
    s_cmp_eq_u32 s62, 63
    s_cbranch_scc1 L_Clast
    v_mfma_f32_16x16x32_bf16 v[164:167], v[132:135], a[212:215], v[164:167]
    s_add_u32 s75, s75, 393216
    s_add_u32 s66, s62, 1
    s_waitcnt lgkmcnt(4)
    v_mfma_f32_16x16x32_bf16 v[152:155], a[52:55], v[136:139], v[152:155]
    s_add_u32 s82, s72, 178176
    ds_read_b128 v[132:135], v232 offset:8192
    s_add_u32 s83, s72, 182272
    v_mfma_f32_16x16x32_bf16 v[160:163], a[132:135], v[136:139], v[160:163]
    s_add_u32 m0, s73, 28672
    s_add_u32 s94, s74, 53248
    buffer_load_dwordx4 v234, s[4:7], s94 offen sc1 lds
    v_mfma_f32_16x16x32_bf16 v[168:171], v[136:139], a[212:215], v[168:171]
    s_waitcnt lgkmcnt(4)
    s_and_b32 s66, s66, 7
    s_cselect_b32 s66, 0, 3145728
    v_mfma_f32_16x16x32_bf16 v[148:151], a[56:59], v[140:143], v[148:151]
    s_add_u32 m0, s73, 32768
    ds_read_b128 v[136:139], v232 offset:28672
    s_add_u32 s94, s74, 65536
    v_mfma_f32_16x16x32_bf16 v[156:159], a[136:139], v[140:143], v[156:159]
    s_sub_u32 s75, s75, s66
    buffer_load_dwordx4 v234, s[4:7], s94 offen sc1 lds
    v_mov_b64 v[194:195], 0
    v_mfma_f32_16x16x32_bf16 v[164:167], v[140:143], a[216:219], v[164:167]
    s_waitcnt lgkmcnt(4)
    v_mov_b64 v[196:197], 0
    v_mov_b64 v[198:199], 0
    v_mfma_f32_16x16x32_bf16 v[152:155], a[56:59], v[144:147], v[152:155]
    s_add_u32 m0, s73, 36864
    ds_read_b128 v[140:143], v233 offset:8192
    s_add_u32 s94, s74, 69632
    v_mfma_f32_16x16x32_bf16 v[160:163], a[136:139], v[144:147], v[160:163]
    buffer_load_dwordx4 v234, s[4:7], s94 offen sc1 lds
    v_mov_b64 v[200:201], 0
    v_mfma_f32_16x16x32_bf16 v[168:171], v[144:147], a[216:219], v[168:171]
    s_waitcnt lgkmcnt(4)
    v_mov_b64 v[202:203], 0
    v_mov_b64 v[204:205], 0
    v_mfma_f32_16x16x32_bf16 v[148:151], a[60:63], v[124:127], v[148:151]
    ds_read_b128 v[144:147], v233 offset:28672
    v_mfma_f32_16x16x32_bf16 v[156:159], a[140:143], v[124:127], v[156:159]
    v_mfma_f32_16x16x32_bf16 v[164:167], v[124:127], a[220:223], v[164:167]
    s_waitcnt lgkmcnt(4)
    v_mfma_f32_16x16x32_bf16 v[152:155], a[60:63], v[128:131], v[152:155]
    ds_read_b128 v[124:127], v232 offset:9216
    v_mfma_f32_16x16x32_bf16 v[160:163], a[140:143], v[128:131], v[160:163]
    v_mfma_f32_16x16x32_bf16 v[168:171], v[128:131], a[220:223], v[168:171]
    s_waitcnt lgkmcnt(4)
    v_mfma_f32_16x16x32_bf16 v[148:151], a[64:67], v[132:135], v[148:151]
    ds_read_b128 v[128:131], v232 offset:29696
    v_mfma_f32_16x16x32_bf16 v[156:159], a[144:147], v[132:135], v[156:159]
    v_add_u32_e64 v218, s62, 1
    v_mfma_f32_16x16x32_bf16 v[164:167], v[132:135], a[224:227], v[164:167]
    s_waitcnt lgkmcnt(4)
    s_waitcnt vmcnt(3)
    buffer_store_dword v218, v1, s[4:7], s3 offen
    v_lshl_add_u32 v3, s62, 1, v225
    v_mfma_f32_16x16x32_bf16 v[152:155], a[64:67], v[136:139], v[152:155]
    ds_read_b128 v[132:135], v233 offset:9216
    v_min_i32 v3, 128, v3
    v_mfma_f32_16x16x32_bf16 v[160:163], a[144:147], v[136:139], v[160:163]
Lfchk_52:
    v_cmp_gt_i32 vcc, v3, v2
    s_cbranch_vccnz Lfrty_53
    v_mfma_f32_16x16x32_bf16 v[168:171], v[136:139], a[224:227], v[168:171]
    s_waitcnt lgkmcnt(4)
    v_mfma_f32_16x16x32_bf16 v[148:151], a[68:71], v[140:143], v[148:151]
    ds_read_b128 v[136:139], v233 offset:29696
    v_mfma_f32_16x16x32_bf16 v[156:159], a[148:151], v[140:143], v[156:159]
    v_mfma_f32_16x16x32_bf16 v[164:167], v[140:143], a[228:231], v[164:167]
    s_waitcnt lgkmcnt(4)
    v_mfma_f32_16x16x32_bf16 v[152:155], a[68:71], v[144:147], v[152:155]
    v_mfma_f32_16x16x32_bf16 v[160:163], a[148:151], v[144:147], v[160:163]
    v_mfma_f32_16x16x32_bf16 v[168:171], v[144:147], a[228:231], v[168:171]
    s_barrier
    s_waitcnt lgkmcnt(3)
    v_mfma_f32_16x16x32_bf16 v[148:151], a[72:75], v[124:127], v[148:151]
    s_add_u32 s86, s72, 262144
    buffer_load_dwordx4 v[206:209], v234, s[4:7], s82 offen sc1
    buffer_load_dwordx4 v[214:217], v234, s[4:7], s83 offen sc1
    v_mfma_f32_16x16x32_bf16 v[156:159], a[152:155], v[124:127], v[156:159]
    s_and_b32 s86, s86, 786432
    buffer_load_dwordx2 v[210:211], v235, s[4:7], s82 offen sc1
    s_andn2_b32 s72, s72, 786432
    v_mfma_f32_16x16x32_bf16 v[164:167], v[124:127], a[232:235], v[164:167]
    s_waitcnt lgkmcnt(2)
    s_or_b32 s72, s72, s86
    s_mov_b32 s74, s92
    v_mfma_f32_16x16x32_bf16 v[152:155], a[72:75], v[128:131], v[152:155]
    s_xor_b32 s73, s73, 65536
    s_add_u32 s91, s91, 131072
    s_lshr_b32 s92, s91, 8
    v_mfma_f32_16x16x32_bf16 v[160:163], a[152:155], v[128:131], v[160:163]
    s_xor_b32 s92, s92, s1
    s_and_b32 s92, s92, s93
    s_or_b32 s92, s92, s91
    v_mfma_f32_16x16x32_bf16 v[168:171], v[128:131], a[232:235], v[168:171]
    s_waitcnt lgkmcnt(1)
    s_xor_b32 s27, s27, 65536
    v_mfma_f32_16x16x32_bf16 v[148:151], a[76:79], v[132:135], v[148:151]
    v_mfma_f32_16x16x32_bf16 v[156:159], a[156:159], v[132:135], v[156:159]
    v_mfma_f32_16x16x32_bf16 v[164:167], v[132:135], a[236:239], v[164:167]
    s_waitcnt lgkmcnt(0)
    v_mfma_f32_16x16x32_bf16 v[152:155], a[76:79], v[136:139], v[152:155]
    v_mfma_f32_16x16x32_bf16 v[160:163], a[156:159], v[136:139], v[160:163]
    v_mfma_f32_16x16x32_bf16 v[168:171], v[136:139], a[236:239], v[168:171]
    v_xor_b32 v232, 0x10000, v232
    v_xor_b32 v233, 0x10000, v233
    v_cvt_pk_bf16_f32 v148, v148, v149
    v_cvt_pk_bf16_f32 v149, v150, v151
    ds_write_b64 v243, v[148:149] offset:22528
    s_nop 0
    v_cvt_pk_bf16_f32 v152, v152, v153
    v_cvt_pk_bf16_f32 v153, v154, v155
    ds_write_b64 v243, v[152:153] offset:24576
    v_cvt_pk_bf16_f32 v156, v156, v157
    v_cvt_pk_bf16_f32 v157, v158, v159
    ds_write_b64 v243, v[156:157] offset:26624
    v_cvt_pk_bf16_f32 v160, v160, v161
    v_cvt_pk_bf16_f32 v161, v162, v163
    ds_write_b64 v243, v[160:161] offset:28672
    v_cvt_pk_bf16_f32 v172, v164, v165
    v_cvt_pk_bf16_f32 v173, v166, v167
    v_cvt_pk_bf16_f32 v176, v168, v169
    v_cvt_pk_bf16_f32 v177, v170, v171
    s_add_u32 s62, s62, 1
    s_branch L_Ctop0
Lrty_41:
    v_max_u32 v218, v206, v208
    v_cmp_lt_u32 s[12:13], -2, v218
    v_max_u32 v218, v214, v216
    v_cmp_lt_u32 s[14:15], -2, v218
    v_cmp_lt_u32 s[16:17], -2, v210
    s_mov_b64 exec, s[12:13]
    buffer_load_dwordx4 v[206:209], v234, s[4:7], s82 offen sc1
    s_mov_b64 exec, s[14:15]
    buffer_load_dwordx4 v[214:217], v234, s[4:7], s83 offen sc1
    s_mov_b64 exec, s[16:17]
    buffer_load_dwordx2 v[210:211], v235, s[4:7], s82 offen sc1
    s_mov_b64 exec, -1
    s_sub_u32 s61, s61, 1
    s_mov_b32 s67, 15
    s_cbranch_scc1 L_fail
    s_waitcnt vmcnt(0)
    v_max3_u32 v218, v206, v208, v214
    v_max3_u32 v218, v218, v216, v210
    v_cmp_lt_u32 vcc, -2, v218
    s_cbranch_vccnz Lrty_41
    ds_write_b128 v234, v[206:209] offset:0
    ds_write_b128 v234, v[214:217] offset:4096
    ds_write_b64 v235, v[210:211] offset:0
    s_branch Lok_40
Lrty_43:
    buffer_load_dwordx4 v[84:87], v236, s[4:7], s80 offen sc1
    buffer_load_dwordx4 v[88:91], v236, s[4:7], s81 offen sc1
    buffer_load_dword v92, v237, s[4:7], s80 offen offset:1024 sc1
    buffer_load_dword v93, v237, s[4:7], s81 offen offset:1024 sc1
    s_sub_u32 s61, s61, 1
    s_mov_b32 s67, 11
    s_cbranch_scc1 L_fail
    s_waitcnt vmcnt(2)
    v_bitop3_b32 v218, v84, v88, s97 bitop3:0x7e
    s_waitcnt vmcnt(0)
    v_bitop3_b32 v219, v92, v93, s97 bitop3:0x7e
    v_bitop3_b32 v218, v218, v219, 1 bitop3:0xa8
    v_cmp_eq_u32 vcc, 1, v218
    s_cbranch_vccnz Lrty_43
    v_pk_add_f32 v[84:85], v[84:85], v[88:89]
    v_pk_add_f32 v[86:87], v[86:87], v[90:91]
    v_add_f32 v92, v92, v93
    v_pk_add_f32 v[220:221], v[220:221], v[84:85]
    v_pk_add_f32 v[222:223], v[222:223], v[86:87]
    v_add_f32 v224, v224, v92
    s_branch Lok_42
Lrty_45:
    buffer_load_dwordx4 v[108:111], v238, s[4:7], s80 offen sc1
    buffer_load_dwordx4 v[112:115], v238, s[4:7], s81 offen sc1
    buffer_load_dword v116, v239, s[4:7], s80 offen offset:1024 sc1
    buffer_load_dword v117, v239, s[4:7], s81 offen offset:1024 sc1
    s_sub_u32 s61, s61, 1
    s_mov_b32 s67, 12
    s_cbranch_scc1 L_fail
    s_waitcnt vmcnt(2)
    v_bitop3_b32 v218, v108, v112, s97 bitop3:0x7e
    s_waitcnt vmcnt(0)
    v_bitop3_b32 v219, v116, v117, s97 bitop3:0x7e
    v_bitop3_b32 v218, v218, v219, 1 bitop3:0xa8
    v_cmp_eq_u32 vcc, 1, v218
    s_cbranch_vccnz Lrty_45
    s_branch Lok_44
Lwrty_47:
    buffer_load_dwordx4 v[84:87], v248, s[4:7], s85 offen offset:0 sc1
    buffer_load_dwordx4 v[88:91], v248, s[4:7], s85 offen offset:1024 sc1
    buffer_load_dwordx4 v[92:95], v248, s[4:7], s85 offen offset:2048 sc1
    buffer_load_dwordx4 v[96:99], v248, s[4:7], s85 offen offset:3072 sc1
    buffer_load_dwordx4 v[100:103], v248, s[4:7], s86 offen offset:0 sc1
    buffer_load_dwordx4 v[104:107], v248, s[4:7], s86 offen offset:1024 sc1
    s_sub_u32 s61, s61, 1
    s_mov_b32 s67, 13
    s_cbranch_scc1 L_fail
    s_branch Lwchk_46
Lwrty_49:
    buffer_load_dwordx4 v[92:95], v248, s[4:7], s85 offen offset:2048 sc1
    buffer_load_dwordx4 v[96:99], v248, s[4:7], s85 offen offset:3072 sc1
    buffer_load_dwordx4 v[100:103], v248, s[4:7], s86 offen offset:0 sc1
    buffer_load_dwordx4 v[104:107], v248, s[4:7], s86 offen offset:1024 sc1
    s_sub_u32 s61, s61, 1
    s_mov_b32 s67, 13
    s_cbranch_scc1 L_fail
    s_branch Lwchk_48
Lwrty_51:
    buffer_load_dwordx4 v[100:103], v248, s[4:7], s86 offen offset:0 sc1
    buffer_load_dwordx4 v[104:107], v248, s[4:7], s86 offen offset:1024 sc1
    s_sub_u32 s61, s61, 1
    s_mov_b32 s67, 13
    s_cbranch_scc1 L_fail
    s_branch Lwchk_50
Lfrty_53:
    s_sleep 2
    buffer_load_dword v2, v252, s[4:7], 0 offen sc1
    s_sub_u32 s61, s61, 1
    s_mov_b32 s67, 10
    s_cbranch_scc1 L_fail
    s_waitcnt vmcnt(0)
    s_branch Lfchk_52
L_Clast:
    s_waitcnt vmcnt(0)
    v_mov_b32 v194, 64
    s_mov_b64 exec, 1
    buffer_store_dword v194, off, s[4:7], s3
    s_mov_b64 exec, -1
    s_endpgm
L_roleT:
    s_mov_b32 s24, s42
    s_mov_b32 s25, s43
    s_mov_b32 s26, 7864320
    s_mov_b32 s27, 0x20000
    v_and_b32 v1, 63, v0
    s_and_b32 s75, s59, 1
    s_bfe_u32 s76, s59, 0x10001
    s_lshl_b32 s64, s69, 1
    s_add_u32 s76, s76, s64
    s_mul_i32 s64, s76, 983040
    s_mul_i32 s65, s60, 10240
    s_add_u32 s64, s64, s65
    s_lshl_b32 s65, s75, 8
    s_add_u32 s65, s65, s64
    v_lshrrev_b32 v164, 4, v1
    v_mul_u32_u24 v164, 1280, v164
    v_and_b32 v166, 15, v1
    v_lshl_add_u32 v164, v166, 4, v164
    v_add_u32 v164, s65, v164
    s_lshl_b32 s65, s75, 7
    s_add_u32 s65, s65, s64
    s_add_u32 s65, s65, 1024
    v_lshrrev_b32 v165, 3, v1
    v_mul_u32_u24 v165, 1280, v165
    v_and_b32 v166, 7, v1
    v_lshl_add_u32 v165, v166, 4, v165
    v_add_u32 v165, s65, v165
    v_lshrrev_b32 v166, 4, v1
    v_lshlrev_b32 v166, 3, v166
    v_bfe_u32 v167, v1, 2, 2
    v_add_u32 v166, v166, v167
    v_and_b32 v167, 3, v1
    v_lshlrev_b32 v168, 7, v166
    v_lshl_add_u32 v168, v167, 3, v168
    s_lshl_b32 s64, s60, 5
    v_add_u32 v168, s64, v168
    v_lshlrev_b32 v166, 1, v168
    v_add_u32 v167, 40960, v166
    v_add_u32 v169, 40960, v168
    v_lshlrev_b32 v238, 4, v0
    v_lshlrev_b32 v239, 4, v1
    s_lshl_b32 s64, s60, 14
    s_add_u32 s64, s64, 98304
    v_add_u32 v240, s64, v239
    s_lshl_b32 s70, s60, 11
    s_lshl_b32 s72, s60, 10
    s_mov_b32 s64, 0
    s_add_u32 m0, s70, 0
    s_nop 0
    buffer_load_dwordx4 v164, s[24:27], s64 offen lds
    s_mov_b32 s64, 5120
    s_add_u32 m0, s70, 1024
    s_nop 0
    buffer_load_dwordx4 v164, s[24:27], s64 offen lds
    s_mov_b32 s64, 512
    s_add_u32 m0, s70, 8192
    s_nop 0
    buffer_load_dwordx4 v164, s[24:27], s64 offen lds
    s_mov_b32 s64, 5632
    s_add_u32 m0, s70, 9216
    s_nop 0
    buffer_load_dwordx4 v164, s[24:27], s64 offen lds
    s_mov_b32 s64, 0
    s_add_u32 m0, s72, 16384
    s_nop 0
    buffer_load_dwordx4 v165, s[24:27], s64 offen lds
    s_mov_b32 s64, 40960
    s_add_u32 m0, s70, 20480
    s_nop 0
    buffer_load_dwordx4 v164, s[24:27], s64 offen lds
    s_mov_b32 s64, 46080
    s_add_u32 m0, s70, 21504
    s_nop 0
    buffer_load_dwordx4 v164, s[24:27], s64 offen lds
    s_mov_b32 s64, 41472
    s_add_u32 m0, s70, 28672
    s_nop 0
    buffer_load_dwordx4 v164, s[24:27], s64 offen lds
    s_mov_b32 s64, 46592
    s_add_u32 m0, s70, 29696
    s_nop 0
    buffer_load_dwordx4 v164, s[24:27], s64 offen lds
    s_mov_b32 s64, 40960
    s_add_u32 m0, s72, 36864
    s_nop 0
    buffer_load_dwordx4 v165, s[24:27], s64 offen lds
    s_mov_b32 s64, 81920
    s_add_u32 m0, s70, 40960
    s_nop 0
    buffer_load_dwordx4 v164, s[24:27], s64 offen lds
    s_mov_b32 s64, 87040
    s_add_u32 m0, s70, 41984
    s_nop 0
    buffer_load_dwordx4 v164, s[24:27], s64 offen lds
    s_mov_b32 s64, 82432
    s_add_u32 m0, s70, 49152
    s_nop 0
    buffer_load_dwordx4 v164, s[24:27], s64 offen lds
    s_mov_b32 s64, 87552
    s_add_u32 m0, s70, 50176
    s_nop 0
    buffer_load_dwordx4 v164, s[24:27], s64 offen lds
    s_mov_b32 s64, 81920
    s_add_u32 m0, s72, 57344
    s_nop 0
    buffer_load_dwordx4 v165, s[24:27], s64 offen lds
    s_cmp_lg_u32 s68, 0
    s_cbranch_scc1 Larr0_54
    s_waitcnt vmcnt(15)
    s_barrier
    s_cmp_lg_u32 s60, 0
    s_cbranch_scc1 Lcnt_55
    s_mov_b64 exec, 1
    v_mov_b32 v2, 1
    buffer_atomic_add v2, off, s[8:11], 0 offset:4 sc0
    s_mov_b64 exec, -1
Lcnt_55:
Larr0_54:
    s_waitcnt vmcnt(10)
    s_waitcnt lgkmcnt(0)
    s_barrier
    s_mov_b32 s64, 122880
    s_add_u32 m0, s70, 61440
    s_nop 0
    buffer_load_dwordx4 v164, s[24:27], s64 offen lds
    s_mov_b32 s64, 128000
    s_add_u32 m0, s70, 62464
    s_nop 0
    buffer_load_dwordx4 v164, s[24:27], s64 offen lds
    s_mov_b32 s64, 123392
    s_add_u32 m0, s70, 69632
    s_nop 0
    buffer_load_dwordx4 v164, s[24:27], s64 offen lds
    s_mov_b32 s64, 128512
    s_add_u32 m0, s70, 70656
    s_nop 0
    buffer_load_dwordx4 v164, s[24:27], s64 offen lds
    s_mov_b32 s64, 122880
    s_add_u32 m0, s72, 77824
    s_nop 0
    buffer_load_dwordx4 v165, s[24:27], s64 offen lds
    ds_read_b64_tr_b16 a[0:1], v166 offset:0
    ds_read_b64_tr_b16 a[2:3], v166 offset:1024
    ds_read_b64_tr_b16 a[4:5], v166 offset:8
    ds_read_b64_tr_b16 a[6:7], v166 offset:1032
    ds_read_b64_tr_b16 a[8:9], v166 offset:8192
    ds_read_b64_tr_b16 a[10:11], v166 offset:9216
    ds_read_b64_tr_b16 a[12:13], v166 offset:8200
    ds_read_b64_tr_b16 a[14:15], v166 offset:9224
    ds_read_b64_tr_b16 v[220:221], v168 offset:16384
    ds_read_b64_tr_b16 v[222:223], v168 offset:16896
    s_waitcnt lgkmcnt(0)
    ds_write_b128 v240, v[220:223] offset:0
    s_waitcnt vmcnt(10)
    s_waitcnt lgkmcnt(0)
    s_barrier
    s_mov_b32 s64, 163840
    s_add_u32 m0, s70, 0
    s_nop 0
    buffer_load_dwordx4 v164, s[24:27], s64 offen lds
    s_mov_b32 s64, 168960
    s_add_u32 m0, s70, 1024
    s_nop 0
    buffer_load_dwordx4 v164, s[24:27], s64 offen lds
    s_mov_b32 s64, 164352
    s_add_u32 m0, s70, 8192
    s_nop 0
    buffer_load_dwordx4 v164, s[24:27], s64 offen lds
    s_mov_b32 s64, 169472
    s_add_u32 m0, s70, 9216
    s_nop 0
    buffer_load_dwordx4 v164, s[24:27], s64 offen lds
    s_mov_b32 s64, 163840
    s_add_u32 m0, s72, 16384
    s_nop 0
    buffer_load_dwordx4 v165, s[24:27], s64 offen lds
    ds_read_b64_tr_b16 a[16:17], v166 offset:20480
    ds_read_b64_tr_b16 a[18:19], v166 offset:21504
    ds_read_b64_tr_b16 a[20:21], v166 offset:20488
    ds_read_b64_tr_b16 a[22:23], v166 offset:21512
    ds_read_b64_tr_b16 a[24:25], v166 offset:28672
    ds_read_b64_tr_b16 a[26:27], v166 offset:29696
    ds_read_b64_tr_b16 a[28:29], v166 offset:28680
    ds_read_b64_tr_b16 a[30:31], v166 offset:29704
    ds_read_b64_tr_b16 v[224:225], v168 offset:36864
    ds_read_b64_tr_b16 v[226:227], v168 offset:37376
    s_waitcnt lgkmcnt(0)
    ds_write_b128 v240, v[224:227] offset:1024
    s_waitcnt vmcnt(10)
    s_waitcnt lgkmcnt(0)
    s_barrier
    s_mov_b32 s64, 204800
    s_add_u32 m0, s70, 20480
    s_nop 0
    buffer_load_dwordx4 v164, s[24:27], s64 offen lds
    s_mov_b32 s64, 209920
    s_add_u32 m0, s70, 21504
    s_nop 0
    buffer_load_dwordx4 v164, s[24:27], s64 offen lds
    s_mov_b32 s64, 205312
    s_add_u32 m0, s70, 28672
    s_nop 0
    buffer_load_dwordx4 v164, s[24:27], s64 offen lds
    s_mov_b32 s64, 210432
    s_add_u32 m0, s70, 29696
    s_nop 0
    buffer_load_dwordx4 v164, s[24:27], s64 offen lds
    s_mov_b32 s64, 204800
    s_add_u32 m0, s72, 36864
    s_nop 0
    buffer_load_dwordx4 v165, s[24:27], s64 offen lds
    s_cmp_lg_u32 s68, 0
    s_cbranch_scc1 Larr0_56
    s_cmp_lg_u32 s60, 0
    s_cbranch_scc1 Lcnt_57
    s_mov_b64 exec, 1
    v_mov_b32 v3, 0x80000000
    v_cmp_ne_u32 vcc, 255, v2
    s_nop 1
    v_cndmask_b32 v3, 4, v3, vcc
    buffer_store_dword v2, v3, s[8:11], 0 offen offset:128 sc1
    s_mov_b64 exec, -1
Lcnt_57:
Larr0_56:
    ds_read_b64_tr_b16 a[32:33], v167 offset:0
    ds_read_b64_tr_b16 a[34:35], v167 offset:1024
    ds_read_b64_tr_b16 a[36:37], v167 offset:8
    ds_read_b64_tr_b16 a[38:39], v167 offset:1032
    ds_read_b64_tr_b16 a[40:41], v167 offset:8192
    ds_read_b64_tr_b16 a[42:43], v167 offset:9216
    ds_read_b64_tr_b16 a[44:45], v167 offset:8200
    ds_read_b64_tr_b16 a[46:47], v167 offset:9224
    ds_read_b64_tr_b16 v[228:229], v169 offset:16384
    ds_read_b64_tr_b16 v[230:231], v169 offset:16896
    s_waitcnt lgkmcnt(0)
    ds_write_b128 v240, v[228:231] offset:2048
    s_waitcnt vmcnt(10)
    s_waitcnt lgkmcnt(0)
    s_barrier
    s_mov_b32 s64, 245760
    s_add_u32 m0, s70, 40960
    s_nop 0
    buffer_load_dwordx4 v164, s[24:27], s64 offen lds
    s_mov_b32 s64, 250880
    s_add_u32 m0, s70, 41984
    s_nop 0
    buffer_load_dwordx4 v164, s[24:27], s64 offen lds
    s_mov_b32 s64, 246272
    s_add_u32 m0, s70, 49152
    s_nop 0
    buffer_load_dwordx4 v164, s[24:27], s64 offen lds
    s_mov_b32 s64, 251392
    s_add_u32 m0, s70, 50176
    s_nop 0
    buffer_load_dwordx4 v164, s[24:27], s64 offen lds
    s_mov_b32 s64, 245760
    s_add_u32 m0, s72, 57344
    s_nop 0
    buffer_load_dwordx4 v165, s[24:27], s64 offen lds
    ds_read_b64_tr_b16 a[48:49], v167 offset:20480
    ds_read_b64_tr_b16 a[50:51], v167 offset:21504
    ds_read_b64_tr_b16 a[52:53], v167 offset:20488
    ds_read_b64_tr_b16 a[54:55], v167 offset:21512
    ds_read_b64_tr_b16 a[56:57], v167 offset:28672
    ds_read_b64_tr_b16 a[58:59], v167 offset:29696
    ds_read_b64_tr_b16 a[60:61], v167 offset:28680
    ds_read_b64_tr_b16 a[62:63], v167 offset:29704
    ds_read_b64_tr_b16 v[232:233], v169 offset:36864
    ds_read_b64_tr_b16 v[234:235], v169 offset:37376
    s_waitcnt lgkmcnt(0)
    ds_write_b128 v240, v[232:235] offset:3072
    s_waitcnt vmcnt(10)
    s_waitcnt lgkmcnt(0)
    s_barrier
    s_mov_b32 s64, 286720
    s_add_u32 m0, s70, 61440
    s_nop 0
    buffer_load_dwordx4 v164, s[24:27], s64 offen lds
    s_mov_b32 s64, 291840
    s_add_u32 m0, s70, 62464
    s_nop 0
    buffer_load_dwordx4 v164, s[24:27], s64 offen lds
    s_mov_b32 s64, 287232
    s_add_u32 m0, s70, 69632
    s_nop 0
    buffer_load_dwordx4 v164, s[24:27], s64 offen lds
    s_mov_b32 s64, 292352
    s_add_u32 m0, s70, 70656
    s_nop 0
    buffer_load_dwordx4 v164, s[24:27], s64 offen lds
    s_mov_b32 s64, 286720
    s_add_u32 m0, s72, 77824
    s_nop 0
    buffer_load_dwordx4 v165, s[24:27], s64 offen lds
    ds_read_b64_tr_b16 a[64:65], v166 offset:0
    ds_read_b64_tr_b16 a[66:67], v166 offset:1024
    ds_read_b64_tr_b16 a[68:69], v166 offset:8
    ds_read_b64_tr_b16 a[70:71], v166 offset:1032
    ds_read_b64_tr_b16 a[72:73], v166 offset:8192
    ds_read_b64_tr_b16 a[74:75], v166 offset:9216
    ds_read_b64_tr_b16 a[76:77], v166 offset:8200
    ds_read_b64_tr_b16 a[78:79], v166 offset:9224
    ds_read_b64_tr_b16 v[220:221], v168 offset:16384
    ds_read_b64_tr_b16 v[222:223], v168 offset:16896
    s_waitcnt lgkmcnt(0)
    ds_write_b128 v240, v[220:223] offset:4096
    s_waitcnt vmcnt(10)
    s_waitcnt lgkmcnt(0)
    s_barrier
    s_mov_b32 s64, 327680
    s_add_u32 m0, s70, 0
    s_nop 0
    buffer_load_dwordx4 v164, s[24:27], s64 offen lds
    s_mov_b32 s64, 332800
    s_add_u32 m0, s70, 1024
    s_nop 0
    buffer_load_dwordx4 v164, s[24:27], s64 offen lds
    s_mov_b32 s64, 328192
    s_add_u32 m0, s70, 8192
    s_nop 0
    buffer_load_dwordx4 v164, s[24:27], s64 offen lds
    s_mov_b32 s64, 333312
    s_add_u32 m0, s70, 9216
    s_nop 0
    buffer_load_dwordx4 v164, s[24:27], s64 offen lds
    s_mov_b32 s64, 327680
    s_add_u32 m0, s72, 16384
    s_nop 0
    buffer_load_dwordx4 v165, s[24:27], s64 offen lds
    ds_read_b64_tr_b16 a[80:81], v166 offset:20480
    ds_read_b64_tr_b16 a[82:83], v166 offset:21504
    ds_read_b64_tr_b16 a[84:85], v166 offset:20488
    ds_read_b64_tr_b16 a[86:87], v166 offset:21512
    ds_read_b64_tr_b16 a[88:89], v166 offset:28672
    ds_read_b64_tr_b16 a[90:91], v166 offset:29696
    ds_read_b64_tr_b16 a[92:93], v166 offset:28680
    ds_read_b64_tr_b16 a[94:95], v166 offset:29704
    ds_read_b64_tr_b16 v[224:225], v168 offset:36864
    ds_read_b64_tr_b16 v[226:227], v168 offset:37376
    s_waitcnt lgkmcnt(0)
    ds_write_b128 v240, v[224:227] offset:5120
    s_waitcnt vmcnt(10)
    s_waitcnt lgkmcnt(0)
    s_barrier
    s_mov_b32 s64, 368640
    s_add_u32 m0, s70, 20480
    s_nop 0
    buffer_load_dwordx4 v164, s[24:27], s64 offen lds
    s_mov_b32 s64, 373760
    s_add_u32 m0, s70, 21504
    s_nop 0
    buffer_load_dwordx4 v164, s[24:27], s64 offen lds
    s_mov_b32 s64, 369152
    s_add_u32 m0, s70, 28672
    s_nop 0
    buffer_load_dwordx4 v164, s[24:27], s64 offen lds
    s_mov_b32 s64, 374272
    s_add_u32 m0, s70, 29696
    s_nop 0
    buffer_load_dwordx4 v164, s[24:27], s64 offen lds
    s_mov_b32 s64, 368640
    s_add_u32 m0, s72, 36864
    s_nop 0
    buffer_load_dwordx4 v165, s[24:27], s64 offen lds
    ds_read_b64_tr_b16 a[96:97], v167 offset:0
    ds_read_b64_tr_b16 a[98:99], v167 offset:1024
    ds_read_b64_tr_b16 a[100:101], v167 offset:8
    ds_read_b64_tr_b16 a[102:103], v167 offset:1032
    ds_read_b64_tr_b16 a[104:105], v167 offset:8192
    ds_read_b64_tr_b16 a[106:107], v167 offset:9216
    ds_read_b64_tr_b16 a[108:109], v167 offset:8200
    ds_read_b64_tr_b16 a[110:111], v167 offset:9224
    ds_read_b64_tr_b16 v[228:229], v169 offset:16384
    ds_read_b64_tr_b16 v[230:231], v169 offset:16896
    s_waitcnt lgkmcnt(0)
    ds_write_b128 v240, v[228:231] offset:6144
    s_waitcnt vmcnt(10)
    s_waitcnt lgkmcnt(0)
    s_barrier
    s_mov_b32 s64, 409600
    s_add_u32 m0, s70, 40960
    s_nop 0
    buffer_load_dwordx4 v164, s[24:27], s64 offen lds
    s_mov_b32 s64, 414720
    s_add_u32 m0, s70, 41984
    s_nop 0
    buffer_load_dwordx4 v164, s[24:27], s64 offen lds
    s_mov_b32 s64, 410112
    s_add_u32 m0, s70, 49152
    s_nop 0
    buffer_load_dwordx4 v164, s[24:27], s64 offen lds
    s_mov_b32 s64, 415232
    s_add_u32 m0, s70, 50176
    s_nop 0
    buffer_load_dwordx4 v164, s[24:27], s64 offen lds
    s_mov_b32 s64, 409600
    s_add_u32 m0, s72, 57344
    s_nop 0
    buffer_load_dwordx4 v165, s[24:27], s64 offen lds
    ds_read_b64_tr_b16 a[112:113], v167 offset:20480
    ds_read_b64_tr_b16 a[114:115], v167 offset:21504
    ds_read_b64_tr_b16 a[116:117], v167 offset:20488
    ds_read_b64_tr_b16 a[118:119], v167 offset:21512
    ds_read_b64_tr_b16 a[120:121], v167 offset:28672
    ds_read_b64_tr_b16 a[122:123], v167 offset:29696
    ds_read_b64_tr_b16 a[124:125], v167 offset:28680
    ds_read_b64_tr_b16 a[126:127], v167 offset:29704
    ds_read_b64_tr_b16 v[232:233], v169 offset:36864
    ds_read_b64_tr_b16 v[234:235], v169 offset:37376
    s_waitcnt lgkmcnt(0)
    ds_write_b128 v240, v[232:235] offset:7168
    s_waitcnt vmcnt(10)
    s_waitcnt lgkmcnt(0)
    s_barrier
    s_mov_b32 s64, 450560
    s_add_u32 m0, s70, 61440
    s_nop 0
    buffer_load_dwordx4 v164, s[24:27], s64 offen lds
    s_mov_b32 s64, 455680
    s_add_u32 m0, s70, 62464
    s_nop 0
    buffer_load_dwordx4 v164, s[24:27], s64 offen lds
    s_mov_b32 s64, 451072
    s_add_u32 m0, s70, 69632
    s_nop 0
    buffer_load_dwordx4 v164, s[24:27], s64 offen lds
    s_mov_b32 s64, 456192
    s_add_u32 m0, s70, 70656
    s_nop 0
    buffer_load_dwordx4 v164, s[24:27], s64 offen lds
    s_mov_b32 s64, 450560
    s_add_u32 m0, s72, 77824
    s_nop 0
    buffer_load_dwordx4 v165, s[24:27], s64 offen lds
    ds_read_b64_tr_b16 a[128:129], v166 offset:0
    ds_read_b64_tr_b16 a[130:131], v166 offset:1024
    ds_read_b64_tr_b16 a[132:133], v166 offset:8
    ds_read_b64_tr_b16 a[134:135], v166 offset:1032
    ds_read_b64_tr_b16 a[136:137], v166 offset:8192
    ds_read_b64_tr_b16 a[138:139], v166 offset:9216
    ds_read_b64_tr_b16 a[140:141], v166 offset:8200
    ds_read_b64_tr_b16 a[142:143], v166 offset:9224
    ds_read_b64_tr_b16 v[220:221], v168 offset:16384
    ds_read_b64_tr_b16 v[222:223], v168 offset:16896
    s_waitcnt lgkmcnt(0)
    ds_write_b128 v240, v[220:223] offset:8192
    s_waitcnt vmcnt(10)
    s_waitcnt lgkmcnt(0)
    s_barrier
    s_mov_b32 s64, 491520
    s_add_u32 m0, s70, 0
    s_nop 0
    buffer_load_dwordx4 v164, s[24:27], s64 offen lds
    s_mov_b32 s64, 496640
    s_add_u32 m0, s70, 1024
    s_nop 0
    buffer_load_dwordx4 v164, s[24:27], s64 offen lds
    s_mov_b32 s64, 492032
    s_add_u32 m0, s70, 8192
    s_nop 0
    buffer_load_dwordx4 v164, s[24:27], s64 offen lds
    s_mov_b32 s64, 497152
    s_add_u32 m0, s70, 9216
    s_nop 0
    buffer_load_dwordx4 v164, s[24:27], s64 offen lds
    s_mov_b32 s64, 491520
    s_add_u32 m0, s72, 16384
    s_nop 0
    buffer_load_dwordx4 v165, s[24:27], s64 offen lds
    ds_read_b64_tr_b16 a[144:145], v166 offset:20480
    ds_read_b64_tr_b16 a[146:147], v166 offset:21504
    ds_read_b64_tr_b16 a[148:149], v166 offset:20488
    ds_read_b64_tr_b16 a[150:151], v166 offset:21512
    ds_read_b64_tr_b16 a[152:153], v166 offset:28672
    ds_read_b64_tr_b16 a[154:155], v166 offset:29696
    ds_read_b64_tr_b16 a[156:157], v166 offset:28680
    ds_read_b64_tr_b16 a[158:159], v166 offset:29704
    ds_read_b64_tr_b16 v[224:225], v168 offset:36864
    ds_read_b64_tr_b16 v[226:227], v168 offset:37376
    s_waitcnt lgkmcnt(0)
    ds_write_b128 v240, v[224:227] offset:9216
    s_waitcnt vmcnt(10)
    s_waitcnt lgkmcnt(0)
    s_barrier
    s_mov_b32 s64, 532480
    s_add_u32 m0, s70, 20480
    s_nop 0
    buffer_load_dwordx4 v164, s[24:27], s64 offen lds
    s_mov_b32 s64, 537600
    s_add_u32 m0, s70, 21504
    s_nop 0
    buffer_load_dwordx4 v164, s[24:27], s64 offen lds
    s_mov_b32 s64, 532992
    s_add_u32 m0, s70, 28672
    s_nop 0
    buffer_load_dwordx4 v164, s[24:27], s64 offen lds
    s_mov_b32 s64, 538112
    s_add_u32 m0, s70, 29696
    s_nop 0
    buffer_load_dwordx4 v164, s[24:27], s64 offen lds
    s_mov_b32 s64, 532480
    s_add_u32 m0, s72, 36864
    s_nop 0
    buffer_load_dwordx4 v165, s[24:27], s64 offen lds
    ds_read_b64_tr_b16 a[160:161], v167 offset:0
    ds_read_b64_tr_b16 a[162:163], v167 offset:1024
    ds_read_b64_tr_b16 a[164:165], v167 offset:8
    ds_read_b64_tr_b16 a[166:167], v167 offset:1032
    ds_read_b64_tr_b16 a[168:169], v167 offset:8192
    ds_read_b64_tr_b16 a[170:171], v167 offset:9216
    ds_read_b64_tr_b16 a[172:173], v167 offset:8200
    ds_read_b64_tr_b16 a[174:175], v167 offset:9224
    ds_read_b64_tr_b16 v[228:229], v169 offset:16384
    ds_read_b64_tr_b16 v[230:231], v169 offset:16896
    s_waitcnt lgkmcnt(0)
    ds_write_b128 v240, v[228:231] offset:10240
    s_waitcnt vmcnt(10)
    s_waitcnt lgkmcnt(0)
    s_barrier
    s_mov_b32 s64, 573440
    s_add_u32 m0, s70, 40960
    s_nop 0
    buffer_load_dwordx4 v164, s[24:27], s64 offen lds
    s_mov_b32 s64, 578560
    s_add_u32 m0, s70, 41984
    s_nop 0
    buffer_load_dwordx4 v164, s[24:27], s64 offen lds
    s_mov_b32 s64, 573952
    s_add_u32 m0, s70, 49152
    s_nop 0
    buffer_load_dwordx4 v164, s[24:27], s64 offen lds
    s_mov_b32 s64, 579072
    s_add_u32 m0, s70, 50176
    s_nop 0
    buffer_load_dwordx4 v164, s[24:27], s64 offen lds
    s_mov_b32 s64, 573440
    s_add_u32 m0, s72, 57344
    s_nop 0
    buffer_load_dwordx4 v165, s[24:27], s64 offen lds
    ds_read_b64_tr_b16 a[176:177], v167 offset:20480
    ds_read_b64_tr_b16 a[178:179], v167 offset:21504
    ds_read_b64_tr_b16 a[180:181], v167 offset:20488
    ds_read_b64_tr_b16 a[182:183], v167 offset:21512
    ds_read_b64_tr_b16 a[184:185], v167 offset:28672
    ds_read_b64_tr_b16 a[186:187], v167 offset:29696
    ds_read_b64_tr_b16 a[188:189], v167 offset:28680
    ds_read_b64_tr_b16 a[190:191], v167 offset:29704
    ds_read_b64_tr_b16 v[232:233], v169 offset:36864
    ds_read_b64_tr_b16 v[234:235], v169 offset:37376
    s_waitcnt lgkmcnt(0)
    ds_write_b128 v240, v[232:235] offset:11264
    s_waitcnt vmcnt(10)
    s_waitcnt lgkmcnt(0)
    s_barrier
    s_mov_b32 s64, 614400
    s_add_u32 m0, s70, 61440
    s_nop 0
    buffer_load_dwordx4 v164, s[24:27], s64 offen lds
    s_mov_b32 s64, 619520
    s_add_u32 m0, s70, 62464
    s_nop 0
    buffer_load_dwordx4 v164, s[24:27], s64 offen lds
    s_mov_b32 s64, 614912
    s_add_u32 m0, s70, 69632
    s_nop 0
    buffer_load_dwordx4 v164, s[24:27], s64 offen lds
    s_mov_b32 s64, 620032
    s_add_u32 m0, s70, 70656
    s_nop 0
    buffer_load_dwordx4 v164, s[24:27], s64 offen lds
    s_mov_b32 s64, 614400
    s_add_u32 m0, s72, 77824
    s_nop 0
    buffer_load_dwordx4 v165, s[24:27], s64 offen lds
    ds_read_b64_tr_b16 a[192:193], v166 offset:0
    ds_read_b64_tr_b16 a[194:195], v166 offset:1024
    ds_read_b64_tr_b16 a[196:197], v166 offset:8
    ds_read_b64_tr_b16 a[198:199], v166 offset:1032
    ds_read_b64_tr_b16 a[200:201], v166 offset:8192
    ds_read_b64_tr_b16 a[202:203], v166 offset:9216
    ds_read_b64_tr_b16 a[204:205], v166 offset:8200
    ds_read_b64_tr_b16 a[206:207], v166 offset:9224
    ds_read_b64_tr_b16 v[220:221], v168 offset:16384
    ds_read_b64_tr_b16 v[222:223], v168 offset:16896
    s_waitcnt lgkmcnt(0)
    ds_write_b128 v240, v[220:223] offset:12288
    s_waitcnt vmcnt(10)
    s_waitcnt lgkmcnt(0)
    s_barrier
    s_mov_b32 s64, 655360
    s_add_u32 m0, s70, 0
    s_nop 0
    buffer_load_dwordx4 v164, s[24:27], s64 offen lds
    s_mov_b32 s64, 660480
    s_add_u32 m0, s70, 1024
    s_nop 0
    buffer_load_dwordx4 v164, s[24:27], s64 offen lds
    s_mov_b32 s64, 655872
    s_add_u32 m0, s70, 8192
    s_nop 0
    buffer_load_dwordx4 v164, s[24:27], s64 offen lds
    s_mov_b32 s64, 660992
    s_add_u32 m0, s70, 9216
    s_nop 0
    buffer_load_dwordx4 v164, s[24:27], s64 offen lds
    s_mov_b32 s64, 655360
    s_add_u32 m0, s72, 16384
    s_nop 0
    buffer_load_dwordx4 v165, s[24:27], s64 offen lds
    ds_read_b64_tr_b16 a[208:209], v166 offset:20480
    ds_read_b64_tr_b16 a[210:211], v166 offset:21504
    ds_read_b64_tr_b16 a[212:213], v166 offset:20488
    ds_read_b64_tr_b16 a[214:215], v166 offset:21512
    ds_read_b64_tr_b16 a[216:217], v166 offset:28672
    ds_read_b64_tr_b16 a[218:219], v166 offset:29696
    ds_read_b64_tr_b16 a[220:221], v166 offset:28680
    ds_read_b64_tr_b16 a[222:223], v166 offset:29704
    ds_read_b64_tr_b16 v[224:225], v168 offset:36864
    ds_read_b64_tr_b16 v[226:227], v168 offset:37376
    s_waitcnt lgkmcnt(0)
    ds_write_b128 v240, v[224:227] offset:13312
    s_waitcnt vmcnt(10)
    s_waitcnt lgkmcnt(0)
    s_barrier
    s_mov_b32 s64, 696320
    s_add_u32 m0, s70, 20480
    s_nop 0
    buffer_load_dwordx4 v164, s[24:27], s64 offen lds
    s_mov_b32 s64, 701440
    s_add_u32 m0, s70, 21504
    s_nop 0
    buffer_load_dwordx4 v164, s[24:27], s64 offen lds
    s_mov_b32 s64, 696832
    s_add_u32 m0, s70, 28672
    s_nop 0
    buffer_load_dwordx4 v164, s[24:27], s64 offen lds
    s_mov_b32 s64, 701952
    s_add_u32 m0, s70, 29696
    s_nop 0
    buffer_load_dwordx4 v164, s[24:27], s64 offen lds
    s_mov_b32 s64, 696320
    s_add_u32 m0, s72, 36864
    s_nop 0
    buffer_load_dwordx4 v165, s[24:27], s64 offen lds
    ds_read_b64_tr_b16 a[224:225], v167 offset:0
    ds_read_b64_tr_b16 a[226:227], v167 offset:1024
    ds_read_b64_tr_b16 a[228:229], v167 offset:8
    ds_read_b64_tr_b16 a[230:231], v167 offset:1032
    ds_read_b64_tr_b16 a[232:233], v167 offset:8192
    ds_read_b64_tr_b16 a[234:235], v167 offset:9216
    ds_read_b64_tr_b16 a[236:237], v167 offset:8200
    ds_read_b64_tr_b16 a[238:239], v167 offset:9224
    ds_read_b64_tr_b16 v[228:229], v169 offset:16384
    ds_read_b64_tr_b16 v[230:231], v169 offset:16896
    s_waitcnt lgkmcnt(0)
    ds_write_b128 v240, v[228:231] offset:14336
    s_waitcnt vmcnt(10)
    s_waitcnt lgkmcnt(0)
    s_barrier
    s_mov_b32 s64, 737280
    s_add_u32 m0, s70, 40960
    s_nop 0
    buffer_load_dwordx4 v164, s[24:27], s64 offen lds
    s_mov_b32 s64, 742400
    s_add_u32 m0, s70, 41984
    s_nop 0
    buffer_load_dwordx4 v164, s[24:27], s64 offen lds
    s_mov_b32 s64, 737792
    s_add_u32 m0, s70, 49152
    s_nop 0
    buffer_load_dwordx4 v164, s[24:27], s64 offen lds
    s_mov_b32 s64, 742912
    s_add_u32 m0, s70, 50176
    s_nop 0
    buffer_load_dwordx4 v164, s[24:27], s64 offen lds
    s_mov_b32 s64, 737280
    s_add_u32 m0, s72, 57344
    s_nop 0
    buffer_load_dwordx4 v165, s[24:27], s64 offen lds
    ds_read_b64_tr_b16 a[240:241], v167 offset:20480
    ds_read_b64_tr_b16 a[242:243], v167 offset:21504
    ds_read_b64_tr_b16 a[244:245], v167 offset:20488
    ds_read_b64_tr_b16 a[246:247], v167 offset:21512
    ds_read_b64_tr_b16 a[248:249], v167 offset:28672
    ds_read_b64_tr_b16 a[250:251], v167 offset:29696
    ds_read_b64_tr_b16 a[252:253], v167 offset:28680
    ds_read_b64_tr_b16 a[254:255], v167 offset:29704
    ds_read_b64_tr_b16 v[232:233], v169 offset:36864
    ds_read_b64_tr_b16 v[234:235], v169 offset:37376
    s_waitcnt lgkmcnt(0)
    ds_write_b128 v240, v[232:235] offset:15360
    s_waitcnt vmcnt(10)
    s_waitcnt lgkmcnt(0)
    s_barrier
    s_mov_b32 s64, 778240
    s_add_u32 m0, s70, 61440
    s_nop 0
    buffer_load_dwordx4 v164, s[24:27], s64 offen lds
    s_mov_b32 s64, 783360
    s_add_u32 m0, s70, 62464
    s_nop 0
    buffer_load_dwordx4 v164, s[24:27], s64 offen lds
    s_mov_b32 s64, 778752
    s_add_u32 m0, s70, 69632
    s_nop 0
    buffer_load_dwordx4 v164, s[24:27], s64 offen lds
    s_mov_b32 s64, 783872
    s_add_u32 m0, s70, 70656
    s_nop 0
    buffer_load_dwordx4 v164, s[24:27], s64 offen lds
    s_mov_b32 s64, 778240
    s_add_u32 m0, s72, 77824
    s_nop 0
    buffer_load_dwordx4 v165, s[24:27], s64 offen lds
    ds_read_b64_tr_b16 v[4:5], v166 offset:0
    ds_read_b64_tr_b16 v[6:7], v166 offset:1024
    ds_read_b64_tr_b16 v[8:9], v166 offset:8
    ds_read_b64_tr_b16 v[10:11], v166 offset:1032
    ds_read_b64_tr_b16 v[12:13], v166 offset:8192
    ds_read_b64_tr_b16 v[14:15], v166 offset:9216
    ds_read_b64_tr_b16 v[16:17], v166 offset:8200
    ds_read_b64_tr_b16 v[18:19], v166 offset:9224
    ds_read_b64_tr_b16 v[132:133], v168 offset:16384
    ds_read_b64_tr_b16 v[134:135], v168 offset:16896
    s_waitcnt vmcnt(10)
    s_waitcnt lgkmcnt(0)
    s_barrier
    s_mov_b32 s64, 819200
    s_add_u32 m0, s70, 0
    s_nop 0
    buffer_load_dwordx4 v164, s[24:27], s64 offen lds
    s_mov_b32 s64, 824320
    s_add_u32 m0, s70, 1024
    s_nop 0
    buffer_load_dwordx4 v164, s[24:27], s64 offen lds
    s_mov_b32 s64, 819712
    s_add_u32 m0, s70, 8192
    s_nop 0
    buffer_load_dwordx4 v164, s[24:27], s64 offen lds
    s_mov_b32 s64, 824832
    s_add_u32 m0, s70, 9216
    s_nop 0
    buffer_load_dwordx4 v164, s[24:27], s64 offen lds
    s_mov_b32 s64, 819200
    s_add_u32 m0, s72, 16384
    s_nop 0
    buffer_load_dwordx4 v165, s[24:27], s64 offen lds
    ds_read_b64_tr_b16 v[20:21], v166 offset:20480
    ds_read_b64_tr_b16 v[22:23], v166 offset:21504
    ds_read_b64_tr_b16 v[24:25], v166 offset:20488
    ds_read_b64_tr_b16 v[26:27], v166 offset:21512
    ds_read_b64_tr_b16 v[28:29], v166 offset:28672
    ds_read_b64_tr_b16 v[30:31], v166 offset:29696
    ds_read_b64_tr_b16 v[32:33], v166 offset:28680
    ds_read_b64_tr_b16 v[34:35], v166 offset:29704
    ds_read_b64_tr_b16 v[136:137], v168 offset:36864
    ds_read_b64_tr_b16 v[138:139], v168 offset:37376
    s_waitcnt vmcnt(10)
    s_waitcnt lgkmcnt(0)
    s_barrier
    s_mov_b32 s64, 860160
    s_add_u32 m0, s70, 20480
    s_nop 0
    buffer_load_dwordx4 v164, s[24:27], s64 offen lds
    s_mov_b32 s64, 865280
    s_add_u32 m0, s70, 21504
    s_nop 0
    buffer_load_dwordx4 v164, s[24:27], s64 offen lds
    s_mov_b32 s64, 860672
    s_add_u32 m0, s70, 28672
    s_nop 0
    buffer_load_dwordx4 v164, s[24:27], s64 offen lds
    s_mov_b32 s64, 865792
    s_add_u32 m0, s70, 29696
    s_nop 0
    buffer_load_dwordx4 v164, s[24:27], s64 offen lds
    s_mov_b32 s64, 860160
    s_add_u32 m0, s72, 36864
    s_nop 0
    buffer_load_dwordx4 v165, s[24:27], s64 offen lds
    ds_read_b64_tr_b16 v[36:37], v167 offset:0
    ds_read_b64_tr_b16 v[38:39], v167 offset:1024
    ds_read_b64_tr_b16 v[40:41], v167 offset:8
    ds_read_b64_tr_b16 v[42:43], v167 offset:1032
    ds_read_b64_tr_b16 v[44:45], v167 offset:8192
    ds_read_b64_tr_b16 v[46:47], v167 offset:9216
    ds_read_b64_tr_b16 v[48:49], v167 offset:8200
    ds_read_b64_tr_b16 v[50:51], v167 offset:9224
    ds_read_b64_tr_b16 v[140:141], v169 offset:16384
    ds_read_b64_tr_b16 v[142:143], v169 offset:16896
    s_waitcnt vmcnt(10)
    s_waitcnt lgkmcnt(0)
    s_barrier
    s_mov_b32 s64, 901120
    s_add_u32 m0, s70, 40960
    s_nop 0
    buffer_load_dwordx4 v164, s[24:27], s64 offen lds
    s_mov_b32 s64, 906240
    s_add_u32 m0, s70, 41984
    s_nop 0
    buffer_load_dwordx4 v164, s[24:27], s64 offen lds
    s_mov_b32 s64, 901632
    s_add_u32 m0, s70, 49152
    s_nop 0
    buffer_load_dwordx4 v164, s[24:27], s64 offen lds
    s_mov_b32 s64, 906752
    s_add_u32 m0, s70, 50176
    s_nop 0
    buffer_load_dwordx4 v164, s[24:27], s64 offen lds
    s_mov_b32 s64, 901120
    s_add_u32 m0, s72, 57344
    s_nop 0
    buffer_load_dwordx4 v165, s[24:27], s64 offen lds
    ds_read_b64_tr_b16 v[52:53], v167 offset:20480
    ds_read_b64_tr_b16 v[54:55], v167 offset:21504
    ds_read_b64_tr_b16 v[56:57], v167 offset:20488
    ds_read_b64_tr_b16 v[58:59], v167 offset:21512
    ds_read_b64_tr_b16 v[60:61], v167 offset:28672
    ds_read_b64_tr_b16 v[62:63], v167 offset:29696
    ds_read_b64_tr_b16 v[64:65], v167 offset:28680
    ds_read_b64_tr_b16 v[66:67], v167 offset:29704
    ds_read_b64_tr_b16 v[144:145], v169 offset:36864
    ds_read_b64_tr_b16 v[146:147], v169 offset:37376
    s_waitcnt vmcnt(10)
    s_waitcnt lgkmcnt(0)
    s_barrier
    s_mov_b32 s64, 942080
    s_add_u32 m0, s70, 61440
    s_nop 0
    buffer_load_dwordx4 v164, s[24:27], s64 offen lds
    s_mov_b32 s64, 947200
    s_add_u32 m0, s70, 62464
    s_nop 0
    buffer_load_dwordx4 v164, s[24:27], s64 offen lds
    s_mov_b32 s64, 942592
    s_add_u32 m0, s70, 69632
    s_nop 0
    buffer_load_dwordx4 v164, s[24:27], s64 offen lds
    s_mov_b32 s64, 947712
    s_add_u32 m0, s70, 70656
    s_nop 0
    buffer_load_dwordx4 v164, s[24:27], s64 offen lds
    s_mov_b32 s64, 942080
    s_add_u32 m0, s72, 77824
    s_nop 0
    buffer_load_dwordx4 v165, s[24:27], s64 offen lds
    ds_read_b64_tr_b16 v[68:69], v166 offset:0
    ds_read_b64_tr_b16 v[70:71], v166 offset:1024
    ds_read_b64_tr_b16 v[72:73], v166 offset:8
    ds_read_b64_tr_b16 v[74:75], v166 offset:1032
    ds_read_b64_tr_b16 v[76:77], v166 offset:8192
    ds_read_b64_tr_b16 v[78:79], v166 offset:9216
    ds_read_b64_tr_b16 v[80:81], v166 offset:8200
    ds_read_b64_tr_b16 v[82:83], v166 offset:9224
    ds_read_b64_tr_b16 v[148:149], v168 offset:16384
    ds_read_b64_tr_b16 v[150:151], v168 offset:16896
    s_waitcnt vmcnt(10)
    s_waitcnt lgkmcnt(0)
    s_barrier
    ds_read_b64_tr_b16 v[84:85], v166 offset:20480
    ds_read_b64_tr_b16 v[86:87], v166 offset:21504
    ds_read_b64_tr_b16 v[88:89], v166 offset:20488
    ds_read_b64_tr_b16 v[90:91], v166 offset:21512
    ds_read_b64_tr_b16 v[92:93], v166 offset:28672
    ds_read_b64_tr_b16 v[94:95], v166 offset:29696
    ds_read_b64_tr_b16 v[96:97], v166 offset:28680
    ds_read_b64_tr_b16 v[98:99], v166 offset:29704
    ds_read_b64_tr_b16 v[152:153], v168 offset:36864
    ds_read_b64_tr_b16 v[154:155], v168 offset:37376
    s_waitcnt vmcnt(5)
    s_waitcnt lgkmcnt(0)
    s_barrier
    ds_read_b64_tr_b16 v[100:101], v167 offset:0
    ds_read_b64_tr_b16 v[102:103], v167 offset:1024
    ds_read_b64_tr_b16 v[104:105], v167 offset:8
    ds_read_b64_tr_b16 v[106:107], v167 offset:1032
    ds_read_b64_tr_b16 v[108:109], v167 offset:8192
    ds_read_b64_tr_b16 v[110:111], v167 offset:9216
    ds_read_b64_tr_b16 v[112:113], v167 offset:8200
    ds_read_b64_tr_b16 v[114:115], v167 offset:9224
    ds_read_b64_tr_b16 v[156:157], v169 offset:16384
    ds_read_b64_tr_b16 v[158:159], v169 offset:16896
    s_waitcnt vmcnt(0)
    s_waitcnt lgkmcnt(0)
    s_barrier
    ds_read_b64_tr_b16 v[116:117], v167 offset:20480
    ds_read_b64_tr_b16 v[118:119], v167 offset:21504
    ds_read_b64_tr_b16 v[120:121], v167 offset:20488
    ds_read_b64_tr_b16 v[122:123], v167 offset:21512
    ds_read_b64_tr_b16 v[124:125], v167 offset:28672
    ds_read_b64_tr_b16 v[126:127], v167 offset:29696
    ds_read_b64_tr_b16 v[128:129], v167 offset:28680
    ds_read_b64_tr_b16 v[130:131], v167 offset:29704
    ds_read_b64_tr_b16 v[160:161], v169 offset:36864
    ds_read_b64_tr_b16 v[162:163], v169 offset:37376
    v_and_b32 v164, 15, v1
    v_lshrrev_b32 v165, 4, v1
    v_lshlrev_b32 v242, 5, v164
    v_lshl_add_u32 v242, v165, 3, v242
    v_lshlrev_b32 v241, 1, v242
    s_lshl_b32 s64, s75, 2
    s_add_u32 s64, s64, s60
    s_lshl_b32 s64, s64, 10
    v_add_u32 v241, s64, v241
    s_add_u32 s64, s64, 65536
    v_add_u32 v242, s64, v242
    v_min_u32 v243, 47, v1
    s_and_b32 s64, s76, 1
    s_mul_i32 s64, s64, 48
    s_lshl_b32 s65, s58, 7
    s_add_u32 s64, s64, s65
    v_add_u32 v243, s64, v243
    v_lshlrev_b32 v243, 7, v243
    v_add_u32 v243, 8388608, v243
    s_mul_i32 s70, s76, 49152
    s_mul_i32 s64, s68, 6291456
    s_add_u32 s70, s70, s64
    s_add_u32 s70, s70, 60817408
    s_mul_i32 s71, s76, 81920
    s_add_u32 s71, s71, 75497472
    s_lshr_b32 s73, s60, 1
    s_lshl_b32 s73, s73, 12
    s_and_b32 s64, s60, 1
    s_lshl_b32 s64, s64, 10
    s_add_u32 s73, s73, s64
    v_add_u32 v238, s73, v239
    s_mov_b32 s74, 0
    s_cmp_lg_u32 s60, 0
    s_cbranch_scc1 Lgskip_60
    buffer_load_dword v2, off, s[8:11], 0 offset:132 sc1
Lgchk_58:
    s_waitcnt vmcnt(0)
    v_cmp_eq_u32 vcc, 0, v2
    s_cbranch_vccnz Lgrty_59
Lgskip_60:
    s_waitcnt lgkmcnt(0)
    s_barrier
    buffer_load_dword v2, off, s[8:11], 0 offset:140 sc1
Lpchk_61:
    s_waitcnt vmcnt(0)
    v_cmp_eq_u32 vcc, 0, v2
    s_cbranch_vccnz Lprty_62
    v_readfirstlane_b32 s1, v2
    s_cmp_gt_u32 s1, 17
    s_cselect_b32 s1, 1, 0
    s_xor_b32 s1, s1, s68
    s_lshl_b32 s1, s1, 13
    s_lshl_b32 s63, s58, 18
    s_and_b32 s64, s3, 0xfff
    s_add_u32 s63, s63, s64
    s_add_u32 s63, s63, 14819328
    s_xor_b32 s63, s63, s1
L_Tseg:
    s_cmp_lg_u32 s74, 0
    s_cbranch_scc1 L_Thave
    buffer_load_dword v244, v243, s[4:7], 0 offen sc1
    s_lshl_b32 s65, s62, 1
    s_add_u32 s65, s65, 0
    s_waitcnt vmcnt(0)
    v_mov_b32 v236, s65
    s_mov_b64 exec, 1
    buffer_store_dword v236, off, s[4:7], s63 sc1
    buffer_store_dword v236, off, s[4:7], s3
    s_mov_b64 exec, -1
    s_add_u32 s65, s62, 1
Lfchk_63:
    v_cmp_gt_u32 vcc, s65, v244
    s_cbranch_vccnz Lfrty_64
    s_add_u32 m0, s73, 0
    s_add_u32 s64, s70, 0
    buffer_load_dwordx4 v238, s[4:7], s64 offen sc1 lds
    s_add_u32 m0, s73, 8192
    s_add_u32 s64, s70, 8192
    buffer_load_dwordx4 v238, s[4:7], s64 offen sc1 lds
    s_add_u32 m0, s73, 16384
    s_add_u32 s64, s70, 16384
    buffer_load_dwordx4 v238, s[4:7], s64 offen sc1 lds
    s_add_u32 m0, s73, 24576
    s_add_u32 s64, s70, 24576
    buffer_load_dwordx4 v238, s[4:7], s64 offen sc1 lds
    s_add_u32 m0, s73, 32768
    s_add_u32 s64, s70, 32768
    buffer_load_dwordx4 v238, s[4:7], s64 offen sc1 lds
    s_add_u32 m0, s73, 40960
    s_add_u32 s64, s70, 40960
    buffer_load_dwordx4 v238, s[4:7], s64 offen sc1 lds
    s_add_u32 m0, s73, 2048
    s_add_u32 s64, s70, 2048
    buffer_load_dwordx4 v238, s[4:7], s64 offen sc1 lds
    s_add_u32 m0, s73, 10240
    s_add_u32 s64, s70, 10240
    buffer_load_dwordx4 v238, s[4:7], s64 offen sc1 lds
    s_add_u32 m0, s73, 18432
    s_add_u32 s64, s70, 18432
    buffer_load_dwordx4 v238, s[4:7], s64 offen sc1 lds
    s_add_u32 m0, s73, 26624
    s_add_u32 s64, s70, 26624
    buffer_load_dwordx4 v238, s[4:7], s64 offen sc1 lds
    s_add_u32 m0, s73, 34816
    s_add_u32 s64, s70, 34816
    buffer_load_dwordx4 v238, s[4:7], s64 offen sc1 lds
    s_add_u32 m0, s73, 43008
    s_add_u32 s64, s70, 43008
    buffer_load_dwordx4 v238, s[4:7], s64 offen sc1 lds
    s_add_u32 s70, s70, 393216
    s_add_u32 s66, s62, 1
    s_and_b32 s66, s66, 7
    s_cselect_b32 s66, 0, 3145728
    s_sub_u32 s70, s70, s66
    s_xor_b32 s73, s73, 49152
    s_waitcnt vmcnt(10)
L_Thave:
    s_waitcnt vmcnt(13)
    s_barrier
    ds_read_b128 v[204:207], v239 offset:0
    ds_read_b128 v[220:223], v240 offset:0
    ds_read_b128 v[208:211], v239 offset:1024
    ds_read_b128 v[224:227], v240 offset:1024
    ds_read_b128 v[212:215], v239 offset:4096
    ds_read_b128 v[228:231], v240 offset:2048
    s_waitcnt lgkmcnt(5)
    v_mfma_f32_16x16x32_bf16 v[164:167], a[0:3], v[204:207], 0
    s_lshr_b32 s72, s71, 8
    ds_read_b128 v[216:219], v239 offset:5120
    s_xor_b32 s72, s72, s1
    v_mfma_f32_16x16x32_bf16 v[168:171], a[4:7], v[204:207], 0
    s_and_b32 s72, s72, 0x2000
    ds_read_b128 v[232:235], v240 offset:3072
    s_or_b32 s72, s72, s71
    v_mfma_f32_16x16x32_bf16 v[172:175], a[8:11], v[204:207], 0
    s_add_u32 s71, s71, 1048576
    v_mfma_f32_16x16x32_bf16 v[176:179], a[12:15], v[204:207], 0
    s_waitcnt lgkmcnt(6)
    v_mfma_f32_16x16x32_bf16 v[180:183], v[220:223], v[204:207], 0
    s_waitcnt lgkmcnt(4)
    v_mfma_f32_16x16x32_bf16 v[164:167], a[16:19], v[208:211], v[164:167]
    ds_read_b128 v[204:207], v239 offset:8192
    v_mfma_f32_16x16x32_bf16 v[168:171], a[20:23], v[208:211], v[168:171]
    ds_read_b128 v[220:223], v240 offset:4096
    v_mfma_f32_16x16x32_bf16 v[172:175], a[24:27], v[208:211], v[172:175]
    v_mfma_f32_16x16x32_bf16 v[176:179], a[28:31], v[208:211], v[176:179]
    v_mfma_f32_16x16x32_bf16 v[180:183], v[224:227], v[208:211], v[180:183]
    s_waitcnt lgkmcnt(4)
    v_mfma_f32_16x16x32_bf16 v[164:167], a[32:35], v[212:215], v[164:167]
    ds_read_b128 v[208:211], v239 offset:9216
    v_mfma_f32_16x16x32_bf16 v[168:171], a[36:39], v[212:215], v[168:171]
    ds_read_b128 v[224:227], v240 offset:5120
    v_mfma_f32_16x16x32_bf16 v[172:175], a[40:43], v[212:215], v[172:175]
    v_mfma_f32_16x16x32_bf16 v[176:179], a[44:47], v[212:215], v[176:179]
    v_mfma_f32_16x16x32_bf16 v[180:183], v[228:231], v[212:215], v[180:183]
    s_waitcnt lgkmcnt(4)
    v_mfma_f32_16x16x32_bf16 v[164:167], a[48:51], v[216:219], v[164:167]
    ds_read_b128 v[212:215], v239 offset:12288
    v_mfma_f32_16x16x32_bf16 v[168:171], a[52:55], v[216:219], v[168:171]
    ds_read_b128 v[228:231], v240 offset:6144
    v_mfma_f32_16x16x32_bf16 v[172:175], a[56:59], v[216:219], v[172:175]
    v_mfma_f32_16x16x32_bf16 v[176:179], a[60:63], v[216:219], v[176:179]
    v_mfma_f32_16x16x32_bf16 v[180:183], v[232:235], v[216:219], v[180:183]
    s_waitcnt lgkmcnt(4)
    v_mfma_f32_16x16x32_bf16 v[164:167], a[64:67], v[204:207], v[164:167]
    ds_read_b128 v[216:219], v239 offset:13312
    v_mfma_f32_16x16x32_bf16 v[168:171], a[68:71], v[204:207], v[168:171]
    ds_read_b128 v[232:235], v240 offset:7168
    v_mfma_f32_16x16x32_bf16 v[172:175], a[72:75], v[204:207], v[172:175]
    v_mfma_f32_16x16x32_bf16 v[176:179], a[76:79], v[204:207], v[176:179]
    v_mfma_f32_16x16x32_bf16 v[180:183], v[220:223], v[204:207], v[180:183]
    s_waitcnt vmcnt(6)
    s_barrier
    s_waitcnt lgkmcnt(5)
    v_mfma_f32_16x16x32_bf16 v[164:167], a[80:83], v[208:211], v[164:167]
    ds_read_b128 v[204:207], v239 offset:16384
    v_mfma_f32_16x16x32_bf16 v[168:171], a[84:87], v[208:211], v[168:171]
    ds_read_b128 v[220:223], v240 offset:8192
    v_mfma_f32_16x16x32_bf16 v[172:175], a[88:91], v[208:211], v[172:175]
    v_mfma_f32_16x16x32_bf16 v[176:179], a[92:95], v[208:211], v[176:179]
    s_waitcnt lgkmcnt(6)
    v_mfma_f32_16x16x32_bf16 v[180:183], v[224:227], v[208:211], v[180:183]
    s_waitcnt lgkmcnt(4)
    v_mfma_f32_16x16x32_bf16 v[164:167], a[96:99], v[212:215], v[164:167]
    ds_read_b128 v[208:211], v239 offset:17408
    v_mfma_f32_16x16x32_bf16 v[168:171], a[100:103], v[212:215], v[168:171]
    ds_read_b128 v[224:227], v240 offset:9216
    v_mfma_f32_16x16x32_bf16 v[172:175], a[104:107], v[212:215], v[172:175]
    v_mfma_f32_16x16x32_bf16 v[176:179], a[108:111], v[212:215], v[176:179]
    v_mfma_f32_16x16x32_bf16 v[180:183], v[228:231], v[212:215], v[180:183]
    s_waitcnt lgkmcnt(4)
    v_mfma_f32_16x16x32_bf16 v[164:167], a[112:115], v[216:219], v[164:167]
    ds_read_b128 v[212:215], v239 offset:20480
    v_mfma_f32_16x16x32_bf16 v[168:171], a[116:119], v[216:219], v[168:171]
    ds_read_b128 v[228:231], v240 offset:10240
    v_mfma_f32_16x16x32_bf16 v[172:175], a[120:123], v[216:219], v[172:175]
    v_mfma_f32_16x16x32_bf16 v[176:179], a[124:127], v[216:219], v[176:179]
    v_mfma_f32_16x16x32_bf16 v[180:183], v[232:235], v[216:219], v[180:183]
    s_cmp_eq_u32 s74, 0
    s_cbranch_scc1 L_Tnofl
    s_lshl_b32 s65, s62, 1
    s_add_u32 s65, s65, 0
    s_waitcnt vmcnt(0)
    v_mov_b32 v236, s65
    s_mov_b64 exec, 1
    buffer_store_dword v236, off, s[4:7], s63 sc1
    buffer_store_dword v236, off, s[4:7], s3
    s_mov_b64 exec, -1
L_Tnofl:
    s_waitcnt lgkmcnt(5)
    v_mfma_f32_16x16x32_bf16 v[164:167], a[128:131], v[204:207], v[164:167]
    ds_read_b128 v[216:219], v239 offset:21504
    v_mfma_f32_16x16x32_bf16 v[168:171], a[132:135], v[204:207], v[168:171]
    ds_read_b128 v[232:235], v240 offset:11264
    v_mfma_f32_16x16x32_bf16 v[172:175], a[136:139], v[204:207], v[172:175]
    v_mfma_f32_16x16x32_bf16 v[176:179], a[140:143], v[204:207], v[176:179]
    s_waitcnt lgkmcnt(6)
    v_mfma_f32_16x16x32_bf16 v[180:183], v[220:223], v[204:207], v[180:183]
    s_waitcnt lgkmcnt(4)
    v_mfma_f32_16x16x32_bf16 v[164:167], a[144:147], v[208:211], v[164:167]
    ds_read_b128 v[204:207], v239 offset:24576
    v_mfma_f32_16x16x32_bf16 v[168:171], a[148:151], v[208:211], v[168:171]
    ds_read_b128 v[220:223], v240 offset:12288
    v_mfma_f32_16x16x32_bf16 v[172:175], a[152:155], v[208:211], v[172:175]
    v_mfma_f32_16x16x32_bf16 v[176:179], a[156:159], v[208:211], v[176:179]
    v_mfma_f32_16x16x32_bf16 v[180:183], v[224:227], v[208:211], v[180:183]
    s_waitcnt lgkmcnt(4)
    v_mfma_f32_16x16x32_bf16 v[164:167], a[160:163], v[212:215], v[164:167]
    ds_read_b128 v[208:211], v239 offset:25600
    v_mfma_f32_16x16x32_bf16 v[168:171], a[164:167], v[212:215], v[168:171]
    ds_read_b128 v[224:227], v240 offset:13312
    v_mfma_f32_16x16x32_bf16 v[172:175], a[168:171], v[212:215], v[172:175]
    v_mfma_f32_16x16x32_bf16 v[176:179], a[172:175], v[212:215], v[176:179]
    v_mfma_f32_16x16x32_bf16 v[180:183], v[228:231], v[212:215], v[180:183]
    s_waitcnt lgkmcnt(4)
    v_mfma_f32_16x16x32_bf16 v[164:167], a[176:179], v[216:219], v[164:167]
    ds_read_b128 v[212:215], v239 offset:28672
    v_mfma_f32_16x16x32_bf16 v[168:171], a[180:183], v[216:219], v[168:171]
    ds_read_b128 v[228:231], v240 offset:14336
    v_mfma_f32_16x16x32_bf16 v[172:175], a[184:187], v[216:219], v[172:175]
    v_mfma_f32_16x16x32_bf16 v[176:179], a[188:191], v[216:219], v[176:179]
    v_mfma_f32_16x16x32_bf16 v[180:183], v[232:235], v[216:219], v[180:183]
    s_waitcnt lgkmcnt(4)
    v_mfma_f32_16x16x32_bf16 v[164:167], a[192:195], v[204:207], v[164:167]
    ds_read_b128 v[216:219], v239 offset:29696
    v_mfma_f32_16x16x32_bf16 v[168:171], a[196:199], v[204:207], v[168:171]
    ds_read_b128 v[232:235], v240 offset:15360
    v_mfma_f32_16x16x32_bf16 v[172:175], a[200:203], v[204:207], v[172:175]
    v_mfma_f32_16x16x32_bf16 v[176:179], a[204:207], v[204:207], v[176:179]
    v_mfma_f32_16x16x32_bf16 v[180:183], v[220:223], v[204:207], v[180:183]
    s_waitcnt lgkmcnt(4)
    v_mfma_f32_16x16x32_bf16 v[164:167], a[208:211], v[208:211], v[164:167]
    ds_read_b128 v[204:207], v239 offset:32768
    v_mfma_f32_16x16x32_bf16 v[168:171], a[212:215], v[208:211], v[168:171]
    v_mfma_f32_16x16x32_bf16 v[172:175], a[216:219], v[208:211], v[172:175]
    v_mfma_f32_16x16x32_bf16 v[176:179], a[220:223], v[208:211], v[176:179]
    v_mfma_f32_16x16x32_bf16 v[180:183], v[224:227], v[208:211], v[180:183]
    s_waitcnt lgkmcnt(3)
    v_mfma_f32_16x16x32_bf16 v[164:167], a[224:227], v[212:215], v[164:167]
    ds_read_b128 v[208:211], v239 offset:33792
    v_mfma_f32_16x16x32_bf16 v[168:171], a[228:231], v[212:215], v[168:171]
    v_mfma_f32_16x16x32_bf16 v[172:175], a[232:235], v[212:215], v[172:175]
    v_mfma_f32_16x16x32_bf16 v[176:179], a[236:239], v[212:215], v[176:179]
    v_mfma_f32_16x16x32_bf16 v[180:183], v[228:231], v[212:215], v[180:183]
    s_waitcnt lgkmcnt(2)
    v_mfma_f32_16x16x32_bf16 v[164:167], a[240:243], v[216:219], v[164:167]
    ds_read_b128 v[212:215], v239 offset:36864
    v_mfma_f32_16x16x32_bf16 v[168:171], a[244:247], v[216:219], v[168:171]
    v_mfma_f32_16x16x32_bf16 v[172:175], a[248:251], v[216:219], v[172:175]
    v_mfma_f32_16x16x32_bf16 v[176:179], a[252:255], v[216:219], v[176:179]
    v_mfma_f32_16x16x32_bf16 v[180:183], v[232:235], v[216:219], v[180:183]
    s_waitcnt lgkmcnt(2)
    v_mfma_f32_16x16x32_bf16 v[164:167], v[4:7], v[204:207], v[164:167]
    ds_read_b128 v[216:219], v239 offset:37888
    v_mfma_f32_16x16x32_bf16 v[168:171], v[8:11], v[204:207], v[168:171]
    v_mfma_f32_16x16x32_bf16 v[172:175], v[12:15], v[204:207], v[172:175]
    v_mfma_f32_16x16x32_bf16 v[176:179], v[16:19], v[204:207], v[176:179]
    v_mfma_f32_16x16x32_bf16 v[180:183], v[132:135], v[204:207], v[180:183]
    s_waitcnt lgkmcnt(2)
    v_mfma_f32_16x16x32_bf16 v[164:167], v[20:23], v[208:211], v[164:167]
    ds_read_b128 v[204:207], v239 offset:40960
    v_mfma_f32_16x16x32_bf16 v[168:171], v[24:27], v[208:211], v[168:171]
    v_mfma_f32_16x16x32_bf16 v[172:175], v[28:31], v[208:211], v[172:175]
    v_mfma_f32_16x16x32_bf16 v[176:179], v[32:35], v[208:211], v[176:179]
    v_mfma_f32_16x16x32_bf16 v[180:183], v[136:139], v[208:211], v[180:183]
    s_waitcnt lgkmcnt(2)
    v_mfma_f32_16x16x32_bf16 v[164:167], v[36:39], v[212:215], v[164:167]
    ds_read_b128 v[208:211], v239 offset:41984
    v_mfma_f32_16x16x32_bf16 v[168:171], v[40:43], v[212:215], v[168:171]
    v_mfma_f32_16x16x32_bf16 v[172:175], v[44:47], v[212:215], v[172:175]
    v_mfma_f32_16x16x32_bf16 v[176:179], v[48:51], v[212:215], v[176:179]
    v_mfma_f32_16x16x32_bf16 v[180:183], v[140:143], v[212:215], v[180:183]
    s_waitcnt lgkmcnt(2)
    v_mfma_f32_16x16x32_bf16 v[164:167], v[52:55], v[216:219], v[164:167]
    ds_read_b128 v[212:215], v239 offset:45056
    v_mfma_f32_16x16x32_bf16 v[168:171], v[56:59], v[216:219], v[168:171]
    v_mfma_f32_16x16x32_bf16 v[172:175], v[60:63], v[216:219], v[172:175]
    v_mfma_f32_16x16x32_bf16 v[176:179], v[64:67], v[216:219], v[176:179]
    v_mfma_f32_16x16x32_bf16 v[180:183], v[144:147], v[216:219], v[180:183]
    s_waitcnt lgkmcnt(2)
    v_mfma_f32_16x16x32_bf16 v[164:167], v[68:71], v[204:207], v[164:167]
    ds_read_b128 v[216:219], v239 offset:46080
    v_mfma_f32_16x16x32_bf16 v[168:171], v[72:75], v[204:207], v[168:171]
    v_mfma_f32_16x16x32_bf16 v[172:175], v[76:79], v[204:207], v[172:175]
    v_mfma_f32_16x16x32_bf16 v[176:179], v[80:83], v[204:207], v[176:179]
    v_mfma_f32_16x16x32_bf16 v[180:183], v[148:151], v[204:207], v[180:183]
    s_waitcnt vmcnt(0)
    s_barrier
    s_waitcnt lgkmcnt(2)
    v_mfma_f32_16x16x32_bf16 v[164:167], v[84:87], v[208:211], v[164:167]
    ds_read_b128 v[204:207], v239 offset:2048
    v_mfma_f32_16x16x32_bf16 v[168:171], v[88:91], v[208:211], v[168:171]
    ds_read_b128 v[220:223], v240 offset:0
    v_mfma_f32_16x16x32_bf16 v[172:175], v[92:95], v[208:211], v[172:175]
    v_mfma_f32_16x16x32_bf16 v[176:179], v[96:99], v[208:211], v[176:179]
    v_mfma_f32_16x16x32_bf16 v[180:183], v[152:155], v[208:211], v[180:183]
    s_waitcnt lgkmcnt(3)
    v_mfma_f32_16x16x32_bf16 v[164:167], v[100:103], v[212:215], v[164:167]
    ds_read_b128 v[208:211], v239 offset:3072
    v_mfma_f32_16x16x32_bf16 v[168:171], v[104:107], v[212:215], v[168:171]
    ds_read_b128 v[224:227], v240 offset:1024
    v_mfma_f32_16x16x32_bf16 v[172:175], v[108:111], v[212:215], v[172:175]
    v_mfma_f32_16x16x32_bf16 v[176:179], v[112:115], v[212:215], v[176:179]
    v_mfma_f32_16x16x32_bf16 v[180:183], v[156:159], v[212:215], v[180:183]
    s_waitcnt lgkmcnt(4)
    v_mfma_f32_16x16x32_bf16 v[164:167], v[116:119], v[216:219], v[164:167]
    ds_read_b128 v[212:215], v239 offset:6144
    v_mfma_f32_16x16x32_bf16 v[168:171], v[120:123], v[216:219], v[168:171]
    ds_read_b128 v[228:231], v240 offset:2048
    v_mfma_f32_16x16x32_bf16 v[172:175], v[124:127], v[216:219], v[172:175]
    v_mfma_f32_16x16x32_bf16 v[176:179], v[128:131], v[216:219], v[176:179]
    v_mfma_f32_16x16x32_bf16 v[180:183], v[160:163], v[216:219], v[180:183]
    s_waitcnt lgkmcnt(4)
    v_mfma_f32_16x16x32_bf16 v[184:187], a[0:3], v[204:207], 0
    ds_read_b128 v[216:219], v239 offset:7168
    v_mfma_f32_16x16x32_bf16 v[188:191], a[4:7], v[204:207], 0
    ds_read_b128 v[232:235], v240 offset:3072
    v_mfma_f32_16x16x32_bf16 v[192:195], a[8:11], v[204:207], 0
    v_mfma_f32_16x16x32_bf16 v[196:199], a[12:15], v[204:207], 0
    v_mfma_f32_16x16x32_bf16 v[200:203], v[220:223], v[204:207], 0
    s_waitcnt lgkmcnt(5)
    v_mfma_f32_16x16x32_bf16 v[184:187], a[16:19], v[208:211], v[184:187]
    s_add_u32 s77, s72, 0
    ds_read_b128 v[204:207], v239 offset:10240
    s_add_u32 s78, s72, 32768
    v_mfma_f32_16x16x32_bf16 v[188:191], a[20:23], v[208:211], v[188:191]
    ds_read_b128 v[220:223], v240 offset:4096
    v_cvt_pk_bf16_f32 v164, v164, v165
    v_mfma_f32_16x16x32_bf16 v[192:195], a[24:27], v[208:211], v[192:195]
    v_cvt_pk_bf16_f32 v165, v166, v167
    v_cvt_pk_bf16_f32 v166, v168, v169
    v_mfma_f32_16x16x32_bf16 v[196:199], a[28:31], v[208:211], v[196:199]
    v_cvt_pk_bf16_f32 v167, v170, v171
    s_waitcnt lgkmcnt(6)
    v_mfma_f32_16x16x32_bf16 v[200:203], v[224:227], v[208:211], v[200:203]
    s_waitcnt lgkmcnt(4)
    buffer_store_dwordx4 v[164:167], v241, s[4:7], s77 offen sc1
    v_cvt_pk_bf16_f32 v168, v172, v173
    v_cvt_pk_bf16_f32 v169, v174, v175
    v_cvt_pk_bf16_f32 v170, v176, v177
    v_cvt_pk_bf16_f32 v171, v178, v179
    v_mfma_f32_16x16x32_bf16 v[184:187], a[32:35], v[212:215], v[184:187]
    ds_read_b128 v[208:211], v239 offset:11264
    v_mfma_f32_16x16x32_bf16 v[188:191], a[36:39], v[212:215], v[188:191]
    ds_read_b128 v[224:227], v240 offset:5120
    v_mfma_f32_16x16x32_bf16 v[192:195], a[40:43], v[212:215], v[192:195]
    buffer_store_dwordx4 v[168:171], v241, s[4:7], s78 offen sc1
    v_cvt_pk_bf16_f32 v172, v180, v181
    v_cvt_pk_bf16_f32 v173, v182, v183
    v_mfma_f32_16x16x32_bf16 v[196:199], a[44:47], v[212:215], v[196:199]
    buffer_store_dwordx2 v[172:173], v242, s[4:7], s72 offen offset:0 sc1
    v_mfma_f32_16x16x32_bf16 v[200:203], v[228:231], v[212:215], v[200:203]
    s_waitcnt lgkmcnt(4)
    v_mfma_f32_16x16x32_bf16 v[184:187], a[48:51], v[216:219], v[184:187]
    ds_read_b128 v[212:215], v239 offset:14336
    v_mfma_f32_16x16x32_bf16 v[188:191], a[52:55], v[216:219], v[188:191]
    ds_read_b128 v[228:231], v240 offset:6144
    v_mfma_f32_16x16x32_bf16 v[192:195], a[56:59], v[216:219], v[192:195]
    v_mfma_f32_16x16x32_bf16 v[196:199], a[60:63], v[216:219], v[196:199]
    v_mfma_f32_16x16x32_bf16 v[200:203], v[232:235], v[216:219], v[200:203]
    s_waitcnt lgkmcnt(4)
    v_mfma_f32_16x16x32_bf16 v[184:187], a[64:67], v[204:207], v[184:187]
    ds_read_b128 v[216:219], v239 offset:15360
    v_mfma_f32_16x16x32_bf16 v[188:191], a[68:71], v[204:207], v[188:191]
    ds_read_b128 v[232:235], v240 offset:7168
    v_mfma_f32_16x16x32_bf16 v[192:195], a[72:75], v[204:207], v[192:195]
    v_mfma_f32_16x16x32_bf16 v[196:199], a[76:79], v[204:207], v[196:199]
    v_mfma_f32_16x16x32_bf16 v[200:203], v[220:223], v[204:207], v[200:203]
    s_waitcnt lgkmcnt(4)
    v_mfma_f32_16x16x32_bf16 v[184:187], a[80:83], v[208:211], v[184:187]
    ds_read_b128 v[204:207], v239 offset:18432
    v_mfma_f32_16x16x32_bf16 v[188:191], a[84:87], v[208:211], v[188:191]
    ds_read_b128 v[220:223], v240 offset:8192
    v_mfma_f32_16x16x32_bf16 v[192:195], a[88:91], v[208:211], v[192:195]
    v_mfma_f32_16x16x32_bf16 v[196:199], a[92:95], v[208:211], v[196:199]
    v_mfma_f32_16x16x32_bf16 v[200:203], v[224:227], v[208:211], v[200:203]
    s_waitcnt lgkmcnt(4)
    v_mfma_f32_16x16x32_bf16 v[184:187], a[96:99], v[212:215], v[184:187]
    ds_read_b128 v[208:211], v239 offset:19456
    v_mfma_f32_16x16x32_bf16 v[188:191], a[100:103], v[212:215], v[188:191]
    ds_read_b128 v[224:227], v240 offset:9216
    v_mfma_f32_16x16x32_bf16 v[192:195], a[104:107], v[212:215], v[192:195]
    v_mfma_f32_16x16x32_bf16 v[196:199], a[108:111], v[212:215], v[196:199]
    v_mfma_f32_16x16x32_bf16 v[200:203], v[228:231], v[212:215], v[200:203]
    s_waitcnt lgkmcnt(4)
    v_mfma_f32_16x16x32_bf16 v[184:187], a[112:115], v[216:219], v[184:187]
    ds_read_b128 v[212:215], v239 offset:22528
    v_mfma_f32_16x16x32_bf16 v[188:191], a[116:119], v[216:219], v[188:191]
    ds_read_b128 v[228:231], v240 offset:10240
    v_mfma_f32_16x16x32_bf16 v[192:195], a[120:123], v[216:219], v[192:195]
    v_mfma_f32_16x16x32_bf16 v[196:199], a[124:127], v[216:219], v[196:199]
    v_mfma_f32_16x16x32_bf16 v[200:203], v[232:235], v[216:219], v[200:203]
    s_waitcnt lgkmcnt(4)
    v_mfma_f32_16x16x32_bf16 v[184:187], a[128:131], v[204:207], v[184:187]
    ds_read_b128 v[216:219], v239 offset:23552
    v_mfma_f32_16x16x32_bf16 v[188:191], a[132:135], v[204:207], v[188:191]
    ds_read_b128 v[232:235], v240 offset:11264
    v_mfma_f32_16x16x32_bf16 v[192:195], a[136:139], v[204:207], v[192:195]
    v_mfma_f32_16x16x32_bf16 v[196:199], a[140:143], v[204:207], v[196:199]
    v_mfma_f32_16x16x32_bf16 v[200:203], v[220:223], v[204:207], v[200:203]
    s_waitcnt lgkmcnt(4)
    v_mfma_f32_16x16x32_bf16 v[184:187], a[144:147], v[208:211], v[184:187]
    ds_read_b128 v[204:207], v239 offset:26624
    v_mfma_f32_16x16x32_bf16 v[188:191], a[148:151], v[208:211], v[188:191]
    ds_read_b128 v[220:223], v240 offset:12288
    v_mfma_f32_16x16x32_bf16 v[192:195], a[152:155], v[208:211], v[192:195]
    v_mfma_f32_16x16x32_bf16 v[196:199], a[156:159], v[208:211], v[196:199]
    v_mfma_f32_16x16x32_bf16 v[200:203], v[224:227], v[208:211], v[200:203]
    s_waitcnt lgkmcnt(4)
    v_mfma_f32_16x16x32_bf16 v[184:187], a[160:163], v[212:215], v[184:187]
    ds_read_b128 v[208:211], v239 offset:27648
    v_mfma_f32_16x16x32_bf16 v[188:191], a[164:167], v[212:215], v[188:191]
    ds_read_b128 v[224:227], v240 offset:13312
    v_mfma_f32_16x16x32_bf16 v[192:195], a[168:171], v[212:215], v[192:195]
    v_mfma_f32_16x16x32_bf16 v[196:199], a[172:175], v[212:215], v[196:199]
    v_mfma_f32_16x16x32_bf16 v[200:203], v[228:231], v[212:215], v[200:203]
    s_lshl_b32 s65, s62, 1
    s_add_u32 s65, s65, 1
    s_waitcnt vmcnt(0)
    v_mov_b32 v236, s65
    s_mov_b64 exec, 1
    buffer_store_dword v236, off, s[4:7], s63 sc1
    buffer_store_dword v236, off, s[4:7], s3
    s_mov_b64 exec, -1
    s_waitcnt lgkmcnt(5)
    v_mfma_f32_16x16x32_bf16 v[184:187], a[176:179], v[216:219], v[184:187]
    ds_read_b128 v[212:215], v239 offset:30720
    v_mfma_f32_16x16x32_bf16 v[188:191], a[180:183], v[216:219], v[188:191]
    ds_read_b128 v[228:231], v240 offset:14336
    v_mfma_f32_16x16x32_bf16 v[192:195], a[184:187], v[216:219], v[192:195]
    v_mfma_f32_16x16x32_bf16 v[196:199], a[188:191], v[216:219], v[196:199]
    s_waitcnt lgkmcnt(6)
    v_mfma_f32_16x16x32_bf16 v[200:203], v[232:235], v[216:219], v[200:203]
    s_waitcnt lgkmcnt(4)
    v_mfma_f32_16x16x32_bf16 v[184:187], a[192:195], v[204:207], v[184:187]
    ds_read_b128 v[216:219], v239 offset:31744
    v_mfma_f32_16x16x32_bf16 v[188:191], a[196:199], v[204:207], v[188:191]
    ds_read_b128 v[232:235], v240 offset:15360
    v_mfma_f32_16x16x32_bf16 v[192:195], a[200:203], v[204:207], v[192:195]
    v_mfma_f32_16x16x32_bf16 v[196:199], a[204:207], v[204:207], v[196:199]
    v_mfma_f32_16x16x32_bf16 v[200:203], v[220:223], v[204:207], v[200:203]
    s_waitcnt lgkmcnt(4)
    v_mfma_f32_16x16x32_bf16 v[184:187], a[208:211], v[208:211], v[184:187]
    ds_read_b128 v[204:207], v239 offset:34816
    v_mfma_f32_16x16x32_bf16 v[188:191], a[212:215], v[208:211], v[188:191]
    v_mfma_f32_16x16x32_bf16 v[192:195], a[216:219], v[208:211], v[192:195]
    v_mfma_f32_16x16x32_bf16 v[196:199], a[220:223], v[208:211], v[196:199]
    v_mfma_f32_16x16x32_bf16 v[200:203], v[224:227], v[208:211], v[200:203]
    s_waitcnt lgkmcnt(3)
    v_mfma_f32_16x16x32_bf16 v[184:187], a[224:227], v[212:215], v[184:187]
    ds_read_b128 v[208:211], v239 offset:35840
    v_mfma_f32_16x16x32_bf16 v[188:191], a[228:231], v[212:215], v[188:191]
    v_mfma_f32_16x16x32_bf16 v[192:195], a[232:235], v[212:215], v[192:195]
    v_mfma_f32_16x16x32_bf16 v[196:199], a[236:239], v[212:215], v[196:199]
    v_mfma_f32_16x16x32_bf16 v[200:203], v[228:231], v[212:215], v[200:203]
    s_waitcnt lgkmcnt(2)
    v_mfma_f32_16x16x32_bf16 v[184:187], a[240:243], v[216:219], v[184:187]
    ds_read_b128 v[212:215], v239 offset:38912
    buffer_load_dword v244, v243, s[4:7], 0 offen sc1
    v_mfma_f32_16x16x32_bf16 v[188:191], a[244:247], v[216:219], v[188:191]
    v_mfma_f32_16x16x32_bf16 v[192:195], a[248:251], v[216:219], v[192:195]
    v_mfma_f32_16x16x32_bf16 v[196:199], a[252:255], v[216:219], v[196:199]
    v_mfma_f32_16x16x32_bf16 v[200:203], v[232:235], v[216:219], v[200:203]
    s_waitcnt lgkmcnt(2)
    v_mfma_f32_16x16x32_bf16 v[184:187], v[4:7], v[204:207], v[184:187]
    ds_read_b128 v[216:219], v239 offset:39936
    v_mfma_f32_16x16x32_bf16 v[188:191], v[8:11], v[204:207], v[188:191]
    v_mfma_f32_16x16x32_bf16 v[192:195], v[12:15], v[204:207], v[192:195]
    v_mfma_f32_16x16x32_bf16 v[196:199], v[16:19], v[204:207], v[196:199]
    v_mfma_f32_16x16x32_bf16 v[200:203], v[132:135], v[204:207], v[200:203]
    s_waitcnt lgkmcnt(2)
    v_mfma_f32_16x16x32_bf16 v[184:187], v[20:23], v[208:211], v[184:187]
    ds_read_b128 v[204:207], v239 offset:43008
    v_mfma_f32_16x16x32_bf16 v[188:191], v[24:27], v[208:211], v[188:191]
    v_mfma_f32_16x16x32_bf16 v[192:195], v[28:31], v[208:211], v[192:195]
    v_mfma_f32_16x16x32_bf16 v[196:199], v[32:35], v[208:211], v[196:199]
    v_mfma_f32_16x16x32_bf16 v[200:203], v[136:139], v[208:211], v[200:203]
    s_waitcnt lgkmcnt(2)
    v_mfma_f32_16x16x32_bf16 v[184:187], v[36:39], v[212:215], v[184:187]
    ds_read_b128 v[208:211], v239 offset:44032
    v_mfma_f32_16x16x32_bf16 v[188:191], v[40:43], v[212:215], v[188:191]
    v_mfma_f32_16x16x32_bf16 v[192:195], v[44:47], v[212:215], v[192:195]
    v_mfma_f32_16x16x32_bf16 v[196:199], v[48:51], v[212:215], v[196:199]
    v_mfma_f32_16x16x32_bf16 v[200:203], v[140:143], v[212:215], v[200:203]
    s_add_u32 s65, s62, 2
    s_waitcnt vmcnt(0)
    v_cmp_gt_u32 vcc, s65, v244
    s_mov_b32 s74, 0
    s_cbranch_vccz L_Tpre
    s_waitcnt lgkmcnt(2)
    v_mfma_f32_16x16x32_bf16 v[184:187], v[52:55], v[216:219], v[184:187]
    ds_read_b128 v[212:215], v239 offset:47104
    v_mfma_f32_16x16x32_bf16 v[188:191], v[56:59], v[216:219], v[188:191]
    v_mfma_f32_16x16x32_bf16 v[192:195], v[60:63], v[216:219], v[192:195]
    v_mfma_f32_16x16x32_bf16 v[196:199], v[64:67], v[216:219], v[196:199]
    v_mfma_f32_16x16x32_bf16 v[200:203], v[144:147], v[216:219], v[200:203]
    s_waitcnt lgkmcnt(2)
    v_mfma_f32_16x16x32_bf16 v[184:187], v[68:71], v[204:207], v[184:187]
    ds_read_b128 v[216:219], v239 offset:48128
    v_mfma_f32_16x16x32_bf16 v[188:191], v[72:75], v[204:207], v[188:191]
    v_mfma_f32_16x16x32_bf16 v[192:195], v[76:79], v[204:207], v[192:195]
    v_mfma_f32_16x16x32_bf16 v[196:199], v[80:83], v[204:207], v[196:199]
    v_mfma_f32_16x16x32_bf16 v[200:203], v[148:151], v[204:207], v[200:203]
    s_waitcnt lgkmcnt(2)
    v_mfma_f32_16x16x32_bf16 v[184:187], v[84:87], v[208:211], v[184:187]
    v_mfma_f32_16x16x32_bf16 v[188:191], v[88:91], v[208:211], v[188:191]
    v_mfma_f32_16x16x32_bf16 v[192:195], v[92:95], v[208:211], v[192:195]
    v_mfma_f32_16x16x32_bf16 v[196:199], v[96:99], v[208:211], v[196:199]
    v_mfma_f32_16x16x32_bf16 v[200:203], v[152:155], v[208:211], v[200:203]
    s_waitcnt lgkmcnt(1)
    v_mfma_f32_16x16x32_bf16 v[184:187], v[100:103], v[212:215], v[184:187]
    v_mfma_f32_16x16x32_bf16 v[188:191], v[104:107], v[212:215], v[188:191]
    v_mfma_f32_16x16x32_bf16 v[192:195], v[108:111], v[212:215], v[192:195]
    v_mfma_f32_16x16x32_bf16 v[196:199], v[112:115], v[212:215], v[196:199]
    v_mfma_f32_16x16x32_bf16 v[200:203], v[156:159], v[212:215], v[200:203]
    s_waitcnt lgkmcnt(0)
    v_mfma_f32_16x16x32_bf16 v[184:187], v[116:119], v[216:219], v[184:187]
    v_mfma_f32_16x16x32_bf16 v[188:191], v[120:123], v[216:219], v[188:191]
    v_mfma_f32_16x16x32_bf16 v[192:195], v[124:127], v[216:219], v[192:195]
    v_mfma_f32_16x16x32_bf16 v[196:199], v[128:131], v[216:219], v[196:199]
    v_mfma_f32_16x16x32_bf16 v[200:203], v[160:163], v[216:219], v[200:203]
L_Tend:
    v_xor_b32 v239, 49152, v239
    s_add_u32 s77, s72, 16384
    s_add_u32 s78, s72, 49152
    s_nop 0
    v_cvt_pk_bf16_f32 v184, v184, v185
    v_cvt_pk_bf16_f32 v185, v186, v187
    v_cvt_pk_bf16_f32 v186, v188, v189
    v_cvt_pk_bf16_f32 v187, v190, v191
    buffer_store_dwordx4 v[184:187], v241, s[4:7], s77 offen sc1
    v_cvt_pk_bf16_f32 v188, v192, v193
    v_cvt_pk_bf16_f32 v189, v194, v195
    v_cvt_pk_bf16_f32 v190, v196, v197
    v_cvt_pk_bf16_f32 v191, v198, v199
    buffer_store_dwordx4 v[188:191], v241, s[4:7], s78 offen sc1
    v_cvt_pk_bf16_f32 v192, v200, v201
    v_cvt_pk_bf16_f32 v193, v202, v203
    buffer_store_dwordx2 v[192:193], v242, s[4:7], s72 offen offset:512 sc1
    s_add_u32 s62, s62, 1
    s_cmp_lt_u32 s62, 64
    s_cbranch_scc1 L_Tseg
    s_lshl_b32 s65, s62, 1
    s_add_u32 s65, s65, 0
    s_waitcnt vmcnt(0)
    v_mov_b32 v236, s65
    s_mov_b64 exec, 1
    buffer_store_dword v236, off, s[4:7], s63 sc1
    buffer_store_dword v236, off, s[4:7], s3
    s_mov_b64 exec, -1
    s_endpgm
L_Tpre:
    s_mov_b32 s74, 1
    s_waitcnt lgkmcnt(2)
    v_mfma_f32_16x16x32_bf16 v[184:187], v[52:55], v[216:219], v[184:187]
    s_add_u32 m0, s73, 0
    ds_read_b128 v[212:215], v239 offset:47104
    s_add_u32 s64, s70, 0
    v_mfma_f32_16x16x32_bf16 v[188:191], v[56:59], v[216:219], v[188:191]
    buffer_load_dwordx4 v238, s[4:7], s64 offen sc1 lds
    s_add_u32 m0, s73, 8192
    v_mfma_f32_16x16x32_bf16 v[192:195], v[60:63], v[216:219], v[192:195]
    s_add_u32 s64, s70, 8192
    buffer_load_dwordx4 v238, s[4:7], s64 offen sc1 lds
    s_add_u32 m0, s73, 16384
    v_mfma_f32_16x16x32_bf16 v[196:199], v[64:67], v[216:219], v[196:199]
    s_add_u32 s64, s70, 16384
    buffer_load_dwordx4 v238, s[4:7], s64 offen sc1 lds
    s_add_u32 m0, s73, 24576
    v_mfma_f32_16x16x32_bf16 v[200:203], v[144:147], v[216:219], v[200:203]
    s_waitcnt lgkmcnt(2)
    s_add_u32 s64, s70, 24576
    buffer_load_dwordx4 v238, s[4:7], s64 offen sc1 lds
    v_mfma_f32_16x16x32_bf16 v[184:187], v[68:71], v[204:207], v[184:187]
    s_add_u32 m0, s73, 32768
    ds_read_b128 v[216:219], v239 offset:48128
    s_add_u32 s64, s70, 32768
    v_mfma_f32_16x16x32_bf16 v[188:191], v[72:75], v[204:207], v[188:191]
    buffer_load_dwordx4 v238, s[4:7], s64 offen sc1 lds
    s_add_u32 m0, s73, 40960
    v_mfma_f32_16x16x32_bf16 v[192:195], v[76:79], v[204:207], v[192:195]
    s_add_u32 s64, s70, 40960
    buffer_load_dwordx4 v238, s[4:7], s64 offen sc1 lds
    s_add_u32 m0, s73, 2048
    v_mfma_f32_16x16x32_bf16 v[196:199], v[80:83], v[204:207], v[196:199]
    s_add_u32 s64, s70, 2048
    buffer_load_dwordx4 v238, s[4:7], s64 offen sc1 lds
    s_add_u32 m0, s73, 10240
    v_mfma_f32_16x16x32_bf16 v[200:203], v[148:151], v[204:207], v[200:203]
    s_waitcnt lgkmcnt(2)
    s_add_u32 s64, s70, 10240
    buffer_load_dwordx4 v238, s[4:7], s64 offen sc1 lds
    v_mfma_f32_16x16x32_bf16 v[184:187], v[84:87], v[208:211], v[184:187]
    s_add_u32 m0, s73, 18432
    s_add_u32 s64, s70, 18432
    buffer_load_dwordx4 v238, s[4:7], s64 offen sc1 lds
    v_mfma_f32_16x16x32_bf16 v[188:191], v[88:91], v[208:211], v[188:191]
    s_add_u32 m0, s73, 26624
    s_add_u32 s64, s70, 26624
    buffer_load_dwordx4 v238, s[4:7], s64 offen sc1 lds
    v_mfma_f32_16x16x32_bf16 v[192:195], v[92:95], v[208:211], v[192:195]
    s_add_u32 m0, s73, 34816
    s_add_u32 s64, s70, 34816
    buffer_load_dwordx4 v238, s[4:7], s64 offen sc1 lds
    v_mfma_f32_16x16x32_bf16 v[196:199], v[96:99], v[208:211], v[196:199]
    s_add_u32 m0, s73, 43008
    s_add_u32 s64, s70, 43008
    buffer_load_dwordx4 v238, s[4:7], s64 offen sc1 lds
    v_mfma_f32_16x16x32_bf16 v[200:203], v[152:155], v[208:211], v[200:203]
    s_waitcnt lgkmcnt(1)
    s_add_u32 s70, s70, 393216
    s_add_u32 s66, s62, 2
    v_mfma_f32_16x16x32_bf16 v[184:187], v[100:103], v[212:215], v[184:187]
    s_and_b32 s66, s66, 7
    s_cselect_b32 s66, 0, 3145728
    s_sub_u32 s70, s70, s66
    v_mfma_f32_16x16x32_bf16 v[188:191], v[104:107], v[212:215], v[188:191]
    s_xor_b32 s73, s73, 49152
    v_mfma_f32_16x16x32_bf16 v[192:195], v[108:111], v[212:215], v[192:195]
    v_mfma_f32_16x16x32_bf16 v[196:199], v[112:115], v[212:215], v[196:199]
    v_mfma_f32_16x16x32_bf16 v[200:203], v[156:159], v[212:215], v[200:203]
    s_waitcnt lgkmcnt(0)
    v_mfma_f32_16x16x32_bf16 v[184:187], v[116:119], v[216:219], v[184:187]
    v_mfma_f32_16x16x32_bf16 v[188:191], v[120:123], v[216:219], v[188:191]
    v_mfma_f32_16x16x32_bf16 v[192:195], v[124:127], v[216:219], v[192:195]
    v_mfma_f32_16x16x32_bf16 v[196:199], v[128:131], v[216:219], v[196:199]
    v_mfma_f32_16x16x32_bf16 v[200:203], v[160:163], v[216:219], v[200:203]
    s_branch L_Tend
Lgrty_59:
    s_sleep 16
    buffer_load_dword v2, off, s[8:11], 0 offset:132 sc1
    s_sub_u32 s61, s61, 1
    s_mov_b32 s67, 1
    s_cbranch_scc1 L_fail
    s_branch Lgchk_58
Lprty_62:
    s_sleep 16
    buffer_load_dword v2, off, s[8:11], 0 offset:140 sc1
    s_sub_u32 s61, s61, 1
    s_mov_b32 s67, 16
    s_cbranch_scc1 L_fail
    s_branch Lpchk_61
Lfrty_64:
    s_sleep 2
    buffer_load_dword v244, v243, s[4:7], 0 offen sc1
    s_sub_u32 s61, s61, 1
    s_mov_b32 s67, 20
    s_cbranch_scc1 L_fail
    s_waitcnt vmcnt(0)
    s_branch Lfchk_63
L_roleB:
    s_mov_b32 s20, s48
    s_mov_b32 s21, s49
    s_mov_b32 s22, 2457600
    s_mov_b32 s23, 0x20000
    s_mov_b32 s24, s50
    s_mov_b32 s25, s51
    s_mov_b32 s26, 819200
    s_mov_b32 s27, 0x20000
    v_and_b32 v1, 63, v0
    s_lshl_b32 s76, s69, 1
    s_and_b32 s64, s59, 1
    s_add_u32 s76, s76, s64
    v_lshrrev_b32 v176, 4, v1
    v_bfe_u32 v177, v1, 2, 2
    v_and_b32 v178, 3, v1
    v_lshlrev_b32 v247, 4, v1
    v_and_b32 v169, 31, v1
    v_mul_u32_u24 v170, 26, v169
    v_lshrrev_b32 v170, 8, v170
    v_mul_u32_u24 v168, 1120, v170
    v_lshl_add_u32 v168, v169, 4, v168
    v_lshrrev_b32 v170, 5, v0
    v_mul_u32_u24 v170, 3840, v170
    s_mul_i32 s64, s76, 160
    v_add3_u32 v168, v168, v170, s64
    v_mov_b32 v170, 0x80000000
    v_cmp_gt_u32 vcc, 30, v169
    s_nop 1
    v_cndmask_b32 v168, v170, v168, vcc
    v_lshl_add_u32 v169, v176, 3, v177
    v_lshlrev_b32 v169, 9, v169
    s_mul_i32 s64, s60, 40
    v_mul_u32_u24 v171, 160, v178
    s_add_u32 s65, s64, 32
    v_mov_b32 v172, s65
    v_cmp_gt_u32 vcc, 3, v178
    s_nop 1
    v_cndmask_b32 v172, 0, v172, vcc
    v_add3_u32 v171, v171, v172, v169
    v_lshl_add_u32 v169, v178, 3, v169
    v_add_u32 v169, s64, v169
    v_add_u32 v170, 65536, v169
    v_add_u32 v172, 65536, v171
    v_lshl_add_u32 v173, v178, 2, v177
    v_lshl_add_u32 v173, v176, 4, v173
    v_lshlrev_b32 v173, 2, v173
    s_lshl_b32 s70, s60, 10
    s_cmp_lg_u32 s68, 0
    s_cbranch_scc1 Larr0_65
    s_waitcnt vmcnt(0)
    s_barrier
    s_cmp_lg_u32 s60, 0
    s_cbranch_scc1 Lcnt_66
    s_mov_b64 exec, 1
    v_mov_b32 v2, 1
    buffer_atomic_add v2, off, s[8:11], 0 offset:4 sc0
    v_mov_b32 v3, 0x80000000
    s_waitcnt vmcnt(0)
    v_cmp_ne_u32 vcc, 255, v2
    s_nop 1
    v_cndmask_b32 v3, 4, v3, vcc
    buffer_store_dword v2, v3, s[8:11], 0 offen offset:128 sc1
    s_mov_b64 exec, -1
Lcnt_66:
Larr0_65:
    s_mov_b32 s64, 0
    s_add_u32 m0, s70, 0
    s_nop 0
    buffer_load_dwordx4 v168, s[20:23], s64 offen nt lds
    s_mov_b32 s64, 30720
    s_add_u32 m0, s70, 4096
    s_nop 0
    buffer_load_dwordx4 v168, s[20:23], s64 offen nt lds
    s_mov_b32 s64, 61440
    s_add_u32 m0, s70, 8192
    s_nop 0
    buffer_load_dwordx4 v168, s[20:23], s64 offen nt lds
    s_mov_b32 s64, 92160
    s_add_u32 m0, s70, 12288
    s_nop 0
    buffer_load_dwordx4 v168, s[20:23], s64 offen nt lds
    s_mov_b32 s64, 122880
    s_add_u32 m0, s70, 16384
    s_nop 0
    buffer_load_dwordx4 v168, s[20:23], s64 offen nt lds
    s_mov_b32 s64, 153600
    s_add_u32 m0, s70, 20480
    s_nop 0
    buffer_load_dwordx4 v168, s[20:23], s64 offen nt lds
    s_mov_b32 s64, 184320
    s_add_u32 m0, s70, 24576
    s_nop 0
    buffer_load_dwordx4 v168, s[20:23], s64 offen nt lds
    s_mov_b32 s64, 215040
    s_add_u32 m0, s70, 28672
    s_nop 0
    buffer_load_dwordx4 v168, s[20:23], s64 offen nt lds
    s_mov_b32 s64, 245760
    s_add_u32 m0, s70, 32768
    s_nop 0
    buffer_load_dwordx4 v168, s[20:23], s64 offen nt lds
    s_mov_b32 s64, 276480
    s_add_u32 m0, s70, 36864
    s_nop 0
    buffer_load_dwordx4 v168, s[20:23], s64 offen nt lds
    s_mov_b32 s64, 307200
    s_add_u32 m0, s70, 40960
    s_nop 0
    buffer_load_dwordx4 v168, s[20:23], s64 offen nt lds
    s_mov_b32 s64, 337920
    s_add_u32 m0, s70, 45056
    s_nop 0
    buffer_load_dwordx4 v168, s[20:23], s64 offen nt lds
    s_mov_b32 s64, 368640
    s_add_u32 m0, s70, 49152
    s_nop 0
    buffer_load_dwordx4 v168, s[20:23], s64 offen nt lds
    s_mov_b32 s64, 399360
    s_add_u32 m0, s70, 53248
    s_nop 0
    buffer_load_dwordx4 v168, s[20:23], s64 offen nt lds
    s_mov_b32 s64, 430080
    s_add_u32 m0, s70, 57344
    s_nop 0
    buffer_load_dwordx4 v168, s[20:23], s64 offen nt lds
    s_mov_b32 s64, 460800
    s_add_u32 m0, s70, 61440
    s_nop 0
    buffer_load_dwordx4 v168, s[20:23], s64 offen nt lds
    s_mov_b32 s64, 491520
    s_add_u32 m0, s70, 65536
    s_nop 0
    buffer_load_dwordx4 v168, s[20:23], s64 offen nt lds
    s_mov_b32 s64, 522240
    s_add_u32 m0, s70, 69632
    s_nop 0
    buffer_load_dwordx4 v168, s[20:23], s64 offen nt lds
    s_mov_b32 s64, 552960
    s_add_u32 m0, s70, 73728
    s_nop 0
    buffer_load_dwordx4 v168, s[20:23], s64 offen nt lds
    s_mov_b32 s64, 583680
    s_add_u32 m0, s70, 77824
    s_nop 0
    buffer_load_dwordx4 v168, s[20:23], s64 offen nt lds
    s_mov_b32 s64, 614400
    s_add_u32 m0, s70, 81920
    s_nop 0
    buffer_load_dwordx4 v168, s[20:23], s64 offen nt lds
    s_mov_b32 s64, 645120
    s_add_u32 m0, s70, 86016
    s_nop 0
    buffer_load_dwordx4 v168, s[20:23], s64 offen nt lds
    s_mov_b32 s64, 675840
    s_add_u32 m0, s70, 90112
    s_nop 0
    buffer_load_dwordx4 v168, s[20:23], s64 offen nt lds
    s_mov_b32 s64, 706560
    s_add_u32 m0, s70, 94208
    s_nop 0
    buffer_load_dwordx4 v168, s[20:23], s64 offen nt lds
    s_mov_b32 s64, 737280
    s_add_u32 m0, s70, 98304
    s_nop 0
    buffer_load_dwordx4 v168, s[20:23], s64 offen nt lds
    s_mov_b32 s64, 768000
    s_add_u32 m0, s70, 102400
    s_nop 0
    buffer_load_dwordx4 v168, s[20:23], s64 offen nt lds
    s_mov_b32 s64, 798720
    s_add_u32 m0, s70, 106496
    s_nop 0
    buffer_load_dwordx4 v168, s[20:23], s64 offen nt lds
    s_mov_b32 s64, 829440
    s_add_u32 m0, s70, 110592
    s_nop 0
    buffer_load_dwordx4 v168, s[20:23], s64 offen nt lds
    s_waitcnt vmcnt(24)
    s_waitcnt lgkmcnt(0)
    s_barrier
    s_mov_b32 s64, 860160
    s_add_u32 m0, s70, 114688
    s_nop 0
    buffer_load_dwordx4 v168, s[20:23], s64 offen nt lds
    s_mov_b32 s64, 890880
    s_add_u32 m0, s70, 118784
    s_nop 0
    buffer_load_dwordx4 v168, s[20:23], s64 offen nt lds
    s_mov_b32 s64, 921600
    s_add_u32 m0, s70, 122880
    s_nop 0
    buffer_load_dwordx4 v168, s[20:23], s64 offen nt lds
    s_mov_b32 s64, 952320
    s_add_u32 m0, s70, 126976
    s_nop 0
    buffer_load_dwordx4 v168, s[20:23], s64 offen nt lds
    ds_read_b64_tr_b16 v[204:205], v171 offset:0
    ds_read_b64_tr_b16 v[206:207], v171 offset:2048
    ds_read_b64_tr_b16 a[0:1], v169 offset:0
    ds_read_b64_tr_b16 a[2:3], v169 offset:2048
    ds_read_b64_tr_b16 a[80:81], v169 offset:160
    ds_read_b64_tr_b16 a[82:83], v169 offset:2208
    ds_read_b64_tr_b16 a[160:161], v169 offset:320
    ds_read_b64_tr_b16 a[162:163], v169 offset:2368
    s_waitcnt lgkmcnt(7)
    ds_bpermute_b32 v4, v173, v204
    ds_bpermute_b32 v5, v173, v205
    s_waitcnt lgkmcnt(8)
    ds_bpermute_b32 v6, v173, v206
    ds_bpermute_b32 v7, v173, v207
    s_waitcnt vmcnt(24)
    s_waitcnt lgkmcnt(0)
    s_barrier
    s_mov_b32 s64, 983040
    s_add_u32 m0, s70, 0
    s_nop 0
    buffer_load_dwordx4 v168, s[20:23], s64 offen nt lds
    s_mov_b32 s64, 1013760
    s_add_u32 m0, s70, 4096
    s_nop 0
    buffer_load_dwordx4 v168, s[20:23], s64 offen nt lds
    s_mov_b32 s64, 1044480
    s_add_u32 m0, s70, 8192
    s_nop 0
    buffer_load_dwordx4 v168, s[20:23], s64 offen nt lds
    s_mov_b32 s64, 1075200
    s_add_u32 m0, s70, 12288
    s_nop 0
    buffer_load_dwordx4 v168, s[20:23], s64 offen nt lds
    ds_read_b64_tr_b16 v[204:205], v171 offset:16384
    ds_read_b64_tr_b16 v[206:207], v171 offset:18432
    ds_read_b64_tr_b16 a[4:5], v169 offset:16384
    ds_read_b64_tr_b16 a[6:7], v169 offset:18432
    ds_read_b64_tr_b16 a[84:85], v169 offset:16544
    ds_read_b64_tr_b16 a[86:87], v169 offset:18592
    ds_read_b64_tr_b16 a[164:165], v169 offset:16704
    ds_read_b64_tr_b16 a[166:167], v169 offset:18752
    s_waitcnt lgkmcnt(7)
    ds_bpermute_b32 v8, v173, v204
    ds_bpermute_b32 v9, v173, v205
    s_waitcnt lgkmcnt(8)
    ds_bpermute_b32 v10, v173, v206
    ds_bpermute_b32 v11, v173, v207
    s_waitcnt vmcnt(24)
    s_waitcnt lgkmcnt(0)
    s_barrier
    s_mov_b32 s64, 1105920
    s_add_u32 m0, s70, 16384
    s_nop 0
    buffer_load_dwordx4 v168, s[20:23], s64 offen nt lds
    s_mov_b32 s64, 1136640
    s_add_u32 m0, s70, 20480
    s_nop 0
    buffer_load_dwordx4 v168, s[20:23], s64 offen nt lds
    s_mov_b32 s64, 1167360
    s_add_u32 m0, s70, 24576
    s_nop 0
    buffer_load_dwordx4 v168, s[20:23], s64 offen nt lds
    s_mov_b32 s64, 1198080
    s_add_u32 m0, s70, 28672
    s_nop 0
    buffer_load_dwordx4 v168, s[20:23], s64 offen nt lds
    ds_read_b64_tr_b16 v[204:205], v171 offset:32768
    ds_read_b64_tr_b16 v[206:207], v171 offset:34816
    ds_read_b64_tr_b16 a[8:9], v169 offset:32768
    ds_read_b64_tr_b16 a[10:11], v169 offset:34816
    ds_read_b64_tr_b16 a[88:89], v169 offset:32928
    ds_read_b64_tr_b16 a[90:91], v169 offset:34976
    ds_read_b64_tr_b16 a[168:169], v169 offset:33088
    ds_read_b64_tr_b16 a[170:171], v169 offset:35136
    s_waitcnt lgkmcnt(7)
    ds_bpermute_b32 v12, v173, v204
    ds_bpermute_b32 v13, v173, v205
    s_waitcnt lgkmcnt(8)
    ds_bpermute_b32 v14, v173, v206
    ds_bpermute_b32 v15, v173, v207
    s_waitcnt vmcnt(24)
    s_waitcnt lgkmcnt(0)
    s_barrier
    s_mov_b32 s64, 1228800
    s_add_u32 m0, s70, 32768
    s_nop 0
    buffer_load_dwordx4 v168, s[20:23], s64 offen nt lds
    s_mov_b32 s64, 1259520
    s_add_u32 m0, s70, 36864
    s_nop 0
    buffer_load_dwordx4 v168, s[20:23], s64 offen nt lds
    s_mov_b32 s64, 1290240
    s_add_u32 m0, s70, 40960
    s_nop 0
    buffer_load_dwordx4 v168, s[20:23], s64 offen nt lds
    s_mov_b32 s64, 1320960
    s_add_u32 m0, s70, 45056
    s_nop 0
    buffer_load_dwordx4 v168, s[20:23], s64 offen nt lds
    ds_read_b64_tr_b16 v[204:205], v171 offset:49152
    ds_read_b64_tr_b16 v[206:207], v171 offset:51200
    ds_read_b64_tr_b16 a[12:13], v169 offset:49152
    ds_read_b64_tr_b16 a[14:15], v169 offset:51200
    ds_read_b64_tr_b16 a[92:93], v169 offset:49312
    ds_read_b64_tr_b16 a[94:95], v169 offset:51360
    ds_read_b64_tr_b16 a[172:173], v169 offset:49472
    ds_read_b64_tr_b16 a[174:175], v169 offset:51520
    s_waitcnt lgkmcnt(7)
    ds_bpermute_b32 v16, v173, v204
    ds_bpermute_b32 v17, v173, v205
    s_waitcnt lgkmcnt(8)
    ds_bpermute_b32 v18, v173, v206
    ds_bpermute_b32 v19, v173, v207
    s_waitcnt vmcnt(24)
    s_waitcnt lgkmcnt(0)
    s_barrier
    s_mov_b32 s64, 1351680
    s_add_u32 m0, s70, 49152
    s_nop 0
    buffer_load_dwordx4 v168, s[20:23], s64 offen nt lds
    s_mov_b32 s64, 1382400
    s_add_u32 m0, s70, 53248
    s_nop 0
    buffer_load_dwordx4 v168, s[20:23], s64 offen nt lds
    s_mov_b32 s64, 1413120
    s_add_u32 m0, s70, 57344
    s_nop 0
    buffer_load_dwordx4 v168, s[20:23], s64 offen nt lds
    s_mov_b32 s64, 1443840
    s_add_u32 m0, s70, 61440
    s_nop 0
    buffer_load_dwordx4 v168, s[20:23], s64 offen nt lds
    ds_read_b64_tr_b16 v[204:205], v172 offset:0
    ds_read_b64_tr_b16 v[206:207], v172 offset:2048
    ds_read_b64_tr_b16 a[16:17], v170 offset:0
    ds_read_b64_tr_b16 a[18:19], v170 offset:2048
    ds_read_b64_tr_b16 a[96:97], v170 offset:160
    ds_read_b64_tr_b16 a[98:99], v170 offset:2208
    ds_read_b64_tr_b16 a[176:177], v170 offset:320
    ds_read_b64_tr_b16 a[178:179], v170 offset:2368
    s_waitcnt lgkmcnt(7)
    ds_bpermute_b32 v20, v173, v204
    ds_bpermute_b32 v21, v173, v205
    s_waitcnt lgkmcnt(8)
    ds_bpermute_b32 v22, v173, v206
    ds_bpermute_b32 v23, v173, v207
    s_waitcnt vmcnt(24)
    s_waitcnt lgkmcnt(0)
    s_barrier
    s_mov_b32 s64, 1474560
    s_add_u32 m0, s70, 65536
    s_nop 0
    buffer_load_dwordx4 v168, s[20:23], s64 offen nt lds
    s_mov_b32 s64, 1505280
    s_add_u32 m0, s70, 69632
    s_nop 0
    buffer_load_dwordx4 v168, s[20:23], s64 offen nt lds
    s_mov_b32 s64, 1536000
    s_add_u32 m0, s70, 73728
    s_nop 0
    buffer_load_dwordx4 v168, s[20:23], s64 offen nt lds
    s_mov_b32 s64, 1566720
    s_add_u32 m0, s70, 77824
    s_nop 0
    buffer_load_dwordx4 v168, s[20:23], s64 offen nt lds
    ds_read_b64_tr_b16 v[204:205], v172 offset:16384
    ds_read_b64_tr_b16 v[206:207], v172 offset:18432
    ds_read_b64_tr_b16 a[20:21], v170 offset:16384
    ds_read_b64_tr_b16 a[22:23], v170 offset:18432
    ds_read_b64_tr_b16 a[100:101], v170 offset:16544
    ds_read_b64_tr_b16 a[102:103], v170 offset:18592
    ds_read_b64_tr_b16 a[180:181], v170 offset:16704
    ds_read_b64_tr_b16 a[182:183], v170 offset:18752
    s_waitcnt lgkmcnt(7)
    ds_bpermute_b32 v24, v173, v204
    ds_bpermute_b32 v25, v173, v205
    s_waitcnt lgkmcnt(8)
    ds_bpermute_b32 v26, v173, v206
    ds_bpermute_b32 v27, v173, v207
    s_waitcnt vmcnt(24)
    s_waitcnt lgkmcnt(0)
    s_barrier
    s_mov_b32 s64, 1597440
    s_add_u32 m0, s70, 81920
    s_nop 0
    buffer_load_dwordx4 v168, s[20:23], s64 offen nt lds
    s_mov_b32 s64, 1628160
    s_add_u32 m0, s70, 86016
    s_nop 0
    buffer_load_dwordx4 v168, s[20:23], s64 offen nt lds
    s_mov_b32 s64, 1658880
    s_add_u32 m0, s70, 90112
    s_nop 0
    buffer_load_dwordx4 v168, s[20:23], s64 offen nt lds
    s_mov_b32 s64, 1689600
    s_add_u32 m0, s70, 94208
    s_nop 0
    buffer_load_dwordx4 v168, s[20:23], s64 offen nt lds
    ds_read_b64_tr_b16 v[204:205], v172 offset:32768
    ds_read_b64_tr_b16 v[206:207], v172 offset:34816
    ds_read_b64_tr_b16 a[24:25], v170 offset:32768
    ds_read_b64_tr_b16 a[26:27], v170 offset:34816
    ds_read_b64_tr_b16 a[104:105], v170 offset:32928
    ds_read_b64_tr_b16 a[106:107], v170 offset:34976
    ds_read_b64_tr_b16 a[184:185], v170 offset:33088
    ds_read_b64_tr_b16 a[186:187], v170 offset:35136
    s_waitcnt lgkmcnt(7)
    ds_bpermute_b32 v28, v173, v204
    ds_bpermute_b32 v29, v173, v205
    s_waitcnt lgkmcnt(8)
    ds_bpermute_b32 v30, v173, v206
    ds_bpermute_b32 v31, v173, v207
    s_waitcnt vmcnt(24)
    s_waitcnt lgkmcnt(0)
    s_barrier
    s_mov_b32 s64, 1720320
    s_add_u32 m0, s70, 98304
    s_nop 0
    buffer_load_dwordx4 v168, s[20:23], s64 offen nt lds
    s_mov_b32 s64, 1751040
    s_add_u32 m0, s70, 102400
    s_nop 0
    buffer_load_dwordx4 v168, s[20:23], s64 offen nt lds
    s_mov_b32 s64, 1781760
    s_add_u32 m0, s70, 106496
    s_nop 0
    buffer_load_dwordx4 v168, s[20:23], s64 offen nt lds
    s_mov_b32 s64, 1812480
    s_add_u32 m0, s70, 110592
    s_nop 0
    buffer_load_dwordx4 v168, s[20:23], s64 offen nt lds
    ds_read_b64_tr_b16 v[204:205], v172 offset:49152
    ds_read_b64_tr_b16 v[206:207], v172 offset:51200
    ds_read_b64_tr_b16 a[28:29], v170 offset:49152
    ds_read_b64_tr_b16 a[30:31], v170 offset:51200
    ds_read_b64_tr_b16 a[108:109], v170 offset:49312
    ds_read_b64_tr_b16 a[110:111], v170 offset:51360
    ds_read_b64_tr_b16 a[188:189], v170 offset:49472
    ds_read_b64_tr_b16 a[190:191], v170 offset:51520
    s_waitcnt lgkmcnt(7)
    ds_bpermute_b32 v32, v173, v204
    ds_bpermute_b32 v33, v173, v205
    s_waitcnt lgkmcnt(8)
    ds_bpermute_b32 v34, v173, v206
    ds_bpermute_b32 v35, v173, v207
    s_waitcnt vmcnt(24)
    s_waitcnt lgkmcnt(0)
    s_barrier
    s_mov_b32 s64, 1843200
    s_add_u32 m0, s70, 114688
    s_nop 0
    buffer_load_dwordx4 v168, s[20:23], s64 offen nt lds
    s_mov_b32 s64, 1873920
    s_add_u32 m0, s70, 118784
    s_nop 0
    buffer_load_dwordx4 v168, s[20:23], s64 offen nt lds
    s_mov_b32 s64, 1904640
    s_add_u32 m0, s70, 122880
    s_nop 0
    buffer_load_dwordx4 v168, s[20:23], s64 offen nt lds
    s_mov_b32 s64, 1935360
    s_add_u32 m0, s70, 126976
    s_nop 0
    buffer_load_dwordx4 v168, s[20:23], s64 offen nt lds
    ds_read_b64_tr_b16 v[204:205], v171 offset:0
    ds_read_b64_tr_b16 v[206:207], v171 offset:2048
    ds_read_b64_tr_b16 a[32:33], v169 offset:0
    ds_read_b64_tr_b16 a[34:35], v169 offset:2048
    ds_read_b64_tr_b16 a[112:113], v169 offset:160
    ds_read_b64_tr_b16 a[114:115], v169 offset:2208
    ds_read_b64_tr_b16 a[192:193], v169 offset:320
    ds_read_b64_tr_b16 a[194:195], v169 offset:2368
    s_waitcnt lgkmcnt(7)
    ds_bpermute_b32 v36, v173, v204
    ds_bpermute_b32 v37, v173, v205
    s_waitcnt lgkmcnt(8)
    ds_bpermute_b32 v38, v173, v206
    ds_bpermute_b32 v39, v173, v207
    s_waitcnt vmcnt(24)
    s_waitcnt lgkmcnt(0)
    s_barrier
    s_mov_b32 s64, 1966080
    s_add_u32 m0, s70, 0
    s_nop 0
    buffer_load_dwordx4 v168, s[20:23], s64 offen nt lds
    s_mov_b32 s64, 1996800
    s_add_u32 m0, s70, 4096
    s_nop 0
    buffer_load_dwordx4 v168, s[20:23], s64 offen nt lds
    s_mov_b32 s64, 2027520
    s_add_u32 m0, s70, 8192
    s_nop 0
    buffer_load_dwordx4 v168, s[20:23], s64 offen nt lds
    s_mov_b32 s64, 2058240
    s_add_u32 m0, s70, 12288
    s_nop 0
    buffer_load_dwordx4 v168, s[20:23], s64 offen nt lds
    ds_read_b64_tr_b16 v[204:205], v171 offset:16384
    ds_read_b64_tr_b16 v[206:207], v171 offset:18432
    ds_read_b64_tr_b16 a[36:37], v169 offset:16384
    ds_read_b64_tr_b16 a[38:39], v169 offset:18432
    ds_read_b64_tr_b16 a[116:117], v169 offset:16544
    ds_read_b64_tr_b16 a[118:119], v169 offset:18592
    ds_read_b64_tr_b16 a[196:197], v169 offset:16704
    ds_read_b64_tr_b16 a[198:199], v169 offset:18752
    s_waitcnt lgkmcnt(7)
    ds_bpermute_b32 v40, v173, v204
    ds_bpermute_b32 v41, v173, v205
    s_waitcnt lgkmcnt(8)
    ds_bpermute_b32 v42, v173, v206
    ds_bpermute_b32 v43, v173, v207
    s_waitcnt vmcnt(24)
    s_waitcnt lgkmcnt(0)
    s_barrier
    s_mov_b32 s64, 2088960
    s_add_u32 m0, s70, 16384
    s_nop 0
    buffer_load_dwordx4 v168, s[20:23], s64 offen nt lds
    s_mov_b32 s64, 2119680
    s_add_u32 m0, s70, 20480
    s_nop 0
    buffer_load_dwordx4 v168, s[20:23], s64 offen nt lds
    s_mov_b32 s64, 2150400
    s_add_u32 m0, s70, 24576
    s_nop 0
    buffer_load_dwordx4 v168, s[20:23], s64 offen nt lds
    s_mov_b32 s64, 2181120
    s_add_u32 m0, s70, 28672
    s_nop 0
    buffer_load_dwordx4 v168, s[20:23], s64 offen nt lds
    ds_read_b64_tr_b16 v[204:205], v171 offset:32768
    ds_read_b64_tr_b16 v[206:207], v171 offset:34816
    ds_read_b64_tr_b16 a[40:41], v169 offset:32768
    ds_read_b64_tr_b16 a[42:43], v169 offset:34816
    ds_read_b64_tr_b16 a[120:121], v169 offset:32928
    ds_read_b64_tr_b16 a[122:123], v169 offset:34976
    ds_read_b64_tr_b16 a[200:201], v169 offset:33088
    ds_read_b64_tr_b16 a[202:203], v169 offset:35136
    s_waitcnt lgkmcnt(7)
    ds_bpermute_b32 v44, v173, v204
    ds_bpermute_b32 v45, v173, v205
    s_waitcnt lgkmcnt(8)
    ds_bpermute_b32 v46, v173, v206
    ds_bpermute_b32 v47, v173, v207
    s_waitcnt vmcnt(24)
    s_waitcnt lgkmcnt(0)
    s_barrier
    s_mov_b32 s64, 2211840
    s_add_u32 m0, s70, 32768
    s_nop 0
    buffer_load_dwordx4 v168, s[20:23], s64 offen nt lds
    s_mov_b32 s64, 2242560
    s_add_u32 m0, s70, 36864
    s_nop 0
    buffer_load_dwordx4 v168, s[20:23], s64 offen nt lds
    s_mov_b32 s64, 2273280
    s_add_u32 m0, s70, 40960
    s_nop 0
    buffer_load_dwordx4 v168, s[20:23], s64 offen nt lds
    s_mov_b32 s64, 2304000
    s_add_u32 m0, s70, 45056
    s_nop 0
    buffer_load_dwordx4 v168, s[20:23], s64 offen nt lds
    ds_read_b64_tr_b16 v[204:205], v171 offset:49152
    ds_read_b64_tr_b16 v[206:207], v171 offset:51200
    ds_read_b64_tr_b16 a[44:45], v169 offset:49152
    ds_read_b64_tr_b16 a[46:47], v169 offset:51200
    ds_read_b64_tr_b16 a[124:125], v169 offset:49312
    ds_read_b64_tr_b16 a[126:127], v169 offset:51360
    ds_read_b64_tr_b16 a[204:205], v169 offset:49472
    ds_read_b64_tr_b16 a[206:207], v169 offset:51520
    s_waitcnt lgkmcnt(7)
    ds_bpermute_b32 v48, v173, v204
    ds_bpermute_b32 v49, v173, v205
    s_waitcnt lgkmcnt(8)
    ds_bpermute_b32 v50, v173, v206
    ds_bpermute_b32 v51, v173, v207
    s_waitcnt vmcnt(24)
    s_waitcnt lgkmcnt(0)
    s_barrier
    s_mov_b32 s64, 2334720
    s_add_u32 m0, s70, 49152
    s_nop 0
    buffer_load_dwordx4 v168, s[20:23], s64 offen nt lds
    s_mov_b32 s64, 2365440
    s_add_u32 m0, s70, 53248
    s_nop 0
    buffer_load_dwordx4 v168, s[20:23], s64 offen nt lds
    s_mov_b32 s64, 2396160
    s_add_u32 m0, s70, 57344
    s_nop 0
    buffer_load_dwordx4 v168, s[20:23], s64 offen nt lds
    s_mov_b32 s64, 2426880
    s_add_u32 m0, s70, 61440
    s_nop 0
    buffer_load_dwordx4 v168, s[20:23], s64 offen nt lds
    ds_read_b64_tr_b16 v[204:205], v172 offset:0
    ds_read_b64_tr_b16 v[206:207], v172 offset:2048
    ds_read_b64_tr_b16 a[48:49], v170 offset:0
    ds_read_b64_tr_b16 a[50:51], v170 offset:2048
    ds_read_b64_tr_b16 a[128:129], v170 offset:160
    ds_read_b64_tr_b16 a[130:131], v170 offset:2208
    ds_read_b64_tr_b16 a[208:209], v170 offset:320
    ds_read_b64_tr_b16 a[210:211], v170 offset:2368
    s_waitcnt lgkmcnt(7)
    ds_bpermute_b32 v52, v173, v204
    ds_bpermute_b32 v53, v173, v205
    s_waitcnt lgkmcnt(8)
    ds_bpermute_b32 v54, v173, v206
    ds_bpermute_b32 v55, v173, v207
    s_waitcnt vmcnt(24)
    s_waitcnt lgkmcnt(0)
    s_barrier
    ds_read_b64_tr_b16 v[204:205], v172 offset:16384
    ds_read_b64_tr_b16 v[206:207], v172 offset:18432
    ds_read_b64_tr_b16 a[52:53], v170 offset:16384
    ds_read_b64_tr_b16 a[54:55], v170 offset:18432
    ds_read_b64_tr_b16 a[132:133], v170 offset:16544
    ds_read_b64_tr_b16 a[134:135], v170 offset:18592
    ds_read_b64_tr_b16 a[212:213], v170 offset:16704
    ds_read_b64_tr_b16 a[214:215], v170 offset:18752
    s_waitcnt lgkmcnt(7)
    ds_bpermute_b32 v56, v173, v204
    ds_bpermute_b32 v57, v173, v205
    s_waitcnt lgkmcnt(8)
    ds_bpermute_b32 v58, v173, v206
    ds_bpermute_b32 v59, v173, v207
    s_waitcnt vmcnt(20)
    s_waitcnt lgkmcnt(0)
    s_barrier
    ds_read_b64_tr_b16 v[204:205], v172 offset:32768
    ds_read_b64_tr_b16 v[206:207], v172 offset:34816
    ds_read_b64_tr_b16 a[56:57], v170 offset:32768
    ds_read_b64_tr_b16 a[58:59], v170 offset:34816
    ds_read_b64_tr_b16 a[136:137], v170 offset:32928
    ds_read_b64_tr_b16 a[138:139], v170 offset:34976
    ds_read_b64_tr_b16 a[216:217], v170 offset:33088
    ds_read_b64_tr_b16 a[218:219], v170 offset:35136
    s_waitcnt lgkmcnt(7)
    ds_bpermute_b32 v60, v173, v204
    ds_bpermute_b32 v61, v173, v205
    s_waitcnt lgkmcnt(8)
    ds_bpermute_b32 v62, v173, v206
    ds_bpermute_b32 v63, v173, v207
    s_waitcnt vmcnt(16)
    s_waitcnt lgkmcnt(0)
    s_barrier
    ds_read_b64_tr_b16 v[204:205], v172 offset:49152
    ds_read_b64_tr_b16 v[206:207], v172 offset:51200
    ds_read_b64_tr_b16 a[60:61], v170 offset:49152
    ds_read_b64_tr_b16 a[62:63], v170 offset:51200
    ds_read_b64_tr_b16 a[140:141], v170 offset:49312
    ds_read_b64_tr_b16 a[142:143], v170 offset:51360
    ds_read_b64_tr_b16 a[220:221], v170 offset:49472
    ds_read_b64_tr_b16 a[222:223], v170 offset:51520
    s_waitcnt lgkmcnt(7)
    ds_bpermute_b32 v64, v173, v204
    ds_bpermute_b32 v65, v173, v205
    s_waitcnt lgkmcnt(8)
    ds_bpermute_b32 v66, v173, v206
    ds_bpermute_b32 v67, v173, v207
    s_waitcnt vmcnt(12)
    s_waitcnt lgkmcnt(0)
    s_barrier
    ds_read_b64_tr_b16 v[204:205], v171 offset:0
    ds_read_b64_tr_b16 v[206:207], v171 offset:2048
    ds_read_b64_tr_b16 a[64:65], v169 offset:0
    ds_read_b64_tr_b16 a[66:67], v169 offset:2048
    ds_read_b64_tr_b16 a[144:145], v169 offset:160
    ds_read_b64_tr_b16 a[146:147], v169 offset:2208
    ds_read_b64_tr_b16 a[224:225], v169 offset:320
    ds_read_b64_tr_b16 a[226:227], v169 offset:2368
    s_waitcnt lgkmcnt(7)
    ds_bpermute_b32 v68, v173, v204
    ds_bpermute_b32 v69, v173, v205
    s_waitcnt lgkmcnt(8)
    ds_bpermute_b32 v70, v173, v206
    ds_bpermute_b32 v71, v173, v207
    s_waitcnt vmcnt(8)
    s_waitcnt lgkmcnt(0)
    s_barrier
    ds_read_b64_tr_b16 v[204:205], v171 offset:16384
    ds_read_b64_tr_b16 v[206:207], v171 offset:18432
    ds_read_b64_tr_b16 a[68:69], v169 offset:16384
    ds_read_b64_tr_b16 a[70:71], v169 offset:18432
    ds_read_b64_tr_b16 a[148:149], v169 offset:16544
    ds_read_b64_tr_b16 a[150:151], v169 offset:18592
    ds_read_b64_tr_b16 a[228:229], v169 offset:16704
    ds_read_b64_tr_b16 a[230:231], v169 offset:18752
    s_waitcnt lgkmcnt(7)
    ds_bpermute_b32 v72, v173, v204
    ds_bpermute_b32 v73, v173, v205
    s_waitcnt lgkmcnt(8)
    ds_bpermute_b32 v74, v173, v206
    ds_bpermute_b32 v75, v173, v207
    s_waitcnt vmcnt(4)
    s_waitcnt lgkmcnt(0)
    s_barrier
    ds_read_b64_tr_b16 v[204:205], v171 offset:32768
    ds_read_b64_tr_b16 v[206:207], v171 offset:34816
    ds_read_b64_tr_b16 a[72:73], v169 offset:32768
    ds_read_b64_tr_b16 a[74:75], v169 offset:34816
    ds_read_b64_tr_b16 a[152:153], v169 offset:32928
    ds_read_b64_tr_b16 a[154:155], v169 offset:34976
    ds_read_b64_tr_b16 a[232:233], v169 offset:33088
    ds_read_b64_tr_b16 a[234:235], v169 offset:35136
    s_waitcnt lgkmcnt(7)
    ds_bpermute_b32 v76, v173, v204
    ds_bpermute_b32 v77, v173, v205
    s_waitcnt lgkmcnt(8)
    ds_bpermute_b32 v78, v173, v206
    ds_bpermute_b32 v79, v173, v207
    s_waitcnt vmcnt(0)
    s_waitcnt lgkmcnt(0)
    s_barrier
    ds_read_b64_tr_b16 v[204:205], v171 offset:49152
    ds_read_b64_tr_b16 v[206:207], v171 offset:51200
    ds_read_b64_tr_b16 a[76:77], v169 offset:49152
    ds_read_b64_tr_b16 a[78:79], v169 offset:51200
    ds_read_b64_tr_b16 a[156:157], v169 offset:49312
    ds_read_b64_tr_b16 a[158:159], v169 offset:51360
    ds_read_b64_tr_b16 a[236:237], v169 offset:49472
    ds_read_b64_tr_b16 a[238:239], v169 offset:51520
    s_waitcnt lgkmcnt(7)
    ds_bpermute_b32 v80, v173, v204
    ds_bpermute_b32 v81, v173, v205
    s_waitcnt lgkmcnt(8)
    ds_bpermute_b32 v82, v173, v206
    ds_bpermute_b32 v83, v173, v207
    s_waitcnt lgkmcnt(0)
    s_barrier
    v_lshlrev_b32 v168, 4, v0
    s_mul_i32 s64, s76, 102400
    s_add_u32 s65, s64, 102400
    s_mov_b32 m0, s70
Lstgb_67:
    s_nop 0
    buffer_load_dwordx4 v168, s[24:27], s64 offen nt lds
    s_add_u32 m0, m0, 4096
    s_add_u32 s64, s64, 4096
    s_cmp_lt_u32 s64, s65
    s_cbranch_scc1 Lstgb_67
    v_lshl_add_u32 v169, v176, 2, v177
    v_mul_u32_u24 v169, 1280, v169
    v_mul_u32_u24 v171, 20, v177
    v_add3_u32 v171, v171, v176, 16
    v_mul_u32_u24 v171, 1280, v171
    s_lshl_b32 s64, s60, 6
    v_lshl_add_u32 v173, v178, 3, s64
    v_add_u32 v170, v169, v173
    v_add_u32 v172, v171, v173
    v_lshl_add_u32 v169, v173, 1, v169
    v_lshl_add_u32 v171, v173, 1, v171
    v_add_u32 v174, 51200, v169
    v_add_u32 v175, 51200, v170
    s_waitcnt vmcnt(0)
    s_barrier
    ds_read_b64_tr_b16 v[84:85], v169 offset:0
    ds_read_b64_tr_b16 v[86:87], v169 offset:25600
    ds_read_b64_tr_b16 v[88:89], v174 offset:0
    ds_read_b64_tr_b16 v[90:91], v174 offset:25600
    ds_read_b64_tr_b16 a[240:241], v171 offset:0
    ds_read_b64_tr_b16 v[92:93], v169 offset:8
    ds_read_b64_tr_b16 v[94:95], v169 offset:25608
    ds_read_b64_tr_b16 v[96:97], v174 offset:8
    ds_read_b64_tr_b16 v[98:99], v174 offset:25608
    ds_read_b64_tr_b16 a[242:243], v171 offset:8
    ds_read_b64_tr_b16 v[100:101], v169 offset:512
    ds_read_b64_tr_b16 v[102:103], v169 offset:26112
    ds_read_b64_tr_b16 v[104:105], v174 offset:512
    ds_read_b64_tr_b16 v[106:107], v174 offset:26112
    ds_read_b64_tr_b16 a[244:245], v171 offset:512
    ds_read_b64_tr_b16 v[108:109], v169 offset:520
    ds_read_b64_tr_b16 v[110:111], v169 offset:26120
    ds_read_b64_tr_b16 v[112:113], v174 offset:520
    ds_read_b64_tr_b16 v[114:115], v174 offset:26120
    ds_read_b64_tr_b16 a[246:247], v171 offset:520
    ds_read_b64_tr_b16 v[116:117], v170 offset:1024
    ds_read_b64_tr_b16 v[118:119], v170 offset:26624
    ds_read_b64_tr_b16 v[120:121], v175 offset:1024
    ds_read_b64_tr_b16 v[122:123], v175 offset:26624
    ds_read_b64_tr_b16 a[248:249], v172 offset:1024
    ds_read_b64_tr_b16 v[124:125], v169 offset:64
    ds_read_b64_tr_b16 v[126:127], v169 offset:25664
    ds_read_b64_tr_b16 v[128:129], v174 offset:64
    ds_read_b64_tr_b16 v[130:131], v174 offset:25664
    ds_read_b64_tr_b16 a[250:251], v171 offset:64
    ds_read_b64_tr_b16 v[132:133], v169 offset:72
    ds_read_b64_tr_b16 v[134:135], v169 offset:25672
    ds_read_b64_tr_b16 v[136:137], v174 offset:72
    ds_read_b64_tr_b16 v[138:139], v174 offset:25672
    ds_read_b64_tr_b16 a[252:253], v171 offset:72
    ds_read_b64_tr_b16 v[140:141], v169 offset:576
    ds_read_b64_tr_b16 v[142:143], v169 offset:26176
    ds_read_b64_tr_b16 v[144:145], v174 offset:576
    ds_read_b64_tr_b16 v[146:147], v174 offset:26176
    ds_read_b64_tr_b16 a[254:255], v171 offset:576
    ds_read_b64_tr_b16 v[148:149], v169 offset:584
    ds_read_b64_tr_b16 v[150:151], v169 offset:26184
    ds_read_b64_tr_b16 v[152:153], v174 offset:584
    ds_read_b64_tr_b16 v[154:155], v174 offset:26184
    ds_read_b64_tr_b16 v[164:165], v171 offset:584
    ds_read_b64_tr_b16 v[156:157], v170 offset:1056
    ds_read_b64_tr_b16 v[158:159], v170 offset:26656
    ds_read_b64_tr_b16 v[160:161], v175 offset:1056
    ds_read_b64_tr_b16 v[162:163], v175 offset:26656
    ds_read_b64_tr_b16 v[166:167], v172 offset:1056
    s_waitcnt lgkmcnt(0)
    s_barrier
    v_and_b32 v179, 7, v1
    v_bfe_u32 v180, v1, 3, 1
    v_lshlrev_b32 v244, 4, v0
    v_lshlrev_b32 v255, 3, v1
    v_mul_u32_u24 v245, 10240, v180
    v_lshl_add_u32 v245, v179, 7, v245
    v_xor_b32 v181, v176, v179
    v_lshl_add_u32 v245, v181, 4, v245
    v_xor_b32 v246, 64, v245
    v_and_b32 v168, 15, v1
    v_lshlrev_b32 v181, 2, v176
    v_cmp_eq_u32 vcc, v168, v181
    s_nop 1
    v_cndmask_b32 v242, 0, 1.0, vcc
    v_mov_b32 v182, 0x3f803f80
    v_cmp_eq_u32 vcc, 1, v178
    s_nop 1
    v_cndmask_b32 v243, 0, v182, vcc
    v_sub_u32 v181, v168, v181
    v_mov_b32 v182, 0xff800000
    v_add_u32 v169, 16, v181
    v_and_b32 v169, 0xfffffff1, v169
    v_cmp_eq_u32 vcc, 0, v169
    s_nop 1
    v_cndmask_b32 v204, v182, 0, vcc
    v_add_u32 v169, 15, v181
    v_and_b32 v169, 0xfffffff1, v169
    v_cmp_eq_u32 vcc, 0, v169
    s_nop 1
    v_cndmask_b32 v205, v182, 0, vcc
    v_add_u32 v169, 14, v181
    v_and_b32 v169, 0xfffffff1, v169
    v_cmp_eq_u32 vcc, 0, v169
    s_nop 1
    v_cndmask_b32 v206, v182, 0, vcc
    v_add_u32 v169, 13, v181
    v_and_b32 v169, 0xfffffff1, v169
    v_cmp_eq_u32 vcc, 0, v169
    s_nop 1
    v_cndmask_b32 v207, v182, 0, vcc
    v_add_u32 v169, 0, v181
    v_and_b32 v169, 0xfffffff1, v169
    v_cmp_eq_u32 vcc, 0, v169
    s_nop 1
    v_cndmask_b32 v208, v182, 0, vcc
    v_add_u32 v169, -1, v181
    v_and_b32 v169, 0xfffffff1, v169
    v_cmp_eq_u32 vcc, 0, v169
    s_nop 1
    v_cndmask_b32 v209, v182, 0, vcc
    v_add_u32 v169, -2, v181
    v_and_b32 v169, 0xfffffff1, v169
    v_cmp_eq_u32 vcc, 0, v169
    s_nop 1
    v_cndmask_b32 v210, v182, 0, vcc
    v_add_u32 v169, -3, v181
    v_and_b32 v169, 0xfffffff1, v169
    v_cmp_eq_u32 vcc, 0, v169
    s_nop 1
    v_cndmask_b32 v211, v182, 0, vcc
    v_mov_b32 v212, v182
    v_mov_b32 v213, v182
    v_mov_b32 v214, v182
    v_mov_b32 v215, v182
    v_mov_b32 v220, 0
    v_mov_b32 v221, 0
    v_mov_b32 v222, 0
    v_mov_b32 v223, 0
    v_mov_b32 v224, 0
    v_mov_b32 v225, 0
    v_mov_b32 v226, 0
    v_mov_b32 v227, 0
    v_mov_b32 v228, 0
    v_mov_b32 v229, 0
    v_mov_b32 v230, 0
    v_mov_b32 v231, 0
    v_mov_b32 v232, 0
    v_mov_b32 v233, 0
    v_mov_b32 v234, 0
    v_mov_b32 v235, 0
    v_mov_b32 v236, 0
    v_mov_b32 v237, 0
    v_mov_b32 v238, 0
    v_mov_b32 v239, 0
    ds_write_b128 v247, v[204:207] offset:5120
    ds_write_b128 v247, v[208:211] offset:6144
    ds_write_b128 v247, v[212:215] offset:7168
    v_add_u32 v248, 2048, v247
    s_lshr_b32 s64, s60, 1
    s_lshl_b32 s64, s64, 10
    s_and_b32 s65, s60, 1
    s_lshl_b32 s65, s65, 3
    s_add_u32 s64, s64, s65
    v_add_u32 v249, s64, v247
    s_lshl_b32 s64, s60, 1
    v_lshl_add_u32 v250, v1, 3, s64
    v_lshlrev_b32 v252, 5, v168
    v_lshl_add_u32 v252, v176, 3, v252
    v_lshlrev_b32 v251, 1, v252
    s_lshl_b32 s64, s60, 11
    v_add_u32 v251, s64, v251
    s_add_u32 s64, s64, 65536
    v_add_u32 v252, s64, v252
    s_lshl_b32 s71, s68, 23
    s_add_u32 s71, s71, 33554432
    s_mul_i32 s72, s76, 81920
    s_add_u32 s72, s72, 142606336
    s_lshl_b32 s74, s60, 10
    s_mov_b32 s77, 0x3ea52b5c
    s_mov_b32 s75, 0
    s_cmp_lg_u32 s60, 0
    s_cbranch_scc1 Lgskip_70
    buffer_load_dword v2, off, s[8:11], 0 offset:132 sc1
Lgchk_68:
    s_waitcnt vmcnt(0)
    v_cmp_eq_u32 vcc, 0, v2
    s_cbranch_vccnz Lgrty_69
Lgskip_70:
    s_waitcnt lgkmcnt(0)
    s_barrier
    buffer_load_dword v2, off, s[8:11], 0 offset:140 sc1
Lpchk_71:
    s_waitcnt vmcnt(0)
    v_cmp_eq_u32 vcc, 0, v2
    s_cbranch_vccnz Lprty_72
    v_readfirstlane_b32 s1, v2
    s_cmp_gt_u32 s1, 17
    s_cselect_b32 s1, 1, 0
    s_xor_b32 s1, s1, s68
    s_lshl_b32 s1, s1, 13
    s_lshl_b32 s63, s58, 18
    s_and_b32 s64, s3, 0xfff
    s_add_u32 s63, s63, s64
    s_add_u32 s63, s63, 14819328
    s_xor_b32 s63, s63, s1
    v_and_b32 v253, 3, v0
    v_mov_b32 v181, 30
    v_lshl_add_u32 v253, v181, 2, v253
    v_lshlrev_b32 v253, 7, v253
    v_bfe_u32 v181, v0, 4, 2
    v_cmp_eq_u32 vcc, s69, v181
    s_xor_b32 s64, s1, 0x2000
    s_add_u32 s64, s64, 14798848
    v_lshl_add_u32 v181, v181, 18, s64
    s_lshl_b32 s64, s68, 20
    v_add_u32 v181, s64, v181
    s_lshl_b32 s64, s58, 14
    s_add_u32 s64, s64, 8388608
    v_mov_b32 v2, s64
    v_cndmask_b32 v181, v181, v2, vcc
    v_add_u32 v253, v253, v181
    s_lshr_b32 s70, s71, 8
    s_xor_b32 s70, s70, s1
    s_and_b32 s70, s70, 0x2000
    s_or_b32 s70, s70, s71
    s_mov_b32 s80, 0
    s_lshl_b32 s64, s60, 2
    v_mov_b32 v3, s64
    v_and_b32 v1, 12, v1
L_Bh0:
    s_cmp_lg_u32 s75, 0
    s_cbranch_scc1 L_Bhave0
    buffer_load_dword v254, v253, s[4:7], 0 offen sc1
    s_waitcnt vmcnt(0)
    s_cmp_eq_u32 s80, 0
    s_cbranch_scc1 Lowed_73
    s_waitcnt vmcnt(0)
    v_mov_b32 v2, s62
    s_mov_b64 exec, 1
    buffer_store_dword v2, off, s[4:7], s63 sc1
    buffer_store_dword v2, off, s[4:7], s3
    s_mov_b64 exec, -1
    s_mov_b32 s80, 0
Lowed_73:
    s_add_u32 s65, s62, 1
Lfchk_74:
    v_cmp_gt_u32 vcc, s65, v254
    s_cbranch_vccnz Lfrty_75
    s_add_u32 m0, s74, 8192
    s_add_u32 s64, s70, 0
    buffer_load_dwordx4 v244, s[4:7], s64 offen sc1 lds
    s_add_u32 m0, s74, 12288
    s_add_u32 s64, s70, 4096
    buffer_load_dwordx4 v244, s[4:7], s64 offen sc1 lds
    s_add_u32 m0, s74, 16384
    s_add_u32 s64, s70, 16384
    buffer_load_dwordx4 v244, s[4:7], s64 offen sc1 lds
    s_add_u32 m0, s74, 20480
    s_add_u32 s64, s70, 20480
    buffer_load_dwordx4 v244, s[4:7], s64 offen sc1 lds
    s_add_u32 m0, s74, 24576
    s_add_u32 s64, s70, 32768
    buffer_load_dwordx4 v244, s[4:7], s64 offen sc1 lds
    s_waitcnt vmcnt(0)
L_Bhave0:
    s_waitcnt vmcnt(6) lgkmcnt(0)
    s_barrier
    s_mov_b32 s75, 0
    ds_read_b128 v[204:207], v245 offset:8192
    ds_read_b128 v[208:211], v246 offset:8192
    s_waitcnt lgkmcnt(1)
    v_mfma_f32_16x16x32_bf16 v[180:183], v[4:7], v[204:207], 0
    ds_read_b128 v[212:215], v245 offset:9216
    v_mfma_f32_16x16x32_bf16 v[168:171], a[0:3], v[204:207], 0
    v_mfma_f32_16x16x32_bf16 v[172:175], a[80:83], v[204:207], 0
    v_mfma_f32_16x16x32_bf16 v[176:179], v[204:207], a[160:163], 0
    s_waitcnt lgkmcnt(1)
    v_mfma_f32_16x16x32_bf16 v[180:183], v[8:11], v[208:211], v[180:183]
    ds_read_b128 v[204:207], v246 offset:9216
    v_mfma_f32_16x16x32_bf16 v[168:171], a[4:7], v[208:211], v[168:171]
    v_mfma_f32_16x16x32_bf16 v[172:175], a[84:87], v[208:211], v[172:175]
    v_mfma_f32_16x16x32_bf16 v[176:179], v[208:211], a[164:167], v[176:179]
    s_waitcnt lgkmcnt(1)
    v_mfma_f32_16x16x32_bf16 v[180:183], v[12:15], v[212:215], v[180:183]
    ds_read_b128 v[208:211], v245 offset:10240
    buffer_load_dword v254, v253, s[4:7], 0 offen sc1
    v_mfma_f32_16x16x32_bf16 v[168:171], a[8:11], v[212:215], v[168:171]
    v_mfma_f32_16x16x32_bf16 v[172:175], a[88:91], v[212:215], v[172:175]
    v_mfma_f32_16x16x32_bf16 v[176:179], v[212:215], a[168:171], v[176:179]
    s_waitcnt lgkmcnt(1)
    v_mfma_f32_16x16x32_bf16 v[180:183], v[16:19], v[204:207], v[180:183]
    ds_read_b128 v[212:215], v246 offset:10240
    v_mfma_f32_16x16x32_bf16 v[168:171], a[12:15], v[204:207], v[168:171]
    v_mfma_f32_16x16x32_bf16 v[172:175], a[92:95], v[204:207], v[172:175]
    v_mfma_f32_16x16x32_bf16 v[176:179], v[204:207], a[172:175], v[176:179]
    s_waitcnt lgkmcnt(1)
    v_mfma_f32_16x16x32_bf16 v[180:183], v[20:23], v[208:211], v[180:183]
    ds_read_b128 v[204:207], v245 offset:11264
    v_mfma_f32_16x16x32_bf16 v[168:171], a[16:19], v[208:211], v[168:171]
    v_mfma_f32_16x16x32_bf16 v[172:175], a[96:99], v[208:211], v[172:175]
    v_mfma_f32_16x16x32_bf16 v[176:179], v[208:211], a[176:179], v[176:179]
    s_waitcnt lgkmcnt(1)
    v_mfma_f32_16x16x32_bf16 v[180:183], v[24:27], v[212:215], v[180:183]
    ds_read_b128 v[208:211], v246 offset:11264
    v_mfma_f32_16x16x32_bf16 v[168:171], a[20:23], v[212:215], v[168:171]
    v_mfma_f32_16x16x32_bf16 v[172:175], a[100:103], v[212:215], v[172:175]
    v_mfma_f32_16x16x32_bf16 v[176:179], v[212:215], a[180:183], v[176:179]
    s_waitcnt lgkmcnt(1)
    v_mfma_f32_16x16x32_bf16 v[180:183], v[28:31], v[204:207], v[180:183]
    ds_read_b128 v[212:215], v245 offset:12288
    v_mfma_f32_16x16x32_bf16 v[168:171], a[24:27], v[204:207], v[168:171]
    v_mfma_f32_16x16x32_bf16 v[172:175], a[104:107], v[204:207], v[172:175]
    v_mfma_f32_16x16x32_bf16 v[176:179], v[204:207], a[184:187], v[176:179]
    s_waitcnt lgkmcnt(1)
    v_mfma_f32_16x16x32_bf16 v[180:183], v[32:35], v[208:211], v[180:183]
    ds_read_b128 v[204:207], v246 offset:12288
    v_mfma_f32_16x16x32_bf16 v[168:171], a[28:31], v[208:211], v[168:171]
    v_mfma_f32_16x16x32_bf16 v[172:175], a[108:111], v[208:211], v[172:175]
    v_mfma_f32_16x16x32_bf16 v[176:179], v[208:211], a[188:191], v[176:179]
    s_waitcnt lgkmcnt(1)
    v_mfma_f32_16x16x32_bf16 v[180:183], v[36:39], v[212:215], v[180:183]
    ds_read_b128 v[208:211], v245 offset:13312
    v_mfma_f32_16x16x32_bf16 v[168:171], a[32:35], v[212:215], v[168:171]
    v_mfma_f32_16x16x32_bf16 v[172:175], a[112:115], v[212:215], v[172:175]
    v_mfma_f32_16x16x32_bf16 v[176:179], v[212:215], a[192:195], v[176:179]
    s_waitcnt lgkmcnt(1)
    v_mfma_f32_16x16x32_bf16 v[180:183], v[40:43], v[204:207], v[180:183]
    ds_read_b128 v[212:215], v246 offset:13312
    v_mfma_f32_16x16x32_bf16 v[168:171], a[36:39], v[204:207], v[168:171]
    v_mfma_f32_16x16x32_bf16 v[172:175], a[116:119], v[204:207], v[172:175]
    v_mfma_f32_16x16x32_bf16 v[176:179], v[204:207], a[196:199], v[176:179]
    s_waitcnt vmcnt(0)
    s_cmp_eq_u32 s80, 0
    s_cbranch_scc1 Lowed_76
    s_waitcnt vmcnt(0)
    v_mov_b32 v2, s62
    s_mov_b64 exec, 1
    buffer_store_dword v2, off, s[4:7], s63 sc1
    buffer_store_dword v2, off, s[4:7], s3
    s_mov_b64 exec, -1
    s_mov_b32 s80, 0
Lowed_76:
    s_add_u32 s65, s62, s75
    s_add_u32 s65, s65, 2
    v_cmp_gt_u32 vcc, s65, v254
    s_cbranch_vccz Lpre_77
    s_waitcnt lgkmcnt(1)
    v_mfma_f32_16x16x32_bf16 v[180:183], v[44:47], v[208:211], v[180:183]
    ds_read_b128 v[204:207], v245 offset:14336
    ds_read_b128 v[184:187], v248 offset:5120
    v_mfma_f32_16x16x32_bf16 v[168:171], a[40:43], v[208:211], v[168:171]
    ds_read_b128 v[188:191], v247 offset:6144
    v_mfma_f32_16x16x32_bf16 v[172:175], a[120:123], v[208:211], v[172:175]
    v_mfma_f32_16x16x32_bf16 v[176:179], v[208:211], a[200:203], v[176:179]
    s_waitcnt lgkmcnt(3)
    v_mfma_f32_16x16x32_bf16 v[180:183], v[48:51], v[212:215], v[180:183]
    ds_read_b128 v[208:211], v246 offset:14336
    v_mfma_f32_16x16x32_bf16 v[168:171], a[44:47], v[212:215], v[168:171]
    v_mfma_f32_16x16x32_bf16 v[172:175], a[124:127], v[212:215], v[172:175]
    v_mfma_f32_16x16x32_bf16 v[176:179], v[212:215], a[204:207], v[176:179]
    s_waitcnt lgkmcnt(3)
    v_mfma_f32_16x16x32_bf16 v[180:183], v[52:55], v[204:207], v[180:183]
    ds_read_b128 v[212:215], v245 offset:15360
    v_mfma_f32_16x16x32_bf16 v[168:171], a[48:51], v[204:207], v[168:171]
    v_mfma_f32_16x16x32_bf16 v[172:175], a[128:131], v[204:207], v[172:175]
    v_mfma_f32_16x16x32_bf16 v[176:179], v[204:207], a[208:211], v[176:179]
    s_waitcnt lgkmcnt(1)
    v_mfma_f32_16x16x32_bf16 v[180:183], v[56:59], v[208:211], v[180:183]
    ds_read_b128 v[204:207], v246 offset:15360
    v_mfma_f32_16x16x32_bf16 v[168:171], a[52:55], v[208:211], v[168:171]
    v_mfma_f32_16x16x32_bf16 v[172:175], a[132:135], v[208:211], v[172:175]
    v_mfma_f32_16x16x32_bf16 v[176:179], v[208:211], a[212:215], v[176:179]
    s_waitcnt lgkmcnt(1)
    v_mfma_f32_16x16x32_bf16 v[180:183], v[60:63], v[212:215], v[180:183]
    ds_read_b128 v[208:211], v245 offset:16384
    v_mfma_f32_16x16x32_bf16 v[168:171], a[56:59], v[212:215], v[168:171]
    v_mfma_f32_16x16x32_bf16 v[172:175], a[136:139], v[212:215], v[172:175]
    v_mfma_f32_16x16x32_bf16 v[176:179], v[212:215], a[216:219], v[176:179]
    s_waitcnt lgkmcnt(1)
    v_mfma_f32_16x16x32_bf16 v[180:183], v[64:67], v[204:207], v[180:183]
    ds_read_b128 v[212:215], v246 offset:16384
    v_mfma_f32_16x16x32_bf16 v[168:171], a[60:63], v[204:207], v[168:171]
    v_mfma_f32_16x16x32_bf16 v[172:175], a[140:143], v[204:207], v[172:175]
    v_mfma_f32_16x16x32_bf16 v[176:179], v[204:207], a[220:223], v[176:179]
    s_waitcnt lgkmcnt(1)
    v_mfma_f32_16x16x32_bf16 v[180:183], v[68:71], v[208:211], v[180:183]
    ds_read_b128 v[204:207], v245 offset:17408
    v_mfma_f32_16x16x32_bf16 v[168:171], a[64:67], v[208:211], v[168:171]
    v_mfma_f32_16x16x32_bf16 v[172:175], a[144:147], v[208:211], v[172:175]
    v_mfma_f32_16x16x32_bf16 v[176:179], v[208:211], a[224:227], v[176:179]
    s_waitcnt lgkmcnt(1)
    v_mfma_f32_16x16x32_bf16 v[180:183], v[72:75], v[212:215], v[180:183]
    ds_read_b128 v[208:211], v246 offset:17408
    v_mfma_f32_16x16x32_bf16 v[168:171], a[68:71], v[212:215], v[168:171]
    v_mfma_f32_16x16x32_bf16 v[172:175], a[148:151], v[212:215], v[172:175]
    v_mfma_f32_16x16x32_bf16 v[176:179], v[212:215], a[228:231], v[176:179]
    s_waitcnt lgkmcnt(1)
    v_mfma_f32_16x16x32_bf16 v[180:183], v[76:79], v[204:207], v[180:183]
    v_mfma_f32_16x16x32_bf16 v[168:171], a[72:75], v[204:207], v[168:171]
    v_mfma_f32_16x16x32_bf16 v[172:175], a[152:155], v[204:207], v[172:175]
    v_mfma_f32_16x16x32_bf16 v[176:179], v[204:207], a[232:235], v[176:179]
    s_waitcnt lgkmcnt(0)
    v_mfma_f32_16x16x32_bf16 v[180:183], v[80:83], v[208:211], v[180:183]
    s_nop 2
    v_mfma_f32_16x16x32_bf16 v[168:171], a[76:79], v[208:211], v[168:171]
    s_nop 2
    v_mfma_f32_16x16x32_bf16 v[172:175], a[156:159], v[208:211], v[172:175]
    s_nop 2
    v_mfma_f32_16x16x32_bf16 v[176:179], v[208:211], a[236:239], v[176:179]
Lback_78:
    s_waitcnt vmcnt(0)
L_Be0:
    v_mov_b32 v2, s75
    ds_write_b32 v3, v2 offset:2560
    buffer_load_dword v254, v253, s[4:7], 0 offen sc1
    v_mfma_f32_16x16x4_f32 v[192:195], v182, v242, 0
    v_cvt_pk_bf16_f32 v222, v180, 0
    v_cvt_pk_bf16_f32 v226, v181, 0
    v_cvt_pk_bf16_f32 v220, v168, v169
    v_cvt_pk_bf16_f32 v221, v170, v171
    v_mov_b32 v223, 0
    v_cvt_pk_bf16_f32 v224, v172, v173
    v_cvt_pk_bf16_f32 v225, v174, v175
    s_waitcnt lgkmcnt(0)
    s_barrier
    ds_read_b32 v2, v1 offset:2560
    v_mfma_f32_16x16x32_bf16 v[184:187], v[228:231], v[220:223], v[184:187]
    v_cvt_pk_bf16_f32 v234, v176, v177
    v_cvt_pk_bf16_f32 v235, v178, v179
    v_mfma_f32_16x16x32_bf16 v[188:191], v[224:227], v[220:223], v[188:191]
    s_lshr_b32 s73, s72, 8
    s_xor_b32 s73, s73, s1
    s_and_b32 s73, s73, 0x2000
    s_or_b32 s73, s73, s72
    s_add_u32 s72, s72, 1048576
    s_add_u32 s78, s73, 0
    s_add_u32 s79, s73, 32768
    v_mov_b32 v248, v247
    v_cvt_pk_bf16_f32 v238, v192, v193
    v_cvt_pk_bf16_f32 v239, v194, v195
    v_or_b32 v238, v243, v238
    v_or_b32 v239, v243, v239
    s_waitcnt lgkmcnt(0)
    v_cmp_eq_u32 vcc, 0, v2
    s_cbranch_vccz L_Bi0
    v_max3_f32 v192, v184, v185, v186
    v_max3_f32 v193, v188, v189, v190
    v_max3_f32 v192, v192, v187, v191
    v_max_f32 v192, v192, v193
    v_mov_b32 v193, v192
    s_nop 1
    v_permlane16_swap_b32 v192, v193
    v_max_f32 v192, v192, v193
    v_mov_b32 v193, v192
    s_nop 1
    v_permlane32_swap_b32 v192, v193
    v_max_f32 v192, v192, v193
    v_mul_f32 v192, s77, v192
    v_fma_f32 v184, v184, s77, -v192
    v_fma_f32 v185, v185, s77, -v192
    v_fma_f32 v186, v186, s77, -v192
    v_fma_f32 v187, v187, s77, -v192
    v_fma_f32 v188, v188, s77, -v192
    v_fma_f32 v189, v189, s77, -v192
    v_fma_f32 v190, v190, s77, -v192
    v_fma_f32 v191, v191, s77, -v192
    v_exp_f32 v184, v184
    v_exp_f32 v185, v185
    v_exp_f32 v186, v186
    v_exp_f32 v187, v187
    v_exp_f32 v188, v188
    v_exp_f32 v189, v189
    v_exp_f32 v190, v190
    v_exp_f32 v191, v191
    v_cvt_pk_bf16_f32 v184, v184, v185
    v_cvt_pk_bf16_f32 v185, v186, v187
    v_cvt_pk_bf16_f32 v186, v188, v189
    v_cvt_pk_bf16_f32 v187, v190, v191
    s_nop 1
    v_mfma_f32_16x16x32_bf16 v[200:203], v[236:239], v[184:187], 0
    s_nop 2
    v_mfma_f32_16x16x32_bf16 v[196:199], v[232:235], v[184:187], 0
    s_nop 3
    v_rcp_f32 v201, v201
    s_nop 0
    v_mul_f32 v200, v200, v201
    s_nop 0
    v_mul_f32 v196, v196, v201
    v_mul_f32 v197, v197, v201
    v_mul_f32 v198, v198, v201
    v_mul_f32 v199, v199, v201
    v_cvt_pk_bf16_f32 v200, v200, v200
    v_cvt_pk_bf16_f32 v196, v196, v197
    v_cvt_pk_bf16_f32 v197, v198, v199
    ds_write_b16 v250, v200 offset:2048
    ds_write_b64 v249, v[196:197] offset:0
    s_waitcnt lgkmcnt(0)
    s_barrier
    ds_read_b64 v[240:241], v255 offset:2048
    ds_read_b128 v[220:223], v247 offset:0
    ds_read_b128 v[216:219], v247 offset:1024
    s_waitcnt vmcnt(0)
    s_cmp_eq_u32 s80, 0
    s_cbranch_scc1 Lowed_79
    s_waitcnt vmcnt(0)
    v_mov_b32 v2, s62
    s_mov_b64 exec, 1
    buffer_store_dword v2, off, s[4:7], s63 sc1
    buffer_store_dword v2, off, s[4:7], s3
    s_mov_b64 exec, -1
    s_mov_b32 s80, 0
Lowed_79:
    s_add_u32 s65, s62, s75
    s_add_u32 s65, s65, 2
    v_cmp_gt_u32 vcc, s65, v254
    s_cbranch_vccz Lpre_80
    s_waitcnt lgkmcnt(2)
    v_mfma_f32_16x16x16_bf16 v[168:171], a[240:241], v[240:241], 0
    v_mfma_f32_16x16x16_bf16 v[172:175], a[242:243], v[240:241], 0
    v_mfma_f32_16x16x16_bf16 v[176:179], a[244:245], v[240:241], 0
    v_mfma_f32_16x16x16_bf16 v[180:183], a[246:247], v[240:241], 0
    v_mfma_f32_16x16x16_bf16 v[204:207], a[248:249], v[240:241], 0
    v_mfma_f32_16x16x16_bf16 v[184:187], a[250:251], v[240:241], 0
    v_mfma_f32_16x16x16_bf16 v[188:191], a[252:253], v[240:241], 0
    v_mfma_f32_16x16x16_bf16 v[192:195], a[254:255], v[240:241], 0
    v_mfma_f32_16x16x16_bf16 v[196:199], v[164:165], v[240:241], 0
    v_mfma_f32_16x16x16_bf16 v[200:203], v[166:167], v[240:241], 0
Lback_81:
    s_waitcnt lgkmcnt(1)
    v_mfma_f32_16x16x32_bf16 v[168:171], v[84:87], v[220:223], v[168:171]
    v_mfma_f32_16x16x32_bf16 v[172:175], v[92:95], v[220:223], v[172:175]
    s_waitcnt lgkmcnt(0)
    v_mfma_f32_16x16x32_bf16 v[168:171], v[88:91], v[216:219], v[168:171]
    s_nop 2
    v_mfma_f32_16x16x32_bf16 v[172:175], v[96:99], v[216:219], v[172:175]
    s_nop 2
    v_mfma_f32_16x16x32_bf16 v[176:179], v[100:103], v[220:223], v[176:179]
    v_cvt_pk_bf16_f32 v168, v168, v169
    v_cvt_pk_bf16_f32 v169, v170, v171
    v_mfma_f32_16x16x32_bf16 v[180:183], v[108:111], v[220:223], v[180:183]
    s_nop 0
    v_cvt_pk_bf16_f32 v170, v172, v173
    v_cvt_pk_bf16_f32 v171, v174, v175
    v_mfma_f32_16x16x32_bf16 v[176:179], v[104:107], v[216:219], v[176:179]
    buffer_store_dwordx4 v[168:171], v251, s[4:7], s78 offen offset:0 sc1
    s_nop 4
    v_mfma_f32_16x16x32_bf16 v[180:183], v[112:115], v[216:219], v[180:183]
    s_nop 0
    v_cvt_pk_bf16_f32 v176, v176, v177
    v_cvt_pk_bf16_f32 v177, v178, v179
    v_mfma_f32_16x16x32_bf16 v[204:207], v[116:119], v[220:223], v[204:207]
    s_nop 2
    v_mfma_f32_16x16x32_bf16 v[204:207], v[120:123], v[216:219], v[204:207]
    v_cvt_pk_bf16_f32 v178, v180, v181
    v_cvt_pk_bf16_f32 v179, v182, v183
    v_mfma_f32_16x16x32_bf16 v[184:187], v[124:127], v[220:223], v[184:187]
    buffer_store_dwordx4 v[176:179], v251, s[4:7], s79 offen offset:0 sc1
    s_nop 3
    v_cvt_pk_bf16_f32 v204, v204, v205
    v_mfma_f32_16x16x32_bf16 v[188:191], v[132:135], v[220:223], v[188:191]
    v_cvt_pk_bf16_f32 v205, v206, v207
    v_mfma_f32_16x16x32_bf16 v[184:187], v[128:131], v[216:219], v[184:187]
    buffer_store_dwordx2 v[204:205], v252, s[4:7], s73 offen offset:0 sc1
    s_nop 2
    v_mfma_f32_16x16x32_bf16 v[188:191], v[136:139], v[216:219], v[188:191]
    s_nop 2
    v_mfma_f32_16x16x32_bf16 v[192:195], v[140:143], v[220:223], v[192:195]
    v_cvt_pk_bf16_f32 v184, v184, v185
    v_cvt_pk_bf16_f32 v185, v186, v187
    v_mfma_f32_16x16x32_bf16 v[196:199], v[148:151], v[220:223], v[196:199]
    s_nop 0
    v_cvt_pk_bf16_f32 v186, v188, v189
    v_cvt_pk_bf16_f32 v187, v190, v191
    v_mfma_f32_16x16x32_bf16 v[192:195], v[144:147], v[216:219], v[192:195]
    buffer_store_dwordx4 v[184:187], v251, s[4:7], s78 offen offset:1024 sc1
    s_nop 4
    v_mfma_f32_16x16x32_bf16 v[196:199], v[152:155], v[216:219], v[196:199]
    s_nop 0
    v_cvt_pk_bf16_f32 v192, v192, v193
    v_cvt_pk_bf16_f32 v193, v194, v195
    v_mfma_f32_16x16x32_bf16 v[200:203], v[156:159], v[220:223], v[200:203]
    s_nop 2
    v_mfma_f32_16x16x32_bf16 v[200:203], v[160:163], v[216:219], v[200:203]
    v_cvt_pk_bf16_f32 v194, v196, v197
    v_cvt_pk_bf16_f32 v195, v198, v199
    buffer_store_dwordx4 v[192:195], v251, s[4:7], s79 offen offset:1024 sc1
    s_nop 4
    v_cvt_pk_bf16_f32 v200, v200, v201
    v_cvt_pk_bf16_f32 v201, v202, v203
    buffer_store_dwordx2 v[200:201], v252, s[4:7], s73 offen offset:1024 sc1
    s_add_u32 s62, s62, 1
    s_mov_b32 s80, 1
L_Bh1:
    s_cmp_lg_u32 s75, 0
    s_cbranch_scc1 L_Bhave1
    buffer_load_dword v254, v253, s[4:7], 0 offen sc1
    s_waitcnt vmcnt(0)
    s_cmp_eq_u32 s80, 0
    s_cbranch_scc1 Lowed_82
    s_waitcnt vmcnt(0)
    v_mov_b32 v2, s62
    s_mov_b64 exec, 1
    buffer_store_dword v2, off, s[4:7], s63 sc1
    buffer_store_dword v2, off, s[4:7], s3
    s_mov_b64 exec, -1
    s_mov_b32 s80, 0
Lowed_82:
    s_add_u32 s65, s62, 1
Lfchk_83:
    v_cmp_gt_u32 vcc, s65, v254
    s_cbranch_vccnz Lfrty_84
    s_add_u32 m0, s74, 28672
    s_add_u32 s64, s70, 36864
    buffer_load_dwordx4 v244, s[4:7], s64 offen sc1 lds
    s_add_u32 m0, s74, 32768
    s_add_u32 s64, s70, 49152
    buffer_load_dwordx4 v244, s[4:7], s64 offen sc1 lds
    s_add_u32 m0, s74, 36864
    s_add_u32 s64, s70, 53248
    buffer_load_dwordx4 v244, s[4:7], s64 offen sc1 lds
    s_add_u32 m0, s74, 40960
    s_add_u32 s64, s70, 65536
    buffer_load_dwordx4 v244, s[4:7], s64 offen sc1 lds
    s_add_u32 m0, s74, 45056
    s_add_u32 s64, s70, 69632
    buffer_load_dwordx4 v244, s[4:7], s64 offen sc1 lds
    s_add_u32 s71, s71, 131072
    s_lshr_b32 s70, s71, 8
    s_xor_b32 s70, s70, s1
    s_and_b32 s70, s70, 0x2000
    s_or_b32 s70, s70, s71
    s_waitcnt vmcnt(0)
L_Bhave1:
    s_waitcnt vmcnt(6) lgkmcnt(0)
    s_barrier
    s_mov_b32 s75, 0
    ds_read_b128 v[204:207], v245 offset:28672
    ds_read_b128 v[208:211], v246 offset:28672
    s_waitcnt lgkmcnt(1)
    v_mfma_f32_16x16x32_bf16 v[180:183], v[4:7], v[204:207], 0
    ds_read_b128 v[212:215], v245 offset:29696
    v_mfma_f32_16x16x32_bf16 v[168:171], a[0:3], v[204:207], 0
    v_mfma_f32_16x16x32_bf16 v[172:175], a[80:83], v[204:207], 0
    v_mfma_f32_16x16x32_bf16 v[176:179], v[204:207], a[160:163], 0
    s_waitcnt lgkmcnt(1)
    v_mfma_f32_16x16x32_bf16 v[180:183], v[8:11], v[208:211], v[180:183]
    ds_read_b128 v[204:207], v246 offset:29696
    v_mfma_f32_16x16x32_bf16 v[168:171], a[4:7], v[208:211], v[168:171]
    v_mfma_f32_16x16x32_bf16 v[172:175], a[84:87], v[208:211], v[172:175]
    v_mfma_f32_16x16x32_bf16 v[176:179], v[208:211], a[164:167], v[176:179]
    s_waitcnt lgkmcnt(1)
    v_mfma_f32_16x16x32_bf16 v[180:183], v[12:15], v[212:215], v[180:183]
    ds_read_b128 v[208:211], v245 offset:30720
    buffer_load_dword v254, v253, s[4:7], 0 offen sc1
    v_mfma_f32_16x16x32_bf16 v[168:171], a[8:11], v[212:215], v[168:171]
    v_mfma_f32_16x16x32_bf16 v[172:175], a[88:91], v[212:215], v[172:175]
    v_mfma_f32_16x16x32_bf16 v[176:179], v[212:215], a[168:171], v[176:179]
    s_waitcnt lgkmcnt(1)
    v_mfma_f32_16x16x32_bf16 v[180:183], v[16:19], v[204:207], v[180:183]
    ds_read_b128 v[212:215], v246 offset:30720
    v_mfma_f32_16x16x32_bf16 v[168:171], a[12:15], v[204:207], v[168:171]
    v_mfma_f32_16x16x32_bf16 v[172:175], a[92:95], v[204:207], v[172:175]
    v_mfma_f32_16x16x32_bf16 v[176:179], v[204:207], a[172:175], v[176:179]
    s_waitcnt lgkmcnt(1)
    v_mfma_f32_16x16x32_bf16 v[180:183], v[20:23], v[208:211], v[180:183]
    ds_read_b128 v[204:207], v245 offset:31744
    v_mfma_f32_16x16x32_bf16 v[168:171], a[16:19], v[208:211], v[168:171]
    v_mfma_f32_16x16x32_bf16 v[172:175], a[96:99], v[208:211], v[172:175]
    v_mfma_f32_16x16x32_bf16 v[176:179], v[208:211], a[176:179], v[176:179]
    s_waitcnt lgkmcnt(1)
    v_mfma_f32_16x16x32_bf16 v[180:183], v[24:27], v[212:215], v[180:183]
    ds_read_b128 v[208:211], v246 offset:31744
    v_mfma_f32_16x16x32_bf16 v[168:171], a[20:23], v[212:215], v[168:171]
    v_mfma_f32_16x16x32_bf16 v[172:175], a[100:103], v[212:215], v[172:175]
    v_mfma_f32_16x16x32_bf16 v[176:179], v[212:215], a[180:183], v[176:179]
    s_waitcnt lgkmcnt(1)
    v_mfma_f32_16x16x32_bf16 v[180:183], v[28:31], v[204:207], v[180:183]
    ds_read_b128 v[212:215], v245 offset:32768
    v_mfma_f32_16x16x32_bf16 v[168:171], a[24:27], v[204:207], v[168:171]
    v_mfma_f32_16x16x32_bf16 v[172:175], a[104:107], v[204:207], v[172:175]
    v_mfma_f32_16x16x32_bf16 v[176:179], v[204:207], a[184:187], v[176:179]
    s_waitcnt lgkmcnt(1)
    v_mfma_f32_16x16x32_bf16 v[180:183], v[32:35], v[208:211], v[180:183]
    ds_read_b128 v[204:207], v246 offset:32768
    v_mfma_f32_16x16x32_bf16 v[168:171], a[28:31], v[208:211], v[168:171]
    v_mfma_f32_16x16x32_bf16 v[172:175], a[108:111], v[208:211], v[172:175]
    v_mfma_f32_16x16x32_bf16 v[176:179], v[208:211], a[188:191], v[176:179]
    s_waitcnt lgkmcnt(1)
    v_mfma_f32_16x16x32_bf16 v[180:183], v[36:39], v[212:215], v[180:183]
    ds_read_b128 v[208:211], v245 offset:33792
    v_mfma_f32_16x16x32_bf16 v[168:171], a[32:35], v[212:215], v[168:171]
    v_mfma_f32_16x16x32_bf16 v[172:175], a[112:115], v[212:215], v[172:175]
    v_mfma_f32_16x16x32_bf16 v[176:179], v[212:215], a[192:195], v[176:179]
    s_waitcnt lgkmcnt(1)
    v_mfma_f32_16x16x32_bf16 v[180:183], v[40:43], v[204:207], v[180:183]
    ds_read_b128 v[212:215], v246 offset:33792
    v_mfma_f32_16x16x32_bf16 v[168:171], a[36:39], v[204:207], v[168:171]
    v_mfma_f32_16x16x32_bf16 v[172:175], a[116:119], v[204:207], v[172:175]
    v_mfma_f32_16x16x32_bf16 v[176:179], v[204:207], a[196:199], v[176:179]
    s_waitcnt vmcnt(0)
    s_cmp_eq_u32 s80, 0
    s_cbranch_scc1 Lowed_85
    s_waitcnt vmcnt(0)
    v_mov_b32 v2, s62
    s_mov_b64 exec, 1
    buffer_store_dword v2, off, s[4:7], s63 sc1
    buffer_store_dword v2, off, s[4:7], s3
    s_mov_b64 exec, -1
    s_mov_b32 s80, 0
Lowed_85:
    s_add_u32 s65, s62, s75
    s_add_u32 s65, s65, 2
    v_cmp_gt_u32 vcc, s65, v254
    s_cbranch_vccz Lpre_86
    s_waitcnt lgkmcnt(1)
    v_mfma_f32_16x16x32_bf16 v[180:183], v[44:47], v[208:211], v[180:183]
    ds_read_b128 v[204:207], v245 offset:34816
    ds_read_b128 v[188:191], v247 offset:5120
    v_mfma_f32_16x16x32_bf16 v[168:171], a[40:43], v[208:211], v[168:171]
    ds_read_b128 v[184:187], v247 offset:6144
    v_mfma_f32_16x16x32_bf16 v[172:175], a[120:123], v[208:211], v[172:175]
    v_mfma_f32_16x16x32_bf16 v[176:179], v[208:211], a[200:203], v[176:179]
    s_waitcnt lgkmcnt(3)
    v_mfma_f32_16x16x32_bf16 v[180:183], v[48:51], v[212:215], v[180:183]
    ds_read_b128 v[208:211], v246 offset:34816
    v_mfma_f32_16x16x32_bf16 v[168:171], a[44:47], v[212:215], v[168:171]
    v_mfma_f32_16x16x32_bf16 v[172:175], a[124:127], v[212:215], v[172:175]
    v_mfma_f32_16x16x32_bf16 v[176:179], v[212:215], a[204:207], v[176:179]
    s_waitcnt lgkmcnt(3)
    v_mfma_f32_16x16x32_bf16 v[180:183], v[52:55], v[204:207], v[180:183]
    ds_read_b128 v[212:215], v245 offset:35840
    v_mfma_f32_16x16x32_bf16 v[168:171], a[48:51], v[204:207], v[168:171]
    v_mfma_f32_16x16x32_bf16 v[172:175], a[128:131], v[204:207], v[172:175]
    v_mfma_f32_16x16x32_bf16 v[176:179], v[204:207], a[208:211], v[176:179]
    s_waitcnt lgkmcnt(1)
    v_mfma_f32_16x16x32_bf16 v[180:183], v[56:59], v[208:211], v[180:183]
    ds_read_b128 v[204:207], v246 offset:35840
    v_mfma_f32_16x16x32_bf16 v[168:171], a[52:55], v[208:211], v[168:171]
    v_mfma_f32_16x16x32_bf16 v[172:175], a[132:135], v[208:211], v[172:175]
    v_mfma_f32_16x16x32_bf16 v[176:179], v[208:211], a[212:215], v[176:179]
    s_waitcnt lgkmcnt(1)
    v_mfma_f32_16x16x32_bf16 v[180:183], v[60:63], v[212:215], v[180:183]
    ds_read_b128 v[208:211], v245 offset:36864
    v_mfma_f32_16x16x32_bf16 v[168:171], a[56:59], v[212:215], v[168:171]
    v_mfma_f32_16x16x32_bf16 v[172:175], a[136:139], v[212:215], v[172:175]
    v_mfma_f32_16x16x32_bf16 v[176:179], v[212:215], a[216:219], v[176:179]
    s_waitcnt lgkmcnt(1)
    v_mfma_f32_16x16x32_bf16 v[180:183], v[64:67], v[204:207], v[180:183]
    ds_read_b128 v[212:215], v246 offset:36864
    v_mfma_f32_16x16x32_bf16 v[168:171], a[60:63], v[204:207], v[168:171]
    v_mfma_f32_16x16x32_bf16 v[172:175], a[140:143], v[204:207], v[172:175]
    v_mfma_f32_16x16x32_bf16 v[176:179], v[204:207], a[220:223], v[176:179]
    s_waitcnt lgkmcnt(1)
    v_mfma_f32_16x16x32_bf16 v[180:183], v[68:71], v[208:211], v[180:183]
    ds_read_b128 v[204:207], v245 offset:37888
    v_mfma_f32_16x16x32_bf16 v[168:171], a[64:67], v[208:211], v[168:171]
    v_mfma_f32_16x16x32_bf16 v[172:175], a[144:147], v[208:211], v[172:175]
    v_mfma_f32_16x16x32_bf16 v[176:179], v[208:211], a[224:227], v[176:179]
    s_waitcnt lgkmcnt(1)
    v_mfma_f32_16x16x32_bf16 v[180:183], v[72:75], v[212:215], v[180:183]
    ds_read_b128 v[208:211], v246 offset:37888
    v_mfma_f32_16x16x32_bf16 v[168:171], a[68:71], v[212:215], v[168:171]
    v_mfma_f32_16x16x32_bf16 v[172:175], a[148:151], v[212:215], v[172:175]
    v_mfma_f32_16x16x32_bf16 v[176:179], v[212:215], a[228:231], v[176:179]
    s_waitcnt lgkmcnt(1)
    v_mfma_f32_16x16x32_bf16 v[180:183], v[76:79], v[204:207], v[180:183]
    v_mfma_f32_16x16x32_bf16 v[168:171], a[72:75], v[204:207], v[168:171]
    v_mfma_f32_16x16x32_bf16 v[172:175], a[152:155], v[204:207], v[172:175]
    v_mfma_f32_16x16x32_bf16 v[176:179], v[204:207], a[232:235], v[176:179]
    s_waitcnt lgkmcnt(0)
    v_mfma_f32_16x16x32_bf16 v[180:183], v[80:83], v[208:211], v[180:183]
    s_nop 2
    v_mfma_f32_16x16x32_bf16 v[168:171], a[76:79], v[208:211], v[168:171]
    s_nop 2
    v_mfma_f32_16x16x32_bf16 v[172:175], a[156:159], v[208:211], v[172:175]
    s_nop 2
    v_mfma_f32_16x16x32_bf16 v[176:179], v[208:211], a[236:239], v[176:179]
Lback_87:
    s_waitcnt vmcnt(0)
L_Be1:
    v_mov_b32 v2, s75
    ds_write_b32 v3, v2 offset:2560
    buffer_load_dword v254, v253, s[4:7], 0 offen sc1
    v_mfma_f32_16x16x4_f32 v[192:195], v182, v242, 0
    v_cvt_pk_bf16_f32 v222, v180, 0
    v_cvt_pk_bf16_f32 v230, v181, 0
    v_cvt_pk_bf16_f32 v220, v168, v169
    v_cvt_pk_bf16_f32 v221, v170, v171
    v_mov_b32 v223, 0
    v_cvt_pk_bf16_f32 v228, v172, v173
    v_cvt_pk_bf16_f32 v229, v174, v175
    s_waitcnt lgkmcnt(0)
    s_barrier
    ds_read_b32 v2, v1 offset:2560
    v_mfma_f32_16x16x32_bf16 v[188:191], v[224:227], v[220:223], v[188:191]
    v_cvt_pk_bf16_f32 v232, v176, v177
    v_cvt_pk_bf16_f32 v233, v178, v179
    v_mfma_f32_16x16x32_bf16 v[184:187], v[228:231], v[220:223], v[184:187]
    s_add_u32 s78, s73, 16384
    s_add_u32 s79, s73, 49152
    v_mov_b32 v248, v247
    v_cvt_pk_bf16_f32 v236, v192, v193
    v_cvt_pk_bf16_f32 v237, v194, v195
    v_or_b32 v236, v243, v236
    v_or_b32 v237, v243, v237
    s_waitcnt lgkmcnt(0)
    v_cmp_eq_u32 vcc, 0, v2
    s_cbranch_vccz L_Bi1
    v_max3_f32 v192, v184, v185, v186
    v_max3_f32 v193, v188, v189, v190
    v_max3_f32 v192, v192, v187, v191
    v_max_f32 v192, v192, v193
    v_mov_b32 v193, v192
    s_nop 1
    v_permlane16_swap_b32 v192, v193
    v_max_f32 v192, v192, v193
    v_mov_b32 v193, v192
    s_nop 1
    v_permlane32_swap_b32 v192, v193
    v_max_f32 v192, v192, v193
    v_mul_f32 v192, s77, v192
    v_fma_f32 v184, v184, s77, -v192
    v_fma_f32 v185, v185, s77, -v192
    v_fma_f32 v186, v186, s77, -v192
    v_fma_f32 v187, v187, s77, -v192
    v_fma_f32 v188, v188, s77, -v192
    v_fma_f32 v189, v189, s77, -v192
    v_fma_f32 v190, v190, s77, -v192
    v_fma_f32 v191, v191, s77, -v192
    v_exp_f32 v184, v184
    v_exp_f32 v185, v185
    v_exp_f32 v186, v186
    v_exp_f32 v187, v187
    v_exp_f32 v188, v188
    v_exp_f32 v189, v189
    v_exp_f32 v190, v190
    v_exp_f32 v191, v191
    v_cvt_pk_bf16_f32 v184, v184, v185
    v_cvt_pk_bf16_f32 v185, v186, v187
    v_cvt_pk_bf16_f32 v186, v188, v189
    v_cvt_pk_bf16_f32 v187, v190, v191
    s_nop 1
    v_mfma_f32_16x16x32_bf16 v[200:203], v[236:239], v[184:187], 0
    s_nop 2
    v_mfma_f32_16x16x32_bf16 v[196:199], v[232:235], v[184:187], 0
    s_nop 3
    v_rcp_f32 v201, v201
    s_nop 0
    v_mul_f32 v200, v200, v201
    s_nop 0
    v_mul_f32 v196, v196, v201
    v_mul_f32 v197, v197, v201
    v_mul_f32 v198, v198, v201
    v_mul_f32 v199, v199, v201
    v_cvt_pk_bf16_f32 v200, v200, v200
    v_cvt_pk_bf16_f32 v196, v196, v197
    v_cvt_pk_bf16_f32 v197, v198, v199
    ds_write_b16 v250, v200 offset:2048
    ds_write_b64 v249, v[196:197] offset:0
    s_waitcnt lgkmcnt(0)
    s_barrier
    ds_read_b64 v[240:241], v255 offset:2048
    ds_read_b128 v[220:223], v247 offset:0
    ds_read_b128 v[216:219], v247 offset:1024
    s_waitcnt vmcnt(0)
    s_cmp_eq_u32 s80, 0
    s_cbranch_scc1 Lowed_88
    s_waitcnt vmcnt(0)
    v_mov_b32 v2, s62
    s_mov_b64 exec, 1
    buffer_store_dword v2, off, s[4:7], s63 sc1
    buffer_store_dword v2, off, s[4:7], s3
    s_mov_b64 exec, -1
    s_mov_b32 s80, 0
Lowed_88:
    s_add_u32 s65, s62, s75
    s_add_u32 s65, s65, 2
    v_cmp_gt_u32 vcc, s65, v254
    s_cbranch_vccz Lpre_89
    s_waitcnt lgkmcnt(2)
    v_mfma_f32_16x16x16_bf16 v[168:171], a[240:241], v[240:241], 0
    v_mfma_f32_16x16x16_bf16 v[172:175], a[242:243], v[240:241], 0
    v_mfma_f32_16x16x16_bf16 v[176:179], a[244:245], v[240:241], 0
    v_mfma_f32_16x16x16_bf16 v[180:183], a[246:247], v[240:241], 0
    v_mfma_f32_16x16x16_bf16 v[204:207], a[248:249], v[240:241], 0
    v_mfma_f32_16x16x16_bf16 v[184:187], a[250:251], v[240:241], 0
    v_mfma_f32_16x16x16_bf16 v[188:191], a[252:253], v[240:241], 0
    v_mfma_f32_16x16x16_bf16 v[192:195], a[254:255], v[240:241], 0
    v_mfma_f32_16x16x16_bf16 v[196:199], v[164:165], v[240:241], 0
    v_mfma_f32_16x16x16_bf16 v[200:203], v[166:167], v[240:241], 0
Lback_90:
    s_waitcnt lgkmcnt(1)
    v_mfma_f32_16x16x32_bf16 v[168:171], v[84:87], v[220:223], v[168:171]
    v_mfma_f32_16x16x32_bf16 v[172:175], v[92:95], v[220:223], v[172:175]
    s_waitcnt lgkmcnt(0)
    v_mfma_f32_16x16x32_bf16 v[168:171], v[88:91], v[216:219], v[168:171]
    s_nop 2
    v_mfma_f32_16x16x32_bf16 v[172:175], v[96:99], v[216:219], v[172:175]
    s_nop 2
    v_mfma_f32_16x16x32_bf16 v[176:179], v[100:103], v[220:223], v[176:179]
    v_cvt_pk_bf16_f32 v168, v168, v169
    v_cvt_pk_bf16_f32 v169, v170, v171
    v_mfma_f32_16x16x32_bf16 v[180:183], v[108:111], v[220:223], v[180:183]
    s_nop 0
    v_cvt_pk_bf16_f32 v170, v172, v173
    v_cvt_pk_bf16_f32 v171, v174, v175
    v_mfma_f32_16x16x32_bf16 v[176:179], v[104:107], v[216:219], v[176:179]
    buffer_store_dwordx4 v[168:171], v251, s[4:7], s78 offen offset:0 sc1
    s_nop 4
    v_mfma_f32_16x16x32_bf16 v[180:183], v[112:115], v[216:219], v[180:183]
    s_nop 0
    v_cvt_pk_bf16_f32 v176, v176, v177
    v_cvt_pk_bf16_f32 v177, v178, v179
    v_mfma_f32_16x16x32_bf16 v[204:207], v[116:119], v[220:223], v[204:207]
    s_nop 2
    v_mfma_f32_16x16x32_bf16 v[204:207], v[120:123], v[216:219], v[204:207]
    v_cvt_pk_bf16_f32 v178, v180, v181
    v_cvt_pk_bf16_f32 v179, v182, v183
    v_mfma_f32_16x16x32_bf16 v[184:187], v[124:127], v[220:223], v[184:187]
    buffer_store_dwordx4 v[176:179], v251, s[4:7], s79 offen offset:0 sc1
    s_nop 3
    v_cvt_pk_bf16_f32 v204, v204, v205
    v_mfma_f32_16x16x32_bf16 v[188:191], v[132:135], v[220:223], v[188:191]
    v_cvt_pk_bf16_f32 v205, v206, v207
    v_mfma_f32_16x16x32_bf16 v[184:187], v[128:131], v[216:219], v[184:187]
    buffer_store_dwordx2 v[204:205], v252, s[4:7], s73 offen offset:512 sc1
    s_nop 2
    v_mfma_f32_16x16x32_bf16 v[188:191], v[136:139], v[216:219], v[188:191]
    s_nop 2
    v_mfma_f32_16x16x32_bf16 v[192:195], v[140:143], v[220:223], v[192:195]
    v_cvt_pk_bf16_f32 v184, v184, v185
    v_cvt_pk_bf16_f32 v185, v186, v187
    v_mfma_f32_16x16x32_bf16 v[196:199], v[148:151], v[220:223], v[196:199]
    s_nop 0
    v_cvt_pk_bf16_f32 v186, v188, v189
    v_cvt_pk_bf16_f32 v187, v190, v191
    v_mfma_f32_16x16x32_bf16 v[192:195], v[144:147], v[216:219], v[192:195]
    buffer_store_dwordx4 v[184:187], v251, s[4:7], s78 offen offset:1024 sc1
    s_nop 4
    v_mfma_f32_16x16x32_bf16 v[196:199], v[152:155], v[216:219], v[196:199]
    s_nop 0
    v_cvt_pk_bf16_f32 v192, v192, v193
    v_cvt_pk_bf16_f32 v193, v194, v195
    v_mfma_f32_16x16x32_bf16 v[200:203], v[156:159], v[220:223], v[200:203]
    s_nop 2
    v_mfma_f32_16x16x32_bf16 v[200:203], v[160:163], v[216:219], v[200:203]
    v_cvt_pk_bf16_f32 v194, v196, v197
    v_cvt_pk_bf16_f32 v195, v198, v199
    buffer_store_dwordx4 v[192:195], v251, s[4:7], s79 offen offset:1024 sc1
    s_nop 4
    v_cvt_pk_bf16_f32 v200, v200, v201
    v_cvt_pk_bf16_f32 v201, v202, v203
    buffer_store_dwordx2 v[200:201], v252, s[4:7], s73 offen offset:1536 sc1
    s_add_u32 s62, s62, 1
    s_mov_b32 s80, 1
    s_cmp_lt_u32 s62, 128
    s_cbranch_scc1 L_Bh0
    s_waitcnt vmcnt(0)
    v_mov_b32 v2, s62
    s_mov_b64 exec, 1
    buffer_store_dword v2, off, s[4:7], s63 sc1
    buffer_store_dword v2, off, s[4:7], s3
    s_mov_b64 exec, -1
    s_endpgm
L_Bi0:
    s_mov_b32 s75, 0
    ds_read_b128 v[204:207], v245 offset:28672
    ds_read_b128 v[208:211], v246 offset:28672
    v_max3_f32 v192, v184, v185, v186
    v_max3_f32 v193, v188, v189, v190
    v_max3_f32 v192, v192, v187, v191
    v_max_f32 v192, v192, v193
    s_waitcnt lgkmcnt(1)
    v_mfma_f32_16x16x32_bf16 v[180:183], v[4:7], v[204:207], 0
    ds_read_b128 v[212:215], v245 offset:29696
    v_mov_b32 v193, v192
    v_mfma_f32_16x16x32_bf16 v[168:171], a[0:3], v[204:207], 0
    s_nop 0
    v_permlane16_swap_b32 v192, v193
    v_mfma_f32_16x16x32_bf16 v[172:175], a[80:83], v[204:207], 0
    v_max_f32 v192, v192, v193
    v_mov_b32 v193, v192
    v_mfma_f32_16x16x32_bf16 v[176:179], v[204:207], a[160:163], 0
    s_waitcnt lgkmcnt(1)
    v_permlane32_swap_b32 v192, v193
    v_mfma_f32_16x16x32_bf16 v[180:183], v[8:11], v[208:211], v[180:183]
    ds_read_b128 v[204:207], v246 offset:29696
    v_max_f32 v192, v192, v193
    v_mfma_f32_16x16x32_bf16 v[168:171], a[4:7], v[208:211], v[168:171]
    v_mul_f32 v192, s77, v192
    v_fma_f32 v184, v184, s77, -v192
    v_mfma_f32_16x16x32_bf16 v[172:175], a[84:87], v[208:211], v[172:175]
    v_fma_f32 v185, v185, s77, -v192
    v_fma_f32 v186, v186, s77, -v192
    v_mfma_f32_16x16x32_bf16 v[176:179], v[208:211], a[164:167], v[176:179]
    s_waitcnt lgkmcnt(1)
    v_fma_f32 v187, v187, s77, -v192
    v_fma_f32 v188, v188, s77, -v192
    v_mfma_f32_16x16x32_bf16 v[180:183], v[12:15], v[212:215], v[180:183]
    ds_read_b128 v[208:211], v245 offset:30720
    v_fma_f32 v189, v189, s77, -v192
    v_mfma_f32_16x16x32_bf16 v[168:171], a[8:11], v[212:215], v[168:171]
    v_fma_f32 v190, v190, s77, -v192
    v_fma_f32 v191, v191, s77, -v192
    v_mfma_f32_16x16x32_bf16 v[172:175], a[88:91], v[212:215], v[172:175]
    v_exp_f32 v184, v184
    v_mfma_f32_16x16x32_bf16 v[176:179], v[212:215], a[168:171], v[176:179]
    s_waitcnt lgkmcnt(1)
    v_exp_f32 v185, v185
    v_mfma_f32_16x16x32_bf16 v[180:183], v[16:19], v[204:207], v[180:183]
    ds_read_b128 v[212:215], v246 offset:30720
    v_mfma_f32_16x16x32_bf16 v[168:171], a[12:15], v[204:207], v[168:171]
    v_exp_f32 v186, v186
    v_mfma_f32_16x16x32_bf16 v[172:175], a[92:95], v[204:207], v[172:175]
    v_exp_f32 v187, v187
    v_mfma_f32_16x16x32_bf16 v[176:179], v[204:207], a[172:175], v[176:179]
    s_waitcnt lgkmcnt(1)
    v_exp_f32 v188, v188
    v_mfma_f32_16x16x32_bf16 v[180:183], v[20:23], v[208:211], v[180:183]
    ds_read_b128 v[204:207], v245 offset:31744
    v_mfma_f32_16x16x32_bf16 v[168:171], a[16:19], v[208:211], v[168:171]
    v_exp_f32 v189, v189
    v_mfma_f32_16x16x32_bf16 v[172:175], a[96:99], v[208:211], v[172:175]
    v_exp_f32 v190, v190
    v_mfma_f32_16x16x32_bf16 v[176:179], v[208:211], a[176:179], v[176:179]
    s_waitcnt lgkmcnt(1)
    v_exp_f32 v191, v191
    v_mfma_f32_16x16x32_bf16 v[180:183], v[24:27], v[212:215], v[180:183]
    ds_read_b128 v[208:211], v246 offset:31744
    v_cvt_pk_bf16_f32 v184, v184, v185
    v_mfma_f32_16x16x32_bf16 v[168:171], a[20:23], v[212:215], v[168:171]
    v_cvt_pk_bf16_f32 v185, v186, v187
    v_cvt_pk_bf16_f32 v186, v188, v189
    v_mfma_f32_16x16x32_bf16 v[172:175], a[100:103], v[212:215], v[172:175]
    v_cvt_pk_bf16_f32 v187, v190, v191
    s_nop 0
    v_mfma_f32_16x16x32_bf16 v[176:179], v[212:215], a[180:183], v[176:179]
    v_mfma_f32_16x16x32_bf16 v[200:203], v[236:239], v[184:187], 0
    s_nop 2
    v_mfma_f32_16x16x32_bf16 v[196:199], v[232:235], v[184:187], 0
    s_waitcnt vmcnt(0)
    s_cmp_eq_u32 s80, 0
    s_cbranch_scc1 Lowed_91
    s_waitcnt vmcnt(0)
    v_mov_b32 v2, s62
    s_mov_b64 exec, 1
    buffer_store_dword v2, off, s[4:7], s63 sc1
    buffer_store_dword v2, off, s[4:7], s3
    s_mov_b64 exec, -1
    s_mov_b32 s80, 0
Lowed_91:
    s_add_u32 s65, s62, s75
    s_add_u32 s65, s65, 3
    v_cmp_gt_u32 vcc, s65, v254
    s_cbranch_vccz Lpre_92
    s_waitcnt lgkmcnt(1)
    v_mfma_f32_16x16x32_bf16 v[180:183], v[28:31], v[204:207], v[180:183]
    ds_read_b128 v[212:215], v245 offset:32768
    v_mfma_f32_16x16x32_bf16 v[168:171], a[24:27], v[204:207], v[168:171]
    v_rcp_f32 v201, v201
    v_mfma_f32_16x16x32_bf16 v[172:175], a[104:107], v[204:207], v[172:175]
    v_mul_f32 v200, v200, v201
    v_mul_f32 v196, v196, v201
    v_mfma_f32_16x16x32_bf16 v[176:179], v[204:207], a[184:187], v[176:179]
    s_waitcnt lgkmcnt(1)
    v_mul_f32 v197, v197, v201
    v_mul_f32 v198, v198, v201
    v_mfma_f32_16x16x32_bf16 v[180:183], v[32:35], v[208:211], v[180:183]
    ds_read_b128 v[204:207], v246 offset:32768
    v_mul_f32 v199, v199, v201
    v_mfma_f32_16x16x32_bf16 v[168:171], a[28:31], v[208:211], v[168:171]
    v_cvt_pk_bf16_f32 v200, v200, v200
    v_cvt_pk_bf16_f32 v196, v196, v197
    v_mfma_f32_16x16x32_bf16 v[172:175], a[108:111], v[208:211], v[172:175]
    v_cvt_pk_bf16_f32 v197, v198, v199
    v_mfma_f32_16x16x32_bf16 v[176:179], v[208:211], a[188:191], v[176:179]
    ds_write_b16 v250, v200 offset:2048
Lback_93:
    s_waitcnt lgkmcnt(2)
    v_mfma_f32_16x16x32_bf16 v[180:183], v[36:39], v[212:215], v[180:183]
    ds_read_b128 v[208:211], v245 offset:33792
    v_mfma_f32_16x16x32_bf16 v[168:171], a[32:35], v[212:215], v[168:171]
    ds_write_b64 v249, v[196:197] offset:0
    v_mfma_f32_16x16x32_bf16 v[172:175], a[112:115], v[212:215], v[172:175]
    v_mfma_f32_16x16x32_bf16 v[176:179], v[212:215], a[192:195], v[176:179]
    s_waitcnt lgkmcnt(3)
    v_mfma_f32_16x16x32_bf16 v[180:183], v[40:43], v[204:207], v[180:183]
    ds_read_b128 v[212:215], v246 offset:33792
    v_mfma_f32_16x16x32_bf16 v[168:171], a[36:39], v[204:207], v[168:171]
    v_mfma_f32_16x16x32_bf16 v[172:175], a[116:119], v[204:207], v[172:175]
    s_waitcnt lgkmcnt(1)
    s_barrier
    ds_read_b64 v[240:241], v255 offset:2048
    ds_read_b128 v[220:223], v247 offset:0
    v_mfma_f32_16x16x32_bf16 v[176:179], v[204:207], a[196:199], v[176:179]
    ds_read_b128 v[216:219], v247 offset:1024
    v_mfma_f32_16x16x32_bf16 v[180:183], v[44:47], v[208:211], v[180:183]
    ds_read_b128 v[204:207], v245 offset:34816
    v_mfma_f32_16x16x32_bf16 v[168:171], a[40:43], v[208:211], v[168:171]
    v_mfma_f32_16x16x32_bf16 v[172:175], a[120:123], v[208:211], v[172:175]
    v_mfma_f32_16x16x32_bf16 v[176:179], v[208:211], a[200:203], v[176:179]
    s_waitcnt lgkmcnt(3)
    v_mfma_f32_16x16x16_bf16 v[184:187], a[240:241], v[240:241], 0
    v_mfma_f32_16x16x16_bf16 v[188:191], a[242:243], v[240:241], 0
    v_mfma_f32_16x16x16_bf16 v[192:195], a[244:245], v[240:241], 0
    v_mfma_f32_16x16x16_bf16 v[196:199], a[246:247], v[240:241], 0
    v_mfma_f32_16x16x16_bf16 v[200:203], a[248:249], v[240:241], 0
    v_mfma_f32_16x16x32_bf16 v[180:183], v[48:51], v[212:215], v[180:183]
    ds_read_b128 v[208:211], v246 offset:34816
    v_mfma_f32_16x16x32_bf16 v[168:171], a[44:47], v[212:215], v[168:171]
    v_mfma_f32_16x16x32_bf16 v[172:175], a[124:127], v[212:215], v[172:175]
    v_mfma_f32_16x16x32_bf16 v[176:179], v[212:215], a[204:207], v[176:179]
    s_waitcnt lgkmcnt(3)
    v_mfma_f32_16x16x32_bf16 v[184:187], v[84:87], v[220:223], v[184:187]
    v_mfma_f32_16x16x32_bf16 v[188:191], v[92:95], v[220:223], v[188:191]
    s_waitcnt lgkmcnt(2)
    v_mfma_f32_16x16x32_bf16 v[184:187], v[88:91], v[216:219], v[184:187]
    s_nop 2
    v_mfma_f32_16x16x32_bf16 v[188:191], v[96:99], v[216:219], v[188:191]
    s_nop 2
    v_mfma_f32_16x16x32_bf16 v[192:195], v[100:103], v[220:223], v[192:195]
    v_cvt_pk_bf16_f32 v184, v184, v185
    v_cvt_pk_bf16_f32 v185, v186, v187
    v_mfma_f32_16x16x32_bf16 v[196:199], v[108:111], v[220:223], v[196:199]
    s_nop 0
    v_cvt_pk_bf16_f32 v186, v188, v189
    v_cvt_pk_bf16_f32 v187, v190, v191
    v_mfma_f32_16x16x32_bf16 v[192:195], v[104:107], v[216:219], v[192:195]
    buffer_store_dwordx4 v[184:187], v251, s[4:7], s78 offen offset:0 sc1
    s_nop 4
    v_mfma_f32_16x16x32_bf16 v[196:199], v[112:115], v[216:219], v[196:199]
    s_nop 0
    v_cvt_pk_bf16_f32 v192, v192, v193
    v_cvt_pk_bf16_f32 v193, v194, v195
    v_mfma_f32_16x16x32_bf16 v[200:203], v[116:119], v[220:223], v[200:203]
    s_nop 2
    v_mfma_f32_16x16x32_bf16 v[200:203], v[120:123], v[216:219], v[200:203]
    v_cvt_pk_bf16_f32 v194, v196, v197
    v_cvt_pk_bf16_f32 v195, v198, v199
    s_waitcnt lgkmcnt(1)
    v_mfma_f32_16x16x32_bf16 v[180:183], v[52:55], v[204:207], v[180:183]
    ds_read_b128 v[212:215], v245 offset:35840
    v_mfma_f32_16x16x32_bf16 v[168:171], a[48:51], v[204:207], v[168:171]
    buffer_store_dwordx4 v[192:195], v251, s[4:7], s79 offen offset:0 sc1
    s_nop 0
    v_cvt_pk_bf16_f32 v200, v200, v201
    v_cvt_pk_bf16_f32 v201, v202, v203
    v_mfma_f32_16x16x32_bf16 v[172:175], a[128:131], v[204:207], v[172:175]
    buffer_store_dwordx2 v[200:201], v252, s[4:7], s73 offen offset:0 sc1
    v_mfma_f32_16x16x32_bf16 v[176:179], v[204:207], a[208:211], v[176:179]
    s_waitcnt lgkmcnt(1)
    v_mfma_f32_16x16x32_bf16 v[180:183], v[56:59], v[208:211], v[180:183]
    ds_read_b128 v[204:207], v246 offset:35840
    v_mfma_f32_16x16x32_bf16 v[168:171], a[52:55], v[208:211], v[168:171]
    v_mfma_f32_16x16x32_bf16 v[172:175], a[132:135], v[208:211], v[172:175]
    v_mfma_f32_16x16x32_bf16 v[176:179], v[208:211], a[212:215], v[176:179]
    v_mfma_f32_16x16x16_bf16 v[184:187], a[250:251], v[240:241], 0
    v_mfma_f32_16x16x16_bf16 v[188:191], a[252:253], v[240:241], 0
    v_mfma_f32_16x16x16_bf16 v[192:195], a[254:255], v[240:241], 0
    v_mfma_f32_16x16x16_bf16 v[196:199], v[164:165], v[240:241], 0
    v_mfma_f32_16x16x16_bf16 v[200:203], v[166:167], v[240:241], 0
    s_waitcnt lgkmcnt(1)
    v_mfma_f32_16x16x32_bf16 v[180:183], v[60:63], v[212:215], v[180:183]
    ds_read_b128 v[208:211], v245 offset:36864
    v_mfma_f32_16x16x32_bf16 v[168:171], a[56:59], v[212:215], v[168:171]
    v_mfma_f32_16x16x32_bf16 v[172:175], a[136:139], v[212:215], v[172:175]
    v_mfma_f32_16x16x32_bf16 v[176:179], v[212:215], a[216:219], v[176:179]
    v_mfma_f32_16x16x32_bf16 v[184:187], v[124:127], v[220:223], v[184:187]
    v_mfma_f32_16x16x32_bf16 v[188:191], v[132:135], v[220:223], v[188:191]
    v_mfma_f32_16x16x32_bf16 v[184:187], v[128:131], v[216:219], v[184:187]
    s_nop 2
    v_mfma_f32_16x16x32_bf16 v[188:191], v[136:139], v[216:219], v[188:191]
    s_nop 2
    v_mfma_f32_16x16x32_bf16 v[192:195], v[140:143], v[220:223], v[192:195]
    v_cvt_pk_bf16_f32 v184, v184, v185
    v_cvt_pk_bf16_f32 v185, v186, v187
    v_mfma_f32_16x16x32_bf16 v[196:199], v[148:151], v[220:223], v[196:199]
    s_nop 0
    v_cvt_pk_bf16_f32 v186, v188, v189
    v_cvt_pk_bf16_f32 v187, v190, v191
    v_mfma_f32_16x16x32_bf16 v[192:195], v[144:147], v[216:219], v[192:195]
    buffer_store_dwordx4 v[184:187], v251, s[4:7], s78 offen offset:1024 sc1
    s_nop 4
    v_mfma_f32_16x16x32_bf16 v[196:199], v[152:155], v[216:219], v[196:199]
    s_nop 0
    v_cvt_pk_bf16_f32 v192, v192, v193
    v_cvt_pk_bf16_f32 v193, v194, v195
    v_mfma_f32_16x16x32_bf16 v[200:203], v[156:159], v[220:223], v[200:203]
    s_nop 2
    v_mfma_f32_16x16x32_bf16 v[200:203], v[160:163], v[216:219], v[200:203]
    v_cvt_pk_bf16_f32 v194, v196, v197
    v_cvt_pk_bf16_f32 v195, v198, v199
    s_waitcnt lgkmcnt(1)
    v_mfma_f32_16x16x32_bf16 v[180:183], v[64:67], v[204:207], v[180:183]
    ds_read_b128 v[212:215], v246 offset:36864
    v_mfma_f32_16x16x32_bf16 v[168:171], a[60:63], v[204:207], v[168:171]
    buffer_store_dwordx4 v[192:195], v251, s[4:7], s79 offen offset:1024 sc1
    s_nop 0
    v_cvt_pk_bf16_f32 v200, v200, v201
    v_cvt_pk_bf16_f32 v201, v202, v203
    v_mfma_f32_16x16x32_bf16 v[172:175], a[140:143], v[204:207], v[172:175]
    buffer_store_dwordx2 v[200:201], v252, s[4:7], s73 offen offset:1024 sc1
    ds_read_b128 v[188:191], v247 offset:5120
    ds_read_b128 v[184:187], v247 offset:6144
    v_mfma_f32_16x16x32_bf16 v[176:179], v[204:207], a[220:223], v[176:179]
    s_waitcnt lgkmcnt(3)
    v_mfma_f32_16x16x32_bf16 v[180:183], v[68:71], v[208:211], v[180:183]
    ds_read_b128 v[204:207], v245 offset:37888
    v_mfma_f32_16x16x32_bf16 v[168:171], a[64:67], v[208:211], v[168:171]
    v_mfma_f32_16x16x32_bf16 v[172:175], a[144:147], v[208:211], v[172:175]
    v_mfma_f32_16x16x32_bf16 v[176:179], v[208:211], a[224:227], v[176:179]
    s_waitcnt lgkmcnt(3)
    v_mfma_f32_16x16x32_bf16 v[180:183], v[72:75], v[212:215], v[180:183]
    ds_read_b128 v[208:211], v246 offset:37888
    v_mfma_f32_16x16x32_bf16 v[168:171], a[68:71], v[212:215], v[168:171]
    v_mfma_f32_16x16x32_bf16 v[172:175], a[148:151], v[212:215], v[172:175]
    v_mfma_f32_16x16x32_bf16 v[176:179], v[212:215], a[228:231], v[176:179]
    s_waitcnt lgkmcnt(1)
    v_mfma_f32_16x16x32_bf16 v[180:183], v[76:79], v[204:207], v[180:183]
    v_mfma_f32_16x16x32_bf16 v[168:171], a[72:75], v[204:207], v[168:171]
    v_mfma_f32_16x16x32_bf16 v[172:175], a[152:155], v[204:207], v[172:175]
    v_mfma_f32_16x16x32_bf16 v[176:179], v[204:207], a[232:235], v[176:179]
    s_waitcnt lgkmcnt(0)
    v_mfma_f32_16x16x32_bf16 v[180:183], v[80:83], v[208:211], v[180:183]
    s_nop 2
    v_mfma_f32_16x16x32_bf16 v[168:171], a[76:79], v[208:211], v[168:171]
    s_nop 2
    v_mfma_f32_16x16x32_bf16 v[172:175], a[156:159], v[208:211], v[172:175]
    s_nop 2
    v_mfma_f32_16x16x32_bf16 v[176:179], v[208:211], a[236:239], v[176:179]
    s_add_u32 s62, s62, 1
    s_mov_b32 s80, 1
    s_waitcnt vmcnt(6)
    s_branch L_Be1
L_Bi1:
    s_mov_b32 s75, 0
    ds_read_b128 v[204:207], v245 offset:8192
    ds_read_b128 v[208:211], v246 offset:8192
    v_max3_f32 v192, v184, v185, v186
    v_max3_f32 v193, v188, v189, v190
    v_max3_f32 v192, v192, v187, v191
    v_max_f32 v192, v192, v193
    s_waitcnt lgkmcnt(1)
    v_mfma_f32_16x16x32_bf16 v[180:183], v[4:7], v[204:207], 0
    ds_read_b128 v[212:215], v245 offset:9216
    v_mov_b32 v193, v192
    v_mfma_f32_16x16x32_bf16 v[168:171], a[0:3], v[204:207], 0
    s_nop 0
    v_permlane16_swap_b32 v192, v193
    v_mfma_f32_16x16x32_bf16 v[172:175], a[80:83], v[204:207], 0
    v_max_f32 v192, v192, v193
    v_mov_b32 v193, v192
    v_mfma_f32_16x16x32_bf16 v[176:179], v[204:207], a[160:163], 0
    s_waitcnt lgkmcnt(1)
    v_permlane32_swap_b32 v192, v193
    v_mfma_f32_16x16x32_bf16 v[180:183], v[8:11], v[208:211], v[180:183]
    ds_read_b128 v[204:207], v246 offset:9216
    v_max_f32 v192, v192, v193
    v_mfma_f32_16x16x32_bf16 v[168:171], a[4:7], v[208:211], v[168:171]
    v_mul_f32 v192, s77, v192
    v_fma_f32 v184, v184, s77, -v192
    v_mfma_f32_16x16x32_bf16 v[172:175], a[84:87], v[208:211], v[172:175]
    v_fma_f32 v185, v185, s77, -v192
    v_fma_f32 v186, v186, s77, -v192
    v_mfma_f32_16x16x32_bf16 v[176:179], v[208:211], a[164:167], v[176:179]
    s_waitcnt lgkmcnt(1)
    v_fma_f32 v187, v187, s77, -v192
    v_fma_f32 v188, v188, s77, -v192
    v_mfma_f32_16x16x32_bf16 v[180:183], v[12:15], v[212:215], v[180:183]
    ds_read_b128 v[208:211], v245 offset:10240
    v_fma_f32 v189, v189, s77, -v192
    v_mfma_f32_16x16x32_bf16 v[168:171], a[8:11], v[212:215], v[168:171]
    v_fma_f32 v190, v190, s77, -v192
    v_fma_f32 v191, v191, s77, -v192
    v_mfma_f32_16x16x32_bf16 v[172:175], a[88:91], v[212:215], v[172:175]
    v_exp_f32 v184, v184
    v_mfma_f32_16x16x32_bf16 v[176:179], v[212:215], a[168:171], v[176:179]
    s_waitcnt lgkmcnt(1)
    v_exp_f32 v185, v185
    v_mfma_f32_16x16x32_bf16 v[180:183], v[16:19], v[204:207], v[180:183]
    ds_read_b128 v[212:215], v246 offset:10240
    v_mfma_f32_16x16x32_bf16 v[168:171], a[12:15], v[204:207], v[168:171]
    v_exp_f32 v186, v186
    v_mfma_f32_16x16x32_bf16 v[172:175], a[92:95], v[204:207], v[172:175]
    v_exp_f32 v187, v187
    v_mfma_f32_16x16x32_bf16 v[176:179], v[204:207], a[172:175], v[176:179]
    s_waitcnt lgkmcnt(1)
    v_exp_f32 v188, v188
    v_mfma_f32_16x16x32_bf16 v[180:183], v[20:23], v[208:211], v[180:183]
    ds_read_b128 v[204:207], v245 offset:11264
    v_mfma_f32_16x16x32_bf16 v[168:171], a[16:19], v[208:211], v[168:171]
    v_exp_f32 v189, v189
    v_mfma_f32_16x16x32_bf16 v[172:175], a[96:99], v[208:211], v[172:175]
    v_exp_f32 v190, v190
    v_mfma_f32_16x16x32_bf16 v[176:179], v[208:211], a[176:179], v[176:179]
    s_waitcnt lgkmcnt(1)
    v_exp_f32 v191, v191
    v_mfma_f32_16x16x32_bf16 v[180:183], v[24:27], v[212:215], v[180:183]
    ds_read_b128 v[208:211], v246 offset:11264
    v_cvt_pk_bf16_f32 v184, v184, v185
    v_mfma_f32_16x16x32_bf16 v[168:171], a[20:23], v[212:215], v[168:171]
    v_cvt_pk_bf16_f32 v185, v186, v187
    v_cvt_pk_bf16_f32 v186, v188, v189
    v_mfma_f32_16x16x32_bf16 v[172:175], a[100:103], v[212:215], v[172:175]
    v_cvt_pk_bf16_f32 v187, v190, v191
    s_nop 0
    v_mfma_f32_16x16x32_bf16 v[176:179], v[212:215], a[180:183], v[176:179]
    v_mfma_f32_16x16x32_bf16 v[200:203], v[236:239], v[184:187], 0
    s_nop 2
    v_mfma_f32_16x16x32_bf16 v[196:199], v[232:235], v[184:187], 0
    s_waitcnt vmcnt(0)
    s_cmp_eq_u32 s80, 0
    s_cbranch_scc1 Lowed_94
    s_waitcnt vmcnt(0)
    v_mov_b32 v2, s62
    s_mov_b64 exec, 1
    buffer_store_dword v2, off, s[4:7], s63 sc1
    buffer_store_dword v2, off, s[4:7], s3
    s_mov_b64 exec, -1
    s_mov_b32 s80, 0
Lowed_94:
    s_add_u32 s65, s62, s75
    s_add_u32 s65, s65, 3
    v_cmp_gt_u32 vcc, s65, v254
    s_cbranch_vccz Lpre_95
    s_waitcnt lgkmcnt(1)
    v_mfma_f32_16x16x32_bf16 v[180:183], v[28:31], v[204:207], v[180:183]
    ds_read_b128 v[212:215], v245 offset:12288
    v_mfma_f32_16x16x32_bf16 v[168:171], a[24:27], v[204:207], v[168:171]
    v_rcp_f32 v201, v201
    v_mfma_f32_16x16x32_bf16 v[172:175], a[104:107], v[204:207], v[172:175]
    v_mul_f32 v200, v200, v201
    v_mul_f32 v196, v196, v201
    v_mfma_f32_16x16x32_bf16 v[176:179], v[204:207], a[184:187], v[176:179]
    s_waitcnt lgkmcnt(1)
    v_mul_f32 v197, v197, v201
    v_mul_f32 v198, v198, v201
    v_mfma_f32_16x16x32_bf16 v[180:183], v[32:35], v[208:211], v[180:183]
    ds_read_b128 v[204:207], v246 offset:12288
    v_mul_f32 v199, v199, v201
    v_mfma_f32_16x16x32_bf16 v[168:171], a[28:31], v[208:211], v[168:171]
    v_cvt_pk_bf16_f32 v200, v200, v200
    v_cvt_pk_bf16_f32 v196, v196, v197
    v_mfma_f32_16x16x32_bf16 v[172:175], a[108:111], v[208:211], v[172:175]
    v_cvt_pk_bf16_f32 v197, v198, v199
    v_mfma_f32_16x16x32_bf16 v[176:179], v[208:211], a[188:191], v[176:179]
    ds_write_b16 v250, v200 offset:2048
Lback_96:
    s_waitcnt lgkmcnt(2)
    v_mfma_f32_16x16x32_bf16 v[180:183], v[36:39], v[212:215], v[180:183]
    ds_read_b128 v[208:211], v245 offset:13312
    v_mfma_f32_16x16x32_bf16 v[168:171], a[32:35], v[212:215], v[168:171]
    ds_write_b64 v249, v[196:197] offset:0
    v_mfma_f32_16x16x32_bf16 v[172:175], a[112:115], v[212:215], v[172:175]
    v_mfma_f32_16x16x32_bf16 v[176:179], v[212:215], a[192:195], v[176:179]
    s_waitcnt lgkmcnt(3)
    v_mfma_f32_16x16x32_bf16 v[180:183], v[40:43], v[204:207], v[180:183]
    ds_read_b128 v[212:215], v246 offset:13312
    v_mfma_f32_16x16x32_bf16 v[168:171], a[36:39], v[204:207], v[168:171]
    v_mfma_f32_16x16x32_bf16 v[172:175], a[116:119], v[204:207], v[172:175]
    s_waitcnt lgkmcnt(1)
    s_barrier
    ds_read_b64 v[240:241], v255 offset:2048
    ds_read_b128 v[220:223], v247 offset:0
    v_mfma_f32_16x16x32_bf16 v[176:179], v[204:207], a[196:199], v[176:179]
    ds_read_b128 v[216:219], v247 offset:1024
    v_mfma_f32_16x16x32_bf16 v[180:183], v[44:47], v[208:211], v[180:183]
    ds_read_b128 v[204:207], v245 offset:14336
    v_mfma_f32_16x16x32_bf16 v[168:171], a[40:43], v[208:211], v[168:171]
    v_mfma_f32_16x16x32_bf16 v[172:175], a[120:123], v[208:211], v[172:175]
    v_mfma_f32_16x16x32_bf16 v[176:179], v[208:211], a[200:203], v[176:179]
    s_waitcnt lgkmcnt(3)
    v_mfma_f32_16x16x16_bf16 v[184:187], a[240:241], v[240:241], 0
    v_mfma_f32_16x16x16_bf16 v[188:191], a[242:243], v[240:241], 0
    v_mfma_f32_16x16x16_bf16 v[192:195], a[244:245], v[240:241], 0
    v_mfma_f32_16x16x16_bf16 v[196:199], a[246:247], v[240:241], 0
    v_mfma_f32_16x16x16_bf16 v[200:203], a[248:249], v[240:241], 0
    v_mfma_f32_16x16x32_bf16 v[180:183], v[48:51], v[212:215], v[180:183]
    ds_read_b128 v[208:211], v246 offset:14336
    v_mfma_f32_16x16x32_bf16 v[168:171], a[44:47], v[212:215], v[168:171]
    v_mfma_f32_16x16x32_bf16 v[172:175], a[124:127], v[212:215], v[172:175]
    v_mfma_f32_16x16x32_bf16 v[176:179], v[212:215], a[204:207], v[176:179]
    s_waitcnt lgkmcnt(3)
    v_mfma_f32_16x16x32_bf16 v[184:187], v[84:87], v[220:223], v[184:187]
    v_mfma_f32_16x16x32_bf16 v[188:191], v[92:95], v[220:223], v[188:191]
    s_waitcnt lgkmcnt(2)
    v_mfma_f32_16x16x32_bf16 v[184:187], v[88:91], v[216:219], v[184:187]
    s_nop 2
    v_mfma_f32_16x16x32_bf16 v[188:191], v[96:99], v[216:219], v[188:191]
    s_nop 2
    v_mfma_f32_16x16x32_bf16 v[192:195], v[100:103], v[220:223], v[192:195]
    v_cvt_pk_bf16_f32 v184, v184, v185
    v_cvt_pk_bf16_f32 v185, v186, v187
    v_mfma_f32_16x16x32_bf16 v[196:199], v[108:111], v[220:223], v[196:199]
    s_nop 0
    v_cvt_pk_bf16_f32 v186, v188, v189
    v_cvt_pk_bf16_f32 v187, v190, v191
    v_mfma_f32_16x16x32_bf16 v[192:195], v[104:107], v[216:219], v[192:195]
    buffer_store_dwordx4 v[184:187], v251, s[4:7], s78 offen offset:0 sc1
    s_nop 4
    v_mfma_f32_16x16x32_bf16 v[196:199], v[112:115], v[216:219], v[196:199]
    s_nop 0
    v_cvt_pk_bf16_f32 v192, v192, v193
    v_cvt_pk_bf16_f32 v193, v194, v195
    v_mfma_f32_16x16x32_bf16 v[200:203], v[116:119], v[220:223], v[200:203]
    s_nop 2
    v_mfma_f32_16x16x32_bf16 v[200:203], v[120:123], v[216:219], v[200:203]
    v_cvt_pk_bf16_f32 v194, v196, v197
    v_cvt_pk_bf16_f32 v195, v198, v199
    s_waitcnt lgkmcnt(1)
    v_mfma_f32_16x16x32_bf16 v[180:183], v[52:55], v[204:207], v[180:183]
    ds_read_b128 v[212:215], v245 offset:15360
    v_mfma_f32_16x16x32_bf16 v[168:171], a[48:51], v[204:207], v[168:171]
    buffer_store_dwordx4 v[192:195], v251, s[4:7], s79 offen offset:0 sc1
    s_nop 0
    v_cvt_pk_bf16_f32 v200, v200, v201
    v_cvt_pk_bf16_f32 v201, v202, v203
    v_mfma_f32_16x16x32_bf16 v[172:175], a[128:131], v[204:207], v[172:175]
    buffer_store_dwordx2 v[200:201], v252, s[4:7], s73 offen offset:512 sc1
    v_mfma_f32_16x16x32_bf16 v[176:179], v[204:207], a[208:211], v[176:179]
    s_waitcnt lgkmcnt(1)
    v_mfma_f32_16x16x32_bf16 v[180:183], v[56:59], v[208:211], v[180:183]
    ds_read_b128 v[204:207], v246 offset:15360
    v_mfma_f32_16x16x32_bf16 v[168:171], a[52:55], v[208:211], v[168:171]
    v_mfma_f32_16x16x32_bf16 v[172:175], a[132:135], v[208:211], v[172:175]
    v_mfma_f32_16x16x32_bf16 v[176:179], v[208:211], a[212:215], v[176:179]
    v_mfma_f32_16x16x16_bf16 v[184:187], a[250:251], v[240:241], 0
    v_mfma_f32_16x16x16_bf16 v[188:191], a[252:253], v[240:241], 0
    v_mfma_f32_16x16x16_bf16 v[192:195], a[254:255], v[240:241], 0
    v_mfma_f32_16x16x16_bf16 v[196:199], v[164:165], v[240:241], 0
    v_mfma_f32_16x16x16_bf16 v[200:203], v[166:167], v[240:241], 0
    s_waitcnt lgkmcnt(1)
    v_mfma_f32_16x16x32_bf16 v[180:183], v[60:63], v[212:215], v[180:183]
    ds_read_b128 v[208:211], v245 offset:16384
    v_mfma_f32_16x16x32_bf16 v[168:171], a[56:59], v[212:215], v[168:171]
    v_mfma_f32_16x16x32_bf16 v[172:175], a[136:139], v[212:215], v[172:175]
    v_mfma_f32_16x16x32_bf16 v[176:179], v[212:215], a[216:219], v[176:179]
    v_mfma_f32_16x16x32_bf16 v[184:187], v[124:127], v[220:223], v[184:187]
    v_mfma_f32_16x16x32_bf16 v[188:191], v[132:135], v[220:223], v[188:191]
    v_mfma_f32_16x16x32_bf16 v[184:187], v[128:131], v[216:219], v[184:187]
    s_nop 2
    v_mfma_f32_16x16x32_bf16 v[188:191], v[136:139], v[216:219], v[188:191]
    s_nop 2
    v_mfma_f32_16x16x32_bf16 v[192:195], v[140:143], v[220:223], v[192:195]
    v_cvt_pk_bf16_f32 v184, v184, v185
    v_cvt_pk_bf16_f32 v185, v186, v187
    v_mfma_f32_16x16x32_bf16 v[196:199], v[148:151], v[220:223], v[196:199]
    s_nop 0
    v_cvt_pk_bf16_f32 v186, v188, v189
    v_cvt_pk_bf16_f32 v187, v190, v191
    v_mfma_f32_16x16x32_bf16 v[192:195], v[144:147], v[216:219], v[192:195]
    buffer_store_dwordx4 v[184:187], v251, s[4:7], s78 offen offset:1024 sc1
    s_nop 4
    v_mfma_f32_16x16x32_bf16 v[196:199], v[152:155], v[216:219], v[196:199]
    s_nop 0
    v_cvt_pk_bf16_f32 v192, v192, v193
    v_cvt_pk_bf16_f32 v193, v194, v195
    v_mfma_f32_16x16x32_bf16 v[200:203], v[156:159], v[220:223], v[200:203]
    s_nop 2
    v_mfma_f32_16x16x32_bf16 v[200:203], v[160:163], v[216:219], v[200:203]
    v_cvt_pk_bf16_f32 v194, v196, v197
    v_cvt_pk_bf16_f32 v195, v198, v199
    s_waitcnt lgkmcnt(1)
    v_mfma_f32_16x16x32_bf16 v[180:183], v[64:67], v[204:207], v[180:183]
    ds_read_b128 v[212:215], v246 offset:16384
    v_mfma_f32_16x16x32_bf16 v[168:171], a[60:63], v[204:207], v[168:171]
    buffer_store_dwordx4 v[192:195], v251, s[4:7], s79 offen offset:1024 sc1
    s_nop 0
    v_cvt_pk_bf16_f32 v200, v200, v201
    v_cvt_pk_bf16_f32 v201, v202, v203
    v_mfma_f32_16x16x32_bf16 v[172:175], a[140:143], v[204:207], v[172:175]
    buffer_store_dwordx2 v[200:201], v252, s[4:7], s73 offen offset:1536 sc1
    ds_read_b128 v[184:187], v248 offset:5120
    ds_read_b128 v[188:191], v247 offset:6144
    v_mfma_f32_16x16x32_bf16 v[176:179], v[204:207], a[220:223], v[176:179]
    s_waitcnt lgkmcnt(3)
    v_mfma_f32_16x16x32_bf16 v[180:183], v[68:71], v[208:211], v[180:183]
    ds_read_b128 v[204:207], v245 offset:17408
    v_mfma_f32_16x16x32_bf16 v[168:171], a[64:67], v[208:211], v[168:171]
    v_mfma_f32_16x16x32_bf16 v[172:175], a[144:147], v[208:211], v[172:175]
    v_mfma_f32_16x16x32_bf16 v[176:179], v[208:211], a[224:227], v[176:179]
    s_waitcnt lgkmcnt(3)
    v_mfma_f32_16x16x32_bf16 v[180:183], v[72:75], v[212:215], v[180:183]
    ds_read_b128 v[208:211], v246 offset:17408
    v_mfma_f32_16x16x32_bf16 v[168:171], a[68:71], v[212:215], v[168:171]
    v_mfma_f32_16x16x32_bf16 v[172:175], a[148:151], v[212:215], v[172:175]
    v_mfma_f32_16x16x32_bf16 v[176:179], v[212:215], a[228:231], v[176:179]
    s_waitcnt lgkmcnt(1)
    v_mfma_f32_16x16x32_bf16 v[180:183], v[76:79], v[204:207], v[180:183]
    v_mfma_f32_16x16x32_bf16 v[168:171], a[72:75], v[204:207], v[168:171]
    v_mfma_f32_16x16x32_bf16 v[172:175], a[152:155], v[204:207], v[172:175]
    v_mfma_f32_16x16x32_bf16 v[176:179], v[204:207], a[232:235], v[176:179]
    s_waitcnt lgkmcnt(0)
    v_mfma_f32_16x16x32_bf16 v[180:183], v[80:83], v[208:211], v[180:183]
    s_nop 2
    v_mfma_f32_16x16x32_bf16 v[168:171], a[76:79], v[208:211], v[168:171]
    s_nop 2
    v_mfma_f32_16x16x32_bf16 v[172:175], a[156:159], v[208:211], v[172:175]
    s_nop 2
    v_mfma_f32_16x16x32_bf16 v[176:179], v[208:211], a[236:239], v[176:179]
    s_add_u32 s62, s62, 1
    s_mov_b32 s80, 1
    s_waitcnt vmcnt(6)
    s_branch L_Be0
Lgrty_69:
    s_sleep 16
    buffer_load_dword v2, off, s[8:11], 0 offset:132 sc1
    s_sub_u32 s61, s61, 1
    s_mov_b32 s67, 1
    s_cbranch_scc1 L_fail
    s_branch Lgchk_68
Lprty_72:
    s_sleep 16
    buffer_load_dword v2, off, s[8:11], 0 offset:140 sc1
    s_sub_u32 s61, s61, 1
    s_mov_b32 s67, 16
    s_cbranch_scc1 L_fail
    s_branch Lpchk_71
Lfrty_75:
    s_sleep 2
    buffer_load_dword v254, v253, s[4:7], 0 offen sc1
    s_sub_u32 s61, s61, 1
    s_mov_b32 s67, 30
    s_cbranch_scc1 L_fail
    s_waitcnt vmcnt(0)
    s_branch Lfchk_74
Lpre_77:
    s_waitcnt lgkmcnt(1)
    v_mfma_f32_16x16x32_bf16 v[180:183], v[44:47], v[208:211], v[180:183]
    s_movk_i32 s75, 1000
    s_add_u32 m0, s74, 28672
    s_add_u32 s64, s70, 36864
    ds_read_b128 v[204:207], v245 offset:14336
    ds_read_b128 v[184:187], v248 offset:5120
    v_mfma_f32_16x16x32_bf16 v[168:171], a[40:43], v[208:211], v[168:171]
    buffer_load_dwordx4 v244, s[4:7], s64 offen sc1 lds
    s_add_u32 m0, s74, 32768
    s_add_u32 s64, s70, 49152
    ds_read_b128 v[188:191], v247 offset:6144
    v_mfma_f32_16x16x32_bf16 v[172:175], a[120:123], v[208:211], v[172:175]
    buffer_load_dwordx4 v244, s[4:7], s64 offen sc1 lds
    s_add_u32 m0, s74, 36864
    s_add_u32 s64, s70, 53248
    v_mfma_f32_16x16x32_bf16 v[176:179], v[208:211], a[200:203], v[176:179]
    buffer_load_dwordx4 v244, s[4:7], s64 offen sc1 lds
    s_add_u32 m0, s74, 40960
    s_add_u32 s64, s70, 65536
    s_waitcnt lgkmcnt(3)
    v_mfma_f32_16x16x32_bf16 v[180:183], v[48:51], v[212:215], v[180:183]
    buffer_load_dwordx4 v244, s[4:7], s64 offen sc1 lds
    s_add_u32 m0, s74, 45056
    s_add_u32 s64, s70, 69632
    ds_read_b128 v[208:211], v246 offset:14336
    v_mfma_f32_16x16x32_bf16 v[168:171], a[44:47], v[212:215], v[168:171]
    buffer_load_dwordx4 v244, s[4:7], s64 offen sc1 lds
    s_add_u32 s71, s71, 131072
    s_lshr_b32 s70, s71, 8
    v_mfma_f32_16x16x32_bf16 v[172:175], a[124:127], v[212:215], v[172:175]
    s_xor_b32 s70, s70, s1
    s_and_b32 s70, s70, 0x2000
    s_or_b32 s70, s70, s71
    v_mfma_f32_16x16x32_bf16 v[176:179], v[212:215], a[204:207], v[176:179]
    s_waitcnt lgkmcnt(3)
    v_mfma_f32_16x16x32_bf16 v[180:183], v[52:55], v[204:207], v[180:183]
    ds_read_b128 v[212:215], v245 offset:15360
    v_mfma_f32_16x16x32_bf16 v[168:171], a[48:51], v[204:207], v[168:171]
    v_mfma_f32_16x16x32_bf16 v[172:175], a[128:131], v[204:207], v[172:175]
    v_mfma_f32_16x16x32_bf16 v[176:179], v[204:207], a[208:211], v[176:179]
    s_waitcnt lgkmcnt(1)
    v_mfma_f32_16x16x32_bf16 v[180:183], v[56:59], v[208:211], v[180:183]
    ds_read_b128 v[204:207], v246 offset:15360
    v_mfma_f32_16x16x32_bf16 v[168:171], a[52:55], v[208:211], v[168:171]
    v_mfma_f32_16x16x32_bf16 v[172:175], a[132:135], v[208:211], v[172:175]
    v_mfma_f32_16x16x32_bf16 v[176:179], v[208:211], a[212:215], v[176:179]
    s_waitcnt lgkmcnt(1)
    v_mfma_f32_16x16x32_bf16 v[180:183], v[60:63], v[212:215], v[180:183]
    ds_read_b128 v[208:211], v245 offset:16384
    v_mfma_f32_16x16x32_bf16 v[168:171], a[56:59], v[212:215], v[168:171]
    v_mfma_f32_16x16x32_bf16 v[172:175], a[136:139], v[212:215], v[172:175]
    v_mfma_f32_16x16x32_bf16 v[176:179], v[212:215], a[216:219], v[176:179]
    s_waitcnt lgkmcnt(1)
    v_mfma_f32_16x16x32_bf16 v[180:183], v[64:67], v[204:207], v[180:183]
    ds_read_b128 v[212:215], v246 offset:16384
    v_mfma_f32_16x16x32_bf16 v[168:171], a[60:63], v[204:207], v[168:171]
    v_mfma_f32_16x16x32_bf16 v[172:175], a[140:143], v[204:207], v[172:175]
    v_mfma_f32_16x16x32_bf16 v[176:179], v[204:207], a[220:223], v[176:179]
    s_waitcnt lgkmcnt(1)
    v_mfma_f32_16x16x32_bf16 v[180:183], v[68:71], v[208:211], v[180:183]
    ds_read_b128 v[204:207], v245 offset:17408
    v_mfma_f32_16x16x32_bf16 v[168:171], a[64:67], v[208:211], v[168:171]
    v_mfma_f32_16x16x32_bf16 v[172:175], a[144:147], v[208:211], v[172:175]
    v_mfma_f32_16x16x32_bf16 v[176:179], v[208:211], a[224:227], v[176:179]
    s_waitcnt lgkmcnt(1)
    v_mfma_f32_16x16x32_bf16 v[180:183], v[72:75], v[212:215], v[180:183]
    ds_read_b128 v[208:211], v246 offset:17408
    v_mfma_f32_16x16x32_bf16 v[168:171], a[68:71], v[212:215], v[168:171]
    v_mfma_f32_16x16x32_bf16 v[172:175], a[148:151], v[212:215], v[172:175]
    v_mfma_f32_16x16x32_bf16 v[176:179], v[212:215], a[228:231], v[176:179]
    s_waitcnt lgkmcnt(1)
    v_mfma_f32_16x16x32_bf16 v[180:183], v[76:79], v[204:207], v[180:183]
    v_mfma_f32_16x16x32_bf16 v[168:171], a[72:75], v[204:207], v[168:171]
    v_mfma_f32_16x16x32_bf16 v[172:175], a[152:155], v[204:207], v[172:175]
    v_mfma_f32_16x16x32_bf16 v[176:179], v[204:207], a[232:235], v[176:179]
    s_waitcnt lgkmcnt(0)
    v_mfma_f32_16x16x32_bf16 v[180:183], v[80:83], v[208:211], v[180:183]
    s_nop 2
    v_mfma_f32_16x16x32_bf16 v[168:171], a[76:79], v[208:211], v[168:171]
    s_nop 2
    v_mfma_f32_16x16x32_bf16 v[172:175], a[156:159], v[208:211], v[172:175]
    s_nop 2
    v_mfma_f32_16x16x32_bf16 v[176:179], v[208:211], a[236:239], v[176:179]
    s_branch Lback_78
Lpre_80:
    s_waitcnt lgkmcnt(2)
    v_mfma_f32_16x16x16_bf16 v[168:171], a[240:241], v[240:241], 0
    s_movk_i32 s75, 1000
    s_add_u32 m0, s74, 28672
    s_add_u32 s64, s70, 36864
    v_mfma_f32_16x16x16_bf16 v[172:175], a[242:243], v[240:241], 0
    buffer_load_dwordx4 v244, s[4:7], s64 offen sc1 lds
    s_add_u32 m0, s74, 32768
    s_add_u32 s64, s70, 49152
    v_mfma_f32_16x16x16_bf16 v[176:179], a[244:245], v[240:241], 0
    buffer_load_dwordx4 v244, s[4:7], s64 offen sc1 lds
    s_add_u32 m0, s74, 36864
    s_add_u32 s64, s70, 53248
    v_mfma_f32_16x16x16_bf16 v[180:183], a[246:247], v[240:241], 0
    buffer_load_dwordx4 v244, s[4:7], s64 offen sc1 lds
    s_add_u32 m0, s74, 40960
    s_add_u32 s64, s70, 65536
    v_mfma_f32_16x16x16_bf16 v[204:207], a[248:249], v[240:241], 0
    buffer_load_dwordx4 v244, s[4:7], s64 offen sc1 lds
    s_add_u32 m0, s74, 45056
    s_add_u32 s64, s70, 69632
    v_mfma_f32_16x16x16_bf16 v[184:187], a[250:251], v[240:241], 0
    buffer_load_dwordx4 v244, s[4:7], s64 offen sc1 lds
    s_add_u32 s71, s71, 131072
    s_lshr_b32 s70, s71, 8
    v_mfma_f32_16x16x16_bf16 v[188:191], a[252:253], v[240:241], 0
    s_xor_b32 s70, s70, s1
    s_and_b32 s70, s70, 0x2000
    s_or_b32 s70, s70, s71
    v_mfma_f32_16x16x16_bf16 v[192:195], a[254:255], v[240:241], 0
    v_mfma_f32_16x16x16_bf16 v[196:199], v[164:165], v[240:241], 0
    v_mfma_f32_16x16x16_bf16 v[200:203], v[166:167], v[240:241], 0
    s_branch Lback_81
Lfrty_84:
    s_sleep 2
    buffer_load_dword v254, v253, s[4:7], 0 offen sc1
    s_sub_u32 s61, s61, 1
    s_mov_b32 s67, 30
    s_cbranch_scc1 L_fail
    s_waitcnt vmcnt(0)
    s_branch Lfchk_83
Lpre_86:
    s_waitcnt lgkmcnt(1)
    v_mfma_f32_16x16x32_bf16 v[180:183], v[44:47], v[208:211], v[180:183]
    s_movk_i32 s75, 1000
    s_add_u32 m0, s74, 8192
    s_add_u32 s64, s70, 0
    ds_read_b128 v[204:207], v245 offset:34816
    ds_read_b128 v[188:191], v247 offset:5120
    v_mfma_f32_16x16x32_bf16 v[168:171], a[40:43], v[208:211], v[168:171]
    buffer_load_dwordx4 v244, s[4:7], s64 offen sc1 lds
    s_add_u32 m0, s74, 12288
    s_add_u32 s64, s70, 4096
    ds_read_b128 v[184:187], v247 offset:6144
    v_mfma_f32_16x16x32_bf16 v[172:175], a[120:123], v[208:211], v[172:175]
    buffer_load_dwordx4 v244, s[4:7], s64 offen sc1 lds
    s_add_u32 m0, s74, 16384
    s_add_u32 s64, s70, 16384
    v_mfma_f32_16x16x32_bf16 v[176:179], v[208:211], a[200:203], v[176:179]
    buffer_load_dwordx4 v244, s[4:7], s64 offen sc1 lds
    s_add_u32 m0, s74, 20480
    s_add_u32 s64, s70, 20480
    s_waitcnt lgkmcnt(3)
    v_mfma_f32_16x16x32_bf16 v[180:183], v[48:51], v[212:215], v[180:183]
    buffer_load_dwordx4 v244, s[4:7], s64 offen sc1 lds
    s_add_u32 m0, s74, 24576
    s_add_u32 s64, s70, 32768
    ds_read_b128 v[208:211], v246 offset:34816
    v_mfma_f32_16x16x32_bf16 v[168:171], a[44:47], v[212:215], v[168:171]
    buffer_load_dwordx4 v244, s[4:7], s64 offen sc1 lds
    v_mfma_f32_16x16x32_bf16 v[172:175], a[124:127], v[212:215], v[172:175]
    v_mfma_f32_16x16x32_bf16 v[176:179], v[212:215], a[204:207], v[176:179]
    s_waitcnt lgkmcnt(3)
    v_mfma_f32_16x16x32_bf16 v[180:183], v[52:55], v[204:207], v[180:183]
    ds_read_b128 v[212:215], v245 offset:35840
    v_mfma_f32_16x16x32_bf16 v[168:171], a[48:51], v[204:207], v[168:171]
    v_mfma_f32_16x16x32_bf16 v[172:175], a[128:131], v[204:207], v[172:175]
    v_mfma_f32_16x16x32_bf16 v[176:179], v[204:207], a[208:211], v[176:179]
    s_waitcnt lgkmcnt(1)
    v_mfma_f32_16x16x32_bf16 v[180:183], v[56:59], v[208:211], v[180:183]
    ds_read_b128 v[204:207], v246 offset:35840
    v_mfma_f32_16x16x32_bf16 v[168:171], a[52:55], v[208:211], v[168:171]
    v_mfma_f32_16x16x32_bf16 v[172:175], a[132:135], v[208:211], v[172:175]
    v_mfma_f32_16x16x32_bf16 v[176:179], v[208:211], a[212:215], v[176:179]
    s_waitcnt lgkmcnt(1)
    v_mfma_f32_16x16x32_bf16 v[180:183], v[60:63], v[212:215], v[180:183]
    ds_read_b128 v[208:211], v245 offset:36864
    v_mfma_f32_16x16x32_bf16 v[168:171], a[56:59], v[212:215], v[168:171]
    v_mfma_f32_16x16x32_bf16 v[172:175], a[136:139], v[212:215], v[172:175]
    v_mfma_f32_16x16x32_bf16 v[176:179], v[212:215], a[216:219], v[176:179]
    s_waitcnt lgkmcnt(1)
    v_mfma_f32_16x16x32_bf16 v[180:183], v[64:67], v[204:207], v[180:183]
    ds_read_b128 v[212:215], v246 offset:36864
    v_mfma_f32_16x16x32_bf16 v[168:171], a[60:63], v[204:207], v[168:171]
    v_mfma_f32_16x16x32_bf16 v[172:175], a[140:143], v[204:207], v[172:175]
    v_mfma_f32_16x16x32_bf16 v[176:179], v[204:207], a[220:223], v[176:179]
    s_waitcnt lgkmcnt(1)
    v_mfma_f32_16x16x32_bf16 v[180:183], v[68:71], v[208:211], v[180:183]
    ds_read_b128 v[204:207], v245 offset:37888
    v_mfma_f32_16x16x32_bf16 v[168:171], a[64:67], v[208:211], v[168:171]
    v_mfma_f32_16x16x32_bf16 v[172:175], a[144:147], v[208:211], v[172:175]
    v_mfma_f32_16x16x32_bf16 v[176:179], v[208:211], a[224:227], v[176:179]
    s_waitcnt lgkmcnt(1)
    v_mfma_f32_16x16x32_bf16 v[180:183], v[72:75], v[212:215], v[180:183]
    ds_read_b128 v[208:211], v246 offset:37888
    v_mfma_f32_16x16x32_bf16 v[168:171], a[68:71], v[212:215], v[168:171]
    v_mfma_f32_16x16x32_bf16 v[172:175], a[148:151], v[212:215], v[172:175]
    v_mfma_f32_16x16x32_bf16 v[176:179], v[212:215], a[228:231], v[176:179]
    s_waitcnt lgkmcnt(1)
    v_mfma_f32_16x16x32_bf16 v[180:183], v[76:79], v[204:207], v[180:183]
    v_mfma_f32_16x16x32_bf16 v[168:171], a[72:75], v[204:207], v[168:171]
    v_mfma_f32_16x16x32_bf16 v[172:175], a[152:155], v[204:207], v[172:175]
    v_mfma_f32_16x16x32_bf16 v[176:179], v[204:207], a[232:235], v[176:179]
    s_waitcnt lgkmcnt(0)
    v_mfma_f32_16x16x32_bf16 v[180:183], v[80:83], v[208:211], v[180:183]
    s_nop 2
    v_mfma_f32_16x16x32_bf16 v[168:171], a[76:79], v[208:211], v[168:171]
    s_nop 2
    v_mfma_f32_16x16x32_bf16 v[172:175], a[156:159], v[208:211], v[172:175]
    s_nop 2
    v_mfma_f32_16x16x32_bf16 v[176:179], v[208:211], a[236:239], v[176:179]
    s_branch Lback_87
Lpre_89:
    s_waitcnt lgkmcnt(2)
    v_mfma_f32_16x16x16_bf16 v[168:171], a[240:241], v[240:241], 0
    s_movk_i32 s75, 1000
    s_add_u32 m0, s74, 8192
    s_add_u32 s64, s70, 0
    v_mfma_f32_16x16x16_bf16 v[172:175], a[242:243], v[240:241], 0
    buffer_load_dwordx4 v244, s[4:7], s64 offen sc1 lds
    s_add_u32 m0, s74, 12288
    s_add_u32 s64, s70, 4096
    v_mfma_f32_16x16x16_bf16 v[176:179], a[244:245], v[240:241], 0
    buffer_load_dwordx4 v244, s[4:7], s64 offen sc1 lds
    s_add_u32 m0, s74, 16384
    s_add_u32 s64, s70, 16384
    v_mfma_f32_16x16x16_bf16 v[180:183], a[246:247], v[240:241], 0
    buffer_load_dwordx4 v244, s[4:7], s64 offen sc1 lds
    s_add_u32 m0, s74, 20480
    s_add_u32 s64, s70, 20480
    v_mfma_f32_16x16x16_bf16 v[204:207], a[248:249], v[240:241], 0
    buffer_load_dwordx4 v244, s[4:7], s64 offen sc1 lds
    s_add_u32 m0, s74, 24576
    s_add_u32 s64, s70, 32768
    v_mfma_f32_16x16x16_bf16 v[184:187], a[250:251], v[240:241], 0
    buffer_load_dwordx4 v244, s[4:7], s64 offen sc1 lds
    v_mfma_f32_16x16x16_bf16 v[188:191], a[252:253], v[240:241], 0
    v_mfma_f32_16x16x16_bf16 v[192:195], a[254:255], v[240:241], 0
    v_mfma_f32_16x16x16_bf16 v[196:199], v[164:165], v[240:241], 0
    v_mfma_f32_16x16x16_bf16 v[200:203], v[166:167], v[240:241], 0
    s_branch Lback_90
Lpre_92:
    s_waitcnt lgkmcnt(1)
    v_mfma_f32_16x16x32_bf16 v[180:183], v[28:31], v[204:207], v[180:183]
    s_movk_i32 s75, 1000
    s_add_u32 m0, s74, 8192
    s_add_u32 s64, s70, 0
    ds_read_b128 v[212:215], v245 offset:32768
    v_mfma_f32_16x16x32_bf16 v[168:171], a[24:27], v[204:207], v[168:171]
    buffer_load_dwordx4 v244, s[4:7], s64 offen sc1 lds
    s_add_u32 m0, s74, 12288
    s_add_u32 s64, s70, 4096
    v_rcp_f32 v201, v201
    v_mfma_f32_16x16x32_bf16 v[172:175], a[104:107], v[204:207], v[172:175]
    buffer_load_dwordx4 v244, s[4:7], s64 offen sc1 lds
    s_add_u32 m0, s74, 16384
    s_add_u32 s64, s70, 16384
    v_mul_f32 v200, v200, v201
    v_mul_f32 v196, v196, v201
    v_mfma_f32_16x16x32_bf16 v[176:179], v[204:207], a[184:187], v[176:179]
    buffer_load_dwordx4 v244, s[4:7], s64 offen sc1 lds
    s_add_u32 m0, s74, 20480
    s_add_u32 s64, s70, 20480
    s_waitcnt lgkmcnt(1)
    v_mul_f32 v197, v197, v201
    v_mul_f32 v198, v198, v201
    v_mfma_f32_16x16x32_bf16 v[180:183], v[32:35], v[208:211], v[180:183]
    buffer_load_dwordx4 v244, s[4:7], s64 offen sc1 lds
    s_add_u32 m0, s74, 24576
    s_add_u32 s64, s70, 32768
    ds_read_b128 v[204:207], v246 offset:32768
    v_mul_f32 v199, v199, v201
    v_mfma_f32_16x16x32_bf16 v[168:171], a[28:31], v[208:211], v[168:171]
    buffer_load_dwordx4 v244, s[4:7], s64 offen sc1 lds
    v_cvt_pk_bf16_f32 v200, v200, v200
    v_cvt_pk_bf16_f32 v196, v196, v197
    v_mfma_f32_16x16x32_bf16 v[172:175], a[108:111], v[208:211], v[172:175]
    v_cvt_pk_bf16_f32 v197, v198, v199
    v_mfma_f32_16x16x32_bf16 v[176:179], v[208:211], a[188:191], v[176:179]
    ds_write_b16 v250, v200 offset:2048
    s_branch Lback_93
Lpre_95:
    s_waitcnt lgkmcnt(1)
    v_mfma_f32_16x16x32_bf16 v[180:183], v[28:31], v[204:207], v[180:183]
    s_movk_i32 s75, 1000
    s_add_u32 m0, s74, 28672
    s_add_u32 s64, s70, 36864
    ds_read_b128 v[212:215], v245 offset:12288
    v_mfma_f32_16x16x32_bf16 v[168:171], a[24:27], v[204:207], v[168:171]
    buffer_load_dwordx4 v244, s[4:7], s64 offen sc1 lds
    s_add_u32 m0, s74, 32768
    s_add_u32 s64, s70, 49152
    v_rcp_f32 v201, v201
    v_mfma_f32_16x16x32_bf16 v[172:175], a[104:107], v[204:207], v[172:175]
    buffer_load_dwordx4 v244, s[4:7], s64 offen sc1 lds
    s_add_u32 m0, s74, 36864
    s_add_u32 s64, s70, 53248
    v_mul_f32 v200, v200, v201
    v_mul_f32 v196, v196, v201
    v_mfma_f32_16x16x32_bf16 v[176:179], v[204:207], a[184:187], v[176:179]
    buffer_load_dwordx4 v244, s[4:7], s64 offen sc1 lds
    s_add_u32 m0, s74, 40960
    s_add_u32 s64, s70, 65536
    s_waitcnt lgkmcnt(1)
    v_mul_f32 v197, v197, v201
    v_mul_f32 v198, v198, v201
    v_mfma_f32_16x16x32_bf16 v[180:183], v[32:35], v[208:211], v[180:183]
    buffer_load_dwordx4 v244, s[4:7], s64 offen sc1 lds
    s_add_u32 m0, s74, 45056
    s_add_u32 s64, s70, 69632
    ds_read_b128 v[204:207], v246 offset:12288
    v_mul_f32 v199, v199, v201
    v_mfma_f32_16x16x32_bf16 v[168:171], a[28:31], v[208:211], v[168:171]
    buffer_load_dwordx4 v244, s[4:7], s64 offen sc1 lds
    s_add_u32 s71, s71, 131072
    s_lshr_b32 s70, s71, 8
    v_cvt_pk_bf16_f32 v200, v200, v200
    v_cvt_pk_bf16_f32 v196, v196, v197
    v_mfma_f32_16x16x32_bf16 v[172:175], a[108:111], v[208:211], v[172:175]
    s_xor_b32 s70, s70, s1
    s_and_b32 s70, s70, 0x2000
    s_or_b32 s70, s70, s71
    v_cvt_pk_bf16_f32 v197, v198, v199
    v_mfma_f32_16x16x32_bf16 v[176:179], v[208:211], a[188:191], v[176:179]
    ds_write_b16 v250, v200 offset:2048
    s_branch Lback_96
L_roleR:
    s_cmp_lg_u32 s68, 0
    s_cbranch_scc1 Larr0_97
    s_waitcnt vmcnt(0)
    s_barrier
    s_cmp_lg_u32 s60, 0
    s_cbranch_scc1 Lcnt_98
    s_mov_b64 exec, 1
    v_mov_b32 v2, 1
    buffer_atomic_add v2, off, s[8:11], 0 offset:4 sc0
    v_mov_b32 v3, 0x80000000
    s_waitcnt vmcnt(0)
    v_cmp_ne_u32 vcc, 255, v2
    s_nop 1
    v_cndmask_b32 v3, 4, v3, vcc
    buffer_store_dword v2, v3, s[8:11], 0 offen offset:128 sc1
    s_mov_b64 exec, -1
Lcnt_98:
Larr0_97:
    s_and_b32 s64, s59, 1
    s_lshl_b32 s76, s68, 1
    s_add_u32 s76, s76, s64
    s_cmp_eq_u32 s76, 0
    s_cselect_b32 s16, s32, s56
    s_cselect_b32 s17, s33, s57
    s_cselect_b32 s18, 2621440, s6
    s_mov_b32 s19, 0x20000
    s_cmp_eq_u32 s76, 3
    s_cselect_b32 s20, s52, s56
    s_cselect_b32 s21, s53, s57
    s_cselect_b32 s22, 2621440, s6
    s_mov_b32 s23, 0x20000
    s_mov_b32 s72, 0
    s_mov_b32 s73, 50331648
    s_mov_b32 s74, 33554432
    s_cmp_eq_u32 s76, 1
    s_cselect_b32 s72, 50331648, s72
    s_cselect_b32 s73, 56623104, s73
    s_cselect_b32 s74, 25165824, s74
    s_cmp_eq_u32 s76, 2
    s_cselect_b32 s72, 56623104, s72
    s_cselect_b32 s73, 52953088, s73
    s_cselect_b32 s74, 41943040, s74
    s_cmp_eq_u32 s76, 3
    s_cselect_b32 s72, 52953088, s72
    s_cselect_b32 s73, 0, s73
    s_cselect_b32 s74, 0, s74
    s_cmp_eq_u32 s76, 1
    s_cselect_b32 s79, 0x2000, 0
    s_cmp_lg_u32 s60, 0
    s_cbranch_scc1 Lgskip_101
    buffer_load_dword v2, off, s[8:11], 0 offset:132 sc1
Lgchk_99:
    s_waitcnt vmcnt(0)
    v_cmp_eq_u32 vcc, 0, v2
    s_cbranch_vccnz Lgrty_100
Lgskip_101:
    s_waitcnt lgkmcnt(0)
    s_barrier
    buffer_load_dword v2, off, s[8:11], 0 offset:140 sc1
Lpchk_102:
    s_waitcnt vmcnt(0)
    v_cmp_eq_u32 vcc, 0, v2
    s_cbranch_vccnz Lprty_103
    v_readfirstlane_b32 s1, v2
    s_cmp_gt_u32 s1, 17
    s_cselect_b32 s1, 1, 0
    s_xor_b32 s1, s1, s68
    s_lshl_b32 s1, s1, 13
    s_lshl_b32 s63, s58, 18
    s_and_b32 s64, s3, 0xfff
    s_add_u32 s63, s63, s64
    s_add_u32 s63, s63, 14819328
    s_xor_b32 s63, s63, s1
    s_xor_b32 s63, s63, s79
    s_xor_b32 s79, s79, s1
    s_mov_b32 s71, 142606336
    s_bitcmp0_b32 s76, 0
    s_cselect_b32 s71, 75497472, s71
    s_cselect_b32 s65, 24, 28
    s_cselect_b32 s66, 15, 7
    v_and_b32 v100, s66, v0
    v_mov_b32 v65, s65
    v_lshl_add_u32 v100, v65, 2, v100
    v_lshlrev_b32 v100, 7, v100
    v_bfe_u32 v65, v0, 4, 2
    v_cmp_eq_u32 vcc, s69, v65
    s_xor_b32 s64, s1, 0x2000
    s_add_u32 s64, s64, 14798848
    v_lshl_add_u32 v65, v65, 18, s64
    s_lshl_b32 s64, s68, 20
    v_add_u32 v65, s64, v65
    s_lshl_b32 s64, s58, 14
    s_add_u32 s64, s64, 8388608
    v_mov_b32 v2, s64
    v_cndmask_b32 v65, v65, v2, vcc
    v_add_u32 v100, v100, v65
    v_and_b32 v64, 63, v0
    s_lshl_b32 s64, s69, 2
    s_add_u32 s64, s64, s60
    s_mul_i32 s65, s64, 1280
    v_lshl_add_u32 v94, v64, 4, s65
    v_lshl_add_u32 v95, v64, 2, s65
    v_bfe_u32 v65, v64, 2, 3
    v_lshlrev_b32 v90, 10, v65
    v_lshrrev_b32 v65, 5, v64
    v_lshl_add_u32 v90, v65, 15, v90
    v_and_b32 v65, 3, v64
    v_lshl_add_u32 v90, v65, 4, v90
    s_lshl_b32 s65, s64, 6
    v_add_u32 v90, s65, v90
    v_add_u32 v91, 16384, v90
    v_lshrrev_b32 v65, 3, v64
    v_lshlrev_b32 v92, 10, v65
    v_and_b32 v65, 7, v64
    v_lshl_add_u32 v92, v65, 2, v92
    s_lshl_b32 s65, s64, 5
    s_add_u32 s65, s65, 65536
    v_add_u32 v92, s65, v92
    v_add_u32 v93, 512, v92
    s_lshr_b32 s65, s64, 3
    s_mul_i32 s65, s65, 10
    s_and_b32 s64, s64, 7
    s_lshl_b32 s66, s64, 7
    v_lshrrev_b32 v65, 3, v64
    v_add3_u32 v96, v65, s65, 0
    v_lshrrev_b32 v65, 3, v96
    v_lshlrev_b32 v96, 10, v96
    v_lshl_add_u32 v96, v65, 13, v96
    v_and_b32 v65, 7, v64
    v_xor_b32 v65, s64, v65
    v_lshl_add_u32 v65, v65, 4, s66
    v_add_u32 v96, v96, v65
    v_lshrrev_b32 v65, 5, v64
    v_add3_u32 v98, v65, s65, 8
    v_lshrrev_b32 v65, 3, v98
    v_lshlrev_b32 v98, 10, v98
    v_lshl_add_u32 v98, v65, 13, v98
    v_bfe_u32 v65, v64, 2, 3
    v_xor_b32 v65, s64, v65
    v_lshl_add_u32 v65, v65, 4, s66
    v_and_b32 v66, 3, v64
    v_lshl_add_u32 v65, v66, 2, v65
    v_add_u32 v98, v98, v65
    v_lshrrev_b32 v65, 3, v64
    v_add3_u32 v97, v65, s65, 20
    v_lshrrev_b32 v65, 3, v97
    v_lshlrev_b32 v97, 10, v97
    v_lshl_add_u32 v97, v65, 13, v97
    v_and_b32 v65, 7, v64
    v_xor_b32 v65, s64, v65
    v_lshl_add_u32 v65, v65, 4, s66
    v_add_u32 v97, v97, v65
    v_lshrrev_b32 v65, 5, v64
    v_add3_u32 v99, v65, s65, 28
    v_lshrrev_b32 v65, 3, v99
    v_lshlrev_b32 v99, 10, v99
    v_lshl_add_u32 v99, v65, 13, v99
    v_bfe_u32 v65, v64, 2, 3
    v_xor_b32 v65, s64, v65
    v_lshl_add_u32 v65, v65, 4, s66
    v_and_b32 v66, 3, v64
    v_lshl_add_u32 v65, v66, 2, v65
    v_add_u32 v99, v99, v65
    v_bfe_u32 v65, v64, 2, 2
    v_lshrrev_b32 v66, 4, v64
    v_cmp_eq_u32 vcc, v65, v66
    v_and_b32 v65, 1, v64
    v_lshlrev_b32 v65, 4, v65
    v_mov_b32 v66, 0x3f80
    v_lshlrev_b32 v66, v65, v66
    v_cndmask_b32 v66, 0, v66, vcc
    v_and_b32 v65, 2, v64
    v_cmp_eq_u32 vcc, 0, v65
    s_nop 1
    v_cndmask_b32 v52, 0, v66, vcc
    v_xor_b32 v53, v52, v66
    v_mov_b32 v58, v52
    v_mov_b32 v59, v53
    v_mov_b32 v101, 0
    v_mov_b32 v54, 0
    v_mov_b32 v55, 0
    v_mov_b32 v56, 0
    v_mov_b32 v57, 0
    v_mov_b32 v49, 0
    v_mov_b32 v50, 0
    v_mov_b32 v51, 0
    v_mov_b32 v60, v52
    v_mov_b32 v61, v52
    v_mov_b32 v62, v52
    v_mov_b32 v63, v52
L_Rseg:
    s_add_u32 s65, s62, 1
    v_cmp_gt_u32 vcc, s65, v101
    s_cbranch_vccz L_Rpre0
    buffer_load_dword v101, v100, s[4:7], 0 offen sc1
    s_waitcnt vmcnt(0)
    v_mov_b32 v88, s62
    s_mov_b64 exec, 1
    buffer_store_dword v88, off, s[4:7], s63 sc1
    buffer_store_dword v88, off, s[4:7], s3
    s_mov_b64 exec, -1
Lfchk_104:
    v_cmp_gt_u32 vcc, s65, v101
    s_cbranch_vccnz Lfrty_105
    s_lshr_b32 s70, s71, 8
    s_xor_b32 s70, s70, s1
    s_and_b32 s70, s70, 0x2000
    s_or_b32 s70, s70, s71
    buffer_load_dwordx4 v[4:7], v90, s[4:7], s70 offen sc1
    buffer_load_dword v40, v92, s[4:7], s70 offen sc1
    s_add_u32 s70, s70, 81920
    buffer_load_dwordx4 v[8:11], v90, s[4:7], s70 offen sc1
    buffer_load_dword v41, v92, s[4:7], s70 offen sc1
    s_add_u32 s70, s70, 81920
    buffer_load_dwordx4 v[12:15], v90, s[4:7], s70 offen sc1
    buffer_load_dword v42, v92, s[4:7], s70 offen sc1
    s_add_u32 s70, s70, 81920
    buffer_load_dwordx4 v[16:19], v90, s[4:7], s70 offen sc1
    buffer_load_dword v43, v92, s[4:7], s70 offen sc1
    s_add_u32 s70, s70, 81920
    buffer_load_dwordx4 v[20:23], v90, s[4:7], s70 offen sc1
    buffer_load_dword v44, v92, s[4:7], s70 offen sc1
    s_add_u32 s70, s70, 81920
    buffer_load_dwordx4 v[24:27], v90, s[4:7], s70 offen sc1
    buffer_load_dword v45, v92, s[4:7], s70 offen sc1
    s_add_u32 s70, s70, 81920
    buffer_load_dwordx4 v[28:31], v90, s[4:7], s70 offen sc1
    buffer_load_dword v46, v92, s[4:7], s70 offen sc1
    s_add_u32 s70, s70, 81920
    buffer_load_dwordx4 v[32:35], v90, s[4:7], s70 offen sc1
    buffer_load_dword v47, v92, s[4:7], s70 offen sc1
    s_add_u32 s70, s70, 81920
    buffer_load_dwordx4 v[36:39], v94, s[16:19], s72 offen sc1
    buffer_load_dword v48, v95, s[16:19], s72 offen offset:1024 sc1
    s_add_u32 s72, s72, 20480
    s_waitcnt vmcnt(17)
    v_mfma_f32_16x16x32_bf16 v[64:67], v[52:55], v[4:7], 0
    v_mfma_f32_16x16x32_bf16 v[68:71], v[56:59], v[4:7], 0
    s_waitcnt vmcnt(15)
    v_mfma_f32_16x16x32_bf16 v[64:67], v[52:55], v[8:11], v[64:67]
    v_mfma_f32_16x16x32_bf16 v[68:71], v[56:59], v[8:11], v[68:71]
    s_waitcnt vmcnt(13)
    v_mfma_f32_16x16x32_bf16 v[64:67], v[52:55], v[12:15], v[64:67]
    v_mfma_f32_16x16x32_bf16 v[68:71], v[56:59], v[12:15], v[68:71]
    s_waitcnt vmcnt(11)
    v_mfma_f32_16x16x32_bf16 v[64:67], v[52:55], v[16:19], v[64:67]
    v_mfma_f32_16x16x32_bf16 v[68:71], v[56:59], v[16:19], v[68:71]
    s_waitcnt vmcnt(10)
    v_mfma_f32_16x16x32_bf16 v[72:75], v[60:63], v[40:43], 0
    s_waitcnt vmcnt(9)
    v_mfma_f32_16x16x32_bf16 v[64:67], v[52:55], v[20:23], v[64:67]
    v_mfma_f32_16x16x32_bf16 v[68:71], v[56:59], v[20:23], v[68:71]
    s_waitcnt vmcnt(7)
    v_mfma_f32_16x16x32_bf16 v[64:67], v[52:55], v[24:27], v[64:67]
    v_mfma_f32_16x16x32_bf16 v[68:71], v[56:59], v[24:27], v[68:71]
    s_waitcnt vmcnt(5)
    v_mfma_f32_16x16x32_bf16 v[64:67], v[52:55], v[28:31], v[64:67]
    v_mfma_f32_16x16x32_bf16 v[68:71], v[56:59], v[28:31], v[68:71]
    s_waitcnt vmcnt(3)
    v_mfma_f32_16x16x32_bf16 v[64:67], v[52:55], v[32:35], v[64:67]
    v_mfma_f32_16x16x32_bf16 v[68:71], v[56:59], v[32:35], v[68:71]
    s_waitcnt vmcnt(2)
    v_mfma_f32_16x16x32_bf16 v[72:75], v[60:63], v[44:47], v[72:75]
    s_waitcnt vmcnt(1)
    v_mfma_f32_16x16x32_bf16 v[64:67], v[52:55], v[36:39], v[64:67]
    v_mfma_f32_16x16x32_bf16 v[68:71], v[56:59], v[36:39], v[68:71]
    s_waitcnt vmcnt(0)
    v_mfma_f32_16x16x32_bf16 v[72:75], v[60:63], v[48:51], v[72:75]
L_Rsum0:
    buffer_load_dword v101, v100, s[4:7], 0 offen sc1
    s_lshr_b32 s75, s74, 8
    s_xor_b32 s75, s75, s79
    s_and_b32 s75, s75, 0x2000
    s_or_b32 s75, s75, s74
    v_cvt_pk_bf16_f32 v76, v64, v65
    v_cvt_pk_bf16_f32 v77, v66, v67
    v_cvt_pk_bf16_f32 v78, v68, v69
    v_cvt_pk_bf16_f32 v79, v70, v71
    v_cvt_pk_bf16_f32 v80, v72, v73
    buffer_store_dwordx4 v[76:79], v94, s[20:23], s73 offen sc1
    buffer_store_dword v80, v95, s[20:23], s73 offen offset:1024 sc1
    s_add_u32 s73, s73, 20480
    s_cmp_eq_u32 s76, 3
    s_cbranch_scc1 L_Rlast0
    v_lshlrev_b32 v64, 16, v76
    v_and_b32 v65, 0xffff0000, v76
    v_lshlrev_b32 v66, 16, v77
    v_and_b32 v67, 0xffff0000, v77
    v_lshlrev_b32 v68, 16, v78
    v_and_b32 v69, 0xffff0000, v78
    v_lshlrev_b32 v70, 16, v79
    v_and_b32 v71, 0xffff0000, v79
    v_lshlrev_b32 v72, 16, v80
    v_and_b32 v73, 0xffff0000, v80
    v_pk_add_f32 v[88:89], v[64:65], v[66:67]
    v_pk_add_f32 v[88:89], v[88:89], v[68:69]
    v_pk_add_f32 v[88:89], v[88:89], v[70:71]
    v_pk_add_f32 v[88:89], v[88:89], v[72:73]
    v_add_f32 v88, v88, v89
    s_nop 1
    v_add_f32_dpp v88, v88, v88 quad_perm:[1,0,3,2] row_mask:0xf bank_mask:0xf
    s_nop 1
    v_add_f32_dpp v88, v88, v88 quad_perm:[2,3,0,1] row_mask:0xf bank_mask:0xf
    s_nop 1
    v_add_f32_dpp v88, v88, v88 row_half_mirror row_mask:0xf bank_mask:0xf
    s_nop 1
    v_add_f32_dpp v88, v88, v88 row_mirror row_mask:0xf bank_mask:0xf
    v_mov_b32 v89, v88
    s_nop 1
    v_permlane16_swap_b32 v88, v89
    v_add_f32 v88, v88, v89
    v_mov_b32 v89, v88
    s_nop 1
    v_permlane32_swap_b32 v88, v89
    v_add_f32 v88, v88, v89
    v_mul_f32 v88, 0xbacccccd, v88
    v_pk_add_f32 v[64:65], v[64:65], v[88:89] op_sel_hi:[1,0]
    v_pk_add_f32 v[66:67], v[66:67], v[88:89] op_sel_hi:[1,0]
    v_pk_add_f32 v[68:69], v[68:69], v[88:89] op_sel_hi:[1,0]
    v_pk_add_f32 v[70:71], v[70:71], v[88:89] op_sel_hi:[1,0]
    v_pk_add_f32 v[72:73], v[72:73], v[88:89] op_sel_hi:[1,0]
    v_pk_mul_f32 v[88:89], v[64:65], v[64:65]
    v_pk_fma_f32 v[88:89], v[66:67], v[66:67], v[88:89]
    v_pk_fma_f32 v[88:89], v[68:69], v[68:69], v[88:89]
    v_pk_fma_f32 v[88:89], v[70:71], v[70:71], v[88:89]
    v_pk_fma_f32 v[88:89], v[72:73], v[72:73], v[88:89]
    v_add_f32 v88, v88, v89
    s_nop 1
    v_add_f32_dpp v88, v88, v88 quad_perm:[1,0,3,2] row_mask:0xf bank_mask:0xf
    s_nop 1
    v_add_f32_dpp v88, v88, v88 quad_perm:[2,3,0,1] row_mask:0xf bank_mask:0xf
    s_nop 1
    v_add_f32_dpp v88, v88, v88 row_half_mirror row_mask:0xf bank_mask:0xf
    s_nop 1
    v_add_f32_dpp v88, v88, v88 row_mirror row_mask:0xf bank_mask:0xf
    v_mov_b32 v89, v88
    s_nop 1
    v_permlane16_swap_b32 v88, v89
    v_add_f32 v88, v88, v89
    v_mov_b32 v89, v88
    s_nop 1
    v_permlane32_swap_b32 v88, v89
    v_add_f32 v88, v88, v89
    v_mov_b32 v89, 0x3727c5ac
    v_fmac_f32 v89, 0x3acccccd, v88
    v_rsq_f32 v88, v89
    s_nop 0
    v_pk_mul_f32 v[64:65], v[64:65], v[88:89] op_sel_hi:[1,0]
    v_pk_mul_f32 v[66:67], v[66:67], v[88:89] op_sel_hi:[1,0]
    v_pk_mul_f32 v[68:69], v[68:69], v[88:89] op_sel_hi:[1,0]
    v_pk_mul_f32 v[70:71], v[70:71], v[88:89] op_sel_hi:[1,0]
    v_pk_mul_f32 v[72:73], v[72:73], v[88:89] op_sel_hi:[1,0]
    v_cvt_pk_bf16_f32 v82, v64, v65
    v_cvt_pk_bf16_f32 v83, v66, v67
    v_cvt_pk_bf16_f32 v84, v68, v69
    v_cvt_pk_bf16_f32 v85, v70, v71
    v_cvt_pk_bf16_f32 v86, v72, v73
    s_waitcnt vmcnt(2)
    buffer_store_dwordx4 v[82:85], v96, s[4:7], s75 offen sc1
    buffer_store_dword v86, v98, s[4:7], s75 offen sc1
L_Rnext0:
    s_add_u32 s62, s62, 1
    s_add_u32 s65, s62, 1
    v_cmp_gt_u32 vcc, s65, v101
    s_cbranch_vccz L_Rpre1
    buffer_load_dword v101, v100, s[4:7], 0 offen sc1
    s_waitcnt vmcnt(0)
    v_mov_b32 v88, s62
    s_mov_b64 exec, 1
    buffer_store_dword v88, off, s[4:7], s63 sc1
    buffer_store_dword v88, off, s[4:7], s3
    s_mov_b64 exec, -1
Lfchk_106:
    v_cmp_gt_u32 vcc, s65, v101
    s_cbranch_vccnz Lfrty_107
    s_lshr_b32 s70, s71, 8
    s_xor_b32 s70, s70, s1
    s_and_b32 s70, s70, 0x2000
    s_or_b32 s70, s70, s71
    buffer_load_dwordx4 v[4:7], v91, s[4:7], s70 offen sc1
    buffer_load_dword v40, v93, s[4:7], s70 offen sc1
    s_add_u32 s70, s70, 81920
    buffer_load_dwordx4 v[8:11], v91, s[4:7], s70 offen sc1
    buffer_load_dword v41, v93, s[4:7], s70 offen sc1
    s_add_u32 s70, s70, 81920
    buffer_load_dwordx4 v[12:15], v91, s[4:7], s70 offen sc1
    buffer_load_dword v42, v93, s[4:7], s70 offen sc1
    s_add_u32 s70, s70, 81920
    buffer_load_dwordx4 v[16:19], v91, s[4:7], s70 offen sc1
    buffer_load_dword v43, v93, s[4:7], s70 offen sc1
    s_add_u32 s70, s70, 81920
    buffer_load_dwordx4 v[20:23], v91, s[4:7], s70 offen sc1
    buffer_load_dword v44, v93, s[4:7], s70 offen sc1
    s_add_u32 s70, s70, 81920
    buffer_load_dwordx4 v[24:27], v91, s[4:7], s70 offen sc1
    buffer_load_dword v45, v93, s[4:7], s70 offen sc1
    s_add_u32 s70, s70, 81920
    buffer_load_dwordx4 v[28:31], v91, s[4:7], s70 offen sc1
    buffer_load_dword v46, v93, s[4:7], s70 offen sc1
    s_add_u32 s70, s70, 81920
    buffer_load_dwordx4 v[32:35], v91, s[4:7], s70 offen sc1
    buffer_load_dword v47, v93, s[4:7], s70 offen sc1
    s_add_u32 s70, s70, 81920
    buffer_load_dwordx4 v[36:39], v94, s[16:19], s72 offen sc1
    buffer_load_dword v48, v95, s[16:19], s72 offen offset:1024 sc1
    s_add_u32 s72, s72, 20480
    s_add_u32 s71, s71, 1048576
    s_waitcnt vmcnt(17)
    v_mfma_f32_16x16x32_bf16 v[64:67], v[52:55], v[4:7], 0
    v_mfma_f32_16x16x32_bf16 v[68:71], v[56:59], v[4:7], 0
    s_waitcnt vmcnt(15)
    v_mfma_f32_16x16x32_bf16 v[64:67], v[52:55], v[8:11], v[64:67]
    v_mfma_f32_16x16x32_bf16 v[68:71], v[56:59], v[8:11], v[68:71]
    s_waitcnt vmcnt(13)
    v_mfma_f32_16x16x32_bf16 v[64:67], v[52:55], v[12:15], v[64:67]
    v_mfma_f32_16x16x32_bf16 v[68:71], v[56:59], v[12:15], v[68:71]
    s_waitcnt vmcnt(11)
    v_mfma_f32_16x16x32_bf16 v[64:67], v[52:55], v[16:19], v[64:67]
    v_mfma_f32_16x16x32_bf16 v[68:71], v[56:59], v[16:19], v[68:71]
    s_waitcnt vmcnt(10)
    v_mfma_f32_16x16x32_bf16 v[72:75], v[60:63], v[40:43], 0
    s_waitcnt vmcnt(9)
    v_mfma_f32_16x16x32_bf16 v[64:67], v[52:55], v[20:23], v[64:67]
    v_mfma_f32_16x16x32_bf16 v[68:71], v[56:59], v[20:23], v[68:71]
    s_waitcnt vmcnt(7)
    v_mfma_f32_16x16x32_bf16 v[64:67], v[52:55], v[24:27], v[64:67]
    v_mfma_f32_16x16x32_bf16 v[68:71], v[56:59], v[24:27], v[68:71]
    s_waitcnt vmcnt(5)
    v_mfma_f32_16x16x32_bf16 v[64:67], v[52:55], v[28:31], v[64:67]
    v_mfma_f32_16x16x32_bf16 v[68:71], v[56:59], v[28:31], v[68:71]
    s_waitcnt vmcnt(3)
    v_mfma_f32_16x16x32_bf16 v[64:67], v[52:55], v[32:35], v[64:67]
    v_mfma_f32_16x16x32_bf16 v[68:71], v[56:59], v[32:35], v[68:71]
    s_waitcnt vmcnt(2)
    v_mfma_f32_16x16x32_bf16 v[72:75], v[60:63], v[44:47], v[72:75]
    s_waitcnt vmcnt(1)
    v_mfma_f32_16x16x32_bf16 v[64:67], v[52:55], v[36:39], v[64:67]
    v_mfma_f32_16x16x32_bf16 v[68:71], v[56:59], v[36:39], v[68:71]
    s_waitcnt vmcnt(0)
    v_mfma_f32_16x16x32_bf16 v[72:75], v[60:63], v[48:51], v[72:75]
L_Rsum1:
    buffer_load_dword v101, v100, s[4:7], 0 offen sc1
    s_lshr_b32 s75, s74, 8
    s_xor_b32 s75, s75, s79
    s_and_b32 s75, s75, 0x2000
    s_or_b32 s75, s75, s74
    v_cvt_pk_bf16_f32 v76, v64, v65
    v_cvt_pk_bf16_f32 v77, v66, v67
    v_cvt_pk_bf16_f32 v78, v68, v69
    v_cvt_pk_bf16_f32 v79, v70, v71
    v_cvt_pk_bf16_f32 v80, v72, v73
    buffer_store_dwordx4 v[76:79], v94, s[20:23], s73 offen sc1
    buffer_store_dword v80, v95, s[20:23], s73 offen offset:1024 sc1
    s_add_u32 s73, s73, 20480
    s_cmp_eq_u32 s76, 3
    s_cbranch_scc1 L_Rlast1
    v_lshlrev_b32 v64, 16, v76
    v_and_b32 v65, 0xffff0000, v76
    v_lshlrev_b32 v66, 16, v77
    v_and_b32 v67, 0xffff0000, v77
    v_lshlrev_b32 v68, 16, v78
    v_and_b32 v69, 0xffff0000, v78
    v_lshlrev_b32 v70, 16, v79
    v_and_b32 v71, 0xffff0000, v79
    v_lshlrev_b32 v72, 16, v80
    v_and_b32 v73, 0xffff0000, v80
    v_pk_add_f32 v[88:89], v[64:65], v[66:67]
    v_pk_add_f32 v[88:89], v[88:89], v[68:69]
    v_pk_add_f32 v[88:89], v[88:89], v[70:71]
    v_pk_add_f32 v[88:89], v[88:89], v[72:73]
    v_add_f32 v88, v88, v89
    s_nop 1
    v_add_f32_dpp v88, v88, v88 quad_perm:[1,0,3,2] row_mask:0xf bank_mask:0xf
    s_nop 1
    v_add_f32_dpp v88, v88, v88 quad_perm:[2,3,0,1] row_mask:0xf bank_mask:0xf
    s_nop 1
    v_add_f32_dpp v88, v88, v88 row_half_mirror row_mask:0xf bank_mask:0xf
    s_nop 1
    v_add_f32_dpp v88, v88, v88 row_mirror row_mask:0xf bank_mask:0xf
    v_mov_b32 v89, v88
    s_nop 1
    v_permlane16_swap_b32 v88, v89
    v_add_f32 v88, v88, v89
    v_mov_b32 v89, v88
    s_nop 1
    v_permlane32_swap_b32 v88, v89
    v_add_f32 v88, v88, v89
    v_mul_f32 v88, 0xbacccccd, v88
    v_pk_add_f32 v[64:65], v[64:65], v[88:89] op_sel_hi:[1,0]
    v_pk_add_f32 v[66:67], v[66:67], v[88:89] op_sel_hi:[1,0]
    v_pk_add_f32 v[68:69], v[68:69], v[88:89] op_sel_hi:[1,0]
    v_pk_add_f32 v[70:71], v[70:71], v[88:89] op_sel_hi:[1,0]
    v_pk_add_f32 v[72:73], v[72:73], v[88:89] op_sel_hi:[1,0]
    v_pk_mul_f32 v[88:89], v[64:65], v[64:65]
    v_pk_fma_f32 v[88:89], v[66:67], v[66:67], v[88:89]
    v_pk_fma_f32 v[88:89], v[68:69], v[68:69], v[88:89]
    v_pk_fma_f32 v[88:89], v[70:71], v[70:71], v[88:89]
    v_pk_fma_f32 v[88:89], v[72:73], v[72:73], v[88:89]
    v_add_f32 v88, v88, v89
    s_nop 1
    v_add_f32_dpp v88, v88, v88 quad_perm:[1,0,3,2] row_mask:0xf bank_mask:0xf
    s_nop 1
    v_add_f32_dpp v88, v88, v88 quad_perm:[2,3,0,1] row_mask:0xf bank_mask:0xf
    s_nop 1
    v_add_f32_dpp v88, v88, v88 row_half_mirror row_mask:0xf bank_mask:0xf
    s_nop 1
    v_add_f32_dpp v88, v88, v88 row_mirror row_mask:0xf bank_mask:0xf
    v_mov_b32 v89, v88
    s_nop 1
    v_permlane16_swap_b32 v88, v89
    v_add_f32 v88, v88, v89
    v_mov_b32 v89, v88
    s_nop 1
    v_permlane32_swap_b32 v88, v89
    v_add_f32 v88, v88, v89
    v_mov_b32 v89, 0x3727c5ac
    v_fmac_f32 v89, 0x3acccccd, v88
    v_rsq_f32 v88, v89
    s_nop 0
    v_pk_mul_f32 v[64:65], v[64:65], v[88:89] op_sel_hi:[1,0]
    v_pk_mul_f32 v[66:67], v[66:67], v[88:89] op_sel_hi:[1,0]
    v_pk_mul_f32 v[68:69], v[68:69], v[88:89] op_sel_hi:[1,0]
    v_pk_mul_f32 v[70:71], v[70:71], v[88:89] op_sel_hi:[1,0]
    v_pk_mul_f32 v[72:73], v[72:73], v[88:89] op_sel_hi:[1,0]
    v_cvt_pk_bf16_f32 v82, v64, v65
    v_cvt_pk_bf16_f32 v83, v66, v67
    v_cvt_pk_bf16_f32 v84, v68, v69
    v_cvt_pk_bf16_f32 v85, v70, v71
    v_cvt_pk_bf16_f32 v86, v72, v73
    s_waitcnt vmcnt(2)
    buffer_store_dwordx4 v[82:85], v97, s[4:7], s75 offen sc1
    buffer_store_dword v86, v99, s[4:7], s75 offen sc1
L_Rnext1:
    s_add_u32 s62, s62, 1
    s_add_u32 s74, s74, 131072
    s_cmp_lt_u32 s62, 128
    s_cbranch_scc1 L_Rseg
    s_waitcnt vmcnt(0)
    v_mov_b32 v88, s62
    s_mov_b64 exec, 1
    buffer_store_dword v88, off, s[4:7], s63 sc1
    buffer_store_dword v88, off, s[4:7], s3
    s_mov_b64 exec, -1
    s_endpgm
Lgrty_100:
    s_sleep 16
    buffer_load_dword v2, off, s[8:11], 0 offset:132 sc1
    s_sub_u32 s61, s61, 1
    s_mov_b32 s67, 1
    s_cbranch_scc1 L_fail
    s_branch Lgchk_99
Lprty_103:
    s_sleep 16
    buffer_load_dword v2, off, s[8:11], 0 offset:140 sc1
    s_sub_u32 s61, s61, 1
    s_mov_b32 s67, 16
    s_cbranch_scc1 L_fail
    s_branch Lpchk_102
Lfrty_105:
    s_sleep 2
    buffer_load_dword v101, v100, s[4:7], 0 offen sc1
    s_sub_u32 s61, s61, 1
    s_mov_b32 s67, 40
    s_cbranch_scc1 L_fail
    s_waitcnt vmcnt(0)
    s_branch Lfchk_104
L_Rpre0:
    s_lshr_b32 s70, s71, 8
    s_xor_b32 s70, s70, s1
    s_and_b32 s70, s70, 0x2000
    s_or_b32 s70, s70, s71
    buffer_load_dwordx4 v[4:7], v90, s[4:7], s70 offen sc1
    buffer_load_dword v40, v92, s[4:7], s70 offen sc1
    s_add_u32 s70, s70, 81920
    buffer_load_dwordx4 v[8:11], v90, s[4:7], s70 offen sc1
    buffer_load_dword v41, v92, s[4:7], s70 offen sc1
    s_add_u32 s70, s70, 81920
    buffer_load_dwordx4 v[12:15], v90, s[4:7], s70 offen sc1
    buffer_load_dword v42, v92, s[4:7], s70 offen sc1
    s_add_u32 s70, s70, 81920
    buffer_load_dwordx4 v[16:19], v90, s[4:7], s70 offen sc1
    buffer_load_dword v43, v92, s[4:7], s70 offen sc1
    s_add_u32 s70, s70, 81920
    buffer_load_dwordx4 v[20:23], v90, s[4:7], s70 offen sc1
    buffer_load_dword v44, v92, s[4:7], s70 offen sc1
    s_add_u32 s70, s70, 81920
    buffer_load_dwordx4 v[24:27], v90, s[4:7], s70 offen sc1
    buffer_load_dword v45, v92, s[4:7], s70 offen sc1
    s_add_u32 s70, s70, 81920
    buffer_load_dwordx4 v[28:31], v90, s[4:7], s70 offen sc1
    buffer_load_dword v46, v92, s[4:7], s70 offen sc1
    s_add_u32 s70, s70, 81920
    buffer_load_dwordx4 v[32:35], v90, s[4:7], s70 offen sc1
    buffer_load_dword v47, v92, s[4:7], s70 offen sc1
    s_add_u32 s70, s70, 81920
    buffer_load_dwordx4 v[36:39], v94, s[16:19], s72 offen sc1
    buffer_load_dword v48, v95, s[16:19], s72 offen offset:1024 sc1
    s_add_u32 s72, s72, 20480
    s_waitcnt vmcnt(18)
    v_mov_b32 v88, s62
    s_mov_b64 exec, 1
    buffer_store_dword v88, off, s[4:7], s63 sc1
    buffer_store_dword v88, off, s[4:7], s3
    s_mov_b64 exec, -1
    s_waitcnt vmcnt(19)
    v_mfma_f32_16x16x32_bf16 v[64:67], v[52:55], v[4:7], 0
    v_mfma_f32_16x16x32_bf16 v[68:71], v[56:59], v[4:7], 0
    s_waitcnt vmcnt(17)
    v_mfma_f32_16x16x32_bf16 v[64:67], v[52:55], v[8:11], v[64:67]
    v_mfma_f32_16x16x32_bf16 v[68:71], v[56:59], v[8:11], v[68:71]
    s_waitcnt vmcnt(15)
    v_mfma_f32_16x16x32_bf16 v[64:67], v[52:55], v[12:15], v[64:67]
    v_mfma_f32_16x16x32_bf16 v[68:71], v[56:59], v[12:15], v[68:71]
    s_waitcnt vmcnt(13)
    v_mfma_f32_16x16x32_bf16 v[64:67], v[52:55], v[16:19], v[64:67]
    v_mfma_f32_16x16x32_bf16 v[68:71], v[56:59], v[16:19], v[68:71]
    s_waitcnt vmcnt(12)
    v_mfma_f32_16x16x32_bf16 v[72:75], v[60:63], v[40:43], 0
    s_waitcnt vmcnt(11)
    v_mfma_f32_16x16x32_bf16 v[64:67], v[52:55], v[20:23], v[64:67]
    v_mfma_f32_16x16x32_bf16 v[68:71], v[56:59], v[20:23], v[68:71]
    s_waitcnt vmcnt(9)
    v_mfma_f32_16x16x32_bf16 v[64:67], v[52:55], v[24:27], v[64:67]
    v_mfma_f32_16x16x32_bf16 v[68:71], v[56:59], v[24:27], v[68:71]
    s_waitcnt vmcnt(7)
    v_mfma_f32_16x16x32_bf16 v[64:67], v[52:55], v[28:31], v[64:67]
    v_mfma_f32_16x16x32_bf16 v[68:71], v[56:59], v[28:31], v[68:71]
    s_waitcnt vmcnt(5)
    v_mfma_f32_16x16x32_bf16 v[64:67], v[52:55], v[32:35], v[64:67]
    v_mfma_f32_16x16x32_bf16 v[68:71], v[56:59], v[32:35], v[68:71]
    s_waitcnt vmcnt(4)
    v_mfma_f32_16x16x32_bf16 v[72:75], v[60:63], v[44:47], v[72:75]
    s_waitcnt vmcnt(3)
    v_mfma_f32_16x16x32_bf16 v[64:67], v[52:55], v[36:39], v[64:67]
    v_mfma_f32_16x16x32_bf16 v[68:71], v[56:59], v[36:39], v[68:71]
    s_waitcnt vmcnt(2)
    v_mfma_f32_16x16x32_bf16 v[72:75], v[60:63], v[48:51], v[72:75]
    s_branch L_Rsum0
L_Rlast0:
    s_waitcnt vmcnt(2)
    s_branch L_Rnext0
Lfrty_107:
    s_sleep 2
    buffer_load_dword v101, v100, s[4:7], 0 offen sc1
    s_sub_u32 s61, s61, 1
    s_mov_b32 s67, 40
    s_cbranch_scc1 L_fail
    s_waitcnt vmcnt(0)
    s_branch Lfchk_106
L_Rpre1:
    s_lshr_b32 s70, s71, 8
    s_xor_b32 s70, s70, s1
    s_and_b32 s70, s70, 0x2000
    s_or_b32 s70, s70, s71
    buffer_load_dwordx4 v[4:7], v91, s[4:7], s70 offen sc1
    buffer_load_dword v40, v93, s[4:7], s70 offen sc1
    s_add_u32 s70, s70, 81920
    buffer_load_dwordx4 v[8:11], v91, s[4:7], s70 offen sc1
    buffer_load_dword v41, v93, s[4:7], s70 offen sc1
    s_add_u32 s70, s70, 81920
    buffer_load_dwordx4 v[12:15], v91, s[4:7], s70 offen sc1
    buffer_load_dword v42, v93, s[4:7], s70 offen sc1
    s_add_u32 s70, s70, 81920
    buffer_load_dwordx4 v[16:19], v91, s[4:7], s70 offen sc1
    buffer_load_dword v43, v93, s[4:7], s70 offen sc1
    s_add_u32 s70, s70, 81920
    buffer_load_dwordx4 v[20:23], v91, s[4:7], s70 offen sc1
    buffer_load_dword v44, v93, s[4:7], s70 offen sc1
    s_add_u32 s70, s70, 81920
    buffer_load_dwordx4 v[24:27], v91, s[4:7], s70 offen sc1
    buffer_load_dword v45, v93, s[4:7], s70 offen sc1
    s_add_u32 s70, s70, 81920
    buffer_load_dwordx4 v[28:31], v91, s[4:7], s70 offen sc1
    buffer_load_dword v46, v93, s[4:7], s70 offen sc1
    s_add_u32 s70, s70, 81920
    buffer_load_dwordx4 v[32:35], v91, s[4:7], s70 offen sc1
    buffer_load_dword v47, v93, s[4:7], s70 offen sc1
    s_add_u32 s70, s70, 81920
    buffer_load_dwordx4 v[36:39], v94, s[16:19], s72 offen sc1
    buffer_load_dword v48, v95, s[16:19], s72 offen offset:1024 sc1
    s_add_u32 s72, s72, 20480
    s_add_u32 s71, s71, 1048576
    s_waitcnt vmcnt(18)
    v_mov_b32 v88, s62
    s_mov_b64 exec, 1
    buffer_store_dword v88, off, s[4:7], s63 sc1
    buffer_store_dword v88, off, s[4:7], s3
    s_mov_b64 exec, -1
    s_waitcnt vmcnt(19)
    v_mfma_f32_16x16x32_bf16 v[64:67], v[52:55], v[4:7], 0
    v_mfma_f32_16x16x32_bf16 v[68:71], v[56:59], v[4:7], 0
    s_waitcnt vmcnt(17)
    v_mfma_f32_16x16x32_bf16 v[64:67], v[52:55], v[8:11], v[64:67]
    v_mfma_f32_16x16x32_bf16 v[68:71], v[56:59], v[8:11], v[68:71]
    s_waitcnt vmcnt(15)
    v_mfma_f32_16x16x32_bf16 v[64:67], v[52:55], v[12:15], v[64:67]
    v_mfma_f32_16x16x32_bf16 v[68:71], v[56:59], v[12:15], v[68:71]
    s_waitcnt vmcnt(13)
    v_mfma_f32_16x16x32_bf16 v[64:67], v[52:55], v[16:19], v[64:67]
    v_mfma_f32_16x16x32_bf16 v[68:71], v[56:59], v[16:19], v[68:71]
    s_waitcnt vmcnt(12)
    v_mfma_f32_16x16x32_bf16 v[72:75], v[60:63], v[40:43], 0
    s_waitcnt vmcnt(11)
    v_mfma_f32_16x16x32_bf16 v[64:67], v[52:55], v[20:23], v[64:67]
    v_mfma_f32_16x16x32_bf16 v[68:71], v[56:59], v[20:23], v[68:71]
    s_waitcnt vmcnt(9)
    v_mfma_f32_16x16x32_bf16 v[64:67], v[52:55], v[24:27], v[64:67]
    v_mfma_f32_16x16x32_bf16 v[68:71], v[56:59], v[24:27], v[68:71]
    s_waitcnt vmcnt(7)
    v_mfma_f32_16x16x32_bf16 v[64:67], v[52:55], v[28:31], v[64:67]
    v_mfma_f32_16x16x32_bf16 v[68:71], v[56:59], v[28:31], v[68:71]
    s_waitcnt vmcnt(5)
    v_mfma_f32_16x16x32_bf16 v[64:67], v[52:55], v[32:35], v[64:67]
    v_mfma_f32_16x16x32_bf16 v[68:71], v[56:59], v[32:35], v[68:71]
    s_waitcnt vmcnt(4)
    v_mfma_f32_16x16x32_bf16 v[72:75], v[60:63], v[44:47], v[72:75]
    s_waitcnt vmcnt(3)
    v_mfma_f32_16x16x32_bf16 v[64:67], v[52:55], v[36:39], v[64:67]
    v_mfma_f32_16x16x32_bf16 v[68:71], v[56:59], v[36:39], v[68:71]
    s_waitcnt vmcnt(2)
    v_mfma_f32_16x16x32_bf16 v[72:75], v[60:63], v[48:51], v[72:75]
    s_branch L_Rsum1
L_Rlast1:
    s_waitcnt vmcnt(2)
    s_branch L_Rnext1
.section .rodata,"a"
.p2align 6
.amdhsa_kernel interleave_layers__memory_aug_recurrent_mem_tr__sliding_local_dilated__prompt_kernel
  .amdhsa_next_free_vgpr 512
  .amdhsa_next_free_sgpr 102
  .amdhsa_accum_offset 256
  .amdhsa_group_segment_fixed_size 0
  .amdhsa_kernarg_size 104
  .amdhsa_user_sgpr_count 2
  .amdhsa_user_sgpr_kernarg_segment_ptr 1
  .amdhsa_system_sgpr_workgroup_id_x 1
  .amdhsa_float_denorm_mode_32 3
.end_amdhsa_kernel
```
